```python
import torch

def _softmax(x, axis=-1):
    return torch.softmax(x, dim=axis)
def _gelu(x):
    return torch.nn.functional.gelu(x, approximate="tanh")
def _silu(x):
    return torch.nn.functional.silu(x)
def _sigmoid(x):
    return torch.sigmoid(x)
def _layernorm(x, axis=-1, eps=1e-5):
    m = x.mean(dim=axis, keepdim=True)
    v = x.var(dim=axis, keepdim=True, unbiased=False)
    return (x - m) / torch.sqrt(v + eps)
def _scatter_add(tgt, idx, src, axis=0):
    return tgt.clone().index_add_(axis, idx, src)
def _segment_sum(src, seg, n):
    out = torch.zeros((n,) + src.shape[1:], dtype=src.dtype)
    return out.index_add_(0, seg, src)
def _pad(x, pw):
    flat = tuple(v for pair in reversed(pw) for v in pair)
    return torch.nn.functional.pad(x, flat)

kernel_name = 'concat_heads__gqa_block_cached__mha_block_cached__near_ridge'

def setup_inputs():

    _w = (lambda a: (lambda t: t.to(torch.bfloat16) if t.is_floating_point() else t)(torch.as_tensor(a)))
    def _A_setup():
        B, Sq, D = 32, 64, 512
        Hq, Hkv, Sk, Dh = 32, 8, 512, 128
        assert Hq % Hkv == 0, (Hq, Hkv)
        return {
            "x": _w((lambda *s: torch.randn(*s, dtype=torch.bfloat16) * 0.8)(B, Sq, D)),
            "k_cache": _w((lambda *s: torch.randn(*s, dtype=torch.bfloat16) * 0.8)(B, Hkv, Sk, Dh)),
            "v_cache": _w((lambda *s: torch.randn(*s, dtype=torch.bfloat16) * 0.05)(B, Hkv, Sk, Dh)),
            "wq": _w((lambda *s: torch.randn(*s, dtype=torch.bfloat16) * 0.8)(D, Hq * Dh) * (D ** -0.5)),
            "wo": _w((lambda *s: torch.randn(*s, dtype=torch.bfloat16) * 0.05)(Hq * Dh, D) * ((Hq * Dh) ** -0.5)),
        }
    _A_in = _A_setup()

    def _B_setup():
        B, Sq, D = 32, 64, 512
        H, Sk, Dh = 32, 512, 128
        return {
            "x": _w((lambda *s: torch.randn(*s, dtype=torch.bfloat16) * 0.8)(B, Sq, D)),
            "k_cache": _w((lambda *s: torch.randn(*s, dtype=torch.bfloat16) * 0.8)(B, H, Sk, Dh)),
            "v_cache": _w((lambda *s: torch.randn(*s, dtype=torch.bfloat16) * 0.05)(B, H, Sk, Dh)),
            "wq": _w((lambda *s: torch.randn(*s, dtype=torch.bfloat16) * 0.8)(D, H * Dh) * (D ** -0.5)),
            "wo": _w((lambda *s: torch.randn(*s, dtype=torch.bfloat16) * 0.05)(H * Dh, D) * ((H * Dh) ** -0.5)),
        }
    _B_in = _B_setup()

    return {
        "A_x": _A_in["x"],
        "A_k_cache": _A_in["k_cache"],
        "A_v_cache": _A_in["v_cache"],
        "A_wq": _A_in["wq"],
        "A_wo": _A_in["wo"],
        "B_x": _B_in["x"],
        "B_k_cache": _B_in["k_cache"],
        "B_v_cache": _B_in["v_cache"],
        "B_wq": _B_in["wq"],
        "B_wo": _B_in["wo"],
    }

def reference(A_x, A_k_cache, A_v_cache, A_wq, A_wo, B_x, B_k_cache, B_v_cache, B_wq, B_wo):
    def _A_ref(x, k_cache, v_cache, wq, wo):
        B, Sq, D = x.shape
        Hq, Dh = 32, 128
        Hkv = k_cache.shape[1]
        rep = Hq // Hkv
        q = (lambda x, *d: x.permute(*d))((x @ wq).reshape(B, Sq, Hq, Dh), 0, 2, 1, 3)
        k = (lambda x, n, axis: torch.repeat_interleave(x, n, dim=axis))(k_cache, rep, axis=1)
        v = (lambda x, n, axis: torch.repeat_interleave(x, n, dim=axis))(v_cache, rep, axis=1)
        scores = torch.einsum("bhqd,bhkd->bhqk", q, k) * (Dh ** -0.5)
        p = _softmax(scores, axis=-1)
        o = torch.einsum("bhqk,bhkd->bhqd", p, v)
        return (lambda x, *d: x.permute(*d))(o, 0, 2, 1, 3).reshape(B, Sq, Hq * Dh) @ wo

    def _B_ref(x, k_cache, v_cache, wq, wo):
        B, Sq, D = x.shape
        H, Dh = 32, 128
        q = (lambda x, *d: x.permute(*d))((x @ wq).reshape(B, Sq, H, Dh), 0, 2, 1, 3)
        scores = torch.einsum("bhqd,bhkd->bhqk", q, k_cache) * (Dh ** -0.5)
        p = _softmax(scores, axis=-1)
        o = torch.einsum("bhqk,bhkd->bhqd", p, v_cache)
        return (lambda x, *d: x.permute(*d))(o, 0, 2, 1, 3).reshape(B, Sq, H * Dh) @ wo

    a = _A_ref(A_x, A_k_cache, A_v_cache, A_wq, A_wo)
    b = _B_ref(B_x, B_k_cache, B_v_cache, B_wq, B_wo)
    return torch.concatenate([a, b], axis=-1)
```

```asm
; @launch grid=(256,1,1) block=(256,1,1) lds=163840
.amdgcn_target "amdgcn-amd-amdhsa--gfx950"
.macro MA d, a, b
v_mfma_f32_16x16x32_bf16 v[\d:\d+3], a[\a:\a+3], v[\b:\b+3], v[\d:\d+3]
.endm
.macro ZA d, a, b
v_mfma_f32_16x16x32_bf16 v[\d:\d+3], a[\a:\a+3], v[\b:\b+3], 0
.endm
.macro MB d, a, b
v_mfma_f32_16x16x32_bf16 v[\d:\d+3], a[\a:\a+3], a[\b:\b+3], v[\d:\d+3]
.endm
.macro ZB d, a, b
v_mfma_f32_16x16x32_bf16 v[\d:\d+3], a[\a:\a+3], a[\b:\b+3], 0
.endm
.macro MC d, a, b
v_mfma_f32_16x16x32_bf16 a[\d:\d+3], a[\a:\a+3], v[\b:\b+3], a[\d:\d+3]
.endm
.macro ZC d, a, b
v_mfma_f32_16x16x32_bf16 a[\d:\d+3], a[\a:\a+3], v[\b:\b+3], 0
.endm
.macro MD d, a, b
v_mfma_f32_16x16x32_bf16 v[\d:\d+3], v[\a:\a+3], v[\b:\b+3], v[\d:\d+3]
.endm
.macro ZD d, a, b
v_mfma_f32_16x16x32_bf16 v[\d:\d+3], v[\a:\a+3], v[\b:\b+3], 0
.endm

.macro T d, ad, off
ds_read_b64_tr_b16 a[\d:\d+1], v\ad offset:\off*1024
.endm
.macro R f, d, ad, off
ds_read_b128 \f[\d:\d+3], v\ad offset:\off*1024
.endm
.macro G v, r, s, off, fl:vararg
buffer_load_dwordx4 v\v, s[\r:\r+3], s\s offen offset:\off*1024 \fl lds
.endm
.macro W n
s_waitcnt lgkmcnt(\n)
.endm
.macro CV d, a
v_cvt_pk_bf16_f32 v\d, v[\a], v[\a+1]
.endm
.macro E d
v_exp_f32 v\d, v\d
.endm
.macro AW d, s
v_accvgpr_write_b32 a\d, v\s
.endm
.macro AR d, s
v_accvgpr_read_b32 v\d, a\s
.endm
.macro UP d, s
v_lshlrev_b32 v\d, 16, v\s
.endm
.macro UH d, s
v_and_b32 v\d, 0xffff0000, v\s
.endm
.macro PA d, s
v_pk_add_f32 v[\d:\d+1], v[\d:\d+1], v[\s:\s+1]
.endm
.text
.globl concat_heads__gqa_block_cached__mha_block_cached__near_ridge_kernel
.p2align 8
.type concat_heads__gqa_block_cached__mha_block_cached__near_ridge_kernel,@function
concat_heads__gqa_block_cached__mha_block_cached__near_ridge_kernel:
s_cmp_lt_u32 s2, 256
s_cbranch_scc1 L_go
s_endpgm
L_go:
s_load_dwordx16 s[68:83], s[0:1], 0
s_load_dwordx8 s[84:91], s[0:1], 64
s_load_dwordx2 s[92:93], s[0:1], 96
v_lshrrev_b32 v1, 6, v0
v_and_b32 v2, 63, v0
v_readfirstlane_b32 s3, v1
v_lshrrev_b32 v3, 4, v2
v_and_b32 v4, 15, v2
v_lshlrev_b32 v59, 4, v2
s_lshr_b32 s4, s2, 3
s_and_b32 s5, s2, 7
s_and_b32 s95, s4, 3
s_lshr_b32 s94, s4, 2
s_lshr_b32 s6, s4, 1
s_getpc_b64 s[8:9]
L_ct:
s_and_b32 s9, s9, 0xffff
s_mov_b32 s10, L_code_end-L_ct
s_mov_b32 s11, 0x20000
s_mov_b32 s7, L_prog0-L_ct
s_cmp_eq_u32 s95, 1
s_cselect_b32 s7, L_prog1-L_ct, s7
s_cmp_eq_u32 s95, 2
s_cselect_b32 s7, L_prog2-L_ct, s7
s_cmp_eq_u32 s95, 3
s_cselect_b32 s7, L_prog3-L_ct, s7
s_lshl_b32 s56, s94, 2
s_add_u32 s56, s56, s3
s_lshl_b32 s56, s56, 10
s_add_u32 s7, s7, s56
v_and_b32 v62, 0x70, v59
v_lshlrev_b32 v62, 3, v62
buffer_load_dword v0, v62, s[8:11], s7 offen
v_xor_b32 v60, v4, v3
v_lshlrev_b32 v60, 4, v60
v_lshlrev_b32 v61, 1, v3
v_xor_b32 v61, v4, v61
v_lshlrev_b32 v61, 4, v61
s_lshr_b32 s62, s3, 1
s_and_b32 s63, s3, 1
s_and_b32 s64, s6, 1
s_lshr_b32 s67, s6, 2
s_and_b32 s7, s6, 3
s_lshl_b32 s7, s7, 6
v_xor_b32 v62, s7, v60
v_xor_b32 v1, 0, v62
v_lshl_add_u32 v1, v3, 10, v1
v_add_u32 v36, 0, v1
v_xor_b32 v1, 64, v62
v_lshl_add_u32 v1, v3, 10, v1
v_add_u32 v37, 3072, v1
v_xor_b32 v1, 128, v62
v_lshl_add_u32 v1, v3, 10, v1
v_add_u32 v38, 6144, v1
v_xor_b32 v1, 192, v62
v_lshl_add_u32 v1, v3, 10, v1
v_add_u32 v39, 9216, v1
v_lshl_add_u32 v1, v3, 13, v61
v_xor_b32 v63, 0, v1
v_add_u32 v40, 0, v63
v_xor_b32 v63, 128, v1
v_add_u32 v41, 64512, v63
v_xor_b32 v63, 0, v1
v_add_u32 v42, 129024, v63
v_xor_b32 v63, 128, v1
v_add_u32 v43, 193536, v63
s_and_b32 s66, s5, 1
s_lshl_b32 s60, s4, 16
s_lshl_b32 s7, s3, 14
s_xor_b32 s60, s60, s7
s_lshl_b32 s7, s66, 14
s_xor_b32 s60, s60, s7
s_lshl_b32 s7, s67, 8
s_xor_b32 s60, s60, s7
s_lshl_b32 s61, s5, 10
s_lshl_b32 s7, s62, 8
s_xor_b32 s61, s61, s7
s_lshl_b32 s7, s63, 15
s_xor_b32 s61, s61, s7
s_lshl_b32 s7, s6, 18
s_xor_b32 s61, s61, s7
s_lshl_b32 s7, s64, 9
s_xor_b32 s61, s61, s7
s_lshl_b32 s65, s3, 12
W 0
s_mov_b32 s8, s68
s_and_b32 s9, s69, 0xffff
s_mov_b32 s10, 0x200000
s_mov_b32 s11, 0x20000
s_mov_b32 s28, s78
s_and_b32 s29, s79, 0xffff
s_mov_b32 s30, 0x200000
s_mov_b32 s31, 0x20000
s_mov_b32 s20, s74
s_and_b32 s21, s75, 0xffff
s_mov_b32 s22, 0x400000
s_mov_b32 s23, 0x20000
s_mov_b32 s40, s84
s_and_b32 s41, s85, 0xffff
s_mov_b32 s42, 0x400000
s_mov_b32 s43, 0x20000
s_bitcmp1_b32 0xf0f0f0f0, s4
s_cbranch_scc1 L_first_donea
s_bitcmp1_b32 0xb, s95
s_cbranch_scc1 L_first1a
s_xor_b32 m0, s65, 0x0
s_xor_b32 s66, s60, 0x0
G 36,8,66,0
G 37,8,66,1
G 38,8,66,2
G 39,8,66,3
s_xor_b32 m0, s65, 0x4000
s_xor_b32 s66, s61, 0x0
G 40,20,66,0
G 41,20,66,1
G 42,20,66,2
G 43,20,66,3
s_xor_b32 m0, s65, 0x8000
s_xor_b32 s66, s61, 0x40000
G 40,20,66,0
G 41,20,66,1
G 42,20,66,2
G 43,20,66,3
s_branch L_first_donea
L_first1a:
s_xor_b32 m0, s65, 0x0
s_xor_b32 s66, s60, 0x0
G 36,28,66,0
G 37,28,66,1
G 38,28,66,2
G 39,28,66,3
s_xor_b32 m0, s65, 0x4000
s_xor_b32 s66, s61, 0x0
G 40,40,66,0
G 41,40,66,1
G 42,40,66,2
G 43,40,66,3
s_xor_b32 m0, s65, 0x8000
s_xor_b32 s66, s61, 0x40000
G 40,40,66,0
G 41,40,66,1
G 42,40,66,2
G 43,40,66,3
L_first_donea:
s_mov_b32 s12, s70
s_and_b32 s13, s71, 0xffff
s_mov_b32 s14, 0x2000000
s_mov_b32 s15, 0x20000
s_mov_b32 s16, s72
s_and_b32 s17, s73, 0xffff
s_mov_b32 s18, 0x2000000
s_mov_b32 s19, 0x20000
s_mov_b32 s24, s76
s_and_b32 s25, s77, 0xffff
s_mov_b32 s26, 0x400000
s_mov_b32 s27, 0x20000
s_mov_b32 s32, s80
s_and_b32 s33, s81, 0xffff
s_mov_b32 s34, 0x8000000
s_mov_b32 s35, 0x20000
s_mov_b32 s36, s82
s_and_b32 s37, s83, 0xffff
s_mov_b32 s38, 0x8000000
s_mov_b32 s39, 0x20000
s_mov_b32 s44, s86
s_and_b32 s45, s87, 0xffff
s_mov_b32 s46, 0x400000
s_mov_b32 s47, 0x20000
s_mov_b32 s56, s88
s_and_b32 s57, s89, 0xffff
s_mov_b32 s58, 0x400000
s_mov_b32 s59, 0x20000
s_mov_b32 s96, s90
s_and_b32 s97, s91, 0xffff
s_mov_b32 s98, 0x100
s_mov_b32 s99, 0x20000
s_mov_b32 s52, s92
s_and_b32 s53, s93, 0xffff
s_mov_b32 s54, 0x20000000
s_mov_b32 s55, 0x20000
s_lshl_b32 s1, s94, 2
s_add_u32 s1, s1, s3
s_lshl_b32 s1, s1, 10
s_cmp_lt_u32 s3, 2
s_cselect_b32 s48, s12, s16
s_cselect_b32 s49, s13, s17
s_mov_b32 s50, 0x2000000
s_mov_b32 s51, 0x20000
s_and_b32 s82, s94, 1
s_bfe_u32 s83, s94, 0x10001
s_bfe_u32 s84, s94, 0x10002
s_mov_b32 s90, s62
s_mov_b32 s91, s63
s_mov_b32 s92, s64
s_bfe_u32 s93, s6, 0x20001
s_lshr_b32 s94, s6, 3
s_lshl_b32 s62, s5, 19
s_lshl_b32 s7, s92, 18
s_xor_b32 s62, s62, s7
s_lshl_b32 s7, s90, 17
s_xor_b32 s62, s62, s7
s_lshl_b32 s7, s93, 15
s_xor_b32 s62, s62, s7
s_lshl_b32 s7, s91, 14
s_xor_b32 s62, s62, s7
s_lshl_b32 s7, s90, 9
s_xor_b32 s62, s62, s7
s_lshl_b32 s7, s94, 8
s_xor_b32 s62, s62, s7
s_lshl_b32 s63, s4, 22
s_lshl_b32 s7, s5, 19
s_xor_b32 s63, s63, s7
s_lshl_b32 s7, s92, 18
s_xor_b32 s63, s63, s7
s_lshl_b32 s7, s90, 17
s_xor_b32 s63, s63, s7
s_lshl_b32 s7, s91, 9
s_xor_b32 s63, s63, s7
s_lshl_b32 s7, s90, 13
s_xor_b32 s63, s63, s7
s_lshl_b32 s7, s82, 12
s_xor_b32 s63, s63, s7
s_lshl_b32 s7, s83, 14
s_xor_b32 s63, s63, s7
s_lshl_b32 s64, s4, 20
s_lshl_b32 s7, s5, 17
s_xor_b32 s64, s64, s7
s_lshl_b32 s7, s91, 9
s_xor_b32 s64, s64, s7
s_lshl_b32 s7, s82, 13
s_xor_b32 s64, s64, s7
s_lshl_b32 s7, s83, 12
s_xor_b32 s64, s64, s7
s_lshl_b32 s7, s84, 14
s_xor_b32 s64, s64, s7
s_lshl_b32 s67, s4, 19
s_lshl_b32 s7, s5, 16
s_xor_b32 s67, s67, s7
s_lshl_b32 s7, s3, 10
s_xor_b32 s67, s67, s7
s_lshl_b32 s68, s90, 13
s_lshl_b32 s69, s91, 13
s_xor_b32 s70, s68, s69
s_xor_b32 s71, s68, 0x2000
s_mov_b32 s74, 0x3e0293ee
s_mov_b32 s75, 0x3e0293ee
s_mov_b32 s76, 0x2f800000
s_mov_b32 s77, 0x57800000
s_lshl_b32 s78, s3, 13
s_add_u32 s78, s78, 131072
v_add_u32 v58, s78, v59
s_lshr_b32 s84, s5, 1
s_and_b32 s83, s5, 1
s_lshl_b32 s72, s4, 9
s_lshl_b32 s7, s3, 5
s_xor_b32 s72, s72, s7
s_add_u32 s72, s72, 0x4000000
s_lshl_b32 s87, s4, 2
s_cmp_eq_u32 s3, 0
s_cselect_b32 s86, s87, 0x1000
s_lshl_b32 s4, s4, 17
s_lshl_b32 s7, s91, 16
s_xor_b32 s4, s4, s7
s_lshl_b32 s7, s83, 15
s_xor_b32 s4, s4, s7
s_lshl_b32 s7, s90, 9
s_xor_b32 s4, s4, s7
s_lshl_b32 s7, s94, 8
s_xor_b32 s4, s4, s7
s_lshl_b32 s7, s84, 6
s_xor_b32 s4, s4, s7
s_lshl_b32 s7, s5, 2
s_add_u32 s5, s72, s7
s_lshl_b32 s7, s84, 6
v_lshl_add_u32 v1, v3, 10, v61
v_xor_b32 v1, s7, v1
v_xor_b32 v63, 0, v1
v_add_u32 v44, 0, v63
v_xor_b32 v63, 128, v1
v_add_u32 v45, 3072, v63
v_xor_b32 v63, 0, v1
v_add_u32 v46, 6144, v63
v_xor_b32 v63, 128, v1
v_add_u32 v47, 9216, v63
v_and_b32 v62, 1, v3
v_lshlrev_b32 v62, 8, v62
v_lshrrev_b32 v63, 1, v3
v_lshl_add_u32 v62, v63, 15, v62
v_add_u32 v1, v62, v60
v_xor_b32 v32, 0, v1
v_xor_b32 v33, 64, v1
v_xor_b32 v34, 128, v1
v_xor_b32 v35, 192, v1
s_lshl_b32 s7, s93, 6
v_add_u32 v1, v62, v61
v_xor_b32 v56, s7, v1
v_xor_b32 v57, 128, v56
s_cmp_lt_u32 s3, 2
s_cselect_b64 vcc, -1, 0
v_cndmask_b32 v48, v56, v32, vcc
v_cndmask_b32 v49, v57, v33, vcc
v_cndmask_b32 v50, v56, v34, vcc
v_cndmask_b32 v51, v57, v35, vcc
v_lshl_add_u32 v61, v4, 8, v60
v_xor_b32 v61, s69, v61
v_xor_b32 v8, 0, v61
v_xor_b32 v12, 0x10000, v61
v_xor_b32 v9, 64, v61
v_xor_b32 v13, 0x10040, v61
v_xor_b32 v10, 128, v61
v_xor_b32 v14, 0x10080, v61
v_xor_b32 v11, 192, v61
v_xor_b32 v15, 0x100c0, v61
v_lshrrev_b32 v1, 2, v2
v_lshlrev_b32 v61, 8, v1
v_and_b32 v1, 7, v1
v_lshl_add_u32 v61, v1, 5, v61
v_and_b32 v1, 3, v2
v_lshl_add_u32 v61, v1, 3, v61
v_xor_b32 v61, s68, v61
v_xor_b32 v16, 0, v61
v_xor_b32 v24, 0x10000, v61
v_xor_b32 v17, 32, v61
v_xor_b32 v25, 0x10020, v61
v_xor_b32 v18, 64, v61
v_xor_b32 v26, 0x10040, v61
v_xor_b32 v19, 96, v61
v_xor_b32 v27, 0x10060, v61
v_xor_b32 v20, 128, v61
v_xor_b32 v28, 0x10080, v61
v_xor_b32 v21, 160, v61
v_xor_b32 v29, 0x100a0, v61
v_xor_b32 v22, 192, v61
v_xor_b32 v30, 0x100c0, v61
v_xor_b32 v23, 224, v61
v_xor_b32 v31, 0x100e0, v61
v_cmp_eq_u32 vcc, 0, v1
v_mov_b32 v61, 0x3f803f80
s_nop 0
v_cndmask_b32 v52, 0, v61, vcc
v_cndmask_b32 v53, 0, v61, vcc
v_cndmask_b32 v54, 0, v61, vcc
v_cndmask_b32 v55, 0, v61, vcc
v_xor_b32 v2, 0x4000, v58
s_lshr_b32 s7, s2, 3
s_bitcmp1_b32 0xf0f0f0f0, s7
s_cbranch_scc0 L_first_donec
s_bitcmp1_b32 0xb, s95
s_cbranch_scc1 L_first1c
s_xor_b32 m0, s65, 0x0
s_xor_b32 s66, s60, 0x0
G 36,8,66,0
G 37,8,66,1
G 38,8,66,2
G 39,8,66,3
s_xor_b32 m0, s65, 0x4000
s_xor_b32 s66, s61, 0x0
G 40,20,66,0
G 41,20,66,1
G 42,20,66,2
G 43,20,66,3
s_xor_b32 m0, s65, 0x8000
s_xor_b32 s66, s61, 0x40000
G 40,20,66,0
G 41,20,66,1
G 42,20,66,2
G 43,20,66,3
s_branch L_first_donec
L_first1c:
s_xor_b32 m0, s65, 0x0
s_xor_b32 s66, s60, 0x0
G 36,28,66,0
G 37,28,66,1
G 38,28,66,2
G 39,28,66,3
s_xor_b32 m0, s65, 0x4000
s_xor_b32 s66, s61, 0x0
G 40,40,66,0
G 41,40,66,1
G 42,40,66,2
G 43,40,66,3
s_xor_b32 m0, s65, 0x8000
s_xor_b32 s66, s61, 0x40000
G 40,40,66,0
G 41,40,66,1
G 42,40,66,2
G 43,40,66,3
L_first_donec:
s_bitcmp1_b32 0xb, s95
s_cbranch_scc1 L_first1b
s_xor_b32 m0, s65, 0xc000
s_xor_b32 s66, s60, 0x100
G 36,8,66,0
G 37,8,66,1
G 38,8,66,2
G 39,8,66,3
s_xor_b32 m0, s65, 0x10000
s_xor_b32 s66, s61, 0x80000
G 40,20,66,0
G 41,20,66,1
G 42,20,66,2
G 43,20,66,3
s_branch L_first_doneb
L_first1b:
s_xor_b32 m0, s65, 0xc000
s_xor_b32 s66, s60, 0x100
G 36,28,66,0
G 37,28,66,1
G 38,28,66,2
G 39,28,66,3
s_xor_b32 m0, s65, 0x10000
s_xor_b32 s66, s61, 0x80000
G 40,40,66,0
G 41,40,66,1
G 42,40,66,2
G 43,40,66,3
L_first_doneb:
s_cmp_lg_u32 s95, 1
s_cbranch_scc1 L_not1
s_getpc_b64 s[82:83]
L_here1:
s_add_u32 s82, s82, L_prog1-L_here1
s_addc_u32 s83, s83, 0
s_setpc_b64 s[82:83]
L_not1:
s_cmp_lg_u32 s95, 2
s_cbranch_scc1 L_not2
s_getpc_b64 s[82:83]
L_here2:
s_add_u32 s82, s82, L_prog2-L_here2
s_addc_u32 s83, s83, 0
s_setpc_b64 s[82:83]
L_not2:
s_cmp_lg_u32 s95, 3
s_cbranch_scc1 L_not3
s_getpc_b64 s[82:83]
L_here3:
s_add_u32 s82, s82, L_prog3-L_here3
s_addc_u32 s83, s83, 0
s_setpc_b64 s[82:83]
L_not3:
.p2align 6
L_prog0:
s_waitcnt vmcnt(12)
s_barrier
R v,128,8,0
R v,132,8,4
R v,136,9,0
R v,140,9,4
R v,144,10,0
R v,148,10,4
R v,152,11,0
R v,156,11,4
T 0,16,16
T 2,16,20
T 4,17,16
T 6,17,20
T 8,18,16
T 10,18,20
T 12,19,16
W 14
T 14,19,20
W 14
T 16,20,16
W 14
T 18,20,20
s_xor_b32 m0, s65, 0x14000
s_xor_b32 s66, s61, 0xc0000
G 40,40,66,0
G 41,40,66,1
W 6
ZA 64,0,128
G 42,40,66,2
ZA 68,0,132
G 43,40,66,3
T 20,21,16
T 22,21,20
ZA 72,4,128
s_xor_b32 m0, s65, 0x18000
s_xor_b32 s66, s61, 0x100000
G 40,40,66,0
ZA 76,4,132
G 41,40,66,1
T 24,22,16
T 26,22,20
W 6
ZA 80,8,128
G 42,40,66,2
ZA 84,8,132
G 43,40,66,3
T 28,23,16
T 30,23,20
ZA 88,12,128
s_waitcnt vmcnt(16)
s_barrier
T 32,16,32
ZA 92,12,132
T 34,16,36
s_xor_b32 m0, s65, 0x1c000
s_xor_b32 s66, s61, 0x140000
W 6
ZA 96,16,128
G 40,40,66,0
ZA 100,16,132
T 36,17,32
T 38,17,36
ZA 104,20,128
G 41,40,66,1
ZA 108,20,132
T 40,18,32
T 42,18,36
W 6
ZA 112,24,128
G 42,40,66,2
ZA 116,24,132
T 44,19,32
T 46,19,36
ZA 120,28,128
G 43,40,66,3
ZA 124,28,132
T 48,20,32
T 50,20,36
W 6
MA 64,32,136
s_waitcnt vmcnt(16)
s_barrier
s_xor_b32 m0, s65, 0x0
s_xor_b32 s66, s60, 0x200
G 36,28,66,0
MA 68,32,140
G 37,28,66,1
T 52,21,32
T 54,21,36
R v,160,8,48
MA 72,36,136
G 38,28,66,2
MA 76,36,140
T 56,22,32
T 58,22,36
R v,164,8,52
W 8
MA 80,40,136
G 39,28,66,3
MA 84,40,140
T 60,23,32
T 62,23,36
R v,168,9,48
MA 88,44,136
s_waitcnt vmcnt(16)
s_barrier
MA 92,44,140
R v,172,9,52
T 0,24,0
T 2,24,4
W 10
MA 96,48,136
R v,176,10,48
MA 100,48,140
T 4,25,0
T 6,25,4
MA 104,52,136
R v,180,10,52
MA 108,52,140
T 8,26,0
W 14
T 10,26,4
W 10
MA 112,56,136
R v,184,11,48
MA 116,56,140
T 12,27,0
T 14,27,4
MA 120,60,136
R v,188,11,52
MA 124,60,140
T 16,28,0
W 14
T 18,28,4
W 9
MA 64,0,144
T 20,29,0
MA 68,0,148
T 22,29,4
MA 72,4,144
T 24,30,0
MA 76,4,148
T 26,30,4
W 7
MA 80,8,144
T 28,31,0
MA 84,8,148
T 30,31,4
MA 88,12,144
s_waitcnt vmcnt(12) lgkmcnt(8)
s_barrier
s_xor_b32 m0, s65, 0x4000
s_xor_b32 s66, s61, 0x180000
MA 92,12,148
G 40,40,66,0
T 32,24,16
T 34,24,20
W 6
MA 96,16,144
G 41,40,66,1
MA 100,16,148
T 36,25,16
T 38,25,20
MA 104,20,144
G 42,40,66,2
MA 108,20,148
T 40,26,16
T 42,26,20
v_mov_b32 v61, 0
v_lshlrev_b32 v62, 3, v59
s_mov_b64 exec, 15
buffer_store_dword v61, v62, s[52:55], s5 offen sc1
s_mov_b64 exec, -1
W 6
MA 112,24,144
G 43,40,66,3
MA 116,24,148
T 44,27,16
T 46,27,20
MA 120,28,144
s_xor_b32 m0, s65, 0x8000
s_xor_b32 s66, s61, 0x1c0000
MA 124,28,148
G 40,40,66,0
T 48,28,16
T 50,28,20
W 6
MA 64,32,152
G 41,40,66,1
MA 68,32,156
T 52,29,16
T 54,29,20
MA 72,36,152
G 42,40,66,2
MA 76,36,156
T 56,30,16
T 58,30,20
W 6
MA 80,40,152
G 43,40,66,3
MA 84,40,156
T 60,31,16
T 62,31,20
MA 88,44,152
s_waitcnt vmcnt(17)
s_barrier
T 0,24,32
MA 92,44,156
T 2,24,36
s_xor_b32 m0, s65, 0xc000
s_xor_b32 s66, s61, 0x200000
W 6
MA 96,48,152
G 40,40,66,0
MA 100,48,156
T 4,25,32
T 6,25,36
MA 104,52,152
T 8,26,32
MA 108,52,156
T 10,26,36
W 6
MA 112,56,152
G 41,40,66,1
MA 116,56,156
T 12,27,32
T 14,27,36
MA 120,60,152
T 16,28,32
MA 124,60,156
T 18,28,36
W 6
MA 64,0,160
G 42,40,66,2
MA 68,0,164
T 20,29,32
T 22,29,36
MA 72,4,160
T 24,30,32
MA 76,4,164
T 26,30,36
W 6
MA 80,8,160
G 43,40,66,3
MA 84,8,164
T 28,31,32
T 30,31,36
MA 88,12,160
s_waitcnt vmcnt(17)
s_barrier
T 32,24,48
MA 92,12,164
T 34,24,52
s_xor_b32 m0, s65, 0x10000
s_xor_b32 s66, s61, 0x240000
W 6
MA 96,16,160
G 40,40,66,0
MA 100,16,164
T 36,25,48
T 38,25,52
MA 104,20,160
G 41,40,66,1
MA 108,20,164
T 40,26,48
T 42,26,52
W 6
MA 112,24,160
G 42,40,66,2
MA 116,24,164
T 44,27,48
T 46,27,52
MA 120,28,160
G 43,40,66,3
MA 124,28,164
T 48,28,48
T 50,28,52
W 6
MA 64,32,168
s_waitcnt vmcnt(17)
s_barrier
s_xor_b32 m0, s65, 0x14000
s_xor_b32 s66, s60, 0x300
G 36,28,66,0
MA 68,32,172
G 37,28,66,1
T 52,29,48
T 54,29,52
R v,192,8,0
MA 72,36,168
G 38,28,66,2
MA 76,36,172
T 56,30,48
T 58,30,52
R v,196,8,4
W 8
MA 80,40,168
G 39,28,66,3
MA 84,40,172
T 60,31,48
T 62,31,52
R v,200,9,0
MA 88,44,168
s_waitcnt vmcnt(16)
s_barrier
MA 92,44,172
R v,204,9,4
T 0,16,16
T 2,16,20
W 10
MA 96,48,168
R v,208,10,0
MA 100,48,172
T 4,17,16
T 6,17,20
MA 104,52,168
R v,212,10,4
MA 108,52,172
T 8,18,16
W 14
T 10,18,20
W 10
MA 112,56,168
R v,216,11,0
MA 116,56,172
T 12,19,16
T 14,19,20
MA 120,60,168
R v,220,11,4
MA 124,60,172
T 16,20,16
W 14
T 18,20,20
W 9
MA 64,0,176
T 20,21,16
MA 68,0,180
T 22,21,20
MA 72,4,176
T 24,22,16
MA 76,4,180
T 26,22,20
W 7
MA 80,8,176
T 28,23,16
MA 84,8,180
T 30,23,20
MA 88,12,176
s_waitcnt vmcnt(12) lgkmcnt(8)
s_barrier
s_xor_b32 m0, s65, 0x18000
s_xor_b32 s66, s61, 0x280000
MA 92,12,180
G 40,40,66,0
T 32,16,32
T 34,16,36
W 6
MA 96,16,176
G 41,40,66,1
MA 100,16,180
T 36,17,32
T 38,17,36
MA 104,20,176
G 42,40,66,2
MA 108,20,180
T 40,18,32
T 42,18,36
W 6
MA 112,24,176
G 43,40,66,3
MA 116,24,180
T 44,19,32
T 46,19,36
MA 120,28,176
s_xor_b32 m0, s65, 0x1c000
s_xor_b32 s66, s61, 0x2c0000
MA 124,28,180
G 40,40,66,0
T 48,20,32
T 50,20,36
W 6
MA 64,32,184
G 41,40,66,1
MA 68,32,188
T 52,21,32
T 54,21,36
MA 72,36,184
G 42,40,66,2
MA 76,36,188
T 56,22,32
T 58,22,36
W 6
MA 80,40,184
G 43,40,66,3
MA 84,40,188
T 60,23,32
T 62,23,36
MA 88,44,184
s_waitcnt vmcnt(16)
s_barrier
T 0,16,48
MA 92,44,188
T 2,16,52
s_xor_b32 m0, s65, 0x0
s_xor_b32 s66, s61, 0x300000
W 6
MA 96,48,184
G 40,40,66,0
MA 100,48,188
T 4,17,48
T 6,17,52
MA 104,52,184
T 8,18,48
MA 108,52,188
T 10,18,52
W 6
MA 112,56,184
G 41,40,66,1
MA 116,56,188
T 12,19,48
T 14,19,52
MA 120,60,184
T 16,20,48
MA 124,60,188
T 18,20,52
W 6
MA 64,0,192
G 42,40,66,2
MA 68,0,196
T 20,21,48
T 22,21,52
MA 72,4,192
T 24,22,48
MA 76,4,196
T 26,22,52
W 6
MA 80,8,192
G 43,40,66,3
MA 84,8,196
T 28,23,48
T 30,23,52
MA 88,12,192
s_waitcnt vmcnt(16)
s_barrier
T 32,24,0
MA 92,12,196
T 34,24,4
s_xor_b32 m0, s65, 0x4000
s_xor_b32 s66, s61, 0x340000
W 6
MA 96,16,192
G 40,40,66,0
MA 100,16,196
T 36,25,0
T 38,25,4
MA 104,20,192
G 41,40,66,1
MA 108,20,196
T 40,26,0
T 42,26,4
v_mov_b32 v61, 1
v_mov_b32 v62, 0
s_mov_b64 exec, 1
buffer_atomic_add v61, v62, s[96:99], s86 offen sc1
s_mov_b64 exec, -1
s_mov_b32 s6, 0
W 6
MA 112,24,192
G 42,40,66,2
MA 116,24,196
T 44,27,0
T 46,27,4
MA 120,28,192
G 43,40,66,3
MA 124,28,196
T 48,28,0
T 50,28,4
W 6
MA 64,32,200
s_waitcnt vmcnt(17)
s_barrier
s_xor_b32 m0, s65, 0x8000
s_xor_b32 s66, s61, 0x380000
G 40,40,66,0
MA 68,32,204
G 41,40,66,1
T 52,29,0
T 54,29,4
R v,224,12,16
MA 72,36,200
G 42,40,66,2
MA 76,36,204
T 56,30,0
T 58,30,4
R v,228,12,20
W 8
MA 80,40,200
G 43,40,66,3
MA 84,40,204
T 60,31,0
T 62,31,4
R v,232,13,16
MA 88,44,200
s_waitcnt vmcnt(17)
s_barrier
MA 92,44,204
R v,236,13,20
T 0,24,32
T 2,24,36
W 10
MA 96,48,200
R v,240,14,16
MA 100,48,204
T 4,25,32
T 6,25,36
MA 104,52,200
R v,244,14,20
MA 108,52,204
T 8,26,32
W 14
T 10,26,36
W 10
MA 112,56,200
R v,248,15,16
MA 116,56,204
T 12,27,32
T 14,27,36
MA 120,60,200
R v,252,15,20
T 16,28,32
MA 124,60,204
W 14
T 18,28,36
v_xor_b32 v8, s70, v8
W 9
MA 64,0,208
T 20,29,32
MA 68,0,212
T 22,29,36
v_xor_b32 v9, s70, v9
MA 72,4,208
T 24,30,32
MA 76,4,212
T 26,30,36
v_xor_b32 v10, s70, v10
W 7
MA 80,8,208
T 28,31,32
MA 84,8,212
T 30,31,36
v_xor_b32 v11, s70, v11
MA 88,12,208
s_waitcnt vmcnt(13) lgkmcnt(8)
s_barrier
s_xor_b32 m0, s65, 0xc000
s_xor_b32 s66, s61, 0x3c0000
MA 92,12,212
G 40,40,66,0
T 32,24,48
T 34,24,52
v_xor_b32 v12, s70, v12
W 6
MA 96,16,208
G 41,40,66,1
MA 100,16,212
T 36,25,48
T 38,25,52
v_xor_b32 v13, s70, v13
MA 104,20,208
G 42,40,66,2
MA 108,20,212
T 40,26,48
T 42,26,52
v_xor_b32 v14, s70, v14
W 6
MA 112,24,208
G 43,40,66,3
MA 116,24,212
T 44,27,48
T 46,27,52
v_xor_b32 v15, s70, v15
MA 120,28,208
s_xor_b32 m0, s65, 0x10000
s_xor_b32 s66, s63, 0x0
MA 124,28,212
G 32,32,66,0,nt
T 48,28,48
T 50,28,52
W 6
MA 64,32,216
G 33,32,66,1,nt
MA 68,32,220
T 52,29,48
T 54,29,52
MA 72,36,216
G 34,32,66,2,nt
MA 76,36,220
T 56,30,48
T 58,30,52
W 6
MA 80,40,216
G 35,32,66,3,nt
MA 84,40,220
T 60,31,48
T 62,31,52
MA 88,44,216
s_waitcnt vmcnt(17)
s_barrier
T 0,16,0
MA 92,44,220
T 2,16,4
s_xor_b32 m0, s65, 0x14000
s_xor_b32 s66, s63, 0x10000
W 6
MA 96,48,216
G 32,32,66,0,nt
MA 100,48,220
T 4,17,0
T 6,17,4
MA 104,52,216
T 8,18,0
MA 108,52,220
T 10,18,4
W 6
MA 112,56,216
G 33,32,66,1,nt
MA 116,56,220
T 12,19,0
T 14,19,4
MA 120,60,216
T 16,20,0
MA 124,60,220
T 18,20,4
W 6
MA 64,0,224
G 34,32,66,2,nt
MA 68,0,228
T 20,21,0
T 22,21,4
MA 72,4,224
T 24,22,0
MA 76,4,228
T 26,22,4
W 6
MA 80,8,224
G 35,32,66,3,nt
MA 84,8,228
T 28,23,0
T 30,23,4
MA 88,12,224
s_waitcnt vmcnt(16)
s_barrier
T 32,16,16
MA 92,12,228
T 34,16,20
s_xor_b32 m0, s65, 0x18000
s_xor_b32 s66, s63, 0x0
W 6
MA 96,16,224
G 56,36,66,0,nt
MA 100,16,228
T 36,17,16
T 38,17,20
MA 104,20,224
T 40,18,16
MA 108,20,228
T 42,18,20
W 6
MA 112,24,224
G 57,36,66,1,nt
MA 116,24,228
T 44,19,16
T 46,19,20
MA 120,28,224
T 48,20,16
MA 124,28,228
T 50,20,20
W 6
MA 64,32,232
G 56,36,66,2,nt
MA 68,32,236
T 52,21,16
T 54,21,20
MA 72,36,232
T 56,22,16
MA 76,36,236
T 58,22,20
W 6
MA 80,40,232
G 57,36,66,3,nt
MA 84,40,236
T 60,23,16
T 62,23,20
MA 88,44,232
s_waitcnt vmcnt(16)
s_barrier
T 0,16,32
MA 92,44,236
T 2,16,36
s_xor_b32 m0, s65, 0x1c000
s_xor_b32 s66, s63, 0x4000
W 6
MA 96,48,232
G 32,32,66,0,nt
MA 100,48,236
T 4,17,32
T 6,17,36
MA 104,52,232
T 8,18,32
MA 108,52,236
T 10,18,36
W 6
MA 112,56,232
G 33,32,66,1,nt
MA 116,56,236
T 12,19,32
T 14,19,36
MA 120,60,232
T 16,20,32
MA 124,60,236
T 18,20,36
W 6
MA 64,0,240
G 34,32,66,2,nt
MA 68,0,244
T 20,21,32
T 22,21,36
MA 72,4,240
T 24,22,32
MA 76,4,244
T 26,22,36
W 6
MA 80,8,240
G 35,32,66,3,nt
MA 84,8,244
T 28,23,32
T 30,23,36
MA 88,12,240
s_waitcnt vmcnt(16)
s_barrier
MA 92,12,244
T 32,16,48
T 34,16,52
W 6
MA 96,16,240
T 36,17,48
MA 100,16,244
T 38,17,52
MA 104,20,240
T 40,18,48
MA 108,20,244
T 42,18,52
W 6
MA 112,24,240
T 44,19,48
MA 116,24,244
T 46,19,52
MA 120,28,240
T 48,20,48
MA 124,28,244
T 50,20,52
W 6
MA 64,32,248
T 52,21,48
MA 68,32,252
T 54,21,52
MA 72,36,248
T 56,22,48
MA 76,36,252
T 58,22,52
W 6
MA 80,40,248
T 60,23,48
MA 84,40,252
T 62,23,52
MA 88,44,248
s_waitcnt vmcnt(12)
s_barrier
MA 92,44,252
R a,0,12,0
s_xor_b32 m0, s65, 0x0
s_xor_b32 s66, s63, 0x10000
W 5
MA 96,48,248
G 56,36,66,0,nt
MA 100,48,252
R a,4,13,0
MA 104,52,248
R a,8,14,0
MA 108,52,252
W 3
MA 112,56,248
G 57,36,66,1,nt
MA 116,56,252
R a,12,15,0
MA 120,60,248
R a,16,12,4
MA 124,60,252
v_pk_mul_f32 v[64:65], v[64:65], s[74:75]
v_pk_mul_f32 v[66:67], v[66:67], s[74:75]
v_pk_mul_f32 v[68:69], v[68:69], s[74:75]
v_pk_mul_f32 v[70:71], v[70:71], s[74:75]
v_pk_mul_f32 v[72:73], v[72:73], s[74:75]
v_pk_mul_f32 v[74:75], v[74:75], s[74:75]
v_pk_mul_f32 v[76:77], v[76:77], s[74:75]
v_pk_mul_f32 v[78:79], v[78:79], s[74:75]
CV 64,64
CV 66,66
CV 68,68
CV 70,70
CV 72,72
CV 74,74
CV 76,76
CV 78,78
v_permlane32_swap_b32 v64, v72
v_permlane32_swap_b32 v66, v74
v_permlane32_swap_b32 v68, v76
v_permlane32_swap_b32 v70, v78
v_permlane16_swap_b32 v64, v72
v_permlane16_swap_b32 v66, v74
v_permlane16_swap_b32 v68, v76
v_permlane16_swap_b32 v70, v78
AW 64,64
AW 65,66
AW 66,72
AW 67,74
AW 68,68
AW 69,70
AW 70,76
AW 71,78
v_pk_mul_f32 v[80:81], v[80:81], s[74:75]
v_pk_mul_f32 v[82:83], v[82:83], s[74:75]
v_pk_mul_f32 v[84:85], v[84:85], s[74:75]
v_pk_mul_f32 v[86:87], v[86:87], s[74:75]
v_pk_mul_f32 v[88:89], v[88:89], s[74:75]
v_pk_mul_f32 v[90:91], v[90:91], s[74:75]
v_pk_mul_f32 v[92:93], v[92:93], s[74:75]
v_pk_mul_f32 v[94:95], v[94:95], s[74:75]
CV 80,80
CV 82,82
CV 84,84
CV 86,86
CV 88,88
CV 90,90
CV 92,92
CV 94,94
v_permlane32_swap_b32 v80, v88
v_permlane32_swap_b32 v82, v90
v_permlane32_swap_b32 v84, v92
v_permlane32_swap_b32 v86, v94
v_permlane16_swap_b32 v80, v88
v_permlane16_swap_b32 v82, v90
v_permlane16_swap_b32 v84, v92
v_permlane16_swap_b32 v86, v94
AW 72,80
AW 73,82
AW 74,88
AW 75,90
AW 76,84
AW 77,86
AW 78,92
AW 79,94
v_pk_mul_f32 v[96:97], v[96:97], s[74:75]
v_pk_mul_f32 v[98:99], v[98:99], s[74:75]
v_pk_mul_f32 v[100:101], v[100:101], s[74:75]
v_pk_mul_f32 v[102:103], v[102:103], s[74:75]
v_pk_mul_f32 v[104:105], v[104:105], s[74:75]
v_pk_mul_f32 v[106:107], v[106:107], s[74:75]
v_pk_mul_f32 v[108:109], v[108:109], s[74:75]
v_pk_mul_f32 v[110:111], v[110:111], s[74:75]
CV 96,96
CV 98,98
CV 100,100
CV 102,102
CV 104,104
CV 106,106
CV 108,108
CV 110,110
v_permlane32_swap_b32 v96, v104
v_permlane32_swap_b32 v98, v106
v_permlane32_swap_b32 v100, v108
v_permlane32_swap_b32 v102, v110
v_permlane16_swap_b32 v96, v104
v_permlane16_swap_b32 v98, v106
v_permlane16_swap_b32 v100, v108
v_permlane16_swap_b32 v102, v110
AW 80,96
AW 81,98
AW 82,104
AW 83,106
AW 84,100
AW 85,102
AW 86,108
AW 87,110
v_pk_mul_f32 v[112:113], v[112:113], s[74:75]
v_pk_mul_f32 v[114:115], v[114:115], s[74:75]
v_pk_mul_f32 v[116:117], v[116:117], s[74:75]
v_pk_mul_f32 v[118:119], v[118:119], s[74:75]
v_pk_mul_f32 v[120:121], v[120:121], s[74:75]
v_pk_mul_f32 v[122:123], v[122:123], s[74:75]
v_pk_mul_f32 v[124:125], v[124:125], s[74:75]
v_pk_mul_f32 v[126:127], v[126:127], s[74:75]
CV 112,112
CV 114,114
CV 116,116
CV 118,118
CV 120,120
CV 122,122
CV 124,124
CV 126,126
v_permlane32_swap_b32 v112, v120
v_permlane32_swap_b32 v114, v122
v_permlane32_swap_b32 v116, v124
v_permlane32_swap_b32 v118, v126
v_permlane16_swap_b32 v112, v120
v_permlane16_swap_b32 v114, v122
v_permlane16_swap_b32 v116, v124
v_permlane16_swap_b32 v118, v126
AW 88,112
AW 89,114
AW 90,120
AW 91,122
AW 92,116
AW 93,118
AW 94,124
AW 95,126
W 3
ZB 64,0,64
G 56,36,66,2,nt
ZB 68,0,68
R a,20,13,4
MB 64,4,72
R a,24,14,4
MB 68,4,76
W 3
MB 64,8,80
G 57,36,66,3,nt
MB 68,8,84
R a,28,15,4
MB 64,12,88
MB 68,12,92
W 2
ZB 72,16,64
ZB 76,16,68
MB 72,20,72
MB 76,20,76
W 0
MB 72,24,80
E 64
MB 76,24,84
MB 72,28,88
E 65
MB 76,28,92
CV 96,64
E 66
E 67
s_nop 0
CV 97,66
E 68
s_waitcnt vmcnt(12)
s_barrier
R a,0,12,16
E 69
s_xor_b32 m0, s65, 0x4000
s_xor_b32 s66, s63, 0x14000
R a,4,13,16
G 32,32,66,0,nt
CV 100,68
E 70
R a,8,14,16
E 71
R a,12,15,16
G 33,32,66,1,nt
CV 101,70
E 72
R a,16,12,20
E 73
W 3
ZB 80,0,64
G 34,32,66,2,nt
R a,20,13,20
ZB 84,0,68
CV 98,72
E 74
MB 80,4,72
R a,24,14,20
MB 84,4,76
E 75
W 3
MB 80,8,80
G 35,32,66,3,nt
R a,28,15,20
MB 84,8,84
CV 99,74
E 76
MB 80,12,88
s_waitcnt vmcnt(12)
s_barrier
T 32,24,32
T 34,24,36
MB 84,12,92
E 77
s_xor_b32 m0, s65, 0x8000
s_xor_b32 s66, s63, 0x4000
W 4
ZB 88,16,64
G 56,36,66,0,nt
T 36,25,32
ZB 92,16,68
T 38,25,36
CV 102,76
E 78
s_getpc_b64 s[88:89]
L_ct0_129:
s_and_b32 s89, s89, 0xffff
s_mov_b32 s90, L_code_end-L_ct0_129
s_mov_b32 s91, 0x20000
v_and_b32 v62, 0x70, v59
v_lshlrev_b32 v62, 3, v62
s_add_u32 s7, s1, 4096
buffer_load_dword v3, v62, s[88:91], s7 offen
MB 88,20,72
T 40,26,32
T 42,26,36
MB 92,20,76
E 79
W 6
MB 88,24,80
G 57,36,66,1,nt
T 44,27,32
MB 92,24,84
T 46,27,36
CV 103,78
E 80
MB 88,28,88
T 48,28,32
T 50,28,36
MB 92,28,92
E 81
W 6
ZC 96,32,96
G 56,36,66,2,nt
T 52,29,32
ZC 100,32,100
T 54,29,36
CV 104,80
E 82
ZC 104,36,96
T 56,30,32
T 58,30,36
ZC 108,36,100
E 83
W 6
ZC 112,40,96
G 57,36,66,3,nt
T 60,31,32
ZC 116,40,100
T 62,31,36
CV 105,82
E 84
ZC 120,44,96
E 85
ZC 124,44,100
W 4
ZC 128,48,96
s_waitcnt vmcnt(13)
s_barrier
R a,0,12,48
CV 108,84
ZC 132,48,100
E 86
s_xor_b32 m0, s65, 0xc000
s_xor_b32 s66, s63, 0x14000
ZC 136,52,96
G 56,36,66,0,nt
ZC 140,52,100
R a,4,13,48
E 87
W 2
ZC 144,56,96
R a,8,14,48
CV 109,86
ZC 148,56,100
E 88
ZC 152,60,96
G 57,36,66,1,nt
ZC 156,60,100
R a,12,15,48
E 89
ZD 112,52,96
R a,16,12,52
CV 106,88
ZD 116,52,100
E 90
W 3
ZB 64,0,64
G 56,36,66,2,nt
ZB 68,0,68
R a,20,13,52
E 91
MB 64,4,72
R a,24,14,52
CV 107,90
MB 68,4,76
E 92
W 3
MB 64,8,80
G 57,36,66,3,nt
MB 68,8,84
R a,28,15,52
E 93
MB 64,12,88
s_waitcnt vmcnt(13)
s_barrier
T 32,16,0
T 34,16,4
MB 68,12,92
CV 110,92
E 94
s_xor_b32 m0, s65, 0x10000
s_xor_b32 s66, s61, 0x200
W 4
ZB 72,16,64
G 40,40,66,0
T 36,17,0
ZB 76,16,68
T 38,17,4
E 95
MB 72,20,72
T 40,18,0
MB 76,20,76
T 42,18,4
CV 111,94
W 6
MB 72,24,80
G 41,40,66,1
T 44,19,0
MB 76,24,84
T 46,19,4
E 64
MB 72,28,88
T 48,20,0
T 50,20,4
MB 76,28,92
E 65
W 6
MC 96,32,104
G 42,40,66,2
T 52,21,0
MC 100,32,108
T 54,21,4
CV 96,64
E 66
MC 104,36,104
T 56,22,0
T 58,22,4
MC 108,36,108
E 67
W 6
MC 112,40,104
G 43,40,66,3
T 60,23,0
MC 116,40,108
T 62,23,4
CV 97,66
E 68
MC 120,44,104
E 69
MC 124,44,108
W 4
MC 128,48,104
s_waitcnt vmcnt(13)
s_barrier
R a,0,8,16
CV 100,68
MC 132,48,108
E 70
s_xor_b32 m0, s65, 0x14000
s_xor_b32 s66, s61, 0x40200
MC 136,52,104
G 40,40,66,0
MC 140,52,108
R a,4,9,16
E 71
W 2
MC 144,56,104
R a,8,10,16
CV 101,70
MC 148,56,108
E 72
MC 152,60,104
G 41,40,66,1
MC 156,60,108
R a,12,11,16
E 73
MD 112,52,104
R a,16,8,20
CV 98,72
MD 116,52,108
E 74
W 3
ZB 80,0,64
G 42,40,66,2
ZB 84,0,68
R a,20,9,20
E 75
MB 80,4,72
R a,24,10,20
CV 99,74
MB 84,4,76
E 76
W 3
MB 80,8,80
G 43,40,66,3
MB 84,8,84
R a,28,11,20
E 77
MB 80,12,88
s_waitcnt vmcnt(12)
s_barrier
T 32,16,32
T 34,16,36
MB 84,12,92
CV 102,76
E 78
s_xor_b32 m0, s65, 0x18000
s_xor_b32 s66, s61, 0x80200
W 4
ZB 88,16,64
G 40,40,66,0
T 36,17,32
ZB 92,16,68
T 38,17,36
E 79
MB 88,20,72
T 40,18,32
MB 92,20,76
T 42,18,36
CV 103,78
W 6
MB 88,24,80
G 41,40,66,1
T 44,19,32
MB 92,24,84
T 46,19,36
E 80
MB 88,28,88
T 48,20,32
T 50,20,36
MB 92,28,92
E 81
W 6
MC 96,32,96
G 42,40,66,2
T 52,21,32
MC 100,32,100
T 54,21,36
CV 104,80
E 82
MC 104,36,96
T 56,22,32
T 58,22,36
MC 108,36,100
E 83
W 6
MC 112,40,96
G 43,40,66,3
T 60,23,32
MC 116,40,100
T 62,23,36
CV 105,82
E 84
MC 120,44,96
E 85
MC 124,44,100
W 4
MC 128,48,96
CV 108,84
MC 132,48,100
E 86
MC 136,52,96
E 87
MC 140,52,100
W 0
MC 144,56,96
CV 109,86
MC 148,56,100
E 88
MC 152,60,96
E 89
MC 156,60,100
MD 112,52,96
CV 106,88
MD 116,52,100
E 90
E 91
s_nop 0
CV 107,90
E 92
E 93
s_waitcnt vmcnt(12)
s_barrier
T 32,16,48
T 34,16,52
CV 110,92
E 94
s_xor_b32 m0, s65, 0x1c000
s_xor_b32 s66, s61, 0xc0200
T 36,17,48
T 38,17,52
G 40,40,66,0
E 95
T 40,18,48
T 42,18,52
CV 111,94
T 44,19,48
T 46,19,52
G 41,40,66,1
T 48,20,48
T 50,20,52
W 6
MC 96,32,104
G 42,40,66,2
MC 100,32,108
T 52,21,48
T 54,21,52
MC 104,36,104
T 56,22,48
MC 108,36,108
T 58,22,52
W 6
MC 112,40,104
G 43,40,66,3
MC 116,40,108
T 60,23,48
T 62,23,52
MC 120,44,104
MC 124,44,108
W 4
MC 128,48,104
s_waitcnt vmcnt(12)
s_barrier
s_xor_b32 m0, s65, 0x0
s_xor_b32 s66, s61, 0x100200
MC 132,48,108
G 40,40,66,0
T 0,24,0
T 2,24,4
MC 136,52,104
G 41,40,66,1
MC 140,52,108
T 4,25,0
T 6,25,4
W 4
MC 144,56,104
G 42,40,66,2
MC 148,56,108
T 8,26,0
T 10,26,4
MC 152,60,104
G 43,40,66,3
MC 156,60,108
T 12,27,0
T 14,27,4
MD 112,52,104
s_xor_b32 m0, s65, 0x4000
s_xor_b32 s66, s61, 0x140200
MD 116,52,108
G 40,40,66,0
T 16,28,0
T 18,28,4
s_nop 1
v_mov_b32 v6, v112
s_nop 1
v_mov_b32 v7, v116
W 6
ZA 64,0,128
G 41,40,66,1
ZA 68,0,132
T 20,29,0
T 22,29,4
ZA 72,4,128
G 42,40,66,2
ZA 76,4,132
T 24,30,0
T 26,30,4
W 6
ZA 80,8,128
G 43,40,66,3
ZA 84,8,132
T 28,31,0
T 30,31,4
ZA 88,12,128
s_waitcnt vmcnt(16)
s_barrier
T 32,24,16
ZA 92,12,132
T 34,24,20
s_xor_b32 m0, s65, 0x8000
s_xor_b32 s66, s61, 0x180200
W 6
ZA 96,16,128
G 40,40,66,0
ZA 100,16,132
T 36,25,16
T 38,25,20
ZA 104,20,128
T 40,26,16
ZA 108,20,132
T 42,26,20
W 6
ZA 112,24,128
G 41,40,66,1
ZA 116,24,132
T 44,27,16
T 46,27,20
ZA 120,28,128
T 48,28,16
ZA 124,28,132
T 50,28,20
W 6
MA 64,32,136
G 42,40,66,2
MA 68,32,140
T 52,29,16
T 54,29,20
MA 72,36,136
T 56,30,16
MA 76,36,140
T 58,30,20
W 6
MA 80,40,136
G 43,40,66,3
MA 84,40,140
T 60,31,16
T 62,31,20
MA 88,44,136
s_waitcnt vmcnt(16)
s_barrier
T 0,24,32
MA 92,44,140
T 2,24,36
s_xor_b32 m0, s65, 0xc000
s_xor_b32 s66, s61, 0x1c0200
W 6
MA 96,48,136
G 40,40,66,0
MA 100,48,140
T 4,25,32
T 6,25,36
MA 104,52,136
T 8,26,32
MA 108,52,140
T 10,26,36
W 6
MA 112,56,136
G 41,40,66,1
MA 116,56,140
T 12,27,32
T 14,27,36
MA 120,60,136
T 16,28,32
MA 124,60,140
T 18,28,36
W 6
MA 64,0,144
G 42,40,66,2
MA 68,0,148
T 20,29,32
T 22,29,36
MA 72,4,144
T 24,30,32
MA 76,4,148
T 26,30,36
W 6
MA 80,8,144
G 43,40,66,3
MA 84,8,148
T 28,31,32
T 30,31,36
MA 88,12,144
s_waitcnt vmcnt(16)
s_barrier
T 32,24,48
MA 92,12,148
T 34,24,52
s_xor_b32 m0, s65, 0x10000
s_xor_b32 s66, s61, 0x200200
W 6
MA 96,16,144
G 40,40,66,0
MA 100,16,148
T 36,25,48
T 38,25,52
s_getpc_b64 s[88:89]
L_ct0_213:
s_and_b32 s89, s89, 0xffff
s_mov_b32 s90, L_code_end-L_ct0_213
s_mov_b32 s91, 0x20000
v_and_b32 v62, 0x70, v59
v_lshlrev_b32 v62, 3, v62
s_add_u32 s7, s1, 4096
buffer_load_dword v3, v62, s[88:91], s7 offen
MA 104,20,144
T 40,26,48
MA 108,20,148
T 42,26,52
W 6
MA 112,24,144
G 41,40,66,1
MA 116,24,148
T 44,27,48
T 46,27,52
MA 120,28,144
T 48,28,48
MA 124,28,148
T 50,28,52
W 6
MA 64,32,152
G 42,40,66,2
MA 68,32,156
T 52,29,48
T 54,29,52
MA 72,36,152
T 56,30,48
MA 76,36,156
T 58,30,52
W 6
MA 80,40,152
G 43,40,66,3
MA 84,40,156
T 60,31,48
T 62,31,52
MA 88,44,152
s_waitcnt vmcnt(17)
s_barrier
T 0,16,0
MA 92,44,156
T 2,16,4
s_xor_b32 m0, s65, 0x14000
s_xor_b32 s66, s61, 0x240200
W 6
MA 96,48,152
G 40,40,66,0
MA 100,48,156
T 4,17,0
T 6,17,4
MA 104,52,152
T 8,18,0
MA 108,52,156
T 10,18,4
W 6
MA 112,56,152
G 41,40,66,1
MA 116,56,156
T 12,19,0
T 14,19,4
MA 120,60,152
T 16,20,0
MA 124,60,156
T 18,20,4
W 6
MA 64,0,160
G 42,40,66,2
MA 68,0,164
T 20,21,0
T 22,21,4
MA 72,4,160
T 24,22,0
MA 76,4,164
T 26,22,4
W 6
MA 80,8,160
G 43,40,66,3
MA 84,8,164
T 28,23,0
T 30,23,4
MA 88,12,160
s_waitcnt vmcnt(17)
s_barrier
T 32,16,16
MA 92,12,164
T 34,16,20
s_xor_b32 m0, s65, 0x18000
s_xor_b32 s66, s61, 0x280200
W 6
MA 96,16,160
G 40,40,66,0
MA 100,16,164
T 36,17,16
T 38,17,20
MA 104,20,160
T 40,18,16
MA 108,20,164
T 42,18,20
W 6
MA 112,24,160
G 41,40,66,1
MA 116,24,164
T 44,19,16
T 46,19,20
MA 120,28,160
T 48,20,16
MA 124,28,164
T 50,20,20
W 6
MA 64,32,168
G 42,40,66,2
MA 68,32,172
T 52,21,16
T 54,21,20
MA 72,36,168
T 56,22,16
MA 76,36,172
T 58,22,20
W 6
MA 80,40,168
G 43,40,66,3
MA 84,40,172
T 60,23,16
T 62,23,20
MA 88,44,168
s_waitcnt vmcnt(17)
s_barrier
T 0,16,32
MA 92,44,172
T 2,16,36
s_xor_b32 m0, s65, 0x1c000
s_xor_b32 s66, s61, 0x2c0200
W 6
MA 96,48,168
G 40,40,66,0
MA 100,48,172
T 4,17,32
T 6,17,36
MA 104,52,168
T 8,18,32
MA 108,52,172
T 10,18,36
W 6
MA 112,56,168
G 41,40,66,1
MA 116,56,172
T 12,19,32
T 14,19,36
MA 120,60,168
T 16,20,32
MA 124,60,172
T 18,20,36
W 6
MA 64,0,176
G 42,40,66,2
MA 68,0,180
T 20,21,32
T 22,21,36
MA 72,4,176
T 24,22,32
MA 76,4,180
T 26,22,36
W 6
MA 80,8,176
G 43,40,66,3
MA 84,8,180
T 28,23,32
T 30,23,36
MA 88,12,176
s_waitcnt vmcnt(17)
s_barrier
T 32,16,48
MA 92,12,180
T 34,16,52
s_xor_b32 m0, s65, 0x0
s_xor_b32 s66, s61, 0x300200
W 6
MA 96,16,176
G 40,40,66,0
MA 100,16,180
T 36,17,48
T 38,17,52
MA 104,20,176
T 40,18,48
MA 108,20,180
T 42,18,52
W 6
MA 112,24,176
G 41,40,66,1
MA 116,24,180
T 44,19,48
T 46,19,52
MA 120,28,176
T 48,20,48
MA 124,28,180
T 50,20,52
W 6
MA 64,32,184
G 42,40,66,2
MA 68,32,188
T 52,21,48
T 54,21,52
MA 72,36,184
T 56,22,48
MA 76,36,188
T 58,22,52
W 6
MA 80,40,184
G 43,40,66,3
MA 84,40,188
T 60,23,48
T 62,23,52
MA 88,44,184
s_waitcnt vmcnt(16)
s_barrier
T 0,24,0
MA 92,44,188
T 2,24,4
s_xor_b32 m0, s65, 0x4000
s_xor_b32 s66, s61, 0x340200
W 6
MA 96,48,184
G 40,40,66,0
MA 100,48,188
T 4,25,0
T 6,25,4
MA 104,52,184
T 8,26,0
MA 108,52,188
T 10,26,4
W 6
MA 112,56,184
G 41,40,66,1
MA 116,56,188
T 12,27,0
T 14,27,4
MA 120,60,184
T 16,28,0
MA 124,60,188
T 18,28,4
W 6
MA 64,0,192
G 42,40,66,2
MA 68,0,196
T 20,29,0
T 22,29,4
MA 72,4,192
T 24,30,0
MA 76,4,196
T 26,30,4
W 6
MA 80,8,192
G 43,40,66,3
MA 84,8,196
T 28,31,0
T 30,31,4
MA 88,12,192
s_waitcnt vmcnt(16)
s_barrier
T 32,24,16
MA 92,12,196
T 34,24,20
s_xor_b32 m0, s65, 0x8000
s_xor_b32 s66, s61, 0x380200
W 6
MA 96,16,192
G 40,40,66,0
MA 100,16,196
T 36,25,16
T 38,25,20
MA 104,20,192
T 40,26,16
MA 108,20,196
T 42,26,20
W 6
MA 112,24,192
G 41,40,66,1
MA 116,24,196
T 44,27,16
T 46,27,20
MA 120,28,192
T 48,28,16
MA 124,28,196
T 50,28,20
W 6
MA 64,32,200
G 42,40,66,2
MA 68,32,204
T 52,29,16
T 54,29,20
MA 72,36,200
T 56,30,16
MA 76,36,204
T 58,30,20
W 6
MA 80,40,200
G 43,40,66,3
MA 84,40,204
T 60,31,16
T 62,31,20
MA 88,44,200
s_waitcnt vmcnt(16)
s_barrier
T 0,24,32
MA 92,44,204
T 2,24,36
s_xor_b32 m0, s65, 0xc000
s_xor_b32 s66, s61, 0x3c0200
W 6
MA 96,48,200
G 40,40,66,0
MA 100,48,204
T 4,25,32
T 6,25,36
MA 104,52,200
T 8,26,32
MA 108,52,204
T 10,26,36
W 6
MA 112,56,200
G 41,40,66,1
MA 116,56,204
T 12,27,32
T 14,27,36
MA 120,60,200
T 16,28,32
MA 124,60,204
T 18,28,36
W 6
MA 64,0,208
G 42,40,66,2
MA 68,0,212
T 20,29,32
T 22,29,36
MA 72,4,208
T 24,30,32
MA 76,4,212
T 26,30,36
W 6
MA 80,8,208
G 43,40,66,3
MA 84,8,212
T 28,31,32
T 30,31,36
MA 88,12,208
s_waitcnt vmcnt(16)
s_barrier
T 32,24,48
MA 92,12,212
T 34,24,52
s_xor_b32 m0, s65, 0x10000
s_xor_b32 s66, s63, 0x1000
W 6
MA 96,16,208
G 32,32,66,0,nt
MA 100,16,212
T 36,25,48
T 38,25,52
MA 104,20,208
T 40,26,48
MA 108,20,212
T 42,26,52
W 6
MA 112,24,208
G 33,32,66,1,nt
MA 116,24,212
T 44,27,48
T 46,27,52
MA 120,28,208
T 48,28,48
MA 124,28,212
T 50,28,52
W 6
MA 64,32,216
G 34,32,66,2,nt
MA 68,32,220
T 52,29,48
T 54,29,52
MA 72,36,216
T 56,30,48
MA 76,36,220
T 58,30,52
W 6
MA 80,40,216
G 35,32,66,3,nt
MA 84,40,220
T 60,31,48
T 62,31,52
MA 88,44,216
s_waitcnt vmcnt(16)
s_barrier
T 0,16,0
MA 92,44,220
T 2,16,4
s_xor_b32 m0, s65, 0x14000
s_xor_b32 s66, s63, 0x11000
W 6
MA 96,48,216
G 32,32,66,0,nt
MA 100,48,220
T 4,17,0
T 6,17,4
MA 104,52,216
T 8,18,0
MA 108,52,220
T 10,18,4
W 6
MA 112,56,216
G 33,32,66,1,nt
MA 116,56,220
T 12,19,0
T 14,19,4
MA 120,60,216
T 16,20,0
MA 124,60,220
T 18,20,4
W 6
MA 64,0,224
G 34,32,66,2,nt
MA 68,0,228
T 20,21,0
T 22,21,4
MA 72,4,224
T 24,22,0
MA 76,4,228
T 26,22,4
W 6
MA 80,8,224
G 35,32,66,3,nt
MA 84,8,228
T 28,23,0
T 30,23,4
MA 88,12,224
s_waitcnt vmcnt(16)
s_barrier
T 32,16,16
MA 92,12,228
T 34,16,20
s_xor_b32 m0, s65, 0x18000
s_xor_b32 s66, s63, 0x1000
W 6
MA 96,16,224
G 56,36,66,0,nt
MA 100,16,228
T 36,17,16
T 38,17,20
MA 104,20,224
T 40,18,16
MA 108,20,228
T 42,18,20
W 6
MA 112,24,224
G 57,36,66,1,nt
MA 116,24,228
T 44,19,16
T 46,19,20
MA 120,28,224
T 48,20,16
MA 124,28,228
T 50,20,20
W 6
MA 64,32,232
G 56,36,66,2,nt
MA 68,32,236
T 52,21,16
T 54,21,20
MA 72,36,232
T 56,22,16
MA 76,36,236
T 58,22,20
W 6
MA 80,40,232
G 57,36,66,3,nt
MA 84,40,236
T 60,23,16
T 62,23,20
MA 88,44,232
s_waitcnt vmcnt(16)
s_barrier
T 0,16,32
MA 92,44,236
T 2,16,36
s_xor_b32 m0, s65, 0x1c000
s_xor_b32 s66, s63, 0x5000
W 6
MA 96,48,232
G 32,32,66,0,nt
MA 100,48,236
T 4,17,32
T 6,17,36
MA 104,52,232
T 8,18,32
MA 108,52,236
T 10,18,36
W 6
MA 112,56,232
G 33,32,66,1,nt
MA 116,56,236
T 12,19,32
T 14,19,36
MA 120,60,232
T 16,20,32
MA 124,60,236
T 18,20,36
W 6
MA 64,0,240
G 34,32,66,2,nt
MA 68,0,244
T 20,21,32
T 22,21,36
MA 72,4,240
T 24,22,32
MA 76,4,244
T 26,22,36
W 6
MA 80,8,240
G 35,32,66,3,nt
MA 84,8,244
T 28,23,32
T 30,23,36
MA 88,12,240
s_waitcnt vmcnt(16)
s_barrier
MA 92,12,244
T 32,16,48
T 34,16,52
W 6
MA 96,16,240
T 36,17,48
MA 100,16,244
T 38,17,52
MA 104,20,240
T 40,18,48
MA 108,20,244
T 42,18,52
W 6
MA 112,24,240
T 44,19,48
MA 116,24,244
T 46,19,52
MA 120,28,240
T 48,20,48
MA 124,28,244
T 50,20,52
W 6
MA 64,32,248
T 52,21,48
MA 68,32,252
T 54,21,52
MA 72,36,248
T 56,22,48
MA 76,36,252
T 58,22,52
W 6
MA 80,40,248
T 60,23,48
MA 84,40,252
T 62,23,52
MA 88,44,248
s_waitcnt vmcnt(12)
s_barrier
MA 92,44,252
R a,0,12,0
s_xor_b32 m0, s65, 0x0
s_xor_b32 s66, s63, 0x11000
W 5
MA 96,48,248
G 56,36,66,0,nt
MA 100,48,252
R a,4,13,0
MA 104,52,248
R a,8,14,0
MA 108,52,252
W 3
MA 112,56,248
G 57,36,66,1,nt
MA 116,56,252
R a,12,15,0
MA 120,60,248
R a,16,12,4
MA 124,60,252
v_pk_mul_f32 v[64:65], v[64:65], s[74:75]
v_pk_mul_f32 v[66:67], v[66:67], s[74:75]
v_pk_mul_f32 v[68:69], v[68:69], s[74:75]
v_pk_mul_f32 v[70:71], v[70:71], s[74:75]
v_pk_mul_f32 v[72:73], v[72:73], s[74:75]
v_pk_mul_f32 v[74:75], v[74:75], s[74:75]
v_pk_mul_f32 v[76:77], v[76:77], s[74:75]
v_pk_mul_f32 v[78:79], v[78:79], s[74:75]
CV 64,64
CV 66,66
CV 68,68
CV 70,70
CV 72,72
CV 74,74
CV 76,76
CV 78,78
v_permlane32_swap_b32 v64, v72
v_permlane32_swap_b32 v66, v74
v_permlane32_swap_b32 v68, v76
v_permlane32_swap_b32 v70, v78
v_permlane16_swap_b32 v64, v72
v_permlane16_swap_b32 v66, v74
v_permlane16_swap_b32 v68, v76
v_permlane16_swap_b32 v70, v78
AW 160,64
AW 161,66
AW 162,72
AW 163,74
AW 164,68
AW 165,70
AW 166,76
AW 167,78
v_pk_mul_f32 v[80:81], v[80:81], s[74:75]
v_pk_mul_f32 v[82:83], v[82:83], s[74:75]
v_pk_mul_f32 v[84:85], v[84:85], s[74:75]
v_pk_mul_f32 v[86:87], v[86:87], s[74:75]
v_pk_mul_f32 v[88:89], v[88:89], s[74:75]
v_pk_mul_f32 v[90:91], v[90:91], s[74:75]
v_pk_mul_f32 v[92:93], v[92:93], s[74:75]
v_pk_mul_f32 v[94:95], v[94:95], s[74:75]
CV 80,80
CV 82,82
CV 84,84
CV 86,86
CV 88,88
CV 90,90
CV 92,92
CV 94,94
v_permlane32_swap_b32 v80, v88
v_permlane32_swap_b32 v82, v90
v_permlane32_swap_b32 v84, v92
v_permlane32_swap_b32 v86, v94
v_permlane16_swap_b32 v80, v88
v_permlane16_swap_b32 v82, v90
v_permlane16_swap_b32 v84, v92
v_permlane16_swap_b32 v86, v94
AW 168,80
AW 169,82
AW 170,88
AW 171,90
AW 172,84
AW 173,86
AW 174,92
AW 175,94
v_pk_mul_f32 v[96:97], v[96:97], s[74:75]
v_pk_mul_f32 v[98:99], v[98:99], s[74:75]
v_pk_mul_f32 v[100:101], v[100:101], s[74:75]
v_pk_mul_f32 v[102:103], v[102:103], s[74:75]
v_pk_mul_f32 v[104:105], v[104:105], s[74:75]
v_pk_mul_f32 v[106:107], v[106:107], s[74:75]
v_pk_mul_f32 v[108:109], v[108:109], s[74:75]
v_pk_mul_f32 v[110:111], v[110:111], s[74:75]
CV 96,96
CV 98,98
CV 100,100
CV 102,102
CV 104,104
CV 106,106
CV 108,108
CV 110,110
v_permlane32_swap_b32 v96, v104
v_permlane32_swap_b32 v98, v106
v_permlane32_swap_b32 v100, v108
v_permlane32_swap_b32 v102, v110
v_permlane16_swap_b32 v96, v104
v_permlane16_swap_b32 v98, v106
v_permlane16_swap_b32 v100, v108
v_permlane16_swap_b32 v102, v110
AW 176,96
AW 177,98
AW 178,104
AW 179,106
AW 180,100
AW 181,102
AW 182,108
AW 183,110
v_pk_mul_f32 v[112:113], v[112:113], s[74:75]
v_pk_mul_f32 v[114:115], v[114:115], s[74:75]
v_pk_mul_f32 v[116:117], v[116:117], s[74:75]
v_pk_mul_f32 v[118:119], v[118:119], s[74:75]
v_pk_mul_f32 v[120:121], v[120:121], s[74:75]
v_pk_mul_f32 v[122:123], v[122:123], s[74:75]
v_pk_mul_f32 v[124:125], v[124:125], s[74:75]
v_pk_mul_f32 v[126:127], v[126:127], s[74:75]
CV 112,112
CV 114,114
CV 116,116
CV 118,118
CV 120,120
CV 122,122
CV 124,124
CV 126,126
v_permlane32_swap_b32 v112, v120
v_permlane32_swap_b32 v114, v122
v_permlane32_swap_b32 v116, v124
v_permlane32_swap_b32 v118, v126
v_permlane16_swap_b32 v112, v120
v_permlane16_swap_b32 v114, v122
v_permlane16_swap_b32 v116, v124
v_permlane16_swap_b32 v118, v126
AW 184,112
AW 185,114
AW 186,120
AW 187,122
AW 188,116
AW 189,118
AW 190,124
AW 191,126
W 3
ZB 64,0,64
G 56,36,66,2,nt
ZB 68,0,68
R a,20,13,4
MB 64,4,72
R a,24,14,4
MB 68,4,76
W 3
MB 64,8,80
G 57,36,66,3,nt
MB 68,8,84
R a,28,15,4
MB 64,12,88
MB 68,12,92
W 2
ZB 72,16,64
ZB 76,16,68
MB 72,20,72
MB 76,20,76
W 0
MB 72,24,80
E 64
MB 76,24,84
MB 72,28,88
E 65
MB 76,28,92
CV 96,64
E 66
E 67
s_nop 0
CV 97,66
E 68
s_waitcnt vmcnt(12)
s_barrier
R a,0,12,16
E 69
s_xor_b32 m0, s65, 0x4000
s_xor_b32 s66, s63, 0x15000
R a,4,13,16
G 32,32,66,0,nt
CV 100,68
E 70
R a,8,14,16
E 71
R a,12,15,16
G 33,32,66,1,nt
CV 101,70
E 72
R a,16,12,20
E 73
W 3
ZB 80,0,64
G 34,32,66,2,nt
R a,20,13,20
ZB 84,0,68
CV 98,72
E 74
MB 80,4,72
R a,24,14,20
MB 84,4,76
E 75
W 3
MB 80,8,80
G 35,32,66,3,nt
R a,28,15,20
MB 84,8,84
CV 99,74
E 76
MB 80,12,88
s_waitcnt vmcnt(12)
s_barrier
T 32,24,32
T 34,24,36
MB 84,12,92
E 77
s_xor_b32 m0, s65, 0x8000
s_xor_b32 s66, s63, 0x5000
W 4
ZB 88,16,64
G 56,36,66,0,nt
T 36,25,32
ZB 92,16,68
T 38,25,36
CV 102,76
E 78
s_getpc_b64 s[88:89]
L_ct0_341:
s_and_b32 s89, s89, 0xffff
s_mov_b32 s90, L_code_end-L_ct0_341
s_mov_b32 s91, 0x20000
v_and_b32 v62, 0x70, v59
v_lshlrev_b32 v62, 3, v62
s_add_u32 s7, s1, 4096
buffer_load_dword v3, v62, s[88:91], s7 offen
MB 88,20,72
T 40,26,32
T 42,26,36
MB 92,20,76
E 79
W 6
MB 88,24,80
G 57,36,66,1,nt
T 44,27,32
MB 92,24,84
T 46,27,36
CV 103,78
E 80
MB 88,28,88
T 48,28,32
T 50,28,36
MB 92,28,92
E 81
W 6
MC 96,32,96
G 56,36,66,2,nt
T 52,29,32
MC 100,32,100
T 54,29,36
CV 104,80
E 82
MC 104,36,96
T 56,30,32
T 58,30,36
MC 108,36,100
E 83
W 6
MC 112,40,96
G 57,36,66,3,nt
T 60,31,32
MC 116,40,100
T 62,31,36
CV 105,82
E 84
MC 120,44,96
E 85
MC 124,44,100
W 4
MC 128,48,96
s_waitcnt vmcnt(13)
s_barrier
R a,0,12,48
CV 108,84
MC 132,48,100
E 86
s_xor_b32 m0, s65, 0xc000
s_xor_b32 s66, s63, 0x2000
MC 136,52,96
G 32,32,66,0,nt
MC 140,52,100
R a,4,13,48
E 87
W 2
MC 144,56,96
R a,8,14,48
CV 109,86
MC 148,56,100
E 88
MC 152,60,96
G 33,32,66,1,nt
MC 156,60,100
R a,12,15,48
E 89
ZD 112,52,96
R a,16,12,52
CV 106,88
ZD 116,52,100
E 90
W 3
ZB 64,0,64
G 34,32,66,2,nt
ZB 68,0,68
R a,20,13,52
E 91
MB 64,4,72
R a,24,14,52
CV 107,90
MB 68,4,76
E 92
W 3
MB 64,8,80
G 35,32,66,3,nt
MB 68,8,84
R a,28,15,52
E 93
MB 64,12,88
s_waitcnt vmcnt(13)
s_barrier
T 32,16,0
T 34,16,4
MB 68,12,92
CV 110,92
E 94
s_xor_b32 m0, s65, 0x10000
s_xor_b32 s66, s63, 0x15000
W 4
ZB 72,16,64
G 56,36,66,0,nt
T 36,17,0
ZB 76,16,68
T 38,17,4
E 95
MB 72,20,72
T 40,18,0
MB 76,20,76
T 42,18,4
CV 111,94
W 6
MB 72,24,80
G 57,36,66,1,nt
T 44,19,0
MB 76,24,84
T 46,19,4
E 64
MB 72,28,88
T 48,20,0
T 50,20,4
MB 76,28,92
E 65
W 6
MC 96,32,104
G 56,36,66,2,nt
T 52,21,0
MC 100,32,108
T 54,21,4
CV 96,64
E 66
MC 104,36,104
T 56,22,0
T 58,22,4
MC 108,36,108
E 67
W 6
MC 112,40,104
G 57,36,66,3,nt
T 60,23,0
MC 116,40,108
T 62,23,4
CV 97,66
E 68
MC 120,44,104
E 69
MC 124,44,108
W 4
MC 128,48,104
s_waitcnt vmcnt(13)
s_barrier
R a,0,8,16
CV 100,68
MC 132,48,108
E 70
s_xor_b32 m0, s65, 0x14000
s_xor_b32 s66, s63, 0x12000
MC 136,52,104
G 32,32,66,0,nt
MC 140,52,108
R a,4,9,16
E 71
W 2
MC 144,56,104
R a,8,10,16
CV 101,70
MC 148,56,108
E 72
MC 152,60,104
G 33,32,66,1,nt
MC 156,60,108
R a,12,11,16
E 73
MD 112,52,104
R a,16,8,20
CV 98,72
MD 116,52,108
E 74
W 3
ZB 80,0,64
G 34,32,66,2,nt
ZB 84,0,68
R a,20,9,20
E 75
MB 80,4,72
R a,24,10,20
CV 99,74
MB 84,4,76
E 76
W 3
MB 80,8,80
G 35,32,66,3,nt
MB 84,8,84
R a,28,11,20
E 77
MB 80,12,88
s_waitcnt vmcnt(12)
s_barrier
T 32,16,32
T 34,16,36
MB 84,12,92
CV 102,76
E 78
s_xor_b32 m0, s65, 0x18000
s_xor_b32 s66, s63, 0x2000
W 4
ZB 88,16,64
G 56,36,66,0,nt
T 36,17,32
ZB 92,16,68
T 38,17,36
E 79
MB 88,20,72
T 40,18,32
MB 92,20,76
T 42,18,36
CV 103,78
W 6
MB 88,24,80
G 57,36,66,1,nt
T 44,19,32
MB 92,24,84
T 46,19,36
E 80
MB 88,28,88
T 48,20,32
T 50,20,36
MB 92,28,92
E 81
W 6
MC 96,32,96
G 56,36,66,2,nt
T 52,21,32
MC 100,32,100
T 54,21,36
CV 104,80
E 82
MC 104,36,96
T 56,22,32
T 58,22,36
MC 108,36,100
E 83
W 6
MC 112,40,96
G 57,36,66,3,nt
T 60,23,32
MC 116,40,100
T 62,23,36
CV 105,82
E 84
MC 120,44,96
E 85
MC 124,44,100
W 4
MC 128,48,96
s_waitcnt vmcnt(12)
s_barrier
R a,0,8,48
CV 108,84
MC 132,48,100
E 86
s_xor_b32 m0, s65, 0x1c000
s_xor_b32 s66, s63, 0x6000
MC 136,52,96
G 32,32,66,0,nt
MC 140,52,100
R a,4,9,48
E 87
W 2
MC 144,56,96
R a,8,10,48
CV 109,86
MC 148,56,100
E 88
MC 152,60,96
G 33,32,66,1,nt
MC 156,60,100
R a,12,11,48
E 89
MD 112,52,96
R a,16,8,52
CV 106,88
MD 116,52,100
E 90
W 3
ZB 64,0,64
G 34,32,66,2,nt
ZB 68,0,68
R a,20,9,52
E 91
MB 64,4,72
R a,24,10,52
CV 107,90
MB 68,4,76
E 92
W 3
MB 64,8,80
G 35,32,66,3,nt
MB 68,8,84
R a,28,11,52
E 93
MB 64,12,88
s_waitcnt vmcnt(12)
s_barrier
T 32,24,0
T 34,24,4
MB 68,12,92
CV 110,92
E 94
s_xor_b32 m0, s65, 0x0
s_xor_b32 s66, s63, 0x12000
W 4
ZB 72,16,64
G 56,36,66,0,nt
T 36,25,0
ZB 76,16,68
T 38,25,4
E 95
MB 72,20,72
T 40,26,0
MB 76,20,76
T 42,26,4
CV 111,94
W 6
MB 72,24,80
G 57,36,66,1,nt
T 44,27,0
MB 76,24,84
T 46,27,4
E 64
MB 72,28,88
T 48,28,0
T 50,28,4
MB 76,28,92
E 65
W 6
MC 96,32,104
G 56,36,66,2,nt
T 52,29,0
MC 100,32,108
T 54,29,4
CV 96,64
E 66
MC 104,36,104
T 56,30,0
T 58,30,4
MC 108,36,108
E 67
W 6
MC 112,40,104
G 57,36,66,3,nt
T 60,31,0
MC 116,40,108
T 62,31,4
CV 97,66
E 68
MC 120,44,104
E 69
MC 124,44,108
W 4
MC 128,48,104
s_waitcnt vmcnt(12)
s_barrier
R a,0,12,16
CV 100,68
MC 132,48,108
E 70
s_xor_b32 m0, s65, 0x4000
s_xor_b32 s66, s63, 0x16000
MC 136,52,104
G 32,32,66,0,nt
MC 140,52,108
R a,4,13,16
E 71
W 2
MC 144,56,104
R a,8,14,16
CV 101,70
MC 148,56,108
E 72
MC 152,60,104
G 33,32,66,1,nt
MC 156,60,108
R a,12,15,16
E 73
MD 112,52,104
R a,16,12,20
CV 98,72
MD 116,52,108
E 74
W 3
ZB 80,0,64
G 34,32,66,2,nt
ZB 84,0,68
R a,20,13,20
E 75
MB 80,4,72
R a,24,14,20
CV 99,74
MB 84,4,76
E 76
W 3
MB 80,8,80
G 35,32,66,3,nt
MB 84,8,84
R a,28,15,20
E 77
MB 80,12,88
s_waitcnt vmcnt(12)
s_barrier
T 32,24,32
T 34,24,36
MB 84,12,92
CV 102,76
E 78
s_xor_b32 m0, s65, 0x8000
s_xor_b32 s66, s63, 0x6000
W 4
ZB 88,16,64
G 56,36,66,0,nt
T 36,25,32
ZB 92,16,68
T 38,25,36
E 79
MB 88,20,72
T 40,26,32
MB 92,20,76
T 42,26,36
CV 103,78
W 6
MB 88,24,80
G 57,36,66,1,nt
T 44,27,32
MB 92,24,84
T 46,27,36
E 80
MB 88,28,88
T 48,28,32
T 50,28,36
MB 92,28,92
E 81
W 6
MC 96,32,96
G 56,36,66,2,nt
T 52,29,32
MC 100,32,100
T 54,29,36
CV 104,80
E 82
MC 104,36,96
T 56,30,32
T 58,30,36
MC 108,36,100
E 83
W 6
MC 112,40,96
G 57,36,66,3,nt
T 60,31,32
MC 116,40,100
T 62,31,36
CV 105,82
E 84
MC 120,44,96
E 85
MC 124,44,100
W 4
MC 128,48,96
s_waitcnt vmcnt(12)
s_barrier
R a,0,12,48
CV 108,84
MC 132,48,100
E 86
s_xor_b32 m0, s65, 0xc000
s_xor_b32 s66, s63, 0x3000
MC 136,52,96
G 32,32,66,0,nt
MC 140,52,100
R a,4,13,48
E 87
W 2
MC 144,56,96
R a,8,14,48
CV 109,86
MC 148,56,100
E 88
MC 152,60,96
G 33,32,66,1,nt
MC 156,60,100
R a,12,15,48
E 89
MD 112,52,96
R a,16,12,52
CV 106,88
MD 116,52,100
E 90
W 3
ZB 64,0,64
G 34,32,66,2,nt
ZB 68,0,68
R a,20,13,52
E 91
MB 64,4,72
R a,24,14,52
CV 107,90
MB 68,4,76
E 92
W 3
MB 64,8,80
G 35,32,66,3,nt
MB 68,8,84
R a,28,15,52
E 93
MB 64,12,88
s_waitcnt vmcnt(12)
s_barrier
T 32,16,0
T 34,16,4
MB 68,12,92
CV 110,92
E 94
s_xor_b32 m0, s65, 0x10000
s_xor_b32 s66, s63, 0x16000
W 4
ZB 72,16,64
G 56,36,66,0,nt
T 36,17,0
ZB 76,16,68
T 38,17,4
E 95
MB 72,20,72
T 40,18,0
MB 76,20,76
T 42,18,4
CV 111,94
W 6
MB 72,24,80
G 57,36,66,1,nt
T 44,19,0
MB 76,24,84
T 46,19,4
E 64
MB 72,28,88
T 48,20,0
T 50,20,4
MB 76,28,92
E 65
W 6
MC 96,32,104
G 56,36,66,2,nt
T 52,21,0
MC 100,32,108
T 54,21,4
CV 96,64
E 66
MC 104,36,104
T 56,22,0
T 58,22,4
MC 108,36,108
E 67
W 6
MC 112,40,104
G 57,36,66,3,nt
T 60,23,0
MC 116,40,108
T 62,23,4
CV 97,66
E 68
MC 120,44,104
E 69
MC 124,44,108
W 4
MC 128,48,104
s_waitcnt vmcnt(12)
s_barrier
R a,0,8,16
CV 100,68
MC 132,48,108
E 70
s_xor_b32 m0, s65, 0x14000
s_xor_b32 s66, s63, 0x13000
MC 136,52,104
G 32,32,66,0,nt
MC 140,52,108
R a,4,9,16
E 71
W 2
MC 144,56,104
R a,8,10,16
CV 101,70
MC 148,56,108
E 72
MC 152,60,104
G 33,32,66,1,nt
MC 156,60,108
R a,12,11,16
E 73
MD 112,52,104
R a,16,8,20
CV 98,72
MD 116,52,108
E 74
W 3
ZB 80,0,64
G 34,32,66,2,nt
ZB 84,0,68
R a,20,9,20
E 75
MB 80,4,72
R a,24,10,20
CV 99,74
MB 84,4,76
E 76
W 3
MB 80,8,80
G 35,32,66,3,nt
MB 84,8,84
R a,28,11,20
E 77
MB 80,12,88
s_waitcnt vmcnt(12)
s_barrier
T 32,16,32
T 34,16,36
MB 84,12,92
CV 102,76
E 78
s_xor_b32 m0, s65, 0x18000
s_xor_b32 s66, s63, 0x3000
W 4
ZB 88,16,64
G 56,36,66,0,nt
T 36,17,32
ZB 92,16,68
T 38,17,36
E 79
MB 88,20,72
T 40,18,32
MB 92,20,76
T 42,18,36
CV 103,78
W 6
MB 88,24,80
G 57,36,66,1,nt
T 44,19,32
MB 92,24,84
T 46,19,36
E 80
MB 88,28,88
T 48,20,32
T 50,20,36
MB 92,28,92
E 81
W 6
MC 96,32,96
G 56,36,66,2,nt
T 52,21,32
MC 100,32,100
T 54,21,36
CV 104,80
E 82
MC 104,36,96
T 56,22,32
T 58,22,36
MC 108,36,100
E 83
W 6
MC 112,40,96
G 57,36,66,3,nt
T 60,23,32
MC 116,40,100
T 62,23,36
CV 105,82
E 84
MC 120,44,96
E 85
MC 124,44,100
W 4
MC 128,48,96
s_waitcnt vmcnt(12)
s_barrier
R a,0,8,48
CV 108,84
MC 132,48,100
E 86
s_xor_b32 m0, s65, 0x1c000
s_xor_b32 s66, s63, 0x7000
MC 136,52,96
G 32,32,66,0,nt
MC 140,52,100
R a,4,9,48
E 87
W 2
MC 144,56,96
R a,8,10,48
CV 109,86
MC 148,56,100
E 88
MC 152,60,96
G 33,32,66,1,nt
MC 156,60,100
R a,12,11,48
E 89
MD 112,52,96
R a,16,8,52
CV 106,88
MD 116,52,100
E 90
W 3
ZB 64,0,64
G 34,32,66,2,nt
ZB 68,0,68
R a,20,9,52
E 91
MB 64,4,72
R a,24,10,52
CV 107,90
MB 68,4,76
E 92
W 3
MB 64,8,80
G 35,32,66,3,nt
MB 68,8,84
R a,28,11,52
E 93
MB 64,12,88
s_waitcnt vmcnt(12)
s_barrier
T 32,24,0
T 34,24,4
MB 68,12,92
CV 110,92
E 94
s_xor_b32 m0, s65, 0x0
s_xor_b32 s66, s63, 0x13000
W 4
ZB 72,16,64
G 56,36,66,0,nt
T 36,25,0
ZB 76,16,68
T 38,25,4
E 95
MB 72,20,72
T 40,26,0
MB 76,20,76
T 42,26,4
CV 111,94
W 6
MB 72,24,80
G 57,36,66,1,nt
T 44,27,0
MB 76,24,84
T 46,27,4
E 64
MB 72,28,88
T 48,28,0
T 50,28,4
MB 76,28,92
E 65
W 6
MC 96,32,104
G 56,36,66,2,nt
T 52,29,0
MC 100,32,108
T 54,29,4
CV 96,64
E 66
MC 104,36,104
T 56,30,0
T 58,30,4
MC 108,36,108
E 67
W 6
MC 112,40,104
G 57,36,66,3,nt
T 60,31,0
MC 116,40,108
T 62,31,4
CV 97,66
E 68
MC 120,44,104
E 69
MC 124,44,108
W 4
MC 128,48,104
s_waitcnt vmcnt(12)
s_barrier
R a,0,12,16
CV 100,68
MC 132,48,108
E 70
s_xor_b32 m0, s65, 0x4000
s_xor_b32 s66, s63, 0x17000
MC 136,52,104
G 32,32,66,0,nt
MC 140,52,108
R a,4,13,16
E 71
W 2
MC 144,56,104
R a,8,14,16
CV 101,70
MC 148,56,108
E 72
MC 152,60,104
G 33,32,66,1,nt
MC 156,60,108
R a,12,15,16
E 73
MD 112,52,104
R a,16,12,20
CV 98,72
MD 116,52,108
E 74
W 3
ZB 80,0,64
G 34,32,66,2,nt
ZB 84,0,68
R a,20,13,20
E 75
MB 80,4,72
R a,24,14,20
CV 99,74
MB 84,4,76
E 76
W 3
MB 80,8,80
G 35,32,66,3,nt
MB 84,8,84
R a,28,15,20
E 77
MB 80,12,88
s_waitcnt vmcnt(12)
s_barrier
T 32,24,32
T 34,24,36
MB 84,12,92
CV 102,76
E 78
s_xor_b32 m0, s65, 0x8000
s_xor_b32 s66, s63, 0x7000
W 4
ZB 88,16,64
G 56,36,66,0,nt
T 36,25,32
ZB 92,16,68
T 38,25,36
E 79
MB 88,20,72
T 40,26,32
MB 92,20,76
T 42,26,36
CV 103,78
W 6
MB 88,24,80
G 57,36,66,1,nt
T 44,27,32
MB 92,24,84
T 46,27,36
E 80
MB 88,28,88
T 48,28,32
T 50,28,36
MB 92,28,92
E 81
W 6
MC 96,32,96
G 56,36,66,2,nt
T 52,29,32
MC 100,32,100
T 54,29,36
CV 104,80
E 82
MC 104,36,96
T 56,30,32
T 58,30,36
MC 108,36,100
E 83
W 6
MC 112,40,96
G 57,36,66,3,nt
T 60,31,32
MC 116,40,100
T 62,31,36
CV 105,82
E 84
MC 120,44,96
E 85
MC 124,44,100
W 4
MC 128,48,96
s_waitcnt vmcnt(12)
s_barrier
R a,0,12,48
CV 108,84
MC 132,48,100
E 86
s_xor_b32 m0, s65, 0xc000
s_xor_b32 s66, s63, 0x17000
MC 136,52,96
G 56,36,66,0,nt
MC 140,52,100
R a,4,13,48
E 87
W 2
MC 144,56,96
R a,8,14,48
CV 109,86
MC 148,56,100
E 88
MC 152,60,96
G 57,36,66,1,nt
MC 156,60,100
R a,12,15,48
E 89
MD 112,52,96
R a,16,12,52
CV 106,88
MD 116,52,100
E 90
W 3
ZB 64,0,64
G 56,36,66,2,nt
ZB 68,0,68
R a,20,13,52
E 91
MB 64,4,72
R a,24,14,52
CV 107,90
MB 68,4,76
E 92
W 3
MB 64,8,80
G 57,36,66,3,nt
MB 68,8,84
R a,28,15,52
E 93
MB 64,12,88
s_waitcnt vmcnt(12)
s_barrier
T 32,16,0
T 34,16,4
MB 68,12,92
CV 110,92
E 94
s_xor_b32 m0, s65, 0x10000
s_xor_b32 s66, s63, 0x40000
W 4
ZB 72,16,64
G 32,32,66,0,nt
T 36,17,0
ZB 76,16,68
T 38,17,4
E 95
MB 72,20,72
T 40,18,0
MB 76,20,76
T 42,18,4
CV 111,94
W 6
MB 72,24,80
G 33,32,66,1,nt
T 44,19,0
MB 76,24,84
T 46,19,4
E 64
MB 72,28,88
T 48,20,0
T 50,20,4
MB 76,28,92
E 65
W 6
MC 96,32,104
G 34,32,66,2,nt
T 52,21,0
MC 100,32,108
T 54,21,4
CV 96,64
E 66
MC 104,36,104
T 56,22,0
T 58,22,4
MC 108,36,108
E 67
W 6
MC 112,40,104
G 35,32,66,3,nt
T 60,23,0
MC 116,40,108
T 62,23,4
CV 97,66
E 68
MC 120,44,104
E 69
MC 124,44,108
W 4
MC 128,48,104
s_waitcnt vmcnt(12)
s_barrier
R a,0,8,16
CV 100,68
MC 132,48,108
E 70
s_xor_b32 m0, s65, 0x14000
s_xor_b32 s66, s63, 0x50000
MC 136,52,104
G 32,32,66,0,nt
MC 140,52,108
R a,4,9,16
E 71
W 2
MC 144,56,104
R a,8,10,16
CV 101,70
MC 148,56,108
E 72
MC 152,60,104
G 33,32,66,1,nt
MC 156,60,108
R a,12,11,16
E 73
MD 112,52,104
R a,16,8,20
CV 98,72
MD 116,52,108
E 74
W 3
ZB 80,0,64
G 34,32,66,2,nt
ZB 84,0,68
R a,20,9,20
E 75
MB 80,4,72
R a,24,10,20
CV 99,74
MB 84,4,76
E 76
W 3
MB 80,8,80
G 35,32,66,3,nt
MB 84,8,84
R a,28,11,20
E 77
MB 80,12,88
s_waitcnt vmcnt(12)
s_barrier
T 32,16,32
T 34,16,36
MB 84,12,92
CV 102,76
E 78
s_xor_b32 m0, s65, 0x18000
s_xor_b32 s66, s63, 0x40000
W 4
ZB 88,16,64
G 56,36,66,0,nt
T 36,17,32
ZB 92,16,68
T 38,17,36
E 79
MB 88,20,72
T 40,18,32
MB 92,20,76
T 42,18,36
CV 103,78
W 6
MB 88,24,80
G 57,36,66,1,nt
T 44,19,32
MB 92,24,84
T 46,19,36
E 80
MB 88,28,88
T 48,20,32
T 50,20,36
MB 92,28,92
E 81
W 6
MC 96,32,96
G 56,36,66,2,nt
T 52,21,32
MC 100,32,100
T 54,21,36
CV 104,80
E 82
MC 104,36,96
T 56,22,32
T 58,22,36
MC 108,36,100
E 83
W 6
MC 112,40,96
G 57,36,66,3,nt
T 60,23,32
MC 116,40,100
T 62,23,36
CV 105,82
E 84
MC 120,44,96
E 85
MC 124,44,100
W 4
MC 128,48,96
CV 108,84
MC 132,48,100
E 86
MC 136,52,96
E 87
MC 140,52,100
W 0
MC 144,56,96
CV 109,86
MC 148,56,100
E 88
MC 152,60,96
E 89
MC 156,60,100
MD 112,52,96
CV 106,88
MD 116,52,100
E 90
E 91
s_nop 0
CV 107,90
E 92
E 93
s_waitcnt vmcnt(12)
s_barrier
T 32,16,48
T 34,16,52
CV 110,92
E 94
s_xor_b32 m0, s65, 0x1c000
s_xor_b32 s66, s63, 0x44000
T 36,17,48
T 38,17,52
G 32,32,66,0,nt
E 95
T 40,18,48
T 42,18,52
CV 111,94
T 44,19,48
T 46,19,52
G 33,32,66,1,nt
T 48,20,48
T 50,20,52
W 6
MC 96,32,104
G 34,32,66,2,nt
MC 100,32,108
T 52,21,48
T 54,21,52
MC 104,36,104
T 56,22,48
MC 108,36,108
T 58,22,52
W 6
MC 112,40,104
G 35,32,66,3,nt
MC 116,40,108
T 60,23,48
T 62,23,52
MC 120,44,104
MC 124,44,108
W 4
MC 128,48,104
s_waitcnt vmcnt(12)
s_barrier
MC 132,48,108
R a,0,12,0
s_xor_b32 m0, s65, 0x0
s_xor_b32 s66, s63, 0x50000
MC 136,52,104
G 56,36,66,0,nt
MC 140,52,108
R a,4,13,0
W 2
MC 144,56,104
R a,8,14,0
MC 148,56,108
MC 152,60,104
G 57,36,66,1,nt
MC 156,60,108
R a,12,15,0
MD 112,52,104
R a,16,12,4
MD 116,52,108
s_nop 5
v_add_f32 v60, v112, v6
s_nop 0
v_add_f32 v61, v116, v7
v_cmp_nle_f32 vcc, s76, v60
v_cmp_nge_f32 s[82:83], s77, v60
v_cmp_nle_f32 s[84:85], s76, v61
v_cmp_nge_f32 s[90:91], s77, v61
s_nop 1
s_or_b64 vcc, vcc, s[82:83]
s_or_b64 vcc, vcc, s[84:85]
s_or_b64 vcc, vcc, s[90:91]
s_cbranch_scc1 L_slow_c0B0
L_back_c0B0:
v_rcp_f32 v0, v60
v_rcp_f32 v1, v61
AR 112,96
AR 113,97
AR 114,98
AR 115,99
AR 116,100
AR 117,101
AR 118,102
AR 119,103
AR 120,104
AR 121,105
AR 122,106
AR 123,107
AR 124,108
AR 125,109
AR 126,110
AR 127,111
v_pk_mul_f32 v[112:113], v[112:113], v[0:1] op_sel_hi:[1,0]
v_pk_mul_f32 v[114:115], v[114:115], v[0:1] op_sel_hi:[1,0]
v_pk_mul_f32 v[116:117], v[116:117], v[0:1] op_sel:[0,1]
v_pk_mul_f32 v[118:119], v[118:119], v[0:1] op_sel:[0,1]
v_pk_mul_f32 v[120:121], v[120:121], v[0:1] op_sel_hi:[1,0]
v_pk_mul_f32 v[122:123], v[122:123], v[0:1] op_sel_hi:[1,0]
v_pk_mul_f32 v[124:125], v[124:125], v[0:1] op_sel:[0,1]
v_pk_mul_f32 v[126:127], v[126:127], v[0:1] op_sel:[0,1]
CV 112,112
CV 114,114
CV 116,116
CV 118,118
CV 120,120
CV 122,122
CV 124,124
CV 126,126
AW 64,112
AW 65,114
AW 68,116
AW 69,118
AW 66,120
AW 67,122
AW 70,124
AW 71,126
AR 112,112
AR 113,113
AR 114,114
AR 115,115
AR 116,116
AR 117,117
AR 118,118
AR 119,119
AR 120,120
AR 121,121
AR 122,122
AR 123,123
AR 124,124
AR 125,125
AR 126,126
AR 127,127
v_pk_mul_f32 v[112:113], v[112:113], v[0:1] op_sel_hi:[1,0]
v_pk_mul_f32 v[114:115], v[114:115], v[0:1] op_sel_hi:[1,0]
v_pk_mul_f32 v[116:117], v[116:117], v[0:1] op_sel:[0,1]
v_pk_mul_f32 v[118:119], v[118:119], v[0:1] op_sel:[0,1]
v_pk_mul_f32 v[120:121], v[120:121], v[0:1] op_sel_hi:[1,0]
v_pk_mul_f32 v[122:123], v[122:123], v[0:1] op_sel_hi:[1,0]
v_pk_mul_f32 v[124:125], v[124:125], v[0:1] op_sel:[0,1]
v_pk_mul_f32 v[126:127], v[126:127], v[0:1] op_sel:[0,1]
CV 112,112
CV 114,114
CV 116,116
CV 118,118
CV 120,120
CV 122,122
CV 124,124
CV 126,126
AW 72,112
AW 73,114
AW 76,116
AW 77,118
AW 74,120
AW 75,122
AW 78,124
AW 79,126
AR 112,128
AR 113,129
AR 114,130
AR 115,131
AR 116,132
AR 117,133
AR 118,134
AR 119,135
AR 120,136
AR 121,137
AR 122,138
AR 123,139
AR 124,140
AR 125,141
AR 126,142
AR 127,143
v_pk_mul_f32 v[112:113], v[112:113], v[0:1] op_sel_hi:[1,0]
v_pk_mul_f32 v[114:115], v[114:115], v[0:1] op_sel_hi:[1,0]
v_pk_mul_f32 v[116:117], v[116:117], v[0:1] op_sel:[0,1]
v_pk_mul_f32 v[118:119], v[118:119], v[0:1] op_sel:[0,1]
v_pk_mul_f32 v[120:121], v[120:121], v[0:1] op_sel_hi:[1,0]
v_pk_mul_f32 v[122:123], v[122:123], v[0:1] op_sel_hi:[1,0]
v_pk_mul_f32 v[124:125], v[124:125], v[0:1] op_sel:[0,1]
v_pk_mul_f32 v[126:127], v[126:127], v[0:1] op_sel:[0,1]
CV 112,112
CV 114,114
CV 116,116
CV 118,118
CV 120,120
CV 122,122
CV 124,124
CV 126,126
AW 80,112
AW 81,114
AW 84,116
AW 85,118
AW 82,120
AW 83,122
AW 86,124
AW 87,126
AR 112,144
AR 113,145
AR 114,146
AR 115,147
AR 116,148
AR 117,149
AR 118,150
AR 119,151
AR 120,152
AR 121,153
AR 122,154
AR 123,155
AR 124,156
AR 125,157
AR 126,158
AR 127,159
v_pk_mul_f32 v[112:113], v[112:113], v[0:1] op_sel_hi:[1,0]
v_pk_mul_f32 v[114:115], v[114:115], v[0:1] op_sel_hi:[1,0]
v_pk_mul_f32 v[116:117], v[116:117], v[0:1] op_sel:[0,1]
v_pk_mul_f32 v[118:119], v[118:119], v[0:1] op_sel:[0,1]
v_pk_mul_f32 v[120:121], v[120:121], v[0:1] op_sel_hi:[1,0]
v_pk_mul_f32 v[122:123], v[122:123], v[0:1] op_sel_hi:[1,0]
v_pk_mul_f32 v[124:125], v[124:125], v[0:1] op_sel:[0,1]
v_pk_mul_f32 v[126:127], v[126:127], v[0:1] op_sel:[0,1]
CV 112,112
CV 114,114
CV 116,116
CV 118,118
CV 120,120
CV 122,122
CV 124,124
CV 126,126
AW 88,112
AW 89,114
AW 92,116
AW 93,118
AW 90,120
AW 91,122
AW 94,124
AW 95,126
W 3
ZB 64,0,160
G 56,36,66,2,nt
ZB 68,0,164
R a,20,13,4
MB 64,4,168
R a,24,14,4
MB 68,4,172
W 3
MB 64,8,176
G 57,36,66,3,nt
MB 68,8,180
R a,28,15,4
MB 64,12,184
MB 68,12,188
W 2
ZB 72,16,160
ZB 76,16,164
MB 72,20,168
MB 76,20,172
W 0
MB 72,24,176
E 64
MB 76,24,180
MB 72,28,184
E 65
MB 76,28,188
CV 96,64
E 66
E 67
s_nop 0
CV 97,66
E 68
s_waitcnt vmcnt(12)
s_barrier
R a,0,12,16
E 69
s_xor_b32 m0, s65, 0x4000
s_xor_b32 s66, s63, 0x54000
R a,4,13,16
G 32,32,66,0,nt
CV 100,68
E 70
R a,8,14,16
E 71
R a,12,15,16
G 33,32,66,1,nt
CV 101,70
E 72
R a,16,12,20
E 73
W 3
ZB 80,0,160
G 34,32,66,2,nt
R a,20,13,20
ZB 84,0,164
CV 98,72
E 74
MB 80,4,168
R a,24,14,20
MB 84,4,172
E 75
W 3
MB 80,8,176
G 35,32,66,3,nt
R a,28,15,20
MB 84,8,180
CV 99,74
E 76
MB 80,12,184
s_waitcnt vmcnt(12)
s_barrier
T 32,24,32
T 34,24,36
MB 84,12,188
E 77
s_xor_b32 m0, s65, 0x8000
s_xor_b32 s66, s63, 0x44000
W 4
ZB 88,16,160
G 56,36,66,0,nt
T 36,25,32
ZB 92,16,164
T 38,25,36
CV 102,76
E 78
s_getpc_b64 s[88:89]
L_ct0_561:
s_and_b32 s89, s89, 0xffff
s_mov_b32 s90, L_code_end-L_ct0_561
s_mov_b32 s91, 0x20000
v_and_b32 v62, 0x70, v59
v_lshlrev_b32 v62, 3, v62
s_add_u32 s7, s1, 4096
buffer_load_dword v3, v62, s[88:91], s7 offen
MB 88,20,168
T 40,26,32
T 42,26,36
MB 92,20,172
E 79
W 6
MB 88,24,176
G 57,36,66,1,nt
T 44,27,32
MB 92,24,180
T 46,27,36
CV 103,78
E 80
MB 88,28,184
T 48,28,32
T 50,28,36
MB 92,28,188
E 81
W 6
ZA 128,32,96
G 56,36,66,2,nt
T 52,29,32
ZA 132,32,100
T 54,29,36
CV 104,80
E 82
ZA 136,36,96
T 56,30,32
T 58,30,36
ZA 140,36,100
E 83
W 6
ZA 144,40,96
G 57,36,66,3,nt
T 60,31,32
ZA 148,40,100
T 62,31,36
CV 105,82
E 84
ZA 152,44,96
E 85
ZA 156,44,100
W 4
ZA 160,48,96
s_waitcnt vmcnt(13)
s_barrier
R a,0,12,48
CV 108,84
ZA 164,48,100
E 86
s_xor_b32 m0, s65, 0xc000
s_xor_b32 s66, s63, 0x41000
ZA 168,52,96
G 32,32,66,0,nt
ZA 172,52,100
R a,4,13,48
E 87
W 2
ZA 176,56,96
R a,8,14,48
CV 109,86
ZA 180,56,100
E 88
ZA 184,60,96
G 33,32,66,1,nt
ZA 188,60,100
R a,12,15,48
E 89
ZD 112,52,96
R a,16,12,52
CV 106,88
ZD 116,52,100
E 90
W 3
ZB 64,0,160
G 34,32,66,2,nt
ZB 68,0,164
R a,20,13,52
E 91
MB 64,4,168
R a,24,14,52
CV 107,90
MB 68,4,172
E 92
W 3
MB 64,8,176
G 35,32,66,3,nt
MB 68,8,180
R a,28,15,52
E 93
MB 64,12,184
s_waitcnt vmcnt(13)
s_barrier
T 32,16,0
T 34,16,4
MB 68,12,188
CV 110,92
E 94
s_xor_b32 m0, s65, 0x10000
s_xor_b32 s66, s63, 0x54000
W 4
ZB 72,16,160
G 56,36,66,0,nt
T 36,17,0
ZB 76,16,164
T 38,17,4
E 95
MB 72,20,168
T 40,18,0
MB 76,20,172
T 42,18,4
CV 111,94
W 6
MB 72,24,176
G 57,36,66,1,nt
T 44,19,0
MB 76,24,180
T 46,19,4
E 64
MB 72,28,184
T 48,20,0
T 50,20,4
MB 76,28,188
E 65
W 6
MA 128,32,104
G 56,36,66,2,nt
T 52,21,0
MA 132,32,108
T 54,21,4
CV 96,64
E 66
MA 136,36,104
T 56,22,0
T 58,22,4
MA 140,36,108
E 67
W 6
MA 144,40,104
G 57,36,66,3,nt
T 60,23,0
MA 148,40,108
T 62,23,4
CV 97,66
E 68
MA 152,44,104
E 69
MA 156,44,108
W 4
MA 160,48,104
s_waitcnt vmcnt(13)
s_barrier
R a,0,8,16
CV 100,68
MA 164,48,108
E 70
s_xor_b32 m0, s65, 0x14000
s_xor_b32 s66, s63, 0x51000
MA 168,52,104
G 32,32,66,0,nt
MA 172,52,108
R a,4,9,16
E 71
W 2
MA 176,56,104
R a,8,10,16
CV 101,70
MA 180,56,108
E 72
MA 184,60,104
G 33,32,66,1,nt
MA 188,60,108
R a,12,11,16
E 73
MD 112,52,104
R a,16,8,20
CV 98,72
MD 116,52,108
E 74
W 3
ZB 80,0,160
G 34,32,66,2,nt
ZB 84,0,164
R a,20,9,20
E 75
MB 80,4,168
R a,24,10,20
CV 99,74
MB 84,4,172
E 76
W 3
MB 80,8,176
G 35,32,66,3,nt
MB 84,8,180
R a,28,11,20
E 77
MB 80,12,184
s_waitcnt vmcnt(12)
s_barrier
T 32,16,32
T 34,16,36
MB 84,12,188
CV 102,76
E 78
s_xor_b32 m0, s65, 0x18000
s_xor_b32 s66, s63, 0x41000
W 4
ZB 88,16,160
G 56,36,66,0,nt
T 36,17,32
ZB 92,16,164
T 38,17,36
E 79
MB 88,20,168
T 40,18,32
MB 92,20,172
T 42,18,36
CV 103,78
W 6
MB 88,24,176
G 57,36,66,1,nt
T 44,19,32
MB 92,24,180
T 46,19,36
E 80
MB 88,28,184
T 48,20,32
T 50,20,36
MB 92,28,188
E 81
W 6
MA 128,32,96
G 56,36,66,2,nt
T 52,21,32
MA 132,32,100
T 54,21,36
CV 104,80
E 82
MA 136,36,96
T 56,22,32
T 58,22,36
MA 140,36,100
E 83
W 6
MA 144,40,96
G 57,36,66,3,nt
T 60,23,32
MA 148,40,100
T 62,23,36
CV 105,82
E 84
MA 152,44,96
E 85
MA 156,44,100
W 4
MA 160,48,96
s_waitcnt vmcnt(12)
s_barrier
R a,0,8,48
CV 108,84
MA 164,48,100
E 86
s_xor_b32 m0, s65, 0x1c000
s_xor_b32 s66, s63, 0x45000
MA 168,52,96
G 32,32,66,0,nt
MA 172,52,100
R a,4,9,48
E 87
W 2
MA 176,56,96
R a,8,10,48
CV 109,86
MA 180,56,100
E 88
MA 184,60,96
G 33,32,66,1,nt
MA 188,60,100
R a,12,11,48
E 89
MD 112,52,96
R a,16,8,52
CV 106,88
MD 116,52,100
E 90
W 3
ZB 64,0,160
G 34,32,66,2,nt
ZB 68,0,164
R a,20,9,52
E 91
MB 64,4,168
R a,24,10,52
CV 107,90
MB 68,4,172
E 92
W 3
MB 64,8,176
G 35,32,66,3,nt
MB 68,8,180
R a,28,11,52
E 93
MB 64,12,184
s_waitcnt vmcnt(12)
s_barrier
T 32,24,0
T 34,24,4
MB 68,12,188
CV 110,92
E 94
s_xor_b32 m0, s65, 0x0
s_xor_b32 s66, s63, 0x51000
W 4
ZB 72,16,160
G 56,36,66,0,nt
T 36,25,0
ZB 76,16,164
T 38,25,4
E 95
MB 72,20,168
T 40,26,0
MB 76,20,172
T 42,26,4
CV 111,94
W 6
MB 72,24,176
G 57,36,66,1,nt
T 44,27,0
MB 76,24,180
T 46,27,4
E 64
MB 72,28,184
T 48,28,0
T 50,28,4
MB 76,28,188
E 65
W 6
MA 128,32,104
G 56,36,66,2,nt
T 52,29,0
MA 132,32,108
T 54,29,4
CV 96,64
E 66
MA 136,36,104
T 56,30,0
T 58,30,4
MA 140,36,108
E 67
W 6
MA 144,40,104
G 57,36,66,3,nt
T 60,31,0
MA 148,40,108
T 62,31,4
CV 97,66
E 68
MA 152,44,104
E 69
MA 156,44,108
W 4
MA 160,48,104
s_waitcnt vmcnt(12)
s_barrier
R a,0,12,16
CV 100,68
MA 164,48,108
E 70
s_xor_b32 m0, s65, 0x4000
s_xor_b32 s66, s63, 0x55000
MA 168,52,104
G 32,32,66,0,nt
MA 172,52,108
R a,4,13,16
E 71
W 2
MA 176,56,104
R a,8,14,16
CV 101,70
MA 180,56,108
E 72
MA 184,60,104
G 33,32,66,1,nt
MA 188,60,108
R a,12,15,16
E 73
MD 112,52,104
R a,16,12,20
CV 98,72
MD 116,52,108
E 74
W 3
ZB 80,0,160
G 34,32,66,2,nt
ZB 84,0,164
R a,20,13,20
E 75
MB 80,4,168
R a,24,14,20
CV 99,74
MB 84,4,172
E 76
W 3
MB 80,8,176
G 35,32,66,3,nt
MB 84,8,180
R a,28,15,20
E 77
MB 80,12,184
s_waitcnt vmcnt(12)
s_barrier
T 32,24,32
T 34,24,36
MB 84,12,188
CV 102,76
E 78
s_xor_b32 m0, s65, 0x8000
s_xor_b32 s66, s63, 0x45000
W 4
ZB 88,16,160
G 56,36,66,0,nt
T 36,25,32
ZB 92,16,164
T 38,25,36
E 79
MB 88,20,168
T 40,26,32
MB 92,20,172
T 42,26,36
CV 103,78
W 6
MB 88,24,176
G 57,36,66,1,nt
T 44,27,32
MB 92,24,180
T 46,27,36
E 80
MB 88,28,184
T 48,28,32
T 50,28,36
MB 92,28,188
E 81
W 6
MA 128,32,96
G 56,36,66,2,nt
T 52,29,32
MA 132,32,100
T 54,29,36
CV 104,80
E 82
MA 136,36,96
T 56,30,32
T 58,30,36
MA 140,36,100
E 83
W 6
MA 144,40,96
G 57,36,66,3,nt
T 60,31,32
MA 148,40,100
T 62,31,36
CV 105,82
E 84
MA 152,44,96
E 85
MA 156,44,100
W 4
MA 160,48,96
s_waitcnt vmcnt(12)
s_barrier
R a,0,12,48
CV 108,84
MA 164,48,100
E 86
s_xor_b32 m0, s65, 0xc000
s_xor_b32 s66, s63, 0x42000
MA 168,52,96
G 32,32,66,0,nt
MA 172,52,100
R a,4,13,48
E 87
W 2
MA 176,56,96
R a,8,14,48
CV 109,86
MA 180,56,100
E 88
MA 184,60,96
G 33,32,66,1,nt
MA 188,60,100
R a,12,15,48
E 89
MD 112,52,96
R a,16,12,52
CV 106,88
MD 116,52,100
E 90
W 3
ZB 64,0,160
G 34,32,66,2,nt
ZB 68,0,164
R a,20,13,52
E 91
MB 64,4,168
R a,24,14,52
CV 107,90
MB 68,4,172
E 92
W 3
MB 64,8,176
G 35,32,66,3,nt
MB 68,8,180
R a,28,15,52
E 93
MB 64,12,184
s_waitcnt vmcnt(12)
s_barrier
T 32,16,0
T 34,16,4
MB 68,12,188
CV 110,92
E 94
s_xor_b32 m0, s65, 0x10000
s_xor_b32 s66, s63, 0x55000
W 4
ZB 72,16,160
G 56,36,66,0,nt
T 36,17,0
ZB 76,16,164
T 38,17,4
E 95
MB 72,20,168
T 40,18,0
MB 76,20,172
T 42,18,4
CV 111,94
W 6
MB 72,24,176
G 57,36,66,1,nt
T 44,19,0
MB 76,24,180
T 46,19,4
E 64
MB 72,28,184
T 48,20,0
T 50,20,4
MB 76,28,188
E 65
W 6
MA 128,32,104
G 56,36,66,2,nt
T 52,21,0
MA 132,32,108
T 54,21,4
CV 96,64
E 66
MA 136,36,104
T 56,22,0
T 58,22,4
MA 140,36,108
E 67
W 6
MA 144,40,104
G 57,36,66,3,nt
T 60,23,0
MA 148,40,108
T 62,23,4
CV 97,66
E 68
MA 152,44,104
E 69
MA 156,44,108
W 4
MA 160,48,104
s_waitcnt vmcnt(12)
s_barrier
R a,0,8,16
CV 100,68
MA 164,48,108
E 70
s_xor_b32 m0, s65, 0x14000
s_xor_b32 s66, s63, 0x52000
MA 168,52,104
G 32,32,66,0,nt
MA 172,52,108
R a,4,9,16
E 71
W 2
MA 176,56,104
R a,8,10,16
CV 101,70
MA 180,56,108
E 72
MA 184,60,104
G 33,32,66,1,nt
MA 188,60,108
R a,12,11,16
E 73
MD 112,52,104
R a,16,8,20
CV 98,72
MD 116,52,108
E 74
W 3
ZB 80,0,160
G 34,32,66,2,nt
ZB 84,0,164
R a,20,9,20
E 75
MB 80,4,168
R a,24,10,20
CV 99,74
MB 84,4,172
E 76
W 3
MB 80,8,176
G 35,32,66,3,nt
MB 84,8,180
R a,28,11,20
E 77
MB 80,12,184
s_waitcnt vmcnt(12)
s_barrier
T 32,16,32
T 34,16,36
MB 84,12,188
CV 102,76
E 78
s_xor_b32 m0, s65, 0x18000
s_xor_b32 s66, s63, 0x42000
W 4
ZB 88,16,160
G 56,36,66,0,nt
T 36,17,32
ZB 92,16,164
T 38,17,36
E 79
MB 88,20,168
T 40,18,32
MB 92,20,172
T 42,18,36
CV 103,78
W 6
MB 88,24,176
G 57,36,66,1,nt
T 44,19,32
MB 92,24,180
T 46,19,36
E 80
MB 88,28,184
T 48,20,32
T 50,20,36
MB 92,28,188
E 81
W 6
MA 128,32,96
G 56,36,66,2,nt
T 52,21,32
MA 132,32,100
T 54,21,36
CV 104,80
E 82
MA 136,36,96
T 56,22,32
T 58,22,36
MA 140,36,100
E 83
W 6
MA 144,40,96
G 57,36,66,3,nt
T 60,23,32
MA 148,40,100
T 62,23,36
CV 105,82
E 84
MA 152,44,96
E 85
MA 156,44,100
W 4
MA 160,48,96
s_waitcnt vmcnt(12)
s_barrier
R a,0,8,48
CV 108,84
MA 164,48,100
E 86
s_xor_b32 m0, s65, 0x1c000
s_xor_b32 s66, s63, 0x46000
MA 168,52,96
G 32,32,66,0,nt
MA 172,52,100
R a,4,9,48
E 87
W 2
MA 176,56,96
R a,8,10,48
CV 109,86
MA 180,56,100
E 88
MA 184,60,96
G 33,32,66,1,nt
MA 188,60,100
R a,12,11,48
E 89
MD 112,52,96
R a,16,8,52
CV 106,88
MD 116,52,100
E 90
W 3
ZB 64,0,160
G 34,32,66,2,nt
ZB 68,0,164
R a,20,9,52
E 91
MB 64,4,168
R a,24,10,52
CV 107,90
MB 68,4,172
E 92
W 3
MB 64,8,176
G 35,32,66,3,nt
MB 68,8,180
R a,28,11,52
E 93
MB 64,12,184
s_waitcnt vmcnt(12)
s_barrier
T 32,24,0
T 34,24,4
MB 68,12,188
CV 110,92
E 94
s_xor_b32 m0, s65, 0x0
s_xor_b32 s66, s63, 0x52000
W 4
ZB 72,16,160
G 56,36,66,0,nt
T 36,25,0
ZB 76,16,164
T 38,25,4
E 95
MB 72,20,168
T 40,26,0
MB 76,20,172
T 42,26,4
CV 111,94
W 6
MB 72,24,176
G 57,36,66,1,nt
T 44,27,0
MB 76,24,180
T 46,27,4
E 64
MB 72,28,184
T 48,28,0
T 50,28,4
MB 76,28,188
E 65
W 6
MA 128,32,104
G 56,36,66,2,nt
T 52,29,0
MA 132,32,108
T 54,29,4
CV 96,64
E 66
MA 136,36,104
T 56,30,0
T 58,30,4
MA 140,36,108
E 67
W 6
MA 144,40,104
G 57,36,66,3,nt
T 60,31,0
MA 148,40,108
T 62,31,4
CV 97,66
E 68
MA 152,44,104
E 69
MA 156,44,108
W 4
MA 160,48,104
s_waitcnt vmcnt(12)
s_barrier
R a,0,12,16
CV 100,68
MA 164,48,108
E 70
s_xor_b32 m0, s65, 0x4000
s_xor_b32 s66, s63, 0x56000
MA 168,52,104
G 32,32,66,0,nt
MA 172,52,108
R a,4,13,16
E 71
W 2
MA 176,56,104
R a,8,14,16
CV 101,70
MA 180,56,108
E 72
MA 184,60,104
G 33,32,66,1,nt
MA 188,60,108
R a,12,15,16
E 73
MD 112,52,104
R a,16,12,20
CV 98,72
MD 116,52,108
E 74
W 3
ZB 80,0,160
G 34,32,66,2,nt
ZB 84,0,164
R a,20,13,20
E 75
MB 80,4,168
R a,24,14,20
CV 99,74
MB 84,4,172
E 76
W 3
MB 80,8,176
G 35,32,66,3,nt
MB 84,8,180
R a,28,15,20
E 77
MB 80,12,184
s_waitcnt vmcnt(12)
s_barrier
T 32,24,32
T 34,24,36
MB 84,12,188
CV 102,76
E 78
s_xor_b32 m0, s65, 0x8000
s_xor_b32 s66, s63, 0x46000
W 4
ZB 88,16,160
G 56,36,66,0,nt
T 36,25,32
ZB 92,16,164
T 38,25,36
E 79
MB 88,20,168
T 40,26,32
MB 92,20,172
T 42,26,36
CV 103,78
W 6
MB 88,24,176
G 57,36,66,1,nt
T 44,27,32
MB 92,24,180
T 46,27,36
E 80
MB 88,28,184
T 48,28,32
T 50,28,36
MB 92,28,188
E 81
W 6
MA 128,32,96
G 56,36,66,2,nt
T 52,29,32
MA 132,32,100
T 54,29,36
CV 104,80
E 82
MA 136,36,96
T 56,30,32
T 58,30,36
MA 140,36,100
E 83
W 6
MA 144,40,96
G 57,36,66,3,nt
T 60,31,32
MA 148,40,100
T 62,31,36
CV 105,82
E 84
MA 152,44,96
E 85
MA 156,44,100
W 4
MA 160,48,96
s_waitcnt vmcnt(12)
s_barrier
R a,0,12,48
CV 108,84
MA 164,48,100
E 86
s_xor_b32 m0, s65, 0xc000
s_xor_b32 s66, s63, 0x43000
MA 168,52,96
G 32,32,66,0,nt
MA 172,52,100
R a,4,13,48
E 87
W 2
MA 176,56,96
R a,8,14,48
CV 109,86
MA 180,56,100
E 88
MA 184,60,96
G 33,32,66,1,nt
MA 188,60,100
R a,12,15,48
E 89
MD 112,52,96
R a,16,12,52
CV 106,88
MD 116,52,100
E 90
W 3
ZB 64,0,160
G 34,32,66,2,nt
ZB 68,0,164
R a,20,13,52
E 91
MB 64,4,168
R a,24,14,52
CV 107,90
MB 68,4,172
E 92
W 3
MB 64,8,176
G 35,32,66,3,nt
MB 68,8,180
R a,28,15,52
E 93
MB 64,12,184
s_waitcnt vmcnt(12)
s_barrier
T 32,16,0
T 34,16,4
MB 68,12,188
CV 110,92
E 94
s_xor_b32 m0, s65, 0x10000
s_xor_b32 s66, s63, 0x56000
W 4
ZB 72,16,160
G 56,36,66,0,nt
T 36,17,0
ZB 76,16,164
T 38,17,4
E 95
MB 72,20,168
T 40,18,0
MB 76,20,172
T 42,18,4
CV 111,94
W 6
MB 72,24,176
G 57,36,66,1,nt
T 44,19,0
MB 76,24,180
T 46,19,4
E 64
MB 72,28,184
T 48,20,0
T 50,20,4
MB 76,28,188
E 65
W 6
MA 128,32,104
G 56,36,66,2,nt
T 52,21,0
MA 132,32,108
T 54,21,4
CV 96,64
E 66
MA 136,36,104
T 56,22,0
T 58,22,4
MA 140,36,108
E 67
W 6
MA 144,40,104
G 57,36,66,3,nt
T 60,23,0
MA 148,40,108
T 62,23,4
CV 97,66
E 68
MA 152,44,104
E 69
MA 156,44,108
W 4
MA 160,48,104
s_waitcnt vmcnt(12)
s_barrier
R a,0,8,16
CV 100,68
MA 164,48,108
E 70
s_xor_b32 m0, s65, 0x14000
s_xor_b32 s66, s63, 0x53000
MA 168,52,104
G 32,32,66,0,nt
MA 172,52,108
R a,4,9,16
E 71
W 2
MA 176,56,104
R a,8,10,16
CV 101,70
MA 180,56,108
E 72
MA 184,60,104
G 33,32,66,1,nt
MA 188,60,108
R a,12,11,16
E 73
MD 112,52,104
R a,16,8,20
CV 98,72
MD 116,52,108
E 74
W 3
ZB 80,0,160
G 34,32,66,2,nt
ZB 84,0,164
R a,20,9,20
E 75
MB 80,4,168
R a,24,10,20
CV 99,74
MB 84,4,172
E 76
W 3
MB 80,8,176
G 35,32,66,3,nt
MB 84,8,180
R a,28,11,20
E 77
MB 80,12,184
s_waitcnt vmcnt(12)
s_barrier
T 32,16,32
T 34,16,36
MB 84,12,188
CV 102,76
E 78
s_xor_b32 m0, s65, 0x18000
s_xor_b32 s66, s63, 0x43000
W 4
ZB 88,16,160
G 56,36,66,0,nt
T 36,17,32
ZB 92,16,164
T 38,17,36
E 79
MB 88,20,168
T 40,18,32
MB 92,20,172
T 42,18,36
CV 103,78
W 6
MB 88,24,176
G 57,36,66,1,nt
T 44,19,32
MB 92,24,180
T 46,19,36
E 80
MB 88,28,184
T 48,20,32
T 50,20,36
MB 92,28,188
E 81
W 6
MA 128,32,96
G 56,36,66,2,nt
T 52,21,32
MA 132,32,100
T 54,21,36
CV 104,80
E 82
MA 136,36,96
T 56,22,32
T 58,22,36
MA 140,36,100
E 83
W 6
MA 144,40,96
G 57,36,66,3,nt
T 60,23,32
MA 148,40,100
T 62,23,36
CV 105,82
E 84
MA 152,44,96
E 85
MA 156,44,100
W 4
MA 160,48,96
s_waitcnt vmcnt(12)
s_barrier
R a,0,8,48
CV 108,84
MA 164,48,100
E 86
s_xor_b32 m0, s65, 0x1c000
s_xor_b32 s66, s63, 0x47000
MA 168,52,96
G 32,32,66,0,nt
MA 172,52,100
R a,4,9,48
E 87
W 2
MA 176,56,96
R a,8,10,48
CV 109,86
MA 180,56,100
E 88
MA 184,60,96
G 33,32,66,1,nt
MA 188,60,100
R a,12,11,48
E 89
MD 112,52,96
R a,16,8,52
CV 106,88
MD 116,52,100
E 90
W 3
ZB 64,0,160
G 34,32,66,2,nt
ZB 68,0,164
R a,20,9,52
E 91
MB 64,4,168
R a,24,10,52
CV 107,90
MB 68,4,172
E 92
W 3
MB 64,8,176
G 35,32,66,3,nt
MB 68,8,180
R a,28,11,52
E 93
MB 64,12,184
s_waitcnt vmcnt(12)
s_barrier
T 32,24,0
T 34,24,4
MB 68,12,188
CV 110,92
E 94
s_xor_b32 m0, s65, 0x0
s_xor_b32 s66, s63, 0x53000
W 4
ZB 72,16,160
G 56,36,66,0,nt
T 36,25,0
ZB 76,16,164
T 38,25,4
E 95
MB 72,20,168
T 40,26,0
MB 76,20,172
T 42,26,4
CV 111,94
W 6
MB 72,24,176
G 57,36,66,1,nt
T 44,27,0
MB 76,24,180
T 46,27,4
E 64
MB 72,28,184
T 48,28,0
T 50,28,4
MB 76,28,188
E 65
W 6
MA 128,32,104
G 56,36,66,2,nt
T 52,29,0
MA 132,32,108
T 54,29,4
CV 96,64
E 66
MA 136,36,104
T 56,30,0
T 58,30,4
MA 140,36,108
E 67
W 6
MA 144,40,104
G 57,36,66,3,nt
T 60,31,0
MA 148,40,108
T 62,31,4
CV 97,66
E 68
MA 152,44,104
E 69
MA 156,44,108
W 4
MA 160,48,104
s_waitcnt vmcnt(12)
s_barrier
R a,0,12,16
CV 100,68
MA 164,48,108
E 70
s_xor_b32 m0, s65, 0x4000
s_xor_b32 s66, s63, 0x57000
MA 168,52,104
G 32,32,66,0,nt
MA 172,52,108
R a,4,13,16
E 71
W 2
MA 176,56,104
R a,8,14,16
CV 101,70
MA 180,56,108
E 72
MA 184,60,104
G 33,32,66,1,nt
MA 188,60,108
R a,12,15,16
E 73
MD 112,52,104
R a,16,12,20
CV 98,72
MD 116,52,108
E 74
W 3
ZB 80,0,160
G 34,32,66,2,nt
ZB 84,0,164
R a,20,13,20
E 75
MB 80,4,168
R a,24,14,20
CV 99,74
MB 84,4,172
E 76
W 3
MB 80,8,176
G 35,32,66,3,nt
MB 84,8,180
R a,28,15,20
E 77
MB 80,12,184
s_waitcnt vmcnt(12)
s_barrier
T 32,24,32
T 34,24,36
MB 84,12,188
CV 102,76
E 78
s_xor_b32 m0, s65, 0x8000
s_xor_b32 s66, s63, 0x47000
W 4
ZB 88,16,160
G 56,36,66,0,nt
T 36,25,32
ZB 92,16,164
T 38,25,36
E 79
MB 88,20,168
T 40,26,32
MB 92,20,172
T 42,26,36
CV 103,78
W 6
MB 88,24,176
G 57,36,66,1,nt
T 44,27,32
MB 92,24,180
T 46,27,36
E 80
MB 88,28,184
T 48,28,32
T 50,28,36
MB 92,28,188
E 81
W 6
MA 128,32,96
G 56,36,66,2,nt
T 52,29,32
MA 132,32,100
T 54,29,36
CV 104,80
E 82
MA 136,36,96
T 56,30,32
T 58,30,36
MA 140,36,100
E 83
W 6
MA 144,40,96
G 57,36,66,3,nt
T 60,31,32
MA 148,40,100
T 62,31,36
CV 105,82
E 84
MA 152,44,96
E 85
MA 156,44,100
W 4
MA 160,48,96
s_waitcnt vmcnt(12)
s_barrier
R a,0,12,48
CV 108,84
MA 164,48,100
E 86
s_xor_b32 m0, s65, 0xc000
s_xor_b32 s66, s63, 0x57000
MA 168,52,96
G 56,36,66,0,nt
MA 172,52,100
R a,4,13,48
E 87
W 2
MA 176,56,96
R a,8,14,48
CV 109,86
MA 180,56,100
E 88
MA 184,60,96
G 57,36,66,1,nt
MA 188,60,100
R a,12,15,48
E 89
MD 112,52,96
R a,16,12,52
CV 106,88
MD 116,52,100
E 90
W 3
ZB 64,0,160
G 56,36,66,2,nt
ZB 68,0,164
R a,20,13,52
E 91
MB 64,4,168
R a,24,14,52
CV 107,90
MB 68,4,172
E 92
W 3
MB 64,8,176
G 57,36,66,3,nt
MB 68,8,180
R a,28,15,52
E 93
MB 64,12,184
s_waitcnt vmcnt(12)
s_barrier
T 32,16,0
T 34,16,4
MB 68,12,188
CV 110,92
E 94
s_xor_b32 m0, s65, 0x10000
s_xor_b32 s66, s60, 0x0
W 4
ZB 72,16,160
G 36,8,66,0
T 36,17,0
ZB 76,16,164
T 38,17,4
E 95
MB 72,20,168
T 40,18,0
MB 76,20,172
T 42,18,4
CV 111,94
W 6
MB 72,24,176
G 37,8,66,1
T 44,19,0
MB 76,24,180
T 46,19,4
E 64
MB 72,28,184
T 48,20,0
T 50,20,4
MB 76,28,188
E 65
W 6
MA 128,32,104
G 38,8,66,2
T 52,21,0
MA 132,32,108
T 54,21,4
CV 96,64
E 66
MA 136,36,104
T 56,22,0
T 58,22,4
MA 140,36,108
E 67
W 6
MA 144,40,104
G 39,8,66,3
T 60,23,0
MA 148,40,108
T 62,23,4
CV 97,66
E 68
MA 152,44,104
E 69
MA 156,44,108
W 4
MA 160,48,104
s_waitcnt vmcnt(12)
s_barrier
R a,0,8,16
CV 100,68
MA 164,48,108
E 70
s_xor_b32 m0, s65, 0x14000
s_xor_b32 s66, s61, 0x0
MA 168,52,104
G 40,20,66,0
MA 172,52,108
R a,4,9,16
E 71
W 2
MA 176,56,104
R a,8,10,16
CV 101,70
MA 180,56,108
E 72
MA 184,60,104
G 41,20,66,1
MA 188,60,108
R a,12,11,16
E 73
MD 112,52,104
R a,16,8,20
CV 98,72
MD 116,52,108
E 74
W 3
ZB 80,0,160
G 42,20,66,2
ZB 84,0,164
R a,20,9,20
E 75
MB 80,4,168
R a,24,10,20
CV 99,74
MB 84,4,172
E 76
W 3
MB 80,8,176
G 43,20,66,3
R a,28,11,20
MB 84,8,180
v_xor_b32 v8, s70, v8
E 77
MB 80,12,184
s_waitcnt vmcnt(12)
s_barrier
T 32,16,32
T 34,16,36
CV 102,76
MB 84,12,188
v_xor_b32 v9, s70, v9
E 78
s_xor_b32 m0, s65, 0x18000
s_xor_b32 s66, s61, 0x40000
W 4
ZB 88,16,160
G 40,20,66,0
T 36,17,32
ZB 92,16,164
T 38,17,36
v_xor_b32 v10, s70, v10
E 79
MB 88,20,168
T 40,18,32
T 42,18,36
MB 92,20,172
CV 103,78
v_xor_b32 v11, s70, v11
W 6
MB 88,24,176
G 41,20,66,1
T 44,19,32
MB 92,24,180
T 46,19,36
v_xor_b32 v12, s70, v12
E 80
MB 88,28,184
T 48,20,32
T 50,20,36
MB 92,28,188
v_xor_b32 v13, s70, v13
E 81
W 6
MA 128,32,96
G 42,20,66,2
T 52,21,32
T 54,21,36
MA 132,32,100
CV 104,80
v_xor_b32 v14, s70, v14
E 82
MA 136,36,96
T 56,22,32
T 58,22,36
MA 140,36,100
v_xor_b32 v15, s70, v15
E 83
W 6
MA 144,40,96
G 43,20,66,3
T 60,23,32
MA 148,40,100
T 62,23,36
CV 105,82
E 84
MA 152,44,96
E 85
MA 156,44,100
W 4
MA 160,48,96
CV 108,84
MA 164,48,100
E 86
MA 168,52,96
E 87
MA 172,52,100
W 0
MA 176,56,96
CV 109,86
MA 180,56,100
E 88
MA 184,60,96
E 89
MA 188,60,100
MD 112,52,96
CV 106,88
MD 116,52,100
E 90
E 91
s_nop 0
CV 107,90
E 92
E 93
s_waitcnt vmcnt(12)
s_barrier
T 32,16,48
T 34,16,52
CV 110,92
E 94
s_xor_b32 m0, s65, 0x1c000
s_xor_b32 s66, s60, 0x100
T 36,17,48
T 38,17,52
G 36,8,66,0
E 95
T 40,18,48
T 42,18,52
CV 111,94
T 44,19,48
T 46,19,52
G 37,8,66,1
T 48,20,48
T 50,20,52
W 6
MA 128,32,104
G 38,8,66,2
MA 132,32,108
T 52,21,48
T 54,21,52
MA 136,36,104
T 56,22,48
MA 140,36,108
T 58,22,52
W 6
MA 144,40,104
G 39,8,66,3
MA 148,40,108
T 60,23,48
T 62,23,52
MA 152,44,104
MA 156,44,108
W 4
MA 160,48,104
MA 164,48,108
MA 168,52,104
MA 172,52,108
W 0
MA 176,56,104
MA 180,56,108
MA 184,60,104
MA 188,60,108
MD 112,52,104
MD 116,52,108
s_nop 6
v_mov_b32 v60, v112
v_mov_b32 v61, v116
v_cmp_nle_f32 vcc, s76, v60
v_cmp_nge_f32 s[82:83], s77, v60
v_cmp_nle_f32 s[84:85], s76, v61
v_cmp_nge_f32 s[90:91], s77, v61
s_nop 1
s_or_b64 vcc, vcc, s[82:83]
s_or_b64 vcc, vcc, s[84:85]
s_or_b64 vcc, vcc, s[90:91]
s_cbranch_scc1 L_slow_c0B1
L_back_c0B1:
v_rcp_f32 v0, v60
v_rcp_f32 v1, v61
s_nop 0
v_pk_mul_f32 v[128:129], v[128:129], v[0:1] op_sel_hi:[1,0]
v_pk_mul_f32 v[130:131], v[130:131], v[0:1] op_sel_hi:[1,0]
v_pk_mul_f32 v[132:133], v[132:133], v[0:1] op_sel:[0,1]
v_pk_mul_f32 v[134:135], v[134:135], v[0:1] op_sel:[0,1]
v_pk_mul_f32 v[136:137], v[136:137], v[0:1] op_sel_hi:[1,0]
v_pk_mul_f32 v[138:139], v[138:139], v[0:1] op_sel_hi:[1,0]
v_pk_mul_f32 v[140:141], v[140:141], v[0:1] op_sel:[0,1]
v_pk_mul_f32 v[142:143], v[142:143], v[0:1] op_sel:[0,1]
CV 128,128
CV 130,130
CV 132,132
CV 134,134
CV 136,136
CV 138,138
CV 140,140
CV 142,142
AW 160,128
AW 161,130
AW 164,132
AW 165,134
AW 162,136
AW 163,138
AW 166,140
AW 167,142
v_pk_mul_f32 v[144:145], v[144:145], v[0:1] op_sel_hi:[1,0]
v_pk_mul_f32 v[146:147], v[146:147], v[0:1] op_sel_hi:[1,0]
v_pk_mul_f32 v[148:149], v[148:149], v[0:1] op_sel:[0,1]
v_pk_mul_f32 v[150:151], v[150:151], v[0:1] op_sel:[0,1]
v_pk_mul_f32 v[152:153], v[152:153], v[0:1] op_sel_hi:[1,0]
v_pk_mul_f32 v[154:155], v[154:155], v[0:1] op_sel_hi:[1,0]
v_pk_mul_f32 v[156:157], v[156:157], v[0:1] op_sel:[0,1]
v_pk_mul_f32 v[158:159], v[158:159], v[0:1] op_sel:[0,1]
CV 144,144
CV 146,146
CV 148,148
CV 150,150
CV 152,152
CV 154,154
CV 156,156
CV 158,158
AW 168,144
AW 169,146
AW 172,148
AW 173,150
AW 170,152
AW 171,154
AW 174,156
AW 175,158
v_pk_mul_f32 v[160:161], v[160:161], v[0:1] op_sel_hi:[1,0]
v_pk_mul_f32 v[162:163], v[162:163], v[0:1] op_sel_hi:[1,0]
v_pk_mul_f32 v[164:165], v[164:165], v[0:1] op_sel:[0,1]
v_pk_mul_f32 v[166:167], v[166:167], v[0:1] op_sel:[0,1]
v_pk_mul_f32 v[168:169], v[168:169], v[0:1] op_sel_hi:[1,0]
v_pk_mul_f32 v[170:171], v[170:171], v[0:1] op_sel_hi:[1,0]
v_pk_mul_f32 v[172:173], v[172:173], v[0:1] op_sel:[0,1]
v_pk_mul_f32 v[174:175], v[174:175], v[0:1] op_sel:[0,1]
CV 160,160
CV 162,162
CV 164,164
CV 166,166
CV 168,168
CV 170,170
CV 172,172
CV 174,174
AW 176,160
AW 177,162
AW 180,164
AW 181,166
AW 178,168
AW 179,170
AW 182,172
AW 183,174
v_pk_mul_f32 v[176:177], v[176:177], v[0:1] op_sel_hi:[1,0]
v_pk_mul_f32 v[178:179], v[178:179], v[0:1] op_sel_hi:[1,0]
v_pk_mul_f32 v[180:181], v[180:181], v[0:1] op_sel:[0,1]
v_pk_mul_f32 v[182:183], v[182:183], v[0:1] op_sel:[0,1]
v_pk_mul_f32 v[184:185], v[184:185], v[0:1] op_sel_hi:[1,0]
v_pk_mul_f32 v[186:187], v[186:187], v[0:1] op_sel_hi:[1,0]
v_pk_mul_f32 v[188:189], v[188:189], v[0:1] op_sel:[0,1]
v_pk_mul_f32 v[190:191], v[190:191], v[0:1] op_sel:[0,1]
CV 176,176
CV 178,178
CV 180,180
CV 182,182
CV 184,184
CV 186,186
CV 188,188
CV 190,190
AW 184,176
AW 185,178
AW 188,180
AW 189,182
AW 186,184
AW 187,186
AW 190,188
AW 191,190
s_waitcnt vmcnt(8)
s_barrier
R v,128,12,0
R v,132,12,4
R v,136,13,0
R v,140,13,4
R v,144,14,0
R v,148,14,4
R v,152,15,0
R v,156,15,4
T 0,24,16
T 2,24,20
T 4,25,16
T 6,25,20
T 8,26,16
T 10,26,20
T 12,27,16
W 14
T 14,27,20
W 14
T 16,28,16
W 14
T 18,28,20
s_xor_b32 m0, s65, 0x0
s_xor_b32 s66, s61, 0x80000
G 40,20,66,0
G 41,20,66,1
G 42,20,66,2
W 6
ZA 64,0,128
G 43,20,66,3
s_xor_b32 m0, s65, 0x4000
s_xor_b32 s66, s61, 0xc0000
ZA 68,0,132
G 40,20,66,0
G 41,20,66,1
T 20,29,16
T 22,29,20
ZA 72,4,128
G 42,20,66,2
G 43,20,66,3
s_xor_b32 m0, s65, 0x8000
ZA 76,4,132
s_xor_b32 s66, s61, 0x100000
G 40,20,66,0
T 24,30,16
T 26,30,20
W 6
ZA 80,8,128
G 41,20,66,1
G 42,20,66,2
ZA 84,8,132
G 43,20,66,3
T 28,31,16
T 30,31,20
ZA 88,12,128
s_waitcnt vmcnt(16)
s_barrier
T 32,24,32
ZA 92,12,132
T 34,24,36
s_xor_b32 m0, s65, 0xc000
s_xor_b32 s66, s61, 0x140000
W 6
ZA 96,16,128
G 40,20,66,0
ZA 100,16,132
T 36,25,32
T 38,25,36
ZA 104,20,128
G 41,20,66,1
ZA 108,20,132
T 40,26,32
T 42,26,36
W 6
ZA 112,24,128
G 42,20,66,2
ZA 116,24,132
T 44,27,32
T 46,27,36
ZA 120,28,128
G 43,20,66,3
ZA 124,28,132
T 48,28,32
T 50,28,36
W 6
MA 64,32,136
s_waitcnt vmcnt(16)
s_barrier
s_xor_b32 m0, s65, 0x10000
s_xor_b32 s66, s60, 0x200
G 36,8,66,0
MA 68,32,140
G 37,8,66,1
T 52,29,32
T 54,29,36
R v,160,12,48
MA 72,36,136
G 38,8,66,2
MA 76,36,140
T 56,30,32
T 58,30,36
R v,164,12,52
W 8
MA 80,40,136
G 39,8,66,3
MA 84,40,140
T 60,31,32
T 62,31,36
R v,168,13,48
MA 88,44,136
s_waitcnt vmcnt(16)
s_barrier
MA 92,44,140
R v,172,13,52
T 0,16,0
T 2,16,4
W 10
MA 96,48,136
R v,176,14,48
MA 100,48,140
T 4,17,0
T 6,17,4
MA 104,52,136
R v,180,14,52
MA 108,52,140
T 8,18,0
W 14
T 10,18,4
W 10
MA 112,56,136
R v,184,15,48
MA 116,56,140
T 12,19,0
T 14,19,4
MA 120,60,136
R v,188,15,52
MA 124,60,140
T 16,20,0
W 14
T 18,20,4
W 9
MA 64,0,144
T 20,21,0
MA 68,0,148
T 22,21,4
MA 72,4,144
T 24,22,0
MA 76,4,148
T 26,22,4
W 7
MA 80,8,144
T 28,23,0
MA 84,8,148
T 30,23,4
MA 88,12,144
s_waitcnt vmcnt(12) lgkmcnt(8)
s_barrier
s_xor_b32 m0, s65, 0x14000
s_xor_b32 s66, s61, 0x180000
MA 92,12,148
G 40,20,66,0
T 32,16,16
T 34,16,20
W 6
MA 96,16,144
G 41,20,66,1
MA 100,16,148
T 36,17,16
T 38,17,20
s_getpc_b64 s[88:89]
L_ct0_850:
s_and_b32 s89, s89, 0xffff
s_mov_b32 s90, L_code_end-L_ct0_850
s_mov_b32 s91, 0x20000
v_and_b32 v62, 0x70, v59
v_lshlrev_b32 v62, 3, v62
s_add_u32 s7, s1, 4096
buffer_load_dword v3, v62, s[88:91], s7 offen
MA 104,20,144
G 42,20,66,2
MA 108,20,148
T 40,18,16
T 42,18,20
W 6
MA 112,24,144
G 43,20,66,3
MA 116,24,148
T 44,19,16
T 46,19,20
MA 120,28,144
s_xor_b32 m0, s65, 0x18000
s_xor_b32 s66, s61, 0x1c0000
MA 124,28,148
G 40,20,66,0
T 48,20,16
T 50,20,20
W 6
MA 64,32,152
G 41,20,66,1
MA 68,32,156
T 52,21,16
T 54,21,20
MA 72,36,152
G 42,20,66,2
MA 76,36,156
T 56,22,16
T 58,22,20
W 6
MA 80,40,152
G 43,20,66,3
MA 84,40,156
T 60,23,16
T 62,23,20
MA 88,44,152
s_waitcnt vmcnt(17)
s_barrier
T 0,16,32
MA 92,44,156
T 2,16,36
s_xor_b32 m0, s65, 0x1c000
s_xor_b32 s66, s61, 0x200000
W 6
MA 96,48,152
G 40,20,66,0
MA 100,48,156
T 4,17,32
T 6,17,36
MA 104,52,152
T 8,18,32
MA 108,52,156
T 10,18,36
W 6
MA 112,56,152
G 41,20,66,1
MA 116,56,156
T 12,19,32
T 14,19,36
MA 120,60,152
T 16,20,32
MA 124,60,156
T 18,20,36
W 6
MA 64,0,160
G 42,20,66,2
MA 68,0,164
T 20,21,32
T 22,21,36
MA 72,4,160
T 24,22,32
MA 76,4,164
T 26,22,36
W 6
MA 80,8,160
G 43,20,66,3
MA 84,8,164
T 28,23,32
T 30,23,36
MA 88,12,160
s_waitcnt vmcnt(17)
s_barrier
T 32,16,48
MA 92,12,164
T 34,16,52
s_xor_b32 m0, s65, 0x0
s_xor_b32 s66, s61, 0x240000
W 6
MA 96,16,160
G 40,20,66,0
MA 100,16,164
T 36,17,48
T 38,17,52
MA 104,20,160
G 41,20,66,1
MA 108,20,164
T 40,18,48
T 42,18,52
W 6
MA 112,24,160
G 42,20,66,2
MA 116,24,164
T 44,19,48
T 46,19,52
MA 120,28,160
G 43,20,66,3
MA 124,28,164
T 48,20,48
T 50,20,52
W 6
MA 64,32,168
s_waitcnt vmcnt(17)
s_barrier
s_xor_b32 m0, s65, 0x4000
s_xor_b32 s66, s60, 0x300
G 36,8,66,0
MA 68,32,172
G 37,8,66,1
T 52,21,48
T 54,21,52
R v,192,12,0
MA 72,36,168
G 38,8,66,2
MA 76,36,172
T 56,22,48
T 58,22,52
R v,196,12,4
W 8
MA 80,40,168
G 39,8,66,3
MA 84,40,172
T 60,23,48
T 62,23,52
R v,200,13,0
MA 88,44,168
s_waitcnt vmcnt(16)
s_barrier
MA 92,44,172
R v,204,13,4
T 0,24,16
T 2,24,20
W 10
MA 96,48,168
R v,208,14,0
MA 100,48,172
T 4,25,16
T 6,25,20
MA 104,52,168
R v,212,14,4
MA 108,52,172
T 8,26,16
W 14
T 10,26,20
W 10
MA 112,56,168
R v,216,15,0
MA 116,56,172
T 12,27,16
T 14,27,20
MA 120,60,168
R v,220,15,4
MA 124,60,172
T 16,28,16
W 14
T 18,28,20
W 9
MA 64,0,176
T 20,29,16
MA 68,0,180
T 22,29,20
MA 72,4,176
T 24,30,16
MA 76,4,180
T 26,30,20
W 7
MA 80,8,176
T 28,31,16
MA 84,8,180
T 30,31,20
MA 88,12,176
s_waitcnt vmcnt(12) lgkmcnt(8)
s_barrier
s_xor_b32 m0, s65, 0x8000
s_xor_b32 s66, s61, 0x280000
MA 92,12,180
G 40,20,66,0
T 32,24,32
T 34,24,36
W 6
MA 96,16,176
G 41,20,66,1
MA 100,16,180
T 36,25,32
T 38,25,36
MA 104,20,176
G 42,20,66,2
MA 108,20,180
T 40,26,32
T 42,26,36
W 6
MA 112,24,176
G 43,20,66,3
MA 116,24,180
T 44,27,32
T 46,27,36
MA 120,28,176
s_xor_b32 m0, s65, 0xc000
s_xor_b32 s66, s61, 0x2c0000
MA 124,28,180
G 40,20,66,0
T 48,28,32
T 50,28,36
W 6
MA 64,32,184
G 41,20,66,1
MA 68,32,188
T 52,29,32
T 54,29,36
MA 72,36,184
G 42,20,66,2
MA 76,36,188
T 56,30,32
T 58,30,36
W 6
MA 80,40,184
G 43,20,66,3
MA 84,40,188
T 60,31,32
T 62,31,36
MA 88,44,184
s_waitcnt vmcnt(16)
s_barrier
T 0,24,48
MA 92,44,188
T 2,24,52
s_xor_b32 m0, s65, 0x10000
s_xor_b32 s66, s61, 0x300000
W 6
MA 96,48,184
G 40,20,66,0
MA 100,48,188
T 4,25,48
T 6,25,52
MA 104,52,184
T 8,26,48
MA 108,52,188
T 10,26,52
W 6
MA 112,56,184
G 41,20,66,1
MA 116,56,188
T 12,27,48
T 14,27,52
MA 120,60,184
T 16,28,48
MA 124,60,188
T 18,28,52
W 6
MA 64,0,192
G 42,20,66,2
MA 68,0,196
T 20,29,48
T 22,29,52
MA 72,4,192
T 24,30,48
MA 76,4,196
T 26,30,52
W 6
MA 80,8,192
G 43,20,66,3
MA 84,8,196
T 28,31,48
T 30,31,52
MA 88,12,192
s_waitcnt vmcnt(16)
s_barrier
T 32,16,0
MA 92,12,196
T 34,16,4
s_xor_b32 m0, s65, 0x14000
s_xor_b32 s66, s61, 0x340000
W 6
MA 96,16,192
G 40,20,66,0
MA 100,16,196
T 36,17,0
T 38,17,4
MA 104,20,192
G 41,20,66,1
MA 108,20,196
T 40,18,0
T 42,18,4
W 6
MA 112,24,192
G 42,20,66,2
MA 116,24,196
T 44,19,0
T 46,19,4
MA 120,28,192
G 43,20,66,3
MA 124,28,196
T 48,20,0
T 50,20,4
W 6
MA 64,32,200
s_waitcnt vmcnt(16)
s_barrier
s_xor_b32 m0, s65, 0x18000
s_xor_b32 s66, s61, 0x380000
G 40,20,66,0
MA 68,32,204
G 41,20,66,1
T 52,21,0
T 54,21,4
R v,224,8,16
MA 72,36,200
G 42,20,66,2
MA 76,36,204
T 56,22,0
T 58,22,4
R v,228,8,20
W 8
MA 80,40,200
G 43,20,66,3
MA 84,40,204
T 60,23,0
T 62,23,4
R v,232,9,16
MA 88,44,200
s_waitcnt vmcnt(16)
s_barrier
MA 92,44,204
R v,236,9,20
T 0,16,32
T 2,16,36
W 10
MA 96,48,200
R v,240,10,16
MA 100,48,204
T 4,17,32
T 6,17,36
MA 104,52,200
R v,244,10,20
MA 108,52,204
T 8,18,32
W 14
T 10,18,36
W 10
MA 112,56,200
R v,248,11,16
MA 116,56,204
T 12,19,32
T 14,19,36
MA 120,60,200
R v,252,11,20
T 16,20,32
MA 124,60,204
W 14
T 18,20,36
v_xor_b32 v8, s69, v8
W 9
MA 64,0,208
T 20,21,32
MA 68,0,212
T 22,21,36
v_xor_b32 v9, s69, v9
MA 72,4,208
T 24,22,32
MA 76,4,212
T 26,22,36
v_xor_b32 v10, s69, v10
W 7
MA 80,8,208
T 28,23,32
MA 84,8,212
T 30,23,36
v_xor_b32 v11, s69, v11
MA 88,12,208
s_waitcnt vmcnt(12) lgkmcnt(8)
s_barrier
s_xor_b32 m0, s65, 0x1c000
s_xor_b32 s66, s61, 0x3c0000
MA 92,12,212
G 40,20,66,0
T 32,16,48
T 34,16,52
v_xor_b32 v12, s69, v12
W 6
MA 96,16,208
G 41,20,66,1
MA 100,16,212
T 36,17,48
T 38,17,52
v_xor_b32 v13, s69, v13
MA 104,20,208
G 42,20,66,2
MA 108,20,212
T 40,18,48
T 42,18,52
v_xor_b32 v14, s69, v14
W 6
MA 112,24,208
G 43,20,66,3
MA 116,24,212
T 44,19,48
T 46,19,52
v_xor_b32 v15, s69, v15
MA 120,28,208
s_xor_b32 m0, s65, 0x0
s_xor_b32 s66, s61, 0x200
MA 124,28,212
G 40,20,66,0
T 48,20,48
T 50,20,52
W 6
MA 64,32,216
G 41,20,66,1
MA 68,32,220
T 52,21,48
T 54,21,52
MA 72,36,216
G 42,20,66,2
MA 76,36,220
T 56,22,48
T 58,22,52
W 6
MA 80,40,216
G 43,20,66,3
MA 84,40,220
T 60,23,48
T 62,23,52
MA 88,44,216
s_waitcnt vmcnt(16)
s_barrier
T 0,24,0
MA 92,44,220
T 2,24,4
s_xor_b32 m0, s65, 0x4000
s_xor_b32 s66, s61, 0x40200
W 6
MA 96,48,216
G 40,20,66,0
MA 100,48,220
T 4,25,0
T 6,25,4
MA 104,52,216
T 8,26,0
MA 108,52,220
T 10,26,4
W 6
MA 112,56,216
G 41,20,66,1
MA 116,56,220
T 12,27,0
T 14,27,4
MA 120,60,216
T 16,28,0
MA 124,60,220
T 18,28,4
W 6
MA 64,0,224
G 42,20,66,2
MA 68,0,228
T 20,29,0
T 22,29,4
MA 72,4,224
T 24,30,0
MA 76,4,228
T 26,30,4
W 6
MA 80,8,224
G 43,20,66,3
MA 84,8,228
T 28,31,0
T 30,31,4
MA 88,12,224
s_waitcnt vmcnt(16)
s_barrier
T 32,24,16
MA 92,12,228
T 34,24,20
s_xor_b32 m0, s65, 0x8000
s_xor_b32 s66, s61, 0x80200
W 6
MA 96,16,224
G 40,20,66,0
MA 100,16,228
T 36,25,16
T 38,25,20
MA 104,20,224
T 40,26,16
MA 108,20,228
T 42,26,20
W 6
MA 112,24,224
G 41,20,66,1
MA 116,24,228
T 44,27,16
T 46,27,20
MA 120,28,224
T 48,28,16
MA 124,28,228
T 50,28,20
W 6
MA 64,32,232
G 42,20,66,2
MA 68,32,236
T 52,29,16
T 54,29,20
MA 72,36,232
T 56,30,16
MA 76,36,236
T 58,30,20
W 6
MA 80,40,232
G 43,20,66,3
MA 84,40,236
T 60,31,16
T 62,31,20
MA 88,44,232
s_waitcnt vmcnt(16)
s_barrier
T 0,24,32
MA 92,44,236
T 2,24,36
s_xor_b32 m0, s65, 0xc000
s_xor_b32 s66, s61, 0xc0200
W 6
MA 96,48,232
G 40,20,66,0
MA 100,48,236
T 4,25,32
T 6,25,36
MA 104,52,232
T 8,26,32
MA 108,52,236
T 10,26,36
W 6
MA 112,56,232
G 41,20,66,1
MA 116,56,236
T 12,27,32
T 14,27,36
MA 120,60,232
T 16,28,32
MA 124,60,236
T 18,28,36
W 6
MA 64,0,240
G 42,20,66,2
MA 68,0,244
T 20,29,32
T 22,29,36
MA 72,4,240
T 24,30,32
MA 76,4,244
T 26,30,36
W 6
MA 80,8,240
G 43,20,66,3
MA 84,8,244
T 28,31,32
T 30,31,36
MA 88,12,240
s_waitcnt vmcnt(16)
s_barrier
T 32,24,48
MA 92,12,244
T 34,24,52
s_xor_b32 m0, s65, 0x10000
s_xor_b32 s66, s61, 0x100200
W 6
MA 96,16,240
G 40,20,66,0
MA 100,16,244
T 36,25,48
T 38,25,52
MA 104,20,240
T 40,26,48
MA 108,20,244
T 42,26,52
W 6
MA 112,24,240
G 41,20,66,1
MA 116,24,244
T 44,27,48
T 46,27,52
MA 120,28,240
T 48,28,48
MA 124,28,244
T 50,28,52
W 6
MA 64,32,248
G 42,20,66,2
MA 68,32,252
T 52,29,48
T 54,29,52
MA 72,36,248
T 56,30,48
MA 76,36,252
T 58,30,52
W 6
MA 80,40,248
G 43,20,66,3
MA 84,40,252
T 60,31,48
T 62,31,52
MA 88,44,248
s_waitcnt vmcnt(16)
s_barrier
T 0,16,0
MA 92,44,252
T 2,16,4
s_xor_b32 m0, s65, 0x14000
s_xor_b32 s66, s61, 0x140200
W 6
MA 96,48,248
G 40,20,66,0
MA 100,48,252
T 4,17,0
T 6,17,4
MA 104,52,248
T 8,18,0
MA 108,52,252
T 10,18,4
W 6
MA 112,56,248
G 41,20,66,1
MA 116,56,252
T 12,19,0
T 14,19,4
MA 120,60,248
T 16,20,0
MA 124,60,252
T 18,20,4
v_pk_mul_f32 v[64:65], v[64:65], s[74:75]
v_pk_mul_f32 v[66:67], v[66:67], s[74:75]
v_pk_mul_f32 v[68:69], v[68:69], s[74:75]
v_pk_mul_f32 v[70:71], v[70:71], s[74:75]
v_pk_mul_f32 v[72:73], v[72:73], s[74:75]
v_pk_mul_f32 v[74:75], v[74:75], s[74:75]
v_pk_mul_f32 v[76:77], v[76:77], s[74:75]
v_pk_mul_f32 v[78:79], v[78:79], s[74:75]
CV 64,64
CV 66,66
CV 68,68
CV 70,70
CV 72,72
CV 74,74
CV 76,76
CV 78,78
v_permlane32_swap_b32 v64, v72
v_permlane32_swap_b32 v66, v74
v_permlane32_swap_b32 v68, v76
v_permlane32_swap_b32 v70, v78
v_permlane16_swap_b32 v64, v72
v_permlane16_swap_b32 v66, v74
v_permlane16_swap_b32 v68, v76
v_permlane16_swap_b32 v70, v78
AW 192,64
AW 193,66
AW 194,72
AW 195,74
AW 196,68
AW 197,70
AW 198,76
AW 199,78
v_pk_mul_f32 v[80:81], v[80:81], s[74:75]
v_pk_mul_f32 v[82:83], v[82:83], s[74:75]
v_pk_mul_f32 v[84:85], v[84:85], s[74:75]
v_pk_mul_f32 v[86:87], v[86:87], s[74:75]
v_pk_mul_f32 v[88:89], v[88:89], s[74:75]
v_pk_mul_f32 v[90:91], v[90:91], s[74:75]
v_pk_mul_f32 v[92:93], v[92:93], s[74:75]
v_pk_mul_f32 v[94:95], v[94:95], s[74:75]
CV 80,80
CV 82,82
CV 84,84
CV 86,86
CV 88,88
CV 90,90
CV 92,92
CV 94,94
v_permlane32_swap_b32 v80, v88
v_permlane32_swap_b32 v82, v90
v_permlane32_swap_b32 v84, v92
v_permlane32_swap_b32 v86, v94
v_permlane16_swap_b32 v80, v88
v_permlane16_swap_b32 v82, v90
v_permlane16_swap_b32 v84, v92
v_permlane16_swap_b32 v86, v94
AW 200,80
AW 201,82
AW 202,88
AW 203,90
AW 204,84
AW 205,86
AW 206,92
AW 207,94
v_pk_mul_f32 v[96:97], v[96:97], s[74:75]
v_pk_mul_f32 v[98:99], v[98:99], s[74:75]
v_pk_mul_f32 v[100:101], v[100:101], s[74:75]
v_pk_mul_f32 v[102:103], v[102:103], s[74:75]
v_pk_mul_f32 v[104:105], v[104:105], s[74:75]
v_pk_mul_f32 v[106:107], v[106:107], s[74:75]
v_pk_mul_f32 v[108:109], v[108:109], s[74:75]
v_pk_mul_f32 v[110:111], v[110:111], s[74:75]
CV 96,96
CV 98,98
CV 100,100
CV 102,102
CV 104,104
CV 106,106
CV 108,108
CV 110,110
v_permlane32_swap_b32 v96, v104
v_permlane32_swap_b32 v98, v106
v_permlane32_swap_b32 v100, v108
v_permlane32_swap_b32 v102, v110
v_permlane16_swap_b32 v96, v104
v_permlane16_swap_b32 v98, v106
v_permlane16_swap_b32 v100, v108
v_permlane16_swap_b32 v102, v110
AW 208,96
AW 209,98
AW 210,104
AW 211,106
AW 212,100
AW 213,102
AW 214,108
AW 215,110
v_pk_mul_f32 v[112:113], v[112:113], s[74:75]
v_pk_mul_f32 v[114:115], v[114:115], s[74:75]
v_pk_mul_f32 v[116:117], v[116:117], s[74:75]
v_pk_mul_f32 v[118:119], v[118:119], s[74:75]
v_pk_mul_f32 v[120:121], v[120:121], s[74:75]
v_pk_mul_f32 v[122:123], v[122:123], s[74:75]
v_pk_mul_f32 v[124:125], v[124:125], s[74:75]
v_pk_mul_f32 v[126:127], v[126:127], s[74:75]
CV 112,112
CV 114,114
CV 116,116
CV 118,118
CV 120,120
CV 122,122
CV 124,124
CV 126,126
v_permlane32_swap_b32 v112, v120
v_permlane32_swap_b32 v114, v122
v_permlane32_swap_b32 v116, v124
v_permlane32_swap_b32 v118, v126
v_permlane16_swap_b32 v112, v120
v_permlane16_swap_b32 v114, v122
v_permlane16_swap_b32 v116, v124
v_permlane16_swap_b32 v118, v126
AW 216,112
AW 217,114
AW 218,120
AW 219,122
AW 220,116
AW 221,118
AW 222,124
AW 223,126
W 6
ZA 64,0,128
G 42,20,66,2
ZA 68,0,132
T 20,21,0
T 22,21,4
ZA 72,4,128
T 24,22,0
ZA 76,4,132
T 26,22,4
W 6
ZA 80,8,128
G 43,20,66,3
ZA 84,8,132
T 28,23,0
T 30,23,4
ZA 88,12,128
s_waitcnt vmcnt(16)
s_barrier
T 32,16,16
ZA 92,12,132
T 34,16,20
s_xor_b32 m0, s65, 0x18000
s_xor_b32 s66, s61, 0x180200
W 6
ZA 96,16,128
G 40,20,66,0
ZA 100,16,132
T 36,17,16
T 38,17,20
ZA 104,20,128
T 40,18,16
ZA 108,20,132
T 42,18,20
W 6
ZA 112,24,128
G 41,20,66,1
ZA 116,24,132
T 44,19,16
T 46,19,20
ZA 120,28,128
T 48,20,16
ZA 124,28,132
T 50,20,20
W 6
MA 64,32,136
G 42,20,66,2
MA 68,32,140
T 52,21,16
T 54,21,20
MA 72,36,136
T 56,22,16
MA 76,36,140
T 58,22,20
W 6
MA 80,40,136
G 43,20,66,3
MA 84,40,140
T 60,23,16
T 62,23,20
MA 88,44,136
s_waitcnt vmcnt(16)
s_barrier
T 0,16,32
MA 92,44,140
T 2,16,36
s_xor_b32 m0, s65, 0x1c000
s_xor_b32 s66, s61, 0x1c0200
W 6
MA 96,48,136
G 40,20,66,0
MA 100,48,140
T 4,17,32
T 6,17,36
MA 104,52,136
T 8,18,32
MA 108,52,140
T 10,18,36
W 6
MA 112,56,136
G 41,20,66,1
MA 116,56,140
T 12,19,32
T 14,19,36
MA 120,60,136
T 16,20,32
MA 124,60,140
T 18,20,36
W 6
MA 64,0,144
G 42,20,66,2
MA 68,0,148
T 20,21,32
T 22,21,36
MA 72,4,144
T 24,22,32
MA 76,4,148
T 26,22,36
W 6
MA 80,8,144
G 43,20,66,3
MA 84,8,148
T 28,23,32
T 30,23,36
MA 88,12,144
s_waitcnt vmcnt(16)
s_barrier
T 32,16,48
MA 92,12,148
T 34,16,52
s_xor_b32 m0, s65, 0x0
s_xor_b32 s66, s61, 0x200200
W 6
MA 96,16,144
G 40,20,66,0
MA 100,16,148
T 36,17,48
T 38,17,52
s_getpc_b64 s[88:89]
L_ct0_978:
s_and_b32 s89, s89, 0xffff
s_mov_b32 s90, L_code_end-L_ct0_978
s_mov_b32 s91, 0x20000
v_and_b32 v62, 0x70, v59
v_lshlrev_b32 v62, 3, v62
s_add_u32 s7, s1, 4096
buffer_load_dword v3, v62, s[88:91], s7 offen
MA 104,20,144
T 40,18,48
MA 108,20,148
T 42,18,52
W 6
MA 112,24,144
G 41,20,66,1
MA 116,24,148
T 44,19,48
T 46,19,52
MA 120,28,144
T 48,20,48
MA 124,28,148
T 50,20,52
W 6
MA 64,32,152
G 42,20,66,2
MA 68,32,156
T 52,21,48
T 54,21,52
MA 72,36,152
T 56,22,48
MA 76,36,156
T 58,22,52
W 6
MA 80,40,152
G 43,20,66,3
MA 84,40,156
T 60,23,48
T 62,23,52
MA 88,44,152
s_waitcnt vmcnt(17)
s_barrier
T 0,24,0
MA 92,44,156
T 2,24,4
s_xor_b32 m0, s65, 0x4000
s_xor_b32 s66, s61, 0x240200
W 6
MA 96,48,152
G 40,20,66,0
MA 100,48,156
T 4,25,0
T 6,25,4
MA 104,52,152
T 8,26,0
MA 108,52,156
T 10,26,4
W 6
MA 112,56,152
G 41,20,66,1
MA 116,56,156
T 12,27,0
T 14,27,4
MA 120,60,152
T 16,28,0
MA 124,60,156
T 18,28,4
W 6
MA 64,0,160
G 42,20,66,2
MA 68,0,164
T 20,29,0
T 22,29,4
MA 72,4,160
T 24,30,0
MA 76,4,164
T 26,30,4
W 6
MA 80,8,160
G 43,20,66,3
MA 84,8,164
T 28,31,0
T 30,31,4
MA 88,12,160
s_waitcnt vmcnt(17)
s_barrier
T 32,24,16
MA 92,12,164
T 34,24,20
s_xor_b32 m0, s65, 0x8000
s_xor_b32 s66, s61, 0x280200
W 6
MA 96,16,160
G 40,20,66,0
MA 100,16,164
T 36,25,16
T 38,25,20
MA 104,20,160
T 40,26,16
MA 108,20,164
T 42,26,20
W 6
MA 112,24,160
G 41,20,66,1
MA 116,24,164
T 44,27,16
T 46,27,20
MA 120,28,160
T 48,28,16
MA 124,28,164
T 50,28,20
W 6
MA 64,32,168
G 42,20,66,2
MA 68,32,172
T 52,29,16
T 54,29,20
MA 72,36,168
T 56,30,16
MA 76,36,172
T 58,30,20
W 6
MA 80,40,168
G 43,20,66,3
MA 84,40,172
T 60,31,16
T 62,31,20
MA 88,44,168
s_waitcnt vmcnt(17)
s_barrier
T 0,24,32
MA 92,44,172
T 2,24,36
s_xor_b32 m0, s65, 0xc000
s_xor_b32 s66, s61, 0x2c0200
W 6
MA 96,48,168
G 40,20,66,0
MA 100,48,172
T 4,25,32
T 6,25,36
MA 104,52,168
T 8,26,32
MA 108,52,172
T 10,26,36
W 6
MA 112,56,168
G 41,20,66,1
MA 116,56,172
T 12,27,32
T 14,27,36
MA 120,60,168
T 16,28,32
MA 124,60,172
T 18,28,36
W 6
MA 64,0,176
G 42,20,66,2
MA 68,0,180
T 20,29,32
T 22,29,36
MA 72,4,176
T 24,30,32
MA 76,4,180
T 26,30,36
W 6
MA 80,8,176
G 43,20,66,3
MA 84,8,180
T 28,31,32
T 30,31,36
MA 88,12,176
s_waitcnt vmcnt(17)
s_barrier
T 32,24,48
MA 92,12,180
T 34,24,52
s_xor_b32 m0, s65, 0x10000
s_xor_b32 s66, s61, 0x300200
W 6
MA 96,16,176
G 40,20,66,0
MA 100,16,180
T 36,25,48
T 38,25,52
MA 104,20,176
T 40,26,48
MA 108,20,180
T 42,26,52
W 6
MA 112,24,176
G 41,20,66,1
MA 116,24,180
T 44,27,48
T 46,27,52
MA 120,28,176
T 48,28,48
MA 124,28,180
T 50,28,52
W 6
MA 64,32,184
G 42,20,66,2
MA 68,32,188
T 52,29,48
T 54,29,52
MA 72,36,184
T 56,30,48
MA 76,36,188
T 58,30,52
W 6
MA 80,40,184
G 43,20,66,3
MA 84,40,188
T 60,31,48
T 62,31,52
MA 88,44,184
s_waitcnt vmcnt(16)
s_barrier
T 0,16,0
MA 92,44,188
T 2,16,4
s_xor_b32 m0, s65, 0x14000
s_xor_b32 s66, s61, 0x340200
W 6
MA 96,48,184
G 40,20,66,0
MA 100,48,188
T 4,17,0
T 6,17,4
MA 104,52,184
T 8,18,0
MA 108,52,188
T 10,18,4
W 6
MA 112,56,184
G 41,20,66,1
MA 116,56,188
T 12,19,0
T 14,19,4
MA 120,60,184
T 16,20,0
MA 124,60,188
T 18,20,4
W 6
MA 64,0,192
G 42,20,66,2
MA 68,0,196
T 20,21,0
T 22,21,4
MA 72,4,192
T 24,22,0
MA 76,4,196
T 26,22,4
W 6
MA 80,8,192
G 43,20,66,3
MA 84,8,196
T 28,23,0
T 30,23,4
MA 88,12,192
s_waitcnt vmcnt(16)
s_barrier
T 32,16,16
MA 92,12,196
T 34,16,20
s_xor_b32 m0, s65, 0x18000
s_xor_b32 s66, s61, 0x380200
W 6
MA 96,16,192
G 40,20,66,0
MA 100,16,196
T 36,17,16
T 38,17,20
MA 104,20,192
T 40,18,16
MA 108,20,196
T 42,18,20
W 6
MA 112,24,192
G 41,20,66,1
MA 116,24,196
T 44,19,16
T 46,19,20
MA 120,28,192
T 48,20,16
MA 124,28,196
T 50,20,20
W 6
MA 64,32,200
G 42,20,66,2
MA 68,32,204
T 52,21,16
T 54,21,20
MA 72,36,200
T 56,22,16
MA 76,36,204
T 58,22,20
W 6
MA 80,40,200
G 43,20,66,3
MA 84,40,204
T 60,23,16
T 62,23,20
MA 88,44,200
s_waitcnt vmcnt(16)
s_barrier
T 0,16,32
MA 92,44,204
T 2,16,36
s_xor_b32 m0, s65, 0x1c000
s_xor_b32 s66, s61, 0x3c0200
W 6
MA 96,48,200
G 40,20,66,0
MA 100,48,204
T 4,17,32
T 6,17,36
MA 104,52,200
T 8,18,32
MA 108,52,204
T 10,18,36
W 6
MA 112,56,200
G 41,20,66,1
MA 116,56,204
T 12,19,32
T 14,19,36
MA 120,60,200
T 16,20,32
MA 124,60,204
T 18,20,36
W 6
MA 64,0,208
G 42,20,66,2
MA 68,0,212
T 20,21,32
T 22,21,36
MA 72,4,208
T 24,22,32
MA 76,4,212
T 26,22,36
W 6
MA 80,8,208
G 43,20,66,3
MA 84,8,212
T 28,23,32
T 30,23,36
MA 88,12,208
s_waitcnt vmcnt(16)
s_barrier
T 32,16,48
MA 92,12,212
T 34,16,52
s_xor_b32 m0, s65, 0x0
s_xor_b32 s66, s62, 0x0
W 6
MA 96,16,208
G 44,44,66,0
MA 100,16,212
T 36,17,48
T 38,17,52
MA 104,20,208
T 40,18,48
MA 108,20,212
T 42,18,52
W 6
MA 112,24,208
G 45,44,66,1
MA 116,24,212
T 44,19,48
T 46,19,52
MA 120,28,208
T 48,20,48
MA 124,28,212
T 50,20,52
W 6
MA 64,32,216
G 46,44,66,2
MA 68,32,220
T 52,21,48
T 54,21,52
MA 72,36,216
T 56,22,48
MA 76,36,220
T 58,22,52
W 6
MA 80,40,216
G 47,44,66,3
MA 84,40,220
T 60,23,48
T 62,23,52
MA 88,44,216
s_waitcnt vmcnt(16)
s_barrier
T 0,24,0
MA 92,44,220
T 2,24,4
s_xor_b32 m0, s65, 0x4000
s_xor_b32 s66, s62, 0x8000
W 6
MA 96,48,216
G 44,44,66,0
MA 100,48,220
T 4,25,0
T 6,25,4
MA 104,52,216
T 8,26,0
MA 108,52,220
T 10,26,4
W 6
MA 112,56,216
G 45,44,66,1
MA 116,56,220
T 12,27,0
T 14,27,4
MA 120,60,216
T 16,28,0
MA 124,60,220
T 18,28,4
W 6
MA 64,0,224
G 46,44,66,2
MA 68,0,228
T 20,29,0
T 22,29,4
MA 72,4,224
T 24,30,0
MA 76,4,228
T 26,30,4
W 6
MA 80,8,224
G 47,44,66,3
MA 84,8,228
T 28,31,0
T 30,31,4
MA 88,12,224
s_waitcnt vmcnt(16)
s_barrier
T 32,24,16
MA 92,12,228
T 34,24,20
s_xor_b32 m0, s65, 0x8000
s_xor_b32 s66, s62, 0x10000
W 6
MA 96,16,224
G 44,44,66,0
MA 100,16,228
T 36,25,16
T 38,25,20
MA 104,20,224
T 40,26,16
MA 108,20,228
T 42,26,20
W 6
MA 112,24,224
G 45,44,66,1
MA 116,24,228
T 44,27,16
T 46,27,20
MA 120,28,224
T 48,28,16
MA 124,28,228
T 50,28,20
W 6
MA 64,32,232
G 46,44,66,2
MA 68,32,236
T 52,29,16
T 54,29,20
MA 72,36,232
T 56,30,16
MA 76,36,236
T 58,30,20
W 6
MA 80,40,232
G 47,44,66,3
MA 84,40,236
T 60,31,16
T 62,31,20
MA 88,44,232
s_waitcnt vmcnt(16)
s_barrier
T 0,24,32
MA 92,44,236
T 2,24,36
s_xor_b32 m0, s65, 0xc000
s_xor_b32 s66, s62, 0x18000
W 6
MA 96,48,232
G 44,44,66,0
MA 100,48,236
T 4,25,32
T 6,25,36
MA 104,52,232
T 8,26,32
MA 108,52,236
T 10,26,36
W 6
MA 112,56,232
G 45,44,66,1
MA 116,56,236
T 12,27,32
T 14,27,36
MA 120,60,232
T 16,28,32
MA 124,60,236
T 18,28,36
W 6
MA 64,0,240
G 46,44,66,2
MA 68,0,244
T 20,29,32
T 22,29,36
MA 72,4,240
T 24,30,32
MA 76,4,244
T 26,30,36
W 6
MA 80,8,240
G 47,44,66,3
MA 84,8,244
T 28,31,32
T 30,31,36
MA 88,12,240
s_waitcnt vmcnt(16)
s_barrier
T 32,24,48
MA 92,12,244
T 34,24,52
s_xor_b32 m0, s65, 0x10000
s_xor_b32 s66, s62, 0x20000
W 6
MA 96,16,240
G 44,44,66,0
MA 100,16,244
T 36,25,48
T 38,25,52
MA 104,20,240
T 40,26,48
MA 108,20,244
T 42,26,52
W 6
MA 112,24,240
G 45,44,66,1
MA 116,24,244
T 44,27,48
T 46,27,52
MA 120,28,240
T 48,28,48
MA 124,28,244
T 50,28,52
W 6
MA 64,32,248
G 46,44,66,2
MA 68,32,252
T 52,29,48
T 54,29,52
MA 72,36,248
T 56,30,48
MA 76,36,252
T 58,30,52
W 6
MA 80,40,248
G 47,44,66,3
MA 84,40,252
T 60,31,48
T 62,31,52
MA 88,44,248
s_waitcnt vmcnt(16)
s_barrier
T 0,16,0
MA 92,44,252
T 2,16,4
s_xor_b32 m0, s65, 0x14000
s_xor_b32 s66, s62, 0x28000
W 6
MA 96,48,248
G 44,44,66,0
MA 100,48,252
T 4,17,0
T 6,17,4
MA 104,52,248
T 8,18,0
MA 108,52,252
T 10,18,4
W 6
MA 112,56,248
G 45,44,66,1
MA 116,56,252
T 12,19,0
T 14,19,4
MA 120,60,248
T 16,20,0
MA 124,60,252
T 18,20,4
v_pk_mul_f32 v[64:65], v[64:65], s[74:75]
v_pk_mul_f32 v[66:67], v[66:67], s[74:75]
v_pk_mul_f32 v[68:69], v[68:69], s[74:75]
v_pk_mul_f32 v[70:71], v[70:71], s[74:75]
v_pk_mul_f32 v[72:73], v[72:73], s[74:75]
v_pk_mul_f32 v[74:75], v[74:75], s[74:75]
v_pk_mul_f32 v[76:77], v[76:77], s[74:75]
v_pk_mul_f32 v[78:79], v[78:79], s[74:75]
CV 64,64
CV 66,66
CV 68,68
CV 70,70
CV 72,72
CV 74,74
CV 76,76
CV 78,78
v_permlane32_swap_b32 v64, v72
v_permlane32_swap_b32 v66, v74
v_permlane32_swap_b32 v68, v76
v_permlane32_swap_b32 v70, v78
v_permlane16_swap_b32 v64, v72
v_permlane16_swap_b32 v66, v74
v_permlane16_swap_b32 v68, v76
v_permlane16_swap_b32 v70, v78
AW 224,64
AW 225,66
AW 226,72
AW 227,74
AW 228,68
AW 229,70
AW 230,76
AW 231,78
v_pk_mul_f32 v[80:81], v[80:81], s[74:75]
v_pk_mul_f32 v[82:83], v[82:83], s[74:75]
v_pk_mul_f32 v[84:85], v[84:85], s[74:75]
v_pk_mul_f32 v[86:87], v[86:87], s[74:75]
v_pk_mul_f32 v[88:89], v[88:89], s[74:75]
v_pk_mul_f32 v[90:91], v[90:91], s[74:75]
v_pk_mul_f32 v[92:93], v[92:93], s[74:75]
v_pk_mul_f32 v[94:95], v[94:95], s[74:75]
CV 80,80
CV 82,82
CV 84,84
CV 86,86
CV 88,88
CV 90,90
CV 92,92
CV 94,94
v_permlane32_swap_b32 v80, v88
v_permlane32_swap_b32 v82, v90
v_permlane32_swap_b32 v84, v92
v_permlane32_swap_b32 v86, v94
v_permlane16_swap_b32 v80, v88
v_permlane16_swap_b32 v82, v90
v_permlane16_swap_b32 v84, v92
v_permlane16_swap_b32 v86, v94
AW 232,80
AW 233,82
AW 234,88
AW 235,90
AW 236,84
AW 237,86
AW 238,92
AW 239,94
v_pk_mul_f32 v[96:97], v[96:97], s[74:75]
v_pk_mul_f32 v[98:99], v[98:99], s[74:75]
v_pk_mul_f32 v[100:101], v[100:101], s[74:75]
v_pk_mul_f32 v[102:103], v[102:103], s[74:75]
v_pk_mul_f32 v[104:105], v[104:105], s[74:75]
v_pk_mul_f32 v[106:107], v[106:107], s[74:75]
v_pk_mul_f32 v[108:109], v[108:109], s[74:75]
v_pk_mul_f32 v[110:111], v[110:111], s[74:75]
CV 96,96
CV 98,98
CV 100,100
CV 102,102
CV 104,104
CV 106,106
CV 108,108
CV 110,110
v_permlane32_swap_b32 v96, v104
v_permlane32_swap_b32 v98, v106
v_permlane32_swap_b32 v100, v108
v_permlane32_swap_b32 v102, v110
v_permlane16_swap_b32 v96, v104
v_permlane16_swap_b32 v98, v106
v_permlane16_swap_b32 v100, v108
v_permlane16_swap_b32 v102, v110
AW 240,96
AW 241,98
AW 242,104
AW 243,106
AW 244,100
AW 245,102
AW 246,108
AW 247,110
v_pk_mul_f32 v[112:113], v[112:113], s[74:75]
v_pk_mul_f32 v[114:115], v[114:115], s[74:75]
v_pk_mul_f32 v[116:117], v[116:117], s[74:75]
v_pk_mul_f32 v[118:119], v[118:119], s[74:75]
v_pk_mul_f32 v[120:121], v[120:121], s[74:75]
v_pk_mul_f32 v[122:123], v[122:123], s[74:75]
v_pk_mul_f32 v[124:125], v[124:125], s[74:75]
v_pk_mul_f32 v[126:127], v[126:127], s[74:75]
CV 112,112
CV 114,114
CV 116,116
CV 118,118
CV 120,120
CV 122,122
CV 124,124
CV 126,126
v_permlane32_swap_b32 v112, v120
v_permlane32_swap_b32 v114, v122
v_permlane32_swap_b32 v116, v124
v_permlane32_swap_b32 v118, v126
v_permlane16_swap_b32 v112, v120
v_permlane16_swap_b32 v114, v122
v_permlane16_swap_b32 v116, v124
v_permlane16_swap_b32 v118, v126
AW 248,112
AW 249,114
AW 250,120
AW 251,122
AW 252,116
AW 253,118
AW 254,124
AW 255,126
W 6
ZB 128,0,64
G 46,44,66,2
ZB 132,0,68
T 20,21,0
T 22,21,4
ds_write_b128 v58, a[64:67] offset:0
ZB 136,4,64
T 24,22,0
ZB 140,4,68
T 26,22,4
ds_write_b128 v58, a[68:71] offset:1024
W 8
ZB 144,8,64
G 47,44,66,3
ZB 148,8,68
T 28,23,0
T 30,23,4
ds_write_b128 v58, a[72:75] offset:2048
ZB 152,12,64
s_waitcnt vmcnt(16) lgkmcnt(0)
s_barrier
T 32,16,16
ZB 156,12,68
T 34,16,20
ds_write_b128 v58, a[76:79] offset:3072
s_xor_b32 m0, s65, 0x18000
s_xor_b32 s66, s62, 0x30000
ZB 160,16,64
G 44,44,66,0
ZB 164,16,68
T 36,17,16
T 38,17,20
ds_write_b128 v58, a[80:83] offset:4096
ZB 168,20,64
T 40,18,16
ZB 172,20,68
T 42,18,20
ds_write_b128 v58, a[84:87] offset:5120
ZB 176,24,64
G 45,44,66,1
ZB 180,24,68
T 44,19,16
T 46,19,20
ds_write_b128 v58, a[88:91] offset:6144
ZB 184,28,64
T 48,20,16
ZB 188,28,68
T 50,20,20
ds_write_b128 v58, a[92:95] offset:7168
W 10
MB 128,32,72
G 46,44,66,2
MB 132,32,76
T 52,21,16
T 54,21,20
MB 136,36,72
T 56,22,16
MB 140,36,76
T 58,22,20
W 8
MB 144,40,72
G 47,44,66,3
MB 148,40,76
T 60,23,16
T 62,23,20
MB 152,44,72
s_waitcnt vmcnt(16) lgkmcnt(6)
s_barrier
T 0,16,32
MB 156,44,76
T 2,16,36
R a,96,2,0
s_xor_b32 m0, s65, 0x1c000
s_xor_b32 s66, s62, 0x38000
MB 160,48,72
G 44,44,66,0
MB 164,48,76
T 4,17,32
T 6,17,36
R a,100,2,1
W 10
MB 168,52,72
T 8,18,32
MB 172,52,76
T 10,18,36
R a,104,2,2
W 9
MB 176,56,72
G 45,44,66,1
MB 180,56,76
T 12,19,32
T 14,19,36
R a,108,2,3
MB 184,60,72
T 16,20,32
MB 188,60,76
T 18,20,36
R a,112,2,4
W 10
MB 128,0,80
G 46,44,66,2
MB 132,0,84
T 20,21,32
T 22,21,36
R a,116,2,5
MB 136,4,80
T 24,22,32
MB 140,4,84
T 26,22,36
W 14
R a,120,2,6
W 10
MB 144,8,80
G 47,44,66,3
MB 148,8,84
T 28,23,32
T 30,23,36
R a,124,2,7
MB 152,12,80
s_waitcnt vmcnt(16)
s_barrier
T 32,16,48
MB 156,12,84
T 34,16,52
s_xor_b32 m0, s65, 0x0
s_xor_b32 s66, s62, 0x100
W 9
MB 160,16,80
G 44,44,66,0
MB 164,16,84
T 36,17,48
T 38,17,52
s_getpc_b64 s[88:89]
L_ct0_1106:
s_and_b32 s89, s89, 0xffff
s_mov_b32 s90, L_code_end-L_ct0_1106
s_mov_b32 s91, 0x20000
v_and_b32 v62, 0x70, v59
v_lshlrev_b32 v62, 3, v62
s_add_u32 s7, s1, 4096
buffer_load_dword v3, v62, s[88:91], s7 offen
MB 168,20,80
T 40,18,48
MB 172,20,84
T 42,18,52
W 7
MB 176,24,80
G 45,44,66,1
MB 180,24,84
T 44,19,48
T 46,19,52
MB 184,28,80
T 48,20,48
MB 188,28,84
T 50,20,52
W 6
MB 128,32,88
G 46,44,66,2
MB 132,32,92
T 52,21,48
T 54,21,52
MB 136,36,88
T 56,22,48
MB 140,36,92
T 58,22,52
W 6
MB 144,40,88
G 47,44,66,3
MB 148,40,92
T 60,23,48
T 62,23,52
MB 152,44,88
s_waitcnt vmcnt(17)
s_barrier
T 0,24,0
MB 156,44,92
T 2,24,4
s_xor_b32 m0, s65, 0x4000
s_xor_b32 s66, s62, 0x8100
W 6
MB 160,48,88
G 44,44,66,0
MB 164,48,92
T 4,25,0
T 6,25,4
MB 168,52,88
T 8,26,0
MB 172,52,92
T 10,26,4
W 6
MB 176,56,88
G 45,44,66,1
MB 180,56,92
T 12,27,0
T 14,27,4
MB 184,60,88
T 16,28,0
MB 188,60,92
T 18,28,4
W 6
MB 128,0,96
G 46,44,66,2
MB 132,0,100
T 20,29,0
T 22,29,4
MB 136,4,96
T 24,30,0
MB 140,4,100
T 26,30,4
W 6
MB 144,8,96
G 47,44,66,3
MB 148,8,100
T 28,31,0
T 30,31,4
MB 152,12,96
s_waitcnt vmcnt(17)
s_barrier
T 32,24,16
MB 156,12,100
T 34,24,20
s_xor_b32 m0, s65, 0x8000
s_xor_b32 s66, s62, 0x10100
W 6
MB 160,16,96
G 44,44,66,0
MB 164,16,100
T 36,25,16
T 38,25,20
MB 168,20,96
T 40,26,16
MB 172,20,100
T 42,26,20
W 6
MB 176,24,96
G 45,44,66,1
MB 180,24,100
T 44,27,16
T 46,27,20
MB 184,28,96
T 48,28,16
MB 188,28,100
T 50,28,20
W 6
MB 128,32,104
G 46,44,66,2
MB 132,32,108
T 52,29,16
T 54,29,20
MB 136,36,104
T 56,30,16
MB 140,36,108
T 58,30,20
W 6
MB 144,40,104
G 47,44,66,3
MB 148,40,108
T 60,31,16
T 62,31,20
MB 152,44,104
s_waitcnt vmcnt(17)
s_barrier
T 0,24,32
MB 156,44,108
T 2,24,36
s_xor_b32 m0, s65, 0xc000
s_xor_b32 s66, s62, 0x18100
W 6
MB 160,48,104
G 44,44,66,0
MB 164,48,108
T 4,25,32
T 6,25,36
MB 168,52,104
T 8,26,32
MB 172,52,108
T 10,26,36
W 6
MB 176,56,104
G 45,44,66,1
MB 180,56,108
T 12,27,32
T 14,27,36
MB 184,60,104
T 16,28,32
MB 188,60,108
T 18,28,36
W 6
MB 128,0,112
G 46,44,66,2
MB 132,0,116
T 20,29,32
T 22,29,36
MB 136,4,112
T 24,30,32
MB 140,4,116
T 26,30,36
W 6
MB 144,8,112
G 47,44,66,3
MB 148,8,116
T 28,31,32
T 30,31,36
MB 152,12,112
s_waitcnt vmcnt(17)
s_barrier
T 32,24,48
MB 156,12,116
T 34,24,52
s_xor_b32 m0, s65, 0x10000
s_xor_b32 s66, s62, 0x20100
W 6
MB 160,16,112
G 44,44,66,0
MB 164,16,116
T 36,25,48
T 38,25,52
MB 168,20,112
T 40,26,48
MB 172,20,116
T 42,26,52
W 6
MB 176,24,112
G 45,44,66,1
MB 180,24,116
T 44,27,48
T 46,27,52
MB 184,28,112
T 48,28,48
MB 188,28,116
T 50,28,52
W 6
MB 128,32,120
G 46,44,66,2
MB 132,32,124
T 52,29,48
T 54,29,52
MB 136,36,120
T 56,30,48
MB 140,36,124
T 58,30,52
W 6
MB 144,40,120
G 47,44,66,3
MB 148,40,124
T 60,31,48
T 62,31,52
MB 152,44,120
s_waitcnt vmcnt(16)
s_barrier
T 0,16,0
MB 156,44,124
T 2,16,4
s_xor_b32 m0, s65, 0x14000
s_xor_b32 s66, s62, 0x28100
W 6
MB 160,48,120
G 44,44,66,0
MB 164,48,124
T 4,17,0
T 6,17,4
MB 168,52,120
T 8,18,0
MB 172,52,124
T 10,18,4
W 6
MB 176,56,120
G 45,44,66,1
MB 180,56,124
T 12,19,0
T 14,19,4
MB 184,60,120
T 16,20,0
MB 188,60,124
T 18,20,4
W 6
ZB 192,0,64
G 46,44,66,2
ZB 196,0,68
T 20,21,0
T 22,21,4
ZB 200,4,64
T 24,22,0
ZB 204,4,68
T 26,22,4
W 6
ZB 208,8,64
G 47,44,66,3
ZB 212,8,68
T 28,23,0
T 30,23,4
ZB 216,12,64
s_waitcnt vmcnt(16)
s_barrier
T 32,16,16
ZB 220,12,68
T 34,16,20
s_xor_b32 m0, s65, 0x18000
s_xor_b32 s66, s62, 0x30100
W 6
ZB 224,16,64
G 44,44,66,0
ZB 228,16,68
T 36,17,16
T 38,17,20
ZB 232,20,64
T 40,18,16
ZB 236,20,68
T 42,18,20
W 6
ZB 240,24,64
G 45,44,66,1
ZB 244,24,68
T 44,19,16
T 46,19,20
ZB 248,28,64
T 48,20,16
ZB 252,28,68
T 50,20,20
W 6
MB 192,32,72
G 46,44,66,2
MB 196,32,76
T 52,21,16
T 54,21,20
MB 200,36,72
T 56,22,16
MB 204,36,76
T 58,22,20
W 6
MB 208,40,72
G 47,44,66,3
MB 212,40,76
T 60,23,16
T 62,23,20
MB 216,44,72
s_waitcnt vmcnt(16)
s_barrier
T 0,16,32
MB 220,44,76
T 2,16,36
s_xor_b32 m0, s65, 0x1c000
s_xor_b32 s66, s62, 0x38100
W 6
MB 224,48,72
G 44,44,66,0
MB 228,48,76
T 4,17,32
T 6,17,36
MB 232,52,72
T 8,18,32
MB 236,52,76
T 10,18,36
W 6
MB 240,56,72
G 45,44,66,1
MB 244,56,76
T 12,19,32
T 14,19,36
MB 248,60,72
T 16,20,32
MB 252,60,76
T 18,20,36
W 6
MB 192,0,80
G 46,44,66,2
MB 196,0,84
T 20,21,32
T 22,21,36
MB 200,4,80
T 24,22,32
MB 204,4,84
T 26,22,36
W 6
MB 208,8,80
G 47,44,66,3
MB 212,8,84
T 28,23,32
T 30,23,36
MB 216,12,80
s_waitcnt vmcnt(16)
s_barrier
T 32,16,48
MB 220,12,84
T 34,16,52
s_xor_b32 m0, s65, 0x0
s_xor_b32 s66, s62, 0x40000
W 6
MB 224,16,80
G 44,44,66,0
MB 228,16,84
T 36,17,48
T 38,17,52
MB 232,20,80
T 40,18,48
MB 236,20,84
T 42,18,52
W 6
MB 240,24,80
G 45,44,66,1
MB 244,24,84
T 44,19,48
T 46,19,52
MB 248,28,80
T 48,20,48
MB 252,28,84
T 50,20,52
W 6
MB 192,32,88
G 46,44,66,2
MB 196,32,92
T 52,21,48
T 54,21,52
MB 200,36,88
T 56,22,48
MB 204,36,92
T 58,22,52
W 6
MB 208,40,88
G 47,44,66,3
MB 212,40,92
T 60,23,48
T 62,23,52
MB 216,44,88
s_waitcnt vmcnt(16)
s_barrier
T 0,24,0
MB 220,44,92
T 2,24,4
s_xor_b32 m0, s65, 0x4000
s_xor_b32 s66, s62, 0x48000
W 6
MB 224,48,88
G 44,44,66,0
MB 228,48,92
T 4,25,0
T 6,25,4
MB 232,52,88
T 8,26,0
MB 236,52,92
T 10,26,4
W 6
MB 240,56,88
G 45,44,66,1
MB 244,56,92
T 12,27,0
T 14,27,4
MB 248,60,88
T 16,28,0
MB 252,60,92
T 18,28,4
W 6
MB 192,0,96
G 46,44,66,2
MB 196,0,100
T 20,29,0
T 22,29,4
MB 200,4,96
T 24,30,0
MB 204,4,100
T 26,30,4
W 6
MB 208,8,96
G 47,44,66,3
MB 212,8,100
T 28,31,0
T 30,31,4
MB 216,12,96
s_waitcnt vmcnt(16)
s_barrier
T 32,24,16
MB 220,12,100
T 34,24,20
s_xor_b32 m0, s65, 0x8000
s_xor_b32 s66, s62, 0x50000
W 6
MB 224,16,96
G 44,44,66,0
MB 228,16,100
T 36,25,16
T 38,25,20
MB 232,20,96
T 40,26,16
MB 236,20,100
T 42,26,20
W 6
MB 240,24,96
G 45,44,66,1
MB 244,24,100
T 44,27,16
T 46,27,20
MB 248,28,96
T 48,28,16
MB 252,28,100
T 50,28,20
W 6
MB 192,32,104
G 46,44,66,2
MB 196,32,108
T 52,29,16
T 54,29,20
MB 200,36,104
T 56,30,16
MB 204,36,108
T 58,30,20
W 6
MB 208,40,104
G 47,44,66,3
MB 212,40,108
T 60,31,16
T 62,31,20
MB 216,44,104
s_waitcnt vmcnt(16)
s_barrier
T 0,24,32
MB 220,44,108
T 2,24,36
s_xor_b32 m0, s65, 0xc000
s_xor_b32 s66, s62, 0x58000
W 6
MB 224,48,104
G 44,44,66,0
MB 228,48,108
T 4,25,32
T 6,25,36
MB 232,52,104
T 8,26,32
MB 236,52,108
T 10,26,36
W 6
MB 240,56,104
G 45,44,66,1
MB 244,56,108
T 12,27,32
T 14,27,36
MB 248,60,104
T 16,28,32
MB 252,60,108
T 18,28,36
W 6
MB 192,0,112
G 46,44,66,2
MB 196,0,116
T 20,29,32
T 22,29,36
MB 200,4,112
T 24,30,32
MB 204,4,116
T 26,30,36
W 6
MB 208,8,112
G 47,44,66,3
MB 212,8,116
T 28,31,32
T 30,31,36
MB 216,12,112
s_waitcnt vmcnt(16)
s_barrier
T 32,24,48
MB 220,12,116
T 34,24,52
s_xor_b32 m0, s65, 0x10000
s_xor_b32 s66, s62, 0x60000
W 6
MB 224,16,112
G 44,44,66,0
MB 228,16,116
T 36,25,48
T 38,25,52
MB 232,20,112
T 40,26,48
MB 236,20,116
T 42,26,52
W 6
MB 240,24,112
G 45,44,66,1
MB 244,24,116
T 44,27,48
T 46,27,52
MB 248,28,112
T 48,28,48
MB 252,28,116
T 50,28,52
W 6
MB 192,32,120
G 46,44,66,2
MB 196,32,124
T 52,29,48
T 54,29,52
MB 200,36,120
T 56,30,48
MB 204,36,124
T 58,30,52
W 6
MB 208,40,120
G 47,44,66,3
MB 212,40,124
T 60,31,48
T 62,31,52
MB 216,44,120
s_waitcnt vmcnt(16)
s_barrier
T 0,16,0
MB 220,44,124
T 2,16,4
s_xor_b32 m0, s65, 0x14000
s_xor_b32 s66, s62, 0x68000
W 6
MB 224,48,120
G 44,44,66,0
MB 228,48,124
T 4,17,0
T 6,17,4
MB 232,52,120
T 8,18,0
MB 236,52,124
T 10,18,4
W 6
MB 240,56,120
G 45,44,66,1
MB 244,56,124
T 12,19,0
T 14,19,4
MB 248,60,120
T 16,20,0
MB 252,60,124
T 18,20,4
W 6
MB 128,0,160
G 46,44,66,2
MB 132,0,164
T 20,21,0
T 22,21,4
ds_write_b128 v58, a[160:163] offset:0
MB 136,4,160
T 24,22,0
MB 140,4,164
T 26,22,4
ds_write_b128 v58, a[164:167] offset:1024
W 8
MB 144,8,160
G 47,44,66,3
MB 148,8,164
T 28,23,0
T 30,23,4
ds_write_b128 v58, a[168:171] offset:2048
MB 152,12,160
s_waitcnt vmcnt(16) lgkmcnt(0)
s_barrier
T 32,16,16
MB 156,12,164
T 34,16,20
ds_write_b128 v58, a[172:175] offset:3072
s_xor_b32 m0, s65, 0x18000
s_xor_b32 s66, s62, 0x70000
MB 160,16,160
G 44,44,66,0
MB 164,16,164
T 36,17,16
T 38,17,20
ds_write_b128 v58, a[176:179] offset:4096
MB 168,20,160
T 40,18,16
MB 172,20,164
T 42,18,20
ds_write_b128 v58, a[180:183] offset:5120
MB 176,24,160
G 45,44,66,1
MB 180,24,164
T 44,19,16
T 46,19,20
ds_write_b128 v58, a[184:187] offset:6144
MB 184,28,160
T 48,20,16
MB 188,28,164
T 50,20,20
ds_write_b128 v58, a[188:191] offset:7168
W 10
MB 128,32,168
G 46,44,66,2
MB 132,32,172
T 52,21,16
T 54,21,20
MB 136,36,168
T 56,22,16
MB 140,36,172
T 58,22,20
W 8
MB 144,40,168
G 47,44,66,3
MB 148,40,172
T 60,23,16
T 62,23,20
MB 152,44,168
s_waitcnt vmcnt(16) lgkmcnt(6)
s_barrier
T 0,16,32
MB 156,44,172
T 2,16,36
R a,128,2,0
s_xor_b32 m0, s65, 0x1c000
s_xor_b32 s66, s62, 0x78000
MB 160,48,168
G 44,44,66,0
MB 164,48,172
T 4,17,32
T 6,17,36
R a,132,2,1
W 10
MB 168,52,168
T 8,18,32
MB 172,52,172
T 10,18,36
R a,136,2,2
W 9
MB 176,56,168
G 45,44,66,1
MB 180,56,172
T 12,19,32
T 14,19,36
R a,140,2,3
MB 184,60,168
T 16,20,32
MB 188,60,172
T 18,20,36
R a,144,2,4
W 10
MB 128,0,176
G 46,44,66,2
MB 132,0,180
T 20,21,32
T 22,21,36
R a,148,2,5
MB 136,4,176
T 24,22,32
MB 140,4,180
T 26,22,36
W 14
R a,152,2,6
W 10
MB 144,8,176
G 47,44,66,3
MB 148,8,180
T 28,23,32
T 30,23,36
R a,156,2,7
MB 152,12,176
s_waitcnt vmcnt(16)
s_barrier
T 32,16,48
MB 156,12,180
T 34,16,52
s_xor_b32 m0, s65, 0x0
s_xor_b32 s66, s62, 0x40100
W 9
MB 160,16,176
G 44,44,66,0
MB 164,16,180
T 36,17,48
T 38,17,52
s_getpc_b64 s[88:89]
L_ct0_1234:
s_and_b32 s89, s89, 0xffff
s_mov_b32 s90, L_code_end-L_ct0_1234
s_mov_b32 s91, 0x20000
v_and_b32 v62, 0x70, v59
v_lshlrev_b32 v62, 3, v62
s_add_u32 s7, s1, 4096
buffer_load_dword v3, v62, s[88:91], s7 offen
MB 168,20,176
T 40,18,48
MB 172,20,180
T 42,18,52
W 7
MB 176,24,176
G 45,44,66,1
MB 180,24,180
T 44,19,48
T 46,19,52
MB 184,28,176
T 48,20,48
MB 188,28,180
T 50,20,52
W 6
MB 128,32,184
G 46,44,66,2
MB 132,32,188
T 52,21,48
T 54,21,52
MB 136,36,184
T 56,22,48
MB 140,36,188
T 58,22,52
W 6
MB 144,40,184
G 47,44,66,3
MB 148,40,188
T 60,23,48
T 62,23,52
MB 152,44,184
s_waitcnt vmcnt(17)
s_barrier
T 0,24,0
MB 156,44,188
T 2,24,4
s_xor_b32 m0, s65, 0x4000
s_xor_b32 s66, s62, 0x48100
W 6
MB 160,48,184
G 44,44,66,0
MB 164,48,188
T 4,25,0
T 6,25,4
MB 168,52,184
T 8,26,0
MB 172,52,188
T 10,26,4
W 6
MB 176,56,184
G 45,44,66,1
MB 180,56,188
T 12,27,0
T 14,27,4
MB 184,60,184
T 16,28,0
MB 188,60,188
T 18,28,4
W 6
MB 128,0,128
G 46,44,66,2
MB 132,0,132
T 20,29,0
T 22,29,4
MB 136,4,128
T 24,30,0
MB 140,4,132
T 26,30,4
W 6
MB 144,8,128
G 47,44,66,3
MB 148,8,132
T 28,31,0
T 30,31,4
MB 152,12,128
s_waitcnt vmcnt(17)
s_barrier
T 32,24,16
MB 156,12,132
T 34,24,20
s_xor_b32 m0, s65, 0x8000
s_xor_b32 s66, s62, 0x50100
W 6
MB 160,16,128
G 44,44,66,0
MB 164,16,132
T 36,25,16
T 38,25,20
MB 168,20,128
T 40,26,16
MB 172,20,132
T 42,26,20
W 6
MB 176,24,128
G 45,44,66,1
MB 180,24,132
T 44,27,16
T 46,27,20
MB 184,28,128
T 48,28,16
MB 188,28,132
T 50,28,20
W 6
MB 128,32,136
G 46,44,66,2
MB 132,32,140
T 52,29,16
T 54,29,20
MB 136,36,136
T 56,30,16
MB 140,36,140
T 58,30,20
W 6
MB 144,40,136
G 47,44,66,3
MB 148,40,140
T 60,31,16
T 62,31,20
MB 152,44,136
s_waitcnt vmcnt(17)
s_barrier
T 0,24,32
MB 156,44,140
T 2,24,36
s_xor_b32 m0, s65, 0xc000
s_xor_b32 s66, s62, 0x58100
W 6
MB 160,48,136
G 44,44,66,0
MB 164,48,140
T 4,25,32
T 6,25,36
MB 168,52,136
T 8,26,32
MB 172,52,140
T 10,26,36
W 6
MB 176,56,136
G 45,44,66,1
MB 180,56,140
T 12,27,32
T 14,27,36
MB 184,60,136
T 16,28,32
MB 188,60,140
T 18,28,36
W 6
MB 128,0,144
G 46,44,66,2
MB 132,0,148
T 20,29,32
T 22,29,36
MB 136,4,144
T 24,30,32
MB 140,4,148
T 26,30,36
W 6
MB 144,8,144
G 47,44,66,3
MB 148,8,148
T 28,31,32
T 30,31,36
MB 152,12,144
s_waitcnt vmcnt(17)
s_barrier
T 32,24,48
MB 156,12,148
T 34,24,52
s_xor_b32 m0, s65, 0x10000
s_xor_b32 s66, s62, 0x60100
W 6
MB 160,16,144
G 44,44,66,0
MB 164,16,148
T 36,25,48
T 38,25,52
MB 168,20,144
T 40,26,48
MB 172,20,148
T 42,26,52
W 6
MB 176,24,144
G 45,44,66,1
MB 180,24,148
T 44,27,48
T 46,27,52
MB 184,28,144
T 48,28,48
MB 188,28,148
T 50,28,52
W 6
MB 128,32,152
G 46,44,66,2
MB 132,32,156
T 52,29,48
T 54,29,52
MB 136,36,152
T 56,30,48
MB 140,36,156
T 58,30,52
W 6
MB 144,40,152
G 47,44,66,3
MB 148,40,156
T 60,31,48
T 62,31,52
MB 152,44,152
s_waitcnt vmcnt(16)
s_barrier
T 0,16,0
MB 156,44,156
T 2,16,4
s_xor_b32 m0, s65, 0x14000
s_xor_b32 s66, s62, 0x68100
W 6
MB 160,48,152
G 44,44,66,0
MB 164,48,156
T 4,17,0
T 6,17,4
MB 168,52,152
T 8,18,0
MB 172,52,156
T 10,18,4
W 6
MB 176,56,152
G 45,44,66,1
MB 180,56,156
T 12,19,0
T 14,19,4
MB 184,60,152
T 16,20,0
MB 188,60,156
T 18,20,4
W 6
MB 192,0,160
G 46,44,66,2
MB 196,0,164
T 20,21,0
T 22,21,4
MB 200,4,160
T 24,22,0
MB 204,4,164
T 26,22,4
W 6
MB 208,8,160
G 47,44,66,3
MB 212,8,164
T 28,23,0
T 30,23,4
MB 216,12,160
s_waitcnt vmcnt(16)
s_barrier
T 32,16,16
T 34,16,20
MB 220,12,164
CV 68,132
CV 69,134
s_xor_b32 m0, s65, 0x18000
s_xor_b32 s66, s62, 0x70100
W 6
MB 224,16,160
G 44,44,66,0
T 36,17,16
MB 228,16,164
T 38,17,20
CV 70,140
CV 71,142
MB 232,20,160
T 40,18,16
T 42,18,20
MB 236,20,164
AW 100,68
AW 101,69
W 6
MB 240,24,160
G 45,44,66,1
T 44,19,16
MB 244,24,164
T 46,19,20
AW 102,70
AW 103,71
MB 248,28,160
T 48,20,16
T 50,20,20
MB 252,28,164
CV 72,144
CV 73,146
W 6
MB 192,32,168
G 46,44,66,2
T 52,21,16
MB 196,32,172
T 54,21,20
CV 74,152
CV 75,154
MB 200,36,168
T 56,22,16
T 58,22,20
MB 204,36,172
AW 104,72
AW 105,73
W 6
MB 208,40,168
G 47,44,66,3
T 60,23,16
MB 212,40,172
T 62,23,20
AW 106,74
AW 107,75
MB 216,44,168
s_waitcnt vmcnt(16)
s_barrier
T 0,16,32
T 2,16,36
MB 220,44,172
CV 76,148
CV 77,150
s_xor_b32 m0, s65, 0x1c000
s_xor_b32 s66, s62, 0x78100
W 6
MB 224,48,168
G 44,44,66,0
T 4,17,32
MB 228,48,172
T 6,17,36
CV 78,156
CV 79,158
MB 232,52,168
T 8,18,32
T 10,18,36
MB 236,52,172
AW 108,76
AW 109,77
W 6
MB 240,56,168
G 45,44,66,1
T 12,19,32
MB 244,56,172
T 14,19,36
AW 110,78
AW 111,79
MB 248,60,168
T 16,20,32
T 18,20,36
MB 252,60,172
CV 80,160
CV 81,162
W 6
MB 192,0,176
G 46,44,66,2
T 20,21,32
MB 196,0,180
T 22,21,36
CV 82,168
CV 83,170
MB 200,4,176
T 24,22,32
T 26,22,36
MB 204,4,180
AW 112,80
AW 113,81
W 6
MB 208,8,176
G 47,44,66,3
T 28,23,32
MB 212,8,180
T 30,23,36
AW 114,82
AW 115,83
MB 216,12,176
s_waitcnt vmcnt(16)
s_barrier
T 32,16,48
T 34,16,52
MB 220,12,180
CV 84,164
CV 85,166
s_xor_b32 m0, s65, 0x0
s_xor_b32 s66, s64, 0x0
W 6
MB 224,16,176
G 48,48,66,0,nt
T 36,17,48
MB 228,16,180
T 38,17,52
CV 86,172
CV 87,174
MB 232,20,176
T 40,18,48
T 42,18,52
MB 236,20,180
AW 116,84
AW 117,85
W 6
MB 240,24,176
G 49,48,66,1,nt
T 44,19,48
MB 244,24,180
T 46,19,52
AW 118,86
AW 119,87
MB 248,28,176
T 48,20,48
T 50,20,52
MB 252,28,180
CV 88,176
CV 89,178
W 6
MB 192,32,184
G 50,48,66,2,nt
T 52,21,48
MB 196,32,188
T 54,21,52
CV 90,184
CV 91,186
MB 200,36,184
T 56,22,48
T 58,22,52
MB 204,36,188
AW 120,88
AW 121,89
W 6
MB 208,40,184
G 51,48,66,3,nt
T 60,23,48
MB 212,40,188
T 62,23,52
AW 122,90
AW 123,91
MB 216,44,184
s_waitcnt vmcnt(16)
s_barrier
T 0,24,0
T 2,24,4
MB 220,44,188
CV 92,180
CV 93,182
s_xor_b32 m0, s65, 0x4000
s_xor_b32 s66, s64, 0x10000
W 6
MB 224,48,184
G 48,48,66,0,nt
T 4,25,0
MB 228,48,188
T 6,25,4
CV 94,188
CV 95,190
MB 232,52,184
T 8,26,0
T 10,26,4
MB 236,52,188
AW 124,92
AW 125,93
W 6
MB 240,56,184
G 49,48,66,1,nt
T 12,27,0
MB 244,56,188
T 14,27,4
AW 126,94
AW 127,95
MB 248,60,184
T 16,28,0
MB 252,60,188
T 18,28,4
CV 36,128
W 6
MB 192,0,128
G 50,48,66,2,nt
MB 196,0,132
T 20,29,0
T 22,29,4
CV 37,130
MB 200,4,128
T 24,30,0
MB 204,4,132
T 26,30,4
CV 38,136
W 6
MB 208,8,128
G 51,48,66,3,nt
MB 212,8,132
T 28,31,0
T 30,31,4
CV 39,138
MB 216,12,128
s_waitcnt vmcnt(16)
s_barrier
T 32,24,16
MB 220,12,132
T 34,24,20
s_xor_b32 m0, s65, 0x8000
s_xor_b32 s66, s64, 0x2000
W 6
MB 224,16,128
G 48,48,66,0,nt
MB 228,16,132
T 36,25,16
T 38,25,20
MB 232,20,128
T 40,26,16
MB 236,20,132
T 42,26,20
W 6
MB 240,24,128
G 49,48,66,1,nt
MB 244,24,132
T 44,27,16
T 46,27,20
MB 248,28,128
T 48,28,16
MB 252,28,132
T 50,28,20
W 6
MB 192,32,136
G 50,48,66,2,nt
MB 196,32,140
T 52,29,16
T 54,29,20
MB 200,36,136
T 56,30,16
MB 204,36,140
T 58,30,20
W 6
MB 208,40,136
G 51,48,66,3,nt
MB 212,40,140
T 60,31,16
T 62,31,20
MB 216,44,136
s_waitcnt vmcnt(16)
s_barrier
MB 220,44,140
T 0,24,32
T 2,24,36
W 6
MB 224,48,136
T 4,25,32
MB 228,48,140
T 6,25,36
MB 232,52,136
T 8,26,32
MB 236,52,140
T 10,26,36
W 6
MB 240,56,136
T 12,27,32
MB 244,56,140
T 14,27,36
MB 248,60,136
T 16,28,32
MB 252,60,140
T 18,28,36
W 6
MB 192,0,144
T 20,29,32
MB 196,0,148
T 22,29,36
MB 200,4,144
T 24,30,32
MB 204,4,148
T 26,30,36
W 6
MB 208,8,144
T 28,31,32
MB 212,8,148
T 30,31,36
MB 216,12,144
s_waitcnt vmcnt(12)
s_barrier
MB 220,12,148
T 32,24,48
T 34,24,52
W 6
MB 224,16,144
T 36,25,48
MB 228,16,148
T 38,25,52
MB 232,20,144
T 40,26,48
MB 236,20,148
T 42,26,52
W 6
MB 240,24,144
T 44,27,48
MB 244,24,148
T 46,27,52
MB 248,28,144
T 48,28,48
MB 252,28,148
T 50,28,52
W 6
MB 192,32,152
T 52,29,48
MB 196,32,156
T 54,29,52
MB 200,36,152
T 56,30,48
MB 204,36,156
T 58,30,52
W 6
MB 208,40,152
T 60,31,48
T 62,31,52
MB 212,40,156
v_xor_b32 v16, s71, v16
v_xor_b32 v17, s71, v17
v_xor_b32 v18, s71, v18
MB 216,44,152
s_waitcnt vmcnt(8)
s_barrier
R a,0,8,0
v_xor_b32 v19, s71, v19
MB 220,44,156
v_xor_b32 v20, s71, v20
v_xor_b32 v21, s71, v21
s_xor_b32 m0, s65, 0xc000
s_xor_b32 s66, s64, 0x12000
W 5
MB 224,48,152
G 48,48,66,0,nt
MB 228,48,156
R a,4,9,0
v_xor_b32 v22, s71, v22
v_xor_b32 v23, s71, v23
MB 232,52,152
R a,8,10,0
v_xor_b32 v24, s71, v24
MB 236,52,156
v_xor_b32 v25, s71, v25
v_xor_b32 v26, s71, v26
W 3
MB 240,56,152
G 49,48,66,1,nt
R a,12,11,0
MB 244,56,156
v_xor_b32 v27, s71, v27
v_xor_b32 v28, s71, v28
v_xor_b32 v29, s71, v29
MB 248,60,152
R a,16,8,4
MB 252,60,156
v_xor_b32 v30, s71, v30
v_xor_b32 v31, s71, v31
CV 100,196
CV 101,198
CV 102,204
CV 103,206
AW 68,100
AW 69,101
AW 70,102
AW 71,103
CV 104,208
CV 105,210
CV 106,216
CV 107,218
AW 72,104
AW 73,105
AW 74,106
AW 75,107
CV 108,212
CV 109,214
CV 110,220
CV 111,222
AW 76,108
AW 77,109
AW 78,110
AW 79,111
CV 112,224
CV 113,226
CV 114,232
CV 115,234
AW 80,112
AW 81,113
AW 82,114
AW 83,115
CV 116,228
CV 117,230
CV 118,236
CV 119,238
AW 84,116
AW 85,117
AW 86,118
AW 87,119
CV 120,240
CV 121,242
CV 122,248
CV 123,250
AW 88,120
AW 89,121
AW 90,122
AW 91,123
CV 124,244
CV 125,246
CV 126,252
CV 127,254
AW 92,124
AW 93,125
AW 94,126
AW 95,127
CV 40,192
CV 41,194
CV 42,200
CV 43,202
W 3
ZB 64,0,192
G 50,48,66,2,nt
ZB 68,0,196
R a,20,9,4
MB 64,4,200
R a,24,10,4
MB 68,4,204
W 3
MB 64,8,208
G 51,48,66,3,nt
MB 68,8,212
R a,28,11,4
MB 64,12,216
MB 68,12,220
W 2
ZB 72,16,192
ZB 76,16,196
MB 72,20,200
MB 76,20,204
W 0
MB 72,24,208
E 64
MB 76,24,212
MB 72,28,216
E 65
MB 76,28,220
CV 96,64
E 66
T 32,16,0
E 67
T 34,16,4
T 36,17,0
CV 97,66
E 68
T 38,17,4
E 69
T 40,18,0
CV 100,68
E 70
T 42,18,4
T 44,19,0
E 71
T 46,19,4
CV 101,70
E 72
T 48,20,0
E 73
T 50,20,4
T 52,21,0
CV 98,72
E 74
ZB 80,0,224
T 54,21,4
ZB 84,0,228
E 75
MB 80,4,232
T 56,22,0
CV 99,74
MB 84,4,236
E 76
MB 80,8,240
T 58,22,4
T 60,23,0
MB 84,8,244
E 77
MB 80,12,248
W 14
T 62,23,4
CV 102,76
MB 84,12,252
E 78
s_getpc_b64 s[88:89]
L_ct0_1362:
s_and_b32 s89, s89, 0xffff
s_mov_b32 s90, L_code_end-L_ct0_1362
s_mov_b32 s91, 0x20000
v_and_b32 v62, 0x70, v59
v_lshlrev_b32 v62, 3, v62
s_add_u32 s7, s1, 4096
buffer_load_dword v3, v62, s[88:91], s7 offen
ZB 88,16,224
E 79
ZB 92,16,228
MB 88,20,232
CV 103,78
MB 92,20,236
MB 88,24,240
E 80
MB 92,24,244
MB 88,28,248
E 81
MB 92,28,252
W 12
ZA 128,32,96
s_waitcnt vmcnt(9) lgkmcnt(0)
s_barrier
R a,0,8,16
ZA 132,32,100
CV 104,80
E 82
ZA 136,36,96
R a,4,9,16
ZA 140,36,100
E 83
ZA 144,40,96
R a,8,10,16
CV 105,82
ZA 148,40,100
E 84
ZA 152,44,96
R a,12,11,16
ZA 156,44,100
E 85
ZA 160,48,96
R a,16,8,20
CV 108,84
ZA 164,48,100
E 86
ZA 168,52,96
R a,20,9,20
ZA 172,52,100
E 87
ZA 176,56,96
R a,24,10,20
CV 109,86
ZA 180,56,100
E 88
ZA 184,60,96
R a,28,11,20
ZA 188,60,100
E 89
ZD 112,52,96
CV 106,88
E 90
ZD 116,52,100
s_xor_b32 m0, s65, 0x10000
s_xor_b32 s66, s64, 0x1000
W 6
ZB 64,0,192
G 48,48,66,0,nt
ZB 68,0,196
E 91
MB 64,4,200
CV 107,90
MB 68,4,204
E 92
W 4
MB 64,8,208
G 49,48,66,1,nt
MB 68,8,212
E 93
MB 64,12,216
CV 110,92
MB 68,12,220
E 94
W 2
ZB 72,16,192
G 50,48,66,2,nt
ZB 76,16,196
E 95
MB 72,20,200
CV 111,94
MB 76,20,204
W 0
MB 72,24,208
G 51,48,66,3,nt
MB 76,24,212
E 64
MB 72,28,216
E 65
MB 76,28,220
ZA 192,32,104
CV 96,64
ZA 196,32,108
E 66
ZA 200,36,104
T 32,16,16
ZA 204,36,108
E 67
ZA 208,40,104
T 34,16,20
T 36,17,16
ZA 212,40,108
CV 97,66
E 68
ZA 216,44,104
T 38,17,20
ZA 220,44,108
E 69
ZA 224,48,104
T 40,18,16
CV 100,68
ZA 228,48,108
E 70
ZA 232,52,104
T 42,18,20
T 44,19,16
ZA 236,52,108
E 71
ZA 240,56,104
T 46,19,20
CV 101,70
ZA 244,56,108
E 72
ZA 248,60,104
T 48,20,16
ZA 252,60,108
E 73
ZD 120,52,104
T 50,20,20
T 52,21,16
ZD 124,52,108
CV 98,72
E 74
ZB 80,0,224
T 54,21,20
ZB 84,0,228
E 75
MB 80,4,232
T 56,22,16
CV 99,74
MB 84,4,236
E 76
MB 80,8,240
T 58,22,20
T 60,23,16
MB 84,8,244
E 77
MB 80,12,248
W 14
T 62,23,20
CV 102,76
MB 84,12,252
E 78
ZB 88,16,224
E 79
ZB 92,16,228
MB 88,20,232
CV 103,78
MB 92,20,236
MB 88,24,240
E 80
MB 92,24,244
MB 88,28,248
E 81
MB 92,28,252
W 12
MA 128,32,96
s_waitcnt vmcnt(9) lgkmcnt(0)
s_barrier
R a,0,8,32
MA 132,32,100
CV 104,80
E 82
MA 136,36,96
R a,4,9,32
MA 140,36,100
E 83
MA 144,40,96
R a,8,10,32
CV 105,82
MA 148,40,100
E 84
MA 152,44,96
R a,12,11,32
MA 156,44,100
E 85
MA 160,48,96
R a,16,8,36
CV 108,84
MA 164,48,100
E 86
MA 168,52,96
R a,20,9,36
MA 172,52,100
E 87
MA 176,56,96
R a,24,10,36
CV 109,86
MA 180,56,100
E 88
MA 184,60,96
R a,28,11,36
MA 188,60,100
E 89
MD 112,52,96
CV 106,88
E 90
MD 116,52,100
s_xor_b32 m0, s65, 0x14000
s_xor_b32 s66, s64, 0x11000
W 6
ZB 64,0,192
G 48,48,66,0,nt
ZB 68,0,196
E 91
MB 64,4,200
CV 107,90
MB 68,4,204
E 92
W 4
MB 64,8,208
G 49,48,66,1,nt
MB 68,8,212
E 93
MB 64,12,216
CV 110,92
MB 68,12,220
E 94
W 2
ZB 72,16,192
G 50,48,66,2,nt
ZB 76,16,196
E 95
MB 72,20,200
CV 111,94
MB 76,20,204
W 0
MB 72,24,208
G 51,48,66,3,nt
MB 76,24,212
E 64
MB 72,28,216
E 65
MB 76,28,220
MA 192,32,104
CV 96,64
MA 196,32,108
E 66
MA 200,36,104
T 32,16,32
MA 204,36,108
E 67
MA 208,40,104
T 34,16,36
T 36,17,32
MA 212,40,108
CV 97,66
E 68
MA 216,44,104
T 38,17,36
MA 220,44,108
E 69
MA 224,48,104
T 40,18,32
CV 100,68
MA 228,48,108
E 70
MA 232,52,104
T 42,18,36
T 44,19,32
MA 236,52,108
E 71
MA 240,56,104
T 46,19,36
CV 101,70
MA 244,56,108
E 72
MA 248,60,104
T 48,20,32
MA 252,60,108
E 73
MD 120,52,104
T 50,20,36
T 52,21,32
MD 124,52,108
CV 98,72
E 74
ZB 80,0,224
T 54,21,36
ZB 84,0,228
E 75
MB 80,4,232
T 56,22,32
CV 99,74
MB 84,4,236
E 76
MB 80,8,240
T 58,22,36
T 60,23,32
MB 84,8,244
E 77
MB 80,12,248
W 14
T 62,23,36
CV 102,76
MB 84,12,252
E 78
ZB 88,16,224
E 79
ZB 92,16,228
MB 88,20,232
CV 103,78
MB 92,20,236
MB 88,24,240
E 80
MB 92,24,244
MB 88,28,248
E 81
MB 92,28,252
W 12
MA 128,32,96
s_waitcnt vmcnt(9) lgkmcnt(0)
s_barrier
R a,0,8,48
MA 132,32,100
CV 104,80
E 82
MA 136,36,96
R a,4,9,48
MA 140,36,100
E 83
MA 144,40,96
R a,8,10,48
CV 105,82
MA 148,40,100
E 84
MA 152,44,96
R a,12,11,48
MA 156,44,100
E 85
MA 160,48,96
R a,16,8,52
CV 108,84
MA 164,48,100
E 86
MA 168,52,96
R a,20,9,52
MA 172,52,100
E 87
MA 176,56,96
R a,24,10,52
CV 109,86
MA 180,56,100
E 88
MA 184,60,96
R a,28,11,52
MA 188,60,100
E 89
MD 112,52,96
CV 106,88
E 90
MD 116,52,100
s_xor_b32 m0, s65, 0x18000
s_xor_b32 s66, s64, 0x3000
W 6
ZB 64,0,192
G 48,48,66,0,nt
ZB 68,0,196
E 91
MB 64,4,200
CV 107,90
MB 68,4,204
E 92
W 4
MB 64,8,208
G 49,48,66,1,nt
MB 68,8,212
E 93
MB 64,12,216
CV 110,92
MB 68,12,220
E 94
W 2
ZB 72,16,192
G 50,48,66,2,nt
ZB 76,16,196
E 95
MB 72,20,200
CV 111,94
MB 76,20,204
W 0
MB 72,24,208
G 51,48,66,3,nt
MB 76,24,212
E 64
MB 72,28,216
E 65
MB 76,28,220
MA 192,32,104
CV 96,64
MA 196,32,108
E 66
MA 200,36,104
T 32,16,48
MA 204,36,108
E 67
MA 208,40,104
T 34,16,52
T 36,17,48
MA 212,40,108
CV 97,66
E 68
MA 216,44,104
T 38,17,52
MA 220,44,108
E 69
MA 224,48,104
T 40,18,48
CV 100,68
MA 228,48,108
E 70
MA 232,52,104
T 42,18,52
T 44,19,48
MA 236,52,108
E 71
MA 240,56,104
T 46,19,52
CV 101,70
MA 244,56,108
E 72
MA 248,60,104
T 48,20,48
MA 252,60,108
E 73
MD 120,52,104
T 50,20,52
T 52,21,48
MD 124,52,108
CV 98,72
E 74
ZB 80,0,224
T 54,21,52
ZB 84,0,228
E 75
MB 80,4,232
T 56,22,48
CV 99,74
MB 84,4,236
E 76
MB 80,8,240
T 58,22,52
T 60,23,48
MB 84,8,244
E 77
MB 80,12,248
W 14
T 62,23,52
CV 102,76
MB 84,12,252
E 78
ZB 88,16,224
E 79
ZB 92,16,228
MB 88,20,232
CV 103,78
MB 92,20,236
MB 88,24,240
E 80
MB 92,24,244
MB 88,28,248
E 81
MB 92,28,252
W 12
MA 128,32,96
s_waitcnt vmcnt(8) lgkmcnt(0)
s_barrier
R a,0,12,0
MA 132,32,100
CV 104,80
E 82
MA 136,36,96
R a,4,13,0
MA 140,36,100
E 83
MA 144,40,96
R a,8,14,0
CV 105,82
MA 148,40,100
E 84
MA 152,44,96
R a,12,15,0
MA 156,44,100
E 85
MA 160,48,96
R a,16,12,4
CV 108,84
MA 164,48,100
E 86
MA 168,52,96
R a,20,13,4
MA 172,52,100
E 87
MA 176,56,96
R a,24,14,4
CV 109,86
MA 180,56,100
E 88
MA 184,60,96
R a,28,15,4
MA 188,60,100
E 89
MD 112,52,96
CV 106,88
E 90
MD 116,52,100
s_xor_b32 m0, s65, 0x1c000
s_xor_b32 s66, s64, 0x13000
W 6
ZB 64,0,192
G 48,48,66,0,nt
ZB 68,0,196
E 91
MB 64,4,200
CV 107,90
MB 68,4,204
E 92
W 4
MB 64,8,208
G 49,48,66,1,nt
MB 68,8,212
E 93
MB 64,12,216
CV 110,92
MB 68,12,220
E 94
W 2
ZB 72,16,192
G 50,48,66,2,nt
ZB 76,16,196
E 95
MB 72,20,200
CV 111,94
MB 76,20,204
W 0
MB 72,24,208
G 51,48,66,3,nt
MB 76,24,212
E 64
MB 72,28,216
E 65
MB 76,28,220
MA 192,32,104
CV 96,64
MA 196,32,108
E 66
MA 200,36,104
T 32,24,0
MA 204,36,108
E 67
MA 208,40,104
T 34,24,4
T 36,25,0
MA 212,40,108
CV 97,66
E 68
MA 216,44,104
T 38,25,4
MA 220,44,108
E 69
MA 224,48,104
T 40,26,0
CV 100,68
MA 228,48,108
E 70
MA 232,52,104
T 42,26,4
T 44,27,0
MA 236,52,108
E 71
MA 240,56,104
T 46,27,4
CV 101,70
MA 244,56,108
E 72
MA 248,60,104
T 48,28,0
MA 252,60,108
E 73
MD 120,52,104
T 50,28,4
T 52,29,0
MD 124,52,108
CV 98,72
E 74
ZB 80,0,224
T 54,29,4
ZB 84,0,228
E 75
MB 80,4,232
T 56,30,0
CV 99,74
MB 84,4,236
E 76
MB 80,8,240
T 58,30,4
T 60,31,0
MB 84,8,244
E 77
MB 80,12,248
W 14
T 62,31,4
CV 102,76
MB 84,12,252
E 78
ZB 88,16,224
E 79
ZB 92,16,228
MB 88,20,232
CV 103,78
MB 92,20,236
MB 88,24,240
E 80
MB 92,24,244
MB 88,28,248
E 81
MB 92,28,252
W 12
MA 128,32,96
s_waitcnt vmcnt(8) lgkmcnt(0)
s_barrier
R a,0,12,16
MA 132,32,100
CV 104,80
E 82
MA 136,36,96
R a,4,13,16
MA 140,36,100
E 83
MA 144,40,96
R a,8,14,16
CV 105,82
MA 148,40,100
E 84
MA 152,44,96
R a,12,15,16
MA 156,44,100
E 85
MA 160,48,96
R a,16,12,20
CV 108,84
MA 164,48,100
E 86
MA 168,52,96
R a,20,13,20
MA 172,52,100
E 87
MA 176,56,96
R a,24,14,20
CV 109,86
MA 180,56,100
E 88
MA 184,60,96
R a,28,15,20
MA 188,60,100
E 89
MD 112,52,96
CV 106,88
E 90
MD 116,52,100
s_xor_b32 m0, s65, 0x0
s_xor_b32 s66, s64, 0x4000
W 6
ZB 64,0,192
G 48,48,66,0,nt
ZB 68,0,196
E 91
MB 64,4,200
CV 107,90
MB 68,4,204
E 92
W 4
MB 64,8,208
G 49,48,66,1,nt
MB 68,8,212
E 93
MB 64,12,216
CV 110,92
MB 68,12,220
E 94
W 2
ZB 72,16,192
G 50,48,66,2,nt
ZB 76,16,196
E 95
MB 72,20,200
CV 111,94
MB 76,20,204
W 0
MB 72,24,208
G 51,48,66,3,nt
MB 76,24,212
E 64
MB 72,28,216
E 65
MB 76,28,220
MA 192,32,104
CV 96,64
MA 196,32,108
E 66
MA 200,36,104
T 32,24,16
MA 204,36,108
E 67
MA 208,40,104
T 34,24,20
T 36,25,16
MA 212,40,108
CV 97,66
E 68
MA 216,44,104
T 38,25,20
MA 220,44,108
E 69
MA 224,48,104
T 40,26,16
CV 100,68
MA 228,48,108
E 70
MA 232,52,104
T 42,26,20
T 44,27,16
MA 236,52,108
E 71
MA 240,56,104
T 46,27,20
CV 101,70
MA 244,56,108
E 72
MA 248,60,104
T 48,28,16
MA 252,60,108
E 73
MD 120,52,104
T 50,28,20
T 52,29,16
MD 124,52,108
CV 98,72
E 74
ZB 80,0,224
T 54,29,20
ZB 84,0,228
E 75
MB 80,4,232
T 56,30,16
CV 99,74
MB 84,4,236
E 76
MB 80,8,240
T 58,30,20
T 60,31,16
MB 84,8,244
E 77
MB 80,12,248
W 14
T 62,31,20
CV 102,76
MB 84,12,252
E 78
ZB 88,16,224
E 79
ZB 92,16,228
MB 88,20,232
CV 103,78
MB 92,20,236
MB 88,24,240
E 80
MB 92,24,244
MB 88,28,248
E 81
MB 92,28,252
W 12
MA 128,32,96
s_waitcnt vmcnt(8) lgkmcnt(0)
s_barrier
R a,0,12,32
MA 132,32,100
CV 104,80
E 82
MA 136,36,96
R a,4,13,32
MA 140,36,100
E 83
MA 144,40,96
R a,8,14,32
CV 105,82
MA 148,40,100
E 84
MA 152,44,96
R a,12,15,32
MA 156,44,100
E 85
MA 160,48,96
R a,16,12,36
CV 108,84
MA 164,48,100
E 86
MA 168,52,96
R a,20,13,36
MA 172,52,100
E 87
MA 176,56,96
R a,24,14,36
CV 109,86
MA 180,56,100
E 88
MA 184,60,96
R a,28,15,36
MA 188,60,100
E 89
MD 112,52,96
CV 106,88
E 90
MD 116,52,100
s_xor_b32 m0, s65, 0x4000
s_xor_b32 s66, s64, 0x14000
W 6
ZB 64,0,192
G 48,48,66,0,nt
ZB 68,0,196
E 91
MB 64,4,200
CV 107,90
MB 68,4,204
E 92
W 4
MB 64,8,208
G 49,48,66,1,nt
MB 68,8,212
E 93
MB 64,12,216
CV 110,92
MB 68,12,220
E 94
W 2
ZB 72,16,192
G 50,48,66,2,nt
ZB 76,16,196
E 95
MB 72,20,200
CV 111,94
MB 76,20,204
W 0
MB 72,24,208
G 51,48,66,3,nt
MB 76,24,212
E 64
MB 72,28,216
E 65
MB 76,28,220
MA 192,32,104
CV 96,64
MA 196,32,108
E 66
MA 200,36,104
T 32,24,32
MA 204,36,108
E 67
MA 208,40,104
T 34,24,36
T 36,25,32
MA 212,40,108
CV 97,66
E 68
MA 216,44,104
T 38,25,36
MA 220,44,108
E 69
MA 224,48,104
T 40,26,32
CV 100,68
MA 228,48,108
E 70
MA 232,52,104
T 42,26,36
T 44,27,32
MA 236,52,108
E 71
MA 240,56,104
T 46,27,36
CV 101,70
MA 244,56,108
E 72
MA 248,60,104
T 48,28,32
MA 252,60,108
E 73
MD 120,52,104
T 50,28,36
T 52,29,32
MD 124,52,108
CV 98,72
E 74
ZB 80,0,224
T 54,29,36
ZB 84,0,228
E 75
MB 80,4,232
T 56,30,32
CV 99,74
MB 84,4,236
E 76
MB 80,8,240
T 58,30,36
T 60,31,32
MB 84,8,244
E 77
MB 80,12,248
W 14
T 62,31,36
CV 102,76
MB 84,12,252
E 78
ZB 88,16,224
E 79
ZB 92,16,228
MB 88,20,232
CV 103,78
MB 92,20,236
MB 88,24,240
E 80
MB 92,24,244
MB 88,28,248
E 81
MB 92,28,252
W 12
MA 128,32,96
s_waitcnt vmcnt(8) lgkmcnt(0)
s_barrier
R a,0,12,48
MA 132,32,100
CV 104,80
E 82
MA 136,36,96
R a,4,13,48
MA 140,36,100
E 83
MA 144,40,96
R a,8,14,48
CV 105,82
MA 148,40,100
E 84
MA 152,44,96
R a,12,15,48
MA 156,44,100
E 85
MA 160,48,96
R a,16,12,52
CV 108,84
MA 164,48,100
E 86
MA 168,52,96
R a,20,13,52
MA 172,52,100
E 87
MA 176,56,96
R a,24,14,52
CV 109,86
MA 180,56,100
E 88
MA 184,60,96
R a,28,15,52
MA 188,60,100
E 89
MD 112,52,96
CV 106,88
E 90
MD 116,52,100
s_xor_b32 m0, s65, 0x8000
s_xor_b32 s66, s64, 0x6000
W 6
ZB 64,0,192
G 48,48,66,0,nt
ZB 68,0,196
E 91
MB 64,4,200
CV 107,90
MB 68,4,204
E 92
W 4
MB 64,8,208
G 49,48,66,1,nt
MB 68,8,212
E 93
MB 64,12,216
CV 110,92
MB 68,12,220
E 94
W 2
ZB 72,16,192
G 50,48,66,2,nt
ZB 76,16,196
E 95
MB 72,20,200
CV 111,94
MB 76,20,204
W 0
MB 72,24,208
G 51,48,66,3,nt
MB 76,24,212
E 64
MB 72,28,216
E 65
MB 76,28,220
MA 192,32,104
CV 96,64
MA 196,32,108
E 66
MA 200,36,104
T 32,24,48
MA 204,36,108
E 67
MA 208,40,104
T 34,24,52
T 36,25,48
MA 212,40,108
CV 97,66
E 68
MA 216,44,104
T 38,25,52
MA 220,44,108
E 69
MA 224,48,104
T 40,26,48
CV 100,68
MA 228,48,108
E 70
MA 232,52,104
T 42,26,52
T 44,27,48
MA 236,52,108
E 71
MA 240,56,104
T 46,27,52
CV 101,70
MA 244,56,108
E 72
MA 248,60,104
T 48,28,48
MA 252,60,108
E 73
MD 120,52,104
T 50,28,52
T 52,29,48
MD 124,52,108
CV 98,72
E 74
ZB 80,0,224
T 54,29,52
ZB 84,0,228
E 75
MB 80,4,232
T 56,30,48
CV 99,74
MB 84,4,236
E 76
MB 80,8,240
T 58,30,52
T 60,31,48
MB 84,8,244
E 77
MB 80,12,248
W 14
T 62,31,52
CV 102,76
MB 84,12,252
E 78
ZB 88,16,224
E 79
ZB 92,16,228
MB 88,20,232
CV 103,78
MB 92,20,236
MB 88,24,240
E 80
MB 92,24,244
MB 88,28,248
E 81
MB 92,28,252
W 12
MA 128,32,96
s_waitcnt vmcnt(8) lgkmcnt(0)
s_barrier
R a,0,8,0
MA 132,32,100
CV 104,80
E 82
MA 136,36,96
R a,4,9,0
MA 140,36,100
E 83
MA 144,40,96
R a,8,10,0
CV 105,82
MA 148,40,100
E 84
MA 152,44,96
R a,12,11,0
MA 156,44,100
E 85
MA 160,48,96
R a,16,8,4
CV 108,84
MA 164,48,100
E 86
MA 168,52,96
R a,20,9,4
MA 172,52,100
E 87
MA 176,56,96
R a,24,10,4
CV 109,86
MA 180,56,100
E 88
MA 184,60,96
R a,28,11,4
MA 188,60,100
E 89
MD 112,52,96
CV 106,88
E 90
MD 116,52,100
s_xor_b32 m0, s65, 0xc000
s_xor_b32 s66, s64, 0x16000
W 6
ZB 64,0,192
G 48,48,66,0,nt
ZB 68,0,196
E 91
MB 64,4,200
CV 107,90
MB 68,4,204
E 92
W 4
MB 64,8,208
G 49,48,66,1,nt
MB 68,8,212
E 93
MB 64,12,216
CV 110,92
MB 68,12,220
E 94
W 2
ZB 72,16,192
G 50,48,66,2,nt
ZB 76,16,196
E 95
MB 72,20,200
CV 111,94
MB 76,20,204
W 0
MB 72,24,208
G 51,48,66,3,nt
MB 76,24,212
E 64
MB 72,28,216
E 65
MB 76,28,220
MA 192,32,104
CV 96,64
MA 196,32,108
E 66
MA 200,36,104
T 32,16,0
MA 204,36,108
E 67
MA 208,40,104
T 34,16,4
T 36,17,0
MA 212,40,108
CV 97,66
E 68
MA 216,44,104
T 38,17,4
MA 220,44,108
E 69
MA 224,48,104
T 40,18,0
CV 100,68
MA 228,48,108
E 70
MA 232,52,104
T 42,18,4
T 44,19,0
MA 236,52,108
E 71
MA 240,56,104
T 46,19,4
CV 101,70
MA 244,56,108
E 72
MA 248,60,104
T 48,20,0
MA 252,60,108
E 73
MD 120,52,104
T 50,20,4
T 52,21,0
MD 124,52,108
CV 98,72
E 74
ZB 80,0,224
T 54,21,4
ZB 84,0,228
E 75
MB 80,4,232
T 56,22,0
CV 99,74
MB 84,4,236
E 76
MB 80,8,240
T 58,22,4
T 60,23,0
MB 84,8,244
E 77
MB 80,12,248
W 14
T 62,23,4
CV 102,76
MB 84,12,252
E 78
ZB 88,16,224
E 79
ZB 92,16,228
MB 88,20,232
CV 103,78
MB 92,20,236
MB 88,24,240
E 80
MB 92,24,244
MB 88,28,248
E 81
MB 92,28,252
W 12
MA 128,32,96
s_waitcnt vmcnt(8) lgkmcnt(0)
s_barrier
R a,0,8,16
MA 132,32,100
CV 104,80
E 82
MA 136,36,96
R a,4,9,16
MA 140,36,100
E 83
MA 144,40,96
R a,8,10,16
CV 105,82
MA 148,40,100
E 84
MA 152,44,96
R a,12,11,16
MA 156,44,100
E 85
MA 160,48,96
R a,16,8,20
CV 108,84
MA 164,48,100
E 86
MA 168,52,96
R a,20,9,20
MA 172,52,100
E 87
MA 176,56,96
R a,24,10,20
CV 109,86
MA 180,56,100
E 88
MA 184,60,96
R a,28,11,20
MA 188,60,100
E 89
MD 112,52,96
CV 106,88
E 90
MD 116,52,100
s_xor_b32 m0, s65, 0x10000
s_xor_b32 s66, s64, 0x5000
W 6
ZB 64,0,192
G 48,48,66,0,nt
ZB 68,0,196
E 91
MB 64,4,200
CV 107,90
MB 68,4,204
E 92
W 4
MB 64,8,208
G 49,48,66,1,nt
MB 68,8,212
E 93
MB 64,12,216
CV 110,92
MB 68,12,220
E 94
W 2
ZB 72,16,192
G 50,48,66,2,nt
ZB 76,16,196
E 95
MB 72,20,200
CV 111,94
MB 76,20,204
W 0
MB 72,24,208
G 51,48,66,3,nt
MB 76,24,212
E 64
MB 72,28,216
E 65
MB 76,28,220
MA 192,32,104
CV 96,64
MA 196,32,108
E 66
MA 200,36,104
T 32,16,16
MA 204,36,108
E 67
MA 208,40,104
T 34,16,20
T 36,17,16
MA 212,40,108
CV 97,66
E 68
MA 216,44,104
T 38,17,20
MA 220,44,108
E 69
MA 224,48,104
T 40,18,16
CV 100,68
MA 228,48,108
E 70
MA 232,52,104
T 42,18,20
T 44,19,16
MA 236,52,108
E 71
MA 240,56,104
T 46,19,20
CV 101,70
MA 244,56,108
E 72
MA 248,60,104
T 48,20,16
MA 252,60,108
E 73
MD 120,52,104
T 50,20,20
T 52,21,16
MD 124,52,108
CV 98,72
E 74
ZB 80,0,224
T 54,21,20
ZB 84,0,228
E 75
MB 80,4,232
T 56,22,16
CV 99,74
MB 84,4,236
E 76
MB 80,8,240
T 58,22,20
T 60,23,16
MB 84,8,244
E 77
MB 80,12,248
W 14
T 62,23,20
CV 102,76
MB 84,12,252
E 78
ZB 88,16,224
E 79
ZB 92,16,228
MB 88,20,232
s_xor_b32 s79, s67, 0x1011000
MB 92,20,236
buffer_store_dwordx4 a[100:103], v59, s[52:55], s79 offen sc1
CV 103,78
MB 88,24,240
E 80
MB 92,24,244
MB 88,28,248
s_xor_b32 s79, s67, 0x1022000
buffer_store_dwordx4 a[104:107], v59, s[52:55], s79 offen sc1
MB 92,28,252
E 81
W 12
MA 128,32,96
s_waitcnt vmcnt(10) lgkmcnt(0)
s_barrier
R a,0,8,32
MA 132,32,100
CV 104,80
E 82
MA 136,36,96
R a,4,9,32
MA 140,36,100
E 83
MA 144,40,96
R a,8,10,32
CV 105,82
MA 148,40,100
E 84
MA 152,44,96
R a,12,11,32
MA 156,44,100
E 85
MA 160,48,96
R a,16,8,36
CV 108,84
MA 164,48,100
E 86
MA 168,52,96
R a,20,9,36
MA 172,52,100
E 87
MA 176,56,96
R a,24,10,36
CV 109,86
MA 180,56,100
E 88
MA 184,60,96
R a,28,11,36
MA 188,60,100
E 89
MD 112,52,96
CV 106,88
E 90
MD 116,52,100
s_xor_b32 m0, s65, 0x14000
s_xor_b32 s66, s64, 0x15000
W 6
ZB 64,0,192
G 48,48,66,0,nt
ZB 68,0,196
E 91
MB 64,4,200
CV 107,90
MB 68,4,204
E 92
W 4
MB 64,8,208
G 49,48,66,1,nt
MB 68,8,212
E 93
MB 64,12,216
CV 110,92
MB 68,12,220
E 94
W 2
ZB 72,16,192
G 50,48,66,2,nt
ZB 76,16,196
E 95
MB 72,20,200
CV 111,94
MB 76,20,204
W 0
MB 72,24,208
G 51,48,66,3,nt
MB 76,24,212
E 64
MB 72,28,216
E 65
MB 76,28,220
MA 192,32,104
CV 96,64
MA 196,32,108
E 66
MA 200,36,104
T 32,16,32
MA 204,36,108
E 67
MA 208,40,104
T 34,16,36
T 36,17,32
MA 212,40,108
CV 97,66
E 68
MA 216,44,104
T 38,17,36
MA 220,44,108
E 69
MA 224,48,104
T 40,18,32
CV 100,68
MA 228,48,108
E 70
MA 232,52,104
T 42,18,36
T 44,19,32
MA 236,52,108
E 71
MA 240,56,104
T 46,19,36
CV 101,70
MA 244,56,108
E 72
MA 248,60,104
T 48,20,32
MA 252,60,108
E 73
MD 120,52,104
T 50,20,36
T 52,21,32
MD 124,52,108
CV 98,72
E 74
ZB 80,0,224
T 54,21,36
ZB 84,0,228
E 75
MB 80,4,232
T 56,22,32
CV 99,74
MB 84,4,236
E 76
MB 80,8,240
T 58,22,36
T 60,23,32
MB 84,8,244
E 77
MB 80,12,248
W 14
T 62,23,36
CV 102,76
MB 84,12,252
E 78
ZB 88,16,224
E 79
ZB 92,16,228
MB 88,20,232
s_xor_b32 s79, s67, 0x1033000
MB 92,20,236
buffer_store_dwordx4 a[108:111], v59, s[52:55], s79 offen sc1
CV 103,78
MB 88,24,240
E 80
MB 92,24,244
MB 88,28,248
s_xor_b32 s79, s67, 0x1044000
buffer_store_dwordx4 a[112:115], v59, s[52:55], s79 offen sc1
MB 92,28,252
E 81
W 12
MA 128,32,96
s_waitcnt vmcnt(12) lgkmcnt(0)
s_barrier
R a,0,8,48
MA 132,32,100
CV 104,80
E 82
MA 136,36,96
R a,4,9,48
MA 140,36,100
E 83
MA 144,40,96
R a,8,10,48
CV 105,82
MA 148,40,100
E 84
MA 152,44,96
R a,12,11,48
MA 156,44,100
E 85
MA 160,48,96
R a,16,8,52
CV 108,84
MA 164,48,100
E 86
MA 168,52,96
R a,20,9,52
MA 172,52,100
E 87
MA 176,56,96
R a,24,10,52
CV 109,86
MA 180,56,100
E 88
MA 184,60,96
R a,28,11,52
MA 188,60,100
E 89
MD 112,52,96
CV 106,88
E 90
MD 116,52,100
s_xor_b32 m0, s65, 0x18000
s_xor_b32 s66, s64, 0x7000
W 6
ZB 64,0,192
G 48,48,66,0,nt
ZB 68,0,196
E 91
MB 64,4,200
CV 107,90
MB 68,4,204
E 92
W 4
MB 64,8,208
G 49,48,66,1,nt
MB 68,8,212
E 93
MB 64,12,216
CV 110,92
MB 68,12,220
E 94
W 2
ZB 72,16,192
G 50,48,66,2,nt
ZB 76,16,196
E 95
MB 72,20,200
CV 111,94
MB 76,20,204
W 0
MB 72,24,208
G 51,48,66,3,nt
MB 76,24,212
E 64
MB 72,28,216
E 65
MB 76,28,220
MA 192,32,104
CV 96,64
MA 196,32,108
E 66
MA 200,36,104
T 32,16,48
MA 204,36,108
E 67
MA 208,40,104
T 34,16,52
T 36,17,48
MA 212,40,108
CV 97,66
E 68
MA 216,44,104
T 38,17,52
MA 220,44,108
E 69
MA 224,48,104
T 40,18,48
CV 100,68
MA 228,48,108
E 70
MA 232,52,104
T 42,18,52
T 44,19,48
MA 236,52,108
E 71
MA 240,56,104
T 46,19,52
CV 101,70
MA 244,56,108
E 72
MA 248,60,104
T 48,20,48
MA 252,60,108
E 73
MD 120,52,104
T 50,20,52
T 52,21,48
MD 124,52,108
CV 98,72
E 74
ZB 80,0,224
T 54,21,52
ZB 84,0,228
E 75
MB 80,4,232
T 56,22,48
CV 99,74
MB 84,4,236
E 76
MB 80,8,240
T 58,22,52
T 60,23,48
MB 84,8,244
E 77
MB 80,12,248
W 14
T 62,23,52
CV 102,76
MB 84,12,252
E 78
ZB 88,16,224
E 79
ZB 92,16,228
MB 88,20,232
s_xor_b32 s79, s67, 0x1055000
MB 92,20,236
buffer_store_dwordx4 a[116:119], v59, s[52:55], s79 offen sc1
CV 103,78
MB 88,24,240
E 80
MB 92,24,244
MB 88,28,248
s_xor_b32 s79, s67, 0x1066000
buffer_store_dwordx4 a[120:123], v59, s[52:55], s79 offen sc1
MB 92,28,252
E 81
W 12
MA 128,32,96
s_waitcnt vmcnt(14) lgkmcnt(0)
s_barrier
R a,0,12,0
MA 132,32,100
CV 104,80
E 82
MA 136,36,96
R a,4,13,0
MA 140,36,100
E 83
MA 144,40,96
R a,8,14,0
CV 105,82
MA 148,40,100
E 84
MA 152,44,96
R a,12,15,0
MA 156,44,100
E 85
MA 160,48,96
R a,16,12,4
CV 108,84
MA 164,48,100
E 86
MA 168,52,96
R a,20,13,4
MA 172,52,100
E 87
MA 176,56,96
R a,24,14,4
CV 109,86
MA 180,56,100
E 88
MA 184,60,96
R a,28,15,4
MA 188,60,100
E 89
MD 112,52,96
CV 106,88
E 90
MD 116,52,100
s_xor_b32 m0, s65, 0x1c000
s_xor_b32 s66, s64, 0x17000
W 6
ZB 64,0,192
G 48,48,66,0,nt
ZB 68,0,196
E 91
MB 64,4,200
CV 107,90
MB 68,4,204
E 92
W 4
MB 64,8,208
G 49,48,66,1,nt
MB 68,8,212
E 93
MB 64,12,216
CV 110,92
MB 68,12,220
E 94
W 2
ZB 72,16,192
G 50,48,66,2,nt
ZB 76,16,196
E 95
MB 72,20,200
CV 111,94
MB 76,20,204
W 0
MB 72,24,208
G 51,48,66,3,nt
MB 76,24,212
E 64
MB 72,28,216
E 65
MB 76,28,220
s_xor_b32 m0, s65, 0x0
s_xor_b32 s66, s62, 0x0
MA 192,32,104
G 44,24,66,0
MA 196,32,108
CV 96,64
E 66
MA 200,36,104
T 32,24,0
MA 204,36,108
E 67
MA 208,40,104
G 45,24,66,1
T 34,24,4
MA 212,40,108
T 36,25,0
CV 97,66
E 68
MA 216,44,104
T 38,25,4
MA 220,44,108
E 69
MA 224,48,104
G 46,24,66,2
T 40,26,0
MA 228,48,108
CV 100,68
E 70
MA 232,52,104
T 42,26,4
T 44,27,0
MA 236,52,108
E 71
MA 240,56,104
G 47,24,66,3
T 46,27,4
MA 244,56,108
CV 101,70
E 72
MA 248,60,104
T 48,28,0
MA 252,60,108
E 73
MD 120,52,104
T 50,28,4
T 52,29,0
MD 124,52,108
CV 98,72
E 74
ZB 80,0,224
T 54,29,4
ZB 84,0,228
E 75
MB 80,4,232
T 56,30,0
CV 99,74
MB 84,4,236
E 76
MB 80,8,240
T 58,30,4
T 60,31,0
MB 84,8,244
E 77
MB 80,12,248
W 14
T 62,31,4
CV 102,76
MB 84,12,252
E 78
ZB 88,16,224
E 79
ZB 92,16,228
MB 88,20,232
s_xor_b32 s79, s67, 0x1077000
MB 92,20,236
buffer_store_dwordx4 a[124:127], v59, s[52:55], s79 offen sc1
CV 103,78
MB 88,24,240
E 80
MB 92,24,244
MB 88,28,248
s_xor_b32 s79, s67, 0x1019000
buffer_store_dwordx4 a[68:71], v59, s[52:55], s79 offen sc1
MB 92,28,252
E 81
W 12
MA 128,32,96
s_waitcnt vmcnt(18) lgkmcnt(0)
s_barrier
R a,0,12,16
MA 132,32,100
CV 104,80
E 82
MA 136,36,96
R a,4,13,16
MA 140,36,100
E 83
MA 144,40,96
R a,8,14,16
CV 105,82
MA 148,40,100
E 84
MA 152,44,96
R a,12,15,16
MA 156,44,100
E 85
MA 160,48,96
R a,16,12,20
CV 108,84
MA 164,48,100
E 86
MA 168,52,96
R a,20,13,20
MA 172,52,100
E 87
MA 176,56,96
R a,24,14,20
CV 109,86
MA 180,56,100
E 88
MA 184,60,96
R a,28,15,20
MA 188,60,100
E 89
MD 112,52,96
CV 106,88
E 90
MD 116,52,100
s_xor_b32 m0, s65, 0x4000
s_xor_b32 s66, s62, 0x8000
W 6
ZB 64,0,192
G 44,24,66,0
ZB 68,0,196
E 91
MB 64,4,200
CV 107,90
MB 68,4,204
E 92
W 4
MB 64,8,208
G 45,24,66,1
MB 68,8,212
E 93
MB 64,12,216
CV 110,92
MB 68,12,220
E 94
W 2
ZB 72,16,192
G 46,24,66,2
ZB 76,16,196
E 95
MB 72,20,200
CV 111,94
MB 76,20,204
W 0
MB 72,24,208
G 47,24,66,3
MB 76,24,212
E 64
MB 72,28,216
E 65
MB 76,28,220
s_xor_b32 m0, s65, 0x8000
s_xor_b32 s66, s62, 0x10000
MA 192,32,104
G 44,24,66,0
MA 196,32,108
CV 96,64
E 66
MA 200,36,104
T 32,24,16
MA 204,36,108
E 67
MA 208,40,104
G 45,24,66,1
T 34,24,20
MA 212,40,108
T 36,25,16
CV 97,66
E 68
MA 216,44,104
T 38,25,20
MA 220,44,108
E 69
MA 224,48,104
G 46,24,66,2
T 40,26,16
MA 228,48,108
CV 100,68
E 70
MA 232,52,104
T 42,26,20
T 44,27,16
MA 236,52,108
E 71
MA 240,56,104
G 47,24,66,3
T 46,27,20
MA 244,56,108
CV 101,70
E 72
MA 248,60,104
T 48,28,16
MA 252,60,108
E 73
MD 120,52,104
T 50,28,20
T 52,29,16
MD 124,52,108
CV 98,72
E 74
ZB 80,0,224
T 54,29,20
ZB 84,0,228
E 75
MB 80,4,232
T 56,30,16
CV 99,74
MB 84,4,236
E 76
MB 80,8,240
T 58,30,20
T 60,31,16
MB 84,8,244
E 77
MB 80,12,248
W 14
T 62,31,20
CV 102,76
MB 84,12,252
E 78
ZB 88,16,224
E 79
ZB 92,16,228
MB 88,20,232
s_xor_b32 s79, s67, 0x102a000
MB 92,20,236
buffer_store_dwordx4 a[72:75], v59, s[52:55], s79 offen sc1
CV 103,78
MB 88,24,240
E 80
MB 92,24,244
MB 88,28,248
s_xor_b32 s79, s67, 0x103b000
buffer_store_dwordx4 a[76:79], v59, s[52:55], s79 offen sc1
MB 92,28,252
E 81
W 12
MA 128,32,96
s_waitcnt vmcnt(22) lgkmcnt(0)
s_barrier
R a,0,12,32
MA 132,32,100
CV 104,80
E 82
MA 136,36,96
R a,4,13,32
MA 140,36,100
E 83
MA 144,40,96
R a,8,14,32
CV 105,82
MA 148,40,100
E 84
MA 152,44,96
R a,12,15,32
MA 156,44,100
E 85
MA 160,48,96
R a,16,12,36
CV 108,84
MA 164,48,100
E 86
MA 168,52,96
R a,20,13,36
MA 172,52,100
E 87
MA 176,56,96
R a,24,14,36
CV 109,86
MA 180,56,100
E 88
MA 184,60,96
R a,28,15,36
MA 188,60,100
E 89
MD 112,52,96
CV 106,88
E 90
MD 116,52,100
s_xor_b32 m0, s65, 0xc000
s_xor_b32 s66, s62, 0x18000
W 6
ZB 64,0,192
G 44,24,66,0
ZB 68,0,196
E 91
MB 64,4,200
CV 107,90
MB 68,4,204
E 92
W 4
MB 64,8,208
G 45,24,66,1
MB 68,8,212
E 93
MB 64,12,216
CV 110,92
MB 68,12,220
E 94
W 2
ZB 72,16,192
G 46,24,66,2
ZB 76,16,196
E 95
MB 72,20,200
CV 111,94
MB 76,20,204
W 0
MB 72,24,208
G 47,24,66,3
MB 76,24,212
E 64
MB 72,28,216
E 65
MB 76,28,220
s_xor_b32 m0, s65, 0x10000
s_xor_b32 s66, s62, 0x20000
MA 192,32,104
G 44,24,66,0
MA 196,32,108
CV 96,64
E 66
MA 200,36,104
T 32,24,32
MA 204,36,108
E 67
MA 208,40,104
G 45,24,66,1
T 34,24,36
MA 212,40,108
T 36,25,32
CV 97,66
E 68
MA 216,44,104
T 38,25,36
MA 220,44,108
E 69
MA 224,48,104
G 46,24,66,2
T 40,26,32
MA 228,48,108
CV 100,68
E 70
MA 232,52,104
T 42,26,36
T 44,27,32
MA 236,52,108
E 71
MA 240,56,104
G 47,24,66,3
T 46,27,36
MA 244,56,108
CV 101,70
E 72
MA 248,60,104
T 48,28,32
MA 252,60,108
E 73
MD 120,52,104
T 50,28,36
T 52,29,32
MD 124,52,108
CV 98,72
E 74
ZB 80,0,224
T 54,29,36
ZB 84,0,228
E 75
MB 80,4,232
T 56,30,32
CV 99,74
MB 84,4,236
E 76
MB 80,8,240
T 58,30,36
T 60,31,32
MB 84,8,244
E 77
MB 80,12,248
W 14
T 62,31,36
CV 102,76
MB 84,12,252
E 78
ZB 88,16,224
E 79
ZB 92,16,228
MB 88,20,232
s_xor_b32 s79, s67, 0x104c000
MB 92,20,236
buffer_store_dwordx4 a[80:83], v59, s[52:55], s79 offen sc1
CV 103,78
MB 88,24,240
E 80
MB 92,24,244
MB 88,28,248
s_xor_b32 s79, s67, 0x105d000
buffer_store_dwordx4 a[84:87], v59, s[52:55], s79 offen sc1
MB 92,28,252
E 81
W 12
MA 128,32,96
s_waitcnt vmcnt(26) lgkmcnt(0)
s_barrier
R a,0,12,48
MA 132,32,100
CV 104,80
E 82
MA 136,36,96
R a,4,13,48
MA 140,36,100
E 83
MA 144,40,96
R a,8,14,48
CV 105,82
MA 148,40,100
E 84
MA 152,44,96
R a,12,15,48
MA 156,44,100
E 85
MA 160,48,96
R a,16,12,52
CV 108,84
MA 164,48,100
E 86
MA 168,52,96
R a,20,13,52
MA 172,52,100
E 87
MA 176,56,96
R a,24,14,52
CV 109,86
MA 180,56,100
E 88
MA 184,60,96
R a,28,15,52
MA 188,60,100
E 89
MD 112,52,96
CV 106,88
E 90
MD 116,52,100
s_xor_b32 m0, s65, 0x14000
s_xor_b32 s66, s62, 0x28000
W 6
ZB 64,0,192
G 44,24,66,0
ZB 68,0,196
E 91
MB 64,4,200
CV 107,90
MB 68,4,204
E 92
W 4
MB 64,8,208
G 45,24,66,1
MB 68,8,212
E 93
MB 64,12,216
CV 110,92
MB 68,12,220
E 94
W 2
ZB 72,16,192
G 46,24,66,2
ZB 76,16,196
E 95
MB 72,20,200
CV 111,94
MB 76,20,204
W 0
MB 72,24,208
G 47,24,66,3
MB 76,24,212
E 64
MB 72,28,216
E 65
MB 76,28,220
MA 192,32,104
CV 96,64
MA 196,32,108
E 66
MA 200,36,104
T 32,24,48
MA 204,36,108
E 67
MA 208,40,104
T 34,24,52
T 36,25,48
MA 212,40,108
CV 97,66
E 68
MA 216,44,104
T 38,25,52
MA 220,44,108
E 69
MA 224,48,104
T 40,26,48
CV 100,68
MA 228,48,108
E 70
MA 232,52,104
T 42,26,52
T 44,27,48
MA 236,52,108
E 71
MA 240,56,104
T 46,27,52
CV 101,70
MA 244,56,108
E 72
MA 248,60,104
T 48,28,48
MA 252,60,108
E 73
MD 120,52,104
T 50,28,52
T 52,29,48
MD 124,52,108
CV 98,72
E 74
ZB 80,0,224
T 54,29,52
ZB 84,0,228
E 75
MB 80,4,232
T 56,30,48
CV 99,74
MB 84,4,236
E 76
MB 80,8,240
T 58,30,52
T 60,31,48
MB 84,8,244
E 77
MB 80,12,248
W 14
T 62,31,52
CV 102,76
v_xor_b32 v16, s71, v16
MB 84,12,252
v_xor_b32 v17, s71, v17
E 78
ZB 88,16,224
v_xor_b32 v18, s71, v18
v_xor_b32 v19, s71, v19
ZB 92,16,228
E 79
MB 88,20,232
s_xor_b32 s79, s67, 0x106e000
buffer_store_dwordx4 a[88:91], v59, s[52:55], s79 offen sc1
MB 92,20,236
CV 103,78
v_xor_b32 v20, s71, v20
v_xor_b32 v21, s71, v21
MB 88,24,240
v_xor_b32 v22, s71, v22
v_xor_b32 v23, s71, v23
MB 92,24,244
E 80
MB 88,28,248
s_xor_b32 s79, s67, 0x107f000
buffer_store_dwordx4 a[92:95], v59, s[52:55], s79 offen sc1
MB 92,28,252
v_xor_b32 v24, s71, v24
v_xor_b32 v25, s71, v25
E 81
W 12
MA 128,32,96
CV 104,80
v_xor_b32 v26, s71, v26
MA 132,32,100
v_xor_b32 v27, s71, v27
E 82
MA 136,36,96
v_xor_b32 v28, s71, v28
v_xor_b32 v29, s71, v29
MA 140,36,100
E 83
W 8
MA 144,40,96
CV 105,82
v_xor_b32 v30, s71, v30
MA 148,40,100
v_xor_b32 v31, s71, v31
E 84
MA 152,44,96
E 85
MA 156,44,100
W 4
MA 160,48,96
CV 108,84
MA 164,48,100
E 86
MA 168,52,96
E 87
MA 172,52,100
W 0
MA 176,56,96
CV 109,86
MA 180,56,100
E 88
MA 184,60,96
E 89
MA 188,60,100
MD 112,52,96
CV 106,88
MD 116,52,100
E 90
E 91
s_nop 0
CV 107,90
E 92
E 93
s_nop 0
CV 110,92
E 94
E 95
s_nop 0
CV 111,94
MA 192,32,104
s_nop 0
MA 196,32,108
MA 200,36,104
MA 204,36,108
MA 208,40,104
MA 212,40,108
MA 216,44,104
MA 220,44,108
MA 224,48,104
s_waitcnt vmcnt(28)
s_barrier
T 0,16,0
MA 228,48,108
T 2,16,4
s_xor_b32 m0, s65, 0x18000
s_xor_b32 s66, s62, 0x30000
MA 232,52,104
G 44,24,66,0
MA 236,52,108
T 4,17,0
T 6,17,4
MA 240,56,104
T 8,18,0
MA 244,56,108
T 10,18,4
MA 248,60,104
G 45,24,66,1
MA 252,60,108
T 12,19,0
T 14,19,4
MD 120,52,104
T 16,20,0
MD 124,52,108
T 18,20,4
v_mov_b32 v60, v112
v_mov_b32 v61, v116
v_cmp_nle_f32 vcc, s76, v60
v_cmp_nge_f32 s[82:83], s77, v60
v_cmp_nle_f32 s[84:85], s76, v61
v_cmp_nge_f32 s[90:91], s77, v61
s_nop 1
s_or_b64 vcc, vcc, s[82:83]
s_or_b64 vcc, vcc, s[84:85]
s_or_b64 vcc, vcc, s[90:91]
s_cbranch_scc1 L_slow_c0A0
L_back_c0A0:
v_rcp_f32 v0, v60
v_rcp_f32 v1, v61
s_nop 0
v_pk_mul_f32 v[128:129], v[128:129], v[0:1] op_sel_hi:[1,0]
v_pk_mul_f32 v[130:131], v[130:131], v[0:1] op_sel_hi:[1,0]
v_pk_mul_f32 v[132:133], v[132:133], v[0:1] op_sel:[0,1]
v_pk_mul_f32 v[134:135], v[134:135], v[0:1] op_sel:[0,1]
v_pk_mul_f32 v[136:137], v[136:137], v[0:1] op_sel_hi:[1,0]
v_pk_mul_f32 v[138:139], v[138:139], v[0:1] op_sel_hi:[1,0]
v_pk_mul_f32 v[140:141], v[140:141], v[0:1] op_sel:[0,1]
v_pk_mul_f32 v[142:143], v[142:143], v[0:1] op_sel:[0,1]
CV 128,128
CV 130,130
CV 132,132
CV 134,134
CV 136,136
CV 138,138
CV 140,140
CV 142,142
AW 192,128
AW 193,130
AW 196,132
AW 197,134
AW 194,136
AW 195,138
AW 198,140
AW 199,142
v_pk_mul_f32 v[144:145], v[144:145], v[0:1] op_sel_hi:[1,0]
v_pk_mul_f32 v[146:147], v[146:147], v[0:1] op_sel_hi:[1,0]
v_pk_mul_f32 v[148:149], v[148:149], v[0:1] op_sel:[0,1]
v_pk_mul_f32 v[150:151], v[150:151], v[0:1] op_sel:[0,1]
v_pk_mul_f32 v[152:153], v[152:153], v[0:1] op_sel_hi:[1,0]
v_pk_mul_f32 v[154:155], v[154:155], v[0:1] op_sel_hi:[1,0]
v_pk_mul_f32 v[156:157], v[156:157], v[0:1] op_sel:[0,1]
v_pk_mul_f32 v[158:159], v[158:159], v[0:1] op_sel:[0,1]
CV 144,144
CV 146,146
CV 148,148
CV 150,150
CV 152,152
CV 154,154
CV 156,156
CV 158,158
AW 200,144
AW 201,146
AW 204,148
AW 205,150
AW 202,152
AW 203,154
AW 206,156
AW 207,158
v_pk_mul_f32 v[160:161], v[160:161], v[0:1] op_sel_hi:[1,0]
v_pk_mul_f32 v[162:163], v[162:163], v[0:1] op_sel_hi:[1,0]
v_pk_mul_f32 v[164:165], v[164:165], v[0:1] op_sel:[0,1]
v_pk_mul_f32 v[166:167], v[166:167], v[0:1] op_sel:[0,1]
v_pk_mul_f32 v[168:169], v[168:169], v[0:1] op_sel_hi:[1,0]
v_pk_mul_f32 v[170:171], v[170:171], v[0:1] op_sel_hi:[1,0]
v_pk_mul_f32 v[172:173], v[172:173], v[0:1] op_sel:[0,1]
v_pk_mul_f32 v[174:175], v[174:175], v[0:1] op_sel:[0,1]
CV 160,160
CV 162,162
CV 164,164
CV 166,166
CV 168,168
CV 170,170
CV 172,172
CV 174,174
AW 208,160
AW 209,162
AW 212,164
AW 213,166
AW 210,168
AW 211,170
AW 214,172
AW 215,174
v_pk_mul_f32 v[176:177], v[176:177], v[0:1] op_sel_hi:[1,0]
v_pk_mul_f32 v[178:179], v[178:179], v[0:1] op_sel_hi:[1,0]
v_pk_mul_f32 v[180:181], v[180:181], v[0:1] op_sel:[0,1]
v_pk_mul_f32 v[182:183], v[182:183], v[0:1] op_sel:[0,1]
v_pk_mul_f32 v[184:185], v[184:185], v[0:1] op_sel_hi:[1,0]
v_pk_mul_f32 v[186:187], v[186:187], v[0:1] op_sel_hi:[1,0]
v_pk_mul_f32 v[188:189], v[188:189], v[0:1] op_sel:[0,1]
v_pk_mul_f32 v[190:191], v[190:191], v[0:1] op_sel:[0,1]
CV 176,176
CV 178,178
CV 180,180
CV 182,182
CV 184,184
CV 186,186
CV 188,188
CV 190,190
AW 216,176
AW 217,178
AW 220,180
AW 221,182
AW 218,184
AW 219,186
AW 222,188
AW 223,190
v_mov_b32 v60, v120
v_mov_b32 v61, v124
v_cmp_nle_f32 vcc, s76, v60
v_cmp_nge_f32 s[82:83], s77, v60
v_cmp_nle_f32 s[84:85], s76, v61
v_cmp_nge_f32 s[90:91], s77, v61
s_nop 1
s_or_b64 vcc, vcc, s[82:83]
s_or_b64 vcc, vcc, s[84:85]
s_or_b64 vcc, vcc, s[90:91]
s_cbranch_scc1 L_slow_c0A1
L_back_c0A1:
v_rcp_f32 v0, v60
v_rcp_f32 v1, v61
s_nop 0
v_pk_mul_f32 v[192:193], v[192:193], v[0:1] op_sel_hi:[1,0]
v_pk_mul_f32 v[194:195], v[194:195], v[0:1] op_sel_hi:[1,0]
v_pk_mul_f32 v[196:197], v[196:197], v[0:1] op_sel:[0,1]
v_pk_mul_f32 v[198:199], v[198:199], v[0:1] op_sel:[0,1]
v_pk_mul_f32 v[200:201], v[200:201], v[0:1] op_sel_hi:[1,0]
v_pk_mul_f32 v[202:203], v[202:203], v[0:1] op_sel_hi:[1,0]
v_pk_mul_f32 v[204:205], v[204:205], v[0:1] op_sel:[0,1]
v_pk_mul_f32 v[206:207], v[206:207], v[0:1] op_sel:[0,1]
CV 192,192
CV 194,194
CV 196,196
CV 198,198
CV 200,200
CV 202,202
CV 204,204
CV 206,206
AW 224,192
AW 225,194
AW 228,196
AW 229,198
AW 226,200
AW 227,202
AW 230,204
AW 231,206
v_pk_mul_f32 v[208:209], v[208:209], v[0:1] op_sel_hi:[1,0]
v_pk_mul_f32 v[210:211], v[210:211], v[0:1] op_sel_hi:[1,0]
v_pk_mul_f32 v[212:213], v[212:213], v[0:1] op_sel:[0,1]
v_pk_mul_f32 v[214:215], v[214:215], v[0:1] op_sel:[0,1]
v_pk_mul_f32 v[216:217], v[216:217], v[0:1] op_sel_hi:[1,0]
v_pk_mul_f32 v[218:219], v[218:219], v[0:1] op_sel_hi:[1,0]
v_pk_mul_f32 v[220:221], v[220:221], v[0:1] op_sel:[0,1]
v_pk_mul_f32 v[222:223], v[222:223], v[0:1] op_sel:[0,1]
CV 208,208
CV 210,210
CV 212,212
CV 214,214
CV 216,216
CV 218,218
CV 220,220
CV 222,222
AW 232,208
AW 233,210
AW 236,212
AW 237,214
AW 234,216
AW 235,218
AW 238,220
AW 239,222
v_pk_mul_f32 v[224:225], v[224:225], v[0:1] op_sel_hi:[1,0]
v_pk_mul_f32 v[226:227], v[226:227], v[0:1] op_sel_hi:[1,0]
v_pk_mul_f32 v[228:229], v[228:229], v[0:1] op_sel:[0,1]
v_pk_mul_f32 v[230:231], v[230:231], v[0:1] op_sel:[0,1]
v_pk_mul_f32 v[232:233], v[232:233], v[0:1] op_sel_hi:[1,0]
v_pk_mul_f32 v[234:235], v[234:235], v[0:1] op_sel_hi:[1,0]
v_pk_mul_f32 v[236:237], v[236:237], v[0:1] op_sel:[0,1]
v_pk_mul_f32 v[238:239], v[238:239], v[0:1] op_sel:[0,1]
CV 224,224
CV 226,226
CV 228,228
CV 230,230
CV 232,232
CV 234,234
CV 236,236
CV 238,238
AW 240,224
AW 241,226
AW 244,228
AW 245,230
AW 242,232
AW 243,234
AW 246,236
AW 247,238
v_pk_mul_f32 v[240:241], v[240:241], v[0:1] op_sel_hi:[1,0]
v_pk_mul_f32 v[242:243], v[242:243], v[0:1] op_sel_hi:[1,0]
v_pk_mul_f32 v[244:245], v[244:245], v[0:1] op_sel:[0,1]
v_pk_mul_f32 v[246:247], v[246:247], v[0:1] op_sel:[0,1]
v_pk_mul_f32 v[248:249], v[248:249], v[0:1] op_sel_hi:[1,0]
v_pk_mul_f32 v[250:251], v[250:251], v[0:1] op_sel_hi:[1,0]
v_pk_mul_f32 v[252:253], v[252:253], v[0:1] op_sel:[0,1]
v_pk_mul_f32 v[254:255], v[254:255], v[0:1] op_sel:[0,1]
CV 240,240
CV 242,242
CV 244,244
CV 246,246
CV 248,248
CV 250,250
CV 252,252
CV 254,254
AW 248,240
AW 249,242
AW 252,244
AW 253,246
AW 250,248
AW 251,250
AW 254,252
AW 255,254
W 6
ZB 128,0,192
G 46,24,66,2
ZB 132,0,196
T 20,21,0
T 22,21,4
ds_write_b128 v58, a[192:195] offset:0
ZB 136,4,192
T 24,22,0
ZB 140,4,196
T 26,22,4
ds_write_b128 v58, a[196:199] offset:1024
W 8
ZB 144,8,192
G 47,24,66,3
ZB 148,8,196
T 28,23,0
T 30,23,4
ds_write_b128 v58, a[200:203] offset:2048
ZB 152,12,192
s_waitcnt vmcnt(26) lgkmcnt(0)
s_barrier
ZB 156,12,196
T 32,16,16
T 34,16,20
ds_write_b128 v58, a[204:207] offset:3072
ZB 160,16,192
T 36,17,16
ZB 164,16,196
T 38,17,20
ds_write_b128 v58, a[208:211] offset:4096
ZB 168,20,192
T 40,18,16
ZB 172,20,196
T 42,18,20
ds_write_b128 v58, a[212:215] offset:5120
ZB 176,24,192
T 44,19,16
ZB 180,24,196
T 46,19,20
ds_write_b128 v58, a[216:219] offset:6144
ZB 184,28,192
T 48,20,16
ZB 188,28,196
T 50,20,20
ds_write_b128 v58, a[220:223] offset:7168
W 10
MB 128,32,200
T 52,21,16
MB 132,32,204
T 54,21,20
MB 136,36,200
T 56,22,16
MB 140,36,204
T 58,22,20
W 8
MB 144,40,200
T 60,23,16
MB 148,40,204
T 62,23,20
MB 152,44,200
s_waitcnt vmcnt(22) lgkmcnt(6)
s_barrier
T 0,16,32
MB 156,44,204
T 2,16,36
R a,128,2,0
s_xor_b32 m0, s65, 0x1c000
s_xor_b32 s66, s62, 0x38000
MB 160,48,200
G 44,24,66,0
MB 164,48,204
T 4,17,32
T 6,17,36
R a,132,2,1
v_mov_b32 v61, 1
v_mov_b32 v62, 0
s_mov_b64 exec, 1
buffer_store_dword v61, v62, s[52:55], s5 offen offset:256 sc1
s_mov_b64 exec, -1
W 10
MB 168,52,200
T 8,18,32
MB 172,52,204
T 10,18,36
R a,136,2,2
W 9
MB 176,56,200
G 45,24,66,1
MB 180,56,204
T 12,19,32
T 14,19,36
R a,140,2,3
MB 184,60,200
T 16,20,32
MB 188,60,204
T 18,20,36
R a,144,2,4
W 10
MB 128,0,208
G 46,24,66,2
MB 132,0,212
T 20,21,32
T 22,21,36
R a,148,2,5
s_waitcnt vmcnt(8)
v_mov_b32 v61, 1
v_mov_b32 v62, 0
s_mov_b64 exec, 1
buffer_store_dword v61, v62, s[52:55], s5 offen offset:384 sc1
s_mov_b64 exec, -1
MB 136,4,208
T 24,22,32
MB 140,4,212
T 26,22,36
W 14
R a,152,2,6
W 10
MB 144,8,208
G 47,24,66,3
MB 148,8,212
T 28,23,32
T 30,23,36
R a,156,2,7
MB 152,12,208
s_barrier
T 32,16,48
MB 156,12,212
T 34,16,52
s_xor_b32 m0, s65, 0x0
s_xor_b32 s66, s62, 0x100
W 9
MB 160,16,208
G 44,24,66,0
MB 164,16,212
T 36,17,48
T 38,17,52
s_getpc_b64 s[88:89]
L_ct0_1923:
s_and_b32 s89, s89, 0xffff
s_mov_b32 s90, L_code_end-L_ct0_1923
s_mov_b32 s91, 0x20000
v_and_b32 v62, 0x70, v59
v_lshlrev_b32 v62, 3, v62
s_add_u32 s7, s1, 4096
buffer_load_dword v3, v62, s[88:91], s7 offen
MB 168,20,208
T 40,18,48
MB 172,20,212
T 42,18,52
W 7
MB 176,24,208
G 45,24,66,1
MB 180,24,212
T 44,19,48
T 46,19,52
MB 184,28,208
T 48,20,48
MB 188,28,212
T 50,20,52
W 6
MB 128,32,216
G 46,24,66,2
MB 132,32,220
T 52,21,48
T 54,21,52
MB 136,36,216
T 56,22,48
MB 140,36,220
T 58,22,52
W 6
MB 144,40,216
G 47,24,66,3
MB 148,40,220
T 60,23,48
T 62,23,52
MB 152,44,216
s_barrier
T 0,24,0
MB 156,44,220
T 2,24,4
s_xor_b32 m0, s65, 0x4000
s_xor_b32 s66, s62, 0x8100
W 6
MB 160,48,216
G 44,24,66,0
MB 164,48,220
T 4,25,0
T 6,25,4
MB 168,52,216
T 8,26,0
MB 172,52,220
T 10,26,4
W 6
MB 176,56,216
G 45,24,66,1
MB 180,56,220
T 12,27,0
T 14,27,4
MB 184,60,216
T 16,28,0
MB 188,60,220
T 18,28,4
W 6
MB 128,0,128
G 46,24,66,2
MB 132,0,132
T 20,29,0
T 22,29,4
MB 136,4,128
T 24,30,0
MB 140,4,132
T 26,30,4
W 6
MB 144,8,128
G 47,24,66,3
MB 148,8,132
T 28,31,0
T 30,31,4
MB 152,12,128
s_barrier
T 32,24,16
MB 156,12,132
T 34,24,20
s_xor_b32 m0, s65, 0x8000
s_xor_b32 s66, s62, 0x10100
W 6
MB 160,16,128
G 44,24,66,0
MB 164,16,132
T 36,25,16
T 38,25,20
MB 168,20,128
T 40,26,16
MB 172,20,132
T 42,26,20
W 6
MB 176,24,128
G 45,24,66,1
MB 180,24,132
T 44,27,16
T 46,27,20
MB 184,28,128
T 48,28,16
MB 188,28,132
T 50,28,20
W 6
MB 128,32,136
G 46,24,66,2
MB 132,32,140
T 52,29,16
T 54,29,20
MB 136,36,136
T 56,30,16
MB 140,36,140
T 58,30,20
W 6
MB 144,40,136
G 47,24,66,3
MB 148,40,140
T 60,31,16
T 62,31,20
MB 152,44,136
s_waitcnt vmcnt(19)
s_barrier
T 0,24,32
MB 156,44,140
T 2,24,36
s_xor_b32 m0, s65, 0xc000
s_xor_b32 s66, s62, 0x18100
W 6
MB 160,48,136
G 44,24,66,0
MB 164,48,140
T 4,25,32
T 6,25,36
MB 168,52,136
T 8,26,32
MB 172,52,140
T 10,26,36
W 6
MB 176,56,136
G 45,24,66,1
MB 180,56,140
T 12,27,32
T 14,27,36
MB 184,60,136
T 16,28,32
MB 188,60,140
T 18,28,36
W 6
MB 128,0,144
G 46,24,66,2
MB 132,0,148
T 20,29,32
T 22,29,36
MB 136,4,144
T 24,30,32
MB 140,4,148
T 26,30,36
W 6
MB 144,8,144
G 47,24,66,3
MB 148,8,148
T 28,31,32
T 30,31,36
MB 152,12,144
s_waitcnt vmcnt(17)
s_barrier
T 32,24,48
MB 156,12,148
T 34,24,52
s_xor_b32 m0, s65, 0x10000
s_xor_b32 s66, s62, 0x20100
W 6
MB 160,16,144
G 44,24,66,0
MB 164,16,148
T 36,25,48
T 38,25,52
MB 168,20,144
T 40,26,48
MB 172,20,148
T 42,26,52
W 6
MB 176,24,144
G 45,24,66,1
MB 180,24,148
T 44,27,48
T 46,27,52
MB 184,28,144
T 48,28,48
MB 188,28,148
T 50,28,52
W 6
MB 128,32,152
G 46,24,66,2
MB 132,32,156
T 52,29,48
T 54,29,52
MB 136,36,152
T 56,30,48
MB 140,36,156
T 58,30,52
W 6
MB 144,40,152
G 47,24,66,3
MB 148,40,156
T 60,31,48
T 62,31,52
MB 152,44,152
s_waitcnt vmcnt(16)
s_barrier
T 0,16,0
MB 156,44,156
T 2,16,4
s_xor_b32 m0, s65, 0x14000
s_xor_b32 s66, s62, 0x28100
W 6
MB 160,48,152
G 44,24,66,0
MB 164,48,156
T 4,17,0
T 6,17,4
MB 168,52,152
T 8,18,0
MB 172,52,156
T 10,18,4
W 6
MB 176,56,152
G 45,24,66,1
MB 180,56,156
T 12,19,0
T 14,19,4
MB 184,60,152
T 16,20,0
MB 188,60,156
T 18,20,4
W 6
ZB 192,0,192
G 46,24,66,2
ZB 196,0,196
T 20,21,0
T 22,21,4
ZB 200,4,192
T 24,22,0
ZB 204,4,196
T 26,22,4
W 6
ZB 208,8,192
G 47,24,66,3
ZB 212,8,196
T 28,23,0
T 30,23,4
ZB 216,12,192
s_waitcnt vmcnt(16)
s_barrier
T 32,16,16
ZB 220,12,196
T 34,16,20
s_xor_b32 m0, s65, 0x18000
s_xor_b32 s66, s62, 0x30100
W 6
ZB 224,16,192
G 44,24,66,0
ZB 228,16,196
T 36,17,16
T 38,17,20
ZB 232,20,192
T 40,18,16
ZB 236,20,196
T 42,18,20
W 6
ZB 240,24,192
G 45,24,66,1
ZB 244,24,196
T 44,19,16
T 46,19,20
ZB 248,28,192
T 48,20,16
ZB 252,28,196
T 50,20,20
W 6
MB 192,32,200
G 46,24,66,2
MB 196,32,204
T 52,21,16
T 54,21,20
MB 200,36,200
T 56,22,16
MB 204,36,204
T 58,22,20
W 6
MB 208,40,200
G 47,24,66,3
MB 212,40,204
T 60,23,16
T 62,23,20
MB 216,44,200
s_waitcnt vmcnt(16)
s_barrier
T 0,16,32
MB 220,44,204
T 2,16,36
s_xor_b32 m0, s65, 0x1c000
s_xor_b32 s66, s62, 0x38100
W 6
MB 224,48,200
G 44,24,66,0
MB 228,48,204
T 4,17,32
T 6,17,36
MB 232,52,200
T 8,18,32
MB 236,52,204
T 10,18,36
W 6
MB 240,56,200
G 45,24,66,1
MB 244,56,204
T 12,19,32
T 14,19,36
MB 248,60,200
T 16,20,32
MB 252,60,204
T 18,20,36
W 6
MB 192,0,208
G 46,24,66,2
MB 196,0,212
T 20,21,32
T 22,21,36
MB 200,4,208
T 24,22,32
MB 204,4,212
T 26,22,36
W 6
MB 208,8,208
G 47,24,66,3
MB 212,8,212
T 28,23,32
T 30,23,36
MB 216,12,208
s_waitcnt vmcnt(16)
s_barrier
T 32,16,48
MB 220,12,212
T 34,16,52
s_xor_b32 m0, s65, 0x0
s_xor_b32 s66, s62, 0x40000
W 6
MB 224,16,208
G 44,24,66,0
MB 228,16,212
T 36,17,48
T 38,17,52
MB 232,20,208
T 40,18,48
MB 236,20,212
T 42,18,52
W 6
MB 240,24,208
G 45,24,66,1
MB 244,24,212
T 44,19,48
T 46,19,52
MB 248,28,208
T 48,20,48
MB 252,28,212
T 50,20,52
W 6
MB 192,32,216
G 46,24,66,2
MB 196,32,220
T 52,21,48
T 54,21,52
v_mov_b32 v62, 0
buffer_load_dword v4, v62, s[96:99], s87 offen sc1
MB 200,36,216
T 56,22,48
MB 204,36,220
T 58,22,52
W 6
MB 208,40,216
G 47,24,66,3
MB 212,40,220
T 60,23,48
T 62,23,52
MB 216,44,216
s_waitcnt vmcnt(17)
s_barrier
T 0,24,0
MB 220,44,220
T 2,24,4
s_xor_b32 m0, s65, 0x4000
s_xor_b32 s66, s62, 0x48000
W 6
MB 224,48,216
G 44,24,66,0
MB 228,48,220
T 4,25,0
T 6,25,4
MB 232,52,216
T 8,26,0
MB 236,52,220
T 10,26,4
W 6
MB 240,56,216
G 45,24,66,1
MB 244,56,220
T 12,27,0
T 14,27,4
MB 248,60,216
T 16,28,0
MB 252,60,220
T 18,28,4
W 6
MB 192,0,128
G 46,24,66,2
MB 196,0,132
T 20,29,0
T 22,29,4
MB 200,4,128
T 24,30,0
MB 204,4,132
T 26,30,4
W 6
MB 208,8,128
G 47,24,66,3
MB 212,8,132
T 28,31,0
T 30,31,4
MB 216,12,128
s_waitcnt vmcnt(17)
s_barrier
T 32,24,16
MB 220,12,132
T 34,24,20
s_xor_b32 m0, s65, 0x8000
s_xor_b32 s66, s62, 0x50000
W 6
MB 224,16,128
G 44,24,66,0
MB 228,16,132
T 36,25,16
T 38,25,20
MB 232,20,128
T 40,26,16
MB 236,20,132
T 42,26,20
W 6
MB 240,24,128
G 45,24,66,1
MB 244,24,132
T 44,27,16
T 46,27,20
MB 248,28,128
T 48,28,16
MB 252,28,132
T 50,28,20
W 6
MB 192,32,136
G 46,24,66,2
MB 196,32,140
T 52,29,16
T 54,29,20
MB 200,36,136
T 56,30,16
MB 204,36,140
T 58,30,20
W 6
MB 208,40,136
G 47,24,66,3
MB 212,40,140
T 60,31,16
T 62,31,20
MB 216,44,136
s_waitcnt vmcnt(17)
s_barrier
T 0,24,32
MB 220,44,140
T 2,24,36
s_xor_b32 m0, s65, 0xc000
s_xor_b32 s66, s62, 0x58000
W 6
MB 224,48,136
G 44,24,66,0
MB 228,48,140
T 4,25,32
T 6,25,36
MB 232,52,136
T 8,26,32
MB 236,52,140
T 10,26,36
W 6
MB 240,56,136
G 45,24,66,1
MB 244,56,140
T 12,27,32
T 14,27,36
MB 248,60,136
T 16,28,32
MB 252,60,140
T 18,28,36
W 6
MB 192,0,144
G 46,24,66,2
MB 196,0,148
T 20,29,32
T 22,29,36
MB 200,4,144
T 24,30,32
MB 204,4,148
T 26,30,36
W 6
MB 208,8,144
G 47,24,66,3
MB 212,8,148
T 28,31,32
T 30,31,36
MB 216,12,144
s_waitcnt vmcnt(17)
s_barrier
T 32,24,48
MB 220,12,148
T 34,24,52
s_xor_b32 m0, s65, 0x10000
s_xor_b32 s66, s62, 0x60000
W 6
MB 224,16,144
G 44,24,66,0
MB 228,16,148
T 36,25,48
T 38,25,52
MB 232,20,144
T 40,26,48
MB 236,20,148
T 42,26,52
W 6
MB 240,24,144
G 45,24,66,1
MB 244,24,148
T 44,27,48
T 46,27,52
MB 248,28,144
T 48,28,48
MB 252,28,148
T 50,28,52
W 6
MB 192,32,152
G 46,24,66,2
MB 196,32,156
T 52,29,48
T 54,29,52
MB 200,36,152
T 56,30,48
MB 204,36,156
T 58,30,52
W 6
MB 208,40,152
G 47,24,66,3
MB 212,40,156
T 60,31,48
T 62,31,52
MB 216,44,152
s_waitcnt vmcnt(16)
s_barrier
T 0,16,0
MB 220,44,156
T 2,16,4
s_xor_b32 m0, s65, 0x14000
s_xor_b32 s66, s62, 0x68000
W 6
MB 224,48,152
G 44,24,66,0
MB 228,48,156
T 4,17,0
T 6,17,4
MB 232,52,152
T 8,18,0
MB 236,52,156
T 10,18,4
W 6
MB 240,56,152
G 45,24,66,1
MB 244,56,156
T 12,19,0
T 14,19,4
MB 248,60,152
T 16,20,0
MB 252,60,156
T 18,20,4
W 6
MB 128,0,224
G 46,24,66,2
MB 132,0,228
T 20,21,0
T 22,21,4
ds_write_b128 v58, a[224:227] offset:0
s_and_b32 s7, s2, 7
v_bfe_u32 v7, v59, 4, 3
v_max_u32 v7, 1, v7
v_xor_b32 v7, s7, v7
v_lshlrev_b32 v7, 2, v7
MB 136,4,224
T 24,22,0
MB 140,4,228
T 26,22,4
ds_write_b128 v58, a[228:231] offset:1024
W 8
MB 144,8,224
G 47,24,66,3
MB 148,8,228
T 28,23,0
T 30,23,4
ds_write_b128 v58, a[232:235] offset:2048
v_and_b32 v6, 0xf0, v59
v_lshlrev_b32 v6, 7, v6
v_lshrrev_b32 v62, 8, v59
v_lshl_add_u32 v6, v62, 4, v6
MB 152,12,224
s_waitcnt vmcnt(16) lgkmcnt(0)
s_barrier
T 32,16,16
MB 156,12,228
T 34,16,20
ds_write_b128 v58, a[236:239] offset:3072
s_xor_b32 m0, s65, 0x18000
s_xor_b32 s66, s62, 0x70000
MB 160,16,224
G 44,24,66,0
MB 164,16,228
T 36,17,16
T 38,17,20
ds_write_b128 v58, a[240:243] offset:4096
MB 168,20,224
T 40,18,16
MB 172,20,228
T 42,18,20
ds_write_b128 v58, a[244:247] offset:5120
MB 176,24,224
G 45,24,66,1
MB 180,24,228
T 44,19,16
T 46,19,20
ds_write_b128 v58, a[248:251] offset:6144
MB 184,28,224
T 48,20,16
MB 188,28,228
T 50,20,20
ds_write_b128 v58, a[252:255] offset:7168
W 10
MB 128,32,232
G 46,24,66,2
MB 132,32,236
T 52,21,16
T 54,21,20
L_ci_c0:
v_cmp_gt_u32 vcc, 8, v4
s_nop 3
s_or_b64 vcc, vcc, vcc
s_cbranch_scc1 L_wi_c0
L_gi_c0:
MB 136,36,232
T 56,22,16
MB 140,36,236
T 58,22,20
W 8
MB 144,40,232
G 47,24,66,3
MB 148,40,236
T 60,23,16
T 62,23,20
MB 152,44,232
s_waitcnt vmcnt(16) lgkmcnt(6)
s_barrier
T 0,16,32
MB 156,44,236
T 2,16,36
R a,160,2,0
s_xor_b32 m0, s65, 0x1c000
s_xor_b32 s66, s62, 0x78000
MB 160,48,232
G 44,24,66,0
MB 164,48,236
T 4,17,32
T 6,17,36
R a,164,2,1
W 10
MB 168,52,232
T 8,18,32
MB 172,52,236
T 10,18,36
R a,168,2,2
W 9
MB 176,56,232
G 45,24,66,1
MB 180,56,236
T 12,19,32
T 14,19,36
R a,172,2,3
MB 184,60,232
T 16,20,32
MB 188,60,236
T 18,20,36
R a,176,2,4
W 10
MB 128,0,240
G 46,24,66,2
MB 132,0,244
T 20,21,32
T 22,21,36
R a,180,2,5
MB 136,4,240
T 24,22,32
MB 140,4,244
T 26,22,36
W 14
R a,184,2,6
W 10
MB 144,8,240
G 47,24,66,3
MB 148,8,244
T 28,23,32
T 30,23,36
R a,188,2,7
MB 152,12,240
s_waitcnt vmcnt(16)
s_barrier
T 32,16,48
MB 156,12,244
T 34,16,52
s_xor_b32 m0, s65, 0x0
s_xor_b32 s66, s62, 0x40100
W 9
MB 160,16,240
G 44,24,66,0
MB 164,16,244
T 36,17,48
T 38,17,52
MB 168,20,240
T 40,18,48
MB 172,20,244
T 42,18,52
W 7
MB 176,24,240
G 45,24,66,1
MB 180,24,244
T 44,19,48
T 46,19,52
MB 184,28,240
T 48,20,48
MB 188,28,244
T 50,20,52
W 6
MB 128,32,248
G 46,24,66,2
MB 132,32,252
T 52,21,48
T 54,21,52
buffer_load_dword v3, v7, s[52:55], s72 offen offset:256 sc1
buffer_load_dword v4, v7, s[52:55], s72 offen offset:384 sc1
MB 136,36,248
T 56,22,48
MB 140,36,252
T 58,22,52
W 6
MB 144,40,248
G 47,24,66,3
MB 148,40,252
T 60,23,48
T 62,23,52
MB 152,44,248
s_waitcnt vmcnt(18)
s_barrier
T 0,24,0
MB 156,44,252
T 2,24,4
s_xor_b32 m0, s65, 0x4000
s_xor_b32 s66, s62, 0x48100
W 6
MB 160,48,248
G 44,24,66,0
MB 164,48,252
T 4,25,0
T 6,25,4
MB 168,52,248
T 8,26,0
MB 172,52,252
T 10,26,4
W 6
MB 176,56,248
G 45,24,66,1
MB 180,56,252
T 12,27,0
T 14,27,4
MB 184,60,248
T 16,28,0
MB 188,60,252
T 18,28,4
W 6
MB 128,0,160
G 46,24,66,2
MB 132,0,164
T 20,29,0
T 22,29,4
MB 136,4,160
T 24,30,0
MB 140,4,164
T 26,30,4
W 6
MB 144,8,160
G 47,24,66,3
MB 148,8,164
T 28,31,0
T 30,31,4
MB 152,12,160
s_waitcnt vmcnt(18)
s_barrier
T 32,24,16
MB 156,12,164
T 34,24,20
s_xor_b32 m0, s65, 0x8000
s_xor_b32 s66, s62, 0x50100
W 6
MB 160,16,160
G 44,24,66,0
MB 164,16,164
T 36,25,16
T 38,25,20
MB 168,20,160
T 40,26,16
MB 172,20,164
T 42,26,20
W 6
MB 176,24,160
G 45,24,66,1
MB 180,24,164
T 44,27,16
T 46,27,20
MB 184,28,160
T 48,28,16
MB 188,28,164
T 50,28,20
W 6
MB 128,32,168
G 46,24,66,2
MB 132,32,172
T 52,29,16
T 54,29,20
MB 136,36,168
T 56,30,16
MB 140,36,172
T 58,30,20
W 6
MB 144,40,168
G 47,24,66,3
MB 148,40,172
T 60,31,16
T 62,31,20
MB 152,44,168
s_waitcnt vmcnt(18)
s_barrier
T 0,24,32
MB 156,44,172
T 2,24,36
s_xor_b32 m0, s65, 0xc000
s_xor_b32 s66, s62, 0x58100
W 6
MB 160,48,168
G 44,24,66,0
MB 164,48,172
T 4,25,32
T 6,25,36
MB 168,52,168
T 8,26,32
MB 172,52,172
T 10,26,36
W 6
MB 176,56,168
G 45,24,66,1
MB 180,56,172
T 12,27,32
T 14,27,36
MB 184,60,168
T 16,28,32
MB 188,60,172
T 18,28,36
W 6
MB 128,0,176
G 46,24,66,2
MB 132,0,180
T 20,29,32
T 22,29,36
MB 136,4,176
T 24,30,32
MB 140,4,180
T 26,30,36
W 6
MB 144,8,176
G 47,24,66,3
MB 148,8,180
T 28,31,32
T 30,31,36
MB 152,12,176
s_waitcnt vmcnt(18)
s_barrier
T 32,24,48
MB 156,12,180
T 34,24,52
s_xor_b32 m0, s65, 0x10000
s_xor_b32 s66, s62, 0x60100
W 6
MB 160,16,176
G 44,24,66,0
MB 164,16,180
T 36,25,48
T 38,25,52
MB 168,20,176
T 40,26,48
MB 172,20,180
T 42,26,52
W 6
MB 176,24,176
G 45,24,66,1
MB 180,24,180
T 44,27,48
T 46,27,52
MB 184,28,176
T 48,28,48
MB 188,28,180
T 50,28,52
W 6
MB 128,32,184
G 46,24,66,2
MB 132,32,188
T 52,29,48
T 54,29,52
MB 136,36,184
T 56,30,48
MB 140,36,188
T 58,30,52
W 6
MB 144,40,184
G 47,24,66,3
MB 148,40,188
T 60,31,48
T 62,31,52
MB 152,44,184
s_waitcnt vmcnt(16)
s_barrier
T 0,16,0
MB 156,44,188
T 2,16,4
s_xor_b32 m0, s65, 0x14000
s_xor_b32 s66, s62, 0x68100
W 6
MB 160,48,184
G 44,24,66,0
MB 164,48,188
T 4,17,0
T 6,17,4
MB 168,52,184
T 8,18,0
MB 172,52,188
T 10,18,4
W 6
MB 176,56,184
G 45,24,66,1
MB 180,56,188
T 12,19,0
T 14,19,4
MB 184,60,184
T 16,20,0
MB 188,60,188
T 18,20,4
W 6
MB 192,0,224
G 46,24,66,2
MB 196,0,228
T 20,21,0
T 22,21,4
MB 200,4,224
T 24,22,0
MB 204,4,228
T 26,22,4
W 6
MB 208,8,224
G 47,24,66,3
MB 212,8,228
T 28,23,0
T 30,23,4
MB 216,12,224
s_waitcnt vmcnt(16)
s_barrier
T 32,16,16
T 34,16,20
MB 220,12,228
CV 68,132
CV 69,134
CV 70,140
s_xor_b32 m0, s65, 0x18000
s_xor_b32 s66, s62, 0x70100
W 6
MB 224,16,224
G 44,24,66,0
T 36,17,16
T 38,17,20
MB 228,16,228
CV 71,142
s_xor_b32 s79, s67, 0x11000
buffer_store_dwordx4 v[68:71], v59, s[52:55], s79 offen sc1
MB 232,20,224
T 40,18,16
T 42,18,20
MB 236,20,228
CV 72,144
CV 73,146
CV 74,152
W 6
MB 240,24,224
G 45,24,66,1
T 44,19,16
T 46,19,20
MB 244,24,228
CV 75,154
s_xor_b32 s79, s67, 0x22000
buffer_store_dwordx4 v[72:75], v59, s[52:55], s79 offen sc1
MB 248,28,224
T 48,20,16
T 50,20,20
MB 252,28,228
CV 76,148
CV 77,150
CV 78,156
W 6
MB 192,32,232
G 46,24,66,2
T 52,21,16
T 54,21,20
MB 196,32,236
CV 79,158
s_xor_b32 s79, s67, 0x33000
buffer_store_dwordx4 v[76:79], v59, s[52:55], s79 offen sc1
L_ce_c0:
v_cmp_ne_u32 vcc, 1, v3
v_cmp_ne_u32 s[82:83], 1, v4
s_nop 3
s_or_b64 vcc, vcc, s[82:83]
s_cbranch_scc1 L_we_c0
L_ge_c0:
MB 200,36,232
T 56,22,16
T 58,22,20
MB 204,36,236
CV 80,160
CV 81,162
CV 82,168
W 6
MB 208,40,232
G 47,24,66,3
T 60,23,16
T 62,23,20
MB 212,40,236
CV 83,170
s_xor_b32 s79, s67, 0x44000
buffer_store_dwordx4 v[80:83], v59, s[52:55], s79 offen sc1
MB 216,44,232
s_waitcnt vmcnt(20)
s_barrier
T 0,16,32
T 2,16,36
MB 220,44,236
CV 84,164
CV 85,166
CV 86,172
s_xor_b32 m0, s65, 0x1c000
s_xor_b32 s66, s62, 0x78100
W 6
MB 224,48,232
G 44,24,66,0
T 4,17,32
T 6,17,36
MB 228,48,236
CV 87,174
s_xor_b32 s79, s67, 0x55000
buffer_store_dwordx4 v[84:87], v59, s[52:55], s79 offen sc1
MB 232,52,232
T 8,18,32
T 10,18,36
MB 236,52,236
CV 88,176
CV 89,178
CV 90,184
W 6
MB 240,56,232
G 45,24,66,1
T 12,19,32
T 14,19,36
MB 244,56,236
CV 91,186
s_xor_b32 s79, s67, 0x66000
buffer_store_dwordx4 v[88:91], v59, s[52:55], s79 offen sc1
MB 248,60,232
T 16,20,32
T 18,20,36
MB 252,60,236
CV 92,180
CV 93,182
CV 94,188
W 6
MB 192,0,240
G 46,24,66,2
T 20,21,32
T 22,21,36
MB 196,0,244
CV 95,190
s_xor_b32 s79, s67, 0x77000
buffer_store_dwordx4 v[92:95], v59, s[52:55], s79 offen sc1
MB 200,4,240
T 24,22,32
T 26,22,36
MB 204,4,244
CV 64,128
CV 65,130
W 6
MB 208,8,240
G 47,24,66,3
T 28,23,32
MB 212,8,244
T 30,23,36
CV 66,136
CV 67,138
MB 216,12,240
s_waitcnt vmcnt(23)
s_barrier
MB 220,12,244
T 32,16,48
T 34,16,52
W 6
MB 224,16,240
s_xor_b32 s80, s67, 0x1001000
buffer_load_dwordx4 v[132:135], v59, s[52:55], s80 offen sc1
MB 228,16,244
T 36,17,48
T 38,17,52
MB 232,20,240
T 40,18,48
MB 236,20,244
T 42,18,52
W 6
MB 240,24,240
T 44,19,48
MB 244,24,244
T 46,19,52
MB 248,28,240
T 48,20,48
MB 252,28,244
T 50,20,52
W 6
MB 192,32,248
T 52,21,48
MB 196,32,252
T 54,21,52
MB 200,36,248
T 56,22,48
MB 204,36,252
T 58,22,52
W 6
MB 208,40,248
s_xor_b32 s80, s67, 0x1002000
buffer_load_dwordx4 v[136:139], v59, s[52:55], s80 offen sc1
MB 212,40,252
T 60,23,48
T 62,23,52
MB 216,44,248
s_waitcnt vmcnt(21)
s_barrier
MB 220,44,252
T 0,24,0
T 2,24,4
W 6
MB 224,48,248
T 4,25,0
MB 228,48,252
T 6,25,4
MB 232,52,248
T 8,26,0
MB 236,52,252
T 10,26,4
W 6
MB 240,56,248
T 12,27,0
MB 244,56,252
T 14,27,4
MB 248,60,248
T 16,28,0
MB 252,60,252
T 18,28,4
W 6
MB 192,0,160
s_xor_b32 s80, s67, 0x1003000
buffer_load_dwordx4 v[140:143], v59, s[52:55], s80 offen sc1
MB 196,0,164
T 20,29,0
T 22,29,4
MB 200,4,160
T 24,30,0
MB 204,4,164
T 26,30,4
W 6
MB 208,8,160
T 28,31,0
MB 212,8,164
T 30,31,4
MB 216,12,160
s_waitcnt vmcnt(18)
s_barrier
MB 220,12,164
T 32,24,16
T 34,24,20
W 6
MB 224,16,160
T 36,25,16
MB 228,16,164
T 38,25,20
MB 232,20,160
T 40,26,16
MB 236,20,164
T 42,26,20
W 6
MB 240,24,160
s_xor_b32 s80, s67, 0x1004000
buffer_load_dwordx4 v[144:147], v59, s[52:55], s80 offen sc1
MB 244,24,164
T 44,27,16
T 46,27,20
MB 248,28,160
T 48,28,16
MB 252,28,164
T 50,28,20
W 6
MB 192,32,168
T 52,29,16
MB 196,32,172
T 54,29,20
MB 200,36,168
T 56,30,16
MB 204,36,172
T 58,30,20
W 6
MB 208,40,168
T 60,31,16
MB 212,40,172
T 62,31,20
MB 216,44,168
s_waitcnt vmcnt(12)
s_barrier
MB 220,44,172
T 0,24,32
T 2,24,36
W 6
MB 224,48,168
T 4,25,32
MB 228,48,172
T 6,25,36
MB 232,52,168
s_xor_b32 s80, s67, 0x1005000
buffer_load_dwordx4 v[148:151], v59, s[52:55], s80 offen sc1
MB 236,52,172
T 8,26,32
T 10,26,36
W 6
MB 240,56,168
T 12,27,32
MB 244,56,172
T 14,27,36
MB 248,60,168
T 16,28,32
MB 252,60,172
T 18,28,36
W 6
MB 192,0,176
T 20,29,32
MB 196,0,180
T 22,29,36
MB 200,4,176
T 24,30,32
MB 204,4,180
T 26,30,36
W 6
MB 208,8,176
T 28,31,32
MB 212,8,180
T 30,31,36
MB 216,12,176
s_waitcnt vmcnt(5)
s_barrier
s_xor_b32 s80, s67, 0x1006000
MB 220,12,180
buffer_load_dwordx4 v[152:155], v59, s[52:55], s80 offen sc1
T 32,24,48
T 34,24,52
W 6
MB 224,16,176
T 36,25,48
MB 228,16,180
T 38,25,52
MB 232,20,176
T 40,26,48
MB 236,20,180
T 42,26,52
W 6
MB 240,24,176
T 44,27,48
MB 244,24,180
T 46,27,52
MB 248,28,176
T 48,28,48
MB 252,28,180
T 50,28,52
W 6
MB 192,32,184
T 52,29,48
MB 196,32,188
T 54,29,52
MB 200,36,184
s_xor_b32 s80, s67, 0x1007000
buffer_load_dwordx4 v[156:159], v59, s[52:55], s80 offen sc1
MB 204,36,188
T 56,30,48
T 58,30,52
W 6
MB 208,40,184
T 60,31,48
MB 212,40,188
T 62,31,52
MB 216,44,184
MB 220,44,188
W 4
MB 224,48,184
MB 228,48,188
MB 232,52,184
MB 236,52,188
W 0
MB 240,56,184
MB 244,56,188
v_mov_b32 v61, 1
v_mov_b32 v62, 0
s_mov_b64 exec, 1
buffer_store_dword v61, v62, s[52:55], s5 offen offset:0 sc1
s_mov_b64 exec, -1
MB 248,60,184
MB 252,60,188
CV 100,196
CV 101,198
CV 102,204
CV 103,206
s_xor_b32 s79, s67, 0x19000
buffer_store_dwordx4 v[100:103], v59, s[52:55], s79 offen sc1
CV 104,208
CV 105,210
CV 106,216
CV 107,218
s_xor_b32 s79, s67, 0x2a000
buffer_store_dwordx4 v[104:107], v59, s[52:55], s79 offen sc1
CV 108,212
CV 109,214
CV 110,220
CV 111,222
s_xor_b32 s79, s67, 0x3b000
buffer_store_dwordx4 v[108:111], v59, s[52:55], s79 offen sc1
CV 112,224
CV 113,226
CV 114,232
CV 115,234
s_xor_b32 s79, s67, 0x4c000
buffer_store_dwordx4 v[112:115], v59, s[52:55], s79 offen sc1
CV 116,228
CV 117,230
CV 118,236
CV 119,238
s_xor_b32 s79, s67, 0x5d000
buffer_store_dwordx4 v[116:119], v59, s[52:55], s79 offen sc1
CV 120,240
CV 121,242
CV 122,248
CV 123,250
s_xor_b32 s79, s67, 0x6e000
buffer_store_dwordx4 v[120:123], v59, s[52:55], s79 offen sc1
CV 124,244
CV 125,246
CV 126,252
CV 127,254
s_xor_b32 s79, s67, 0x7f000
buffer_store_dwordx4 v[124:127], v59, s[52:55], s79 offen sc1
CV 96,192
CV 97,194
CV 98,200
CV 99,202
buffer_load_dword v0, v7, s[52:55], s72 offen offset:0 sc1
UP 68,36
UH 69,36
UP 70,37
UH 71,37
UP 72,38
UH 73,38
UP 74,39
UH 75,39
s_waitcnt vmcnt(15)
UP 76,132
UH 77,132
UP 78,133
UH 79,133
UP 80,134
UH 81,134
UP 82,135
UH 83,135
PA 68,76
PA 70,78
PA 72,80
PA 74,82
s_waitcnt vmcnt(14)
UP 76,136
UH 77,136
UP 78,137
UH 79,137
UP 80,138
UH 81,138
UP 82,139
UH 83,139
PA 68,76
PA 70,78
PA 72,80
PA 74,82
s_waitcnt vmcnt(13)
UP 76,140
UH 77,140
UP 78,141
UH 79,141
UP 80,142
UH 81,142
UP 82,143
UH 83,143
PA 68,76
PA 70,78
PA 72,80
PA 74,82
s_waitcnt vmcnt(12)
UP 76,144
UH 77,144
UP 78,145
UH 79,145
UP 80,146
UH 81,146
UP 82,147
UH 83,147
PA 68,76
PA 70,78
PA 72,80
PA 74,82
s_waitcnt vmcnt(11)
UP 76,148
UH 77,148
UP 78,149
UH 79,149
UP 80,150
UH 81,150
UP 82,151
UH 83,151
PA 68,76
PA 70,78
PA 72,80
PA 74,82
s_waitcnt vmcnt(10)
UP 76,152
UH 77,152
UP 78,153
UH 79,153
UP 80,154
UH 81,154
UP 82,155
UH 83,155
PA 68,76
PA 70,78
PA 72,80
PA 74,82
s_waitcnt vmcnt(9)
UP 76,156
UH 77,156
UP 78,157
UH 79,157
UP 80,158
UH 81,158
UP 82,159
UH 83,159
PA 68,76
PA 70,78
PA 72,80
PA 74,82
CV 128,68
CV 129,70
CV 130,72
CV 131,74
s_nop 0
v_permlane32_swap_b32 v128, v130
v_permlane32_swap_b32 v129, v131
s_nop 0
v_permlane16_swap_b32 v128, v130
v_permlane16_swap_b32 v129, v131
s_xor_b32 s80, s4, 0x400
buffer_store_dwordx4 v[128:131], v6, s[56:59], s80 offen
s_waitcnt vmcnt(2)
v_mov_b32 v61, 1
v_mov_b32 v62, 0
s_mov_b64 exec, 1
buffer_store_dword v61, v62, s[52:55], s5 offen offset:128 sc1
s_mov_b64 exec, -1
s_xor_b32 s80, s67, 0x1009000
buffer_load_dwordx4 v[164:167], v59, s[52:55], s80 offen sc1
s_xor_b32 s80, s67, 0x100a000
buffer_load_dwordx4 v[168:171], v59, s[52:55], s80 offen sc1
s_xor_b32 s80, s67, 0x100b000
buffer_load_dwordx4 v[172:175], v59, s[52:55], s80 offen sc1
s_xor_b32 s80, s67, 0x100c000
buffer_load_dwordx4 v[176:179], v59, s[52:55], s80 offen sc1
s_xor_b32 s80, s67, 0x100d000
buffer_load_dwordx4 v[180:183], v59, s[52:55], s80 offen sc1
s_xor_b32 s80, s67, 0x100e000
buffer_load_dwordx4 v[184:187], v59, s[52:55], s80 offen sc1
s_xor_b32 s80, s67, 0x100f000
buffer_load_dwordx4 v[188:191], v59, s[52:55], s80 offen sc1
L_cm_c0:
s_waitcnt vmcnt(9)
v_cmp_ne_u32 vcc, 1, v0
s_nop 3
s_or_b64 vcc, vcc, vcc
s_cbranch_scc1 L_wm_c0
L_gm_c0:
s_xor_b32 s80, s67, 0x1000
buffer_load_dwordx4 v[196:199], v59, s[52:55], s80 offen sc1
s_xor_b32 s80, s67, 0x2000
buffer_load_dwordx4 v[200:203], v59, s[52:55], s80 offen sc1
s_xor_b32 s80, s67, 0x3000
buffer_load_dwordx4 v[204:207], v59, s[52:55], s80 offen sc1
s_xor_b32 s80, s67, 0x4000
buffer_load_dwordx4 v[208:211], v59, s[52:55], s80 offen sc1
s_xor_b32 s80, s67, 0x5000
buffer_load_dwordx4 v[212:215], v59, s[52:55], s80 offen sc1
s_xor_b32 s80, s67, 0x6000
buffer_load_dwordx4 v[216:219], v59, s[52:55], s80 offen sc1
s_xor_b32 s80, s67, 0x7000
buffer_load_dwordx4 v[220:223], v59, s[52:55], s80 offen sc1
buffer_load_dword v4, v7, s[52:55], s72 offen offset:128 sc1
UP 68,40
UH 69,40
UP 70,41
UH 71,41
UP 72,42
UH 73,42
UP 74,43
UH 75,43
s_waitcnt vmcnt(14)
UP 76,164
UH 77,164
UP 78,165
UH 79,165
UP 80,166
UH 81,166
UP 82,167
UH 83,167
PA 68,76
PA 70,78
PA 72,80
PA 74,82
s_waitcnt vmcnt(13)
UP 76,168
UH 77,168
UP 78,169
UH 79,169
UP 80,170
UH 81,170
UP 82,171
UH 83,171
PA 68,76
PA 70,78
PA 72,80
PA 74,82
s_waitcnt vmcnt(12)
UP 76,172
UH 77,172
UP 78,173
UH 79,173
UP 80,174
UH 81,174
UP 82,175
UH 83,175
PA 68,76
PA 70,78
PA 72,80
PA 74,82
s_waitcnt vmcnt(11)
UP 76,176
UH 77,176
UP 78,177
UH 79,177
UP 80,178
UH 81,178
UP 82,179
UH 83,179
PA 68,76
PA 70,78
PA 72,80
PA 74,82
s_waitcnt vmcnt(10)
UP 76,180
UH 77,180
UP 78,181
UH 79,181
UP 80,182
UH 81,182
UP 82,183
UH 83,183
PA 68,76
PA 70,78
PA 72,80
PA 74,82
s_waitcnt vmcnt(9)
UP 76,184
UH 77,184
UP 78,185
UH 79,185
UP 80,186
UH 81,186
UP 82,187
UH 83,187
PA 68,76
PA 70,78
PA 72,80
PA 74,82
s_waitcnt vmcnt(8)
UP 76,188
UH 77,188
UP 78,189
UH 79,189
UP 80,190
UH 81,190
UP 82,191
UH 83,191
PA 68,76
PA 70,78
PA 72,80
PA 74,82
CV 160,68
CV 161,70
CV 162,72
CV 163,74
s_nop 0
v_permlane32_swap_b32 v160, v162
v_permlane32_swap_b32 v161, v163
s_nop 0
v_permlane16_swap_b32 v160, v162
v_permlane16_swap_b32 v161, v163
s_xor_b32 s80, s4, 0x500
buffer_store_dwordx4 v[160:163], v6, s[56:59], s80 offen
L_cl_c0:
s_waitcnt vmcnt(1)
v_cmp_ne_u32 vcc, 1, v4
s_nop 3
s_or_b64 vcc, vcc, vcc
s_cbranch_scc1 L_wl_c0
L_gl_c0:
s_xor_b32 s80, s67, 0x9000
buffer_load_dwordx4 v[228:231], v59, s[52:55], s80 offen sc1
s_xor_b32 s80, s67, 0xa000
buffer_load_dwordx4 v[232:235], v59, s[52:55], s80 offen sc1
s_xor_b32 s80, s67, 0xb000
buffer_load_dwordx4 v[236:239], v59, s[52:55], s80 offen sc1
s_xor_b32 s80, s67, 0xc000
buffer_load_dwordx4 v[240:243], v59, s[52:55], s80 offen sc1
s_xor_b32 s80, s67, 0xd000
buffer_load_dwordx4 v[244:247], v59, s[52:55], s80 offen sc1
s_xor_b32 s80, s67, 0xe000
buffer_load_dwordx4 v[248:251], v59, s[52:55], s80 offen sc1
s_xor_b32 s80, s67, 0xf000
buffer_load_dwordx4 v[252:255], v59, s[52:55], s80 offen sc1
UP 68,64
UH 69,64
UP 70,65
UH 71,65
UP 72,66
UH 73,66
UP 74,67
UH 75,67
UP 76,196
UH 77,196
UP 78,197
UH 79,197
UP 80,198
UH 81,198
UP 82,199
UH 83,199
PA 68,76
PA 70,78
PA 72,80
PA 74,82
UP 76,200
UH 77,200
UP 78,201
UH 79,201
UP 80,202
UH 81,202
UP 82,203
UH 83,203
PA 68,76
PA 70,78
PA 72,80
PA 74,82
UP 76,204
UH 77,204
UP 78,205
UH 79,205
UP 80,206
UH 81,206
UP 82,207
UH 83,207
PA 68,76
PA 70,78
PA 72,80
PA 74,82
UP 76,208
UH 77,208
UP 78,209
UH 79,209
UP 80,210
UH 81,210
UP 82,211
UH 83,211
PA 68,76
PA 70,78
PA 72,80
PA 74,82
UP 76,212
UH 77,212
UP 78,213
UH 79,213
UP 80,214
UH 81,214
UP 82,215
UH 83,215
PA 68,76
PA 70,78
PA 72,80
PA 74,82
UP 76,216
UH 77,216
UP 78,217
UH 79,217
UP 80,218
UH 81,218
UP 82,219
UH 83,219
PA 68,76
PA 70,78
PA 72,80
PA 74,82
UP 76,220
UH 77,220
UP 78,221
UH 79,221
UP 80,222
UH 81,222
UP 82,223
UH 83,223
PA 68,76
PA 70,78
PA 72,80
PA 74,82
CV 192,68
CV 193,70
CV 194,72
CV 195,74
s_nop 0
v_permlane32_swap_b32 v192, v194
v_permlane32_swap_b32 v193, v195
s_nop 0
v_permlane16_swap_b32 v192, v194
v_permlane16_swap_b32 v193, v195
s_xor_b32 s80, s4, 0x0
buffer_store_dwordx4 v[192:195], v6, s[56:59], s80 offen
UP 68,96
UH 69,96
UP 70,97
UH 71,97
UP 72,98
UH 73,98
UP 74,99
UH 75,99
s_waitcnt vmcnt(7)
UP 76,228
UH 77,228
UP 78,229
UH 79,229
UP 80,230
UH 81,230
UP 82,231
UH 83,231
PA 68,76
PA 70,78
PA 72,80
PA 74,82
s_waitcnt vmcnt(6)
UP 76,232
UH 77,232
UP 78,233
UH 79,233
UP 80,234
UH 81,234
UP 82,235
UH 83,235
PA 68,76
PA 70,78
PA 72,80
PA 74,82
s_waitcnt vmcnt(5)
UP 76,236
UH 77,236
UP 78,237
UH 79,237
UP 80,238
UH 81,238
UP 82,239
UH 83,239
PA 68,76
PA 70,78
PA 72,80
PA 74,82
s_waitcnt vmcnt(4)
UP 76,240
UH 77,240
UP 78,241
UH 79,241
UP 80,242
UH 81,242
UP 82,243
UH 83,243
PA 68,76
PA 70,78
PA 72,80
PA 74,82
s_waitcnt vmcnt(3)
UP 76,244
UH 77,244
UP 78,245
UH 79,245
UP 80,246
UH 81,246
UP 82,247
UH 83,247
PA 68,76
PA 70,78
PA 72,80
PA 74,82
s_waitcnt vmcnt(2)
UP 76,248
UH 77,248
UP 78,249
UH 79,249
UP 80,250
UH 81,250
UP 82,251
UH 83,251
PA 68,76
PA 70,78
PA 72,80
PA 74,82
s_waitcnt vmcnt(1)
UP 76,252
UH 77,252
UP 78,253
UH 79,253
UP 80,254
UH 81,254
UP 82,255
UH 83,255
PA 68,76
PA 70,78
PA 72,80
PA 74,82
CV 224,68
CV 225,70
CV 226,72
CV 227,74
s_nop 0
v_permlane32_swap_b32 v224, v226
v_permlane32_swap_b32 v225, v227
s_nop 0
v_permlane16_swap_b32 v224, v226
v_permlane16_swap_b32 v225, v227
s_xor_b32 s80, s4, 0x100
buffer_store_dwordx4 v[224:227], v6, s[56:59], s80 offen
s_endpgm
L_slow_c0B0:
s_waitcnt vmcnt(0) lgkmcnt(0)
s_nop 15
s_mov_b32 s93, m0
s_andn2_b32 s80, s63, 0x1ff00
s_xor_b32 s80, s80, 0x0
v_mov_b32 v62, 0xff800000
v_mov_b32 v63, 0xff800000
s_mov_b32 s94, s80
s_mov_b32 s81, 0
L_slow1_c0B0:
s_add_u32 m0, s78, 0
s_add_u32 s92, s94, 0
G 32,32,92,0
G 33,32,92,1
G 34,32,92,2
G 35,32,92,3
s_add_u32 m0, s78, 4096
s_add_u32 s92, s94, 512
G 32,32,92,0
G 33,32,92,1
G 34,32,92,2
G 35,32,92,3
s_waitcnt vmcnt(0)
v_and_b32 v0, 0x1fff, v8
v_add_u32 v0, s78, v0
R a,32,0,0
R a,48,0,4
v_and_b32 v0, 0x1fff, v9
v_add_u32 v0, s78, v0
R a,36,0,0
R a,52,0,4
v_and_b32 v0, 0x1fff, v10
v_add_u32 v0, s78, v0
R a,40,0,0
R a,56,0,4
v_and_b32 v0, 0x1fff, v11
v_add_u32 v0, s78, v0
R a,44,0,0
R a,60,0,4
W 7
ZB 64,32,64
ZB 68,32,68
W 5
MB 64,36,72
MB 68,36,76
W 3
MB 64,40,80
MB 68,40,84
W 1
MB 64,44,88
MB 68,44,92
ZB 72,48,64
ZB 76,48,68
MB 72,52,72
MB 76,52,76
MB 72,56,80
MB 76,56,84
W 0
MB 72,60,88
MB 76,60,92
v_max_f32 v62, v62, v64
v_max_f32 v62, v62, v65
v_max_f32 v62, v62, v66
v_max_f32 v62, v62, v67
v_max_f32 v63, v63, v68
v_max_f32 v63, v63, v69
v_max_f32 v63, v63, v70
v_max_f32 v63, v63, v71
v_max_f32 v62, v62, v72
v_max_f32 v62, v62, v73
v_max_f32 v62, v62, v74
v_max_f32 v62, v62, v75
v_max_f32 v63, v63, v76
v_max_f32 v63, v63, v77
v_max_f32 v63, v63, v78
v_max_f32 v63, v63, v79
s_or_b32 s81, s81, 0x7ffe8fff
s_add_u32 s81, s81, 1
s_and_b32 s81, s81, 0x17000
s_add_u32 s94, s80, s81
s_cmp_lg_u32 s81, 0
s_cbranch_scc1 L_slow1_c0B0
v_mov_b32 v1, v62
s_nop 1
v_permlane32_swap_b32 v1, v62
v_max_f32 v62, v62, v1
v_mov_b32 v1, v62
s_nop 1
v_permlane16_swap_b32 v1, v62
v_max_f32 v62, v62, v1
v_mov_b32 v1, v63
s_nop 1
v_permlane32_swap_b32 v1, v63
v_max_f32 v63, v63, v1
v_mov_b32 v1, v63
s_nop 1
v_permlane16_swap_b32 v1, v63
v_max_f32 v63, v63, v1
v_mov_b32 v60, 0
v_mov_b32 v61, 0
v_accvgpr_write_b32 a96, 0
v_accvgpr_write_b32 a97, 0
v_accvgpr_write_b32 a98, 0
v_accvgpr_write_b32 a99, 0
v_accvgpr_write_b32 a100, 0
v_accvgpr_write_b32 a101, 0
v_accvgpr_write_b32 a102, 0
v_accvgpr_write_b32 a103, 0
v_accvgpr_write_b32 a104, 0
v_accvgpr_write_b32 a105, 0
v_accvgpr_write_b32 a106, 0
v_accvgpr_write_b32 a107, 0
v_accvgpr_write_b32 a108, 0
v_accvgpr_write_b32 a109, 0
v_accvgpr_write_b32 a110, 0
v_accvgpr_write_b32 a111, 0
v_accvgpr_write_b32 a112, 0
v_accvgpr_write_b32 a113, 0
v_accvgpr_write_b32 a114, 0
v_accvgpr_write_b32 a115, 0
v_accvgpr_write_b32 a116, 0
v_accvgpr_write_b32 a117, 0
v_accvgpr_write_b32 a118, 0
v_accvgpr_write_b32 a119, 0
v_accvgpr_write_b32 a120, 0
v_accvgpr_write_b32 a121, 0
v_accvgpr_write_b32 a122, 0
v_accvgpr_write_b32 a123, 0
v_accvgpr_write_b32 a124, 0
v_accvgpr_write_b32 a125, 0
v_accvgpr_write_b32 a126, 0
v_accvgpr_write_b32 a127, 0
v_accvgpr_write_b32 a128, 0
v_accvgpr_write_b32 a129, 0
v_accvgpr_write_b32 a130, 0
v_accvgpr_write_b32 a131, 0
v_accvgpr_write_b32 a132, 0
v_accvgpr_write_b32 a133, 0
v_accvgpr_write_b32 a134, 0
v_accvgpr_write_b32 a135, 0
v_accvgpr_write_b32 a136, 0
v_accvgpr_write_b32 a137, 0
v_accvgpr_write_b32 a138, 0
v_accvgpr_write_b32 a139, 0
v_accvgpr_write_b32 a140, 0
v_accvgpr_write_b32 a141, 0
v_accvgpr_write_b32 a142, 0
v_accvgpr_write_b32 a143, 0
v_accvgpr_write_b32 a144, 0
v_accvgpr_write_b32 a145, 0
v_accvgpr_write_b32 a146, 0
v_accvgpr_write_b32 a147, 0
v_accvgpr_write_b32 a148, 0
v_accvgpr_write_b32 a149, 0
v_accvgpr_write_b32 a150, 0
v_accvgpr_write_b32 a151, 0
v_accvgpr_write_b32 a152, 0
v_accvgpr_write_b32 a153, 0
v_accvgpr_write_b32 a154, 0
v_accvgpr_write_b32 a155, 0
v_accvgpr_write_b32 a156, 0
v_accvgpr_write_b32 a157, 0
v_accvgpr_write_b32 a158, 0
v_accvgpr_write_b32 a159, 0
s_mov_b32 s94, s80
s_mov_b32 s81, 0
s_nop 4
L_slow2_c0B0:
s_add_u32 m0, s78, 0
s_add_u32 s92, s94, 0
G 32,32,92,0
G 33,32,92,1
G 34,32,92,2
G 35,32,92,3
s_add_u32 m0, s78, 4096
s_add_u32 s92, s94, 512
G 32,32,92,0
G 33,32,92,1
G 34,32,92,2
G 35,32,92,3
s_waitcnt vmcnt(0)
v_and_b32 v0, 0x1fff, v8
v_add_u32 v0, s78, v0
R a,32,0,0
R a,48,0,4
v_and_b32 v0, 0x1fff, v9
v_add_u32 v0, s78, v0
R a,36,0,0
R a,52,0,4
v_and_b32 v0, 0x1fff, v10
v_add_u32 v0, s78, v0
R a,40,0,0
R a,56,0,4
v_and_b32 v0, 0x1fff, v11
v_add_u32 v0, s78, v0
R a,44,0,0
R a,60,0,4
W 7
ZB 64,32,64
ZB 68,32,68
W 5
MB 64,36,72
MB 68,36,76
W 3
MB 64,40,80
MB 68,40,84
W 1
MB 64,44,88
MB 68,44,92
ZB 72,48,64
ZB 76,48,68
MB 72,52,72
MB 76,52,76
MB 72,56,80
MB 76,56,84
W 0
MB 72,60,88
MB 76,60,92
v_sub_f32 v64, v64, v62
v_sub_f32 v65, v65, v62
v_sub_f32 v66, v66, v62
v_sub_f32 v67, v67, v62
v_sub_f32 v68, v68, v63
v_sub_f32 v69, v69, v63
v_sub_f32 v70, v70, v63
v_sub_f32 v71, v71, v63
v_sub_f32 v72, v72, v62
v_sub_f32 v73, v73, v62
v_sub_f32 v74, v74, v62
v_sub_f32 v75, v75, v62
v_sub_f32 v76, v76, v63
v_sub_f32 v77, v77, v63
v_sub_f32 v78, v78, v63
v_sub_f32 v79, v79, v63
E 64
E 65
E 66
E 67
E 68
E 69
E 70
E 71
E 72
E 73
E 74
E 75
E 76
E 77
E 78
E 79
v_add_f32 v60, v60, v64
v_add_f32 v60, v60, v65
v_add_f32 v60, v60, v66
v_add_f32 v60, v60, v67
v_add_f32 v61, v61, v68
v_add_f32 v61, v61, v69
v_add_f32 v61, v61, v70
v_add_f32 v61, v61, v71
v_add_f32 v60, v60, v72
v_add_f32 v60, v60, v73
v_add_f32 v60, v60, v74
v_add_f32 v60, v60, v75
v_add_f32 v61, v61, v76
v_add_f32 v61, v61, v77
v_add_f32 v61, v61, v78
v_add_f32 v61, v61, v79
CV 96,64
CV 97,66
CV 100,68
CV 101,70
CV 98,72
CV 99,74
CV 102,76
CV 103,78
s_add_u32 m0, s78, 0
s_add_u32 s92, s94, 0
G 56,36,92,0
G 57,36,92,1
G 56,36,92,2
G 57,36,92,3
s_add_u32 m0, s78, 4096
s_add_u32 s92, s94, 512
G 56,36,92,0
G 57,36,92,1
G 56,36,92,2
G 57,36,92,3
s_waitcnt vmcnt(0)
v_and_b32 v0, 0x1fff, v16
v_add_u32 v0, s78, v0
T 32,0,0
T 34,0,4
v_and_b32 v0, 0x1fff, v17
v_add_u32 v0, s78, v0
T 36,0,0
T 38,0,4
v_and_b32 v0, 0x1fff, v18
v_add_u32 v0, s78, v0
T 40,0,0
T 42,0,4
v_and_b32 v0, 0x1fff, v19
v_add_u32 v0, s78, v0
T 44,0,0
T 46,0,4
v_and_b32 v0, 0x1fff, v20
v_add_u32 v0, s78, v0
T 48,0,0
T 50,0,4
v_and_b32 v0, 0x1fff, v21
v_add_u32 v0, s78, v0
T 52,0,0
T 54,0,4
v_and_b32 v0, 0x1fff, v22
v_add_u32 v0, s78, v0
T 56,0,0
T 58,0,4
v_and_b32 v0, 0x1fff, v23
v_add_u32 v0, s78, v0
T 60,0,0
W 14
T 62,0,4
W 14
MC 96,32,96
MC 100,32,100
W 12
MC 104,36,96
MC 108,36,100
W 10
MC 112,40,96
MC 116,40,100
W 8
MC 120,44,96
MC 124,44,100
W 6
MC 128,48,96
MC 132,48,100
W 4
MC 136,52,96
MC 140,52,100
W 2
MC 144,56,96
MC 148,56,100
W 0
MC 152,60,96
MC 156,60,100
s_nop 15
s_or_b32 s81, s81, 0x7ffe8fff
s_add_u32 s81, s81, 1
s_and_b32 s81, s81, 0x17000
s_add_u32 s94, s80, s81
s_cmp_lg_u32 s81, 0
s_cbranch_scc1 L_slow2_c0B0
v_mov_b32 v1, v60
s_nop 1
v_permlane32_swap_b32 v1, v60
v_add_f32 v60, v60, v1
v_mov_b32 v1, v60
s_nop 1
v_permlane16_swap_b32 v1, v60
v_add_f32 v60, v60, v1
v_mov_b32 v1, v61
s_nop 1
v_permlane32_swap_b32 v1, v61
v_add_f32 v61, v61, v1
v_mov_b32 v1, v61
s_nop 1
v_permlane16_swap_b32 v1, v61
v_add_f32 v61, v61, v1
s_mov_b32 m0, s93
s_nop 4
s_branch L_back_c0B0
L_slow_c0B1:
s_waitcnt vmcnt(0) lgkmcnt(0)
s_nop 15
s_mov_b32 s93, m0
s_andn2_b32 s80, s63, 0x1ff00
s_xor_b32 s80, s80, 0x40000
v_mov_b32 v62, 0xff800000
v_mov_b32 v63, 0xff800000
s_mov_b32 s94, s80
s_mov_b32 s81, 0
L_slow1_c0B1:
s_add_u32 m0, s78, 0
s_add_u32 s92, s94, 0
G 32,32,92,0
G 33,32,92,1
G 34,32,92,2
G 35,32,92,3
s_add_u32 m0, s78, 4096
s_add_u32 s92, s94, 512
G 32,32,92,0
G 33,32,92,1
G 34,32,92,2
G 35,32,92,3
s_waitcnt vmcnt(0)
v_and_b32 v0, 0x1fff, v8
v_add_u32 v0, s78, v0
R a,32,0,0
R a,48,0,4
v_and_b32 v0, 0x1fff, v9
v_add_u32 v0, s78, v0
R a,36,0,0
R a,52,0,4
v_and_b32 v0, 0x1fff, v10
v_add_u32 v0, s78, v0
R a,40,0,0
R a,56,0,4
v_and_b32 v0, 0x1fff, v11
v_add_u32 v0, s78, v0
R a,44,0,0
R a,60,0,4
W 7
ZB 64,32,160
ZB 68,32,164
W 5
MB 64,36,168
MB 68,36,172
W 3
MB 64,40,176
MB 68,40,180
W 1
MB 64,44,184
MB 68,44,188
ZB 72,48,160
ZB 76,48,164
MB 72,52,168
MB 76,52,172
MB 72,56,176
MB 76,56,180
W 0
MB 72,60,184
MB 76,60,188
v_max_f32 v62, v62, v64
v_max_f32 v62, v62, v65
v_max_f32 v62, v62, v66
v_max_f32 v62, v62, v67
v_max_f32 v63, v63, v68
v_max_f32 v63, v63, v69
v_max_f32 v63, v63, v70
v_max_f32 v63, v63, v71
v_max_f32 v62, v62, v72
v_max_f32 v62, v62, v73
v_max_f32 v62, v62, v74
v_max_f32 v62, v62, v75
v_max_f32 v63, v63, v76
v_max_f32 v63, v63, v77
v_max_f32 v63, v63, v78
v_max_f32 v63, v63, v79
s_or_b32 s81, s81, 0x7ffe8fff
s_add_u32 s81, s81, 1
s_and_b32 s81, s81, 0x17000
s_add_u32 s94, s80, s81
s_cmp_lg_u32 s81, 0
s_cbranch_scc1 L_slow1_c0B1
v_mov_b32 v1, v62
s_nop 1
v_permlane32_swap_b32 v1, v62
v_max_f32 v62, v62, v1
v_mov_b32 v1, v62
s_nop 1
v_permlane16_swap_b32 v1, v62
v_max_f32 v62, v62, v1
v_mov_b32 v1, v63
s_nop 1
v_permlane32_swap_b32 v1, v63
v_max_f32 v63, v63, v1
v_mov_b32 v1, v63
s_nop 1
v_permlane16_swap_b32 v1, v63
v_max_f32 v63, v63, v1
v_mov_b32 v60, 0
v_mov_b32 v61, 0
v_mov_b32 v128, 0
v_mov_b32 v129, 0
v_mov_b32 v130, 0
v_mov_b32 v131, 0
v_mov_b32 v132, 0
v_mov_b32 v133, 0
v_mov_b32 v134, 0
v_mov_b32 v135, 0
v_mov_b32 v136, 0
v_mov_b32 v137, 0
v_mov_b32 v138, 0
v_mov_b32 v139, 0
v_mov_b32 v140, 0
v_mov_b32 v141, 0
v_mov_b32 v142, 0
v_mov_b32 v143, 0
v_mov_b32 v144, 0
v_mov_b32 v145, 0
v_mov_b32 v146, 0
v_mov_b32 v147, 0
v_mov_b32 v148, 0
v_mov_b32 v149, 0
v_mov_b32 v150, 0
v_mov_b32 v151, 0
v_mov_b32 v152, 0
v_mov_b32 v153, 0
v_mov_b32 v154, 0
v_mov_b32 v155, 0
v_mov_b32 v156, 0
v_mov_b32 v157, 0
v_mov_b32 v158, 0
v_mov_b32 v159, 0
v_mov_b32 v160, 0
v_mov_b32 v161, 0
v_mov_b32 v162, 0
v_mov_b32 v163, 0
v_mov_b32 v164, 0
v_mov_b32 v165, 0
v_mov_b32 v166, 0
v_mov_b32 v167, 0
v_mov_b32 v168, 0
v_mov_b32 v169, 0
v_mov_b32 v170, 0
v_mov_b32 v171, 0
v_mov_b32 v172, 0
v_mov_b32 v173, 0
v_mov_b32 v174, 0
v_mov_b32 v175, 0
v_mov_b32 v176, 0
v_mov_b32 v177, 0
v_mov_b32 v178, 0
v_mov_b32 v179, 0
v_mov_b32 v180, 0
v_mov_b32 v181, 0
v_mov_b32 v182, 0
v_mov_b32 v183, 0
v_mov_b32 v184, 0
v_mov_b32 v185, 0
v_mov_b32 v186, 0
v_mov_b32 v187, 0
v_mov_b32 v188, 0
v_mov_b32 v189, 0
v_mov_b32 v190, 0
v_mov_b32 v191, 0
s_mov_b32 s94, s80
s_mov_b32 s81, 0
s_nop 4
L_slow2_c0B1:
s_add_u32 m0, s78, 0
s_add_u32 s92, s94, 0
G 32,32,92,0
G 33,32,92,1
G 34,32,92,2
G 35,32,92,3
s_add_u32 m0, s78, 4096
s_add_u32 s92, s94, 512
G 32,32,92,0
G 33,32,92,1
G 34,32,92,2
G 35,32,92,3
s_waitcnt vmcnt(0)
v_and_b32 v0, 0x1fff, v8
v_add_u32 v0, s78, v0
R a,32,0,0
R a,48,0,4
v_and_b32 v0, 0x1fff, v9
v_add_u32 v0, s78, v0
R a,36,0,0
R a,52,0,4
v_and_b32 v0, 0x1fff, v10
v_add_u32 v0, s78, v0
R a,40,0,0
R a,56,0,4
v_and_b32 v0, 0x1fff, v11
v_add_u32 v0, s78, v0
R a,44,0,0
R a,60,0,4
W 7
ZB 64,32,160
ZB 68,32,164
W 5
MB 64,36,168
MB 68,36,172
W 3
MB 64,40,176
MB 68,40,180
W 1
MB 64,44,184
MB 68,44,188
ZB 72,48,160
ZB 76,48,164
MB 72,52,168
MB 76,52,172
MB 72,56,176
MB 76,56,180
W 0
MB 72,60,184
MB 76,60,188
v_sub_f32 v64, v64, v62
v_sub_f32 v65, v65, v62
v_sub_f32 v66, v66, v62
v_sub_f32 v67, v67, v62
v_sub_f32 v68, v68, v63
v_sub_f32 v69, v69, v63
v_sub_f32 v70, v70, v63
v_sub_f32 v71, v71, v63
v_sub_f32 v72, v72, v62
v_sub_f32 v73, v73, v62
v_sub_f32 v74, v74, v62
v_sub_f32 v75, v75, v62
v_sub_f32 v76, v76, v63
v_sub_f32 v77, v77, v63
v_sub_f32 v78, v78, v63
v_sub_f32 v79, v79, v63
E 64
E 65
E 66
E 67
E 68
E 69
E 70
E 71
E 72
E 73
E 74
E 75
E 76
E 77
E 78
E 79
v_add_f32 v60, v60, v64
v_add_f32 v60, v60, v65
v_add_f32 v60, v60, v66
v_add_f32 v60, v60, v67
v_add_f32 v61, v61, v68
v_add_f32 v61, v61, v69
v_add_f32 v61, v61, v70
v_add_f32 v61, v61, v71
v_add_f32 v60, v60, v72
v_add_f32 v60, v60, v73
v_add_f32 v60, v60, v74
v_add_f32 v60, v60, v75
v_add_f32 v61, v61, v76
v_add_f32 v61, v61, v77
v_add_f32 v61, v61, v78
v_add_f32 v61, v61, v79
CV 96,64
CV 97,66
CV 100,68
CV 101,70
CV 98,72
CV 99,74
CV 102,76
CV 103,78
s_add_u32 m0, s78, 0
s_add_u32 s92, s94, 0
G 56,36,92,0
G 57,36,92,1
G 56,36,92,2
G 57,36,92,3
s_add_u32 m0, s78, 4096
s_add_u32 s92, s94, 512
G 56,36,92,0
G 57,36,92,1
G 56,36,92,2
G 57,36,92,3
s_waitcnt vmcnt(0)
v_and_b32 v0, 0x1fff, v16
v_add_u32 v0, s78, v0
T 32,0,0
T 34,0,4
v_and_b32 v0, 0x1fff, v17
v_add_u32 v0, s78, v0
T 36,0,0
T 38,0,4
v_and_b32 v0, 0x1fff, v18
v_add_u32 v0, s78, v0
T 40,0,0
T 42,0,4
v_and_b32 v0, 0x1fff, v19
v_add_u32 v0, s78, v0
T 44,0,0
T 46,0,4
v_and_b32 v0, 0x1fff, v20
v_add_u32 v0, s78, v0
T 48,0,0
T 50,0,4
v_and_b32 v0, 0x1fff, v21
v_add_u32 v0, s78, v0
T 52,0,0
T 54,0,4
v_and_b32 v0, 0x1fff, v22
v_add_u32 v0, s78, v0
T 56,0,0
T 58,0,4
v_and_b32 v0, 0x1fff, v23
v_add_u32 v0, s78, v0
T 60,0,0
W 14
T 62,0,4
W 14
MA 128,32,96
MA 132,32,100
W 12
MA 136,36,96
MA 140,36,100
W 10
MA 144,40,96
MA 148,40,100
W 8
MA 152,44,96
MA 156,44,100
W 6
MA 160,48,96
MA 164,48,100
W 4
MA 168,52,96
MA 172,52,100
W 2
MA 176,56,96
MA 180,56,100
W 0
MA 184,60,96
MA 188,60,100
s_nop 15
s_or_b32 s81, s81, 0x7ffe8fff
s_add_u32 s81, s81, 1
s_and_b32 s81, s81, 0x17000
s_add_u32 s94, s80, s81
s_cmp_lg_u32 s81, 0
s_cbranch_scc1 L_slow2_c0B1
v_mov_b32 v1, v60
s_nop 1
v_permlane32_swap_b32 v1, v60
v_add_f32 v60, v60, v1
v_mov_b32 v1, v60
s_nop 1
v_permlane16_swap_b32 v1, v60
v_add_f32 v60, v60, v1
v_mov_b32 v1, v61
s_nop 1
v_permlane32_swap_b32 v1, v61
v_add_f32 v61, v61, v1
v_mov_b32 v1, v61
s_nop 1
v_permlane16_swap_b32 v1, v61
v_add_f32 v61, v61, v1
s_mov_b32 m0, s93
s_nop 4
s_branch L_back_c0B1
L_slow_c0A0:
s_waitcnt vmcnt(0) lgkmcnt(0)
s_nop 15
s_mov_b32 s93, m0
s_andn2_b32 s80, s64, 0x1ff00
s_xor_b32 s80, s80, 0x0
v_mov_b32 v62, 0xff800000
v_mov_b32 v63, 0xff800000
s_mov_b32 s94, s80
s_mov_b32 s81, 0
L_slow1_c0A0:
s_add_u32 m0, s78, 0
s_add_u32 s92, s94, 0
G 32,12,92,0
G 33,12,92,1
G 34,12,92,2
G 35,12,92,3
s_add_u32 m0, s78, 4096
s_add_u32 s92, s94, 512
G 32,12,92,0
G 33,12,92,1
G 34,12,92,2
G 35,12,92,3
s_waitcnt vmcnt(0)
v_and_b32 v0, 0x1fff, v8
v_add_u32 v0, s78, v0
R a,32,0,0
R a,48,0,4
v_and_b32 v0, 0x1fff, v9
v_add_u32 v0, s78, v0
R a,36,0,0
R a,52,0,4
v_and_b32 v0, 0x1fff, v10
v_add_u32 v0, s78, v0
R a,40,0,0
R a,56,0,4
v_and_b32 v0, 0x1fff, v11
v_add_u32 v0, s78, v0
R a,44,0,0
R a,60,0,4
W 7
ZB 64,32,192
ZB 68,32,196
W 5
MB 64,36,200
MB 68,36,204
W 3
MB 64,40,208
MB 68,40,212
W 1
MB 64,44,216
MB 68,44,220
ZB 72,48,192
ZB 76,48,196
MB 72,52,200
MB 76,52,204
MB 72,56,208
MB 76,56,212
W 0
MB 72,60,216
MB 76,60,220
v_max_f32 v62, v62, v64
v_max_f32 v62, v62, v65
v_max_f32 v62, v62, v66
v_max_f32 v62, v62, v67
v_max_f32 v63, v63, v68
v_max_f32 v63, v63, v69
v_max_f32 v63, v63, v70
v_max_f32 v63, v63, v71
v_max_f32 v62, v62, v72
v_max_f32 v62, v62, v73
v_max_f32 v62, v62, v74
v_max_f32 v62, v62, v75
v_max_f32 v63, v63, v76
v_max_f32 v63, v63, v77
v_max_f32 v63, v63, v78
v_max_f32 v63, v63, v79
s_or_b32 s81, s81, 0x7ffe8fff
s_add_u32 s81, s81, 1
s_and_b32 s81, s81, 0x17000
s_add_u32 s94, s80, s81
s_cmp_lg_u32 s81, 0
s_cbranch_scc1 L_slow1_c0A0
v_mov_b32 v1, v62
s_nop 1
v_permlane32_swap_b32 v1, v62
v_max_f32 v62, v62, v1
v_mov_b32 v1, v62
s_nop 1
v_permlane16_swap_b32 v1, v62
v_max_f32 v62, v62, v1
v_mov_b32 v1, v63
s_nop 1
v_permlane32_swap_b32 v1, v63
v_max_f32 v63, v63, v1
v_mov_b32 v1, v63
s_nop 1
v_permlane16_swap_b32 v1, v63
v_max_f32 v63, v63, v1
v_mov_b32 v60, 0
v_mov_b32 v61, 0
v_mov_b32 v128, 0
v_mov_b32 v129, 0
v_mov_b32 v130, 0
v_mov_b32 v131, 0
v_mov_b32 v132, 0
v_mov_b32 v133, 0
v_mov_b32 v134, 0
v_mov_b32 v135, 0
v_mov_b32 v136, 0
v_mov_b32 v137, 0
v_mov_b32 v138, 0
v_mov_b32 v139, 0
v_mov_b32 v140, 0
v_mov_b32 v141, 0
v_mov_b32 v142, 0
v_mov_b32 v143, 0
v_mov_b32 v144, 0
v_mov_b32 v145, 0
v_mov_b32 v146, 0
v_mov_b32 v147, 0
v_mov_b32 v148, 0
v_mov_b32 v149, 0
v_mov_b32 v150, 0
v_mov_b32 v151, 0
v_mov_b32 v152, 0
v_mov_b32 v153, 0
v_mov_b32 v154, 0
v_mov_b32 v155, 0
v_mov_b32 v156, 0
v_mov_b32 v157, 0
v_mov_b32 v158, 0
v_mov_b32 v159, 0
v_mov_b32 v160, 0
v_mov_b32 v161, 0
v_mov_b32 v162, 0
v_mov_b32 v163, 0
v_mov_b32 v164, 0
v_mov_b32 v165, 0
v_mov_b32 v166, 0
v_mov_b32 v167, 0
v_mov_b32 v168, 0
v_mov_b32 v169, 0
v_mov_b32 v170, 0
v_mov_b32 v171, 0
v_mov_b32 v172, 0
v_mov_b32 v173, 0
v_mov_b32 v174, 0
v_mov_b32 v175, 0
v_mov_b32 v176, 0
v_mov_b32 v177, 0
v_mov_b32 v178, 0
v_mov_b32 v179, 0
v_mov_b32 v180, 0
v_mov_b32 v181, 0
v_mov_b32 v182, 0
v_mov_b32 v183, 0
v_mov_b32 v184, 0
v_mov_b32 v185, 0
v_mov_b32 v186, 0
v_mov_b32 v187, 0
v_mov_b32 v188, 0
v_mov_b32 v189, 0
v_mov_b32 v190, 0
v_mov_b32 v191, 0
s_mov_b32 s94, s80
s_mov_b32 s81, 0
s_nop 4
L_slow2_c0A0:
s_add_u32 m0, s78, 0
s_add_u32 s92, s94, 0
G 32,12,92,0
G 33,12,92,1
G 34,12,92,2
G 35,12,92,3
s_add_u32 m0, s78, 4096
s_add_u32 s92, s94, 512
G 32,12,92,0
G 33,12,92,1
G 34,12,92,2
G 35,12,92,3
s_waitcnt vmcnt(0)
v_and_b32 v0, 0x1fff, v8
v_add_u32 v0, s78, v0
R a,32,0,0
R a,48,0,4
v_and_b32 v0, 0x1fff, v9
v_add_u32 v0, s78, v0
R a,36,0,0
R a,52,0,4
v_and_b32 v0, 0x1fff, v10
v_add_u32 v0, s78, v0
R a,40,0,0
R a,56,0,4
v_and_b32 v0, 0x1fff, v11
v_add_u32 v0, s78, v0
R a,44,0,0
R a,60,0,4
W 7
ZB 64,32,192
ZB 68,32,196
W 5
MB 64,36,200
MB 68,36,204
W 3
MB 64,40,208
MB 68,40,212
W 1
MB 64,44,216
MB 68,44,220
ZB 72,48,192
ZB 76,48,196
MB 72,52,200
MB 76,52,204
MB 72,56,208
MB 76,56,212
W 0
MB 72,60,216
MB 76,60,220
v_sub_f32 v64, v64, v62
v_sub_f32 v65, v65, v62
v_sub_f32 v66, v66, v62
v_sub_f32 v67, v67, v62
v_sub_f32 v68, v68, v63
v_sub_f32 v69, v69, v63
v_sub_f32 v70, v70, v63
v_sub_f32 v71, v71, v63
v_sub_f32 v72, v72, v62
v_sub_f32 v73, v73, v62
v_sub_f32 v74, v74, v62
v_sub_f32 v75, v75, v62
v_sub_f32 v76, v76, v63
v_sub_f32 v77, v77, v63
v_sub_f32 v78, v78, v63
v_sub_f32 v79, v79, v63
E 64
E 65
E 66
E 67
E 68
E 69
E 70
E 71
E 72
E 73
E 74
E 75
E 76
E 77
E 78
E 79
v_add_f32 v60, v60, v64
v_add_f32 v60, v60, v65
v_add_f32 v60, v60, v66
v_add_f32 v60, v60, v67
v_add_f32 v61, v61, v68
v_add_f32 v61, v61, v69
v_add_f32 v61, v61, v70
v_add_f32 v61, v61, v71
v_add_f32 v60, v60, v72
v_add_f32 v60, v60, v73
v_add_f32 v60, v60, v74
v_add_f32 v60, v60, v75
v_add_f32 v61, v61, v76
v_add_f32 v61, v61, v77
v_add_f32 v61, v61, v78
v_add_f32 v61, v61, v79
CV 96,64
CV 97,66
CV 100,68
CV 101,70
CV 98,72
CV 99,74
CV 102,76
CV 103,78
s_add_u32 m0, s78, 0
s_add_u32 s92, s94, 0
G 56,16,92,0
G 57,16,92,1
G 56,16,92,2
G 57,16,92,3
s_add_u32 m0, s78, 4096
s_add_u32 s92, s94, 512
G 56,16,92,0
G 57,16,92,1
G 56,16,92,2
G 57,16,92,3
s_waitcnt vmcnt(0)
v_and_b32 v0, 0x1fff, v16
v_add_u32 v0, s78, v0
T 32,0,0
T 34,0,4
v_and_b32 v0, 0x1fff, v17
v_add_u32 v0, s78, v0
T 36,0,0
T 38,0,4
v_and_b32 v0, 0x1fff, v18
v_add_u32 v0, s78, v0
T 40,0,0
T 42,0,4
v_and_b32 v0, 0x1fff, v19
v_add_u32 v0, s78, v0
T 44,0,0
T 46,0,4
v_and_b32 v0, 0x1fff, v20
v_add_u32 v0, s78, v0
T 48,0,0
T 50,0,4
v_and_b32 v0, 0x1fff, v21
v_add_u32 v0, s78, v0
T 52,0,0
T 54,0,4
v_and_b32 v0, 0x1fff, v22
v_add_u32 v0, s78, v0
T 56,0,0
T 58,0,4
v_and_b32 v0, 0x1fff, v23
v_add_u32 v0, s78, v0
T 60,0,0
W 14
T 62,0,4
W 14
MA 128,32,96
MA 132,32,100
W 12
MA 136,36,96
MA 140,36,100
W 10
MA 144,40,96
MA 148,40,100
W 8
MA 152,44,96
MA 156,44,100
W 6
MA 160,48,96
MA 164,48,100
W 4
MA 168,52,96
MA 172,52,100
W 2
MA 176,56,96
MA 180,56,100
W 0
MA 184,60,96
MA 188,60,100
s_nop 15
s_or_b32 s81, s81, 0x7ffe8fff
s_add_u32 s81, s81, 1
s_and_b32 s81, s81, 0x17000
s_add_u32 s94, s80, s81
s_cmp_lg_u32 s81, 0
s_cbranch_scc1 L_slow2_c0A0
v_mov_b32 v1, v60
s_nop 1
v_permlane32_swap_b32 v1, v60
v_add_f32 v60, v60, v1
v_mov_b32 v1, v60
s_nop 1
v_permlane16_swap_b32 v1, v60
v_add_f32 v60, v60, v1
v_mov_b32 v1, v61
s_nop 1
v_permlane32_swap_b32 v1, v61
v_add_f32 v61, v61, v1
v_mov_b32 v1, v61
s_nop 1
v_permlane16_swap_b32 v1, v61
v_add_f32 v61, v61, v1
s_mov_b32 m0, s93
s_nop 4
s_branch L_back_c0A0
L_slow_c0A1:
s_waitcnt vmcnt(0) lgkmcnt(0)
s_nop 15
s_mov_b32 s93, m0
s_andn2_b32 s80, s64, 0x1ff00
s_xor_b32 s80, s80, 0x0
v_mov_b32 v62, 0xff800000
v_mov_b32 v63, 0xff800000
s_mov_b32 s94, s80
s_mov_b32 s81, 0
L_slow1_c0A1:
s_add_u32 m0, s78, 0
s_add_u32 s92, s94, 0
G 32,12,92,0
G 33,12,92,1
G 34,12,92,2
G 35,12,92,3
s_add_u32 m0, s78, 4096
s_add_u32 s92, s94, 512
G 32,12,92,0
G 33,12,92,1
G 34,12,92,2
G 35,12,92,3
s_waitcnt vmcnt(0)
v_and_b32 v0, 0x1fff, v8
v_add_u32 v0, s78, v0
R a,32,0,0
R a,48,0,4
v_and_b32 v0, 0x1fff, v9
v_add_u32 v0, s78, v0
R a,36,0,0
R a,52,0,4
v_and_b32 v0, 0x1fff, v10
v_add_u32 v0, s78, v0
R a,40,0,0
R a,56,0,4
v_and_b32 v0, 0x1fff, v11
v_add_u32 v0, s78, v0
R a,44,0,0
R a,60,0,4
W 7
ZB 64,32,224
ZB 68,32,228
W 5
MB 64,36,232
MB 68,36,236
W 3
MB 64,40,240
MB 68,40,244
W 1
MB 64,44,248
MB 68,44,252
ZB 72,48,224
ZB 76,48,228
MB 72,52,232
MB 76,52,236
MB 72,56,240
MB 76,56,244
W 0
MB 72,60,248
MB 76,60,252
v_max_f32 v62, v62, v64
v_max_f32 v62, v62, v65
v_max_f32 v62, v62, v66
v_max_f32 v62, v62, v67
v_max_f32 v63, v63, v68
v_max_f32 v63, v63, v69
v_max_f32 v63, v63, v70
v_max_f32 v63, v63, v71
v_max_f32 v62, v62, v72
v_max_f32 v62, v62, v73
v_max_f32 v62, v62, v74
v_max_f32 v62, v62, v75
v_max_f32 v63, v63, v76
v_max_f32 v63, v63, v77
v_max_f32 v63, v63, v78
v_max_f32 v63, v63, v79
s_or_b32 s81, s81, 0x7ffe8fff
s_add_u32 s81, s81, 1
s_and_b32 s81, s81, 0x17000
s_add_u32 s94, s80, s81
s_cmp_lg_u32 s81, 0
s_cbranch_scc1 L_slow1_c0A1
v_mov_b32 v1, v62
s_nop 1
v_permlane32_swap_b32 v1, v62
v_max_f32 v62, v62, v1
v_mov_b32 v1, v62
s_nop 1
v_permlane16_swap_b32 v1, v62
v_max_f32 v62, v62, v1
v_mov_b32 v1, v63
s_nop 1
v_permlane32_swap_b32 v1, v63
v_max_f32 v63, v63, v1
v_mov_b32 v1, v63
s_nop 1
v_permlane16_swap_b32 v1, v63
v_max_f32 v63, v63, v1
v_mov_b32 v60, 0
v_mov_b32 v61, 0
v_mov_b32 v192, 0
v_mov_b32 v193, 0
v_mov_b32 v194, 0
v_mov_b32 v195, 0
v_mov_b32 v196, 0
v_mov_b32 v197, 0
v_mov_b32 v198, 0
v_mov_b32 v199, 0
v_mov_b32 v200, 0
v_mov_b32 v201, 0
v_mov_b32 v202, 0
v_mov_b32 v203, 0
v_mov_b32 v204, 0
v_mov_b32 v205, 0
v_mov_b32 v206, 0
v_mov_b32 v207, 0
v_mov_b32 v208, 0
v_mov_b32 v209, 0
v_mov_b32 v210, 0
v_mov_b32 v211, 0
v_mov_b32 v212, 0
v_mov_b32 v213, 0
v_mov_b32 v214, 0
v_mov_b32 v215, 0
v_mov_b32 v216, 0
v_mov_b32 v217, 0
v_mov_b32 v218, 0
v_mov_b32 v219, 0
v_mov_b32 v220, 0
v_mov_b32 v221, 0
v_mov_b32 v222, 0
v_mov_b32 v223, 0
v_mov_b32 v224, 0
v_mov_b32 v225, 0
v_mov_b32 v226, 0
v_mov_b32 v227, 0
v_mov_b32 v228, 0
v_mov_b32 v229, 0
v_mov_b32 v230, 0
v_mov_b32 v231, 0
v_mov_b32 v232, 0
v_mov_b32 v233, 0
v_mov_b32 v234, 0
v_mov_b32 v235, 0
v_mov_b32 v236, 0
v_mov_b32 v237, 0
v_mov_b32 v238, 0
v_mov_b32 v239, 0
v_mov_b32 v240, 0
v_mov_b32 v241, 0
v_mov_b32 v242, 0
v_mov_b32 v243, 0
v_mov_b32 v244, 0
v_mov_b32 v245, 0
v_mov_b32 v246, 0
v_mov_b32 v247, 0
v_mov_b32 v248, 0
v_mov_b32 v249, 0
v_mov_b32 v250, 0
v_mov_b32 v251, 0
v_mov_b32 v252, 0
v_mov_b32 v253, 0
v_mov_b32 v254, 0
v_mov_b32 v255, 0
s_mov_b32 s94, s80
s_mov_b32 s81, 0
s_nop 4
L_slow2_c0A1:
s_add_u32 m0, s78, 0
s_add_u32 s92, s94, 0
G 32,12,92,0
G 33,12,92,1
G 34,12,92,2
G 35,12,92,3
s_add_u32 m0, s78, 4096
s_add_u32 s92, s94, 512
G 32,12,92,0
G 33,12,92,1
G 34,12,92,2
G 35,12,92,3
s_waitcnt vmcnt(0)
v_and_b32 v0, 0x1fff, v8
v_add_u32 v0, s78, v0
R a,32,0,0
R a,48,0,4
v_and_b32 v0, 0x1fff, v9
v_add_u32 v0, s78, v0
R a,36,0,0
R a,52,0,4
v_and_b32 v0, 0x1fff, v10
v_add_u32 v0, s78, v0
R a,40,0,0
R a,56,0,4
v_and_b32 v0, 0x1fff, v11
v_add_u32 v0, s78, v0
R a,44,0,0
R a,60,0,4
W 7
ZB 64,32,224
ZB 68,32,228
W 5
MB 64,36,232
MB 68,36,236
W 3
MB 64,40,240
MB 68,40,244
W 1
MB 64,44,248
MB 68,44,252
ZB 72,48,224
ZB 76,48,228
MB 72,52,232
MB 76,52,236
MB 72,56,240
MB 76,56,244
W 0
MB 72,60,248
MB 76,60,252
v_sub_f32 v64, v64, v62
v_sub_f32 v65, v65, v62
v_sub_f32 v66, v66, v62
v_sub_f32 v67, v67, v62
v_sub_f32 v68, v68, v63
v_sub_f32 v69, v69, v63
v_sub_f32 v70, v70, v63
v_sub_f32 v71, v71, v63
v_sub_f32 v72, v72, v62
v_sub_f32 v73, v73, v62
v_sub_f32 v74, v74, v62
v_sub_f32 v75, v75, v62
v_sub_f32 v76, v76, v63
v_sub_f32 v77, v77, v63
v_sub_f32 v78, v78, v63
v_sub_f32 v79, v79, v63
E 64
E 65
E 66
E 67
E 68
E 69
E 70
E 71
E 72
E 73
E 74
E 75
E 76
E 77
E 78
E 79
v_add_f32 v60, v60, v64
v_add_f32 v60, v60, v65
v_add_f32 v60, v60, v66
v_add_f32 v60, v60, v67
v_add_f32 v61, v61, v68
v_add_f32 v61, v61, v69
v_add_f32 v61, v61, v70
v_add_f32 v61, v61, v71
v_add_f32 v60, v60, v72
v_add_f32 v60, v60, v73
v_add_f32 v60, v60, v74
v_add_f32 v60, v60, v75
v_add_f32 v61, v61, v76
v_add_f32 v61, v61, v77
v_add_f32 v61, v61, v78
v_add_f32 v61, v61, v79
CV 96,64
CV 97,66
CV 100,68
CV 101,70
CV 98,72
CV 99,74
CV 102,76
CV 103,78
s_add_u32 m0, s78, 0
s_add_u32 s92, s94, 0
G 56,16,92,0
G 57,16,92,1
G 56,16,92,2
G 57,16,92,3
s_add_u32 m0, s78, 4096
s_add_u32 s92, s94, 512
G 56,16,92,0
G 57,16,92,1
G 56,16,92,2
G 57,16,92,3
s_waitcnt vmcnt(0)
v_and_b32 v0, 0x1fff, v16
v_add_u32 v0, s78, v0
T 32,0,0
T 34,0,4
v_and_b32 v0, 0x1fff, v17
v_add_u32 v0, s78, v0
T 36,0,0
T 38,0,4
v_and_b32 v0, 0x1fff, v18
v_add_u32 v0, s78, v0
T 40,0,0
T 42,0,4
v_and_b32 v0, 0x1fff, v19
v_add_u32 v0, s78, v0
T 44,0,0
T 46,0,4
v_and_b32 v0, 0x1fff, v20
v_add_u32 v0, s78, v0
T 48,0,0
T 50,0,4
v_and_b32 v0, 0x1fff, v21
v_add_u32 v0, s78, v0
T 52,0,0
T 54,0,4
v_and_b32 v0, 0x1fff, v22
v_add_u32 v0, s78, v0
T 56,0,0
T 58,0,4
v_and_b32 v0, 0x1fff, v23
v_add_u32 v0, s78, v0
T 60,0,0
W 14
T 62,0,4
W 14
MA 192,32,96
MA 196,32,100
W 12
MA 200,36,96
MA 204,36,100
W 10
MA 208,40,96
MA 212,40,100
W 8
MA 216,44,96
MA 220,44,100
W 6
MA 224,48,96
MA 228,48,100
W 4
MA 232,52,96
MA 236,52,100
W 2
MA 240,56,96
MA 244,56,100
W 0
MA 248,60,96
MA 252,60,100
s_nop 15
s_or_b32 s81, s81, 0x7ffe8fff
s_add_u32 s81, s81, 1
s_and_b32 s81, s81, 0x17000
s_add_u32 s94, s80, s81
s_cmp_lg_u32 s81, 0
s_cbranch_scc1 L_slow2_c0A1
v_mov_b32 v1, v60
s_nop 1
v_permlane32_swap_b32 v1, v60
v_add_f32 v60, v60, v1
v_mov_b32 v1, v60
s_nop 1
v_permlane16_swap_b32 v1, v60
v_add_f32 v60, v60, v1
v_mov_b32 v1, v61
s_nop 1
v_permlane32_swap_b32 v1, v61
v_add_f32 v61, v61, v1
v_mov_b32 v1, v61
s_nop 1
v_permlane16_swap_b32 v1, v61
v_add_f32 v61, v61, v1
s_mov_b32 m0, s93
s_nop 4
s_branch L_back_c0A1
L_wi_c0:
s_sleep 6
v_mov_b32 v62, 0
buffer_load_dword v4, v62, s[96:99], s87 offen sc1
s_waitcnt vmcnt(0)
s_add_u32 s6, s6, 1
s_cmp_ge_u32 s6, 0x100000
s_cbranch_scc1 L_gi_c0
s_branch L_ci_c0
L_we_c0:
s_sleep 6
buffer_load_dword v3, v7, s[52:55], s72 offen offset:256 sc1
buffer_load_dword v4, v7, s[52:55], s72 offen offset:384 sc1
s_waitcnt vmcnt(0)
s_add_u32 s6, s6, 1
s_cmp_ge_u32 s6, 0x100000
s_cbranch_scc1 L_ge_c0
s_branch L_ce_c0
L_wm_c0:
s_sleep 6
buffer_load_dword v0, v7, s[52:55], s72 offen offset:0 sc1
s_waitcnt vmcnt(0)
s_add_u32 s6, s6, 1
s_cmp_ge_u32 s6, 0x100000
s_cbranch_scc1 L_gm_c0
s_branch L_cm_c0
L_wl_c0:
s_sleep 6
buffer_load_dword v4, v7, s[52:55], s72 offen offset:128 sc1
s_waitcnt vmcnt(0)
s_add_u32 s6, s6, 1
s_cmp_ge_u32 s6, 0x100000
s_cbranch_scc1 L_gl_c0
s_branch L_cl_c0
.p2align 6
L_prog1:
s_waitcnt vmcnt(12)
s_barrier
R v,128,8,0
R v,132,8,4
R v,136,9,0
R v,140,9,4
R v,144,10,0
R v,148,10,4
R v,152,11,0
R v,156,11,4
T 0,16,16
T 2,16,20
T 4,17,16
T 6,17,20
T 8,18,16
T 10,18,20
T 12,19,16
W 14
T 14,19,20
W 14
T 16,20,16
W 14
T 18,20,20
s_xor_b32 m0, s65, 0x14000
s_xor_b32 s66, s61, 0xc0000
G 40,40,66,0
G 41,40,66,1
W 6
ZA 64,0,128
G 42,40,66,2
ZA 68,0,132
G 43,40,66,3
T 20,21,16
T 22,21,20
ZA 72,4,128
s_xor_b32 m0, s65, 0x18000
s_xor_b32 s66, s61, 0x100000
G 40,40,66,0
ZA 76,4,132
G 41,40,66,1
T 24,22,16
T 26,22,20
W 6
ZA 80,8,128
G 42,40,66,2
ZA 84,8,132
G 43,40,66,3
T 28,23,16
T 30,23,20
ZA 88,12,128
s_waitcnt vmcnt(16)
s_barrier
T 32,16,32
ZA 92,12,132
T 34,16,36
s_xor_b32 m0, s65, 0x1c000
s_xor_b32 s66, s61, 0x140000
W 6
ZA 96,16,128
G 40,40,66,0
ZA 100,16,132
T 36,17,32
T 38,17,36
ZA 104,20,128
G 41,40,66,1
ZA 108,20,132
T 40,18,32
T 42,18,36
W 6
ZA 112,24,128
G 42,40,66,2
ZA 116,24,132
T 44,19,32
T 46,19,36
ZA 120,28,128
G 43,40,66,3
ZA 124,28,132
T 48,20,32
T 50,20,36
W 6
MA 64,32,136
s_waitcnt vmcnt(16)
s_barrier
s_xor_b32 m0, s65, 0x0
s_xor_b32 s66, s60, 0x200
G 36,28,66,0
MA 68,32,140
G 37,28,66,1
T 52,21,32
T 54,21,36
R v,160,8,48
MA 72,36,136
G 38,28,66,2
MA 76,36,140
T 56,22,32
T 58,22,36
R v,164,8,52
W 8
MA 80,40,136
G 39,28,66,3
MA 84,40,140
T 60,23,32
T 62,23,36
R v,168,9,48
MA 88,44,136
s_waitcnt vmcnt(16)
s_barrier
MA 92,44,140
R v,172,9,52
T 0,24,0
T 2,24,4
W 10
MA 96,48,136
R v,176,10,48
MA 100,48,140
T 4,25,0
T 6,25,4
MA 104,52,136
R v,180,10,52
MA 108,52,140
T 8,26,0
W 14
T 10,26,4
W 10
MA 112,56,136
R v,184,11,48
MA 116,56,140
T 12,27,0
T 14,27,4
MA 120,60,136
R v,188,11,52
MA 124,60,140
T 16,28,0
W 14
T 18,28,4
W 9
MA 64,0,144
T 20,29,0
MA 68,0,148
T 22,29,4
MA 72,4,144
T 24,30,0
MA 76,4,148
T 26,30,4
W 7
MA 80,8,144
T 28,31,0
MA 84,8,148
T 30,31,4
MA 88,12,144
s_waitcnt vmcnt(12) lgkmcnt(8)
s_barrier
s_xor_b32 m0, s65, 0x4000
s_xor_b32 s66, s61, 0x180000
MA 92,12,148
G 40,40,66,0
T 32,24,16
T 34,24,20
W 6
MA 96,16,144
G 41,40,66,1
MA 100,16,148
T 36,25,16
T 38,25,20
MA 104,20,144
G 42,40,66,2
MA 108,20,148
T 40,26,16
T 42,26,20
v_mov_b32 v61, 0
v_lshlrev_b32 v62, 3, v59
s_mov_b64 exec, 15
buffer_store_dword v61, v62, s[52:55], s5 offen sc1
s_mov_b64 exec, -1
W 6
MA 112,24,144
G 43,40,66,3
MA 116,24,148
T 44,27,16
T 46,27,20
MA 120,28,144
s_xor_b32 m0, s65, 0x8000
s_xor_b32 s66, s61, 0x1c0000
MA 124,28,148
G 40,40,66,0
T 48,28,16
T 50,28,20
W 6
MA 64,32,152
G 41,40,66,1
MA 68,32,156
T 52,29,16
T 54,29,20
MA 72,36,152
G 42,40,66,2
MA 76,36,156
T 56,30,16
T 58,30,20
W 6
MA 80,40,152
G 43,40,66,3
MA 84,40,156
T 60,31,16
T 62,31,20
MA 88,44,152
s_waitcnt vmcnt(17)
s_barrier
T 0,24,32
MA 92,44,156
T 2,24,36
s_xor_b32 m0, s65, 0xc000
s_xor_b32 s66, s61, 0x200000
W 6
MA 96,48,152
G 40,40,66,0
MA 100,48,156
T 4,25,32
T 6,25,36
MA 104,52,152
T 8,26,32
MA 108,52,156
T 10,26,36
W 6
MA 112,56,152
G 41,40,66,1
MA 116,56,156
T 12,27,32
T 14,27,36
MA 120,60,152
T 16,28,32
MA 124,60,156
T 18,28,36
W 6
MA 64,0,160
G 42,40,66,2
MA 68,0,164
T 20,29,32
T 22,29,36
MA 72,4,160
T 24,30,32
MA 76,4,164
T 26,30,36
W 6
MA 80,8,160
G 43,40,66,3
MA 84,8,164
T 28,31,32
T 30,31,36
MA 88,12,160
s_waitcnt vmcnt(17)
s_barrier
T 32,24,48
MA 92,12,164
T 34,24,52
s_xor_b32 m0, s65, 0x10000
s_xor_b32 s66, s61, 0x240000
W 6
MA 96,16,160
G 40,40,66,0
MA 100,16,164
T 36,25,48
T 38,25,52
MA 104,20,160
G 41,40,66,1
MA 108,20,164
T 40,26,48
T 42,26,52
W 6
MA 112,24,160
G 42,40,66,2
MA 116,24,164
T 44,27,48
T 46,27,52
MA 120,28,160
G 43,40,66,3
MA 124,28,164
T 48,28,48
T 50,28,52
W 6
MA 64,32,168
s_waitcnt vmcnt(17)
s_barrier
s_xor_b32 m0, s65, 0x14000
s_xor_b32 s66, s60, 0x300
G 36,28,66,0
MA 68,32,172
G 37,28,66,1
T 52,29,48
T 54,29,52
R v,192,8,0
MA 72,36,168
G 38,28,66,2
MA 76,36,172
T 56,30,48
T 58,30,52
R v,196,8,4
W 8
MA 80,40,168
G 39,28,66,3
MA 84,40,172
T 60,31,48
T 62,31,52
R v,200,9,0
MA 88,44,168
s_waitcnt vmcnt(16)
s_barrier
MA 92,44,172
R v,204,9,4
T 0,16,16
T 2,16,20
W 10
MA 96,48,168
R v,208,10,0
MA 100,48,172
T 4,17,16
T 6,17,20
MA 104,52,168
R v,212,10,4
MA 108,52,172
T 8,18,16
W 14
T 10,18,20
W 10
MA 112,56,168
R v,216,11,0
MA 116,56,172
T 12,19,16
T 14,19,20
MA 120,60,168
R v,220,11,4
MA 124,60,172
T 16,20,16
W 14
T 18,20,20
W 9
MA 64,0,176
T 20,21,16
MA 68,0,180
T 22,21,20
MA 72,4,176
T 24,22,16
MA 76,4,180
T 26,22,20
W 7
MA 80,8,176
T 28,23,16
MA 84,8,180
T 30,23,20
MA 88,12,176
s_waitcnt vmcnt(12) lgkmcnt(8)
s_barrier
s_xor_b32 m0, s65, 0x18000
s_xor_b32 s66, s61, 0x280000
MA 92,12,180
G 40,40,66,0
T 32,16,32
T 34,16,36
W 6
MA 96,16,176
G 41,40,66,1
MA 100,16,180
T 36,17,32
T 38,17,36
MA 104,20,176
G 42,40,66,2
MA 108,20,180
T 40,18,32
T 42,18,36
W 6
MA 112,24,176
G 43,40,66,3
MA 116,24,180
T 44,19,32
T 46,19,36
MA 120,28,176
s_xor_b32 m0, s65, 0x1c000
s_xor_b32 s66, s61, 0x2c0000
MA 124,28,180
G 40,40,66,0
T 48,20,32
T 50,20,36
W 6
MA 64,32,184
G 41,40,66,1
MA 68,32,188
T 52,21,32
T 54,21,36
MA 72,36,184
G 42,40,66,2
MA 76,36,188
T 56,22,32
T 58,22,36
W 6
MA 80,40,184
G 43,40,66,3
MA 84,40,188
T 60,23,32
T 62,23,36
MA 88,44,184
s_waitcnt vmcnt(16)
s_barrier
T 0,16,48
MA 92,44,188
T 2,16,52
s_xor_b32 m0, s65, 0x0
s_xor_b32 s66, s61, 0x300000
W 6
MA 96,48,184
G 40,40,66,0
MA 100,48,188
T 4,17,48
T 6,17,52
MA 104,52,184
T 8,18,48
MA 108,52,188
T 10,18,52
W 6
MA 112,56,184
G 41,40,66,1
MA 116,56,188
T 12,19,48
T 14,19,52
MA 120,60,184
T 16,20,48
MA 124,60,188
T 18,20,52
W 6
MA 64,0,192
G 42,40,66,2
MA 68,0,196
T 20,21,48
T 22,21,52
MA 72,4,192
T 24,22,48
MA 76,4,196
T 26,22,52
W 6
MA 80,8,192
G 43,40,66,3
MA 84,8,196
T 28,23,48
T 30,23,52
MA 88,12,192
s_waitcnt vmcnt(16)
s_barrier
T 32,24,0
MA 92,12,196
T 34,24,4
s_xor_b32 m0, s65, 0x4000
s_xor_b32 s66, s61, 0x340000
W 6
MA 96,16,192
G 40,40,66,0
MA 100,16,196
T 36,25,0
T 38,25,4
MA 104,20,192
G 41,40,66,1
MA 108,20,196
T 40,26,0
T 42,26,4
v_mov_b32 v61, 1
v_mov_b32 v62, 0
s_mov_b64 exec, 1
buffer_atomic_add v61, v62, s[96:99], s86 offen sc1
s_mov_b64 exec, -1
s_mov_b32 s6, 0
W 6
MA 112,24,192
G 42,40,66,2
MA 116,24,196
T 44,27,0
T 46,27,4
MA 120,28,192
G 43,40,66,3
MA 124,28,196
T 48,28,0
T 50,28,4
W 6
MA 64,32,200
s_waitcnt vmcnt(17)
s_barrier
s_xor_b32 m0, s65, 0x8000
s_xor_b32 s66, s61, 0x380000
G 40,40,66,0
MA 68,32,204
G 41,40,66,1
T 52,29,0
T 54,29,4
R v,224,12,16
MA 72,36,200
G 42,40,66,2
MA 76,36,204
T 56,30,0
T 58,30,4
R v,228,12,20
W 8
MA 80,40,200
G 43,40,66,3
MA 84,40,204
T 60,31,0
T 62,31,4
R v,232,13,16
MA 88,44,200
s_waitcnt vmcnt(17)
s_barrier
MA 92,44,204
R v,236,13,20
T 0,24,32
T 2,24,36
W 10
MA 96,48,200
R v,240,14,16
MA 100,48,204
T 4,25,32
T 6,25,36
MA 104,52,200
R v,244,14,20
MA 108,52,204
T 8,26,32
W 14
T 10,26,36
W 10
MA 112,56,200
R v,248,15,16
MA 116,56,204
T 12,27,32
T 14,27,36
MA 120,60,200
R v,252,15,20
T 16,28,32
MA 124,60,204
W 14
T 18,28,36
v_xor_b32 v8, s70, v8
W 9
MA 64,0,208
T 20,29,32
MA 68,0,212
T 22,29,36
v_xor_b32 v9, s70, v9
MA 72,4,208
T 24,30,32
MA 76,4,212
T 26,30,36
v_xor_b32 v10, s70, v10
W 7
MA 80,8,208
T 28,31,32
MA 84,8,212
T 30,31,36
v_xor_b32 v11, s70, v11
MA 88,12,208
s_waitcnt vmcnt(13) lgkmcnt(8)
s_barrier
s_xor_b32 m0, s65, 0xc000
s_xor_b32 s66, s61, 0x3c0000
MA 92,12,212
G 40,40,66,0
T 32,24,48
T 34,24,52
v_xor_b32 v12, s70, v12
W 6
MA 96,16,208
G 41,40,66,1
MA 100,16,212
T 36,25,48
T 38,25,52
v_xor_b32 v13, s70, v13
MA 104,20,208
G 42,40,66,2
MA 108,20,212
T 40,26,48
T 42,26,52
v_xor_b32 v14, s70, v14
W 6
MA 112,24,208
G 43,40,66,3
MA 116,24,212
T 44,27,48
T 46,27,52
v_xor_b32 v15, s70, v15
MA 120,28,208
s_xor_b32 m0, s65, 0x10000
s_xor_b32 s66, s61, 0x200
MA 124,28,212
G 40,40,66,0
T 48,28,48
T 50,28,52
W 6
MA 64,32,216
G 41,40,66,1
MA 68,32,220
T 52,29,48
T 54,29,52
MA 72,36,216
G 42,40,66,2
MA 76,36,220
T 56,30,48
T 58,30,52
W 6
MA 80,40,216
G 43,40,66,3
MA 84,40,220
T 60,31,48
T 62,31,52
MA 88,44,216
s_waitcnt vmcnt(17)
s_barrier
T 0,16,0
MA 92,44,220
T 2,16,4
s_xor_b32 m0, s65, 0x14000
s_xor_b32 s66, s61, 0x40200
W 6
MA 96,48,216
G 40,40,66,0
MA 100,48,220
T 4,17,0
T 6,17,4
MA 104,52,216
T 8,18,0
MA 108,52,220
T 10,18,4
W 6
MA 112,56,216
G 41,40,66,1
MA 116,56,220
T 12,19,0
T 14,19,4
MA 120,60,216
T 16,20,0
MA 124,60,220
T 18,20,4
W 6
MA 64,0,224
G 42,40,66,2
MA 68,0,228
T 20,21,0
T 22,21,4
MA 72,4,224
T 24,22,0
MA 76,4,228
T 26,22,4
W 6
MA 80,8,224
G 43,40,66,3
MA 84,8,228
T 28,23,0
T 30,23,4
MA 88,12,224
s_waitcnt vmcnt(16)
s_barrier
T 32,16,16
MA 92,12,228
T 34,16,20
s_xor_b32 m0, s65, 0x18000
s_xor_b32 s66, s61, 0x80200
W 6
MA 96,16,224
G 40,40,66,0
MA 100,16,228
T 36,17,16
T 38,17,20
MA 104,20,224
T 40,18,16
MA 108,20,228
T 42,18,20
W 6
MA 112,24,224
G 41,40,66,1
MA 116,24,228
T 44,19,16
T 46,19,20
MA 120,28,224
T 48,20,16
MA 124,28,228
T 50,20,20
W 6
MA 64,32,232
G 42,40,66,2
MA 68,32,236
T 52,21,16
T 54,21,20
MA 72,36,232
T 56,22,16
MA 76,36,236
T 58,22,20
W 6
MA 80,40,232
G 43,40,66,3
MA 84,40,236
T 60,23,16
T 62,23,20
MA 88,44,232
s_waitcnt vmcnt(16)
s_barrier
T 0,16,32
MA 92,44,236
T 2,16,36
s_xor_b32 m0, s65, 0x1c000
s_xor_b32 s66, s61, 0xc0200
W 6
MA 96,48,232
G 40,40,66,0
MA 100,48,236
T 4,17,32
T 6,17,36
MA 104,52,232
T 8,18,32
MA 108,52,236
T 10,18,36
W 6
MA 112,56,232
G 41,40,66,1
MA 116,56,236
T 12,19,32
T 14,19,36
MA 120,60,232
T 16,20,32
MA 124,60,236
T 18,20,36
W 6
MA 64,0,240
G 42,40,66,2
MA 68,0,244
T 20,21,32
T 22,21,36
MA 72,4,240
T 24,22,32
MA 76,4,244
T 26,22,36
W 6
MA 80,8,240
G 43,40,66,3
MA 84,8,244
T 28,23,32
T 30,23,36
MA 88,12,240
s_waitcnt vmcnt(16)
s_barrier
T 32,16,48
MA 92,12,244
T 34,16,52
s_xor_b32 m0, s65, 0x0
s_xor_b32 s66, s61, 0x100200
W 6
MA 96,16,240
G 40,40,66,0
MA 100,16,244
T 36,17,48
T 38,17,52
MA 104,20,240
T 40,18,48
MA 108,20,244
T 42,18,52
W 6
MA 112,24,240
G 41,40,66,1
MA 116,24,244
T 44,19,48
T 46,19,52
MA 120,28,240
T 48,20,48
MA 124,28,244
T 50,20,52
W 6
MA 64,32,248
G 42,40,66,2
MA 68,32,252
T 52,21,48
T 54,21,52
MA 72,36,248
T 56,22,48
MA 76,36,252
T 58,22,52
W 6
MA 80,40,248
G 43,40,66,3
MA 84,40,252
T 60,23,48
T 62,23,52
MA 88,44,248
s_waitcnt vmcnt(16)
s_barrier
T 0,24,0
MA 92,44,252
T 2,24,4
s_xor_b32 m0, s65, 0x4000
s_xor_b32 s66, s61, 0x140200
W 6
MA 96,48,248
G 40,40,66,0
MA 100,48,252
T 4,25,0
T 6,25,4
MA 104,52,248
T 8,26,0
MA 108,52,252
T 10,26,4
W 6
MA 112,56,248
G 41,40,66,1
MA 116,56,252
T 12,27,0
T 14,27,4
MA 120,60,248
T 16,28,0
MA 124,60,252
T 18,28,4
v_pk_mul_f32 v[64:65], v[64:65], s[74:75]
v_pk_mul_f32 v[66:67], v[66:67], s[74:75]
v_pk_mul_f32 v[68:69], v[68:69], s[74:75]
v_pk_mul_f32 v[70:71], v[70:71], s[74:75]
v_pk_mul_f32 v[72:73], v[72:73], s[74:75]
v_pk_mul_f32 v[74:75], v[74:75], s[74:75]
v_pk_mul_f32 v[76:77], v[76:77], s[74:75]
v_pk_mul_f32 v[78:79], v[78:79], s[74:75]
CV 64,64
CV 66,66
CV 68,68
CV 70,70
CV 72,72
CV 74,74
CV 76,76
CV 78,78
v_permlane32_swap_b32 v64, v72
v_permlane32_swap_b32 v66, v74
v_permlane32_swap_b32 v68, v76
v_permlane32_swap_b32 v70, v78
v_permlane16_swap_b32 v64, v72
v_permlane16_swap_b32 v66, v74
v_permlane16_swap_b32 v68, v76
v_permlane16_swap_b32 v70, v78
AW 64,64
AW 65,66
AW 66,72
AW 67,74
AW 68,68
AW 69,70
AW 70,76
AW 71,78
v_pk_mul_f32 v[80:81], v[80:81], s[74:75]
v_pk_mul_f32 v[82:83], v[82:83], s[74:75]
v_pk_mul_f32 v[84:85], v[84:85], s[74:75]
v_pk_mul_f32 v[86:87], v[86:87], s[74:75]
v_pk_mul_f32 v[88:89], v[88:89], s[74:75]
v_pk_mul_f32 v[90:91], v[90:91], s[74:75]
v_pk_mul_f32 v[92:93], v[92:93], s[74:75]
v_pk_mul_f32 v[94:95], v[94:95], s[74:75]
CV 80,80
CV 82,82
CV 84,84
CV 86,86
CV 88,88
CV 90,90
CV 92,92
CV 94,94
v_permlane32_swap_b32 v80, v88
v_permlane32_swap_b32 v82, v90
v_permlane32_swap_b32 v84, v92
v_permlane32_swap_b32 v86, v94
v_permlane16_swap_b32 v80, v88
v_permlane16_swap_b32 v82, v90
v_permlane16_swap_b32 v84, v92
v_permlane16_swap_b32 v86, v94
AW 72,80
AW 73,82
AW 74,88
AW 75,90
AW 76,84
AW 77,86
AW 78,92
AW 79,94
v_pk_mul_f32 v[96:97], v[96:97], s[74:75]
v_pk_mul_f32 v[98:99], v[98:99], s[74:75]
v_pk_mul_f32 v[100:101], v[100:101], s[74:75]
v_pk_mul_f32 v[102:103], v[102:103], s[74:75]
v_pk_mul_f32 v[104:105], v[104:105], s[74:75]
v_pk_mul_f32 v[106:107], v[106:107], s[74:75]
v_pk_mul_f32 v[108:109], v[108:109], s[74:75]
v_pk_mul_f32 v[110:111], v[110:111], s[74:75]
CV 96,96
CV 98,98
CV 100,100
CV 102,102
CV 104,104
CV 106,106
CV 108,108
CV 110,110
v_permlane32_swap_b32 v96, v104
v_permlane32_swap_b32 v98, v106
v_permlane32_swap_b32 v100, v108
v_permlane32_swap_b32 v102, v110
v_permlane16_swap_b32 v96, v104
v_permlane16_swap_b32 v98, v106
v_permlane16_swap_b32 v100, v108
v_permlane16_swap_b32 v102, v110
AW 80,96
AW 81,98
AW 82,104
AW 83,106
AW 84,100
AW 85,102
AW 86,108
AW 87,110
v_pk_mul_f32 v[112:113], v[112:113], s[74:75]
v_pk_mul_f32 v[114:115], v[114:115], s[74:75]
v_pk_mul_f32 v[116:117], v[116:117], s[74:75]
v_pk_mul_f32 v[118:119], v[118:119], s[74:75]
v_pk_mul_f32 v[120:121], v[120:121], s[74:75]
v_pk_mul_f32 v[122:123], v[122:123], s[74:75]
v_pk_mul_f32 v[124:125], v[124:125], s[74:75]
v_pk_mul_f32 v[126:127], v[126:127], s[74:75]
CV 112,112
CV 114,114
CV 116,116
CV 118,118
CV 120,120
CV 122,122
CV 124,124
CV 126,126
v_permlane32_swap_b32 v112, v120
v_permlane32_swap_b32 v114, v122
v_permlane32_swap_b32 v116, v124
v_permlane32_swap_b32 v118, v126
v_permlane16_swap_b32 v112, v120
v_permlane16_swap_b32 v114, v122
v_permlane16_swap_b32 v116, v124
v_permlane16_swap_b32 v118, v126
AW 88,112
AW 89,114
AW 90,120
AW 91,122
AW 92,116
AW 93,118
AW 94,124
AW 95,126
W 6
ZA 64,0,128
G 42,40,66,2
ZA 68,0,132
T 20,29,0
T 22,29,4
ZA 72,4,128
T 24,30,0
ZA 76,4,132
T 26,30,4
W 6
ZA 80,8,128
G 43,40,66,3
ZA 84,8,132
T 28,31,0
T 30,31,4
ZA 88,12,128
s_waitcnt vmcnt(16)
s_barrier
T 32,24,16
ZA 92,12,132
T 34,24,20
s_xor_b32 m0, s65, 0x8000
s_xor_b32 s66, s61, 0x180200
W 6
ZA 96,16,128
G 40,40,66,0
ZA 100,16,132
T 36,25,16
T 38,25,20
ZA 104,20,128
T 40,26,16
ZA 108,20,132
T 42,26,20
W 6
ZA 112,24,128
G 41,40,66,1
ZA 116,24,132
T 44,27,16
T 46,27,20
ZA 120,28,128
T 48,28,16
ZA 124,28,132
T 50,28,20
W 6
MA 64,32,136
G 42,40,66,2
MA 68,32,140
T 52,29,16
T 54,29,20
MA 72,36,136
T 56,30,16
MA 76,36,140
T 58,30,20
W 6
MA 80,40,136
G 43,40,66,3
MA 84,40,140
T 60,31,16
T 62,31,20
MA 88,44,136
s_waitcnt vmcnt(16)
s_barrier
T 0,24,32
MA 92,44,140
T 2,24,36
s_xor_b32 m0, s65, 0xc000
s_xor_b32 s66, s61, 0x1c0200
W 6
MA 96,48,136
G 40,40,66,0
MA 100,48,140
T 4,25,32
T 6,25,36
MA 104,52,136
T 8,26,32
MA 108,52,140
T 10,26,36
W 6
MA 112,56,136
G 41,40,66,1
MA 116,56,140
T 12,27,32
T 14,27,36
MA 120,60,136
T 16,28,32
MA 124,60,140
T 18,28,36
W 6
MA 64,0,144
G 42,40,66,2
MA 68,0,148
T 20,29,32
T 22,29,36
MA 72,4,144
T 24,30,32
MA 76,4,148
T 26,30,36
W 6
MA 80,8,144
G 43,40,66,3
MA 84,8,148
T 28,31,32
T 30,31,36
MA 88,12,144
s_waitcnt vmcnt(16)
s_barrier
T 32,24,48
MA 92,12,148
T 34,24,52
s_xor_b32 m0, s65, 0x10000
s_xor_b32 s66, s61, 0x200200
W 6
MA 96,16,144
G 40,40,66,0
MA 100,16,148
T 36,25,48
T 38,25,52
s_getpc_b64 s[88:89]
L_ct1_129:
s_and_b32 s89, s89, 0xffff
s_mov_b32 s90, L_code_end-L_ct1_129
s_mov_b32 s91, 0x20000
v_and_b32 v62, 0x70, v59
v_lshlrev_b32 v62, 3, v62
s_add_u32 s7, s1, 4096
buffer_load_dword v3, v62, s[88:91], s7 offen
MA 104,20,144
T 40,26,48
MA 108,20,148
T 42,26,52
W 6
MA 112,24,144
G 41,40,66,1
MA 116,24,148
T 44,27,48
T 46,27,52
MA 120,28,144
T 48,28,48
MA 124,28,148
T 50,28,52
W 6
MA 64,32,152
G 42,40,66,2
MA 68,32,156
T 52,29,48
T 54,29,52
MA 72,36,152
T 56,30,48
MA 76,36,156
T 58,30,52
W 6
MA 80,40,152
G 43,40,66,3
MA 84,40,156
T 60,31,48
T 62,31,52
MA 88,44,152
s_waitcnt vmcnt(17)
s_barrier
T 0,16,0
MA 92,44,156
T 2,16,4
s_xor_b32 m0, s65, 0x14000
s_xor_b32 s66, s61, 0x240200
W 6
MA 96,48,152
G 40,40,66,0
MA 100,48,156
T 4,17,0
T 6,17,4
MA 104,52,152
T 8,18,0
MA 108,52,156
T 10,18,4
W 6
MA 112,56,152
G 41,40,66,1
MA 116,56,156
T 12,19,0
T 14,19,4
MA 120,60,152
T 16,20,0
MA 124,60,156
T 18,20,4
W 6
MA 64,0,160
G 42,40,66,2
MA 68,0,164
T 20,21,0
T 22,21,4
MA 72,4,160
T 24,22,0
MA 76,4,164
T 26,22,4
W 6
MA 80,8,160
G 43,40,66,3
MA 84,8,164
T 28,23,0
T 30,23,4
MA 88,12,160
s_waitcnt vmcnt(17)
s_barrier
T 32,16,16
MA 92,12,164
T 34,16,20
s_xor_b32 m0, s65, 0x18000
s_xor_b32 s66, s61, 0x280200
W 6
MA 96,16,160
G 40,40,66,0
MA 100,16,164
T 36,17,16
T 38,17,20
MA 104,20,160
T 40,18,16
MA 108,20,164
T 42,18,20
W 6
MA 112,24,160
G 41,40,66,1
MA 116,24,164
T 44,19,16
T 46,19,20
MA 120,28,160
T 48,20,16
MA 124,28,164
T 50,20,20
W 6
MA 64,32,168
G 42,40,66,2
MA 68,32,172
T 52,21,16
T 54,21,20
MA 72,36,168
T 56,22,16
MA 76,36,172
T 58,22,20
W 6
MA 80,40,168
G 43,40,66,3
MA 84,40,172
T 60,23,16
T 62,23,20
MA 88,44,168
s_waitcnt vmcnt(17)
s_barrier
T 0,16,32
MA 92,44,172
T 2,16,36
s_xor_b32 m0, s65, 0x1c000
s_xor_b32 s66, s61, 0x2c0200
W 6
MA 96,48,168
G 40,40,66,0
MA 100,48,172
T 4,17,32
T 6,17,36
MA 104,52,168
T 8,18,32
MA 108,52,172
T 10,18,36
W 6
MA 112,56,168
G 41,40,66,1
MA 116,56,172
T 12,19,32
T 14,19,36
MA 120,60,168
T 16,20,32
MA 124,60,172
T 18,20,36
W 6
MA 64,0,176
G 42,40,66,2
MA 68,0,180
T 20,21,32
T 22,21,36
MA 72,4,176
T 24,22,32
MA 76,4,180
T 26,22,36
W 6
MA 80,8,176
G 43,40,66,3
MA 84,8,180
T 28,23,32
T 30,23,36
MA 88,12,176
s_waitcnt vmcnt(17)
s_barrier
T 32,16,48
MA 92,12,180
T 34,16,52
s_xor_b32 m0, s65, 0x0
s_xor_b32 s66, s61, 0x300200
W 6
MA 96,16,176
G 40,40,66,0
MA 100,16,180
T 36,17,48
T 38,17,52
MA 104,20,176
T 40,18,48
MA 108,20,180
T 42,18,52
W 6
MA 112,24,176
G 41,40,66,1
MA 116,24,180
T 44,19,48
T 46,19,52
MA 120,28,176
T 48,20,48
MA 124,28,180
T 50,20,52
W 6
MA 64,32,184
G 42,40,66,2
MA 68,32,188
T 52,21,48
T 54,21,52
MA 72,36,184
T 56,22,48
MA 76,36,188
T 58,22,52
W 6
MA 80,40,184
G 43,40,66,3
MA 84,40,188
T 60,23,48
T 62,23,52
MA 88,44,184
s_waitcnt vmcnt(16)
s_barrier
T 0,24,0
MA 92,44,188
T 2,24,4
s_xor_b32 m0, s65, 0x4000
s_xor_b32 s66, s61, 0x340200
W 6
MA 96,48,184
G 40,40,66,0
MA 100,48,188
T 4,25,0
T 6,25,4
MA 104,52,184
T 8,26,0
MA 108,52,188
T 10,26,4
W 6
MA 112,56,184
G 41,40,66,1
MA 116,56,188
T 12,27,0
T 14,27,4
MA 120,60,184
T 16,28,0
MA 124,60,188
T 18,28,4
W 6
MA 64,0,192
G 42,40,66,2
MA 68,0,196
T 20,29,0
T 22,29,4
MA 72,4,192
T 24,30,0
MA 76,4,196
T 26,30,4
W 6
MA 80,8,192
G 43,40,66,3
MA 84,8,196
T 28,31,0
T 30,31,4
MA 88,12,192
s_waitcnt vmcnt(16)
s_barrier
T 32,24,16
MA 92,12,196
T 34,24,20
s_xor_b32 m0, s65, 0x8000
s_xor_b32 s66, s61, 0x380200
W 6
MA 96,16,192
G 40,40,66,0
MA 100,16,196
T 36,25,16
T 38,25,20
MA 104,20,192
T 40,26,16
MA 108,20,196
T 42,26,20
W 6
MA 112,24,192
G 41,40,66,1
MA 116,24,196
T 44,27,16
T 46,27,20
MA 120,28,192
T 48,28,16
MA 124,28,196
T 50,28,20
W 6
MA 64,32,200
G 42,40,66,2
MA 68,32,204
T 52,29,16
T 54,29,20
MA 72,36,200
T 56,30,16
MA 76,36,204
T 58,30,20
W 6
MA 80,40,200
G 43,40,66,3
MA 84,40,204
T 60,31,16
T 62,31,20
MA 88,44,200
s_waitcnt vmcnt(16)
s_barrier
T 0,24,32
MA 92,44,204
T 2,24,36
s_xor_b32 m0, s65, 0xc000
s_xor_b32 s66, s61, 0x3c0200
W 6
MA 96,48,200
G 40,40,66,0
MA 100,48,204
T 4,25,32
T 6,25,36
MA 104,52,200
T 8,26,32
MA 108,52,204
T 10,26,36
W 6
MA 112,56,200
G 41,40,66,1
MA 116,56,204
T 12,27,32
T 14,27,36
MA 120,60,200
T 16,28,32
MA 124,60,204
T 18,28,36
W 6
MA 64,0,208
G 42,40,66,2
MA 68,0,212
T 20,29,32
T 22,29,36
MA 72,4,208
T 24,30,32
MA 76,4,212
T 26,30,36
W 6
MA 80,8,208
G 43,40,66,3
MA 84,8,212
T 28,31,32
T 30,31,36
MA 88,12,208
s_waitcnt vmcnt(16)
s_barrier
T 32,24,48
MA 92,12,212
T 34,24,52
s_xor_b32 m0, s65, 0x10000
s_xor_b32 s66, s63, 0x0
W 6
MA 96,16,208
G 32,32,66,0,nt
MA 100,16,212
T 36,25,48
T 38,25,52
MA 104,20,208
T 40,26,48
MA 108,20,212
T 42,26,52
W 6
MA 112,24,208
G 33,32,66,1,nt
MA 116,24,212
T 44,27,48
T 46,27,52
MA 120,28,208
T 48,28,48
MA 124,28,212
T 50,28,52
W 6
MA 64,32,216
G 34,32,66,2,nt
MA 68,32,220
T 52,29,48
T 54,29,52
MA 72,36,216
T 56,30,48
MA 76,36,220
T 58,30,52
W 6
MA 80,40,216
G 35,32,66,3,nt
MA 84,40,220
T 60,31,48
T 62,31,52
MA 88,44,216
s_waitcnt vmcnt(16)
s_barrier
T 0,16,0
MA 92,44,220
T 2,16,4
s_xor_b32 m0, s65, 0x14000
s_xor_b32 s66, s63, 0x10000
W 6
MA 96,48,216
G 32,32,66,0,nt
MA 100,48,220
T 4,17,0
T 6,17,4
MA 104,52,216
T 8,18,0
MA 108,52,220
T 10,18,4
W 6
MA 112,56,216
G 33,32,66,1,nt
MA 116,56,220
T 12,19,0
T 14,19,4
MA 120,60,216
T 16,20,0
MA 124,60,220
T 18,20,4
W 6
MA 64,0,224
G 34,32,66,2,nt
MA 68,0,228
T 20,21,0
T 22,21,4
MA 72,4,224
T 24,22,0
MA 76,4,228
T 26,22,4
W 6
MA 80,8,224
G 35,32,66,3,nt
MA 84,8,228
T 28,23,0
T 30,23,4
MA 88,12,224
s_waitcnt vmcnt(16)
s_barrier
T 32,16,16
MA 92,12,228
T 34,16,20
s_xor_b32 m0, s65, 0x18000
s_xor_b32 s66, s63, 0x0
W 6
MA 96,16,224
G 56,36,66,0,nt
MA 100,16,228
T 36,17,16
T 38,17,20
MA 104,20,224
T 40,18,16
MA 108,20,228
T 42,18,20
W 6
MA 112,24,224
G 57,36,66,1,nt
MA 116,24,228
T 44,19,16
T 46,19,20
MA 120,28,224
T 48,20,16
MA 124,28,228
T 50,20,20
W 6
MA 64,32,232
G 56,36,66,2,nt
MA 68,32,236
T 52,21,16
T 54,21,20
MA 72,36,232
T 56,22,16
MA 76,36,236
T 58,22,20
W 6
MA 80,40,232
G 57,36,66,3,nt
MA 84,40,236
T 60,23,16
T 62,23,20
MA 88,44,232
s_waitcnt vmcnt(16)
s_barrier
T 0,16,32
MA 92,44,236
T 2,16,36
s_xor_b32 m0, s65, 0x1c000
s_xor_b32 s66, s63, 0x4000
W 6
MA 96,48,232
G 32,32,66,0,nt
MA 100,48,236
T 4,17,32
T 6,17,36
MA 104,52,232
T 8,18,32
MA 108,52,236
T 10,18,36
W 6
MA 112,56,232
G 33,32,66,1,nt
MA 116,56,236
T 12,19,32
T 14,19,36
MA 120,60,232
T 16,20,32
MA 124,60,236
T 18,20,36
W 6
MA 64,0,240
G 34,32,66,2,nt
MA 68,0,244
T 20,21,32
T 22,21,36
MA 72,4,240
T 24,22,32
MA 76,4,244
T 26,22,36
W 6
MA 80,8,240
G 35,32,66,3,nt
MA 84,8,244
T 28,23,32
T 30,23,36
MA 88,12,240
s_waitcnt vmcnt(16)
s_barrier
MA 92,12,244
T 32,16,48
T 34,16,52
W 6
MA 96,16,240
T 36,17,48
MA 100,16,244
T 38,17,52
MA 104,20,240
T 40,18,48
MA 108,20,244
T 42,18,52
W 6
MA 112,24,240
T 44,19,48
MA 116,24,244
T 46,19,52
MA 120,28,240
T 48,20,48
MA 124,28,244
T 50,20,52
W 6
MA 64,32,248
T 52,21,48
MA 68,32,252
T 54,21,52
MA 72,36,248
T 56,22,48
MA 76,36,252
T 58,22,52
W 6
MA 80,40,248
T 60,23,48
MA 84,40,252
T 62,23,52
MA 88,44,248
s_waitcnt vmcnt(12)
s_barrier
MA 92,44,252
R a,0,12,0
s_xor_b32 m0, s65, 0x0
s_xor_b32 s66, s63, 0x10000
W 5
MA 96,48,248
G 56,36,66,0,nt
MA 100,48,252
R a,4,13,0
MA 104,52,248
R a,8,14,0
MA 108,52,252
W 3
MA 112,56,248
G 57,36,66,1,nt
MA 116,56,252
R a,12,15,0
MA 120,60,248
R a,16,12,4
MA 124,60,252
v_pk_mul_f32 v[64:65], v[64:65], s[74:75]
v_pk_mul_f32 v[66:67], v[66:67], s[74:75]
v_pk_mul_f32 v[68:69], v[68:69], s[74:75]
v_pk_mul_f32 v[70:71], v[70:71], s[74:75]
v_pk_mul_f32 v[72:73], v[72:73], s[74:75]
v_pk_mul_f32 v[74:75], v[74:75], s[74:75]
v_pk_mul_f32 v[76:77], v[76:77], s[74:75]
v_pk_mul_f32 v[78:79], v[78:79], s[74:75]
CV 64,64
CV 66,66
CV 68,68
CV 70,70
CV 72,72
CV 74,74
CV 76,76
CV 78,78
v_permlane32_swap_b32 v64, v72
v_permlane32_swap_b32 v66, v74
v_permlane32_swap_b32 v68, v76
v_permlane32_swap_b32 v70, v78
v_permlane16_swap_b32 v64, v72
v_permlane16_swap_b32 v66, v74
v_permlane16_swap_b32 v68, v76
v_permlane16_swap_b32 v70, v78
AW 96,64
AW 97,66
AW 98,72
AW 99,74
AW 100,68
AW 101,70
AW 102,76
AW 103,78
v_pk_mul_f32 v[80:81], v[80:81], s[74:75]
v_pk_mul_f32 v[82:83], v[82:83], s[74:75]
v_pk_mul_f32 v[84:85], v[84:85], s[74:75]
v_pk_mul_f32 v[86:87], v[86:87], s[74:75]
v_pk_mul_f32 v[88:89], v[88:89], s[74:75]
v_pk_mul_f32 v[90:91], v[90:91], s[74:75]
v_pk_mul_f32 v[92:93], v[92:93], s[74:75]
v_pk_mul_f32 v[94:95], v[94:95], s[74:75]
CV 80,80
CV 82,82
CV 84,84
CV 86,86
CV 88,88
CV 90,90
CV 92,92
CV 94,94
v_permlane32_swap_b32 v80, v88
v_permlane32_swap_b32 v82, v90
v_permlane32_swap_b32 v84, v92
v_permlane32_swap_b32 v86, v94
v_permlane16_swap_b32 v80, v88
v_permlane16_swap_b32 v82, v90
v_permlane16_swap_b32 v84, v92
v_permlane16_swap_b32 v86, v94
AW 104,80
AW 105,82
AW 106,88
AW 107,90
AW 108,84
AW 109,86
AW 110,92
AW 111,94
v_pk_mul_f32 v[96:97], v[96:97], s[74:75]
v_pk_mul_f32 v[98:99], v[98:99], s[74:75]
v_pk_mul_f32 v[100:101], v[100:101], s[74:75]
v_pk_mul_f32 v[102:103], v[102:103], s[74:75]
v_pk_mul_f32 v[104:105], v[104:105], s[74:75]
v_pk_mul_f32 v[106:107], v[106:107], s[74:75]
v_pk_mul_f32 v[108:109], v[108:109], s[74:75]
v_pk_mul_f32 v[110:111], v[110:111], s[74:75]
CV 96,96
CV 98,98
CV 100,100
CV 102,102
CV 104,104
CV 106,106
CV 108,108
CV 110,110
v_permlane32_swap_b32 v96, v104
v_permlane32_swap_b32 v98, v106
v_permlane32_swap_b32 v100, v108
v_permlane32_swap_b32 v102, v110
v_permlane16_swap_b32 v96, v104
v_permlane16_swap_b32 v98, v106
v_permlane16_swap_b32 v100, v108
v_permlane16_swap_b32 v102, v110
AW 112,96
AW 113,98
AW 114,104
AW 115,106
AW 116,100
AW 117,102
AW 118,108
AW 119,110
v_pk_mul_f32 v[112:113], v[112:113], s[74:75]
v_pk_mul_f32 v[114:115], v[114:115], s[74:75]
v_pk_mul_f32 v[116:117], v[116:117], s[74:75]
v_pk_mul_f32 v[118:119], v[118:119], s[74:75]
v_pk_mul_f32 v[120:121], v[120:121], s[74:75]
v_pk_mul_f32 v[122:123], v[122:123], s[74:75]
v_pk_mul_f32 v[124:125], v[124:125], s[74:75]
v_pk_mul_f32 v[126:127], v[126:127], s[74:75]
CV 112,112
CV 114,114
CV 116,116
CV 118,118
CV 120,120
CV 122,122
CV 124,124
CV 126,126
v_permlane32_swap_b32 v112, v120
v_permlane32_swap_b32 v114, v122
v_permlane32_swap_b32 v116, v124
v_permlane32_swap_b32 v118, v126
v_permlane16_swap_b32 v112, v120
v_permlane16_swap_b32 v114, v122
v_permlane16_swap_b32 v116, v124
v_permlane16_swap_b32 v118, v126
AW 120,112
AW 121,114
AW 122,120
AW 123,122
AW 124,116
AW 125,118
AW 126,124
AW 127,126
W 3
ZB 64,0,64
G 56,36,66,2,nt
ZB 68,0,68
R a,20,13,4
MB 64,4,72
R a,24,14,4
MB 68,4,76
W 3
MB 64,8,80
G 57,36,66,3,nt
MB 68,8,84
R a,28,15,4
MB 64,12,88
MB 68,12,92
W 2
ZB 72,16,64
ZB 76,16,68
MB 72,20,72
MB 76,20,76
W 0
MB 72,24,80
E 64
MB 76,24,84
MB 72,28,88
E 65
MB 76,28,92
CV 96,64
E 66
E 67
s_nop 0
CV 97,66
E 68
s_waitcnt vmcnt(12)
s_barrier
R a,0,12,16
E 69
s_xor_b32 m0, s65, 0x4000
s_xor_b32 s66, s63, 0x14000
R a,4,13,16
G 32,32,66,0,nt
CV 100,68
E 70
R a,8,14,16
E 71
R a,12,15,16
G 33,32,66,1,nt
CV 101,70
E 72
R a,16,12,20
E 73
W 3
ZB 80,0,64
G 34,32,66,2,nt
R a,20,13,20
ZB 84,0,68
CV 98,72
E 74
MB 80,4,72
R a,24,14,20
MB 84,4,76
E 75
W 3
MB 80,8,80
G 35,32,66,3,nt
R a,28,15,20
MB 84,8,84
CV 99,74
E 76
MB 80,12,88
s_waitcnt vmcnt(12)
s_barrier
T 32,24,32
T 34,24,36
MB 84,12,92
E 77
s_xor_b32 m0, s65, 0x8000
s_xor_b32 s66, s63, 0x4000
W 4
ZB 88,16,64
G 56,36,66,0,nt
T 36,25,32
ZB 92,16,68
T 38,25,36
CV 102,76
E 78
s_getpc_b64 s[88:89]
L_ct1_257:
s_and_b32 s89, s89, 0xffff
s_mov_b32 s90, L_code_end-L_ct1_257
s_mov_b32 s91, 0x20000
v_and_b32 v62, 0x70, v59
v_lshlrev_b32 v62, 3, v62
s_add_u32 s7, s1, 4096
buffer_load_dword v3, v62, s[88:91], s7 offen
MB 88,20,72
T 40,26,32
T 42,26,36
MB 92,20,76
E 79
W 6
MB 88,24,80
G 57,36,66,1,nt
T 44,27,32
MB 92,24,84
T 46,27,36
CV 103,78
E 80
MB 88,28,88
T 48,28,32
T 50,28,36
MB 92,28,92
E 81
W 6
ZC 128,32,96
G 56,36,66,2,nt
T 52,29,32
ZC 132,32,100
T 54,29,36
CV 104,80
E 82
ZC 136,36,96
T 56,30,32
T 58,30,36
ZC 140,36,100
E 83
W 6
ZC 144,40,96
G 57,36,66,3,nt
T 60,31,32
ZC 148,40,100
T 62,31,36
CV 105,82
E 84
ZC 152,44,96
E 85
ZC 156,44,100
W 4
ZC 160,48,96
s_waitcnt vmcnt(13)
s_barrier
R a,0,12,48
CV 108,84
ZC 164,48,100
E 86
s_xor_b32 m0, s65, 0xc000
s_xor_b32 s66, s63, 0x1000
ZC 168,52,96
G 32,32,66,0,nt
ZC 172,52,100
R a,4,13,48
E 87
W 2
ZC 176,56,96
R a,8,14,48
CV 109,86
ZC 180,56,100
E 88
ZC 184,60,96
G 33,32,66,1,nt
ZC 188,60,100
R a,12,15,48
E 89
ZD 112,52,96
R a,16,12,52
CV 106,88
ZD 116,52,100
E 90
W 3
ZB 64,0,64
G 34,32,66,2,nt
ZB 68,0,68
R a,20,13,52
E 91
MB 64,4,72
R a,24,14,52
CV 107,90
MB 68,4,76
E 92
W 3
MB 64,8,80
G 35,32,66,3,nt
MB 68,8,84
R a,28,15,52
E 93
MB 64,12,88
s_waitcnt vmcnt(13)
s_barrier
T 32,16,0
T 34,16,4
MB 68,12,92
CV 110,92
E 94
s_xor_b32 m0, s65, 0x10000
s_xor_b32 s66, s63, 0x14000
W 4
ZB 72,16,64
G 56,36,66,0,nt
T 36,17,0
ZB 76,16,68
T 38,17,4
E 95
MB 72,20,72
T 40,18,0
MB 76,20,76
T 42,18,4
CV 111,94
W 6
MB 72,24,80
G 57,36,66,1,nt
T 44,19,0
MB 76,24,84
T 46,19,4
E 64
MB 72,28,88
T 48,20,0
T 50,20,4
MB 76,28,92
E 65
W 6
MC 128,32,104
G 56,36,66,2,nt
T 52,21,0
MC 132,32,108
T 54,21,4
CV 96,64
E 66
MC 136,36,104
T 56,22,0
T 58,22,4
MC 140,36,108
E 67
W 6
MC 144,40,104
G 57,36,66,3,nt
T 60,23,0
MC 148,40,108
T 62,23,4
CV 97,66
E 68
MC 152,44,104
E 69
MC 156,44,108
W 4
MC 160,48,104
s_waitcnt vmcnt(13)
s_barrier
R a,0,8,16
CV 100,68
MC 164,48,108
E 70
s_xor_b32 m0, s65, 0x14000
s_xor_b32 s66, s63, 0x11000
MC 168,52,104
G 32,32,66,0,nt
MC 172,52,108
R a,4,9,16
E 71
W 2
MC 176,56,104
R a,8,10,16
CV 101,70
MC 180,56,108
E 72
MC 184,60,104
G 33,32,66,1,nt
MC 188,60,108
R a,12,11,16
E 73
MD 112,52,104
R a,16,8,20
CV 98,72
MD 116,52,108
E 74
W 3
ZB 80,0,64
G 34,32,66,2,nt
ZB 84,0,68
R a,20,9,20
E 75
MB 80,4,72
R a,24,10,20
CV 99,74
MB 84,4,76
E 76
W 3
MB 80,8,80
G 35,32,66,3,nt
MB 84,8,84
R a,28,11,20
E 77
MB 80,12,88
s_waitcnt vmcnt(12)
s_barrier
T 32,16,32
T 34,16,36
MB 84,12,92
CV 102,76
E 78
s_xor_b32 m0, s65, 0x18000
s_xor_b32 s66, s63, 0x1000
W 4
ZB 88,16,64
G 56,36,66,0,nt
T 36,17,32
ZB 92,16,68
T 38,17,36
E 79
MB 88,20,72
T 40,18,32
MB 92,20,76
T 42,18,36
CV 103,78
W 6
MB 88,24,80
G 57,36,66,1,nt
T 44,19,32
MB 92,24,84
T 46,19,36
E 80
MB 88,28,88
T 48,20,32
T 50,20,36
MB 92,28,92
E 81
W 6
MC 128,32,96
G 56,36,66,2,nt
T 52,21,32
MC 132,32,100
T 54,21,36
CV 104,80
E 82
MC 136,36,96
T 56,22,32
T 58,22,36
MC 140,36,100
E 83
W 6
MC 144,40,96
G 57,36,66,3,nt
T 60,23,32
MC 148,40,100
T 62,23,36
CV 105,82
E 84
MC 152,44,96
E 85
MC 156,44,100
W 4
MC 160,48,96
s_waitcnt vmcnt(12)
s_barrier
R a,0,8,48
CV 108,84
MC 164,48,100
E 86
s_xor_b32 m0, s65, 0x1c000
s_xor_b32 s66, s63, 0x11000
MC 168,52,96
G 56,36,66,0,nt
MC 172,52,100
R a,4,9,48
E 87
W 2
MC 176,56,96
R a,8,10,48
CV 109,86
MC 180,56,100
E 88
MC 184,60,96
G 57,36,66,1,nt
MC 188,60,100
R a,12,11,48
E 89
MD 112,52,96
R a,16,8,52
CV 106,88
MD 116,52,100
E 90
W 3
ZB 64,0,64
G 56,36,66,2,nt
ZB 68,0,68
R a,20,9,52
E 91
MB 64,4,72
R a,24,10,52
CV 107,90
MB 68,4,76
E 92
W 3
MB 64,8,80
G 57,36,66,3,nt
MB 68,8,84
R a,28,11,52
E 93
MB 64,12,88
s_waitcnt vmcnt(12)
s_barrier
T 32,24,0
T 34,24,4
MB 68,12,92
CV 110,92
E 94
s_xor_b32 m0, s65, 0x0
s_xor_b32 s66, s60, 0x0
W 4
ZB 72,16,64
G 36,8,66,0
T 36,25,0
ZB 76,16,68
T 38,25,4
E 95
MB 72,20,72
T 40,26,0
MB 76,20,76
T 42,26,4
CV 111,94
W 6
MB 72,24,80
G 37,8,66,1
T 44,27,0
MB 76,24,84
T 46,27,4
E 64
MB 72,28,88
T 48,28,0
T 50,28,4
MB 76,28,92
E 65
W 6
MC 128,32,104
G 38,8,66,2
T 52,29,0
MC 132,32,108
T 54,29,4
CV 96,64
E 66
MC 136,36,104
T 56,30,0
T 58,30,4
MC 140,36,108
E 67
W 6
MC 144,40,104
G 39,8,66,3
T 60,31,0
MC 148,40,108
T 62,31,4
CV 97,66
E 68
MC 152,44,104
E 69
MC 156,44,108
W 4
MC 160,48,104
s_waitcnt vmcnt(12)
s_barrier
R a,0,12,16
CV 100,68
MC 164,48,108
E 70
s_xor_b32 m0, s65, 0x4000
s_xor_b32 s66, s61, 0x0
MC 168,52,104
G 40,20,66,0
MC 172,52,108
R a,4,13,16
E 71
W 2
MC 176,56,104
R a,8,14,16
CV 101,70
MC 180,56,108
E 72
MC 184,60,104
G 41,20,66,1
MC 188,60,108
R a,12,15,16
E 73
MD 112,52,104
R a,16,12,20
CV 98,72
MD 116,52,108
E 74
W 3
ZB 80,0,64
G 42,20,66,2
ZB 84,0,68
R a,20,13,20
E 75
MB 80,4,72
R a,24,14,20
CV 99,74
MB 84,4,76
E 76
W 3
MB 80,8,80
G 43,20,66,3
R a,28,15,20
MB 84,8,84
v_xor_b32 v8, s70, v8
E 77
MB 80,12,88
s_waitcnt vmcnt(12)
s_barrier
T 32,24,32
T 34,24,36
CV 102,76
MB 84,12,92
v_xor_b32 v9, s70, v9
E 78
s_xor_b32 m0, s65, 0x8000
s_xor_b32 s66, s61, 0x40000
W 4
ZB 88,16,64
G 40,20,66,0
T 36,25,32
ZB 92,16,68
T 38,25,36
v_xor_b32 v10, s70, v10
E 79
MB 88,20,72
T 40,26,32
T 42,26,36
MB 92,20,76
CV 103,78
v_xor_b32 v11, s70, v11
W 6
MB 88,24,80
G 41,20,66,1
T 44,27,32
MB 92,24,84
T 46,27,36
v_xor_b32 v12, s70, v12
E 80
MB 88,28,88
T 48,28,32
T 50,28,36
MB 92,28,92
v_xor_b32 v13, s70, v13
E 81
W 6
MC 128,32,96
G 42,20,66,2
T 52,29,32
T 54,29,36
MC 132,32,100
CV 104,80
v_xor_b32 v14, s70, v14
E 82
MC 136,36,96
T 56,30,32
T 58,30,36
MC 140,36,100
v_xor_b32 v15, s70, v15
E 83
W 6
MC 144,40,96
G 43,20,66,3
T 60,31,32
MC 148,40,100
T 62,31,36
CV 105,82
E 84
MC 152,44,96
E 85
MC 156,44,100
W 4
MC 160,48,96
CV 108,84
MC 164,48,100
E 86
MC 168,52,96
E 87
MC 172,52,100
W 0
MC 176,56,96
CV 109,86
MC 180,56,100
E 88
MC 184,60,96
E 89
MC 188,60,100
MD 112,52,96
CV 106,88
MD 116,52,100
E 90
E 91
s_nop 0
CV 107,90
E 92
E 93
s_waitcnt vmcnt(12)
s_barrier
T 32,24,48
T 34,24,52
CV 110,92
E 94
s_xor_b32 m0, s65, 0xc000
s_xor_b32 s66, s60, 0x100
T 36,25,48
T 38,25,52
G 36,8,66,0
E 95
T 40,26,48
T 42,26,52
CV 111,94
T 44,27,48
T 46,27,52
G 37,8,66,1
T 48,28,48
T 50,28,52
W 6
MC 128,32,104
G 38,8,66,2
MC 132,32,108
T 52,29,48
T 54,29,52
MC 136,36,104
T 56,30,48
MC 140,36,108
T 58,30,52
W 6
MC 144,40,104
G 39,8,66,3
MC 148,40,108
T 60,31,48
T 62,31,52
MC 152,44,104
MC 156,44,108
W 4
MC 160,48,104
MC 164,48,108
MC 168,52,104
MC 172,52,108
W 0
MC 176,56,104
MC 180,56,108
MC 184,60,104
MC 188,60,108
MD 112,52,104
MD 116,52,108
s_nop 6
v_mov_b32 v6, v112
v_mov_b32 v7, v116
s_waitcnt vmcnt(8)
s_barrier
R v,128,8,0
R v,132,8,4
R v,136,9,0
R v,140,9,4
R v,144,10,0
R v,148,10,4
R v,152,11,0
R v,156,11,4
T 0,16,16
T 2,16,20
T 4,17,16
T 6,17,20
T 8,18,16
T 10,18,20
T 12,19,16
W 14
T 14,19,20
W 14
T 16,20,16
W 14
T 18,20,20
s_xor_b32 m0, s65, 0x10000
s_xor_b32 s66, s61, 0x80000
G 40,20,66,0
G 41,20,66,1
G 42,20,66,2
W 6
ZA 64,0,128
G 43,20,66,3
s_xor_b32 m0, s65, 0x14000
s_xor_b32 s66, s61, 0xc0000
ZA 68,0,132
G 40,20,66,0
G 41,20,66,1
T 20,21,16
T 22,21,20
ZA 72,4,128
G 42,20,66,2
G 43,20,66,3
s_xor_b32 m0, s65, 0x18000
ZA 76,4,132
s_xor_b32 s66, s61, 0x100000
G 40,20,66,0
T 24,22,16
T 26,22,20
W 6
ZA 80,8,128
G 41,20,66,1
G 42,20,66,2
ZA 84,8,132
G 43,20,66,3
T 28,23,16
T 30,23,20
ZA 88,12,128
s_waitcnt vmcnt(16)
s_barrier
T 32,16,32
ZA 92,12,132
T 34,16,36
s_xor_b32 m0, s65, 0x1c000
s_xor_b32 s66, s61, 0x140000
W 6
ZA 96,16,128
G 40,20,66,0
ZA 100,16,132
T 36,17,32
T 38,17,36
ZA 104,20,128
G 41,20,66,1
ZA 108,20,132
T 40,18,32
T 42,18,36
W 6
ZA 112,24,128
G 42,20,66,2
ZA 116,24,132
T 44,19,32
T 46,19,36
ZA 120,28,128
G 43,20,66,3
ZA 124,28,132
T 48,20,32
T 50,20,36
W 6
MA 64,32,136
s_waitcnt vmcnt(16)
s_barrier
s_xor_b32 m0, s65, 0x0
s_xor_b32 s66, s60, 0x200
G 36,8,66,0
MA 68,32,140
G 37,8,66,1
T 52,21,32
T 54,21,36
R v,160,8,48
MA 72,36,136
G 38,8,66,2
MA 76,36,140
T 56,22,32
T 58,22,36
R v,164,8,52
W 8
MA 80,40,136
G 39,8,66,3
MA 84,40,140
T 60,23,32
T 62,23,36
R v,168,9,48
MA 88,44,136
s_waitcnt vmcnt(16)
s_barrier
MA 92,44,140
R v,172,9,52
T 0,24,0
T 2,24,4
W 10
MA 96,48,136
R v,176,10,48
MA 100,48,140
T 4,25,0
T 6,25,4
MA 104,52,136
R v,180,10,52
MA 108,52,140
T 8,26,0
W 14
T 10,26,4
W 10
MA 112,56,136
R v,184,11,48
MA 116,56,140
T 12,27,0
T 14,27,4
MA 120,60,136
R v,188,11,52
MA 124,60,140
T 16,28,0
W 14
T 18,28,4
W 9
MA 64,0,144
T 20,29,0
MA 68,0,148
T 22,29,4
MA 72,4,144
T 24,30,0
MA 76,4,148
T 26,30,4
W 7
MA 80,8,144
T 28,31,0
MA 84,8,148
T 30,31,4
MA 88,12,144
s_waitcnt vmcnt(12) lgkmcnt(8)
s_barrier
s_xor_b32 m0, s65, 0x4000
s_xor_b32 s66, s61, 0x180000
MA 92,12,148
G 40,20,66,0
T 32,24,16
T 34,24,20
W 6
MA 96,16,144
G 41,20,66,1
MA 100,16,148
T 36,25,16
T 38,25,20
s_getpc_b64 s[88:89]
L_ct1_376:
s_and_b32 s89, s89, 0xffff
s_mov_b32 s90, L_code_end-L_ct1_376
s_mov_b32 s91, 0x20000
v_and_b32 v62, 0x70, v59
v_lshlrev_b32 v62, 3, v62
s_add_u32 s7, s1, 4096
buffer_load_dword v3, v62, s[88:91], s7 offen
MA 104,20,144
G 42,20,66,2
MA 108,20,148
T 40,26,16
T 42,26,20
W 6
MA 112,24,144
G 43,20,66,3
MA 116,24,148
T 44,27,16
T 46,27,20
MA 120,28,144
s_xor_b32 m0, s65, 0x8000
s_xor_b32 s66, s61, 0x1c0000
MA 124,28,148
G 40,20,66,0
T 48,28,16
T 50,28,20
W 6
MA 64,32,152
G 41,20,66,1
MA 68,32,156
T 52,29,16
T 54,29,20
MA 72,36,152
G 42,20,66,2
MA 76,36,156
T 56,30,16
T 58,30,20
W 6
MA 80,40,152
G 43,20,66,3
MA 84,40,156
T 60,31,16
T 62,31,20
MA 88,44,152
s_waitcnt vmcnt(17)
s_barrier
T 0,24,32
MA 92,44,156
T 2,24,36
s_xor_b32 m0, s65, 0xc000
s_xor_b32 s66, s61, 0x200000
W 6
MA 96,48,152
G 40,20,66,0
MA 100,48,156
T 4,25,32
T 6,25,36
MA 104,52,152
T 8,26,32
MA 108,52,156
T 10,26,36
W 6
MA 112,56,152
G 41,20,66,1
MA 116,56,156
T 12,27,32
T 14,27,36
MA 120,60,152
T 16,28,32
MA 124,60,156
T 18,28,36
W 6
MA 64,0,160
G 42,20,66,2
MA 68,0,164
T 20,29,32
T 22,29,36
MA 72,4,160
T 24,30,32
MA 76,4,164
T 26,30,36
W 6
MA 80,8,160
G 43,20,66,3
MA 84,8,164
T 28,31,32
T 30,31,36
MA 88,12,160
s_waitcnt vmcnt(17)
s_barrier
T 32,24,48
MA 92,12,164
T 34,24,52
s_xor_b32 m0, s65, 0x10000
s_xor_b32 s66, s61, 0x240000
W 6
MA 96,16,160
G 40,20,66,0
MA 100,16,164
T 36,25,48
T 38,25,52
MA 104,20,160
G 41,20,66,1
MA 108,20,164
T 40,26,48
T 42,26,52
W 6
MA 112,24,160
G 42,20,66,2
MA 116,24,164
T 44,27,48
T 46,27,52
MA 120,28,160
G 43,20,66,3
MA 124,28,164
T 48,28,48
T 50,28,52
W 6
MA 64,32,168
s_waitcnt vmcnt(17)
s_barrier
s_xor_b32 m0, s65, 0x14000
s_xor_b32 s66, s60, 0x300
G 36,8,66,0
MA 68,32,172
G 37,8,66,1
T 52,29,48
T 54,29,52
R v,192,8,0
MA 72,36,168
G 38,8,66,2
MA 76,36,172
T 56,30,48
T 58,30,52
R v,196,8,4
W 8
MA 80,40,168
G 39,8,66,3
MA 84,40,172
T 60,31,48
T 62,31,52
R v,200,9,0
MA 88,44,168
s_waitcnt vmcnt(16)
s_barrier
MA 92,44,172
R v,204,9,4
T 0,16,16
T 2,16,20
W 10
MA 96,48,168
R v,208,10,0
MA 100,48,172
T 4,17,16
T 6,17,20
MA 104,52,168
R v,212,10,4
MA 108,52,172
T 8,18,16
W 14
T 10,18,20
W 10
MA 112,56,168
R v,216,11,0
MA 116,56,172
T 12,19,16
T 14,19,20
MA 120,60,168
R v,220,11,4
MA 124,60,172
T 16,20,16
W 14
T 18,20,20
W 9
MA 64,0,176
T 20,21,16
MA 68,0,180
T 22,21,20
MA 72,4,176
T 24,22,16
MA 76,4,180
T 26,22,20
W 7
MA 80,8,176
T 28,23,16
MA 84,8,180
T 30,23,20
MA 88,12,176
s_waitcnt vmcnt(12) lgkmcnt(8)
s_barrier
s_xor_b32 m0, s65, 0x18000
s_xor_b32 s66, s61, 0x280000
MA 92,12,180
G 40,20,66,0
T 32,16,32
T 34,16,36
W 6
MA 96,16,176
G 41,20,66,1
MA 100,16,180
T 36,17,32
T 38,17,36
MA 104,20,176
G 42,20,66,2
MA 108,20,180
T 40,18,32
T 42,18,36
W 6
MA 112,24,176
G 43,20,66,3
MA 116,24,180
T 44,19,32
T 46,19,36
MA 120,28,176
s_xor_b32 m0, s65, 0x1c000
s_xor_b32 s66, s61, 0x2c0000
MA 124,28,180
G 40,20,66,0
T 48,20,32
T 50,20,36
W 6
MA 64,32,184
G 41,20,66,1
MA 68,32,188
T 52,21,32
T 54,21,36
MA 72,36,184
G 42,20,66,2
MA 76,36,188
T 56,22,32
T 58,22,36
W 6
MA 80,40,184
G 43,20,66,3
MA 84,40,188
T 60,23,32
T 62,23,36
MA 88,44,184
s_waitcnt vmcnt(16)
s_barrier
T 0,16,48
MA 92,44,188
T 2,16,52
s_xor_b32 m0, s65, 0x0
s_xor_b32 s66, s61, 0x300000
W 6
MA 96,48,184
G 40,20,66,0
MA 100,48,188
T 4,17,48
T 6,17,52
MA 104,52,184
T 8,18,48
MA 108,52,188
T 10,18,52
W 6
MA 112,56,184
G 41,20,66,1
MA 116,56,188
T 12,19,48
T 14,19,52
MA 120,60,184
T 16,20,48
MA 124,60,188
T 18,20,52
W 6
MA 64,0,192
G 42,20,66,2
MA 68,0,196
T 20,21,48
T 22,21,52
MA 72,4,192
T 24,22,48
MA 76,4,196
T 26,22,52
W 6
MA 80,8,192
G 43,20,66,3
MA 84,8,196
T 28,23,48
T 30,23,52
MA 88,12,192
s_waitcnt vmcnt(16)
s_barrier
T 32,24,0
MA 92,12,196
T 34,24,4
s_xor_b32 m0, s65, 0x4000
s_xor_b32 s66, s61, 0x340000
W 6
MA 96,16,192
G 40,20,66,0
MA 100,16,196
T 36,25,0
T 38,25,4
MA 104,20,192
G 41,20,66,1
MA 108,20,196
T 40,26,0
T 42,26,4
W 6
MA 112,24,192
G 42,20,66,2
MA 116,24,196
T 44,27,0
T 46,27,4
MA 120,28,192
G 43,20,66,3
MA 124,28,196
T 48,28,0
T 50,28,4
W 6
MA 64,32,200
s_waitcnt vmcnt(16)
s_barrier
s_xor_b32 m0, s65, 0x8000
s_xor_b32 s66, s61, 0x380000
G 40,20,66,0
MA 68,32,204
G 41,20,66,1
T 52,29,0
T 54,29,4
R v,224,12,16
MA 72,36,200
G 42,20,66,2
MA 76,36,204
T 56,30,0
T 58,30,4
R v,228,12,20
W 8
MA 80,40,200
G 43,20,66,3
MA 84,40,204
T 60,31,0
T 62,31,4
R v,232,13,16
MA 88,44,200
s_waitcnt vmcnt(16)
s_barrier
MA 92,44,204
R v,236,13,20
T 0,24,32
T 2,24,36
W 10
MA 96,48,200
R v,240,14,16
MA 100,48,204
T 4,25,32
T 6,25,36
MA 104,52,200
R v,244,14,20
MA 108,52,204
T 8,26,32
W 14
T 10,26,36
W 10
MA 112,56,200
R v,248,15,16
MA 116,56,204
T 12,27,32
T 14,27,36
MA 120,60,200
R v,252,15,20
T 16,28,32
MA 124,60,204
W 14
T 18,28,36
v_xor_b32 v8, s70, v8
W 9
MA 64,0,208
T 20,29,32
MA 68,0,212
T 22,29,36
v_xor_b32 v9, s70, v9
MA 72,4,208
T 24,30,32
MA 76,4,212
T 26,30,36
v_xor_b32 v10, s70, v10
W 7
MA 80,8,208
T 28,31,32
MA 84,8,212
T 30,31,36
v_xor_b32 v11, s70, v11
MA 88,12,208
s_waitcnt vmcnt(12) lgkmcnt(8)
s_barrier
s_xor_b32 m0, s65, 0xc000
s_xor_b32 s66, s61, 0x3c0000
MA 92,12,212
G 40,20,66,0
T 32,24,48
T 34,24,52
v_xor_b32 v12, s70, v12
W 6
MA 96,16,208
G 41,20,66,1
MA 100,16,212
T 36,25,48
T 38,25,52
v_xor_b32 v13, s70, v13
MA 104,20,208
G 42,20,66,2
MA 108,20,212
T 40,26,48
T 42,26,52
v_xor_b32 v14, s70, v14
W 6
MA 112,24,208
G 43,20,66,3
MA 116,24,212
T 44,27,48
T 46,27,52
v_xor_b32 v15, s70, v15
MA 120,28,208
s_xor_b32 m0, s65, 0x10000
s_xor_b32 s66, s61, 0x200
MA 124,28,212
G 40,20,66,0
T 48,28,48
T 50,28,52
W 6
MA 64,32,216
G 41,20,66,1
MA 68,32,220
T 52,29,48
T 54,29,52
MA 72,36,216
G 42,20,66,2
MA 76,36,220
T 56,30,48
T 58,30,52
W 6
MA 80,40,216
G 43,20,66,3
MA 84,40,220
T 60,31,48
T 62,31,52
MA 88,44,216
s_waitcnt vmcnt(16)
s_barrier
T 0,16,0
MA 92,44,220
T 2,16,4
s_xor_b32 m0, s65, 0x14000
s_xor_b32 s66, s61, 0x40200
W 6
MA 96,48,216
G 40,20,66,0
MA 100,48,220
T 4,17,0
T 6,17,4
MA 104,52,216
T 8,18,0
MA 108,52,220
T 10,18,4
W 6
MA 112,56,216
G 41,20,66,1
MA 116,56,220
T 12,19,0
T 14,19,4
MA 120,60,216
T 16,20,0
MA 124,60,220
T 18,20,4
W 6
MA 64,0,224
G 42,20,66,2
MA 68,0,228
T 20,21,0
T 22,21,4
MA 72,4,224
T 24,22,0
MA 76,4,228
T 26,22,4
W 6
MA 80,8,224
G 43,20,66,3
MA 84,8,228
T 28,23,0
T 30,23,4
MA 88,12,224
s_waitcnt vmcnt(16)
s_barrier
T 32,16,16
MA 92,12,228
T 34,16,20
s_xor_b32 m0, s65, 0x18000
s_xor_b32 s66, s61, 0x80200
W 6
MA 96,16,224
G 40,20,66,0
MA 100,16,228
T 36,17,16
T 38,17,20
MA 104,20,224
T 40,18,16
MA 108,20,228
T 42,18,20
W 6
MA 112,24,224
G 41,20,66,1
MA 116,24,228
T 44,19,16
T 46,19,20
MA 120,28,224
T 48,20,16
MA 124,28,228
T 50,20,20
W 6
MA 64,32,232
G 42,20,66,2
MA 68,32,236
T 52,21,16
T 54,21,20
MA 72,36,232
T 56,22,16
MA 76,36,236
T 58,22,20
W 6
MA 80,40,232
G 43,20,66,3
MA 84,40,236
T 60,23,16
T 62,23,20
MA 88,44,232
s_waitcnt vmcnt(16)
s_barrier
T 0,16,32
MA 92,44,236
T 2,16,36
s_xor_b32 m0, s65, 0x1c000
s_xor_b32 s66, s61, 0xc0200
W 6
MA 96,48,232
G 40,20,66,0
MA 100,48,236
T 4,17,32
T 6,17,36
MA 104,52,232
T 8,18,32
MA 108,52,236
T 10,18,36
W 6
MA 112,56,232
G 41,20,66,1
MA 116,56,236
T 12,19,32
T 14,19,36
MA 120,60,232
T 16,20,32
MA 124,60,236
T 18,20,36
W 6
MA 64,0,240
G 42,20,66,2
MA 68,0,244
T 20,21,32
T 22,21,36
MA 72,4,240
T 24,22,32
MA 76,4,244
T 26,22,36
W 6
MA 80,8,240
G 43,20,66,3
MA 84,8,244
T 28,23,32
T 30,23,36
MA 88,12,240
s_waitcnt vmcnt(16)
s_barrier
T 32,16,48
MA 92,12,244
T 34,16,52
s_xor_b32 m0, s65, 0x0
s_xor_b32 s66, s61, 0x100200
W 6
MA 96,16,240
G 40,20,66,0
MA 100,16,244
T 36,17,48
T 38,17,52
MA 104,20,240
T 40,18,48
MA 108,20,244
T 42,18,52
W 6
MA 112,24,240
G 41,20,66,1
MA 116,24,244
T 44,19,48
T 46,19,52
MA 120,28,240
T 48,20,48
MA 124,28,244
T 50,20,52
W 6
MA 64,32,248
G 42,20,66,2
MA 68,32,252
T 52,21,48
T 54,21,52
MA 72,36,248
T 56,22,48
MA 76,36,252
T 58,22,52
W 6
MA 80,40,248
G 43,20,66,3
MA 84,40,252
T 60,23,48
T 62,23,52
MA 88,44,248
s_waitcnt vmcnt(16)
s_barrier
T 0,24,0
MA 92,44,252
T 2,24,4
s_xor_b32 m0, s65, 0x4000
s_xor_b32 s66, s61, 0x140200
W 6
MA 96,48,248
G 40,20,66,0
MA 100,48,252
T 4,25,0
T 6,25,4
MA 104,52,248
T 8,26,0
MA 108,52,252
T 10,26,4
W 6
MA 112,56,248
G 41,20,66,1
MA 116,56,252
T 12,27,0
T 14,27,4
MA 120,60,248
T 16,28,0
MA 124,60,252
T 18,28,4
v_pk_mul_f32 v[64:65], v[64:65], s[74:75]
v_pk_mul_f32 v[66:67], v[66:67], s[74:75]
v_pk_mul_f32 v[68:69], v[68:69], s[74:75]
v_pk_mul_f32 v[70:71], v[70:71], s[74:75]
v_pk_mul_f32 v[72:73], v[72:73], s[74:75]
v_pk_mul_f32 v[74:75], v[74:75], s[74:75]
v_pk_mul_f32 v[76:77], v[76:77], s[74:75]
v_pk_mul_f32 v[78:79], v[78:79], s[74:75]
CV 64,64
CV 66,66
CV 68,68
CV 70,70
CV 72,72
CV 74,74
CV 76,76
CV 78,78
v_permlane32_swap_b32 v64, v72
v_permlane32_swap_b32 v66, v74
v_permlane32_swap_b32 v68, v76
v_permlane32_swap_b32 v70, v78
v_permlane16_swap_b32 v64, v72
v_permlane16_swap_b32 v66, v74
v_permlane16_swap_b32 v68, v76
v_permlane16_swap_b32 v70, v78
AW 192,64
AW 193,66
AW 194,72
AW 195,74
AW 196,68
AW 197,70
AW 198,76
AW 199,78
v_pk_mul_f32 v[80:81], v[80:81], s[74:75]
v_pk_mul_f32 v[82:83], v[82:83], s[74:75]
v_pk_mul_f32 v[84:85], v[84:85], s[74:75]
v_pk_mul_f32 v[86:87], v[86:87], s[74:75]
v_pk_mul_f32 v[88:89], v[88:89], s[74:75]
v_pk_mul_f32 v[90:91], v[90:91], s[74:75]
v_pk_mul_f32 v[92:93], v[92:93], s[74:75]
v_pk_mul_f32 v[94:95], v[94:95], s[74:75]
CV 80,80
CV 82,82
CV 84,84
CV 86,86
CV 88,88
CV 90,90
CV 92,92
CV 94,94
v_permlane32_swap_b32 v80, v88
v_permlane32_swap_b32 v82, v90
v_permlane32_swap_b32 v84, v92
v_permlane32_swap_b32 v86, v94
v_permlane16_swap_b32 v80, v88
v_permlane16_swap_b32 v82, v90
v_permlane16_swap_b32 v84, v92
v_permlane16_swap_b32 v86, v94
AW 200,80
AW 201,82
AW 202,88
AW 203,90
AW 204,84
AW 205,86
AW 206,92
AW 207,94
v_pk_mul_f32 v[96:97], v[96:97], s[74:75]
v_pk_mul_f32 v[98:99], v[98:99], s[74:75]
v_pk_mul_f32 v[100:101], v[100:101], s[74:75]
v_pk_mul_f32 v[102:103], v[102:103], s[74:75]
v_pk_mul_f32 v[104:105], v[104:105], s[74:75]
v_pk_mul_f32 v[106:107], v[106:107], s[74:75]
v_pk_mul_f32 v[108:109], v[108:109], s[74:75]
v_pk_mul_f32 v[110:111], v[110:111], s[74:75]
CV 96,96
CV 98,98
CV 100,100
CV 102,102
CV 104,104
CV 106,106
CV 108,108
CV 110,110
v_permlane32_swap_b32 v96, v104
v_permlane32_swap_b32 v98, v106
v_permlane32_swap_b32 v100, v108
v_permlane32_swap_b32 v102, v110
v_permlane16_swap_b32 v96, v104
v_permlane16_swap_b32 v98, v106
v_permlane16_swap_b32 v100, v108
v_permlane16_swap_b32 v102, v110
AW 208,96
AW 209,98
AW 210,104
AW 211,106
AW 212,100
AW 213,102
AW 214,108
AW 215,110
v_pk_mul_f32 v[112:113], v[112:113], s[74:75]
v_pk_mul_f32 v[114:115], v[114:115], s[74:75]
v_pk_mul_f32 v[116:117], v[116:117], s[74:75]
v_pk_mul_f32 v[118:119], v[118:119], s[74:75]
v_pk_mul_f32 v[120:121], v[120:121], s[74:75]
v_pk_mul_f32 v[122:123], v[122:123], s[74:75]
v_pk_mul_f32 v[124:125], v[124:125], s[74:75]
v_pk_mul_f32 v[126:127], v[126:127], s[74:75]
CV 112,112
CV 114,114
CV 116,116
CV 118,118
CV 120,120
CV 122,122
CV 124,124
CV 126,126
v_permlane32_swap_b32 v112, v120
v_permlane32_swap_b32 v114, v122
v_permlane32_swap_b32 v116, v124
v_permlane32_swap_b32 v118, v126
v_permlane16_swap_b32 v112, v120
v_permlane16_swap_b32 v114, v122
v_permlane16_swap_b32 v116, v124
v_permlane16_swap_b32 v118, v126
AW 216,112
AW 217,114
AW 218,120
AW 219,122
AW 220,116
AW 221,118
AW 222,124
AW 223,126
W 6
ZA 64,0,128
G 42,20,66,2
ZA 68,0,132
T 20,29,0
T 22,29,4
ZA 72,4,128
T 24,30,0
ZA 76,4,132
T 26,30,4
W 6
ZA 80,8,128
G 43,20,66,3
ZA 84,8,132
T 28,31,0
T 30,31,4
ZA 88,12,128
s_waitcnt vmcnt(16)
s_barrier
T 32,24,16
ZA 92,12,132
T 34,24,20
s_xor_b32 m0, s65, 0x8000
s_xor_b32 s66, s61, 0x180200
W 6
ZA 96,16,128
G 40,20,66,0
ZA 100,16,132
T 36,25,16
T 38,25,20
ZA 104,20,128
T 40,26,16
ZA 108,20,132
T 42,26,20
W 6
ZA 112,24,128
G 41,20,66,1
ZA 116,24,132
T 44,27,16
T 46,27,20
ZA 120,28,128
T 48,28,16
ZA 124,28,132
T 50,28,20
W 6
MA 64,32,136
G 42,20,66,2
MA 68,32,140
T 52,29,16
T 54,29,20
MA 72,36,136
T 56,30,16
MA 76,36,140
T 58,30,20
W 6
MA 80,40,136
G 43,20,66,3
MA 84,40,140
T 60,31,16
T 62,31,20
MA 88,44,136
s_waitcnt vmcnt(16)
s_barrier
T 0,24,32
MA 92,44,140
T 2,24,36
s_xor_b32 m0, s65, 0xc000
s_xor_b32 s66, s61, 0x1c0200
W 6
MA 96,48,136
G 40,20,66,0
MA 100,48,140
T 4,25,32
T 6,25,36
MA 104,52,136
T 8,26,32
MA 108,52,140
T 10,26,36
W 6
MA 112,56,136
G 41,20,66,1
MA 116,56,140
T 12,27,32
T 14,27,36
MA 120,60,136
T 16,28,32
MA 124,60,140
T 18,28,36
W 6
MA 64,0,144
G 42,20,66,2
MA 68,0,148
T 20,29,32
T 22,29,36
MA 72,4,144
T 24,30,32
MA 76,4,148
T 26,30,36
W 6
MA 80,8,144
G 43,20,66,3
MA 84,8,148
T 28,31,32
T 30,31,36
MA 88,12,144
s_waitcnt vmcnt(16)
s_barrier
T 32,24,48
MA 92,12,148
T 34,24,52
s_xor_b32 m0, s65, 0x10000
s_xor_b32 s66, s61, 0x200200
W 6
MA 96,16,144
G 40,20,66,0
MA 100,16,148
T 36,25,48
T 38,25,52
s_getpc_b64 s[88:89]
L_ct1_504:
s_and_b32 s89, s89, 0xffff
s_mov_b32 s90, L_code_end-L_ct1_504
s_mov_b32 s91, 0x20000
v_and_b32 v62, 0x70, v59
v_lshlrev_b32 v62, 3, v62
s_add_u32 s7, s1, 4096
buffer_load_dword v3, v62, s[88:91], s7 offen
MA 104,20,144
T 40,26,48
MA 108,20,148
T 42,26,52
W 6
MA 112,24,144
G 41,20,66,1
MA 116,24,148
T 44,27,48
T 46,27,52
MA 120,28,144
T 48,28,48
MA 124,28,148
T 50,28,52
W 6
MA 64,32,152
G 42,20,66,2
MA 68,32,156
T 52,29,48
T 54,29,52
MA 72,36,152
T 56,30,48
MA 76,36,156
T 58,30,52
W 6
MA 80,40,152
G 43,20,66,3
MA 84,40,156
T 60,31,48
T 62,31,52
MA 88,44,152
s_waitcnt vmcnt(17)
s_barrier
T 0,16,0
MA 92,44,156
T 2,16,4
s_xor_b32 m0, s65, 0x14000
s_xor_b32 s66, s61, 0x240200
W 6
MA 96,48,152
G 40,20,66,0
MA 100,48,156
T 4,17,0
T 6,17,4
MA 104,52,152
T 8,18,0
MA 108,52,156
T 10,18,4
W 6
MA 112,56,152
G 41,20,66,1
MA 116,56,156
T 12,19,0
T 14,19,4
MA 120,60,152
T 16,20,0
MA 124,60,156
T 18,20,4
W 6
MA 64,0,160
G 42,20,66,2
MA 68,0,164
T 20,21,0
T 22,21,4
MA 72,4,160
T 24,22,0
MA 76,4,164
T 26,22,4
W 6
MA 80,8,160
G 43,20,66,3
MA 84,8,164
T 28,23,0
T 30,23,4
MA 88,12,160
s_waitcnt vmcnt(17)
s_barrier
T 32,16,16
MA 92,12,164
T 34,16,20
s_xor_b32 m0, s65, 0x18000
s_xor_b32 s66, s61, 0x280200
W 6
MA 96,16,160
G 40,20,66,0
MA 100,16,164
T 36,17,16
T 38,17,20
MA 104,20,160
T 40,18,16
MA 108,20,164
T 42,18,20
W 6
MA 112,24,160
G 41,20,66,1
MA 116,24,164
T 44,19,16
T 46,19,20
MA 120,28,160
T 48,20,16
MA 124,28,164
T 50,20,20
W 6
MA 64,32,168
G 42,20,66,2
MA 68,32,172
T 52,21,16
T 54,21,20
MA 72,36,168
T 56,22,16
MA 76,36,172
T 58,22,20
W 6
MA 80,40,168
G 43,20,66,3
MA 84,40,172
T 60,23,16
T 62,23,20
MA 88,44,168
s_waitcnt vmcnt(17)
s_barrier
T 0,16,32
MA 92,44,172
T 2,16,36
s_xor_b32 m0, s65, 0x1c000
s_xor_b32 s66, s61, 0x2c0200
W 6
MA 96,48,168
G 40,20,66,0
MA 100,48,172
T 4,17,32
T 6,17,36
MA 104,52,168
T 8,18,32
MA 108,52,172
T 10,18,36
W 6
MA 112,56,168
G 41,20,66,1
MA 116,56,172
T 12,19,32
T 14,19,36
MA 120,60,168
T 16,20,32
MA 124,60,172
T 18,20,36
W 6
MA 64,0,176
G 42,20,66,2
MA 68,0,180
T 20,21,32
T 22,21,36
MA 72,4,176
T 24,22,32
MA 76,4,180
T 26,22,36
W 6
MA 80,8,176
G 43,20,66,3
MA 84,8,180
T 28,23,32
T 30,23,36
MA 88,12,176
s_waitcnt vmcnt(17)
s_barrier
T 32,16,48
MA 92,12,180
T 34,16,52
s_xor_b32 m0, s65, 0x0
s_xor_b32 s66, s61, 0x300200
W 6
MA 96,16,176
G 40,20,66,0
MA 100,16,180
T 36,17,48
T 38,17,52
MA 104,20,176
T 40,18,48
MA 108,20,180
T 42,18,52
W 6
MA 112,24,176
G 41,20,66,1
MA 116,24,180
T 44,19,48
T 46,19,52
MA 120,28,176
T 48,20,48
MA 124,28,180
T 50,20,52
W 6
MA 64,32,184
G 42,20,66,2
MA 68,32,188
T 52,21,48
T 54,21,52
MA 72,36,184
T 56,22,48
MA 76,36,188
T 58,22,52
W 6
MA 80,40,184
G 43,20,66,3
MA 84,40,188
T 60,23,48
T 62,23,52
MA 88,44,184
s_waitcnt vmcnt(16)
s_barrier
T 0,24,0
MA 92,44,188
T 2,24,4
s_xor_b32 m0, s65, 0x4000
s_xor_b32 s66, s61, 0x340200
W 6
MA 96,48,184
G 40,20,66,0
MA 100,48,188
T 4,25,0
T 6,25,4
MA 104,52,184
T 8,26,0
MA 108,52,188
T 10,26,4
W 6
MA 112,56,184
G 41,20,66,1
MA 116,56,188
T 12,27,0
T 14,27,4
MA 120,60,184
T 16,28,0
MA 124,60,188
T 18,28,4
W 6
MA 64,0,192
G 42,20,66,2
MA 68,0,196
T 20,29,0
T 22,29,4
MA 72,4,192
T 24,30,0
MA 76,4,196
T 26,30,4
W 6
MA 80,8,192
G 43,20,66,3
MA 84,8,196
T 28,31,0
T 30,31,4
MA 88,12,192
s_waitcnt vmcnt(16)
s_barrier
T 32,24,16
MA 92,12,196
T 34,24,20
s_xor_b32 m0, s65, 0x8000
s_xor_b32 s66, s61, 0x380200
W 6
MA 96,16,192
G 40,20,66,0
MA 100,16,196
T 36,25,16
T 38,25,20
MA 104,20,192
T 40,26,16
MA 108,20,196
T 42,26,20
W 6
MA 112,24,192
G 41,20,66,1
MA 116,24,196
T 44,27,16
T 46,27,20
MA 120,28,192
T 48,28,16
MA 124,28,196
T 50,28,20
W 6
MA 64,32,200
G 42,20,66,2
MA 68,32,204
T 52,29,16
T 54,29,20
MA 72,36,200
T 56,30,16
MA 76,36,204
T 58,30,20
W 6
MA 80,40,200
G 43,20,66,3
MA 84,40,204
T 60,31,16
T 62,31,20
MA 88,44,200
s_waitcnt vmcnt(16)
s_barrier
T 0,24,32
MA 92,44,204
T 2,24,36
s_xor_b32 m0, s65, 0xc000
s_xor_b32 s66, s61, 0x3c0200
W 6
MA 96,48,200
G 40,20,66,0
MA 100,48,204
T 4,25,32
T 6,25,36
MA 104,52,200
T 8,26,32
MA 108,52,204
T 10,26,36
W 6
MA 112,56,200
G 41,20,66,1
MA 116,56,204
T 12,27,32
T 14,27,36
MA 120,60,200
T 16,28,32
MA 124,60,204
T 18,28,36
W 6
MA 64,0,208
G 42,20,66,2
MA 68,0,212
T 20,29,32
T 22,29,36
MA 72,4,208
T 24,30,32
MA 76,4,212
T 26,30,36
W 6
MA 80,8,208
G 43,20,66,3
MA 84,8,212
T 28,31,32
T 30,31,36
MA 88,12,208
s_waitcnt vmcnt(16)
s_barrier
T 32,24,48
MA 92,12,212
T 34,24,52
s_xor_b32 m0, s65, 0x10000
s_xor_b32 s66, s63, 0x5000
W 6
MA 96,16,208
G 32,32,66,0,nt
MA 100,16,212
T 36,25,48
T 38,25,52
MA 104,20,208
T 40,26,48
MA 108,20,212
T 42,26,52
W 6
MA 112,24,208
G 33,32,66,1,nt
MA 116,24,212
T 44,27,48
T 46,27,52
MA 120,28,208
T 48,28,48
MA 124,28,212
T 50,28,52
W 6
MA 64,32,216
G 34,32,66,2,nt
MA 68,32,220
T 52,29,48
T 54,29,52
MA 72,36,216
T 56,30,48
MA 76,36,220
T 58,30,52
W 6
MA 80,40,216
G 35,32,66,3,nt
MA 84,40,220
T 60,31,48
T 62,31,52
MA 88,44,216
s_waitcnt vmcnt(16)
s_barrier
T 0,16,0
MA 92,44,220
T 2,16,4
s_xor_b32 m0, s65, 0x14000
s_xor_b32 s66, s63, 0x15000
W 6
MA 96,48,216
G 32,32,66,0,nt
MA 100,48,220
T 4,17,0
T 6,17,4
MA 104,52,216
T 8,18,0
MA 108,52,220
T 10,18,4
W 6
MA 112,56,216
G 33,32,66,1,nt
MA 116,56,220
T 12,19,0
T 14,19,4
MA 120,60,216
T 16,20,0
MA 124,60,220
T 18,20,4
W 6
MA 64,0,224
G 34,32,66,2,nt
MA 68,0,228
T 20,21,0
T 22,21,4
MA 72,4,224
T 24,22,0
MA 76,4,228
T 26,22,4
W 6
MA 80,8,224
G 35,32,66,3,nt
MA 84,8,228
T 28,23,0
T 30,23,4
MA 88,12,224
s_waitcnt vmcnt(16)
s_barrier
T 32,16,16
MA 92,12,228
T 34,16,20
s_xor_b32 m0, s65, 0x18000
s_xor_b32 s66, s63, 0x5000
W 6
MA 96,16,224
G 56,36,66,0,nt
MA 100,16,228
T 36,17,16
T 38,17,20
MA 104,20,224
T 40,18,16
MA 108,20,228
T 42,18,20
W 6
MA 112,24,224
G 57,36,66,1,nt
MA 116,24,228
T 44,19,16
T 46,19,20
MA 120,28,224
T 48,20,16
MA 124,28,228
T 50,20,20
W 6
MA 64,32,232
G 56,36,66,2,nt
MA 68,32,236
T 52,21,16
T 54,21,20
MA 72,36,232
T 56,22,16
MA 76,36,236
T 58,22,20
W 6
MA 80,40,232
G 57,36,66,3,nt
MA 84,40,236
T 60,23,16
T 62,23,20
MA 88,44,232
s_waitcnt vmcnt(16)
s_barrier
T 0,16,32
MA 92,44,236
T 2,16,36
s_xor_b32 m0, s65, 0x1c000
s_xor_b32 s66, s63, 0x2000
W 6
MA 96,48,232
G 32,32,66,0,nt
MA 100,48,236
T 4,17,32
T 6,17,36
MA 104,52,232
T 8,18,32
MA 108,52,236
T 10,18,36
W 6
MA 112,56,232
G 33,32,66,1,nt
MA 116,56,236
T 12,19,32
T 14,19,36
MA 120,60,232
T 16,20,32
MA 124,60,236
T 18,20,36
W 6
MA 64,0,240
G 34,32,66,2,nt
MA 68,0,244
T 20,21,32
T 22,21,36
MA 72,4,240
T 24,22,32
MA 76,4,244
T 26,22,36
W 6
MA 80,8,240
G 35,32,66,3,nt
MA 84,8,244
T 28,23,32
T 30,23,36
MA 88,12,240
s_waitcnt vmcnt(16)
s_barrier
MA 92,12,244
T 32,16,48
T 34,16,52
W 6
MA 96,16,240
T 36,17,48
MA 100,16,244
T 38,17,52
MA 104,20,240
T 40,18,48
MA 108,20,244
T 42,18,52
W 6
MA 112,24,240
T 44,19,48
MA 116,24,244
T 46,19,52
MA 120,28,240
T 48,20,48
MA 124,28,244
T 50,20,52
W 6
MA 64,32,248
T 52,21,48
MA 68,32,252
T 54,21,52
MA 72,36,248
T 56,22,48
MA 76,36,252
T 58,22,52
W 6
MA 80,40,248
T 60,23,48
MA 84,40,252
T 62,23,52
MA 88,44,248
s_waitcnt vmcnt(12)
s_barrier
MA 92,44,252
R a,0,12,0
s_xor_b32 m0, s65, 0x0
s_xor_b32 s66, s63, 0x15000
W 5
MA 96,48,248
G 56,36,66,0,nt
MA 100,48,252
R a,4,13,0
MA 104,52,248
R a,8,14,0
MA 108,52,252
W 3
MA 112,56,248
G 57,36,66,1,nt
MA 116,56,252
R a,12,15,0
MA 120,60,248
R a,16,12,4
MA 124,60,252
v_pk_mul_f32 v[64:65], v[64:65], s[74:75]
v_pk_mul_f32 v[66:67], v[66:67], s[74:75]
v_pk_mul_f32 v[68:69], v[68:69], s[74:75]
v_pk_mul_f32 v[70:71], v[70:71], s[74:75]
v_pk_mul_f32 v[72:73], v[72:73], s[74:75]
v_pk_mul_f32 v[74:75], v[74:75], s[74:75]
v_pk_mul_f32 v[76:77], v[76:77], s[74:75]
v_pk_mul_f32 v[78:79], v[78:79], s[74:75]
CV 64,64
CV 66,66
CV 68,68
CV 70,70
CV 72,72
CV 74,74
CV 76,76
CV 78,78
v_permlane32_swap_b32 v64, v72
v_permlane32_swap_b32 v66, v74
v_permlane32_swap_b32 v68, v76
v_permlane32_swap_b32 v70, v78
v_permlane16_swap_b32 v64, v72
v_permlane16_swap_b32 v66, v74
v_permlane16_swap_b32 v68, v76
v_permlane16_swap_b32 v70, v78
AW 224,64
AW 225,66
AW 226,72
AW 227,74
AW 228,68
AW 229,70
AW 230,76
AW 231,78
v_pk_mul_f32 v[80:81], v[80:81], s[74:75]
v_pk_mul_f32 v[82:83], v[82:83], s[74:75]
v_pk_mul_f32 v[84:85], v[84:85], s[74:75]
v_pk_mul_f32 v[86:87], v[86:87], s[74:75]
v_pk_mul_f32 v[88:89], v[88:89], s[74:75]
v_pk_mul_f32 v[90:91], v[90:91], s[74:75]
v_pk_mul_f32 v[92:93], v[92:93], s[74:75]
v_pk_mul_f32 v[94:95], v[94:95], s[74:75]
CV 80,80
CV 82,82
CV 84,84
CV 86,86
CV 88,88
CV 90,90
CV 92,92
CV 94,94
v_permlane32_swap_b32 v80, v88
v_permlane32_swap_b32 v82, v90
v_permlane32_swap_b32 v84, v92
v_permlane32_swap_b32 v86, v94
v_permlane16_swap_b32 v80, v88
v_permlane16_swap_b32 v82, v90
v_permlane16_swap_b32 v84, v92
v_permlane16_swap_b32 v86, v94
AW 232,80
AW 233,82
AW 234,88
AW 235,90
AW 236,84
AW 237,86
AW 238,92
AW 239,94
v_pk_mul_f32 v[96:97], v[96:97], s[74:75]
v_pk_mul_f32 v[98:99], v[98:99], s[74:75]
v_pk_mul_f32 v[100:101], v[100:101], s[74:75]
v_pk_mul_f32 v[102:103], v[102:103], s[74:75]
v_pk_mul_f32 v[104:105], v[104:105], s[74:75]
v_pk_mul_f32 v[106:107], v[106:107], s[74:75]
v_pk_mul_f32 v[108:109], v[108:109], s[74:75]
v_pk_mul_f32 v[110:111], v[110:111], s[74:75]
CV 96,96
CV 98,98
CV 100,100
CV 102,102
CV 104,104
CV 106,106
CV 108,108
CV 110,110
v_permlane32_swap_b32 v96, v104
v_permlane32_swap_b32 v98, v106
v_permlane32_swap_b32 v100, v108
v_permlane32_swap_b32 v102, v110
v_permlane16_swap_b32 v96, v104
v_permlane16_swap_b32 v98, v106
v_permlane16_swap_b32 v100, v108
v_permlane16_swap_b32 v102, v110
AW 240,96
AW 241,98
AW 242,104
AW 243,106
AW 244,100
AW 245,102
AW 246,108
AW 247,110
v_pk_mul_f32 v[112:113], v[112:113], s[74:75]
v_pk_mul_f32 v[114:115], v[114:115], s[74:75]
v_pk_mul_f32 v[116:117], v[116:117], s[74:75]
v_pk_mul_f32 v[118:119], v[118:119], s[74:75]
v_pk_mul_f32 v[120:121], v[120:121], s[74:75]
v_pk_mul_f32 v[122:123], v[122:123], s[74:75]
v_pk_mul_f32 v[124:125], v[124:125], s[74:75]
v_pk_mul_f32 v[126:127], v[126:127], s[74:75]
CV 112,112
CV 114,114
CV 116,116
CV 118,118
CV 120,120
CV 122,122
CV 124,124
CV 126,126
v_permlane32_swap_b32 v112, v120
v_permlane32_swap_b32 v114, v122
v_permlane32_swap_b32 v116, v124
v_permlane32_swap_b32 v118, v126
v_permlane16_swap_b32 v112, v120
v_permlane16_swap_b32 v114, v122
v_permlane16_swap_b32 v116, v124
v_permlane16_swap_b32 v118, v126
AW 248,112
AW 249,114
AW 250,120
AW 251,122
AW 252,116
AW 253,118
AW 254,124
AW 255,126
W 3
ZB 64,0,64
G 56,36,66,2,nt
ZB 68,0,68
R a,20,13,4
MB 64,4,72
R a,24,14,4
MB 68,4,76
W 3
MB 64,8,80
G 57,36,66,3,nt
MB 68,8,84
R a,28,15,4
MB 64,12,88
MB 68,12,92
W 2
ZB 72,16,64
ZB 76,16,68
MB 72,20,72
MB 76,20,76
W 0
MB 72,24,80
E 64
MB 76,24,84
MB 72,28,88
E 65
MB 76,28,92
CV 96,64
E 66
E 67
s_nop 0
CV 97,66
E 68
s_waitcnt vmcnt(12)
s_barrier
R a,0,12,16
E 69
s_xor_b32 m0, s65, 0x4000
s_xor_b32 s66, s63, 0x12000
R a,4,13,16
G 32,32,66,0,nt
CV 100,68
E 70
R a,8,14,16
E 71
R a,12,15,16
G 33,32,66,1,nt
CV 101,70
E 72
R a,16,12,20
E 73
W 3
ZB 80,0,64
G 34,32,66,2,nt
R a,20,13,20
ZB 84,0,68
CV 98,72
E 74
MB 80,4,72
R a,24,14,20
MB 84,4,76
E 75
W 3
MB 80,8,80
G 35,32,66,3,nt
R a,28,15,20
MB 84,8,84
CV 99,74
E 76
MB 80,12,88
s_waitcnt vmcnt(12)
s_barrier
T 32,24,32
T 34,24,36
MB 84,12,92
E 77
s_xor_b32 m0, s65, 0x8000
s_xor_b32 s66, s63, 0x2000
W 4
ZB 88,16,64
G 56,36,66,0,nt
T 36,25,32
ZB 92,16,68
T 38,25,36
CV 102,76
E 78
s_getpc_b64 s[88:89]
L_ct1_632:
s_and_b32 s89, s89, 0xffff
s_mov_b32 s90, L_code_end-L_ct1_632
s_mov_b32 s91, 0x20000
v_and_b32 v62, 0x70, v59
v_lshlrev_b32 v62, 3, v62
s_add_u32 s7, s1, 4096
buffer_load_dword v3, v62, s[88:91], s7 offen
MB 88,20,72
T 40,26,32
T 42,26,36
MB 92,20,76
E 79
W 6
MB 88,24,80
G 57,36,66,1,nt
T 44,27,32
MB 92,24,84
T 46,27,36
CV 103,78
E 80
MB 88,28,88
T 48,28,32
T 50,28,36
MB 92,28,92
E 81
W 6
MC 128,32,96
G 56,36,66,2,nt
T 52,29,32
MC 132,32,100
T 54,29,36
CV 104,80
E 82
MC 136,36,96
T 56,30,32
T 58,30,36
MC 140,36,100
E 83
W 6
MC 144,40,96
G 57,36,66,3,nt
T 60,31,32
MC 148,40,100
T 62,31,36
CV 105,82
E 84
MC 152,44,96
E 85
MC 156,44,100
W 4
MC 160,48,96
s_waitcnt vmcnt(13)
s_barrier
R a,0,12,48
CV 108,84
MC 164,48,100
E 86
s_xor_b32 m0, s65, 0xc000
s_xor_b32 s66, s63, 0x6000
MC 168,52,96
G 32,32,66,0,nt
MC 172,52,100
R a,4,13,48
E 87
W 2
MC 176,56,96
R a,8,14,48
CV 109,86
MC 180,56,100
E 88
MC 184,60,96
G 33,32,66,1,nt
MC 188,60,100
R a,12,15,48
E 89
ZD 112,52,96
R a,16,12,52
CV 106,88
ZD 116,52,100
E 90
W 3
ZB 64,0,64
G 34,32,66,2,nt
ZB 68,0,68
R a,20,13,52
E 91
MB 64,4,72
R a,24,14,52
CV 107,90
MB 68,4,76
E 92
W 3
MB 64,8,80
G 35,32,66,3,nt
MB 68,8,84
R a,28,15,52
E 93
MB 64,12,88
s_waitcnt vmcnt(13)
s_barrier
T 32,16,0
T 34,16,4
MB 68,12,92
CV 110,92
E 94
s_xor_b32 m0, s65, 0x10000
s_xor_b32 s66, s63, 0x12000
W 4
ZB 72,16,64
G 56,36,66,0,nt
T 36,17,0
ZB 76,16,68
T 38,17,4
E 95
MB 72,20,72
T 40,18,0
MB 76,20,76
T 42,18,4
CV 111,94
W 6
MB 72,24,80
G 57,36,66,1,nt
T 44,19,0
MB 76,24,84
T 46,19,4
E 64
MB 72,28,88
T 48,20,0
T 50,20,4
MB 76,28,92
E 65
W 6
MC 128,32,104
G 56,36,66,2,nt
T 52,21,0
MC 132,32,108
T 54,21,4
CV 96,64
E 66
MC 136,36,104
T 56,22,0
T 58,22,4
MC 140,36,108
E 67
W 6
MC 144,40,104
G 57,36,66,3,nt
T 60,23,0
MC 148,40,108
T 62,23,4
CV 97,66
E 68
MC 152,44,104
E 69
MC 156,44,108
W 4
MC 160,48,104
s_waitcnt vmcnt(13)
s_barrier
R a,0,8,16
CV 100,68
MC 164,48,108
E 70
s_xor_b32 m0, s65, 0x14000
s_xor_b32 s66, s63, 0x16000
MC 168,52,104
G 32,32,66,0,nt
MC 172,52,108
R a,4,9,16
E 71
W 2
MC 176,56,104
R a,8,10,16
CV 101,70
MC 180,56,108
E 72
MC 184,60,104
G 33,32,66,1,nt
MC 188,60,108
R a,12,11,16
E 73
MD 112,52,104
R a,16,8,20
CV 98,72
MD 116,52,108
E 74
W 3
ZB 80,0,64
G 34,32,66,2,nt
ZB 84,0,68
R a,20,9,20
E 75
MB 80,4,72
R a,24,10,20
CV 99,74
MB 84,4,76
E 76
W 3
MB 80,8,80
G 35,32,66,3,nt
MB 84,8,84
R a,28,11,20
E 77
MB 80,12,88
s_waitcnt vmcnt(12)
s_barrier
T 32,16,32
T 34,16,36
MB 84,12,92
CV 102,76
E 78
s_xor_b32 m0, s65, 0x18000
s_xor_b32 s66, s63, 0x6000
W 4
ZB 88,16,64
G 56,36,66,0,nt
T 36,17,32
ZB 92,16,68
T 38,17,36
E 79
MB 88,20,72
T 40,18,32
MB 92,20,76
T 42,18,36
CV 103,78
W 6
MB 88,24,80
G 57,36,66,1,nt
T 44,19,32
MB 92,24,84
T 46,19,36
E 80
MB 88,28,88
T 48,20,32
T 50,20,36
MB 92,28,92
E 81
W 6
MC 128,32,96
G 56,36,66,2,nt
T 52,21,32
MC 132,32,100
T 54,21,36
CV 104,80
E 82
MC 136,36,96
T 56,22,32
T 58,22,36
MC 140,36,100
E 83
W 6
MC 144,40,96
G 57,36,66,3,nt
T 60,23,32
MC 148,40,100
T 62,23,36
CV 105,82
E 84
MC 152,44,96
E 85
MC 156,44,100
W 4
MC 160,48,96
s_waitcnt vmcnt(12)
s_barrier
R a,0,8,48
CV 108,84
MC 164,48,100
E 86
s_xor_b32 m0, s65, 0x1c000
s_xor_b32 s66, s63, 0x3000
MC 168,52,96
G 32,32,66,0,nt
MC 172,52,100
R a,4,9,48
E 87
W 2
MC 176,56,96
R a,8,10,48
CV 109,86
MC 180,56,100
E 88
MC 184,60,96
G 33,32,66,1,nt
MC 188,60,100
R a,12,11,48
E 89
MD 112,52,96
R a,16,8,52
CV 106,88
MD 116,52,100
E 90
W 3
ZB 64,0,64
G 34,32,66,2,nt
ZB 68,0,68
R a,20,9,52
E 91
MB 64,4,72
R a,24,10,52
CV 107,90
MB 68,4,76
E 92
W 3
MB 64,8,80
G 35,32,66,3,nt
MB 68,8,84
R a,28,11,52
E 93
MB 64,12,88
s_waitcnt vmcnt(12)
s_barrier
T 32,24,0
T 34,24,4
MB 68,12,92
CV 110,92
E 94
s_xor_b32 m0, s65, 0x0
s_xor_b32 s66, s63, 0x16000
W 4
ZB 72,16,64
G 56,36,66,0,nt
T 36,25,0
ZB 76,16,68
T 38,25,4
E 95
MB 72,20,72
T 40,26,0
MB 76,20,76
T 42,26,4
CV 111,94
W 6
MB 72,24,80
G 57,36,66,1,nt
T 44,27,0
MB 76,24,84
T 46,27,4
E 64
MB 72,28,88
T 48,28,0
T 50,28,4
MB 76,28,92
E 65
W 6
MC 128,32,104
G 56,36,66,2,nt
T 52,29,0
MC 132,32,108
T 54,29,4
CV 96,64
E 66
MC 136,36,104
T 56,30,0
T 58,30,4
MC 140,36,108
E 67
W 6
MC 144,40,104
G 57,36,66,3,nt
T 60,31,0
MC 148,40,108
T 62,31,4
CV 97,66
E 68
MC 152,44,104
E 69
MC 156,44,108
W 4
MC 160,48,104
s_waitcnt vmcnt(12)
s_barrier
R a,0,12,16
CV 100,68
MC 164,48,108
E 70
s_xor_b32 m0, s65, 0x4000
s_xor_b32 s66, s63, 0x13000
MC 168,52,104
G 32,32,66,0,nt
MC 172,52,108
R a,4,13,16
E 71
W 2
MC 176,56,104
R a,8,14,16
CV 101,70
MC 180,56,108
E 72
MC 184,60,104
G 33,32,66,1,nt
MC 188,60,108
R a,12,15,16
E 73
MD 112,52,104
R a,16,12,20
CV 98,72
MD 116,52,108
E 74
W 3
ZB 80,0,64
G 34,32,66,2,nt
ZB 84,0,68
R a,20,13,20
E 75
MB 80,4,72
R a,24,14,20
CV 99,74
MB 84,4,76
E 76
W 3
MB 80,8,80
G 35,32,66,3,nt
MB 84,8,84
R a,28,15,20
E 77
MB 80,12,88
s_waitcnt vmcnt(12)
s_barrier
T 32,24,32
T 34,24,36
MB 84,12,92
CV 102,76
E 78
s_xor_b32 m0, s65, 0x8000
s_xor_b32 s66, s63, 0x3000
W 4
ZB 88,16,64
G 56,36,66,0,nt
T 36,25,32
ZB 92,16,68
T 38,25,36
E 79
MB 88,20,72
T 40,26,32
MB 92,20,76
T 42,26,36
CV 103,78
W 6
MB 88,24,80
G 57,36,66,1,nt
T 44,27,32
MB 92,24,84
T 46,27,36
E 80
MB 88,28,88
T 48,28,32
T 50,28,36
MB 92,28,92
E 81
W 6
MC 128,32,96
G 56,36,66,2,nt
T 52,29,32
MC 132,32,100
T 54,29,36
CV 104,80
E 82
MC 136,36,96
T 56,30,32
T 58,30,36
MC 140,36,100
E 83
W 6
MC 144,40,96
G 57,36,66,3,nt
T 60,31,32
MC 148,40,100
T 62,31,36
CV 105,82
E 84
MC 152,44,96
E 85
MC 156,44,100
W 4
MC 160,48,96
s_waitcnt vmcnt(12)
s_barrier
R a,0,12,48
CV 108,84
MC 164,48,100
E 86
s_xor_b32 m0, s65, 0xc000
s_xor_b32 s66, s63, 0x7000
MC 168,52,96
G 32,32,66,0,nt
MC 172,52,100
R a,4,13,48
E 87
W 2
MC 176,56,96
R a,8,14,48
CV 109,86
MC 180,56,100
E 88
MC 184,60,96
G 33,32,66,1,nt
MC 188,60,100
R a,12,15,48
E 89
MD 112,52,96
R a,16,12,52
CV 106,88
MD 116,52,100
E 90
W 3
ZB 64,0,64
G 34,32,66,2,nt
ZB 68,0,68
R a,20,13,52
E 91
MB 64,4,72
R a,24,14,52
CV 107,90
MB 68,4,76
E 92
W 3
MB 64,8,80
G 35,32,66,3,nt
MB 68,8,84
R a,28,15,52
E 93
MB 64,12,88
s_waitcnt vmcnt(12)
s_barrier
T 32,16,0
T 34,16,4
MB 68,12,92
CV 110,92
E 94
s_xor_b32 m0, s65, 0x10000
s_xor_b32 s66, s63, 0x13000
W 4
ZB 72,16,64
G 56,36,66,0,nt
T 36,17,0
ZB 76,16,68
T 38,17,4
E 95
MB 72,20,72
T 40,18,0
MB 76,20,76
T 42,18,4
CV 111,94
W 6
MB 72,24,80
G 57,36,66,1,nt
T 44,19,0
MB 76,24,84
T 46,19,4
E 64
MB 72,28,88
T 48,20,0
T 50,20,4
MB 76,28,92
E 65
W 6
MC 128,32,104
G 56,36,66,2,nt
T 52,21,0
MC 132,32,108
T 54,21,4
CV 96,64
E 66
MC 136,36,104
T 56,22,0
T 58,22,4
MC 140,36,108
E 67
W 6
MC 144,40,104
G 57,36,66,3,nt
T 60,23,0
MC 148,40,108
T 62,23,4
CV 97,66
E 68
MC 152,44,104
E 69
MC 156,44,108
W 4
MC 160,48,104
s_waitcnt vmcnt(12)
s_barrier
R a,0,8,16
CV 100,68
MC 164,48,108
E 70
s_xor_b32 m0, s65, 0x14000
s_xor_b32 s66, s63, 0x17000
MC 168,52,104
G 32,32,66,0,nt
MC 172,52,108
R a,4,9,16
E 71
W 2
MC 176,56,104
R a,8,10,16
CV 101,70
MC 180,56,108
E 72
MC 184,60,104
G 33,32,66,1,nt
MC 188,60,108
R a,12,11,16
E 73
MD 112,52,104
R a,16,8,20
CV 98,72
MD 116,52,108
E 74
W 3
ZB 80,0,64
G 34,32,66,2,nt
ZB 84,0,68
R a,20,9,20
E 75
MB 80,4,72
R a,24,10,20
CV 99,74
MB 84,4,76
E 76
W 3
MB 80,8,80
G 35,32,66,3,nt
MB 84,8,84
R a,28,11,20
E 77
MB 80,12,88
s_waitcnt vmcnt(12)
s_barrier
T 32,16,32
T 34,16,36
MB 84,12,92
CV 102,76
E 78
s_xor_b32 m0, s65, 0x18000
s_xor_b32 s66, s63, 0x7000
W 4
ZB 88,16,64
G 56,36,66,0,nt
T 36,17,32
ZB 92,16,68
T 38,17,36
E 79
MB 88,20,72
T 40,18,32
MB 92,20,76
T 42,18,36
CV 103,78
W 6
MB 88,24,80
G 57,36,66,1,nt
T 44,19,32
MB 92,24,84
T 46,19,36
E 80
MB 88,28,88
T 48,20,32
T 50,20,36
MB 92,28,92
E 81
W 6
MC 128,32,96
G 56,36,66,2,nt
T 52,21,32
MC 132,32,100
T 54,21,36
CV 104,80
E 82
MC 136,36,96
T 56,22,32
T 58,22,36
MC 140,36,100
E 83
W 6
MC 144,40,96
G 57,36,66,3,nt
T 60,23,32
MC 148,40,100
T 62,23,36
CV 105,82
E 84
MC 152,44,96
E 85
MC 156,44,100
W 4
MC 160,48,96
s_waitcnt vmcnt(12)
s_barrier
R a,0,8,48
CV 108,84
MC 164,48,100
E 86
s_xor_b32 m0, s65, 0x1c000
s_xor_b32 s66, s63, 0x17000
MC 168,52,96
G 56,36,66,0,nt
MC 172,52,100
R a,4,9,48
E 87
W 2
MC 176,56,96
R a,8,10,48
CV 109,86
MC 180,56,100
E 88
MC 184,60,96
G 57,36,66,1,nt
MC 188,60,100
R a,12,11,48
E 89
MD 112,52,96
R a,16,8,52
CV 106,88
MD 116,52,100
E 90
W 3
ZB 64,0,64
G 56,36,66,2,nt
ZB 68,0,68
R a,20,9,52
E 91
MB 64,4,72
R a,24,10,52
CV 107,90
MB 68,4,76
E 92
W 3
MB 64,8,80
G 57,36,66,3,nt
MB 68,8,84
R a,28,11,52
E 93
MB 64,12,88
s_waitcnt vmcnt(12)
s_barrier
T 32,24,0
T 34,24,4
MB 68,12,92
CV 110,92
E 94
s_xor_b32 m0, s65, 0x0
s_xor_b32 s66, s63, 0x40000
W 4
ZB 72,16,64
G 32,32,66,0,nt
T 36,25,0
ZB 76,16,68
T 38,25,4
E 95
MB 72,20,72
T 40,26,0
MB 76,20,76
T 42,26,4
CV 111,94
W 6
MB 72,24,80
G 33,32,66,1,nt
T 44,27,0
MB 76,24,84
T 46,27,4
E 64
MB 72,28,88
T 48,28,0
T 50,28,4
MB 76,28,92
E 65
W 6
MC 128,32,104
G 34,32,66,2,nt
T 52,29,0
MC 132,32,108
T 54,29,4
CV 96,64
E 66
MC 136,36,104
T 56,30,0
T 58,30,4
MC 140,36,108
E 67
W 6
MC 144,40,104
G 35,32,66,3,nt
T 60,31,0
MC 148,40,108
T 62,31,4
CV 97,66
E 68
MC 152,44,104
E 69
MC 156,44,108
W 4
MC 160,48,104
s_waitcnt vmcnt(12)
s_barrier
R a,0,12,16
CV 100,68
MC 164,48,108
E 70
s_xor_b32 m0, s65, 0x4000
s_xor_b32 s66, s63, 0x50000
MC 168,52,104
G 32,32,66,0,nt
MC 172,52,108
R a,4,13,16
E 71
W 2
MC 176,56,104
R a,8,14,16
CV 101,70
MC 180,56,108
E 72
MC 184,60,104
G 33,32,66,1,nt
MC 188,60,108
R a,12,15,16
E 73
MD 112,52,104
R a,16,12,20
CV 98,72
MD 116,52,108
E 74
W 3
ZB 80,0,64
G 34,32,66,2,nt
ZB 84,0,68
R a,20,13,20
E 75
MB 80,4,72
R a,24,14,20
CV 99,74
MB 84,4,76
E 76
W 3
MB 80,8,80
G 35,32,66,3,nt
MB 84,8,84
R a,28,15,20
E 77
MB 80,12,88
s_waitcnt vmcnt(12)
s_barrier
T 32,24,32
T 34,24,36
MB 84,12,92
CV 102,76
E 78
s_xor_b32 m0, s65, 0x8000
s_xor_b32 s66, s63, 0x40000
W 4
ZB 88,16,64
G 56,36,66,0,nt
T 36,25,32
ZB 92,16,68
T 38,25,36
E 79
MB 88,20,72
T 40,26,32
MB 92,20,76
T 42,26,36
CV 103,78
W 6
MB 88,24,80
G 57,36,66,1,nt
T 44,27,32
MB 92,24,84
T 46,27,36
E 80
MB 88,28,88
T 48,28,32
T 50,28,36
MB 92,28,92
E 81
W 6
MC 128,32,96
G 56,36,66,2,nt
T 52,29,32
MC 132,32,100
T 54,29,36
CV 104,80
E 82
MC 136,36,96
T 56,30,32
T 58,30,36
MC 140,36,100
E 83
W 6
MC 144,40,96
G 57,36,66,3,nt
T 60,31,32
MC 148,40,100
T 62,31,36
CV 105,82
E 84
MC 152,44,96
E 85
MC 156,44,100
W 4
MC 160,48,96
CV 108,84
MC 164,48,100
E 86
MC 168,52,96
E 87
MC 172,52,100
W 0
MC 176,56,96
CV 109,86
MC 180,56,100
E 88
MC 184,60,96
E 89
MC 188,60,100
MD 112,52,96
CV 106,88
MD 116,52,100
E 90
E 91
s_nop 0
CV 107,90
E 92
E 93
s_waitcnt vmcnt(12)
s_barrier
T 32,24,48
T 34,24,52
CV 110,92
E 94
s_xor_b32 m0, s65, 0xc000
s_xor_b32 s66, s63, 0x44000
T 36,25,48
T 38,25,52
G 32,32,66,0,nt
E 95
T 40,26,48
T 42,26,52
CV 111,94
T 44,27,48
T 46,27,52
G 33,32,66,1,nt
T 48,28,48
T 50,28,52
W 6
MC 128,32,104
G 34,32,66,2,nt
MC 132,32,108
T 52,29,48
T 54,29,52
MC 136,36,104
T 56,30,48
MC 140,36,108
T 58,30,52
W 6
MC 144,40,104
G 35,32,66,3,nt
MC 148,40,108
T 60,31,48
T 62,31,52
MC 152,44,104
MC 156,44,108
W 4
MC 160,48,104
s_waitcnt vmcnt(12)
s_barrier
MC 164,48,108
R a,0,8,0
s_xor_b32 m0, s65, 0x10000
s_xor_b32 s66, s63, 0x50000
MC 168,52,104
G 56,36,66,0,nt
MC 172,52,108
R a,4,9,0
W 2
MC 176,56,104
R a,8,10,0
MC 180,56,108
MC 184,60,104
G 57,36,66,1,nt
MC 188,60,108
R a,12,11,0
MD 112,52,104
R a,16,8,4
MD 116,52,108
s_nop 5
v_add_f32 v60, v112, v6
s_nop 0
v_add_f32 v61, v116, v7
v_cmp_nle_f32 vcc, s76, v60
v_cmp_nge_f32 s[82:83], s77, v60
v_cmp_nle_f32 s[84:85], s76, v61
v_cmp_nge_f32 s[90:91], s77, v61
s_nop 1
s_or_b64 vcc, vcc, s[82:83]
s_or_b64 vcc, vcc, s[84:85]
s_or_b64 vcc, vcc, s[90:91]
s_cbranch_scc1 L_slow_c1B0
L_back_c1B0:
v_rcp_f32 v0, v60
v_rcp_f32 v1, v61
AR 112,128
AR 113,129
AR 114,130
AR 115,131
AR 116,132
AR 117,133
AR 118,134
AR 119,135
AR 120,136
AR 121,137
AR 122,138
AR 123,139
AR 124,140
AR 125,141
AR 126,142
AR 127,143
v_pk_mul_f32 v[112:113], v[112:113], v[0:1] op_sel_hi:[1,0]
v_pk_mul_f32 v[114:115], v[114:115], v[0:1] op_sel_hi:[1,0]
v_pk_mul_f32 v[116:117], v[116:117], v[0:1] op_sel:[0,1]
v_pk_mul_f32 v[118:119], v[118:119], v[0:1] op_sel:[0,1]
v_pk_mul_f32 v[120:121], v[120:121], v[0:1] op_sel_hi:[1,0]
v_pk_mul_f32 v[122:123], v[122:123], v[0:1] op_sel_hi:[1,0]
v_pk_mul_f32 v[124:125], v[124:125], v[0:1] op_sel:[0,1]
v_pk_mul_f32 v[126:127], v[126:127], v[0:1] op_sel:[0,1]
CV 112,112
CV 114,114
CV 116,116
CV 118,118
CV 120,120
CV 122,122
CV 124,124
CV 126,126
AW 64,112
AW 65,114
AW 68,116
AW 69,118
AW 66,120
AW 67,122
AW 70,124
AW 71,126
AR 112,144
AR 113,145
AR 114,146
AR 115,147
AR 116,148
AR 117,149
AR 118,150
AR 119,151
AR 120,152
AR 121,153
AR 122,154
AR 123,155
AR 124,156
AR 125,157
AR 126,158
AR 127,159
v_pk_mul_f32 v[112:113], v[112:113], v[0:1] op_sel_hi:[1,0]
v_pk_mul_f32 v[114:115], v[114:115], v[0:1] op_sel_hi:[1,0]
v_pk_mul_f32 v[116:117], v[116:117], v[0:1] op_sel:[0,1]
v_pk_mul_f32 v[118:119], v[118:119], v[0:1] op_sel:[0,1]
v_pk_mul_f32 v[120:121], v[120:121], v[0:1] op_sel_hi:[1,0]
v_pk_mul_f32 v[122:123], v[122:123], v[0:1] op_sel_hi:[1,0]
v_pk_mul_f32 v[124:125], v[124:125], v[0:1] op_sel:[0,1]
v_pk_mul_f32 v[126:127], v[126:127], v[0:1] op_sel:[0,1]
CV 112,112
CV 114,114
CV 116,116
CV 118,118
CV 120,120
CV 122,122
CV 124,124
CV 126,126
AW 72,112
AW 73,114
AW 76,116
AW 77,118
AW 74,120
AW 75,122
AW 78,124
AW 79,126
AR 112,160
AR 113,161
AR 114,162
AR 115,163
AR 116,164
AR 117,165
AR 118,166
AR 119,167
AR 120,168
AR 121,169
AR 122,170
AR 123,171
AR 124,172
AR 125,173
AR 126,174
AR 127,175
v_pk_mul_f32 v[112:113], v[112:113], v[0:1] op_sel_hi:[1,0]
v_pk_mul_f32 v[114:115], v[114:115], v[0:1] op_sel_hi:[1,0]
v_pk_mul_f32 v[116:117], v[116:117], v[0:1] op_sel:[0,1]
v_pk_mul_f32 v[118:119], v[118:119], v[0:1] op_sel:[0,1]
v_pk_mul_f32 v[120:121], v[120:121], v[0:1] op_sel_hi:[1,0]
v_pk_mul_f32 v[122:123], v[122:123], v[0:1] op_sel_hi:[1,0]
v_pk_mul_f32 v[124:125], v[124:125], v[0:1] op_sel:[0,1]
v_pk_mul_f32 v[126:127], v[126:127], v[0:1] op_sel:[0,1]
CV 112,112
CV 114,114
CV 116,116
CV 118,118
CV 120,120
CV 122,122
CV 124,124
CV 126,126
AW 80,112
AW 81,114
AW 84,116
AW 85,118
AW 82,120
AW 83,122
AW 86,124
AW 87,126
AR 112,176
AR 113,177
AR 114,178
AR 115,179
AR 116,180
AR 117,181
AR 118,182
AR 119,183
AR 120,184
AR 121,185
AR 122,186
AR 123,187
AR 124,188
AR 125,189
AR 126,190
AR 127,191
v_pk_mul_f32 v[112:113], v[112:113], v[0:1] op_sel_hi:[1,0]
v_pk_mul_f32 v[114:115], v[114:115], v[0:1] op_sel_hi:[1,0]
v_pk_mul_f32 v[116:117], v[116:117], v[0:1] op_sel:[0,1]
v_pk_mul_f32 v[118:119], v[118:119], v[0:1] op_sel:[0,1]
v_pk_mul_f32 v[120:121], v[120:121], v[0:1] op_sel_hi:[1,0]
v_pk_mul_f32 v[122:123], v[122:123], v[0:1] op_sel_hi:[1,0]
v_pk_mul_f32 v[124:125], v[124:125], v[0:1] op_sel:[0,1]
v_pk_mul_f32 v[126:127], v[126:127], v[0:1] op_sel:[0,1]
CV 112,112
CV 114,114
CV 116,116
CV 118,118
CV 120,120
CV 122,122
CV 124,124
CV 126,126
AW 88,112
AW 89,114
AW 92,116
AW 93,118
AW 90,120
AW 91,122
AW 94,124
AW 95,126
W 3
ZB 64,0,96
G 56,36,66,2,nt
ZB 68,0,100
R a,20,9,4
MB 64,4,104
R a,24,10,4
MB 68,4,108
W 3
MB 64,8,112
G 57,36,66,3,nt
MB 68,8,116
R a,28,11,4
MB 64,12,120
MB 68,12,124
W 2
ZB 72,16,96
ZB 76,16,100
MB 72,20,104
MB 76,20,108
W 0
MB 72,24,112
E 64
MB 76,24,116
MB 72,28,120
E 65
MB 76,28,124
CV 96,64
E 66
E 67
s_nop 0
CV 97,66
E 68
s_waitcnt vmcnt(12)
s_barrier
R a,0,8,16
E 69
s_xor_b32 m0, s65, 0x14000
s_xor_b32 s66, s63, 0x54000
R a,4,9,16
G 32,32,66,0,nt
CV 100,68
E 70
R a,8,10,16
E 71
R a,12,11,16
G 33,32,66,1,nt
CV 101,70
E 72
R a,16,8,20
E 73
W 3
ZB 80,0,96
G 34,32,66,2,nt
R a,20,9,20
ZB 84,0,100
CV 98,72
E 74
MB 80,4,104
R a,24,10,20
MB 84,4,108
E 75
W 3
MB 80,8,112
G 35,32,66,3,nt
R a,28,11,20
MB 84,8,116
CV 99,74
E 76
MB 80,12,120
s_waitcnt vmcnt(12)
s_barrier
T 32,16,32
T 34,16,36
MB 84,12,124
E 77
s_xor_b32 m0, s65, 0x18000
s_xor_b32 s66, s63, 0x44000
W 4
ZB 88,16,96
G 56,36,66,0,nt
T 36,17,32
ZB 92,16,100
T 38,17,36
CV 102,76
E 78
s_getpc_b64 s[88:89]
L_ct1_818:
s_and_b32 s89, s89, 0xffff
s_mov_b32 s90, L_code_end-L_ct1_818
s_mov_b32 s91, 0x20000
v_and_b32 v62, 0x70, v59
v_lshlrev_b32 v62, 3, v62
s_add_u32 s7, s1, 4096
buffer_load_dword v3, v62, s[88:91], s7 offen
MB 88,20,104
T 40,18,32
T 42,18,36
MB 92,20,108
E 79
W 6
MB 88,24,112
G 57,36,66,1,nt
T 44,19,32
MB 92,24,116
T 46,19,36
CV 103,78
E 80
MB 88,28,120
T 48,20,32
T 50,20,36
MB 92,28,124
E 81
W 6
ZA 128,32,96
G 56,36,66,2,nt
T 52,21,32
ZA 132,32,100
T 54,21,36
CV 104,80
E 82
ZA 136,36,96
T 56,22,32
T 58,22,36
ZA 140,36,100
E 83
W 6
ZA 144,40,96
G 57,36,66,3,nt
T 60,23,32
ZA 148,40,100
T 62,23,36
CV 105,82
E 84
ZA 152,44,96
E 85
ZA 156,44,100
W 4
ZA 160,48,96
s_waitcnt vmcnt(13)
s_barrier
R a,0,8,48
CV 108,84
ZA 164,48,100
E 86
s_xor_b32 m0, s65, 0x1c000
s_xor_b32 s66, s63, 0x41000
ZA 168,52,96
G 32,32,66,0,nt
ZA 172,52,100
R a,4,9,48
E 87
W 2
ZA 176,56,96
R a,8,10,48
CV 109,86
ZA 180,56,100
E 88
ZA 184,60,96
G 33,32,66,1,nt
ZA 188,60,100
R a,12,11,48
E 89
ZD 112,52,96
R a,16,8,52
CV 106,88
ZD 116,52,100
E 90
W 3
ZB 64,0,96
G 34,32,66,2,nt
ZB 68,0,100
R a,20,9,52
E 91
MB 64,4,104
R a,24,10,52
CV 107,90
MB 68,4,108
E 92
W 3
MB 64,8,112
G 35,32,66,3,nt
MB 68,8,116
R a,28,11,52
E 93
MB 64,12,120
s_waitcnt vmcnt(13)
s_barrier
T 32,24,0
T 34,24,4
MB 68,12,124
CV 110,92
E 94
s_xor_b32 m0, s65, 0x0
s_xor_b32 s66, s63, 0x54000
W 4
ZB 72,16,96
G 56,36,66,0,nt
T 36,25,0
ZB 76,16,100
T 38,25,4
E 95
MB 72,20,104
T 40,26,0
MB 76,20,108
T 42,26,4
CV 111,94
W 6
MB 72,24,112
G 57,36,66,1,nt
T 44,27,0
MB 76,24,116
T 46,27,4
E 64
MB 72,28,120
T 48,28,0
T 50,28,4
MB 76,28,124
E 65
W 6
MA 128,32,104
G 56,36,66,2,nt
T 52,29,0
MA 132,32,108
T 54,29,4
CV 96,64
E 66
MA 136,36,104
T 56,30,0
T 58,30,4
MA 140,36,108
E 67
W 6
MA 144,40,104
G 57,36,66,3,nt
T 60,31,0
MA 148,40,108
T 62,31,4
CV 97,66
E 68
MA 152,44,104
E 69
MA 156,44,108
W 4
MA 160,48,104
s_waitcnt vmcnt(13)
s_barrier
R a,0,12,16
CV 100,68
MA 164,48,108
E 70
s_xor_b32 m0, s65, 0x4000
s_xor_b32 s66, s63, 0x51000
MA 168,52,104
G 32,32,66,0,nt
MA 172,52,108
R a,4,13,16
E 71
W 2
MA 176,56,104
R a,8,14,16
CV 101,70
MA 180,56,108
E 72
MA 184,60,104
G 33,32,66,1,nt
MA 188,60,108
R a,12,15,16
E 73
MD 112,52,104
R a,16,12,20
CV 98,72
MD 116,52,108
E 74
W 3
ZB 80,0,96
G 34,32,66,2,nt
ZB 84,0,100
R a,20,13,20
E 75
MB 80,4,104
R a,24,14,20
CV 99,74
MB 84,4,108
E 76
W 3
MB 80,8,112
G 35,32,66,3,nt
MB 84,8,116
R a,28,15,20
E 77
MB 80,12,120
s_waitcnt vmcnt(12)
s_barrier
T 32,24,32
T 34,24,36
MB 84,12,124
CV 102,76
E 78
s_xor_b32 m0, s65, 0x8000
s_xor_b32 s66, s63, 0x41000
W 4
ZB 88,16,96
G 56,36,66,0,nt
T 36,25,32
ZB 92,16,100
T 38,25,36
E 79
MB 88,20,104
T 40,26,32
MB 92,20,108
T 42,26,36
CV 103,78
W 6
MB 88,24,112
G 57,36,66,1,nt
T 44,27,32
MB 92,24,116
T 46,27,36
E 80
MB 88,28,120
T 48,28,32
T 50,28,36
MB 92,28,124
E 81
W 6
MA 128,32,96
G 56,36,66,2,nt
T 52,29,32
MA 132,32,100
T 54,29,36
CV 104,80
E 82
MA 136,36,96
T 56,30,32
T 58,30,36
MA 140,36,100
E 83
W 6
MA 144,40,96
G 57,36,66,3,nt
T 60,31,32
MA 148,40,100
T 62,31,36
CV 105,82
E 84
MA 152,44,96
E 85
MA 156,44,100
W 4
MA 160,48,96
s_waitcnt vmcnt(12)
s_barrier
R a,0,12,48
CV 108,84
MA 164,48,100
E 86
s_xor_b32 m0, s65, 0xc000
s_xor_b32 s66, s63, 0x45000
MA 168,52,96
G 32,32,66,0,nt
MA 172,52,100
R a,4,13,48
E 87
W 2
MA 176,56,96
R a,8,14,48
CV 109,86
MA 180,56,100
E 88
MA 184,60,96
G 33,32,66,1,nt
MA 188,60,100
R a,12,15,48
E 89
MD 112,52,96
R a,16,12,52
CV 106,88
MD 116,52,100
E 90
W 3
ZB 64,0,96
G 34,32,66,2,nt
ZB 68,0,100
R a,20,13,52
E 91
MB 64,4,104
R a,24,14,52
CV 107,90
MB 68,4,108
E 92
W 3
MB 64,8,112
G 35,32,66,3,nt
MB 68,8,116
R a,28,15,52
E 93
MB 64,12,120
s_waitcnt vmcnt(12)
s_barrier
T 32,16,0
T 34,16,4
MB 68,12,124
CV 110,92
E 94
s_xor_b32 m0, s65, 0x10000
s_xor_b32 s66, s63, 0x51000
W 4
ZB 72,16,96
G 56,36,66,0,nt
T 36,17,0
ZB 76,16,100
T 38,17,4
E 95
MB 72,20,104
T 40,18,0
MB 76,20,108
T 42,18,4
CV 111,94
W 6
MB 72,24,112
G 57,36,66,1,nt
T 44,19,0
MB 76,24,116
T 46,19,4
E 64
MB 72,28,120
T 48,20,0
T 50,20,4
MB 76,28,124
E 65
W 6
MA 128,32,104
G 56,36,66,2,nt
T 52,21,0
MA 132,32,108
T 54,21,4
CV 96,64
E 66
MA 136,36,104
T 56,22,0
T 58,22,4
MA 140,36,108
E 67
W 6
MA 144,40,104
G 57,36,66,3,nt
T 60,23,0
MA 148,40,108
T 62,23,4
CV 97,66
E 68
MA 152,44,104
E 69
MA 156,44,108
W 4
MA 160,48,104
s_waitcnt vmcnt(12)
s_barrier
R a,0,8,16
CV 100,68
MA 164,48,108
E 70
s_xor_b32 m0, s65, 0x14000
s_xor_b32 s66, s63, 0x55000
MA 168,52,104
G 32,32,66,0,nt
MA 172,52,108
R a,4,9,16
E 71
W 2
MA 176,56,104
R a,8,10,16
CV 101,70
MA 180,56,108
E 72
MA 184,60,104
G 33,32,66,1,nt
MA 188,60,108
R a,12,11,16
E 73
MD 112,52,104
R a,16,8,20
CV 98,72
MD 116,52,108
E 74
W 3
ZB 80,0,96
G 34,32,66,2,nt
ZB 84,0,100
R a,20,9,20
E 75
MB 80,4,104
R a,24,10,20
CV 99,74
MB 84,4,108
E 76
W 3
MB 80,8,112
G 35,32,66,3,nt
MB 84,8,116
R a,28,11,20
E 77
MB 80,12,120
s_waitcnt vmcnt(12)
s_barrier
T 32,16,32
T 34,16,36
MB 84,12,124
CV 102,76
E 78
s_xor_b32 m0, s65, 0x18000
s_xor_b32 s66, s63, 0x45000
W 4
ZB 88,16,96
G 56,36,66,0,nt
T 36,17,32
ZB 92,16,100
T 38,17,36
E 79
MB 88,20,104
T 40,18,32
MB 92,20,108
T 42,18,36
CV 103,78
W 6
MB 88,24,112
G 57,36,66,1,nt
T 44,19,32
MB 92,24,116
T 46,19,36
E 80
MB 88,28,120
T 48,20,32
T 50,20,36
MB 92,28,124
E 81
W 6
MA 128,32,96
G 56,36,66,2,nt
T 52,21,32
MA 132,32,100
T 54,21,36
CV 104,80
E 82
MA 136,36,96
T 56,22,32
T 58,22,36
MA 140,36,100
E 83
W 6
MA 144,40,96
G 57,36,66,3,nt
T 60,23,32
MA 148,40,100
T 62,23,36
CV 105,82
E 84
MA 152,44,96
E 85
MA 156,44,100
W 4
MA 160,48,96
s_waitcnt vmcnt(12)
s_barrier
R a,0,8,48
CV 108,84
MA 164,48,100
E 86
s_xor_b32 m0, s65, 0x1c000
s_xor_b32 s66, s63, 0x42000
MA 168,52,96
G 32,32,66,0,nt
MA 172,52,100
R a,4,9,48
E 87
W 2
MA 176,56,96
R a,8,10,48
CV 109,86
MA 180,56,100
E 88
MA 184,60,96
G 33,32,66,1,nt
MA 188,60,100
R a,12,11,48
E 89
MD 112,52,96
R a,16,8,52
CV 106,88
MD 116,52,100
E 90
W 3
ZB 64,0,96
G 34,32,66,2,nt
ZB 68,0,100
R a,20,9,52
E 91
MB 64,4,104
R a,24,10,52
CV 107,90
MB 68,4,108
E 92
W 3
MB 64,8,112
G 35,32,66,3,nt
MB 68,8,116
R a,28,11,52
E 93
MB 64,12,120
s_waitcnt vmcnt(12)
s_barrier
T 32,24,0
T 34,24,4
MB 68,12,124
CV 110,92
E 94
s_xor_b32 m0, s65, 0x0
s_xor_b32 s66, s63, 0x55000
W 4
ZB 72,16,96
G 56,36,66,0,nt
T 36,25,0
ZB 76,16,100
T 38,25,4
E 95
MB 72,20,104
T 40,26,0
MB 76,20,108
T 42,26,4
CV 111,94
W 6
MB 72,24,112
G 57,36,66,1,nt
T 44,27,0
MB 76,24,116
T 46,27,4
E 64
MB 72,28,120
T 48,28,0
T 50,28,4
MB 76,28,124
E 65
W 6
MA 128,32,104
G 56,36,66,2,nt
T 52,29,0
MA 132,32,108
T 54,29,4
CV 96,64
E 66
MA 136,36,104
T 56,30,0
T 58,30,4
MA 140,36,108
E 67
W 6
MA 144,40,104
G 57,36,66,3,nt
T 60,31,0
MA 148,40,108
T 62,31,4
CV 97,66
E 68
MA 152,44,104
E 69
MA 156,44,108
W 4
MA 160,48,104
s_waitcnt vmcnt(12)
s_barrier
R a,0,12,16
CV 100,68
MA 164,48,108
E 70
s_xor_b32 m0, s65, 0x4000
s_xor_b32 s66, s63, 0x52000
MA 168,52,104
G 32,32,66,0,nt
MA 172,52,108
R a,4,13,16
E 71
W 2
MA 176,56,104
R a,8,14,16
CV 101,70
MA 180,56,108
E 72
MA 184,60,104
G 33,32,66,1,nt
MA 188,60,108
R a,12,15,16
E 73
MD 112,52,104
R a,16,12,20
CV 98,72
MD 116,52,108
E 74
W 3
ZB 80,0,96
G 34,32,66,2,nt
ZB 84,0,100
R a,20,13,20
E 75
MB 80,4,104
R a,24,14,20
CV 99,74
MB 84,4,108
E 76
W 3
MB 80,8,112
G 35,32,66,3,nt
MB 84,8,116
R a,28,15,20
E 77
MB 80,12,120
s_waitcnt vmcnt(12)
s_barrier
T 32,24,32
T 34,24,36
MB 84,12,124
CV 102,76
E 78
s_xor_b32 m0, s65, 0x8000
s_xor_b32 s66, s63, 0x42000
W 4
ZB 88,16,96
G 56,36,66,0,nt
T 36,25,32
ZB 92,16,100
T 38,25,36
E 79
MB 88,20,104
T 40,26,32
MB 92,20,108
T 42,26,36
CV 103,78
W 6
MB 88,24,112
G 57,36,66,1,nt
T 44,27,32
MB 92,24,116
T 46,27,36
E 80
MB 88,28,120
T 48,28,32
T 50,28,36
MB 92,28,124
E 81
W 6
MA 128,32,96
G 56,36,66,2,nt
T 52,29,32
MA 132,32,100
T 54,29,36
CV 104,80
E 82
MA 136,36,96
T 56,30,32
T 58,30,36
MA 140,36,100
E 83
W 6
MA 144,40,96
G 57,36,66,3,nt
T 60,31,32
MA 148,40,100
T 62,31,36
CV 105,82
E 84
MA 152,44,96
E 85
MA 156,44,100
W 4
MA 160,48,96
s_waitcnt vmcnt(12)
s_barrier
R a,0,12,48
CV 108,84
MA 164,48,100
E 86
s_xor_b32 m0, s65, 0xc000
s_xor_b32 s66, s63, 0x46000
MA 168,52,96
G 32,32,66,0,nt
MA 172,52,100
R a,4,13,48
E 87
W 2
MA 176,56,96
R a,8,14,48
CV 109,86
MA 180,56,100
E 88
MA 184,60,96
G 33,32,66,1,nt
MA 188,60,100
R a,12,15,48
E 89
MD 112,52,96
R a,16,12,52
CV 106,88
MD 116,52,100
E 90
W 3
ZB 64,0,96
G 34,32,66,2,nt
ZB 68,0,100
R a,20,13,52
E 91
MB 64,4,104
R a,24,14,52
CV 107,90
MB 68,4,108
E 92
W 3
MB 64,8,112
G 35,32,66,3,nt
MB 68,8,116
R a,28,15,52
E 93
MB 64,12,120
s_waitcnt vmcnt(12)
s_barrier
T 32,16,0
T 34,16,4
MB 68,12,124
CV 110,92
E 94
s_xor_b32 m0, s65, 0x10000
s_xor_b32 s66, s63, 0x52000
W 4
ZB 72,16,96
G 56,36,66,0,nt
T 36,17,0
ZB 76,16,100
T 38,17,4
E 95
MB 72,20,104
T 40,18,0
MB 76,20,108
T 42,18,4
CV 111,94
W 6
MB 72,24,112
G 57,36,66,1,nt
T 44,19,0
MB 76,24,116
T 46,19,4
E 64
MB 72,28,120
T 48,20,0
T 50,20,4
MB 76,28,124
E 65
W 6
MA 128,32,104
G 56,36,66,2,nt
T 52,21,0
MA 132,32,108
T 54,21,4
CV 96,64
E 66
MA 136,36,104
T 56,22,0
T 58,22,4
MA 140,36,108
E 67
W 6
MA 144,40,104
G 57,36,66,3,nt
T 60,23,0
MA 148,40,108
T 62,23,4
CV 97,66
E 68
MA 152,44,104
E 69
MA 156,44,108
W 4
MA 160,48,104
s_waitcnt vmcnt(12)
s_barrier
R a,0,8,16
CV 100,68
MA 164,48,108
E 70
s_xor_b32 m0, s65, 0x14000
s_xor_b32 s66, s63, 0x56000
MA 168,52,104
G 32,32,66,0,nt
MA 172,52,108
R a,4,9,16
E 71
W 2
MA 176,56,104
R a,8,10,16
CV 101,70
MA 180,56,108
E 72
MA 184,60,104
G 33,32,66,1,nt
MA 188,60,108
R a,12,11,16
E 73
MD 112,52,104
R a,16,8,20
CV 98,72
MD 116,52,108
E 74
W 3
ZB 80,0,96
G 34,32,66,2,nt
ZB 84,0,100
R a,20,9,20
E 75
MB 80,4,104
R a,24,10,20
CV 99,74
MB 84,4,108
E 76
W 3
MB 80,8,112
G 35,32,66,3,nt
MB 84,8,116
R a,28,11,20
E 77
MB 80,12,120
s_waitcnt vmcnt(12)
s_barrier
T 32,16,32
T 34,16,36
MB 84,12,124
CV 102,76
E 78
s_xor_b32 m0, s65, 0x18000
s_xor_b32 s66, s63, 0x46000
W 4
ZB 88,16,96
G 56,36,66,0,nt
T 36,17,32
ZB 92,16,100
T 38,17,36
E 79
MB 88,20,104
T 40,18,32
MB 92,20,108
T 42,18,36
CV 103,78
W 6
MB 88,24,112
G 57,36,66,1,nt
T 44,19,32
MB 92,24,116
T 46,19,36
E 80
MB 88,28,120
T 48,20,32
T 50,20,36
MB 92,28,124
E 81
W 6
MA 128,32,96
G 56,36,66,2,nt
T 52,21,32
MA 132,32,100
T 54,21,36
CV 104,80
E 82
MA 136,36,96
T 56,22,32
T 58,22,36
MA 140,36,100
E 83
W 6
MA 144,40,96
G 57,36,66,3,nt
T 60,23,32
MA 148,40,100
T 62,23,36
CV 105,82
E 84
MA 152,44,96
E 85
MA 156,44,100
W 4
MA 160,48,96
s_waitcnt vmcnt(12)
s_barrier
R a,0,8,48
CV 108,84
MA 164,48,100
E 86
s_xor_b32 m0, s65, 0x1c000
s_xor_b32 s66, s63, 0x43000
MA 168,52,96
G 32,32,66,0,nt
MA 172,52,100
R a,4,9,48
E 87
W 2
MA 176,56,96
R a,8,10,48
CV 109,86
MA 180,56,100
E 88
MA 184,60,96
G 33,32,66,1,nt
MA 188,60,100
R a,12,11,48
E 89
MD 112,52,96
R a,16,8,52
CV 106,88
MD 116,52,100
E 90
W 3
ZB 64,0,96
G 34,32,66,2,nt
ZB 68,0,100
R a,20,9,52
E 91
MB 64,4,104
R a,24,10,52
CV 107,90
MB 68,4,108
E 92
W 3
MB 64,8,112
G 35,32,66,3,nt
MB 68,8,116
R a,28,11,52
E 93
MB 64,12,120
s_waitcnt vmcnt(12)
s_barrier
T 32,24,0
T 34,24,4
MB 68,12,124
CV 110,92
E 94
s_xor_b32 m0, s65, 0x0
s_xor_b32 s66, s63, 0x56000
W 4
ZB 72,16,96
G 56,36,66,0,nt
T 36,25,0
ZB 76,16,100
T 38,25,4
E 95
MB 72,20,104
T 40,26,0
MB 76,20,108
T 42,26,4
CV 111,94
W 6
MB 72,24,112
G 57,36,66,1,nt
T 44,27,0
MB 76,24,116
T 46,27,4
E 64
MB 72,28,120
T 48,28,0
T 50,28,4
MB 76,28,124
E 65
W 6
MA 128,32,104
G 56,36,66,2,nt
T 52,29,0
MA 132,32,108
T 54,29,4
CV 96,64
E 66
MA 136,36,104
T 56,30,0
T 58,30,4
MA 140,36,108
E 67
W 6
MA 144,40,104
G 57,36,66,3,nt
T 60,31,0
MA 148,40,108
T 62,31,4
CV 97,66
E 68
MA 152,44,104
E 69
MA 156,44,108
W 4
MA 160,48,104
s_waitcnt vmcnt(12)
s_barrier
R a,0,12,16
CV 100,68
MA 164,48,108
E 70
s_xor_b32 m0, s65, 0x4000
s_xor_b32 s66, s63, 0x53000
MA 168,52,104
G 32,32,66,0,nt
MA 172,52,108
R a,4,13,16
E 71
W 2
MA 176,56,104
R a,8,14,16
CV 101,70
MA 180,56,108
E 72
MA 184,60,104
G 33,32,66,1,nt
MA 188,60,108
R a,12,15,16
E 73
MD 112,52,104
R a,16,12,20
CV 98,72
MD 116,52,108
E 74
W 3
ZB 80,0,96
G 34,32,66,2,nt
ZB 84,0,100
R a,20,13,20
E 75
MB 80,4,104
R a,24,14,20
CV 99,74
MB 84,4,108
E 76
W 3
MB 80,8,112
G 35,32,66,3,nt
MB 84,8,116
R a,28,15,20
E 77
MB 80,12,120
s_waitcnt vmcnt(12)
s_barrier
T 32,24,32
T 34,24,36
MB 84,12,124
CV 102,76
E 78
s_xor_b32 m0, s65, 0x8000
s_xor_b32 s66, s63, 0x43000
W 4
ZB 88,16,96
G 56,36,66,0,nt
T 36,25,32
ZB 92,16,100
T 38,25,36
E 79
MB 88,20,104
T 40,26,32
MB 92,20,108
T 42,26,36
CV 103,78
W 6
MB 88,24,112
G 57,36,66,1,nt
T 44,27,32
MB 92,24,116
T 46,27,36
E 80
MB 88,28,120
T 48,28,32
T 50,28,36
MB 92,28,124
E 81
W 6
MA 128,32,96
G 56,36,66,2,nt
T 52,29,32
MA 132,32,100
T 54,29,36
CV 104,80
E 82
MA 136,36,96
T 56,30,32
T 58,30,36
MA 140,36,100
E 83
W 6
MA 144,40,96
G 57,36,66,3,nt
T 60,31,32
MA 148,40,100
T 62,31,36
CV 105,82
E 84
MA 152,44,96
E 85
MA 156,44,100
W 4
MA 160,48,96
s_waitcnt vmcnt(12)
s_barrier
R a,0,12,48
CV 108,84
MA 164,48,100
E 86
s_xor_b32 m0, s65, 0xc000
s_xor_b32 s66, s63, 0x47000
MA 168,52,96
G 32,32,66,0,nt
MA 172,52,100
R a,4,13,48
E 87
W 2
MA 176,56,96
R a,8,14,48
CV 109,86
MA 180,56,100
E 88
MA 184,60,96
G 33,32,66,1,nt
MA 188,60,100
R a,12,15,48
E 89
MD 112,52,96
R a,16,12,52
CV 106,88
MD 116,52,100
E 90
W 3
ZB 64,0,96
G 34,32,66,2,nt
ZB 68,0,100
R a,20,13,52
E 91
MB 64,4,104
R a,24,14,52
CV 107,90
MB 68,4,108
E 92
W 3
MB 64,8,112
G 35,32,66,3,nt
MB 68,8,116
R a,28,15,52
E 93
MB 64,12,120
s_waitcnt vmcnt(12)
s_barrier
T 32,16,0
T 34,16,4
MB 68,12,124
CV 110,92
E 94
s_xor_b32 m0, s65, 0x10000
s_xor_b32 s66, s63, 0x53000
W 4
ZB 72,16,96
G 56,36,66,0,nt
T 36,17,0
ZB 76,16,100
T 38,17,4
E 95
MB 72,20,104
T 40,18,0
MB 76,20,108
T 42,18,4
CV 111,94
W 6
MB 72,24,112
G 57,36,66,1,nt
T 44,19,0
MB 76,24,116
T 46,19,4
E 64
MB 72,28,120
T 48,20,0
T 50,20,4
MB 76,28,124
E 65
W 6
MA 128,32,104
G 56,36,66,2,nt
T 52,21,0
MA 132,32,108
T 54,21,4
CV 96,64
E 66
MA 136,36,104
T 56,22,0
T 58,22,4
MA 140,36,108
E 67
W 6
MA 144,40,104
G 57,36,66,3,nt
T 60,23,0
MA 148,40,108
T 62,23,4
CV 97,66
E 68
MA 152,44,104
E 69
MA 156,44,108
W 4
MA 160,48,104
s_waitcnt vmcnt(12)
s_barrier
R a,0,8,16
CV 100,68
MA 164,48,108
E 70
s_xor_b32 m0, s65, 0x14000
s_xor_b32 s66, s63, 0x57000
MA 168,52,104
G 32,32,66,0,nt
MA 172,52,108
R a,4,9,16
E 71
W 2
MA 176,56,104
R a,8,10,16
CV 101,70
MA 180,56,108
E 72
MA 184,60,104
G 33,32,66,1,nt
MA 188,60,108
R a,12,11,16
E 73
MD 112,52,104
R a,16,8,20
CV 98,72
MD 116,52,108
E 74
W 3
ZB 80,0,96
G 34,32,66,2,nt
ZB 84,0,100
R a,20,9,20
E 75
MB 80,4,104
R a,24,10,20
CV 99,74
MB 84,4,108
E 76
W 3
MB 80,8,112
G 35,32,66,3,nt
MB 84,8,116
R a,28,11,20
E 77
MB 80,12,120
s_waitcnt vmcnt(12)
s_barrier
T 32,16,32
T 34,16,36
MB 84,12,124
CV 102,76
E 78
s_xor_b32 m0, s65, 0x18000
s_xor_b32 s66, s63, 0x47000
W 4
ZB 88,16,96
G 56,36,66,0,nt
T 36,17,32
ZB 92,16,100
T 38,17,36
E 79
MB 88,20,104
T 40,18,32
MB 92,20,108
T 42,18,36
CV 103,78
W 6
MB 88,24,112
G 57,36,66,1,nt
T 44,19,32
MB 92,24,116
T 46,19,36
E 80
MB 88,28,120
T 48,20,32
T 50,20,36
MB 92,28,124
E 81
W 6
MA 128,32,96
G 56,36,66,2,nt
T 52,21,32
MA 132,32,100
T 54,21,36
CV 104,80
E 82
MA 136,36,96
T 56,22,32
T 58,22,36
MA 140,36,100
E 83
W 6
MA 144,40,96
G 57,36,66,3,nt
T 60,23,32
MA 148,40,100
T 62,23,36
CV 105,82
E 84
MA 152,44,96
E 85
MA 156,44,100
W 4
MA 160,48,96
s_waitcnt vmcnt(12)
s_barrier
R a,0,8,48
CV 108,84
MA 164,48,100
E 86
s_xor_b32 m0, s65, 0x1c000
s_xor_b32 s66, s63, 0x57000
MA 168,52,96
G 56,36,66,0,nt
MA 172,52,100
R a,4,9,48
E 87
W 2
MA 176,56,96
R a,8,10,48
CV 109,86
MA 180,56,100
E 88
MA 184,60,96
G 57,36,66,1,nt
MA 188,60,100
R a,12,11,48
E 89
MD 112,52,96
R a,16,8,52
CV 106,88
MD 116,52,100
E 90
W 3
ZB 64,0,96
G 56,36,66,2,nt
ZB 68,0,100
R a,20,9,52
E 91
MB 64,4,104
R a,24,10,52
CV 107,90
MB 68,4,108
E 92
W 3
MB 64,8,112
G 57,36,66,3,nt
MB 68,8,116
R a,28,11,52
E 93
MB 64,12,120
s_waitcnt vmcnt(12)
s_barrier
T 32,24,0
T 34,24,4
MB 68,12,124
CV 110,92
E 94
s_xor_b32 m0, s65, 0x0
s_xor_b32 s66, s62, 0x0
W 4
ZB 72,16,96
G 44,44,66,0
T 36,25,0
ZB 76,16,100
T 38,25,4
E 95
MB 72,20,104
T 40,26,0
MB 76,20,108
T 42,26,4
CV 111,94
W 6
MB 72,24,112
G 45,44,66,1
T 44,27,0
MB 76,24,116
T 46,27,4
E 64
MB 72,28,120
T 48,28,0
T 50,28,4
MB 76,28,124
E 65
W 6
MA 128,32,104
G 46,44,66,2
T 52,29,0
MA 132,32,108
T 54,29,4
CV 96,64
E 66
MA 136,36,104
T 56,30,0
T 58,30,4
MA 140,36,108
E 67
W 6
MA 144,40,104
G 47,44,66,3
T 60,31,0
MA 148,40,108
T 62,31,4
CV 97,66
E 68
MA 152,44,104
E 69
MA 156,44,108
W 4
MA 160,48,104
s_waitcnt vmcnt(12)
s_barrier
R a,0,12,16
CV 100,68
MA 164,48,108
E 70
s_xor_b32 m0, s65, 0x4000
s_xor_b32 s66, s62, 0x8000
MA 168,52,104
G 44,44,66,0
MA 172,52,108
R a,4,13,16
E 71
W 2
MA 176,56,104
R a,8,14,16
CV 101,70
MA 180,56,108
E 72
MA 184,60,104
G 45,44,66,1
MA 188,60,108
R a,12,15,16
E 73
MD 112,52,104
R a,16,12,20
CV 98,72
MD 116,52,108
E 74
W 3
ZB 80,0,96
G 46,44,66,2
ZB 84,0,100
R a,20,13,20
E 75
MB 80,4,104
R a,24,14,20
CV 99,74
MB 84,4,108
E 76
W 3
MB 80,8,112
G 47,44,66,3
R a,28,15,20
MB 84,8,116
v_xor_b32 v8, s68, v8
E 77
MB 80,12,120
s_waitcnt vmcnt(12)
s_barrier
T 32,24,32
T 34,24,36
CV 102,76
MB 84,12,124
v_xor_b32 v9, s68, v9
E 78
s_xor_b32 m0, s65, 0x8000
s_xor_b32 s66, s62, 0x10000
W 4
ZB 88,16,96
G 44,44,66,0
T 36,25,32
ZB 92,16,100
T 38,25,36
v_xor_b32 v10, s68, v10
E 79
MB 88,20,104
T 40,26,32
T 42,26,36
MB 92,20,108
CV 103,78
v_xor_b32 v11, s68, v11
W 6
MB 88,24,112
G 45,44,66,1
T 44,27,32
MB 92,24,116
T 46,27,36
v_xor_b32 v12, s68, v12
E 80
MB 88,28,120
T 48,28,32
T 50,28,36
MB 92,28,124
v_xor_b32 v13, s68, v13
E 81
W 6
MA 128,32,96
G 46,44,66,2
T 52,29,32
T 54,29,36
MA 132,32,100
CV 104,80
v_xor_b32 v14, s68, v14
E 82
MA 136,36,96
T 56,30,32
T 58,30,36
MA 140,36,100
v_xor_b32 v15, s68, v15
E 83
W 6
MA 144,40,96
G 47,44,66,3
T 60,31,32
MA 148,40,100
T 62,31,36
CV 105,82
E 84
MA 152,44,96
E 85
MA 156,44,100
W 4
MA 160,48,96
CV 108,84
MA 164,48,100
E 86
MA 168,52,96
E 87
MA 172,52,100
W 0
MA 176,56,96
CV 109,86
MA 180,56,100
E 88
MA 184,60,96
E 89
MA 188,60,100
MD 112,52,96
CV 106,88
MD 116,52,100
E 90
E 91
s_nop 0
CV 107,90
E 92
E 93
s_waitcnt vmcnt(12)
s_barrier
T 32,24,48
T 34,24,52
CV 110,92
E 94
s_xor_b32 m0, s65, 0xc000
s_xor_b32 s66, s62, 0x18000
T 36,25,48
T 38,25,52
G 44,44,66,0
E 95
T 40,26,48
T 42,26,52
CV 111,94
T 44,27,48
T 46,27,52
G 45,44,66,1
T 48,28,48
T 50,28,52
W 6
MA 128,32,104
G 46,44,66,2
MA 132,32,108
T 52,29,48
T 54,29,52
MA 136,36,104
T 56,30,48
MA 140,36,108
T 58,30,52
W 6
MA 144,40,104
G 47,44,66,3
MA 148,40,108
T 60,31,48
T 62,31,52
MA 152,44,104
MA 156,44,108
W 4
MA 160,48,104
s_waitcnt vmcnt(12)
s_barrier
s_xor_b32 m0, s65, 0x10000
s_xor_b32 s66, s62, 0x20000
MA 164,48,108
G 44,44,66,0
T 0,16,0
T 2,16,4
MA 168,52,104
G 45,44,66,1
MA 172,52,108
T 4,17,0
T 6,17,4
W 4
MA 176,56,104
G 46,44,66,2
MA 180,56,108
T 8,18,0
T 10,18,4
MA 184,60,104
G 47,44,66,3
MA 188,60,108
T 12,19,0
T 14,19,4
MD 112,52,104
s_xor_b32 m0, s65, 0x14000
s_xor_b32 s66, s62, 0x28000
MD 116,52,108
G 44,44,66,0
T 16,20,0
T 18,20,4
s_nop 1
v_mov_b32 v60, v112
s_nop 1
v_mov_b32 v61, v116
v_cmp_nle_f32 vcc, s76, v60
v_cmp_nge_f32 s[82:83], s77, v60
v_cmp_nle_f32 s[84:85], s76, v61
v_cmp_nge_f32 s[90:91], s77, v61
s_nop 1
s_or_b64 vcc, vcc, s[82:83]
s_or_b64 vcc, vcc, s[84:85]
s_or_b64 vcc, vcc, s[90:91]
s_cbranch_scc1 L_slow_c1B1
L_back_c1B1:
v_rcp_f32 v0, v60
v_rcp_f32 v1, v61
s_nop 0
v_pk_mul_f32 v[128:129], v[128:129], v[0:1] op_sel_hi:[1,0]
v_pk_mul_f32 v[130:131], v[130:131], v[0:1] op_sel_hi:[1,0]
v_pk_mul_f32 v[132:133], v[132:133], v[0:1] op_sel:[0,1]
v_pk_mul_f32 v[134:135], v[134:135], v[0:1] op_sel:[0,1]
v_pk_mul_f32 v[136:137], v[136:137], v[0:1] op_sel_hi:[1,0]
v_pk_mul_f32 v[138:139], v[138:139], v[0:1] op_sel_hi:[1,0]
v_pk_mul_f32 v[140:141], v[140:141], v[0:1] op_sel:[0,1]
v_pk_mul_f32 v[142:143], v[142:143], v[0:1] op_sel:[0,1]
CV 128,128
CV 130,130
CV 132,132
CV 134,134
CV 136,136
CV 138,138
CV 140,140
CV 142,142
AW 96,128
AW 97,130
AW 100,132
AW 101,134
AW 98,136
AW 99,138
AW 102,140
AW 103,142
v_pk_mul_f32 v[144:145], v[144:145], v[0:1] op_sel_hi:[1,0]
v_pk_mul_f32 v[146:147], v[146:147], v[0:1] op_sel_hi:[1,0]
v_pk_mul_f32 v[148:149], v[148:149], v[0:1] op_sel:[0,1]
v_pk_mul_f32 v[150:151], v[150:151], v[0:1] op_sel:[0,1]
v_pk_mul_f32 v[152:153], v[152:153], v[0:1] op_sel_hi:[1,0]
v_pk_mul_f32 v[154:155], v[154:155], v[0:1] op_sel_hi:[1,0]
v_pk_mul_f32 v[156:157], v[156:157], v[0:1] op_sel:[0,1]
v_pk_mul_f32 v[158:159], v[158:159], v[0:1] op_sel:[0,1]
CV 144,144
CV 146,146
CV 148,148
CV 150,150
CV 152,152
CV 154,154
CV 156,156
CV 158,158
AW 104,144
AW 105,146
AW 108,148
AW 109,150
AW 106,152
AW 107,154
AW 110,156
AW 111,158
v_pk_mul_f32 v[160:161], v[160:161], v[0:1] op_sel_hi:[1,0]
v_pk_mul_f32 v[162:163], v[162:163], v[0:1] op_sel_hi:[1,0]
v_pk_mul_f32 v[164:165], v[164:165], v[0:1] op_sel:[0,1]
v_pk_mul_f32 v[166:167], v[166:167], v[0:1] op_sel:[0,1]
v_pk_mul_f32 v[168:169], v[168:169], v[0:1] op_sel_hi:[1,0]
v_pk_mul_f32 v[170:171], v[170:171], v[0:1] op_sel_hi:[1,0]
v_pk_mul_f32 v[172:173], v[172:173], v[0:1] op_sel:[0,1]
v_pk_mul_f32 v[174:175], v[174:175], v[0:1] op_sel:[0,1]
CV 160,160
CV 162,162
CV 164,164
CV 166,166
CV 168,168
CV 170,170
CV 172,172
CV 174,174
AW 112,160
AW 113,162
AW 116,164
AW 117,166
AW 114,168
AW 115,170
AW 118,172
AW 119,174
v_pk_mul_f32 v[176:177], v[176:177], v[0:1] op_sel_hi:[1,0]
v_pk_mul_f32 v[178:179], v[178:179], v[0:1] op_sel_hi:[1,0]
v_pk_mul_f32 v[180:181], v[180:181], v[0:1] op_sel:[0,1]
v_pk_mul_f32 v[182:183], v[182:183], v[0:1] op_sel:[0,1]
v_pk_mul_f32 v[184:185], v[184:185], v[0:1] op_sel_hi:[1,0]
v_pk_mul_f32 v[186:187], v[186:187], v[0:1] op_sel_hi:[1,0]
v_pk_mul_f32 v[188:189], v[188:189], v[0:1] op_sel:[0,1]
v_pk_mul_f32 v[190:191], v[190:191], v[0:1] op_sel:[0,1]
CV 176,176
CV 178,178
CV 180,180
CV 182,182
CV 184,184
CV 186,186
CV 188,188
CV 190,190
AW 120,176
AW 121,178
AW 124,180
AW 125,182
AW 122,184
AW 123,186
AW 126,188
AW 127,190
W 6
ZB 128,0,64
G 45,44,66,1
ZB 132,0,68
T 20,21,0
T 22,21,4
ds_write_b128 v58, a[64:67] offset:0
ZB 136,4,64
G 46,44,66,2
ZB 140,4,68
T 24,22,0
T 26,22,4
ds_write_b128 v58, a[68:71] offset:1024
W 8
ZB 144,8,64
G 47,44,66,3
ZB 148,8,68
T 28,23,0
T 30,23,4
ds_write_b128 v58, a[72:75] offset:2048
ZB 152,12,64
s_waitcnt vmcnt(16) lgkmcnt(0)
s_barrier
T 32,16,16
ZB 156,12,68
T 34,16,20
ds_write_b128 v58, a[76:79] offset:3072
s_xor_b32 m0, s65, 0x18000
s_xor_b32 s66, s62, 0x30000
ZB 160,16,64
G 44,44,66,0
ZB 164,16,68
T 36,17,16
T 38,17,20
ds_write_b128 v58, a[80:83] offset:4096
ZB 168,20,64
T 40,18,16
ZB 172,20,68
T 42,18,20
ds_write_b128 v58, a[84:87] offset:5120
ZB 176,24,64
G 45,44,66,1
ZB 180,24,68
T 44,19,16
T 46,19,20
ds_write_b128 v58, a[88:91] offset:6144
ZB 184,28,64
T 48,20,16
ZB 188,28,68
T 50,20,20
ds_write_b128 v58, a[92:95] offset:7168
W 10
MB 128,32,72
G 46,44,66,2
MB 132,32,76
T 52,21,16
T 54,21,20
MB 136,36,72
T 56,22,16
MB 140,36,76
T 58,22,20
W 8
MB 144,40,72
G 47,44,66,3
MB 148,40,76
T 60,23,16
T 62,23,20
MB 152,44,72
s_waitcnt vmcnt(16) lgkmcnt(6)
s_barrier
T 0,16,32
MB 156,44,76
T 2,16,36
R a,128,2,0
s_xor_b32 m0, s65, 0x1c000
s_xor_b32 s66, s62, 0x38000
MB 160,48,72
G 44,44,66,0
MB 164,48,76
T 4,17,32
T 6,17,36
R a,132,2,1
W 10
MB 168,52,72
T 8,18,32
MB 172,52,76
T 10,18,36
R a,136,2,2
W 9
MB 176,56,72
G 45,44,66,1
MB 180,56,76
T 12,19,32
T 14,19,36
R a,140,2,3
MB 184,60,72
T 16,20,32
MB 188,60,76
T 18,20,36
R a,144,2,4
W 10
MB 128,0,80
G 46,44,66,2
MB 132,0,84
T 20,21,32
T 22,21,36
R a,148,2,5
MB 136,4,80
T 24,22,32
MB 140,4,84
T 26,22,36
W 14
R a,152,2,6
W 10
MB 144,8,80
G 47,44,66,3
MB 148,8,84
T 28,23,32
T 30,23,36
R a,156,2,7
MB 152,12,80
s_waitcnt vmcnt(16)
s_barrier
T 32,16,48
MB 156,12,84
T 34,16,52
s_xor_b32 m0, s65, 0x0
s_xor_b32 s66, s62, 0x100
W 9
MB 160,16,80
G 44,44,66,0
MB 164,16,84
T 36,17,48
T 38,17,52
s_getpc_b64 s[88:89]
L_ct1_1106:
s_and_b32 s89, s89, 0xffff
s_mov_b32 s90, L_code_end-L_ct1_1106
s_mov_b32 s91, 0x20000
v_and_b32 v62, 0x70, v59
v_lshlrev_b32 v62, 3, v62
s_add_u32 s7, s1, 4096
buffer_load_dword v3, v62, s[88:91], s7 offen
MB 168,20,80
T 40,18,48
MB 172,20,84
T 42,18,52
W 7
MB 176,24,80
G 45,44,66,1
MB 180,24,84
T 44,19,48
T 46,19,52
MB 184,28,80
T 48,20,48
MB 188,28,84
T 50,20,52
W 6
MB 128,32,88
G 46,44,66,2
MB 132,32,92
T 52,21,48
T 54,21,52
MB 136,36,88
T 56,22,48
MB 140,36,92
T 58,22,52
W 6
MB 144,40,88
G 47,44,66,3
MB 148,40,92
T 60,23,48
T 62,23,52
MB 152,44,88
s_waitcnt vmcnt(17)
s_barrier
T 0,24,0
MB 156,44,92
T 2,24,4
s_xor_b32 m0, s65, 0x4000
s_xor_b32 s66, s62, 0x8100
W 6
MB 160,48,88
G 44,44,66,0
MB 164,48,92
T 4,25,0
T 6,25,4
MB 168,52,88
T 8,26,0
MB 172,52,92
T 10,26,4
W 6
MB 176,56,88
G 45,44,66,1
MB 180,56,92
T 12,27,0
T 14,27,4
MB 184,60,88
T 16,28,0
MB 188,60,92
T 18,28,4
W 6
MB 128,0,128
G 46,44,66,2
MB 132,0,132
T 20,29,0
T 22,29,4
MB 136,4,128
T 24,30,0
MB 140,4,132
T 26,30,4
W 6
MB 144,8,128
G 47,44,66,3
MB 148,8,132
T 28,31,0
T 30,31,4
MB 152,12,128
s_waitcnt vmcnt(17)
s_barrier
T 32,24,16
MB 156,12,132
T 34,24,20
s_xor_b32 m0, s65, 0x8000
s_xor_b32 s66, s62, 0x10100
W 6
MB 160,16,128
G 44,44,66,0
MB 164,16,132
T 36,25,16
T 38,25,20
MB 168,20,128
T 40,26,16
MB 172,20,132
T 42,26,20
W 6
MB 176,24,128
G 45,44,66,1
MB 180,24,132
T 44,27,16
T 46,27,20
MB 184,28,128
T 48,28,16
MB 188,28,132
T 50,28,20
W 6
MB 128,32,136
G 46,44,66,2
MB 132,32,140
T 52,29,16
T 54,29,20
MB 136,36,136
T 56,30,16
MB 140,36,140
T 58,30,20
W 6
MB 144,40,136
G 47,44,66,3
MB 148,40,140
T 60,31,16
T 62,31,20
MB 152,44,136
s_waitcnt vmcnt(17)
s_barrier
T 0,24,32
MB 156,44,140
T 2,24,36
s_xor_b32 m0, s65, 0xc000
s_xor_b32 s66, s62, 0x18100
W 6
MB 160,48,136
G 44,44,66,0
MB 164,48,140
T 4,25,32
T 6,25,36
MB 168,52,136
T 8,26,32
MB 172,52,140
T 10,26,36
W 6
MB 176,56,136
G 45,44,66,1
MB 180,56,140
T 12,27,32
T 14,27,36
MB 184,60,136
T 16,28,32
MB 188,60,140
T 18,28,36
W 6
MB 128,0,144
G 46,44,66,2
MB 132,0,148
T 20,29,32
T 22,29,36
MB 136,4,144
T 24,30,32
MB 140,4,148
T 26,30,36
W 6
MB 144,8,144
G 47,44,66,3
MB 148,8,148
T 28,31,32
T 30,31,36
MB 152,12,144
s_waitcnt vmcnt(17)
s_barrier
T 32,24,48
MB 156,12,148
T 34,24,52
s_xor_b32 m0, s65, 0x10000
s_xor_b32 s66, s62, 0x20100
W 6
MB 160,16,144
G 44,44,66,0
MB 164,16,148
T 36,25,48
T 38,25,52
MB 168,20,144
T 40,26,48
MB 172,20,148
T 42,26,52
W 6
MB 176,24,144
G 45,44,66,1
MB 180,24,148
T 44,27,48
T 46,27,52
MB 184,28,144
T 48,28,48
MB 188,28,148
T 50,28,52
W 6
MB 128,32,152
G 46,44,66,2
MB 132,32,156
T 52,29,48
T 54,29,52
MB 136,36,152
T 56,30,48
MB 140,36,156
T 58,30,52
W 6
MB 144,40,152
G 47,44,66,3
MB 148,40,156
T 60,31,48
T 62,31,52
MB 152,44,152
s_waitcnt vmcnt(16)
s_barrier
T 0,16,0
MB 156,44,156
T 2,16,4
s_xor_b32 m0, s65, 0x14000
s_xor_b32 s66, s62, 0x28100
W 6
MB 160,48,152
G 44,44,66,0
MB 164,48,156
T 4,17,0
T 6,17,4
MB 168,52,152
T 8,18,0
MB 172,52,156
T 10,18,4
W 6
MB 176,56,152
G 45,44,66,1
MB 180,56,156
T 12,19,0
T 14,19,4
MB 184,60,152
T 16,20,0
MB 188,60,156
T 18,20,4
W 6
ZB 192,0,64
G 46,44,66,2
ZB 196,0,68
T 20,21,0
T 22,21,4
ZB 200,4,64
T 24,22,0
ZB 204,4,68
T 26,22,4
W 6
ZB 208,8,64
G 47,44,66,3
ZB 212,8,68
T 28,23,0
T 30,23,4
ZB 216,12,64
s_waitcnt vmcnt(16)
s_barrier
T 32,16,16
ZB 220,12,68
T 34,16,20
s_xor_b32 m0, s65, 0x18000
s_xor_b32 s66, s62, 0x30100
W 6
ZB 224,16,64
G 44,44,66,0
ZB 228,16,68
T 36,17,16
T 38,17,20
ZB 232,20,64
T 40,18,16
ZB 236,20,68
T 42,18,20
W 6
ZB 240,24,64
G 45,44,66,1
ZB 244,24,68
T 44,19,16
T 46,19,20
ZB 248,28,64
T 48,20,16
ZB 252,28,68
T 50,20,20
W 6
MB 192,32,72
G 46,44,66,2
MB 196,32,76
T 52,21,16
T 54,21,20
MB 200,36,72
T 56,22,16
MB 204,36,76
T 58,22,20
W 6
MB 208,40,72
G 47,44,66,3
MB 212,40,76
T 60,23,16
T 62,23,20
MB 216,44,72
s_waitcnt vmcnt(16)
s_barrier
T 0,16,32
MB 220,44,76
T 2,16,36
s_xor_b32 m0, s65, 0x1c000
s_xor_b32 s66, s62, 0x38100
W 6
MB 224,48,72
G 44,44,66,0
MB 228,48,76
T 4,17,32
T 6,17,36
MB 232,52,72
T 8,18,32
MB 236,52,76
T 10,18,36
W 6
MB 240,56,72
G 45,44,66,1
MB 244,56,76
T 12,19,32
T 14,19,36
MB 248,60,72
T 16,20,32
MB 252,60,76
T 18,20,36
W 6
MB 192,0,80
G 46,44,66,2
MB 196,0,84
T 20,21,32
T 22,21,36
MB 200,4,80
T 24,22,32
MB 204,4,84
T 26,22,36
W 6
MB 208,8,80
G 47,44,66,3
MB 212,8,84
T 28,23,32
T 30,23,36
MB 216,12,80
s_waitcnt vmcnt(16)
s_barrier
T 32,16,48
MB 220,12,84
T 34,16,52
s_xor_b32 m0, s65, 0x0
s_xor_b32 s66, s62, 0x40000
W 6
MB 224,16,80
G 44,44,66,0
MB 228,16,84
T 36,17,48
T 38,17,52
MB 232,20,80
T 40,18,48
MB 236,20,84
T 42,18,52
W 6
MB 240,24,80
G 45,44,66,1
MB 244,24,84
T 44,19,48
T 46,19,52
MB 248,28,80
T 48,20,48
MB 252,28,84
T 50,20,52
W 6
MB 192,32,88
G 46,44,66,2
MB 196,32,92
T 52,21,48
T 54,21,52
MB 200,36,88
T 56,22,48
MB 204,36,92
T 58,22,52
W 6
MB 208,40,88
G 47,44,66,3
MB 212,40,92
T 60,23,48
T 62,23,52
MB 216,44,88
s_waitcnt vmcnt(16)
s_barrier
T 0,24,0
MB 220,44,92
T 2,24,4
s_xor_b32 m0, s65, 0x4000
s_xor_b32 s66, s62, 0x48000
W 6
MB 224,48,88
G 44,44,66,0
MB 228,48,92
T 4,25,0
T 6,25,4
MB 232,52,88
T 8,26,0
MB 236,52,92
T 10,26,4
W 6
MB 240,56,88
G 45,44,66,1
MB 244,56,92
T 12,27,0
T 14,27,4
MB 248,60,88
T 16,28,0
MB 252,60,92
T 18,28,4
W 6
MB 192,0,128
G 46,44,66,2
MB 196,0,132
T 20,29,0
T 22,29,4
MB 200,4,128
T 24,30,0
MB 204,4,132
T 26,30,4
W 6
MB 208,8,128
G 47,44,66,3
MB 212,8,132
T 28,31,0
T 30,31,4
MB 216,12,128
s_waitcnt vmcnt(16)
s_barrier
T 32,24,16
MB 220,12,132
T 34,24,20
s_xor_b32 m0, s65, 0x8000
s_xor_b32 s66, s62, 0x50000
W 6
MB 224,16,128
G 44,44,66,0
MB 228,16,132
T 36,25,16
T 38,25,20
MB 232,20,128
T 40,26,16
MB 236,20,132
T 42,26,20
W 6
MB 240,24,128
G 45,44,66,1
MB 244,24,132
T 44,27,16
T 46,27,20
MB 248,28,128
T 48,28,16
MB 252,28,132
T 50,28,20
W 6
MB 192,32,136
G 46,44,66,2
MB 196,32,140
T 52,29,16
T 54,29,20
MB 200,36,136
T 56,30,16
MB 204,36,140
T 58,30,20
W 6
MB 208,40,136
G 47,44,66,3
MB 212,40,140
T 60,31,16
T 62,31,20
MB 216,44,136
s_waitcnt vmcnt(16)
s_barrier
T 0,24,32
MB 220,44,140
T 2,24,36
s_xor_b32 m0, s65, 0xc000
s_xor_b32 s66, s62, 0x58000
W 6
MB 224,48,136
G 44,44,66,0
MB 228,48,140
T 4,25,32
T 6,25,36
MB 232,52,136
T 8,26,32
MB 236,52,140
T 10,26,36
W 6
MB 240,56,136
G 45,44,66,1
MB 244,56,140
T 12,27,32
T 14,27,36
MB 248,60,136
T 16,28,32
MB 252,60,140
T 18,28,36
W 6
MB 192,0,144
G 46,44,66,2
MB 196,0,148
T 20,29,32
T 22,29,36
MB 200,4,144
T 24,30,32
MB 204,4,148
T 26,30,36
W 6
MB 208,8,144
G 47,44,66,3
MB 212,8,148
T 28,31,32
T 30,31,36
MB 216,12,144
s_waitcnt vmcnt(16)
s_barrier
T 32,24,48
MB 220,12,148
T 34,24,52
s_xor_b32 m0, s65, 0x10000
s_xor_b32 s66, s62, 0x60000
W 6
MB 224,16,144
G 44,44,66,0
MB 228,16,148
T 36,25,48
T 38,25,52
MB 232,20,144
T 40,26,48
MB 236,20,148
T 42,26,52
W 6
MB 240,24,144
G 45,44,66,1
MB 244,24,148
T 44,27,48
T 46,27,52
MB 248,28,144
T 48,28,48
MB 252,28,148
T 50,28,52
W 6
MB 192,32,152
G 46,44,66,2
MB 196,32,156
T 52,29,48
T 54,29,52
MB 200,36,152
T 56,30,48
MB 204,36,156
T 58,30,52
W 6
MB 208,40,152
G 47,44,66,3
MB 212,40,156
T 60,31,48
T 62,31,52
MB 216,44,152
s_waitcnt vmcnt(16)
s_barrier
T 0,16,0
MB 220,44,156
T 2,16,4
s_xor_b32 m0, s65, 0x14000
s_xor_b32 s66, s62, 0x68000
W 6
MB 224,48,152
G 44,44,66,0
MB 228,48,156
T 4,17,0
T 6,17,4
MB 232,52,152
T 8,18,0
MB 236,52,156
T 10,18,4
W 6
MB 240,56,152
G 45,44,66,1
MB 244,56,156
T 12,19,0
T 14,19,4
MB 248,60,152
T 16,20,0
MB 252,60,156
T 18,20,4
W 6
MB 128,0,96
G 46,44,66,2
MB 132,0,100
T 20,21,0
T 22,21,4
ds_write_b128 v58, a[96:99] offset:0
MB 136,4,96
T 24,22,0
MB 140,4,100
T 26,22,4
ds_write_b128 v58, a[100:103] offset:1024
W 8
MB 144,8,96
G 47,44,66,3
MB 148,8,100
T 28,23,0
T 30,23,4
ds_write_b128 v58, a[104:107] offset:2048
MB 152,12,96
s_waitcnt vmcnt(16) lgkmcnt(0)
s_barrier
T 32,16,16
MB 156,12,100
T 34,16,20
ds_write_b128 v58, a[108:111] offset:3072
s_xor_b32 m0, s65, 0x18000
s_xor_b32 s66, s62, 0x70000
MB 160,16,96
G 44,44,66,0
MB 164,16,100
T 36,17,16
T 38,17,20
ds_write_b128 v58, a[112:115] offset:4096
MB 168,20,96
T 40,18,16
MB 172,20,100
T 42,18,20
ds_write_b128 v58, a[116:119] offset:5120
MB 176,24,96
G 45,44,66,1
MB 180,24,100
T 44,19,16
T 46,19,20
ds_write_b128 v58, a[120:123] offset:6144
MB 184,28,96
T 48,20,16
MB 188,28,100
T 50,20,20
ds_write_b128 v58, a[124:127] offset:7168
W 10
MB 128,32,104
G 46,44,66,2
MB 132,32,108
T 52,21,16
T 54,21,20
MB 136,36,104
T 56,22,16
MB 140,36,108
T 58,22,20
W 8
MB 144,40,104
G 47,44,66,3
MB 148,40,108
T 60,23,16
T 62,23,20
MB 152,44,104
s_waitcnt vmcnt(16) lgkmcnt(6)
s_barrier
T 0,16,32
MB 156,44,108
T 2,16,36
R a,160,2,0
s_xor_b32 m0, s65, 0x1c000
s_xor_b32 s66, s62, 0x78000
MB 160,48,104
G 44,44,66,0
MB 164,48,108
T 4,17,32
T 6,17,36
R a,164,2,1
W 10
MB 168,52,104
T 8,18,32
MB 172,52,108
T 10,18,36
R a,168,2,2
W 9
MB 176,56,104
G 45,44,66,1
MB 180,56,108
T 12,19,32
T 14,19,36
R a,172,2,3
MB 184,60,104
T 16,20,32
MB 188,60,108
T 18,20,36
R a,176,2,4
W 10
MB 128,0,112
G 46,44,66,2
MB 132,0,116
T 20,21,32
T 22,21,36
R a,180,2,5
MB 136,4,112
T 24,22,32
MB 140,4,116
T 26,22,36
W 14
R a,184,2,6
W 10
MB 144,8,112
G 47,44,66,3
MB 148,8,116
T 28,23,32
T 30,23,36
R a,188,2,7
MB 152,12,112
s_waitcnt vmcnt(16)
s_barrier
T 32,16,48
MB 156,12,116
T 34,16,52
s_xor_b32 m0, s65, 0x0
s_xor_b32 s66, s62, 0x40100
W 9
MB 160,16,112
G 44,44,66,0
MB 164,16,116
T 36,17,48
T 38,17,52
s_getpc_b64 s[88:89]
L_ct1_1234:
s_and_b32 s89, s89, 0xffff
s_mov_b32 s90, L_code_end-L_ct1_1234
s_mov_b32 s91, 0x20000
v_and_b32 v62, 0x70, v59
v_lshlrev_b32 v62, 3, v62
s_add_u32 s7, s1, 4096
buffer_load_dword v3, v62, s[88:91], s7 offen
MB 168,20,112
T 40,18,48
MB 172,20,116
T 42,18,52
W 7
MB 176,24,112
G 45,44,66,1
MB 180,24,116
T 44,19,48
T 46,19,52
MB 184,28,112
T 48,20,48
MB 188,28,116
T 50,20,52
W 6
MB 128,32,120
G 46,44,66,2
MB 132,32,124
T 52,21,48
T 54,21,52
MB 136,36,120
T 56,22,48
MB 140,36,124
T 58,22,52
W 6
MB 144,40,120
G 47,44,66,3
MB 148,40,124
T 60,23,48
T 62,23,52
MB 152,44,120
s_waitcnt vmcnt(17)
s_barrier
T 0,24,0
MB 156,44,124
T 2,24,4
s_xor_b32 m0, s65, 0x4000
s_xor_b32 s66, s62, 0x48100
W 6
MB 160,48,120
G 44,44,66,0
MB 164,48,124
T 4,25,0
T 6,25,4
MB 168,52,120
T 8,26,0
MB 172,52,124
T 10,26,4
W 6
MB 176,56,120
G 45,44,66,1
MB 180,56,124
T 12,27,0
T 14,27,4
MB 184,60,120
T 16,28,0
MB 188,60,124
T 18,28,4
W 6
MB 128,0,160
G 46,44,66,2
MB 132,0,164
T 20,29,0
T 22,29,4
MB 136,4,160
T 24,30,0
MB 140,4,164
T 26,30,4
W 6
MB 144,8,160
G 47,44,66,3
MB 148,8,164
T 28,31,0
T 30,31,4
MB 152,12,160
s_waitcnt vmcnt(17)
s_barrier
T 32,24,16
MB 156,12,164
T 34,24,20
s_xor_b32 m0, s65, 0x8000
s_xor_b32 s66, s62, 0x50100
W 6
MB 160,16,160
G 44,44,66,0
MB 164,16,164
T 36,25,16
T 38,25,20
MB 168,20,160
T 40,26,16
MB 172,20,164
T 42,26,20
W 6
MB 176,24,160
G 45,44,66,1
MB 180,24,164
T 44,27,16
T 46,27,20
MB 184,28,160
T 48,28,16
MB 188,28,164
T 50,28,20
W 6
MB 128,32,168
G 46,44,66,2
MB 132,32,172
T 52,29,16
T 54,29,20
MB 136,36,168
T 56,30,16
MB 140,36,172
T 58,30,20
W 6
MB 144,40,168
G 47,44,66,3
MB 148,40,172
T 60,31,16
T 62,31,20
MB 152,44,168
s_waitcnt vmcnt(17)
s_barrier
T 0,24,32
MB 156,44,172
T 2,24,36
s_xor_b32 m0, s65, 0xc000
s_xor_b32 s66, s62, 0x58100
W 6
MB 160,48,168
G 44,44,66,0
MB 164,48,172
T 4,25,32
T 6,25,36
MB 168,52,168
T 8,26,32
MB 172,52,172
T 10,26,36
W 6
MB 176,56,168
G 45,44,66,1
MB 180,56,172
T 12,27,32
T 14,27,36
MB 184,60,168
T 16,28,32
MB 188,60,172
T 18,28,36
W 6
MB 128,0,176
G 46,44,66,2
MB 132,0,180
T 20,29,32
T 22,29,36
MB 136,4,176
T 24,30,32
MB 140,4,180
T 26,30,36
W 6
MB 144,8,176
G 47,44,66,3
MB 148,8,180
T 28,31,32
T 30,31,36
MB 152,12,176
s_waitcnt vmcnt(17)
s_barrier
T 32,24,48
MB 156,12,180
T 34,24,52
s_xor_b32 m0, s65, 0x10000
s_xor_b32 s66, s62, 0x60100
W 6
MB 160,16,176
G 44,44,66,0
MB 164,16,180
T 36,25,48
T 38,25,52
MB 168,20,176
T 40,26,48
MB 172,20,180
T 42,26,52
W 6
MB 176,24,176
G 45,44,66,1
MB 180,24,180
T 44,27,48
T 46,27,52
MB 184,28,176
T 48,28,48
MB 188,28,180
T 50,28,52
W 6
MB 128,32,184
G 46,44,66,2
MB 132,32,188
T 52,29,48
T 54,29,52
MB 136,36,184
T 56,30,48
MB 140,36,188
T 58,30,52
W 6
MB 144,40,184
G 47,44,66,3
MB 148,40,188
T 60,31,48
T 62,31,52
MB 152,44,184
s_waitcnt vmcnt(16)
s_barrier
T 0,16,0
MB 156,44,188
T 2,16,4
s_xor_b32 m0, s65, 0x14000
s_xor_b32 s66, s62, 0x68100
W 6
MB 160,48,184
G 44,44,66,0
MB 164,48,188
T 4,17,0
T 6,17,4
MB 168,52,184
T 8,18,0
MB 172,52,188
T 10,18,4
W 6
MB 176,56,184
G 45,44,66,1
MB 180,56,188
T 12,19,0
T 14,19,4
MB 184,60,184
T 16,20,0
MB 188,60,188
T 18,20,4
W 6
MB 192,0,96
G 46,44,66,2
MB 196,0,100
T 20,21,0
T 22,21,4
MB 200,4,96
T 24,22,0
MB 204,4,100
T 26,22,4
W 6
MB 208,8,96
G 47,44,66,3
MB 212,8,100
T 28,23,0
T 30,23,4
MB 216,12,96
s_waitcnt vmcnt(16)
s_barrier
T 32,16,16
T 34,16,20
MB 220,12,100
CV 68,132
CV 69,134
s_xor_b32 m0, s65, 0x18000
s_xor_b32 s66, s62, 0x70100
W 6
MB 224,16,96
G 44,44,66,0
T 36,17,16
MB 228,16,100
T 38,17,20
CV 70,140
CV 71,142
MB 232,20,96
T 40,18,16
T 42,18,20
MB 236,20,100
AW 132,68
AW 133,69
W 6
MB 240,24,96
G 45,44,66,1
T 44,19,16
MB 244,24,100
T 46,19,20
AW 134,70
AW 135,71
MB 248,28,96
T 48,20,16
T 50,20,20
MB 252,28,100
CV 72,144
CV 73,146
W 6
MB 192,32,104
G 46,44,66,2
T 52,21,16
MB 196,32,108
T 54,21,20
CV 74,152
CV 75,154
MB 200,36,104
T 56,22,16
T 58,22,20
MB 204,36,108
AW 136,72
AW 137,73
W 6
MB 208,40,104
G 47,44,66,3
T 60,23,16
MB 212,40,108
T 62,23,20
AW 138,74
AW 139,75
MB 216,44,104
s_waitcnt vmcnt(16)
s_barrier
T 0,16,32
T 2,16,36
MB 220,44,108
CV 76,148
CV 77,150
s_xor_b32 m0, s65, 0x1c000
s_xor_b32 s66, s62, 0x78100
W 6
MB 224,48,104
G 44,44,66,0
T 4,17,32
MB 228,48,108
T 6,17,36
CV 78,156
CV 79,158
MB 232,52,104
T 8,18,32
T 10,18,36
MB 236,52,108
AW 140,76
AW 141,77
W 6
MB 240,56,104
G 45,44,66,1
T 12,19,32
MB 244,56,108
T 14,19,36
AW 142,78
AW 143,79
MB 248,60,104
T 16,20,32
T 18,20,36
MB 252,60,108
CV 80,160
CV 81,162
W 6
MB 192,0,112
G 46,44,66,2
T 20,21,32
MB 196,0,116
T 22,21,36
CV 82,168
CV 83,170
MB 200,4,112
T 24,22,32
T 26,22,36
MB 204,4,116
AW 144,80
AW 145,81
W 6
MB 208,8,112
G 47,44,66,3
T 28,23,32
MB 212,8,116
T 30,23,36
AW 146,82
AW 147,83
MB 216,12,112
s_waitcnt vmcnt(16)
s_barrier
T 32,16,48
T 34,16,52
MB 220,12,116
CV 84,164
CV 85,166
s_xor_b32 m0, s65, 0x0
s_xor_b32 s66, s64, 0x0
W 6
MB 224,16,112
G 48,48,66,0,nt
T 36,17,48
MB 228,16,116
T 38,17,52
CV 86,172
CV 87,174
MB 232,20,112
T 40,18,48
T 42,18,52
MB 236,20,116
AW 148,84
AW 149,85
W 6
MB 240,24,112
G 49,48,66,1,nt
T 44,19,48
MB 244,24,116
T 46,19,52
AW 150,86
AW 151,87
MB 248,28,112
T 48,20,48
T 50,20,52
MB 252,28,116
CV 88,176
CV 89,178
W 6
MB 192,32,120
G 50,48,66,2,nt
T 52,21,48
MB 196,32,124
T 54,21,52
CV 90,184
CV 91,186
MB 200,36,120
T 56,22,48
T 58,22,52
MB 204,36,124
AW 152,88
AW 153,89
W 6
MB 208,40,120
G 51,48,66,3,nt
T 60,23,48
MB 212,40,124
T 62,23,52
AW 154,90
AW 155,91
MB 216,44,120
s_waitcnt vmcnt(16)
s_barrier
T 0,24,0
T 2,24,4
MB 220,44,124
CV 92,180
CV 93,182
s_xor_b32 m0, s65, 0x4000
s_xor_b32 s66, s64, 0x10000
W 6
MB 224,48,120
G 48,48,66,0,nt
T 4,25,0
MB 228,48,124
T 6,25,4
CV 94,188
CV 95,190
MB 232,52,120
T 8,26,0
T 10,26,4
MB 236,52,124
AW 156,92
AW 157,93
W 6
MB 240,56,120
G 49,48,66,1,nt
T 12,27,0
MB 244,56,124
T 14,27,4
AW 158,94
AW 159,95
MB 248,60,120
T 16,28,0
MB 252,60,124
T 18,28,4
CV 36,128
W 6
MB 192,0,160
G 50,48,66,2,nt
MB 196,0,164
T 20,29,0
T 22,29,4
CV 37,130
MB 200,4,160
T 24,30,0
MB 204,4,164
T 26,30,4
CV 38,136
W 6
MB 208,8,160
G 51,48,66,3,nt
MB 212,8,164
T 28,31,0
T 30,31,4
CV 39,138
MB 216,12,160
s_waitcnt vmcnt(16)
s_barrier
T 32,24,16
MB 220,12,164
T 34,24,20
s_xor_b32 m0, s65, 0x8000
s_xor_b32 s66, s64, 0x2000
W 6
MB 224,16,160
G 48,48,66,0,nt
MB 228,16,164
T 36,25,16
T 38,25,20
MB 232,20,160
T 40,26,16
MB 236,20,164
T 42,26,20
W 6
MB 240,24,160
G 49,48,66,1,nt
MB 244,24,164
T 44,27,16
T 46,27,20
MB 248,28,160
T 48,28,16
MB 252,28,164
T 50,28,20
W 6
MB 192,32,168
G 50,48,66,2,nt
MB 196,32,172
T 52,29,16
T 54,29,20
MB 200,36,168
T 56,30,16
MB 204,36,172
T 58,30,20
W 6
MB 208,40,168
G 51,48,66,3,nt
MB 212,40,172
T 60,31,16
T 62,31,20
MB 216,44,168
s_waitcnt vmcnt(16)
s_barrier
MB 220,44,172
T 0,24,32
T 2,24,36
W 6
MB 224,48,168
T 4,25,32
MB 228,48,172
T 6,25,36
MB 232,52,168
T 8,26,32
MB 236,52,172
T 10,26,36
W 6
MB 240,56,168
T 12,27,32
MB 244,56,172
T 14,27,36
MB 248,60,168
T 16,28,32
MB 252,60,172
T 18,28,36
W 6
MB 192,0,176
T 20,29,32
MB 196,0,180
T 22,29,36
MB 200,4,176
T 24,30,32
MB 204,4,180
T 26,30,36
W 6
MB 208,8,176
T 28,31,32
MB 212,8,180
T 30,31,36
MB 216,12,176
s_waitcnt vmcnt(12)
s_barrier
MB 220,12,180
T 32,24,48
T 34,24,52
W 6
MB 224,16,176
T 36,25,48
MB 228,16,180
T 38,25,52
MB 232,20,176
T 40,26,48
MB 236,20,180
T 42,26,52
W 6
MB 240,24,176
T 44,27,48
MB 244,24,180
T 46,27,52
MB 248,28,176
T 48,28,48
MB 252,28,180
T 50,28,52
W 6
MB 192,32,184
T 52,29,48
MB 196,32,188
T 54,29,52
MB 200,36,184
T 56,30,48
MB 204,36,188
T 58,30,52
W 6
MB 208,40,184
T 60,31,48
T 62,31,52
MB 212,40,188
v_xor_b32 v16, s71, v16
v_xor_b32 v17, s71, v17
v_xor_b32 v18, s71, v18
MB 216,44,184
s_waitcnt vmcnt(8)
s_barrier
R a,0,8,0
v_xor_b32 v19, s71, v19
MB 220,44,188
v_xor_b32 v20, s71, v20
v_xor_b32 v21, s71, v21
s_xor_b32 m0, s65, 0xc000
s_xor_b32 s66, s64, 0x12000
W 5
MB 224,48,184
G 48,48,66,0,nt
MB 228,48,188
R a,4,9,0
v_xor_b32 v22, s71, v22
v_xor_b32 v23, s71, v23
MB 232,52,184
R a,8,10,0
v_xor_b32 v24, s71, v24
MB 236,52,188
v_xor_b32 v25, s71, v25
v_xor_b32 v26, s71, v26
W 3
MB 240,56,184
G 49,48,66,1,nt
R a,12,11,0
MB 244,56,188
v_xor_b32 v27, s71, v27
v_xor_b32 v28, s71, v28
v_xor_b32 v29, s71, v29
MB 248,60,184
R a,16,8,4
MB 252,60,188
v_xor_b32 v30, s71, v30
v_xor_b32 v31, s71, v31
CV 100,196
CV 101,198
CV 102,204
CV 103,206
AW 68,100
AW 69,101
AW 70,102
AW 71,103
CV 104,208
CV 105,210
CV 106,216
CV 107,218
AW 72,104
AW 73,105
AW 74,106
AW 75,107
CV 108,212
CV 109,214
CV 110,220
CV 111,222
AW 76,108
AW 77,109
AW 78,110
AW 79,111
CV 112,224
CV 113,226
CV 114,232
CV 115,234
AW 80,112
AW 81,113
AW 82,114
AW 83,115
CV 116,228
CV 117,230
CV 118,236
CV 119,238
AW 84,116
AW 85,117
AW 86,118
AW 87,119
CV 120,240
CV 121,242
CV 122,248
CV 123,250
AW 88,120
AW 89,121
AW 90,122
AW 91,123
CV 124,244
CV 125,246
CV 126,252
CV 127,254
AW 92,124
AW 93,125
AW 94,126
AW 95,127
CV 40,192
CV 41,194
CV 42,200
CV 43,202
W 3
ZB 64,0,192
G 50,48,66,2,nt
ZB 68,0,196
R a,20,9,4
MB 64,4,200
R a,24,10,4
MB 68,4,204
W 3
MB 64,8,208
G 51,48,66,3,nt
MB 68,8,212
R a,28,11,4
MB 64,12,216
MB 68,12,220
W 2
ZB 72,16,192
ZB 76,16,196
MB 72,20,200
MB 76,20,204
W 0
MB 72,24,208
E 64
MB 76,24,212
MB 72,28,216
E 65
MB 76,28,220
CV 96,64
E 66
T 32,16,0
E 67
T 34,16,4
T 36,17,0
CV 97,66
E 68
T 38,17,4
E 69
T 40,18,0
CV 100,68
E 70
T 42,18,4
T 44,19,0
E 71
T 46,19,4
CV 101,70
E 72
T 48,20,0
E 73
T 50,20,4
T 52,21,0
CV 98,72
E 74
ZB 80,0,224
T 54,21,4
ZB 84,0,228
E 75
MB 80,4,232
T 56,22,0
CV 99,74
MB 84,4,236
E 76
MB 80,8,240
T 58,22,4
T 60,23,0
MB 84,8,244
E 77
MB 80,12,248
W 14
T 62,23,4
CV 102,76
MB 84,12,252
E 78
s_getpc_b64 s[88:89]
L_ct1_1362:
s_and_b32 s89, s89, 0xffff
s_mov_b32 s90, L_code_end-L_ct1_1362
s_mov_b32 s91, 0x20000
v_and_b32 v62, 0x70, v59
v_lshlrev_b32 v62, 3, v62
s_add_u32 s7, s1, 4096
buffer_load_dword v3, v62, s[88:91], s7 offen
ZB 88,16,224
E 79
ZB 92,16,228
MB 88,20,232
CV 103,78
MB 92,20,236
MB 88,24,240
E 80
MB 92,24,244
MB 88,28,248
E 81
MB 92,28,252
W 12
ZA 128,32,96
s_waitcnt vmcnt(9) lgkmcnt(0)
s_barrier
R a,0,8,16
ZA 132,32,100
CV 104,80
E 82
ZA 136,36,96
R a,4,9,16
ZA 140,36,100
E 83
ZA 144,40,96
R a,8,10,16
CV 105,82
ZA 148,40,100
E 84
ZA 152,44,96
R a,12,11,16
ZA 156,44,100
E 85
ZA 160,48,96
R a,16,8,20
CV 108,84
ZA 164,48,100
E 86
ZA 168,52,96
R a,20,9,20
ZA 172,52,100
E 87
ZA 176,56,96
R a,24,10,20
CV 109,86
ZA 180,56,100
E 88
ZA 184,60,96
R a,28,11,20
ZA 188,60,100
E 89
ZD 112,52,96
CV 106,88
E 90
ZD 116,52,100
s_xor_b32 m0, s65, 0x10000
s_xor_b32 s66, s64, 0x1000
W 6
ZB 64,0,192
G 48,48,66,0,nt
ZB 68,0,196
E 91
MB 64,4,200
CV 107,90
MB 68,4,204
E 92
W 4
MB 64,8,208
G 49,48,66,1,nt
MB 68,8,212
E 93
MB 64,12,216
CV 110,92
MB 68,12,220
E 94
W 2
ZB 72,16,192
G 50,48,66,2,nt
ZB 76,16,196
E 95
MB 72,20,200
CV 111,94
MB 76,20,204
W 0
MB 72,24,208
G 51,48,66,3,nt
MB 76,24,212
E 64
MB 72,28,216
E 65
MB 76,28,220
ZA 192,32,104
CV 96,64
ZA 196,32,108
E 66
ZA 200,36,104
T 32,16,16
ZA 204,36,108
E 67
ZA 208,40,104
T 34,16,20
T 36,17,16
ZA 212,40,108
CV 97,66
E 68
ZA 216,44,104
T 38,17,20
ZA 220,44,108
E 69
ZA 224,48,104
T 40,18,16
CV 100,68
ZA 228,48,108
E 70
ZA 232,52,104
T 42,18,20
T 44,19,16
ZA 236,52,108
E 71
ZA 240,56,104
T 46,19,20
CV 101,70
ZA 244,56,108
E 72
ZA 248,60,104
T 48,20,16
ZA 252,60,108
E 73
ZD 120,52,104
T 50,20,20
T 52,21,16
ZD 124,52,108
CV 98,72
E 74
ZB 80,0,224
T 54,21,20
ZB 84,0,228
E 75
MB 80,4,232
T 56,22,16
CV 99,74
MB 84,4,236
E 76
MB 80,8,240
T 58,22,20
T 60,23,16
MB 84,8,244
E 77
MB 80,12,248
W 14
T 62,23,20
CV 102,76
MB 84,12,252
E 78
ZB 88,16,224
E 79
ZB 92,16,228
MB 88,20,232
CV 103,78
MB 92,20,236
MB 88,24,240
E 80
MB 92,24,244
MB 88,28,248
E 81
MB 92,28,252
W 12
MA 128,32,96
s_waitcnt vmcnt(9) lgkmcnt(0)
s_barrier
R a,0,8,32
MA 132,32,100
CV 104,80
E 82
MA 136,36,96
R a,4,9,32
MA 140,36,100
E 83
MA 144,40,96
R a,8,10,32
CV 105,82
MA 148,40,100
E 84
MA 152,44,96
R a,12,11,32
MA 156,44,100
E 85
MA 160,48,96
R a,16,8,36
CV 108,84
MA 164,48,100
E 86
MA 168,52,96
R a,20,9,36
MA 172,52,100
E 87
MA 176,56,96
R a,24,10,36
CV 109,86
MA 180,56,100
E 88
MA 184,60,96
R a,28,11,36
MA 188,60,100
E 89
MD 112,52,96
CV 106,88
E 90
MD 116,52,100
s_xor_b32 m0, s65, 0x14000
s_xor_b32 s66, s64, 0x11000
W 6
ZB 64,0,192
G 48,48,66,0,nt
ZB 68,0,196
E 91
MB 64,4,200
CV 107,90
MB 68,4,204
E 92
W 4
MB 64,8,208
G 49,48,66,1,nt
MB 68,8,212
E 93
MB 64,12,216
CV 110,92
MB 68,12,220
E 94
W 2
ZB 72,16,192
G 50,48,66,2,nt
ZB 76,16,196
E 95
MB 72,20,200
CV 111,94
MB 76,20,204
W 0
MB 72,24,208
G 51,48,66,3,nt
MB 76,24,212
E 64
MB 72,28,216
E 65
MB 76,28,220
MA 192,32,104
CV 96,64
MA 196,32,108
E 66
MA 200,36,104
T 32,16,32
MA 204,36,108
E 67
MA 208,40,104
T 34,16,36
T 36,17,32
MA 212,40,108
CV 97,66
E 68
MA 216,44,104
T 38,17,36
MA 220,44,108
E 69
MA 224,48,104
T 40,18,32
CV 100,68
MA 228,48,108
E 70
MA 232,52,104
T 42,18,36
T 44,19,32
MA 236,52,108
E 71
MA 240,56,104
T 46,19,36
CV 101,70
MA 244,56,108
E 72
MA 248,60,104
T 48,20,32
MA 252,60,108
E 73
MD 120,52,104
T 50,20,36
T 52,21,32
MD 124,52,108
CV 98,72
E 74
ZB 80,0,224
T 54,21,36
ZB 84,0,228
E 75
MB 80,4,232
T 56,22,32
CV 99,74
MB 84,4,236
E 76
MB 80,8,240
T 58,22,36
T 60,23,32
MB 84,8,244
E 77
MB 80,12,248
W 14
T 62,23,36
CV 102,76
MB 84,12,252
E 78
ZB 88,16,224
E 79
ZB 92,16,228
MB 88,20,232
CV 103,78
MB 92,20,236
MB 88,24,240
E 80
MB 92,24,244
MB 88,28,248
E 81
MB 92,28,252
W 12
MA 128,32,96
s_waitcnt vmcnt(9) lgkmcnt(0)
s_barrier
R a,0,8,48
MA 132,32,100
CV 104,80
E 82
MA 136,36,96
R a,4,9,48
MA 140,36,100
E 83
MA 144,40,96
R a,8,10,48
CV 105,82
MA 148,40,100
E 84
MA 152,44,96
R a,12,11,48
MA 156,44,100
E 85
MA 160,48,96
R a,16,8,52
CV 108,84
MA 164,48,100
E 86
MA 168,52,96
R a,20,9,52
MA 172,52,100
E 87
MA 176,56,96
R a,24,10,52
CV 109,86
MA 180,56,100
E 88
MA 184,60,96
R a,28,11,52
MA 188,60,100
E 89
MD 112,52,96
CV 106,88
E 90
MD 116,52,100
s_xor_b32 m0, s65, 0x18000
s_xor_b32 s66, s64, 0x3000
W 6
ZB 64,0,192
G 48,48,66,0,nt
ZB 68,0,196
E 91
MB 64,4,200
CV 107,90
MB 68,4,204
E 92
W 4
MB 64,8,208
G 49,48,66,1,nt
MB 68,8,212
E 93
MB 64,12,216
CV 110,92
MB 68,12,220
E 94
W 2
ZB 72,16,192
G 50,48,66,2,nt
ZB 76,16,196
E 95
MB 72,20,200
CV 111,94
MB 76,20,204
W 0
MB 72,24,208
G 51,48,66,3,nt
MB 76,24,212
E 64
MB 72,28,216
E 65
MB 76,28,220
MA 192,32,104
CV 96,64
MA 196,32,108
E 66
MA 200,36,104
T 32,16,48
MA 204,36,108
E 67
MA 208,40,104
T 34,16,52
T 36,17,48
MA 212,40,108
CV 97,66
E 68
MA 216,44,104
T 38,17,52
MA 220,44,108
E 69
MA 224,48,104
T 40,18,48
CV 100,68
MA 228,48,108
E 70
MA 232,52,104
T 42,18,52
T 44,19,48
MA 236,52,108
E 71
MA 240,56,104
T 46,19,52
CV 101,70
MA 244,56,108
E 72
MA 248,60,104
T 48,20,48
MA 252,60,108
E 73
MD 120,52,104
T 50,20,52
T 52,21,48
MD 124,52,108
CV 98,72
E 74
ZB 80,0,224
T 54,21,52
ZB 84,0,228
E 75
MB 80,4,232
T 56,22,48
CV 99,74
MB 84,4,236
E 76
MB 80,8,240
T 58,22,52
T 60,23,48
MB 84,8,244
E 77
MB 80,12,248
W 14
T 62,23,52
CV 102,76
MB 84,12,252
E 78
ZB 88,16,224
E 79
ZB 92,16,228
MB 88,20,232
CV 103,78
MB 92,20,236
MB 88,24,240
E 80
MB 92,24,244
MB 88,28,248
E 81
MB 92,28,252
W 12
MA 128,32,96
s_waitcnt vmcnt(8) lgkmcnt(0)
s_barrier
R a,0,12,0
MA 132,32,100
CV 104,80
E 82
MA 136,36,96
R a,4,13,0
MA 140,36,100
E 83
MA 144,40,96
R a,8,14,0
CV 105,82
MA 148,40,100
E 84
MA 152,44,96
R a,12,15,0
MA 156,44,100
E 85
MA 160,48,96
R a,16,12,4
CV 108,84
MA 164,48,100
E 86
MA 168,52,96
R a,20,13,4
MA 172,52,100
E 87
MA 176,56,96
R a,24,14,4
CV 109,86
MA 180,56,100
E 88
MA 184,60,96
R a,28,15,4
MA 188,60,100
E 89
MD 112,52,96
CV 106,88
E 90
MD 116,52,100
s_xor_b32 m0, s65, 0x1c000
s_xor_b32 s66, s64, 0x13000
W 6
ZB 64,0,192
G 48,48,66,0,nt
ZB 68,0,196
E 91
MB 64,4,200
CV 107,90
MB 68,4,204
E 92
W 4
MB 64,8,208
G 49,48,66,1,nt
MB 68,8,212
E 93
MB 64,12,216
CV 110,92
MB 68,12,220
E 94
W 2
ZB 72,16,192
G 50,48,66,2,nt
ZB 76,16,196
E 95
MB 72,20,200
CV 111,94
MB 76,20,204
W 0
MB 72,24,208
G 51,48,66,3,nt
MB 76,24,212
E 64
MB 72,28,216
E 65
MB 76,28,220
MA 192,32,104
CV 96,64
MA 196,32,108
E 66
MA 200,36,104
T 32,24,0
MA 204,36,108
E 67
MA 208,40,104
T 34,24,4
T 36,25,0
MA 212,40,108
CV 97,66
E 68
MA 216,44,104
T 38,25,4
MA 220,44,108
E 69
MA 224,48,104
T 40,26,0
CV 100,68
MA 228,48,108
E 70
MA 232,52,104
T 42,26,4
T 44,27,0
MA 236,52,108
E 71
MA 240,56,104
T 46,27,4
CV 101,70
MA 244,56,108
E 72
MA 248,60,104
T 48,28,0
MA 252,60,108
E 73
MD 120,52,104
T 50,28,4
T 52,29,0
MD 124,52,108
CV 98,72
E 74
ZB 80,0,224
T 54,29,4
ZB 84,0,228
E 75
MB 80,4,232
T 56,30,0
CV 99,74
MB 84,4,236
E 76
MB 80,8,240
T 58,30,4
T 60,31,0
MB 84,8,244
E 77
MB 80,12,248
W 14
T 62,31,4
CV 102,76
MB 84,12,252
E 78
ZB 88,16,224
E 79
ZB 92,16,228
MB 88,20,232
CV 103,78
MB 92,20,236
MB 88,24,240
E 80
MB 92,24,244
MB 88,28,248
E 81
MB 92,28,252
W 12
MA 128,32,96
s_waitcnt vmcnt(8) lgkmcnt(0)
s_barrier
R a,0,12,16
MA 132,32,100
CV 104,80
E 82
MA 136,36,96
R a,4,13,16
MA 140,36,100
E 83
MA 144,40,96
R a,8,14,16
CV 105,82
MA 148,40,100
E 84
MA 152,44,96
R a,12,15,16
MA 156,44,100
E 85
MA 160,48,96
R a,16,12,20
CV 108,84
MA 164,48,100
E 86
MA 168,52,96
R a,20,13,20
MA 172,52,100
E 87
MA 176,56,96
R a,24,14,20
CV 109,86
MA 180,56,100
E 88
MA 184,60,96
R a,28,15,20
MA 188,60,100
E 89
MD 112,52,96
CV 106,88
E 90
MD 116,52,100
s_xor_b32 m0, s65, 0x0
s_xor_b32 s66, s64, 0x4000
W 6
ZB 64,0,192
G 48,48,66,0,nt
ZB 68,0,196
E 91
MB 64,4,200
CV 107,90
MB 68,4,204
E 92
W 4
MB 64,8,208
G 49,48,66,1,nt
MB 68,8,212
E 93
MB 64,12,216
CV 110,92
MB 68,12,220
E 94
W 2
ZB 72,16,192
G 50,48,66,2,nt
ZB 76,16,196
E 95
MB 72,20,200
CV 111,94
MB 76,20,204
W 0
MB 72,24,208
G 51,48,66,3,nt
MB 76,24,212
E 64
MB 72,28,216
E 65
MB 76,28,220
MA 192,32,104
CV 96,64
MA 196,32,108
E 66
MA 200,36,104
T 32,24,16
MA 204,36,108
E 67
MA 208,40,104
T 34,24,20
T 36,25,16
MA 212,40,108
CV 97,66
E 68
MA 216,44,104
T 38,25,20
MA 220,44,108
E 69
MA 224,48,104
T 40,26,16
CV 100,68
MA 228,48,108
E 70
MA 232,52,104
T 42,26,20
T 44,27,16
MA 236,52,108
E 71
MA 240,56,104
T 46,27,20
CV 101,70
MA 244,56,108
E 72
MA 248,60,104
T 48,28,16
MA 252,60,108
E 73
MD 120,52,104
T 50,28,20
T 52,29,16
MD 124,52,108
CV 98,72
E 74
ZB 80,0,224
T 54,29,20
ZB 84,0,228
E 75
MB 80,4,232
T 56,30,16
CV 99,74
MB 84,4,236
E 76
MB 80,8,240
T 58,30,20
T 60,31,16
MB 84,8,244
E 77
MB 80,12,248
W 14
T 62,31,20
CV 102,76
MB 84,12,252
E 78
ZB 88,16,224
E 79
ZB 92,16,228
MB 88,20,232
CV 103,78
MB 92,20,236
MB 88,24,240
E 80
MB 92,24,244
MB 88,28,248
E 81
MB 92,28,252
W 12
MA 128,32,96
s_waitcnt vmcnt(8) lgkmcnt(0)
s_barrier
R a,0,12,32
MA 132,32,100
CV 104,80
E 82
MA 136,36,96
R a,4,13,32
MA 140,36,100
E 83
MA 144,40,96
R a,8,14,32
CV 105,82
MA 148,40,100
E 84
MA 152,44,96
R a,12,15,32
MA 156,44,100
E 85
MA 160,48,96
R a,16,12,36
CV 108,84
MA 164,48,100
E 86
MA 168,52,96
R a,20,13,36
MA 172,52,100
E 87
MA 176,56,96
R a,24,14,36
CV 109,86
MA 180,56,100
E 88
MA 184,60,96
R a,28,15,36
MA 188,60,100
E 89
MD 112,52,96
CV 106,88
E 90
MD 116,52,100
s_xor_b32 m0, s65, 0x4000
s_xor_b32 s66, s64, 0x14000
W 6
ZB 64,0,192
G 48,48,66,0,nt
ZB 68,0,196
E 91
MB 64,4,200
CV 107,90
MB 68,4,204
E 92
W 4
MB 64,8,208
G 49,48,66,1,nt
MB 68,8,212
E 93
MB 64,12,216
CV 110,92
MB 68,12,220
E 94
W 2
ZB 72,16,192
G 50,48,66,2,nt
ZB 76,16,196
E 95
MB 72,20,200
CV 111,94
MB 76,20,204
W 0
MB 72,24,208
G 51,48,66,3,nt
MB 76,24,212
E 64
MB 72,28,216
E 65
MB 76,28,220
MA 192,32,104
CV 96,64
MA 196,32,108
E 66
MA 200,36,104
T 32,24,32
MA 204,36,108
E 67
MA 208,40,104
T 34,24,36
T 36,25,32
MA 212,40,108
CV 97,66
E 68
MA 216,44,104
T 38,25,36
MA 220,44,108
E 69
MA 224,48,104
T 40,26,32
CV 100,68
MA 228,48,108
E 70
MA 232,52,104
T 42,26,36
T 44,27,32
MA 236,52,108
E 71
MA 240,56,104
T 46,27,36
CV 101,70
MA 244,56,108
E 72
MA 248,60,104
T 48,28,32
MA 252,60,108
E 73
MD 120,52,104
T 50,28,36
T 52,29,32
MD 124,52,108
CV 98,72
E 74
ZB 80,0,224
T 54,29,36
ZB 84,0,228
E 75
MB 80,4,232
T 56,30,32
CV 99,74
MB 84,4,236
E 76
MB 80,8,240
T 58,30,36
T 60,31,32
MB 84,8,244
E 77
MB 80,12,248
W 14
T 62,31,36
CV 102,76
MB 84,12,252
E 78
ZB 88,16,224
E 79
ZB 92,16,228
MB 88,20,232
CV 103,78
MB 92,20,236
MB 88,24,240
E 80
MB 92,24,244
MB 88,28,248
E 81
MB 92,28,252
W 12
MA 128,32,96
s_waitcnt vmcnt(8) lgkmcnt(0)
s_barrier
R a,0,12,48
MA 132,32,100
CV 104,80
E 82
MA 136,36,96
R a,4,13,48
MA 140,36,100
E 83
MA 144,40,96
R a,8,14,48
CV 105,82
MA 148,40,100
E 84
MA 152,44,96
R a,12,15,48
MA 156,44,100
E 85
MA 160,48,96
R a,16,12,52
CV 108,84
MA 164,48,100
E 86
MA 168,52,96
R a,20,13,52
MA 172,52,100
E 87
MA 176,56,96
R a,24,14,52
CV 109,86
MA 180,56,100
E 88
MA 184,60,96
R a,28,15,52
MA 188,60,100
E 89
MD 112,52,96
CV 106,88
E 90
MD 116,52,100
s_xor_b32 m0, s65, 0x8000
s_xor_b32 s66, s64, 0x6000
W 6
ZB 64,0,192
G 48,48,66,0,nt
ZB 68,0,196
E 91
MB 64,4,200
CV 107,90
MB 68,4,204
E 92
W 4
MB 64,8,208
G 49,48,66,1,nt
MB 68,8,212
E 93
MB 64,12,216
CV 110,92
MB 68,12,220
E 94
W 2
ZB 72,16,192
G 50,48,66,2,nt
ZB 76,16,196
E 95
MB 72,20,200
CV 111,94
MB 76,20,204
W 0
MB 72,24,208
G 51,48,66,3,nt
MB 76,24,212
E 64
MB 72,28,216
E 65
MB 76,28,220
MA 192,32,104
CV 96,64
MA 196,32,108
E 66
MA 200,36,104
T 32,24,48
MA 204,36,108
E 67
MA 208,40,104
T 34,24,52
T 36,25,48
MA 212,40,108
CV 97,66
E 68
MA 216,44,104
T 38,25,52
MA 220,44,108
E 69
MA 224,48,104
T 40,26,48
CV 100,68
MA 228,48,108
E 70
MA 232,52,104
T 42,26,52
T 44,27,48
MA 236,52,108
E 71
MA 240,56,104
T 46,27,52
CV 101,70
MA 244,56,108
E 72
MA 248,60,104
T 48,28,48
MA 252,60,108
E 73
MD 120,52,104
T 50,28,52
T 52,29,48
MD 124,52,108
CV 98,72
E 74
ZB 80,0,224
T 54,29,52
ZB 84,0,228
E 75
MB 80,4,232
T 56,30,48
CV 99,74
MB 84,4,236
E 76
MB 80,8,240
T 58,30,52
T 60,31,48
MB 84,8,244
E 77
MB 80,12,248
W 14
T 62,31,52
CV 102,76
MB 84,12,252
E 78
ZB 88,16,224
E 79
ZB 92,16,228
MB 88,20,232
CV 103,78
MB 92,20,236
MB 88,24,240
E 80
MB 92,24,244
MB 88,28,248
E 81
MB 92,28,252
W 12
MA 128,32,96
s_waitcnt vmcnt(8) lgkmcnt(0)
s_barrier
R a,0,8,0
MA 132,32,100
CV 104,80
E 82
MA 136,36,96
R a,4,9,0
MA 140,36,100
E 83
MA 144,40,96
R a,8,10,0
CV 105,82
MA 148,40,100
E 84
MA 152,44,96
R a,12,11,0
MA 156,44,100
E 85
MA 160,48,96
R a,16,8,4
CV 108,84
MA 164,48,100
E 86
MA 168,52,96
R a,20,9,4
MA 172,52,100
E 87
MA 176,56,96
R a,24,10,4
CV 109,86
MA 180,56,100
E 88
MA 184,60,96
R a,28,11,4
MA 188,60,100
E 89
MD 112,52,96
CV 106,88
E 90
MD 116,52,100
s_xor_b32 m0, s65, 0xc000
s_xor_b32 s66, s64, 0x16000
W 6
ZB 64,0,192
G 48,48,66,0,nt
ZB 68,0,196
E 91
MB 64,4,200
CV 107,90
MB 68,4,204
E 92
W 4
MB 64,8,208
G 49,48,66,1,nt
MB 68,8,212
E 93
MB 64,12,216
CV 110,92
MB 68,12,220
E 94
W 2
ZB 72,16,192
G 50,48,66,2,nt
ZB 76,16,196
E 95
MB 72,20,200
CV 111,94
MB 76,20,204
W 0
MB 72,24,208
G 51,48,66,3,nt
MB 76,24,212
E 64
MB 72,28,216
E 65
MB 76,28,220
MA 192,32,104
CV 96,64
MA 196,32,108
E 66
MA 200,36,104
T 32,16,0
MA 204,36,108
E 67
MA 208,40,104
T 34,16,4
T 36,17,0
MA 212,40,108
CV 97,66
E 68
MA 216,44,104
T 38,17,4
MA 220,44,108
E 69
MA 224,48,104
T 40,18,0
CV 100,68
MA 228,48,108
E 70
MA 232,52,104
T 42,18,4
T 44,19,0
MA 236,52,108
E 71
MA 240,56,104
T 46,19,4
CV 101,70
MA 244,56,108
E 72
MA 248,60,104
T 48,20,0
MA 252,60,108
E 73
MD 120,52,104
T 50,20,4
T 52,21,0
MD 124,52,108
CV 98,72
E 74
ZB 80,0,224
T 54,21,4
ZB 84,0,228
E 75
MB 80,4,232
T 56,22,0
CV 99,74
MB 84,4,236
E 76
MB 80,8,240
T 58,22,4
T 60,23,0
MB 84,8,244
E 77
MB 80,12,248
W 14
T 62,23,4
CV 102,76
MB 84,12,252
E 78
ZB 88,16,224
E 79
ZB 92,16,228
MB 88,20,232
CV 103,78
MB 92,20,236
MB 88,24,240
E 80
MB 92,24,244
MB 88,28,248
E 81
MB 92,28,252
W 12
MA 128,32,96
s_waitcnt vmcnt(8) lgkmcnt(0)
s_barrier
R a,0,8,16
MA 132,32,100
CV 104,80
E 82
MA 136,36,96
R a,4,9,16
MA 140,36,100
E 83
MA 144,40,96
R a,8,10,16
CV 105,82
MA 148,40,100
E 84
MA 152,44,96
R a,12,11,16
MA 156,44,100
E 85
MA 160,48,96
R a,16,8,20
CV 108,84
MA 164,48,100
E 86
MA 168,52,96
R a,20,9,20
MA 172,52,100
E 87
MA 176,56,96
R a,24,10,20
CV 109,86
MA 180,56,100
E 88
MA 184,60,96
R a,28,11,20
MA 188,60,100
E 89
MD 112,52,96
CV 106,88
E 90
MD 116,52,100
s_xor_b32 m0, s65, 0x10000
s_xor_b32 s66, s64, 0x5000
W 6
ZB 64,0,192
G 48,48,66,0,nt
ZB 68,0,196
E 91
MB 64,4,200
CV 107,90
MB 68,4,204
E 92
W 4
MB 64,8,208
G 49,48,66,1,nt
MB 68,8,212
E 93
MB 64,12,216
CV 110,92
MB 68,12,220
E 94
W 2
ZB 72,16,192
G 50,48,66,2,nt
ZB 76,16,196
E 95
MB 72,20,200
CV 111,94
MB 76,20,204
W 0
MB 72,24,208
G 51,48,66,3,nt
MB 76,24,212
E 64
MB 72,28,216
E 65
MB 76,28,220
MA 192,32,104
CV 96,64
MA 196,32,108
E 66
MA 200,36,104
T 32,16,16
MA 204,36,108
E 67
MA 208,40,104
T 34,16,20
T 36,17,16
MA 212,40,108
CV 97,66
E 68
MA 216,44,104
T 38,17,20
MA 220,44,108
E 69
MA 224,48,104
T 40,18,16
CV 100,68
MA 228,48,108
E 70
MA 232,52,104
T 42,18,20
T 44,19,16
MA 236,52,108
E 71
MA 240,56,104
T 46,19,20
CV 101,70
MA 244,56,108
E 72
MA 248,60,104
T 48,20,16
MA 252,60,108
E 73
MD 120,52,104
T 50,20,20
T 52,21,16
MD 124,52,108
CV 98,72
E 74
ZB 80,0,224
T 54,21,20
ZB 84,0,228
E 75
MB 80,4,232
T 56,22,16
CV 99,74
MB 84,4,236
E 76
MB 80,8,240
T 58,22,20
T 60,23,16
MB 84,8,244
E 77
MB 80,12,248
W 14
T 62,23,20
CV 102,76
MB 84,12,252
E 78
ZB 88,16,224
E 79
ZB 92,16,228
MB 88,20,232
s_xor_b32 s79, s67, 0x1011000
MB 92,20,236
buffer_store_dwordx4 a[132:135], v59, s[52:55], s79 offen sc1
CV 103,78
MB 88,24,240
E 80
MB 92,24,244
MB 88,28,248
s_xor_b32 s79, s67, 0x1022000
buffer_store_dwordx4 a[136:139], v59, s[52:55], s79 offen sc1
MB 92,28,252
E 81
W 12
MA 128,32,96
s_waitcnt vmcnt(10) lgkmcnt(0)
s_barrier
R a,0,8,32
MA 132,32,100
CV 104,80
E 82
MA 136,36,96
R a,4,9,32
MA 140,36,100
E 83
MA 144,40,96
R a,8,10,32
CV 105,82
MA 148,40,100
E 84
MA 152,44,96
R a,12,11,32
MA 156,44,100
E 85
MA 160,48,96
R a,16,8,36
CV 108,84
MA 164,48,100
E 86
MA 168,52,96
R a,20,9,36
MA 172,52,100
E 87
MA 176,56,96
R a,24,10,36
CV 109,86
MA 180,56,100
E 88
MA 184,60,96
R a,28,11,36
MA 188,60,100
E 89
MD 112,52,96
CV 106,88
E 90
MD 116,52,100
s_xor_b32 m0, s65, 0x14000
s_xor_b32 s66, s64, 0x15000
W 6
ZB 64,0,192
G 48,48,66,0,nt
ZB 68,0,196
E 91
MB 64,4,200
CV 107,90
MB 68,4,204
E 92
W 4
MB 64,8,208
G 49,48,66,1,nt
MB 68,8,212
E 93
MB 64,12,216
CV 110,92
MB 68,12,220
E 94
W 2
ZB 72,16,192
G 50,48,66,2,nt
ZB 76,16,196
E 95
MB 72,20,200
CV 111,94
MB 76,20,204
W 0
MB 72,24,208
G 51,48,66,3,nt
MB 76,24,212
E 64
MB 72,28,216
E 65
MB 76,28,220
MA 192,32,104
CV 96,64
MA 196,32,108
E 66
MA 200,36,104
T 32,16,32
MA 204,36,108
E 67
MA 208,40,104
T 34,16,36
T 36,17,32
MA 212,40,108
CV 97,66
E 68
MA 216,44,104
T 38,17,36
MA 220,44,108
E 69
MA 224,48,104
T 40,18,32
CV 100,68
MA 228,48,108
E 70
MA 232,52,104
T 42,18,36
T 44,19,32
MA 236,52,108
E 71
MA 240,56,104
T 46,19,36
CV 101,70
MA 244,56,108
E 72
MA 248,60,104
T 48,20,32
MA 252,60,108
E 73
MD 120,52,104
T 50,20,36
T 52,21,32
MD 124,52,108
CV 98,72
E 74
ZB 80,0,224
T 54,21,36
ZB 84,0,228
E 75
MB 80,4,232
T 56,22,32
CV 99,74
MB 84,4,236
E 76
MB 80,8,240
T 58,22,36
T 60,23,32
MB 84,8,244
E 77
MB 80,12,248
W 14
T 62,23,36
CV 102,76
MB 84,12,252
E 78
ZB 88,16,224
E 79
ZB 92,16,228
MB 88,20,232
s_xor_b32 s79, s67, 0x1033000
MB 92,20,236
buffer_store_dwordx4 a[140:143], v59, s[52:55], s79 offen sc1
CV 103,78
MB 88,24,240
E 80
MB 92,24,244
MB 88,28,248
s_xor_b32 s79, s67, 0x1044000
buffer_store_dwordx4 a[144:147], v59, s[52:55], s79 offen sc1
MB 92,28,252
E 81
W 12
MA 128,32,96
s_waitcnt vmcnt(12) lgkmcnt(0)
s_barrier
R a,0,8,48
MA 132,32,100
CV 104,80
E 82
MA 136,36,96
R a,4,9,48
MA 140,36,100
E 83
MA 144,40,96
R a,8,10,48
CV 105,82
MA 148,40,100
E 84
MA 152,44,96
R a,12,11,48
MA 156,44,100
E 85
MA 160,48,96
R a,16,8,52
CV 108,84
MA 164,48,100
E 86
MA 168,52,96
R a,20,9,52
MA 172,52,100
E 87
MA 176,56,96
R a,24,10,52
CV 109,86
MA 180,56,100
E 88
MA 184,60,96
R a,28,11,52
MA 188,60,100
E 89
MD 112,52,96
CV 106,88
E 90
MD 116,52,100
s_xor_b32 m0, s65, 0x18000
s_xor_b32 s66, s64, 0x7000
W 6
ZB 64,0,192
G 48,48,66,0,nt
ZB 68,0,196
E 91
MB 64,4,200
CV 107,90
MB 68,4,204
E 92
W 4
MB 64,8,208
G 49,48,66,1,nt
MB 68,8,212
E 93
MB 64,12,216
CV 110,92
MB 68,12,220
E 94
W 2
ZB 72,16,192
G 50,48,66,2,nt
ZB 76,16,196
E 95
MB 72,20,200
CV 111,94
MB 76,20,204
W 0
MB 72,24,208
G 51,48,66,3,nt
MB 76,24,212
E 64
MB 72,28,216
E 65
MB 76,28,220
MA 192,32,104
CV 96,64
MA 196,32,108
E 66
MA 200,36,104
T 32,16,48
MA 204,36,108
E 67
MA 208,40,104
T 34,16,52
T 36,17,48
MA 212,40,108
CV 97,66
E 68
MA 216,44,104
T 38,17,52
MA 220,44,108
E 69
MA 224,48,104
T 40,18,48
CV 100,68
MA 228,48,108
E 70
MA 232,52,104
T 42,18,52
T 44,19,48
MA 236,52,108
E 71
MA 240,56,104
T 46,19,52
CV 101,70
MA 244,56,108
E 72
MA 248,60,104
T 48,20,48
MA 252,60,108
E 73
MD 120,52,104
T 50,20,52
T 52,21,48
MD 124,52,108
CV 98,72
E 74
ZB 80,0,224
T 54,21,52
ZB 84,0,228
E 75
MB 80,4,232
T 56,22,48
CV 99,74
MB 84,4,236
E 76
MB 80,8,240
T 58,22,52
T 60,23,48
MB 84,8,244
E 77
MB 80,12,248
W 14
T 62,23,52
CV 102,76
MB 84,12,252
E 78
ZB 88,16,224
E 79
ZB 92,16,228
MB 88,20,232
s_xor_b32 s79, s67, 0x1055000
MB 92,20,236
buffer_store_dwordx4 a[148:151], v59, s[52:55], s79 offen sc1
CV 103,78
MB 88,24,240
E 80
MB 92,24,244
MB 88,28,248
s_xor_b32 s79, s67, 0x1066000
buffer_store_dwordx4 a[152:155], v59, s[52:55], s79 offen sc1
MB 92,28,252
E 81
W 12
MA 128,32,96
s_waitcnt vmcnt(14) lgkmcnt(0)
s_barrier
R a,0,12,0
MA 132,32,100
CV 104,80
E 82
MA 136,36,96
R a,4,13,0
MA 140,36,100
E 83
MA 144,40,96
R a,8,14,0
CV 105,82
MA 148,40,100
E 84
MA 152,44,96
R a,12,15,0
MA 156,44,100
E 85
MA 160,48,96
R a,16,12,4
CV 108,84
MA 164,48,100
E 86
MA 168,52,96
R a,20,13,4
MA 172,52,100
E 87
MA 176,56,96
R a,24,14,4
CV 109,86
MA 180,56,100
E 88
MA 184,60,96
R a,28,15,4
MA 188,60,100
E 89
MD 112,52,96
CV 106,88
E 90
MD 116,52,100
s_xor_b32 m0, s65, 0x1c000
s_xor_b32 s66, s64, 0x17000
W 6
ZB 64,0,192
G 48,48,66,0,nt
ZB 68,0,196
E 91
MB 64,4,200
CV 107,90
MB 68,4,204
E 92
W 4
MB 64,8,208
G 49,48,66,1,nt
MB 68,8,212
E 93
MB 64,12,216
CV 110,92
MB 68,12,220
E 94
W 2
ZB 72,16,192
G 50,48,66,2,nt
ZB 76,16,196
E 95
MB 72,20,200
CV 111,94
MB 76,20,204
W 0
MB 72,24,208
G 51,48,66,3,nt
MB 76,24,212
E 64
MB 72,28,216
E 65
MB 76,28,220
s_xor_b32 m0, s65, 0x0
s_xor_b32 s66, s62, 0x0
MA 192,32,104
G 44,24,66,0
MA 196,32,108
CV 96,64
E 66
MA 200,36,104
T 32,24,0
MA 204,36,108
E 67
MA 208,40,104
G 45,24,66,1
T 34,24,4
MA 212,40,108
T 36,25,0
CV 97,66
E 68
MA 216,44,104
T 38,25,4
MA 220,44,108
E 69
MA 224,48,104
G 46,24,66,2
T 40,26,0
MA 228,48,108
CV 100,68
E 70
MA 232,52,104
T 42,26,4
T 44,27,0
MA 236,52,108
E 71
MA 240,56,104
G 47,24,66,3
T 46,27,4
MA 244,56,108
CV 101,70
E 72
MA 248,60,104
T 48,28,0
MA 252,60,108
E 73
MD 120,52,104
T 50,28,4
T 52,29,0
MD 124,52,108
CV 98,72
E 74
ZB 80,0,224
T 54,29,4
ZB 84,0,228
E 75
MB 80,4,232
T 56,30,0
CV 99,74
MB 84,4,236
E 76
MB 80,8,240
T 58,30,4
T 60,31,0
MB 84,8,244
E 77
MB 80,12,248
W 14
T 62,31,4
CV 102,76
MB 84,12,252
E 78
ZB 88,16,224
E 79
ZB 92,16,228
MB 88,20,232
s_xor_b32 s79, s67, 0x1077000
MB 92,20,236
buffer_store_dwordx4 a[156:159], v59, s[52:55], s79 offen sc1
CV 103,78
MB 88,24,240
E 80
MB 92,24,244
MB 88,28,248
s_xor_b32 s79, s67, 0x1019000
buffer_store_dwordx4 a[68:71], v59, s[52:55], s79 offen sc1
MB 92,28,252
E 81
W 12
MA 128,32,96
s_waitcnt vmcnt(18) lgkmcnt(0)
s_barrier
R a,0,12,16
MA 132,32,100
CV 104,80
E 82
MA 136,36,96
R a,4,13,16
MA 140,36,100
E 83
MA 144,40,96
R a,8,14,16
CV 105,82
MA 148,40,100
E 84
MA 152,44,96
R a,12,15,16
MA 156,44,100
E 85
MA 160,48,96
R a,16,12,20
CV 108,84
MA 164,48,100
E 86
MA 168,52,96
R a,20,13,20
MA 172,52,100
E 87
MA 176,56,96
R a,24,14,20
CV 109,86
MA 180,56,100
E 88
MA 184,60,96
R a,28,15,20
MA 188,60,100
E 89
MD 112,52,96
CV 106,88
E 90
MD 116,52,100
s_xor_b32 m0, s65, 0x4000
s_xor_b32 s66, s62, 0x8000
W 6
ZB 64,0,192
G 44,24,66,0
ZB 68,0,196
E 91
MB 64,4,200
CV 107,90
MB 68,4,204
E 92
W 4
MB 64,8,208
G 45,24,66,1
MB 68,8,212
E 93
MB 64,12,216
CV 110,92
MB 68,12,220
E 94
W 2
ZB 72,16,192
G 46,24,66,2
ZB 76,16,196
E 95
MB 72,20,200
CV 111,94
MB 76,20,204
W 0
MB 72,24,208
G 47,24,66,3
MB 76,24,212
E 64
MB 72,28,216
E 65
MB 76,28,220
s_xor_b32 m0, s65, 0x8000
s_xor_b32 s66, s62, 0x10000
MA 192,32,104
G 44,24,66,0
MA 196,32,108
CV 96,64
E 66
MA 200,36,104
T 32,24,16
MA 204,36,108
E 67
MA 208,40,104
G 45,24,66,1
T 34,24,20
MA 212,40,108
T 36,25,16
CV 97,66
E 68
MA 216,44,104
T 38,25,20
MA 220,44,108
E 69
MA 224,48,104
G 46,24,66,2
T 40,26,16
MA 228,48,108
CV 100,68
E 70
MA 232,52,104
T 42,26,20
T 44,27,16
MA 236,52,108
E 71
MA 240,56,104
G 47,24,66,3
T 46,27,20
MA 244,56,108
CV 101,70
E 72
MA 248,60,104
T 48,28,16
MA 252,60,108
E 73
MD 120,52,104
T 50,28,20
T 52,29,16
MD 124,52,108
CV 98,72
E 74
ZB 80,0,224
T 54,29,20
ZB 84,0,228
E 75
MB 80,4,232
T 56,30,16
CV 99,74
MB 84,4,236
E 76
MB 80,8,240
T 58,30,20
T 60,31,16
MB 84,8,244
E 77
MB 80,12,248
W 14
T 62,31,20
CV 102,76
MB 84,12,252
E 78
ZB 88,16,224
E 79
ZB 92,16,228
MB 88,20,232
s_xor_b32 s79, s67, 0x102a000
MB 92,20,236
buffer_store_dwordx4 a[72:75], v59, s[52:55], s79 offen sc1
CV 103,78
MB 88,24,240
E 80
MB 92,24,244
MB 88,28,248
s_xor_b32 s79, s67, 0x103b000
buffer_store_dwordx4 a[76:79], v59, s[52:55], s79 offen sc1
MB 92,28,252
E 81
W 12
MA 128,32,96
s_waitcnt vmcnt(22) lgkmcnt(0)
s_barrier
R a,0,12,32
MA 132,32,100
CV 104,80
E 82
MA 136,36,96
R a,4,13,32
MA 140,36,100
E 83
MA 144,40,96
R a,8,14,32
CV 105,82
MA 148,40,100
E 84
MA 152,44,96
R a,12,15,32
MA 156,44,100
E 85
MA 160,48,96
R a,16,12,36
CV 108,84
MA 164,48,100
E 86
MA 168,52,96
R a,20,13,36
MA 172,52,100
E 87
MA 176,56,96
R a,24,14,36
CV 109,86
MA 180,56,100
E 88
MA 184,60,96
R a,28,15,36
MA 188,60,100
E 89
MD 112,52,96
CV 106,88
E 90
MD 116,52,100
s_xor_b32 m0, s65, 0xc000
s_xor_b32 s66, s62, 0x18000
W 6
ZB 64,0,192
G 44,24,66,0
ZB 68,0,196
E 91
MB 64,4,200
CV 107,90
MB 68,4,204
E 92
W 4
MB 64,8,208
G 45,24,66,1
MB 68,8,212
E 93
MB 64,12,216
CV 110,92
MB 68,12,220
E 94
W 2
ZB 72,16,192
G 46,24,66,2
ZB 76,16,196
E 95
MB 72,20,200
CV 111,94
MB 76,20,204
W 0
MB 72,24,208
G 47,24,66,3
MB 76,24,212
E 64
MB 72,28,216
E 65
MB 76,28,220
s_xor_b32 m0, s65, 0x10000
s_xor_b32 s66, s62, 0x20000
MA 192,32,104
G 44,24,66,0
MA 196,32,108
CV 96,64
E 66
MA 200,36,104
T 32,24,32
MA 204,36,108
E 67
MA 208,40,104
G 45,24,66,1
T 34,24,36
MA 212,40,108
T 36,25,32
CV 97,66
E 68
MA 216,44,104
T 38,25,36
MA 220,44,108
E 69
MA 224,48,104
G 46,24,66,2
T 40,26,32
MA 228,48,108
CV 100,68
E 70
MA 232,52,104
T 42,26,36
T 44,27,32
MA 236,52,108
E 71
MA 240,56,104
G 47,24,66,3
T 46,27,36
MA 244,56,108
CV 101,70
E 72
MA 248,60,104
T 48,28,32
MA 252,60,108
E 73
MD 120,52,104
T 50,28,36
T 52,29,32
MD 124,52,108
CV 98,72
E 74
ZB 80,0,224
T 54,29,36
ZB 84,0,228
E 75
MB 80,4,232
T 56,30,32
CV 99,74
MB 84,4,236
E 76
MB 80,8,240
T 58,30,36
T 60,31,32
MB 84,8,244
E 77
MB 80,12,248
W 14
T 62,31,36
CV 102,76
MB 84,12,252
E 78
ZB 88,16,224
E 79
ZB 92,16,228
MB 88,20,232
s_xor_b32 s79, s67, 0x104c000
MB 92,20,236
buffer_store_dwordx4 a[80:83], v59, s[52:55], s79 offen sc1
CV 103,78
MB 88,24,240
E 80
MB 92,24,244
MB 88,28,248
s_xor_b32 s79, s67, 0x105d000
buffer_store_dwordx4 a[84:87], v59, s[52:55], s79 offen sc1
MB 92,28,252
E 81
W 12
MA 128,32,96
s_waitcnt vmcnt(26) lgkmcnt(0)
s_barrier
R a,0,12,48
MA 132,32,100
CV 104,80
E 82
MA 136,36,96
R a,4,13,48
MA 140,36,100
E 83
MA 144,40,96
R a,8,14,48
CV 105,82
MA 148,40,100
E 84
MA 152,44,96
R a,12,15,48
MA 156,44,100
E 85
MA 160,48,96
R a,16,12,52
CV 108,84
MA 164,48,100
E 86
MA 168,52,96
R a,20,13,52
MA 172,52,100
E 87
MA 176,56,96
R a,24,14,52
CV 109,86
MA 180,56,100
E 88
MA 184,60,96
R a,28,15,52
MA 188,60,100
E 89
MD 112,52,96
CV 106,88
E 90
MD 116,52,100
s_xor_b32 m0, s65, 0x14000
s_xor_b32 s66, s62, 0x28000
W 6
ZB 64,0,192
G 44,24,66,0
ZB 68,0,196
E 91
MB 64,4,200
CV 107,90
MB 68,4,204
E 92
W 4
MB 64,8,208
G 45,24,66,1
MB 68,8,212
E 93
MB 64,12,216
CV 110,92
MB 68,12,220
E 94
W 2
ZB 72,16,192
G 46,24,66,2
ZB 76,16,196
E 95
MB 72,20,200
CV 111,94
MB 76,20,204
W 0
MB 72,24,208
G 47,24,66,3
MB 76,24,212
E 64
MB 72,28,216
E 65
MB 76,28,220
MA 192,32,104
CV 96,64
MA 196,32,108
E 66
MA 200,36,104
T 32,24,48
MA 204,36,108
E 67
MA 208,40,104
T 34,24,52
T 36,25,48
MA 212,40,108
CV 97,66
E 68
MA 216,44,104
T 38,25,52
MA 220,44,108
E 69
MA 224,48,104
T 40,26,48
CV 100,68
MA 228,48,108
E 70
MA 232,52,104
T 42,26,52
T 44,27,48
MA 236,52,108
E 71
MA 240,56,104
T 46,27,52
CV 101,70
MA 244,56,108
E 72
MA 248,60,104
T 48,28,48
MA 252,60,108
E 73
MD 120,52,104
T 50,28,52
T 52,29,48
MD 124,52,108
CV 98,72
E 74
ZB 80,0,224
T 54,29,52
ZB 84,0,228
E 75
MB 80,4,232
T 56,30,48
CV 99,74
MB 84,4,236
E 76
MB 80,8,240
T 58,30,52
T 60,31,48
MB 84,8,244
E 77
MB 80,12,248
W 14
T 62,31,52
CV 102,76
v_xor_b32 v16, s71, v16
MB 84,12,252
v_xor_b32 v17, s71, v17
E 78
ZB 88,16,224
v_xor_b32 v18, s71, v18
v_xor_b32 v19, s71, v19
ZB 92,16,228
E 79
MB 88,20,232
s_xor_b32 s79, s67, 0x106e000
buffer_store_dwordx4 a[88:91], v59, s[52:55], s79 offen sc1
MB 92,20,236
CV 103,78
v_xor_b32 v20, s71, v20
v_xor_b32 v21, s71, v21
MB 88,24,240
v_xor_b32 v22, s71, v22
v_xor_b32 v23, s71, v23
MB 92,24,244
E 80
MB 88,28,248
s_xor_b32 s79, s67, 0x107f000
buffer_store_dwordx4 a[92:95], v59, s[52:55], s79 offen sc1
MB 92,28,252
v_xor_b32 v24, s71, v24
v_xor_b32 v25, s71, v25
E 81
W 12
MA 128,32,96
CV 104,80
v_xor_b32 v26, s71, v26
MA 132,32,100
v_xor_b32 v27, s71, v27
E 82
MA 136,36,96
v_xor_b32 v28, s71, v28
v_xor_b32 v29, s71, v29
MA 140,36,100
E 83
W 8
MA 144,40,96
CV 105,82
v_xor_b32 v30, s71, v30
MA 148,40,100
v_xor_b32 v31, s71, v31
E 84
MA 152,44,96
E 85
MA 156,44,100
W 4
MA 160,48,96
CV 108,84
MA 164,48,100
E 86
MA 168,52,96
E 87
MA 172,52,100
W 0
MA 176,56,96
CV 109,86
MA 180,56,100
E 88
MA 184,60,96
E 89
MA 188,60,100
MD 112,52,96
CV 106,88
MD 116,52,100
E 90
E 91
s_nop 0
CV 107,90
E 92
E 93
s_nop 0
CV 110,92
E 94
E 95
s_nop 0
CV 111,94
MA 192,32,104
s_nop 0
MA 196,32,108
MA 200,36,104
MA 204,36,108
MA 208,40,104
MA 212,40,108
MA 216,44,104
MA 220,44,108
MA 224,48,104
s_waitcnt vmcnt(28)
s_barrier
T 0,16,0
MA 228,48,108
T 2,16,4
s_xor_b32 m0, s65, 0x18000
s_xor_b32 s66, s62, 0x30000
MA 232,52,104
G 44,24,66,0
MA 236,52,108
T 4,17,0
T 6,17,4
MA 240,56,104
T 8,18,0
MA 244,56,108
T 10,18,4
MA 248,60,104
G 45,24,66,1
MA 252,60,108
T 12,19,0
T 14,19,4
MD 120,52,104
T 16,20,0
MD 124,52,108
T 18,20,4
v_mov_b32 v60, v112
v_mov_b32 v61, v116
v_cmp_nle_f32 vcc, s76, v60
v_cmp_nge_f32 s[82:83], s77, v60
v_cmp_nle_f32 s[84:85], s76, v61
v_cmp_nge_f32 s[90:91], s77, v61
s_nop 1
s_or_b64 vcc, vcc, s[82:83]
s_or_b64 vcc, vcc, s[84:85]
s_or_b64 vcc, vcc, s[90:91]
s_cbranch_scc1 L_slow_c1A0
L_back_c1A0:
v_rcp_f32 v0, v60
v_rcp_f32 v1, v61
s_nop 0
v_pk_mul_f32 v[128:129], v[128:129], v[0:1] op_sel_hi:[1,0]
v_pk_mul_f32 v[130:131], v[130:131], v[0:1] op_sel_hi:[1,0]
v_pk_mul_f32 v[132:133], v[132:133], v[0:1] op_sel:[0,1]
v_pk_mul_f32 v[134:135], v[134:135], v[0:1] op_sel:[0,1]
v_pk_mul_f32 v[136:137], v[136:137], v[0:1] op_sel_hi:[1,0]
v_pk_mul_f32 v[138:139], v[138:139], v[0:1] op_sel_hi:[1,0]
v_pk_mul_f32 v[140:141], v[140:141], v[0:1] op_sel:[0,1]
v_pk_mul_f32 v[142:143], v[142:143], v[0:1] op_sel:[0,1]
CV 128,128
CV 130,130
CV 132,132
CV 134,134
CV 136,136
CV 138,138
CV 140,140
CV 142,142
AW 192,128
AW 193,130
AW 196,132
AW 197,134
AW 194,136
AW 195,138
AW 198,140
AW 199,142
v_pk_mul_f32 v[144:145], v[144:145], v[0:1] op_sel_hi:[1,0]
v_pk_mul_f32 v[146:147], v[146:147], v[0:1] op_sel_hi:[1,0]
v_pk_mul_f32 v[148:149], v[148:149], v[0:1] op_sel:[0,1]
v_pk_mul_f32 v[150:151], v[150:151], v[0:1] op_sel:[0,1]
v_pk_mul_f32 v[152:153], v[152:153], v[0:1] op_sel_hi:[1,0]
v_pk_mul_f32 v[154:155], v[154:155], v[0:1] op_sel_hi:[1,0]
v_pk_mul_f32 v[156:157], v[156:157], v[0:1] op_sel:[0,1]
v_pk_mul_f32 v[158:159], v[158:159], v[0:1] op_sel:[0,1]
CV 144,144
CV 146,146
CV 148,148
CV 150,150
CV 152,152
CV 154,154
CV 156,156
CV 158,158
AW 200,144
AW 201,146
AW 204,148
AW 205,150
AW 202,152
AW 203,154
AW 206,156
AW 207,158
v_pk_mul_f32 v[160:161], v[160:161], v[0:1] op_sel_hi:[1,0]
v_pk_mul_f32 v[162:163], v[162:163], v[0:1] op_sel_hi:[1,0]
v_pk_mul_f32 v[164:165], v[164:165], v[0:1] op_sel:[0,1]
v_pk_mul_f32 v[166:167], v[166:167], v[0:1] op_sel:[0,1]
v_pk_mul_f32 v[168:169], v[168:169], v[0:1] op_sel_hi:[1,0]
v_pk_mul_f32 v[170:171], v[170:171], v[0:1] op_sel_hi:[1,0]
v_pk_mul_f32 v[172:173], v[172:173], v[0:1] op_sel:[0,1]
v_pk_mul_f32 v[174:175], v[174:175], v[0:1] op_sel:[0,1]
CV 160,160
CV 162,162
CV 164,164
CV 166,166
CV 168,168
CV 170,170
CV 172,172
CV 174,174
AW 208,160
AW 209,162
AW 212,164
AW 213,166
AW 210,168
AW 211,170
AW 214,172
AW 215,174
v_pk_mul_f32 v[176:177], v[176:177], v[0:1] op_sel_hi:[1,0]
v_pk_mul_f32 v[178:179], v[178:179], v[0:1] op_sel_hi:[1,0]
v_pk_mul_f32 v[180:181], v[180:181], v[0:1] op_sel:[0,1]
v_pk_mul_f32 v[182:183], v[182:183], v[0:1] op_sel:[0,1]
v_pk_mul_f32 v[184:185], v[184:185], v[0:1] op_sel_hi:[1,0]
v_pk_mul_f32 v[186:187], v[186:187], v[0:1] op_sel_hi:[1,0]
v_pk_mul_f32 v[188:189], v[188:189], v[0:1] op_sel:[0,1]
v_pk_mul_f32 v[190:191], v[190:191], v[0:1] op_sel:[0,1]
CV 176,176
CV 178,178
CV 180,180
CV 182,182
CV 184,184
CV 186,186
CV 188,188
CV 190,190
AW 216,176
AW 217,178
AW 220,180
AW 221,182
AW 218,184
AW 219,186
AW 222,188
AW 223,190
v_mov_b32 v60, v120
v_mov_b32 v61, v124
v_cmp_nle_f32 vcc, s76, v60
v_cmp_nge_f32 s[82:83], s77, v60
v_cmp_nle_f32 s[84:85], s76, v61
v_cmp_nge_f32 s[90:91], s77, v61
s_nop 1
s_or_b64 vcc, vcc, s[82:83]
s_or_b64 vcc, vcc, s[84:85]
s_or_b64 vcc, vcc, s[90:91]
s_cbranch_scc1 L_slow_c1A1
L_back_c1A1:
v_rcp_f32 v0, v60
v_rcp_f32 v1, v61
s_nop 0
v_pk_mul_f32 v[192:193], v[192:193], v[0:1] op_sel_hi:[1,0]
v_pk_mul_f32 v[194:195], v[194:195], v[0:1] op_sel_hi:[1,0]
v_pk_mul_f32 v[196:197], v[196:197], v[0:1] op_sel:[0,1]
v_pk_mul_f32 v[198:199], v[198:199], v[0:1] op_sel:[0,1]
v_pk_mul_f32 v[200:201], v[200:201], v[0:1] op_sel_hi:[1,0]
v_pk_mul_f32 v[202:203], v[202:203], v[0:1] op_sel_hi:[1,0]
v_pk_mul_f32 v[204:205], v[204:205], v[0:1] op_sel:[0,1]
v_pk_mul_f32 v[206:207], v[206:207], v[0:1] op_sel:[0,1]
CV 192,192
CV 194,194
CV 196,196
CV 198,198
CV 200,200
CV 202,202
CV 204,204
CV 206,206
AW 224,192
AW 225,194
AW 228,196
AW 229,198
AW 226,200
AW 227,202
AW 230,204
AW 231,206
v_pk_mul_f32 v[208:209], v[208:209], v[0:1] op_sel_hi:[1,0]
v_pk_mul_f32 v[210:211], v[210:211], v[0:1] op_sel_hi:[1,0]
v_pk_mul_f32 v[212:213], v[212:213], v[0:1] op_sel:[0,1]
v_pk_mul_f32 v[214:215], v[214:215], v[0:1] op_sel:[0,1]
v_pk_mul_f32 v[216:217], v[216:217], v[0:1] op_sel_hi:[1,0]
v_pk_mul_f32 v[218:219], v[218:219], v[0:1] op_sel_hi:[1,0]
v_pk_mul_f32 v[220:221], v[220:221], v[0:1] op_sel:[0,1]
v_pk_mul_f32 v[222:223], v[222:223], v[0:1] op_sel:[0,1]
CV 208,208
CV 210,210
CV 212,212
CV 214,214
CV 216,216
CV 218,218
CV 220,220
CV 222,222
AW 232,208
AW 233,210
AW 236,212
AW 237,214
AW 234,216
AW 235,218
AW 238,220
AW 239,222
v_pk_mul_f32 v[224:225], v[224:225], v[0:1] op_sel_hi:[1,0]
v_pk_mul_f32 v[226:227], v[226:227], v[0:1] op_sel_hi:[1,0]
v_pk_mul_f32 v[228:229], v[228:229], v[0:1] op_sel:[0,1]
v_pk_mul_f32 v[230:231], v[230:231], v[0:1] op_sel:[0,1]
v_pk_mul_f32 v[232:233], v[232:233], v[0:1] op_sel_hi:[1,0]
v_pk_mul_f32 v[234:235], v[234:235], v[0:1] op_sel_hi:[1,0]
v_pk_mul_f32 v[236:237], v[236:237], v[0:1] op_sel:[0,1]
v_pk_mul_f32 v[238:239], v[238:239], v[0:1] op_sel:[0,1]
CV 224,224
CV 226,226
CV 228,228
CV 230,230
CV 232,232
CV 234,234
CV 236,236
CV 238,238
AW 240,224
AW 241,226
AW 244,228
AW 245,230
AW 242,232
AW 243,234
AW 246,236
AW 247,238
v_pk_mul_f32 v[240:241], v[240:241], v[0:1] op_sel_hi:[1,0]
v_pk_mul_f32 v[242:243], v[242:243], v[0:1] op_sel_hi:[1,0]
v_pk_mul_f32 v[244:245], v[244:245], v[0:1] op_sel:[0,1]
v_pk_mul_f32 v[246:247], v[246:247], v[0:1] op_sel:[0,1]
v_pk_mul_f32 v[248:249], v[248:249], v[0:1] op_sel_hi:[1,0]
v_pk_mul_f32 v[250:251], v[250:251], v[0:1] op_sel_hi:[1,0]
v_pk_mul_f32 v[252:253], v[252:253], v[0:1] op_sel:[0,1]
v_pk_mul_f32 v[254:255], v[254:255], v[0:1] op_sel:[0,1]
CV 240,240
CV 242,242
CV 244,244
CV 246,246
CV 248,248
CV 250,250
CV 252,252
CV 254,254
AW 248,240
AW 249,242
AW 252,244
AW 253,246
AW 250,248
AW 251,250
AW 254,252
AW 255,254
W 6
ZB 128,0,192
G 46,24,66,2
ZB 132,0,196
T 20,21,0
T 22,21,4
ds_write_b128 v58, a[192:195] offset:0
ZB 136,4,192
T 24,22,0
ZB 140,4,196
T 26,22,4
ds_write_b128 v58, a[196:199] offset:1024
W 8
ZB 144,8,192
G 47,24,66,3
ZB 148,8,196
T 28,23,0
T 30,23,4
ds_write_b128 v58, a[200:203] offset:2048
ZB 152,12,192
s_waitcnt vmcnt(26) lgkmcnt(0)
s_barrier
ZB 156,12,196
T 32,16,16
T 34,16,20
ds_write_b128 v58, a[204:207] offset:3072
ZB 160,16,192
T 36,17,16
ZB 164,16,196
T 38,17,20
ds_write_b128 v58, a[208:211] offset:4096
ZB 168,20,192
T 40,18,16
ZB 172,20,196
T 42,18,20
ds_write_b128 v58, a[212:215] offset:5120
ZB 176,24,192
T 44,19,16
ZB 180,24,196
T 46,19,20
ds_write_b128 v58, a[216:219] offset:6144
ZB 184,28,192
T 48,20,16
ZB 188,28,196
T 50,20,20
ds_write_b128 v58, a[220:223] offset:7168
W 10
MB 128,32,200
T 52,21,16
MB 132,32,204
T 54,21,20
MB 136,36,200
T 56,22,16
MB 140,36,204
T 58,22,20
W 8
MB 144,40,200
T 60,23,16
MB 148,40,204
T 62,23,20
MB 152,44,200
s_waitcnt vmcnt(22) lgkmcnt(6)
s_barrier
T 0,16,32
MB 156,44,204
T 2,16,36
R a,160,2,0
s_xor_b32 m0, s65, 0x1c000
s_xor_b32 s66, s62, 0x38000
MB 160,48,200
G 44,24,66,0
MB 164,48,204
T 4,17,32
T 6,17,36
R a,164,2,1
v_mov_b32 v61, 1
v_mov_b32 v62, 0
s_mov_b64 exec, 1
buffer_store_dword v61, v62, s[52:55], s5 offen offset:256 sc1
s_mov_b64 exec, -1
W 10
MB 168,52,200
T 8,18,32
MB 172,52,204
T 10,18,36
R a,168,2,2
W 9
MB 176,56,200
G 45,24,66,1
MB 180,56,204
T 12,19,32
T 14,19,36
R a,172,2,3
MB 184,60,200
T 16,20,32
MB 188,60,204
T 18,20,36
R a,176,2,4
W 10
MB 128,0,208
G 46,24,66,2
MB 132,0,212
T 20,21,32
T 22,21,36
R a,180,2,5
s_waitcnt vmcnt(8)
v_mov_b32 v61, 1
v_mov_b32 v62, 0
s_mov_b64 exec, 1
buffer_store_dword v61, v62, s[52:55], s5 offen offset:384 sc1
s_mov_b64 exec, -1
MB 136,4,208
T 24,22,32
MB 140,4,212
T 26,22,36
W 14
R a,184,2,6
W 10
MB 144,8,208
G 47,24,66,3
MB 148,8,212
T 28,23,32
T 30,23,36
R a,188,2,7
MB 152,12,208
s_barrier
T 32,16,48
MB 156,12,212
T 34,16,52
s_xor_b32 m0, s65, 0x0
s_xor_b32 s66, s62, 0x100
W 9
MB 160,16,208
G 44,24,66,0
MB 164,16,212
T 36,17,48
T 38,17,52
s_getpc_b64 s[88:89]
L_ct1_1923:
s_and_b32 s89, s89, 0xffff
s_mov_b32 s90, L_code_end-L_ct1_1923
s_mov_b32 s91, 0x20000
v_and_b32 v62, 0x70, v59
v_lshlrev_b32 v62, 3, v62
s_add_u32 s7, s1, 4096
buffer_load_dword v3, v62, s[88:91], s7 offen
MB 168,20,208
T 40,18,48
MB 172,20,212
T 42,18,52
W 7
MB 176,24,208
G 45,24,66,1
MB 180,24,212
T 44,19,48
T 46,19,52
MB 184,28,208
T 48,20,48
MB 188,28,212
T 50,20,52
W 6
MB 128,32,216
G 46,24,66,2
MB 132,32,220
T 52,21,48
T 54,21,52
MB 136,36,216
T 56,22,48
MB 140,36,220
T 58,22,52
W 6
MB 144,40,216
G 47,24,66,3
MB 148,40,220
T 60,23,48
T 62,23,52
MB 152,44,216
s_barrier
T 0,24,0
MB 156,44,220
T 2,24,4
s_xor_b32 m0, s65, 0x4000
s_xor_b32 s66, s62, 0x8100
W 6
MB 160,48,216
G 44,24,66,0
MB 164,48,220
T 4,25,0
T 6,25,4
MB 168,52,216
T 8,26,0
MB 172,52,220
T 10,26,4
W 6
MB 176,56,216
G 45,24,66,1
MB 180,56,220
T 12,27,0
T 14,27,4
MB 184,60,216
T 16,28,0
MB 188,60,220
T 18,28,4
W 6
MB 128,0,160
G 46,24,66,2
MB 132,0,164
T 20,29,0
T 22,29,4
MB 136,4,160
T 24,30,0
MB 140,4,164
T 26,30,4
W 6
MB 144,8,160
G 47,24,66,3
MB 148,8,164
T 28,31,0
T 30,31,4
MB 152,12,160
s_barrier
T 32,24,16
MB 156,12,164
T 34,24,20
s_xor_b32 m0, s65, 0x8000
s_xor_b32 s66, s62, 0x10100
W 6
MB 160,16,160
G 44,24,66,0
MB 164,16,164
T 36,25,16
T 38,25,20
MB 168,20,160
T 40,26,16
MB 172,20,164
T 42,26,20
W 6
MB 176,24,160
G 45,24,66,1
MB 180,24,164
T 44,27,16
T 46,27,20
MB 184,28,160
T 48,28,16
MB 188,28,164
T 50,28,20
W 6
MB 128,32,168
G 46,24,66,2
MB 132,32,172
T 52,29,16
T 54,29,20
MB 136,36,168
T 56,30,16
MB 140,36,172
T 58,30,20
W 6
MB 144,40,168
G 47,24,66,3
MB 148,40,172
T 60,31,16
T 62,31,20
MB 152,44,168
s_waitcnt vmcnt(19)
s_barrier
T 0,24,32
MB 156,44,172
T 2,24,36
s_xor_b32 m0, s65, 0xc000
s_xor_b32 s66, s62, 0x18100
W 6
MB 160,48,168
G 44,24,66,0
MB 164,48,172
T 4,25,32
T 6,25,36
MB 168,52,168
T 8,26,32
MB 172,52,172
T 10,26,36
W 6
MB 176,56,168
G 45,24,66,1
MB 180,56,172
T 12,27,32
T 14,27,36
MB 184,60,168
T 16,28,32
MB 188,60,172
T 18,28,36
W 6
MB 128,0,176
G 46,24,66,2
MB 132,0,180
T 20,29,32
T 22,29,36
MB 136,4,176
T 24,30,32
MB 140,4,180
T 26,30,36
W 6
MB 144,8,176
G 47,24,66,3
MB 148,8,180
T 28,31,32
T 30,31,36
MB 152,12,176
s_waitcnt vmcnt(17)
s_barrier
T 32,24,48
MB 156,12,180
T 34,24,52
s_xor_b32 m0, s65, 0x10000
s_xor_b32 s66, s62, 0x20100
W 6
MB 160,16,176
G 44,24,66,0
MB 164,16,180
T 36,25,48
T 38,25,52
MB 168,20,176
T 40,26,48
MB 172,20,180
T 42,26,52
W 6
MB 176,24,176
G 45,24,66,1
MB 180,24,180
T 44,27,48
T 46,27,52
MB 184,28,176
T 48,28,48
MB 188,28,180
T 50,28,52
W 6
MB 128,32,184
G 46,24,66,2
MB 132,32,188
T 52,29,48
T 54,29,52
MB 136,36,184
T 56,30,48
MB 140,36,188
T 58,30,52
W 6
MB 144,40,184
G 47,24,66,3
MB 148,40,188
T 60,31,48
T 62,31,52
MB 152,44,184
s_waitcnt vmcnt(16)
s_barrier
T 0,16,0
MB 156,44,188
T 2,16,4
s_xor_b32 m0, s65, 0x14000
s_xor_b32 s66, s62, 0x28100
W 6
MB 160,48,184
G 44,24,66,0
MB 164,48,188
T 4,17,0
T 6,17,4
MB 168,52,184
T 8,18,0
MB 172,52,188
T 10,18,4
W 6
MB 176,56,184
G 45,24,66,1
MB 180,56,188
T 12,19,0
T 14,19,4
MB 184,60,184
T 16,20,0
MB 188,60,188
T 18,20,4
W 6
ZB 192,0,192
G 46,24,66,2
ZB 196,0,196
T 20,21,0
T 22,21,4
ZB 200,4,192
T 24,22,0
ZB 204,4,196
T 26,22,4
W 6
ZB 208,8,192
G 47,24,66,3
ZB 212,8,196
T 28,23,0
T 30,23,4
ZB 216,12,192
s_waitcnt vmcnt(16)
s_barrier
T 32,16,16
ZB 220,12,196
T 34,16,20
s_xor_b32 m0, s65, 0x18000
s_xor_b32 s66, s62, 0x30100
W 6
ZB 224,16,192
G 44,24,66,0
ZB 228,16,196
T 36,17,16
T 38,17,20
ZB 232,20,192
T 40,18,16
ZB 236,20,196
T 42,18,20
W 6
ZB 240,24,192
G 45,24,66,1
ZB 244,24,196
T 44,19,16
T 46,19,20
ZB 248,28,192
T 48,20,16
ZB 252,28,196
T 50,20,20
W 6
MB 192,32,200
G 46,24,66,2
MB 196,32,204
T 52,21,16
T 54,21,20
MB 200,36,200
T 56,22,16
MB 204,36,204
T 58,22,20
W 6
MB 208,40,200
G 47,24,66,3
MB 212,40,204
T 60,23,16
T 62,23,20
MB 216,44,200
s_waitcnt vmcnt(16)
s_barrier
T 0,16,32
MB 220,44,204
T 2,16,36
s_xor_b32 m0, s65, 0x1c000
s_xor_b32 s66, s62, 0x38100
W 6
MB 224,48,200
G 44,24,66,0
MB 228,48,204
T 4,17,32
T 6,17,36
MB 232,52,200
T 8,18,32
MB 236,52,204
T 10,18,36
W 6
MB 240,56,200
G 45,24,66,1
MB 244,56,204
T 12,19,32
T 14,19,36
MB 248,60,200
T 16,20,32
MB 252,60,204
T 18,20,36
W 6
MB 192,0,208
G 46,24,66,2
MB 196,0,212
T 20,21,32
T 22,21,36
MB 200,4,208
T 24,22,32
MB 204,4,212
T 26,22,36
W 6
MB 208,8,208
G 47,24,66,3
MB 212,8,212
T 28,23,32
T 30,23,36
MB 216,12,208
s_waitcnt vmcnt(16)
s_barrier
T 32,16,48
MB 220,12,212
T 34,16,52
s_xor_b32 m0, s65, 0x0
s_xor_b32 s66, s62, 0x40000
W 6
MB 224,16,208
G 44,24,66,0
MB 228,16,212
T 36,17,48
T 38,17,52
MB 232,20,208
T 40,18,48
MB 236,20,212
T 42,18,52
W 6
MB 240,24,208
G 45,24,66,1
MB 244,24,212
T 44,19,48
T 46,19,52
MB 248,28,208
T 48,20,48
MB 252,28,212
T 50,20,52
W 6
MB 192,32,216
G 46,24,66,2
MB 196,32,220
T 52,21,48
T 54,21,52
v_mov_b32 v62, 0
buffer_load_dword v4, v62, s[96:99], s87 offen sc1
MB 200,36,216
T 56,22,48
MB 204,36,220
T 58,22,52
W 6
MB 208,40,216
G 47,24,66,3
MB 212,40,220
T 60,23,48
T 62,23,52
MB 216,44,216
s_waitcnt vmcnt(17)
s_barrier
T 0,24,0
MB 220,44,220
T 2,24,4
s_xor_b32 m0, s65, 0x4000
s_xor_b32 s66, s62, 0x48000
W 6
MB 224,48,216
G 44,24,66,0
MB 228,48,220
T 4,25,0
T 6,25,4
MB 232,52,216
T 8,26,0
MB 236,52,220
T 10,26,4
W 6
MB 240,56,216
G 45,24,66,1
MB 244,56,220
T 12,27,0
T 14,27,4
MB 248,60,216
T 16,28,0
MB 252,60,220
T 18,28,4
W 6
MB 192,0,160
G 46,24,66,2
MB 196,0,164
T 20,29,0
T 22,29,4
MB 200,4,160
T 24,30,0
MB 204,4,164
T 26,30,4
W 6
MB 208,8,160
G 47,24,66,3
MB 212,8,164
T 28,31,0
T 30,31,4
MB 216,12,160
s_waitcnt vmcnt(17)
s_barrier
T 32,24,16
MB 220,12,164
T 34,24,20
s_xor_b32 m0, s65, 0x8000
s_xor_b32 s66, s62, 0x50000
W 6
MB 224,16,160
G 44,24,66,0
MB 228,16,164
T 36,25,16
T 38,25,20
MB 232,20,160
T 40,26,16
MB 236,20,164
T 42,26,20
W 6
MB 240,24,160
G 45,24,66,1
MB 244,24,164
T 44,27,16
T 46,27,20
MB 248,28,160
T 48,28,16
MB 252,28,164
T 50,28,20
W 6
MB 192,32,168
G 46,24,66,2
MB 196,32,172
T 52,29,16
T 54,29,20
MB 200,36,168
T 56,30,16
MB 204,36,172
T 58,30,20
W 6
MB 208,40,168
G 47,24,66,3
MB 212,40,172
T 60,31,16
T 62,31,20
MB 216,44,168
s_waitcnt vmcnt(17)
s_barrier
T 0,24,32
MB 220,44,172
T 2,24,36
s_xor_b32 m0, s65, 0xc000
s_xor_b32 s66, s62, 0x58000
W 6
MB 224,48,168
G 44,24,66,0
MB 228,48,172
T 4,25,32
T 6,25,36
MB 232,52,168
T 8,26,32
MB 236,52,172
T 10,26,36
W 6
MB 240,56,168
G 45,24,66,1
MB 244,56,172
T 12,27,32
T 14,27,36
MB 248,60,168
T 16,28,32
MB 252,60,172
T 18,28,36
W 6
MB 192,0,176
G 46,24,66,2
MB 196,0,180
T 20,29,32
T 22,29,36
MB 200,4,176
T 24,30,32
MB 204,4,180
T 26,30,36
W 6
MB 208,8,176
G 47,24,66,3
MB 212,8,180
T 28,31,32
T 30,31,36
MB 216,12,176
s_waitcnt vmcnt(17)
s_barrier
T 32,24,48
MB 220,12,180
T 34,24,52
s_xor_b32 m0, s65, 0x10000
s_xor_b32 s66, s62, 0x60000
W 6
MB 224,16,176
G 44,24,66,0
MB 228,16,180
T 36,25,48
T 38,25,52
MB 232,20,176
T 40,26,48
MB 236,20,180
T 42,26,52
W 6
MB 240,24,176
G 45,24,66,1
MB 244,24,180
T 44,27,48
T 46,27,52
MB 248,28,176
T 48,28,48
MB 252,28,180
T 50,28,52
W 6
MB 192,32,184
G 46,24,66,2
MB 196,32,188
T 52,29,48
T 54,29,52
MB 200,36,184
T 56,30,48
MB 204,36,188
T 58,30,52
W 6
MB 208,40,184
G 47,24,66,3
MB 212,40,188
T 60,31,48
T 62,31,52
MB 216,44,184
s_waitcnt vmcnt(16)
s_barrier
T 0,16,0
MB 220,44,188
T 2,16,4
s_xor_b32 m0, s65, 0x14000
s_xor_b32 s66, s62, 0x68000
W 6
MB 224,48,184
G 44,24,66,0
MB 228,48,188
T 4,17,0
T 6,17,4
MB 232,52,184
T 8,18,0
MB 236,52,188
T 10,18,4
W 6
MB 240,56,184
G 45,24,66,1
MB 244,56,188
T 12,19,0
T 14,19,4
MB 248,60,184
T 16,20,0
MB 252,60,188
T 18,20,4
W 6
MB 128,0,224
G 46,24,66,2
MB 132,0,228
T 20,21,0
T 22,21,4
ds_write_b128 v58, a[224:227] offset:0
s_and_b32 s7, s2, 7
v_bfe_u32 v7, v59, 4, 3
v_max_u32 v7, 1, v7
v_xor_b32 v7, s7, v7
v_lshlrev_b32 v7, 2, v7
MB 136,4,224
T 24,22,0
MB 140,4,228
T 26,22,4
ds_write_b128 v58, a[228:231] offset:1024
W 8
MB 144,8,224
G 47,24,66,3
MB 148,8,228
T 28,23,0
T 30,23,4
ds_write_b128 v58, a[232:235] offset:2048
v_and_b32 v6, 0xf0, v59
v_lshlrev_b32 v6, 7, v6
v_lshrrev_b32 v62, 8, v59
v_lshl_add_u32 v6, v62, 4, v6
MB 152,12,224
s_waitcnt vmcnt(16) lgkmcnt(0)
s_barrier
T 32,16,16
MB 156,12,228
T 34,16,20
ds_write_b128 v58, a[236:239] offset:3072
s_xor_b32 m0, s65, 0x18000
s_xor_b32 s66, s62, 0x70000
MB 160,16,224
G 44,24,66,0
MB 164,16,228
T 36,17,16
T 38,17,20
ds_write_b128 v58, a[240:243] offset:4096
MB 168,20,224
T 40,18,16
MB 172,20,228
T 42,18,20
ds_write_b128 v58, a[244:247] offset:5120
MB 176,24,224
G 45,24,66,1
MB 180,24,228
T 44,19,16
T 46,19,20
ds_write_b128 v58, a[248:251] offset:6144
MB 184,28,224
T 48,20,16
MB 188,28,228
T 50,20,20
ds_write_b128 v58, a[252:255] offset:7168
W 10
MB 128,32,232
G 46,24,66,2
MB 132,32,236
T 52,21,16
T 54,21,20
L_ci_c1:
v_cmp_gt_u32 vcc, 8, v4
s_nop 3
s_or_b64 vcc, vcc, vcc
s_cbranch_scc1 L_wi_c1
L_gi_c1:
MB 136,36,232
T 56,22,16
MB 140,36,236
T 58,22,20
W 8
MB 144,40,232
G 47,24,66,3
MB 148,40,236
T 60,23,16
T 62,23,20
MB 152,44,232
s_waitcnt vmcnt(16) lgkmcnt(6)
s_barrier
T 0,16,32
MB 156,44,236
T 2,16,36
R a,96,2,0
s_xor_b32 m0, s65, 0x1c000
s_xor_b32 s66, s62, 0x78000
MB 160,48,232
G 44,24,66,0
MB 164,48,236
T 4,17,32
T 6,17,36
R a,100,2,1
W 10
MB 168,52,232
T 8,18,32
MB 172,52,236
T 10,18,36
R a,104,2,2
W 9
MB 176,56,232
G 45,24,66,1
MB 180,56,236
T 12,19,32
T 14,19,36
R a,108,2,3
MB 184,60,232
T 16,20,32
MB 188,60,236
T 18,20,36
R a,112,2,4
W 10
MB 128,0,240
G 46,24,66,2
MB 132,0,244
T 20,21,32
T 22,21,36
R a,116,2,5
MB 136,4,240
T 24,22,32
MB 140,4,244
T 26,22,36
W 14
R a,120,2,6
W 10
MB 144,8,240
G 47,24,66,3
MB 148,8,244
T 28,23,32
T 30,23,36
R a,124,2,7
MB 152,12,240
s_waitcnt vmcnt(16)
s_barrier
T 32,16,48
MB 156,12,244
T 34,16,52
s_xor_b32 m0, s65, 0x0
s_xor_b32 s66, s62, 0x40100
W 9
MB 160,16,240
G 44,24,66,0
MB 164,16,244
T 36,17,48
T 38,17,52
MB 168,20,240
T 40,18,48
MB 172,20,244
T 42,18,52
W 7
MB 176,24,240
G 45,24,66,1
MB 180,24,244
T 44,19,48
T 46,19,52
MB 184,28,240
T 48,20,48
MB 188,28,244
T 50,20,52
W 6
MB 128,32,248
G 46,24,66,2
MB 132,32,252
T 52,21,48
T 54,21,52
buffer_load_dword v3, v7, s[52:55], s72 offen offset:256 sc1
buffer_load_dword v4, v7, s[52:55], s72 offen offset:384 sc1
MB 136,36,248
T 56,22,48
MB 140,36,252
T 58,22,52
W 6
MB 144,40,248
G 47,24,66,3
MB 148,40,252
T 60,23,48
T 62,23,52
MB 152,44,248
s_waitcnt vmcnt(18)
s_barrier
T 0,24,0
MB 156,44,252
T 2,24,4
s_xor_b32 m0, s65, 0x4000
s_xor_b32 s66, s62, 0x48100
W 6
MB 160,48,248
G 44,24,66,0
MB 164,48,252
T 4,25,0
T 6,25,4
MB 168,52,248
T 8,26,0
MB 172,52,252
T 10,26,4
W 6
MB 176,56,248
G 45,24,66,1
MB 180,56,252
T 12,27,0
T 14,27,4
MB 184,60,248
T 16,28,0
MB 188,60,252
T 18,28,4
W 6
MB 128,0,96
G 46,24,66,2
MB 132,0,100
T 20,29,0
T 22,29,4
MB 136,4,96
T 24,30,0
MB 140,4,100
T 26,30,4
W 6
MB 144,8,96
G 47,24,66,3
MB 148,8,100
T 28,31,0
T 30,31,4
MB 152,12,96
s_waitcnt vmcnt(18)
s_barrier
T 32,24,16
MB 156,12,100
T 34,24,20
s_xor_b32 m0, s65, 0x8000
s_xor_b32 s66, s62, 0x50100
W 6
MB 160,16,96
G 44,24,66,0
MB 164,16,100
T 36,25,16
T 38,25,20
MB 168,20,96
T 40,26,16
MB 172,20,100
T 42,26,20
W 6
MB 176,24,96
G 45,24,66,1
MB 180,24,100
T 44,27,16
T 46,27,20
MB 184,28,96
T 48,28,16
MB 188,28,100
T 50,28,20
W 6
MB 128,32,104
G 46,24,66,2
MB 132,32,108
T 52,29,16
T 54,29,20
MB 136,36,104
T 56,30,16
MB 140,36,108
T 58,30,20
W 6
MB 144,40,104
G 47,24,66,3
MB 148,40,108
T 60,31,16
T 62,31,20
MB 152,44,104
s_waitcnt vmcnt(18)
s_barrier
T 0,24,32
MB 156,44,108
T 2,24,36
s_xor_b32 m0, s65, 0xc000
s_xor_b32 s66, s62, 0x58100
W 6
MB 160,48,104
G 44,24,66,0
MB 164,48,108
T 4,25,32
T 6,25,36
MB 168,52,104
T 8,26,32
MB 172,52,108
T 10,26,36
W 6
MB 176,56,104
G 45,24,66,1
MB 180,56,108
T 12,27,32
T 14,27,36
MB 184,60,104
T 16,28,32
MB 188,60,108
T 18,28,36
W 6
MB 128,0,112
G 46,24,66,2
MB 132,0,116
T 20,29,32
T 22,29,36
MB 136,4,112
T 24,30,32
MB 140,4,116
T 26,30,36
W 6
MB 144,8,112
G 47,24,66,3
MB 148,8,116
T 28,31,32
T 30,31,36
MB 152,12,112
s_waitcnt vmcnt(18)
s_barrier
T 32,24,48
MB 156,12,116
T 34,24,52
s_xor_b32 m0, s65, 0x10000
s_xor_b32 s66, s62, 0x60100
W 6
MB 160,16,112
G 44,24,66,0
MB 164,16,116
T 36,25,48
T 38,25,52
MB 168,20,112
T 40,26,48
MB 172,20,116
T 42,26,52
W 6
MB 176,24,112
G 45,24,66,1
MB 180,24,116
T 44,27,48
T 46,27,52
MB 184,28,112
T 48,28,48
MB 188,28,116
T 50,28,52
W 6
MB 128,32,120
G 46,24,66,2
MB 132,32,124
T 52,29,48
T 54,29,52
MB 136,36,120
T 56,30,48
MB 140,36,124
T 58,30,52
W 6
MB 144,40,120
G 47,24,66,3
MB 148,40,124
T 60,31,48
T 62,31,52
MB 152,44,120
s_waitcnt vmcnt(16)
s_barrier
T 0,16,0
MB 156,44,124
T 2,16,4
s_xor_b32 m0, s65, 0x14000
s_xor_b32 s66, s62, 0x68100
W 6
MB 160,48,120
G 44,24,66,0
MB 164,48,124
T 4,17,0
T 6,17,4
MB 168,52,120
T 8,18,0
MB 172,52,124
T 10,18,4
W 6
MB 176,56,120
G 45,24,66,1
MB 180,56,124
T 12,19,0
T 14,19,4
MB 184,60,120
T 16,20,0
MB 188,60,124
T 18,20,4
W 6
MB 192,0,224
G 46,24,66,2
MB 196,0,228
T 20,21,0
T 22,21,4
MB 200,4,224
T 24,22,0
MB 204,4,228
T 26,22,4
W 6
MB 208,8,224
G 47,24,66,3
MB 212,8,228
T 28,23,0
T 30,23,4
MB 216,12,224
s_waitcnt vmcnt(16)
s_barrier
T 32,16,16
T 34,16,20
MB 220,12,228
CV 68,132
CV 69,134
CV 70,140
s_xor_b32 m0, s65, 0x18000
s_xor_b32 s66, s62, 0x70100
W 6
MB 224,16,224
G 44,24,66,0
T 36,17,16
T 38,17,20
MB 228,16,228
CV 71,142
s_xor_b32 s79, s67, 0x11000
buffer_store_dwordx4 v[68:71], v59, s[52:55], s79 offen sc1
MB 232,20,224
T 40,18,16
T 42,18,20
MB 236,20,228
CV 72,144
CV 73,146
CV 74,152
W 6
MB 240,24,224
G 45,24,66,1
T 44,19,16
T 46,19,20
MB 244,24,228
CV 75,154
s_xor_b32 s79, s67, 0x22000
buffer_store_dwordx4 v[72:75], v59, s[52:55], s79 offen sc1
MB 248,28,224
T 48,20,16
T 50,20,20
MB 252,28,228
CV 76,148
CV 77,150
CV 78,156
W 6
MB 192,32,232
G 46,24,66,2
T 52,21,16
T 54,21,20
MB 196,32,236
CV 79,158
s_xor_b32 s79, s67, 0x33000
buffer_store_dwordx4 v[76:79], v59, s[52:55], s79 offen sc1
L_ce_c1:
v_cmp_ne_u32 vcc, 1, v3
v_cmp_ne_u32 s[82:83], 1, v4
s_nop 3
s_or_b64 vcc, vcc, s[82:83]
s_cbranch_scc1 L_we_c1
L_ge_c1:
MB 200,36,232
T 56,22,16
T 58,22,20
MB 204,36,236
CV 80,160
CV 81,162
CV 82,168
W 6
MB 208,40,232
G 47,24,66,3
T 60,23,16
T 62,23,20
MB 212,40,236
CV 83,170
s_xor_b32 s79, s67, 0x44000
buffer_store_dwordx4 v[80:83], v59, s[52:55], s79 offen sc1
MB 216,44,232
s_waitcnt vmcnt(20)
s_barrier
T 0,16,32
T 2,16,36
MB 220,44,236
CV 84,164
CV 85,166
CV 86,172
s_xor_b32 m0, s65, 0x1c000
s_xor_b32 s66, s62, 0x78100
W 6
MB 224,48,232
G 44,24,66,0
T 4,17,32
T 6,17,36
MB 228,48,236
CV 87,174
s_xor_b32 s79, s67, 0x55000
buffer_store_dwordx4 v[84:87], v59, s[52:55], s79 offen sc1
MB 232,52,232
T 8,18,32
T 10,18,36
MB 236,52,236
CV 88,176
CV 89,178
CV 90,184
W 6
MB 240,56,232
G 45,24,66,1
T 12,19,32
T 14,19,36
MB 244,56,236
CV 91,186
s_xor_b32 s79, s67, 0x66000
buffer_store_dwordx4 v[88:91], v59, s[52:55], s79 offen sc1
MB 248,60,232
T 16,20,32
T 18,20,36
MB 252,60,236
CV 92,180
CV 93,182
CV 94,188
W 6
MB 192,0,240
G 46,24,66,2
T 20,21,32
T 22,21,36
MB 196,0,244
CV 95,190
s_xor_b32 s79, s67, 0x77000
buffer_store_dwordx4 v[92:95], v59, s[52:55], s79 offen sc1
MB 200,4,240
T 24,22,32
T 26,22,36
MB 204,4,244
CV 64,128
CV 65,130
W 6
MB 208,8,240
G 47,24,66,3
T 28,23,32
MB 212,8,244
T 30,23,36
CV 66,136
CV 67,138
MB 216,12,240
s_waitcnt vmcnt(23)
s_barrier
MB 220,12,244
T 32,16,48
T 34,16,52
W 6
MB 224,16,240
s_xor_b32 s80, s67, 0x1001000
buffer_load_dwordx4 v[132:135], v59, s[52:55], s80 offen sc1
MB 228,16,244
T 36,17,48
T 38,17,52
MB 232,20,240
T 40,18,48
MB 236,20,244
T 42,18,52
W 6
MB 240,24,240
T 44,19,48
MB 244,24,244
T 46,19,52
MB 248,28,240
T 48,20,48
MB 252,28,244
T 50,20,52
W 6
MB 192,32,248
T 52,21,48
MB 196,32,252
T 54,21,52
MB 200,36,248
T 56,22,48
MB 204,36,252
T 58,22,52
W 6
MB 208,40,248
s_xor_b32 s80, s67, 0x1002000
buffer_load_dwordx4 v[136:139], v59, s[52:55], s80 offen sc1
MB 212,40,252
T 60,23,48
T 62,23,52
MB 216,44,248
s_waitcnt vmcnt(21)
s_barrier
MB 220,44,252
T 0,24,0
T 2,24,4
W 6
MB 224,48,248
T 4,25,0
MB 228,48,252
T 6,25,4
MB 232,52,248
T 8,26,0
MB 236,52,252
T 10,26,4
W 6
MB 240,56,248
T 12,27,0
MB 244,56,252
T 14,27,4
MB 248,60,248
T 16,28,0
MB 252,60,252
T 18,28,4
W 6
MB 192,0,96
s_xor_b32 s80, s67, 0x1003000
buffer_load_dwordx4 v[140:143], v59, s[52:55], s80 offen sc1
MB 196,0,100
T 20,29,0
T 22,29,4
MB 200,4,96
T 24,30,0
MB 204,4,100
T 26,30,4
W 6
MB 208,8,96
T 28,31,0
MB 212,8,100
T 30,31,4
MB 216,12,96
s_waitcnt vmcnt(18)
s_barrier
MB 220,12,100
T 32,24,16
T 34,24,20
W 6
MB 224,16,96
T 36,25,16
MB 228,16,100
T 38,25,20
MB 232,20,96
T 40,26,16
MB 236,20,100
T 42,26,20
W 6
MB 240,24,96
s_xor_b32 s80, s67, 0x1004000
buffer_load_dwordx4 v[144:147], v59, s[52:55], s80 offen sc1
MB 244,24,100
T 44,27,16
T 46,27,20
MB 248,28,96
T 48,28,16
MB 252,28,100
T 50,28,20
W 6
MB 192,32,104
T 52,29,16
MB 196,32,108
T 54,29,20
MB 200,36,104
T 56,30,16
MB 204,36,108
T 58,30,20
W 6
MB 208,40,104
T 60,31,16
MB 212,40,108
T 62,31,20
MB 216,44,104
s_waitcnt vmcnt(12)
s_barrier
MB 220,44,108
T 0,24,32
T 2,24,36
W 6
MB 224,48,104
T 4,25,32
MB 228,48,108
T 6,25,36
MB 232,52,104
s_xor_b32 s80, s67, 0x1005000
buffer_load_dwordx4 v[148:151], v59, s[52:55], s80 offen sc1
MB 236,52,108
T 8,26,32
T 10,26,36
W 6
MB 240,56,104
T 12,27,32
MB 244,56,108
T 14,27,36
MB 248,60,104
T 16,28,32
MB 252,60,108
T 18,28,36
W 6
MB 192,0,112
T 20,29,32
MB 196,0,116
T 22,29,36
MB 200,4,112
T 24,30,32
MB 204,4,116
T 26,30,36
W 6
MB 208,8,112
T 28,31,32
MB 212,8,116
T 30,31,36
MB 216,12,112
s_waitcnt vmcnt(5)
s_barrier
s_xor_b32 s80, s67, 0x1006000
MB 220,12,116
buffer_load_dwordx4 v[152:155], v59, s[52:55], s80 offen sc1
T 32,24,48
T 34,24,52
W 6
MB 224,16,112
T 36,25,48
MB 228,16,116
T 38,25,52
MB 232,20,112
T 40,26,48
MB 236,20,116
T 42,26,52
W 6
MB 240,24,112
T 44,27,48
MB 244,24,116
T 46,27,52
MB 248,28,112
T 48,28,48
MB 252,28,116
T 50,28,52
W 6
MB 192,32,120
T 52,29,48
MB 196,32,124
T 54,29,52
MB 200,36,120
s_xor_b32 s80, s67, 0x1007000
buffer_load_dwordx4 v[156:159], v59, s[52:55], s80 offen sc1
MB 204,36,124
T 56,30,48
T 58,30,52
W 6
MB 208,40,120
T 60,31,48
MB 212,40,124
T 62,31,52
MB 216,44,120
MB 220,44,124
W 4
MB 224,48,120
MB 228,48,124
MB 232,52,120
MB 236,52,124
W 0
MB 240,56,120
MB 244,56,124
v_mov_b32 v61, 1
v_mov_b32 v62, 0
s_mov_b64 exec, 1
buffer_store_dword v61, v62, s[52:55], s5 offen offset:0 sc1
s_mov_b64 exec, -1
MB 248,60,120
MB 252,60,124
CV 100,196
CV 101,198
CV 102,204
CV 103,206
s_xor_b32 s79, s67, 0x19000
buffer_store_dwordx4 v[100:103], v59, s[52:55], s79 offen sc1
CV 104,208
CV 105,210
CV 106,216
CV 107,218
s_xor_b32 s79, s67, 0x2a000
buffer_store_dwordx4 v[104:107], v59, s[52:55], s79 offen sc1
CV 108,212
CV 109,214
CV 110,220
CV 111,222
s_xor_b32 s79, s67, 0x3b000
buffer_store_dwordx4 v[108:111], v59, s[52:55], s79 offen sc1
CV 112,224
CV 113,226
CV 114,232
CV 115,234
s_xor_b32 s79, s67, 0x4c000
buffer_store_dwordx4 v[112:115], v59, s[52:55], s79 offen sc1
CV 116,228
CV 117,230
CV 118,236
CV 119,238
s_xor_b32 s79, s67, 0x5d000
buffer_store_dwordx4 v[116:119], v59, s[52:55], s79 offen sc1
CV 120,240
CV 121,242
CV 122,248
CV 123,250
s_xor_b32 s79, s67, 0x6e000
buffer_store_dwordx4 v[120:123], v59, s[52:55], s79 offen sc1
CV 124,244
CV 125,246
CV 126,252
CV 127,254
s_xor_b32 s79, s67, 0x7f000
buffer_store_dwordx4 v[124:127], v59, s[52:55], s79 offen sc1
CV 96,192
CV 97,194
CV 98,200
CV 99,202
buffer_load_dword v0, v7, s[52:55], s72 offen offset:0 sc1
UP 68,36
UH 69,36
UP 70,37
UH 71,37
UP 72,38
UH 73,38
UP 74,39
UH 75,39
s_waitcnt vmcnt(15)
UP 76,132
UH 77,132
UP 78,133
UH 79,133
UP 80,134
UH 81,134
UP 82,135
UH 83,135
PA 68,76
PA 70,78
PA 72,80
PA 74,82
s_waitcnt vmcnt(14)
UP 76,136
UH 77,136
UP 78,137
UH 79,137
UP 80,138
UH 81,138
UP 82,139
UH 83,139
PA 68,76
PA 70,78
PA 72,80
PA 74,82
s_waitcnt vmcnt(13)
UP 76,140
UH 77,140
UP 78,141
UH 79,141
UP 80,142
UH 81,142
UP 82,143
UH 83,143
PA 68,76
PA 70,78
PA 72,80
PA 74,82
s_waitcnt vmcnt(12)
UP 76,144
UH 77,144
UP 78,145
UH 79,145
UP 80,146
UH 81,146
UP 82,147
UH 83,147
PA 68,76
PA 70,78
PA 72,80
PA 74,82
s_waitcnt vmcnt(11)
UP 76,148
UH 77,148
UP 78,149
UH 79,149
UP 80,150
UH 81,150
UP 82,151
UH 83,151
PA 68,76
PA 70,78
PA 72,80
PA 74,82
s_waitcnt vmcnt(10)
UP 76,152
UH 77,152
UP 78,153
UH 79,153
UP 80,154
UH 81,154
UP 82,155
UH 83,155
PA 68,76
PA 70,78
PA 72,80
PA 74,82
s_waitcnt vmcnt(9)
UP 76,156
UH 77,156
UP 78,157
UH 79,157
UP 80,158
UH 81,158
UP 82,159
UH 83,159
PA 68,76
PA 70,78
PA 72,80
PA 74,82
CV 128,68
CV 129,70
CV 130,72
CV 131,74
s_nop 0
v_permlane32_swap_b32 v128, v130
v_permlane32_swap_b32 v129, v131
s_nop 0
v_permlane16_swap_b32 v128, v130
v_permlane16_swap_b32 v129, v131
s_xor_b32 s80, s4, 0x400
buffer_store_dwordx4 v[128:131], v6, s[56:59], s80 offen
s_waitcnt vmcnt(2)
v_mov_b32 v61, 1
v_mov_b32 v62, 0
s_mov_b64 exec, 1
buffer_store_dword v61, v62, s[52:55], s5 offen offset:128 sc1
s_mov_b64 exec, -1
s_xor_b32 s80, s67, 0x1009000
buffer_load_dwordx4 v[164:167], v59, s[52:55], s80 offen sc1
s_xor_b32 s80, s67, 0x100a000
buffer_load_dwordx4 v[168:171], v59, s[52:55], s80 offen sc1
s_xor_b32 s80, s67, 0x100b000
buffer_load_dwordx4 v[172:175], v59, s[52:55], s80 offen sc1
s_xor_b32 s80, s67, 0x100c000
buffer_load_dwordx4 v[176:179], v59, s[52:55], s80 offen sc1
s_xor_b32 s80, s67, 0x100d000
buffer_load_dwordx4 v[180:183], v59, s[52:55], s80 offen sc1
s_xor_b32 s80, s67, 0x100e000
buffer_load_dwordx4 v[184:187], v59, s[52:55], s80 offen sc1
s_xor_b32 s80, s67, 0x100f000
buffer_load_dwordx4 v[188:191], v59, s[52:55], s80 offen sc1
L_cm_c1:
s_waitcnt vmcnt(9)
v_cmp_ne_u32 vcc, 1, v0
s_nop 3
s_or_b64 vcc, vcc, vcc
s_cbranch_scc1 L_wm_c1
L_gm_c1:
s_xor_b32 s80, s67, 0x1000
buffer_load_dwordx4 v[196:199], v59, s[52:55], s80 offen sc1
s_xor_b32 s80, s67, 0x2000
buffer_load_dwordx4 v[200:203], v59, s[52:55], s80 offen sc1
s_xor_b32 s80, s67, 0x3000
buffer_load_dwordx4 v[204:207], v59, s[52:55], s80 offen sc1
s_xor_b32 s80, s67, 0x4000
buffer_load_dwordx4 v[208:211], v59, s[52:55], s80 offen sc1
s_xor_b32 s80, s67, 0x5000
buffer_load_dwordx4 v[212:215], v59, s[52:55], s80 offen sc1
s_xor_b32 s80, s67, 0x6000
buffer_load_dwordx4 v[216:219], v59, s[52:55], s80 offen sc1
s_xor_b32 s80, s67, 0x7000
buffer_load_dwordx4 v[220:223], v59, s[52:55], s80 offen sc1
buffer_load_dword v4, v7, s[52:55], s72 offen offset:128 sc1
UP 68,40
UH 69,40
UP 70,41
UH 71,41
UP 72,42
UH 73,42
UP 74,43
UH 75,43
s_waitcnt vmcnt(14)
UP 76,164
UH 77,164
UP 78,165
UH 79,165
UP 80,166
UH 81,166
UP 82,167
UH 83,167
PA 68,76
PA 70,78
PA 72,80
PA 74,82
s_waitcnt vmcnt(13)
UP 76,168
UH 77,168
UP 78,169
UH 79,169
UP 80,170
UH 81,170
UP 82,171
UH 83,171
PA 68,76
PA 70,78
PA 72,80
PA 74,82
s_waitcnt vmcnt(12)
UP 76,172
UH 77,172
UP 78,173
UH 79,173
UP 80,174
UH 81,174
UP 82,175
UH 83,175
PA 68,76
PA 70,78
PA 72,80
PA 74,82
s_waitcnt vmcnt(11)
UP 76,176
UH 77,176
UP 78,177
UH 79,177
UP 80,178
UH 81,178
UP 82,179
UH 83,179
PA 68,76
PA 70,78
PA 72,80
PA 74,82
s_waitcnt vmcnt(10)
UP 76,180
UH 77,180
UP 78,181
UH 79,181
UP 80,182
UH 81,182
UP 82,183
UH 83,183
PA 68,76
PA 70,78
PA 72,80
PA 74,82
s_waitcnt vmcnt(9)
UP 76,184
UH 77,184
UP 78,185
UH 79,185
UP 80,186
UH 81,186
UP 82,187
UH 83,187
PA 68,76
PA 70,78
PA 72,80
PA 74,82
s_waitcnt vmcnt(8)
UP 76,188
UH 77,188
UP 78,189
UH 79,189
UP 80,190
UH 81,190
UP 82,191
UH 83,191
PA 68,76
PA 70,78
PA 72,80
PA 74,82
CV 160,68
CV 161,70
CV 162,72
CV 163,74
s_nop 0
v_permlane32_swap_b32 v160, v162
v_permlane32_swap_b32 v161, v163
s_nop 0
v_permlane16_swap_b32 v160, v162
v_permlane16_swap_b32 v161, v163
s_xor_b32 s80, s4, 0x500
buffer_store_dwordx4 v[160:163], v6, s[56:59], s80 offen
L_cl_c1:
s_waitcnt vmcnt(1)
v_cmp_ne_u32 vcc, 1, v4
s_nop 3
s_or_b64 vcc, vcc, vcc
s_cbranch_scc1 L_wl_c1
L_gl_c1:
s_xor_b32 s80, s67, 0x9000
buffer_load_dwordx4 v[228:231], v59, s[52:55], s80 offen sc1
s_xor_b32 s80, s67, 0xa000
buffer_load_dwordx4 v[232:235], v59, s[52:55], s80 offen sc1
s_xor_b32 s80, s67, 0xb000
buffer_load_dwordx4 v[236:239], v59, s[52:55], s80 offen sc1
s_xor_b32 s80, s67, 0xc000
buffer_load_dwordx4 v[240:243], v59, s[52:55], s80 offen sc1
s_xor_b32 s80, s67, 0xd000
buffer_load_dwordx4 v[244:247], v59, s[52:55], s80 offen sc1
s_xor_b32 s80, s67, 0xe000
buffer_load_dwordx4 v[248:251], v59, s[52:55], s80 offen sc1
s_xor_b32 s80, s67, 0xf000
buffer_load_dwordx4 v[252:255], v59, s[52:55], s80 offen sc1
UP 68,64
UH 69,64
UP 70,65
UH 71,65
UP 72,66
UH 73,66
UP 74,67
UH 75,67
UP 76,196
UH 77,196
UP 78,197
UH 79,197
UP 80,198
UH 81,198
UP 82,199
UH 83,199
PA 68,76
PA 70,78
PA 72,80
PA 74,82
UP 76,200
UH 77,200
UP 78,201
UH 79,201
UP 80,202
UH 81,202
UP 82,203
UH 83,203
PA 68,76
PA 70,78
PA 72,80
PA 74,82
UP 76,204
UH 77,204
UP 78,205
UH 79,205
UP 80,206
UH 81,206
UP 82,207
UH 83,207
PA 68,76
PA 70,78
PA 72,80
PA 74,82
UP 76,208
UH 77,208
UP 78,209
UH 79,209
UP 80,210
UH 81,210
UP 82,211
UH 83,211
PA 68,76
PA 70,78
PA 72,80
PA 74,82
UP 76,212
UH 77,212
UP 78,213
UH 79,213
UP 80,214
UH 81,214
UP 82,215
UH 83,215
PA 68,76
PA 70,78
PA 72,80
PA 74,82
UP 76,216
UH 77,216
UP 78,217
UH 79,217
UP 80,218
UH 81,218
UP 82,219
UH 83,219
PA 68,76
PA 70,78
PA 72,80
PA 74,82
UP 76,220
UH 77,220
UP 78,221
UH 79,221
UP 80,222
UH 81,222
UP 82,223
UH 83,223
PA 68,76
PA 70,78
PA 72,80
PA 74,82
CV 192,68
CV 193,70
CV 194,72
CV 195,74
s_nop 0
v_permlane32_swap_b32 v192, v194
v_permlane32_swap_b32 v193, v195
s_nop 0
v_permlane16_swap_b32 v192, v194
v_permlane16_swap_b32 v193, v195
s_xor_b32 s80, s4, 0x0
buffer_store_dwordx4 v[192:195], v6, s[56:59], s80 offen
UP 68,96
UH 69,96
UP 70,97
UH 71,97
UP 72,98
UH 73,98
UP 74,99
UH 75,99
s_waitcnt vmcnt(7)
UP 76,228
UH 77,228
UP 78,229
UH 79,229
UP 80,230
UH 81,230
UP 82,231
UH 83,231
PA 68,76
PA 70,78
PA 72,80
PA 74,82
s_waitcnt vmcnt(6)
UP 76,232
UH 77,232
UP 78,233
UH 79,233
UP 80,234
UH 81,234
UP 82,235
UH 83,235
PA 68,76
PA 70,78
PA 72,80
PA 74,82
s_waitcnt vmcnt(5)
UP 76,236
UH 77,236
UP 78,237
UH 79,237
UP 80,238
UH 81,238
UP 82,239
UH 83,239
PA 68,76
PA 70,78
PA 72,80
PA 74,82
s_waitcnt vmcnt(4)
UP 76,240
UH 77,240
UP 78,241
UH 79,241
UP 80,242
UH 81,242
UP 82,243
UH 83,243
PA 68,76
PA 70,78
PA 72,80
PA 74,82
s_waitcnt vmcnt(3)
UP 76,244
UH 77,244
UP 78,245
UH 79,245
UP 80,246
UH 81,246
UP 82,247
UH 83,247
PA 68,76
PA 70,78
PA 72,80
PA 74,82
s_waitcnt vmcnt(2)
UP 76,248
UH 77,248
UP 78,249
UH 79,249
UP 80,250
UH 81,250
UP 82,251
UH 83,251
PA 68,76
PA 70,78
PA 72,80
PA 74,82
s_waitcnt vmcnt(1)
UP 76,252
UH 77,252
UP 78,253
UH 79,253
UP 80,254
UH 81,254
UP 82,255
UH 83,255
PA 68,76
PA 70,78
PA 72,80
PA 74,82
CV 224,68
CV 225,70
CV 226,72
CV 227,74
s_nop 0
v_permlane32_swap_b32 v224, v226
v_permlane32_swap_b32 v225, v227
s_nop 0
v_permlane16_swap_b32 v224, v226
v_permlane16_swap_b32 v225, v227
s_xor_b32 s80, s4, 0x100
buffer_store_dwordx4 v[224:227], v6, s[56:59], s80 offen
s_endpgm
L_slow_c1B0:
s_waitcnt vmcnt(0) lgkmcnt(0)
s_nop 15
s_mov_b32 s93, m0
s_andn2_b32 s80, s63, 0x1ff00
s_xor_b32 s80, s80, 0x0
v_mov_b32 v62, 0xff800000
v_mov_b32 v63, 0xff800000
s_mov_b32 s94, s80
s_mov_b32 s81, 0
L_slow1_c1B0:
s_add_u32 m0, s78, 0
s_add_u32 s92, s94, 0
G 32,32,92,0
G 33,32,92,1
G 34,32,92,2
G 35,32,92,3
s_add_u32 m0, s78, 4096
s_add_u32 s92, s94, 512
G 32,32,92,0
G 33,32,92,1
G 34,32,92,2
G 35,32,92,3
s_waitcnt vmcnt(0)
v_and_b32 v0, 0x1fff, v8
v_add_u32 v0, s78, v0
R a,32,0,0
R a,48,0,4
v_and_b32 v0, 0x1fff, v9
v_add_u32 v0, s78, v0
R a,36,0,0
R a,52,0,4
v_and_b32 v0, 0x1fff, v10
v_add_u32 v0, s78, v0
R a,40,0,0
R a,56,0,4
v_and_b32 v0, 0x1fff, v11
v_add_u32 v0, s78, v0
R a,44,0,0
R a,60,0,4
W 7
ZB 64,32,64
ZB 68,32,68
W 5
MB 64,36,72
MB 68,36,76
W 3
MB 64,40,80
MB 68,40,84
W 1
MB 64,44,88
MB 68,44,92
ZB 72,48,64
ZB 76,48,68
MB 72,52,72
MB 76,52,76
MB 72,56,80
MB 76,56,84
W 0
MB 72,60,88
MB 76,60,92
v_max_f32 v62, v62, v64
v_max_f32 v62, v62, v65
v_max_f32 v62, v62, v66
v_max_f32 v62, v62, v67
v_max_f32 v63, v63, v68
v_max_f32 v63, v63, v69
v_max_f32 v63, v63, v70
v_max_f32 v63, v63, v71
v_max_f32 v62, v62, v72
v_max_f32 v62, v62, v73
v_max_f32 v62, v62, v74
v_max_f32 v62, v62, v75
v_max_f32 v63, v63, v76
v_max_f32 v63, v63, v77
v_max_f32 v63, v63, v78
v_max_f32 v63, v63, v79
s_or_b32 s81, s81, 0x7ffe8fff
s_add_u32 s81, s81, 1
s_and_b32 s81, s81, 0x17000
s_add_u32 s94, s80, s81
s_cmp_lg_u32 s81, 0
s_cbranch_scc1 L_slow1_c1B0
v_mov_b32 v1, v62
s_nop 1
v_permlane32_swap_b32 v1, v62
v_max_f32 v62, v62, v1
v_mov_b32 v1, v62
s_nop 1
v_permlane16_swap_b32 v1, v62
v_max_f32 v62, v62, v1
v_mov_b32 v1, v63
s_nop 1
v_permlane32_swap_b32 v1, v63
v_max_f32 v63, v63, v1
v_mov_b32 v1, v63
s_nop 1
v_permlane16_swap_b32 v1, v63
v_max_f32 v63, v63, v1
v_mov_b32 v60, 0
v_mov_b32 v61, 0
v_accvgpr_write_b32 a128, 0
v_accvgpr_write_b32 a129, 0
v_accvgpr_write_b32 a130, 0
v_accvgpr_write_b32 a131, 0
v_accvgpr_write_b32 a132, 0
v_accvgpr_write_b32 a133, 0
v_accvgpr_write_b32 a134, 0
v_accvgpr_write_b32 a135, 0
v_accvgpr_write_b32 a136, 0
v_accvgpr_write_b32 a137, 0
v_accvgpr_write_b32 a138, 0
v_accvgpr_write_b32 a139, 0
v_accvgpr_write_b32 a140, 0
v_accvgpr_write_b32 a141, 0
v_accvgpr_write_b32 a142, 0
v_accvgpr_write_b32 a143, 0
v_accvgpr_write_b32 a144, 0
v_accvgpr_write_b32 a145, 0
v_accvgpr_write_b32 a146, 0
v_accvgpr_write_b32 a147, 0
v_accvgpr_write_b32 a148, 0
v_accvgpr_write_b32 a149, 0
v_accvgpr_write_b32 a150, 0
v_accvgpr_write_b32 a151, 0
v_accvgpr_write_b32 a152, 0
v_accvgpr_write_b32 a153, 0
v_accvgpr_write_b32 a154, 0
v_accvgpr_write_b32 a155, 0
v_accvgpr_write_b32 a156, 0
v_accvgpr_write_b32 a157, 0
v_accvgpr_write_b32 a158, 0
v_accvgpr_write_b32 a159, 0
v_accvgpr_write_b32 a160, 0
v_accvgpr_write_b32 a161, 0
v_accvgpr_write_b32 a162, 0
v_accvgpr_write_b32 a163, 0
v_accvgpr_write_b32 a164, 0
v_accvgpr_write_b32 a165, 0
v_accvgpr_write_b32 a166, 0
v_accvgpr_write_b32 a167, 0
v_accvgpr_write_b32 a168, 0
v_accvgpr_write_b32 a169, 0
v_accvgpr_write_b32 a170, 0
v_accvgpr_write_b32 a171, 0
v_accvgpr_write_b32 a172, 0
v_accvgpr_write_b32 a173, 0
v_accvgpr_write_b32 a174, 0
v_accvgpr_write_b32 a175, 0
v_accvgpr_write_b32 a176, 0
v_accvgpr_write_b32 a177, 0
v_accvgpr_write_b32 a178, 0
v_accvgpr_write_b32 a179, 0
v_accvgpr_write_b32 a180, 0
v_accvgpr_write_b32 a181, 0
v_accvgpr_write_b32 a182, 0
v_accvgpr_write_b32 a183, 0
v_accvgpr_write_b32 a184, 0
v_accvgpr_write_b32 a185, 0
v_accvgpr_write_b32 a186, 0
v_accvgpr_write_b32 a187, 0
v_accvgpr_write_b32 a188, 0
v_accvgpr_write_b32 a189, 0
v_accvgpr_write_b32 a190, 0
v_accvgpr_write_b32 a191, 0
s_mov_b32 s94, s80
s_mov_b32 s81, 0
s_nop 4
L_slow2_c1B0:
s_add_u32 m0, s78, 0
s_add_u32 s92, s94, 0
G 32,32,92,0
G 33,32,92,1
G 34,32,92,2
G 35,32,92,3
s_add_u32 m0, s78, 4096
s_add_u32 s92, s94, 512
G 32,32,92,0
G 33,32,92,1
G 34,32,92,2
G 35,32,92,3
s_waitcnt vmcnt(0)
v_and_b32 v0, 0x1fff, v8
v_add_u32 v0, s78, v0
R a,32,0,0
R a,48,0,4
v_and_b32 v0, 0x1fff, v9
v_add_u32 v0, s78, v0
R a,36,0,0
R a,52,0,4
v_and_b32 v0, 0x1fff, v10
v_add_u32 v0, s78, v0
R a,40,0,0
R a,56,0,4
v_and_b32 v0, 0x1fff, v11
v_add_u32 v0, s78, v0
R a,44,0,0
R a,60,0,4
W 7
ZB 64,32,64
ZB 68,32,68
W 5
MB 64,36,72
MB 68,36,76
W 3
MB 64,40,80
MB 68,40,84
W 1
MB 64,44,88
MB 68,44,92
ZB 72,48,64
ZB 76,48,68
MB 72,52,72
MB 76,52,76
MB 72,56,80
MB 76,56,84
W 0
MB 72,60,88
MB 76,60,92
v_sub_f32 v64, v64, v62
v_sub_f32 v65, v65, v62
v_sub_f32 v66, v66, v62
v_sub_f32 v67, v67, v62
v_sub_f32 v68, v68, v63
v_sub_f32 v69, v69, v63
v_sub_f32 v70, v70, v63
v_sub_f32 v71, v71, v63
v_sub_f32 v72, v72, v62
v_sub_f32 v73, v73, v62
v_sub_f32 v74, v74, v62
v_sub_f32 v75, v75, v62
v_sub_f32 v76, v76, v63
v_sub_f32 v77, v77, v63
v_sub_f32 v78, v78, v63
v_sub_f32 v79, v79, v63
E 64
E 65
E 66
E 67
E 68
E 69
E 70
E 71
E 72
E 73
E 74
E 75
E 76
E 77
E 78
E 79
v_add_f32 v60, v60, v64
v_add_f32 v60, v60, v65
v_add_f32 v60, v60, v66
v_add_f32 v60, v60, v67
v_add_f32 v61, v61, v68
v_add_f32 v61, v61, v69
v_add_f32 v61, v61, v70
v_add_f32 v61, v61, v71
v_add_f32 v60, v60, v72
v_add_f32 v60, v60, v73
v_add_f32 v60, v60, v74
v_add_f32 v60, v60, v75
v_add_f32 v61, v61, v76
v_add_f32 v61, v61, v77
v_add_f32 v61, v61, v78
v_add_f32 v61, v61, v79
CV 96,64
CV 97,66
CV 100,68
CV 101,70
CV 98,72
CV 99,74
CV 102,76
CV 103,78
s_add_u32 m0, s78, 0
s_add_u32 s92, s94, 0
G 56,36,92,0
G 57,36,92,1
G 56,36,92,2
G 57,36,92,3
s_add_u32 m0, s78, 4096
s_add_u32 s92, s94, 512
G 56,36,92,0
G 57,36,92,1
G 56,36,92,2
G 57,36,92,3
s_waitcnt vmcnt(0)
v_and_b32 v0, 0x1fff, v16
v_add_u32 v0, s78, v0
T 32,0,0
T 34,0,4
v_and_b32 v0, 0x1fff, v17
v_add_u32 v0, s78, v0
T 36,0,0
T 38,0,4
v_and_b32 v0, 0x1fff, v18
v_add_u32 v0, s78, v0
T 40,0,0
T 42,0,4
v_and_b32 v0, 0x1fff, v19
v_add_u32 v0, s78, v0
T 44,0,0
T 46,0,4
v_and_b32 v0, 0x1fff, v20
v_add_u32 v0, s78, v0
T 48,0,0
T 50,0,4
v_and_b32 v0, 0x1fff, v21
v_add_u32 v0, s78, v0
T 52,0,0
T 54,0,4
v_and_b32 v0, 0x1fff, v22
v_add_u32 v0, s78, v0
T 56,0,0
T 58,0,4
v_and_b32 v0, 0x1fff, v23
v_add_u32 v0, s78, v0
T 60,0,0
W 14
T 62,0,4
W 14
MC 128,32,96
MC 132,32,100
W 12
MC 136,36,96
MC 140,36,100
W 10
MC 144,40,96
MC 148,40,100
W 8
MC 152,44,96
MC 156,44,100
W 6
MC 160,48,96
MC 164,48,100
W 4
MC 168,52,96
MC 172,52,100
W 2
MC 176,56,96
MC 180,56,100
W 0
MC 184,60,96
MC 188,60,100
s_nop 15
s_or_b32 s81, s81, 0x7ffe8fff
s_add_u32 s81, s81, 1
s_and_b32 s81, s81, 0x17000
s_add_u32 s94, s80, s81
s_cmp_lg_u32 s81, 0
s_cbranch_scc1 L_slow2_c1B0
v_mov_b32 v1, v60
s_nop 1
v_permlane32_swap_b32 v1, v60
v_add_f32 v60, v60, v1
v_mov_b32 v1, v60
s_nop 1
v_permlane16_swap_b32 v1, v60
v_add_f32 v60, v60, v1
v_mov_b32 v1, v61
s_nop 1
v_permlane32_swap_b32 v1, v61
v_add_f32 v61, v61, v1
v_mov_b32 v1, v61
s_nop 1
v_permlane16_swap_b32 v1, v61
v_add_f32 v61, v61, v1
s_mov_b32 m0, s93
s_nop 4
s_branch L_back_c1B0
L_slow_c1B1:
s_waitcnt vmcnt(0) lgkmcnt(0)
s_nop 15
s_mov_b32 s93, m0
s_andn2_b32 s80, s63, 0x1ff00
s_xor_b32 s80, s80, 0x40000
v_mov_b32 v62, 0xff800000
v_mov_b32 v63, 0xff800000
s_mov_b32 s94, s80
s_mov_b32 s81, 0
L_slow1_c1B1:
s_add_u32 m0, s78, 0
s_add_u32 s92, s94, 0
G 32,32,92,0
G 33,32,92,1
G 34,32,92,2
G 35,32,92,3
s_add_u32 m0, s78, 4096
s_add_u32 s92, s94, 512
G 32,32,92,0
G 33,32,92,1
G 34,32,92,2
G 35,32,92,3
s_waitcnt vmcnt(0)
v_and_b32 v0, 0x1fff, v8
v_add_u32 v0, s78, v0
R a,32,0,0
R a,48,0,4
v_and_b32 v0, 0x1fff, v9
v_add_u32 v0, s78, v0
R a,36,0,0
R a,52,0,4
v_and_b32 v0, 0x1fff, v10
v_add_u32 v0, s78, v0
R a,40,0,0
R a,56,0,4
v_and_b32 v0, 0x1fff, v11
v_add_u32 v0, s78, v0
R a,44,0,0
R a,60,0,4
W 7
ZB 64,32,96
ZB 68,32,100
W 5
MB 64,36,104
MB 68,36,108
W 3
MB 64,40,112
MB 68,40,116
W 1
MB 64,44,120
MB 68,44,124
ZB 72,48,96
ZB 76,48,100
MB 72,52,104
MB 76,52,108
MB 72,56,112
MB 76,56,116
W 0
MB 72,60,120
MB 76,60,124
v_max_f32 v62, v62, v64
v_max_f32 v62, v62, v65
v_max_f32 v62, v62, v66
v_max_f32 v62, v62, v67
v_max_f32 v63, v63, v68
v_max_f32 v63, v63, v69
v_max_f32 v63, v63, v70
v_max_f32 v63, v63, v71
v_max_f32 v62, v62, v72
v_max_f32 v62, v62, v73
v_max_f32 v62, v62, v74
v_max_f32 v62, v62, v75
v_max_f32 v63, v63, v76
v_max_f32 v63, v63, v77
v_max_f32 v63, v63, v78
v_max_f32 v63, v63, v79
s_or_b32 s81, s81, 0x7ffe8fff
s_add_u32 s81, s81, 1
s_and_b32 s81, s81, 0x17000
s_add_u32 s94, s80, s81
s_cmp_lg_u32 s81, 0
s_cbranch_scc1 L_slow1_c1B1
v_mov_b32 v1, v62
s_nop 1
v_permlane32_swap_b32 v1, v62
v_max_f32 v62, v62, v1
v_mov_b32 v1, v62
s_nop 1
v_permlane16_swap_b32 v1, v62
v_max_f32 v62, v62, v1
v_mov_b32 v1, v63
s_nop 1
v_permlane32_swap_b32 v1, v63
v_max_f32 v63, v63, v1
v_mov_b32 v1, v63
s_nop 1
v_permlane16_swap_b32 v1, v63
v_max_f32 v63, v63, v1
v_mov_b32 v60, 0
v_mov_b32 v61, 0
v_mov_b32 v128, 0
v_mov_b32 v129, 0
v_mov_b32 v130, 0
v_mov_b32 v131, 0
v_mov_b32 v132, 0
v_mov_b32 v133, 0
v_mov_b32 v134, 0
v_mov_b32 v135, 0
v_mov_b32 v136, 0
v_mov_b32 v137, 0
v_mov_b32 v138, 0
v_mov_b32 v139, 0
v_mov_b32 v140, 0
v_mov_b32 v141, 0
v_mov_b32 v142, 0
v_mov_b32 v143, 0
v_mov_b32 v144, 0
v_mov_b32 v145, 0
v_mov_b32 v146, 0
v_mov_b32 v147, 0
v_mov_b32 v148, 0
v_mov_b32 v149, 0
v_mov_b32 v150, 0
v_mov_b32 v151, 0
v_mov_b32 v152, 0
v_mov_b32 v153, 0
v_mov_b32 v154, 0
v_mov_b32 v155, 0
v_mov_b32 v156, 0
v_mov_b32 v157, 0
v_mov_b32 v158, 0
v_mov_b32 v159, 0
v_mov_b32 v160, 0
v_mov_b32 v161, 0
v_mov_b32 v162, 0
v_mov_b32 v163, 0
v_mov_b32 v164, 0
v_mov_b32 v165, 0
v_mov_b32 v166, 0
v_mov_b32 v167, 0
v_mov_b32 v168, 0
v_mov_b32 v169, 0
v_mov_b32 v170, 0
v_mov_b32 v171, 0
v_mov_b32 v172, 0
v_mov_b32 v173, 0
v_mov_b32 v174, 0
v_mov_b32 v175, 0
v_mov_b32 v176, 0
v_mov_b32 v177, 0
v_mov_b32 v178, 0
v_mov_b32 v179, 0
v_mov_b32 v180, 0
v_mov_b32 v181, 0
v_mov_b32 v182, 0
v_mov_b32 v183, 0
v_mov_b32 v184, 0
v_mov_b32 v185, 0
v_mov_b32 v186, 0
v_mov_b32 v187, 0
v_mov_b32 v188, 0
v_mov_b32 v189, 0
v_mov_b32 v190, 0
v_mov_b32 v191, 0
s_mov_b32 s94, s80
s_mov_b32 s81, 0
s_nop 4
L_slow2_c1B1:
s_add_u32 m0, s78, 0
s_add_u32 s92, s94, 0
G 32,32,92,0
G 33,32,92,1
G 34,32,92,2
G 35,32,92,3
s_add_u32 m0, s78, 4096
s_add_u32 s92, s94, 512
G 32,32,92,0
G 33,32,92,1
G 34,32,92,2
G 35,32,92,3
s_waitcnt vmcnt(0)
v_and_b32 v0, 0x1fff, v8
v_add_u32 v0, s78, v0
R a,32,0,0
R a,48,0,4
v_and_b32 v0, 0x1fff, v9
v_add_u32 v0, s78, v0
R a,36,0,0
R a,52,0,4
v_and_b32 v0, 0x1fff, v10
v_add_u32 v0, s78, v0
R a,40,0,0
R a,56,0,4
v_and_b32 v0, 0x1fff, v11
v_add_u32 v0, s78, v0
R a,44,0,0
R a,60,0,4
W 7
ZB 64,32,96
ZB 68,32,100
W 5
MB 64,36,104
MB 68,36,108
W 3
MB 64,40,112
MB 68,40,116
W 1
MB 64,44,120
MB 68,44,124
ZB 72,48,96
ZB 76,48,100
MB 72,52,104
MB 76,52,108
MB 72,56,112
MB 76,56,116
W 0
MB 72,60,120
MB 76,60,124
v_sub_f32 v64, v64, v62
v_sub_f32 v65, v65, v62
v_sub_f32 v66, v66, v62
v_sub_f32 v67, v67, v62
v_sub_f32 v68, v68, v63
v_sub_f32 v69, v69, v63
v_sub_f32 v70, v70, v63
v_sub_f32 v71, v71, v63
v_sub_f32 v72, v72, v62
v_sub_f32 v73, v73, v62
v_sub_f32 v74, v74, v62
v_sub_f32 v75, v75, v62
v_sub_f32 v76, v76, v63
v_sub_f32 v77, v77, v63
v_sub_f32 v78, v78, v63
v_sub_f32 v79, v79, v63
E 64
E 65
E 66
E 67
E 68
E 69
E 70
E 71
E 72
E 73
E 74
E 75
E 76
E 77
E 78
E 79
v_add_f32 v60, v60, v64
v_add_f32 v60, v60, v65
v_add_f32 v60, v60, v66
v_add_f32 v60, v60, v67
v_add_f32 v61, v61, v68
v_add_f32 v61, v61, v69
v_add_f32 v61, v61, v70
v_add_f32 v61, v61, v71
v_add_f32 v60, v60, v72
v_add_f32 v60, v60, v73
v_add_f32 v60, v60, v74
v_add_f32 v60, v60, v75
v_add_f32 v61, v61, v76
v_add_f32 v61, v61, v77
v_add_f32 v61, v61, v78
v_add_f32 v61, v61, v79
CV 96,64
CV 97,66
CV 100,68
CV 101,70
CV 98,72
CV 99,74
CV 102,76
CV 103,78
s_add_u32 m0, s78, 0
s_add_u32 s92, s94, 0
G 56,36,92,0
G 57,36,92,1
G 56,36,92,2
G 57,36,92,3
s_add_u32 m0, s78, 4096
s_add_u32 s92, s94, 512
G 56,36,92,0
G 57,36,92,1
G 56,36,92,2
G 57,36,92,3
s_waitcnt vmcnt(0)
v_and_b32 v0, 0x1fff, v16
v_add_u32 v0, s78, v0
T 32,0,0
T 34,0,4
v_and_b32 v0, 0x1fff, v17
v_add_u32 v0, s78, v0
T 36,0,0
T 38,0,4
v_and_b32 v0, 0x1fff, v18
v_add_u32 v0, s78, v0
T 40,0,0
T 42,0,4
v_and_b32 v0, 0x1fff, v19
v_add_u32 v0, s78, v0
T 44,0,0
T 46,0,4
v_and_b32 v0, 0x1fff, v20
v_add_u32 v0, s78, v0
T 48,0,0
T 50,0,4
v_and_b32 v0, 0x1fff, v21
v_add_u32 v0, s78, v0
T 52,0,0
T 54,0,4
v_and_b32 v0, 0x1fff, v22
v_add_u32 v0, s78, v0
T 56,0,0
T 58,0,4
v_and_b32 v0, 0x1fff, v23
v_add_u32 v0, s78, v0
T 60,0,0
W 14
T 62,0,4
W 14
MA 128,32,96
MA 132,32,100
W 12
MA 136,36,96
MA 140,36,100
W 10
MA 144,40,96
MA 148,40,100
W 8
MA 152,44,96
MA 156,44,100
W 6
MA 160,48,96
MA 164,48,100
W 4
MA 168,52,96
MA 172,52,100
W 2
MA 176,56,96
MA 180,56,100
W 0
MA 184,60,96
MA 188,60,100
s_nop 15
s_or_b32 s81, s81, 0x7ffe8fff
s_add_u32 s81, s81, 1
s_and_b32 s81, s81, 0x17000
s_add_u32 s94, s80, s81
s_cmp_lg_u32 s81, 0
s_cbranch_scc1 L_slow2_c1B1
v_mov_b32 v1, v60
s_nop 1
v_permlane32_swap_b32 v1, v60
v_add_f32 v60, v60, v1
v_mov_b32 v1, v60
s_nop 1
v_permlane16_swap_b32 v1, v60
v_add_f32 v60, v60, v1
v_mov_b32 v1, v61
s_nop 1
v_permlane32_swap_b32 v1, v61
v_add_f32 v61, v61, v1
v_mov_b32 v1, v61
s_nop 1
v_permlane16_swap_b32 v1, v61
v_add_f32 v61, v61, v1
s_mov_b32 m0, s93
s_nop 4
s_branch L_back_c1B1
L_slow_c1A0:
s_waitcnt vmcnt(0) lgkmcnt(0)
s_nop 15
s_mov_b32 s93, m0
s_andn2_b32 s80, s64, 0x1ff00
s_xor_b32 s80, s80, 0x0
v_mov_b32 v62, 0xff800000
v_mov_b32 v63, 0xff800000
s_mov_b32 s94, s80
s_mov_b32 s81, 0
L_slow1_c1A0:
s_add_u32 m0, s78, 0
s_add_u32 s92, s94, 0
G 32,12,92,0
G 33,12,92,1
G 34,12,92,2
G 35,12,92,3
s_add_u32 m0, s78, 4096
s_add_u32 s92, s94, 512
G 32,12,92,0
G 33,12,92,1
G 34,12,92,2
G 35,12,92,3
s_waitcnt vmcnt(0)
v_and_b32 v0, 0x1fff, v8
v_add_u32 v0, s78, v0
R a,32,0,0
R a,48,0,4
v_and_b32 v0, 0x1fff, v9
v_add_u32 v0, s78, v0
R a,36,0,0
R a,52,0,4
v_and_b32 v0, 0x1fff, v10
v_add_u32 v0, s78, v0
R a,40,0,0
R a,56,0,4
v_and_b32 v0, 0x1fff, v11
v_add_u32 v0, s78, v0
R a,44,0,0
R a,60,0,4
W 7
ZB 64,32,192
ZB 68,32,196
W 5
MB 64,36,200
MB 68,36,204
W 3
MB 64,40,208
MB 68,40,212
W 1
MB 64,44,216
MB 68,44,220
ZB 72,48,192
ZB 76,48,196
MB 72,52,200
MB 76,52,204
MB 72,56,208
MB 76,56,212
W 0
MB 72,60,216
MB 76,60,220
v_max_f32 v62, v62, v64
v_max_f32 v62, v62, v65
v_max_f32 v62, v62, v66
v_max_f32 v62, v62, v67
v_max_f32 v63, v63, v68
v_max_f32 v63, v63, v69
v_max_f32 v63, v63, v70
v_max_f32 v63, v63, v71
v_max_f32 v62, v62, v72
v_max_f32 v62, v62, v73
v_max_f32 v62, v62, v74
v_max_f32 v62, v62, v75
v_max_f32 v63, v63, v76
v_max_f32 v63, v63, v77
v_max_f32 v63, v63, v78
v_max_f32 v63, v63, v79
s_or_b32 s81, s81, 0x7ffe8fff
s_add_u32 s81, s81, 1
s_and_b32 s81, s81, 0x17000
s_add_u32 s94, s80, s81
s_cmp_lg_u32 s81, 0
s_cbranch_scc1 L_slow1_c1A0
v_mov_b32 v1, v62
s_nop 1
v_permlane32_swap_b32 v1, v62
v_max_f32 v62, v62, v1
v_mov_b32 v1, v62
s_nop 1
v_permlane16_swap_b32 v1, v62
v_max_f32 v62, v62, v1
v_mov_b32 v1, v63
s_nop 1
v_permlane32_swap_b32 v1, v63
v_max_f32 v63, v63, v1
v_mov_b32 v1, v63
s_nop 1
v_permlane16_swap_b32 v1, v63
v_max_f32 v63, v63, v1
v_mov_b32 v60, 0
v_mov_b32 v61, 0
v_mov_b32 v128, 0
v_mov_b32 v129, 0
v_mov_b32 v130, 0
v_mov_b32 v131, 0
v_mov_b32 v132, 0
v_mov_b32 v133, 0
v_mov_b32 v134, 0
v_mov_b32 v135, 0
v_mov_b32 v136, 0
v_mov_b32 v137, 0
v_mov_b32 v138, 0
v_mov_b32 v139, 0
v_mov_b32 v140, 0
v_mov_b32 v141, 0
v_mov_b32 v142, 0
v_mov_b32 v143, 0
v_mov_b32 v144, 0
v_mov_b32 v145, 0
v_mov_b32 v146, 0
v_mov_b32 v147, 0
v_mov_b32 v148, 0
v_mov_b32 v149, 0
v_mov_b32 v150, 0
v_mov_b32 v151, 0
v_mov_b32 v152, 0
v_mov_b32 v153, 0
v_mov_b32 v154, 0
v_mov_b32 v155, 0
v_mov_b32 v156, 0
v_mov_b32 v157, 0
v_mov_b32 v158, 0
v_mov_b32 v159, 0
v_mov_b32 v160, 0
v_mov_b32 v161, 0
v_mov_b32 v162, 0
v_mov_b32 v163, 0
v_mov_b32 v164, 0
v_mov_b32 v165, 0
v_mov_b32 v166, 0
v_mov_b32 v167, 0
v_mov_b32 v168, 0
v_mov_b32 v169, 0
v_mov_b32 v170, 0
v_mov_b32 v171, 0
v_mov_b32 v172, 0
v_mov_b32 v173, 0
v_mov_b32 v174, 0
v_mov_b32 v175, 0
v_mov_b32 v176, 0
v_mov_b32 v177, 0
v_mov_b32 v178, 0
v_mov_b32 v179, 0
v_mov_b32 v180, 0
v_mov_b32 v181, 0
v_mov_b32 v182, 0
v_mov_b32 v183, 0
v_mov_b32 v184, 0
v_mov_b32 v185, 0
v_mov_b32 v186, 0
v_mov_b32 v187, 0
v_mov_b32 v188, 0
v_mov_b32 v189, 0
v_mov_b32 v190, 0
v_mov_b32 v191, 0
s_mov_b32 s94, s80
s_mov_b32 s81, 0
s_nop 4
L_slow2_c1A0:
s_add_u32 m0, s78, 0
s_add_u32 s92, s94, 0
G 32,12,92,0
G 33,12,92,1
G 34,12,92,2
G 35,12,92,3
s_add_u32 m0, s78, 4096
s_add_u32 s92, s94, 512
G 32,12,92,0
G 33,12,92,1
G 34,12,92,2
G 35,12,92,3
s_waitcnt vmcnt(0)
v_and_b32 v0, 0x1fff, v8
v_add_u32 v0, s78, v0
R a,32,0,0
R a,48,0,4
v_and_b32 v0, 0x1fff, v9
v_add_u32 v0, s78, v0
R a,36,0,0
R a,52,0,4
v_and_b32 v0, 0x1fff, v10
v_add_u32 v0, s78, v0
R a,40,0,0
R a,56,0,4
v_and_b32 v0, 0x1fff, v11
v_add_u32 v0, s78, v0
R a,44,0,0
R a,60,0,4
W 7
ZB 64,32,192
ZB 68,32,196
W 5
MB 64,36,200
MB 68,36,204
W 3
MB 64,40,208
MB 68,40,212
W 1
MB 64,44,216
MB 68,44,220
ZB 72,48,192
ZB 76,48,196
MB 72,52,200
MB 76,52,204
MB 72,56,208
MB 76,56,212
W 0
MB 72,60,216
MB 76,60,220
v_sub_f32 v64, v64, v62
v_sub_f32 v65, v65, v62
v_sub_f32 v66, v66, v62
v_sub_f32 v67, v67, v62
v_sub_f32 v68, v68, v63
v_sub_f32 v69, v69, v63
v_sub_f32 v70, v70, v63
v_sub_f32 v71, v71, v63
v_sub_f32 v72, v72, v62
v_sub_f32 v73, v73, v62
v_sub_f32 v74, v74, v62
v_sub_f32 v75, v75, v62
v_sub_f32 v76, v76, v63
v_sub_f32 v77, v77, v63
v_sub_f32 v78, v78, v63
v_sub_f32 v79, v79, v63
E 64
E 65
E 66
E 67
E 68
E 69
E 70
E 71
E 72
E 73
E 74
E 75
E 76
E 77
E 78
E 79
v_add_f32 v60, v60, v64
v_add_f32 v60, v60, v65
v_add_f32 v60, v60, v66
v_add_f32 v60, v60, v67
v_add_f32 v61, v61, v68
v_add_f32 v61, v61, v69
v_add_f32 v61, v61, v70
v_add_f32 v61, v61, v71
v_add_f32 v60, v60, v72
v_add_f32 v60, v60, v73
v_add_f32 v60, v60, v74
v_add_f32 v60, v60, v75
v_add_f32 v61, v61, v76
v_add_f32 v61, v61, v77
v_add_f32 v61, v61, v78
v_add_f32 v61, v61, v79
CV 96,64
CV 97,66
CV 100,68
CV 101,70
CV 98,72
CV 99,74
CV 102,76
CV 103,78
s_add_u32 m0, s78, 0
s_add_u32 s92, s94, 0
G 56,16,92,0
G 57,16,92,1
G 56,16,92,2
G 57,16,92,3
s_add_u32 m0, s78, 4096
s_add_u32 s92, s94, 512
G 56,16,92,0
G 57,16,92,1
G 56,16,92,2
G 57,16,92,3
s_waitcnt vmcnt(0)
v_and_b32 v0, 0x1fff, v16
v_add_u32 v0, s78, v0
T 32,0,0
T 34,0,4
v_and_b32 v0, 0x1fff, v17
v_add_u32 v0, s78, v0
T 36,0,0
T 38,0,4
v_and_b32 v0, 0x1fff, v18
v_add_u32 v0, s78, v0
T 40,0,0
T 42,0,4
v_and_b32 v0, 0x1fff, v19
v_add_u32 v0, s78, v0
T 44,0,0
T 46,0,4
v_and_b32 v0, 0x1fff, v20
v_add_u32 v0, s78, v0
T 48,0,0
T 50,0,4
v_and_b32 v0, 0x1fff, v21
v_add_u32 v0, s78, v0
T 52,0,0
T 54,0,4
v_and_b32 v0, 0x1fff, v22
v_add_u32 v0, s78, v0
T 56,0,0
T 58,0,4
v_and_b32 v0, 0x1fff, v23
v_add_u32 v0, s78, v0
T 60,0,0
W 14
T 62,0,4
W 14
MA 128,32,96
MA 132,32,100
W 12
MA 136,36,96
MA 140,36,100
W 10
MA 144,40,96
MA 148,40,100
W 8
MA 152,44,96
MA 156,44,100
W 6
MA 160,48,96
MA 164,48,100
W 4
MA 168,52,96
MA 172,52,100
W 2
MA 176,56,96
MA 180,56,100
W 0
MA 184,60,96
MA 188,60,100
s_nop 15
s_or_b32 s81, s81, 0x7ffe8fff
s_add_u32 s81, s81, 1
s_and_b32 s81, s81, 0x17000
s_add_u32 s94, s80, s81
s_cmp_lg_u32 s81, 0
s_cbranch_scc1 L_slow2_c1A0
v_mov_b32 v1, v60
s_nop 1
v_permlane32_swap_b32 v1, v60
v_add_f32 v60, v60, v1
v_mov_b32 v1, v60
s_nop 1
v_permlane16_swap_b32 v1, v60
v_add_f32 v60, v60, v1
v_mov_b32 v1, v61
s_nop 1
v_permlane32_swap_b32 v1, v61
v_add_f32 v61, v61, v1
v_mov_b32 v1, v61
s_nop 1
v_permlane16_swap_b32 v1, v61
v_add_f32 v61, v61, v1
s_mov_b32 m0, s93
s_nop 4
s_branch L_back_c1A0
L_slow_c1A1:
s_waitcnt vmcnt(0) lgkmcnt(0)
s_nop 15
s_mov_b32 s93, m0
s_andn2_b32 s80, s64, 0x1ff00
s_xor_b32 s80, s80, 0x0
v_mov_b32 v62, 0xff800000
v_mov_b32 v63, 0xff800000
s_mov_b32 s94, s80
s_mov_b32 s81, 0
L_slow1_c1A1:
s_add_u32 m0, s78, 0
s_add_u32 s92, s94, 0
G 32,12,92,0
G 33,12,92,1
G 34,12,92,2
G 35,12,92,3
s_add_u32 m0, s78, 4096
s_add_u32 s92, s94, 512
G 32,12,92,0
G 33,12,92,1
G 34,12,92,2
G 35,12,92,3
s_waitcnt vmcnt(0)
v_and_b32 v0, 0x1fff, v8
v_add_u32 v0, s78, v0
R a,32,0,0
R a,48,0,4
v_and_b32 v0, 0x1fff, v9
v_add_u32 v0, s78, v0
R a,36,0,0
R a,52,0,4
v_and_b32 v0, 0x1fff, v10
v_add_u32 v0, s78, v0
R a,40,0,0
R a,56,0,4
v_and_b32 v0, 0x1fff, v11
v_add_u32 v0, s78, v0
R a,44,0,0
R a,60,0,4
W 7
ZB 64,32,224
ZB 68,32,228
W 5
MB 64,36,232
MB 68,36,236
W 3
MB 64,40,240
MB 68,40,244
W 1
MB 64,44,248
MB 68,44,252
ZB 72,48,224
ZB 76,48,228
MB 72,52,232
MB 76,52,236
MB 72,56,240
MB 76,56,244
W 0
MB 72,60,248
MB 76,60,252
v_max_f32 v62, v62, v64
v_max_f32 v62, v62, v65
v_max_f32 v62, v62, v66
v_max_f32 v62, v62, v67
v_max_f32 v63, v63, v68
v_max_f32 v63, v63, v69
v_max_f32 v63, v63, v70
v_max_f32 v63, v63, v71
v_max_f32 v62, v62, v72
v_max_f32 v62, v62, v73
v_max_f32 v62, v62, v74
v_max_f32 v62, v62, v75
v_max_f32 v63, v63, v76
v_max_f32 v63, v63, v77
v_max_f32 v63, v63, v78
v_max_f32 v63, v63, v79
s_or_b32 s81, s81, 0x7ffe8fff
s_add_u32 s81, s81, 1
s_and_b32 s81, s81, 0x17000
s_add_u32 s94, s80, s81
s_cmp_lg_u32 s81, 0
s_cbranch_scc1 L_slow1_c1A1
v_mov_b32 v1, v62
s_nop 1
v_permlane32_swap_b32 v1, v62
v_max_f32 v62, v62, v1
v_mov_b32 v1, v62
s_nop 1
v_permlane16_swap_b32 v1, v62
v_max_f32 v62, v62, v1
v_mov_b32 v1, v63
s_nop 1
v_permlane32_swap_b32 v1, v63
v_max_f32 v63, v63, v1
v_mov_b32 v1, v63
s_nop 1
v_permlane16_swap_b32 v1, v63
v_max_f32 v63, v63, v1
v_mov_b32 v60, 0
v_mov_b32 v61, 0
v_mov_b32 v192, 0
v_mov_b32 v193, 0
v_mov_b32 v194, 0
v_mov_b32 v195, 0
v_mov_b32 v196, 0
v_mov_b32 v197, 0
v_mov_b32 v198, 0
v_mov_b32 v199, 0
v_mov_b32 v200, 0
v_mov_b32 v201, 0
v_mov_b32 v202, 0
v_mov_b32 v203, 0
v_mov_b32 v204, 0
v_mov_b32 v205, 0
v_mov_b32 v206, 0
v_mov_b32 v207, 0
v_mov_b32 v208, 0
v_mov_b32 v209, 0
v_mov_b32 v210, 0
v_mov_b32 v211, 0
v_mov_b32 v212, 0
v_mov_b32 v213, 0
v_mov_b32 v214, 0
v_mov_b32 v215, 0
v_mov_b32 v216, 0
v_mov_b32 v217, 0
v_mov_b32 v218, 0
v_mov_b32 v219, 0
v_mov_b32 v220, 0
v_mov_b32 v221, 0
v_mov_b32 v222, 0
v_mov_b32 v223, 0
v_mov_b32 v224, 0
v_mov_b32 v225, 0
v_mov_b32 v226, 0
v_mov_b32 v227, 0
v_mov_b32 v228, 0
v_mov_b32 v229, 0
v_mov_b32 v230, 0
v_mov_b32 v231, 0
v_mov_b32 v232, 0
v_mov_b32 v233, 0
v_mov_b32 v234, 0
v_mov_b32 v235, 0
v_mov_b32 v236, 0
v_mov_b32 v237, 0
v_mov_b32 v238, 0
v_mov_b32 v239, 0
v_mov_b32 v240, 0
v_mov_b32 v241, 0
v_mov_b32 v242, 0
v_mov_b32 v243, 0
v_mov_b32 v244, 0
v_mov_b32 v245, 0
v_mov_b32 v246, 0
v_mov_b32 v247, 0
v_mov_b32 v248, 0
v_mov_b32 v249, 0
v_mov_b32 v250, 0
v_mov_b32 v251, 0
v_mov_b32 v252, 0
v_mov_b32 v253, 0
v_mov_b32 v254, 0
v_mov_b32 v255, 0
s_mov_b32 s94, s80
s_mov_b32 s81, 0
s_nop 4
L_slow2_c1A1:
s_add_u32 m0, s78, 0
s_add_u32 s92, s94, 0
G 32,12,92,0
G 33,12,92,1
G 34,12,92,2
G 35,12,92,3
s_add_u32 m0, s78, 4096
s_add_u32 s92, s94, 512
G 32,12,92,0
G 33,12,92,1
G 34,12,92,2
G 35,12,92,3
s_waitcnt vmcnt(0)
v_and_b32 v0, 0x1fff, v8
v_add_u32 v0, s78, v0
R a,32,0,0
R a,48,0,4
v_and_b32 v0, 0x1fff, v9
v_add_u32 v0, s78, v0
R a,36,0,0
R a,52,0,4
v_and_b32 v0, 0x1fff, v10
v_add_u32 v0, s78, v0
R a,40,0,0
R a,56,0,4
v_and_b32 v0, 0x1fff, v11
v_add_u32 v0, s78, v0
R a,44,0,0
R a,60,0,4
W 7
ZB 64,32,224
ZB 68,32,228
W 5
MB 64,36,232
MB 68,36,236
W 3
MB 64,40,240
MB 68,40,244
W 1
MB 64,44,248
MB 68,44,252
ZB 72,48,224
ZB 76,48,228
MB 72,52,232
MB 76,52,236
MB 72,56,240
MB 76,56,244
W 0
MB 72,60,248
MB 76,60,252
v_sub_f32 v64, v64, v62
v_sub_f32 v65, v65, v62
v_sub_f32 v66, v66, v62
v_sub_f32 v67, v67, v62
v_sub_f32 v68, v68, v63
v_sub_f32 v69, v69, v63
v_sub_f32 v70, v70, v63
v_sub_f32 v71, v71, v63
v_sub_f32 v72, v72, v62
v_sub_f32 v73, v73, v62
v_sub_f32 v74, v74, v62
v_sub_f32 v75, v75, v62
v_sub_f32 v76, v76, v63
v_sub_f32 v77, v77, v63
v_sub_f32 v78, v78, v63
v_sub_f32 v79, v79, v63
E 64
E 65
E 66
E 67
E 68
E 69
E 70
E 71
E 72
E 73
E 74
E 75
E 76
E 77
E 78
E 79
v_add_f32 v60, v60, v64
v_add_f32 v60, v60, v65
v_add_f32 v60, v60, v66
v_add_f32 v60, v60, v67
v_add_f32 v61, v61, v68
v_add_f32 v61, v61, v69
v_add_f32 v61, v61, v70
v_add_f32 v61, v61, v71
v_add_f32 v60, v60, v72
v_add_f32 v60, v60, v73
v_add_f32 v60, v60, v74
v_add_f32 v60, v60, v75
v_add_f32 v61, v61, v76
v_add_f32 v61, v61, v77
v_add_f32 v61, v61, v78
v_add_f32 v61, v61, v79
CV 96,64
CV 97,66
CV 100,68
CV 101,70
CV 98,72
CV 99,74
CV 102,76
CV 103,78
s_add_u32 m0, s78, 0
s_add_u32 s92, s94, 0
G 56,16,92,0
G 57,16,92,1
G 56,16,92,2
G 57,16,92,3
s_add_u32 m0, s78, 4096
s_add_u32 s92, s94, 512
G 56,16,92,0
G 57,16,92,1
G 56,16,92,2
G 57,16,92,3
s_waitcnt vmcnt(0)
v_and_b32 v0, 0x1fff, v16
v_add_u32 v0, s78, v0
T 32,0,0
T 34,0,4
v_and_b32 v0, 0x1fff, v17
v_add_u32 v0, s78, v0
T 36,0,0
T 38,0,4
v_and_b32 v0, 0x1fff, v18
v_add_u32 v0, s78, v0
T 40,0,0
T 42,0,4
v_and_b32 v0, 0x1fff, v19
v_add_u32 v0, s78, v0
T 44,0,0
T 46,0,4
v_and_b32 v0, 0x1fff, v20
v_add_u32 v0, s78, v0
T 48,0,0
T 50,0,4
v_and_b32 v0, 0x1fff, v21
v_add_u32 v0, s78, v0
T 52,0,0
T 54,0,4
v_and_b32 v0, 0x1fff, v22
v_add_u32 v0, s78, v0
T 56,0,0
T 58,0,4
v_and_b32 v0, 0x1fff, v23
v_add_u32 v0, s78, v0
T 60,0,0
W 14
T 62,0,4
W 14
MA 192,32,96
MA 196,32,100
W 12
MA 200,36,96
MA 204,36,100
W 10
MA 208,40,96
MA 212,40,100
W 8
MA 216,44,96
MA 220,44,100
W 6
MA 224,48,96
MA 228,48,100
W 4
MA 232,52,96
MA 236,52,100
W 2
MA 240,56,96
MA 244,56,100
W 0
MA 248,60,96
MA 252,60,100
s_nop 15
s_or_b32 s81, s81, 0x7ffe8fff
s_add_u32 s81, s81, 1
s_and_b32 s81, s81, 0x17000
s_add_u32 s94, s80, s81
s_cmp_lg_u32 s81, 0
s_cbranch_scc1 L_slow2_c1A1
v_mov_b32 v1, v60
s_nop 1
v_permlane32_swap_b32 v1, v60
v_add_f32 v60, v60, v1
v_mov_b32 v1, v60
s_nop 1
v_permlane16_swap_b32 v1, v60
v_add_f32 v60, v60, v1
v_mov_b32 v1, v61
s_nop 1
v_permlane32_swap_b32 v1, v61
v_add_f32 v61, v61, v1
v_mov_b32 v1, v61
s_nop 1
v_permlane16_swap_b32 v1, v61
v_add_f32 v61, v61, v1
s_mov_b32 m0, s93
s_nop 4
s_branch L_back_c1A1
L_wi_c1:
s_sleep 6
v_mov_b32 v62, 0
buffer_load_dword v4, v62, s[96:99], s87 offen sc1
s_waitcnt vmcnt(0)
s_add_u32 s6, s6, 1
s_cmp_ge_u32 s6, 0x100000
s_cbranch_scc1 L_gi_c1
s_branch L_ci_c1
L_we_c1:
s_sleep 6
buffer_load_dword v3, v7, s[52:55], s72 offen offset:256 sc1
buffer_load_dword v4, v7, s[52:55], s72 offen offset:384 sc1
s_waitcnt vmcnt(0)
s_add_u32 s6, s6, 1
s_cmp_ge_u32 s6, 0x100000
s_cbranch_scc1 L_ge_c1
s_branch L_ce_c1
L_wm_c1:
s_sleep 6
buffer_load_dword v0, v7, s[52:55], s72 offen offset:0 sc1
s_waitcnt vmcnt(0)
s_add_u32 s6, s6, 1
s_cmp_ge_u32 s6, 0x100000
s_cbranch_scc1 L_gm_c1
s_branch L_cm_c1
L_wl_c1:
s_sleep 6
buffer_load_dword v4, v7, s[52:55], s72 offen offset:128 sc1
s_waitcnt vmcnt(0)
s_add_u32 s6, s6, 1
s_cmp_ge_u32 s6, 0x100000
s_cbranch_scc1 L_gl_c1
s_branch L_cl_c1
.p2align 6
L_prog2:
s_waitcnt vmcnt(12)
s_barrier
R v,128,8,0
R v,132,8,4
R v,136,9,0
R v,140,9,4
R v,144,10,0
R v,148,10,4
R v,152,11,0
R v,156,11,4
T 0,16,16
T 2,16,20
T 4,17,16
T 6,17,20
T 8,18,16
T 10,18,20
T 12,19,16
W 14
T 14,19,20
W 14
T 16,20,16
W 14
T 18,20,20
s_xor_b32 m0, s65, 0x14000
s_xor_b32 s66, s61, 0xc0000
G 40,20,66,0
G 41,20,66,1
G 42,20,66,2
W 6
ZA 64,0,128
G 43,20,66,3
s_xor_b32 m0, s65, 0x18000
s_xor_b32 s66, s61, 0x100000
ZA 68,0,132
G 40,20,66,0
G 41,20,66,1
T 20,21,16
T 22,21,20
ZA 72,4,128
G 42,20,66,2
G 43,20,66,3
s_xor_b32 m0, s65, 0x1c000
ZA 76,4,132
s_xor_b32 s66, s61, 0x140000
G 40,20,66,0
T 24,22,16
T 26,22,20
W 6
ZA 80,8,128
G 41,20,66,1
G 42,20,66,2
ZA 84,8,132
G 43,20,66,3
T 28,23,16
T 30,23,20
ZA 88,12,128
s_waitcnt vmcnt(16)
s_barrier
T 32,16,32
ZA 92,12,132
T 34,16,36
s_xor_b32 m0, s65, 0x0
s_xor_b32 s66, s60, 0x200
W 6
ZA 96,16,128
G 36,8,66,0
ZA 100,16,132
T 36,17,32
T 38,17,36
ZA 104,20,128
T 40,18,32
ZA 108,20,132
T 42,18,36
W 6
ZA 112,24,128
G 37,8,66,1
ZA 116,24,132
T 44,19,32
T 46,19,36
ZA 120,28,128
T 48,20,32
ZA 124,28,132
T 50,20,36
W 6
MA 64,32,136
G 38,8,66,2
MA 68,32,140
T 52,21,32
T 54,21,36
R v,160,8,48
MA 72,36,136
T 56,22,32
MA 76,36,140
T 58,22,36
R v,164,8,52
W 8
MA 80,40,136
G 39,8,66,3
MA 84,40,140
T 60,23,32
T 62,23,36
R v,168,9,48
MA 88,44,136
s_waitcnt vmcnt(12)
s_barrier
R v,172,9,52
MA 92,44,140
T 0,24,0
T 2,24,4
s_xor_b32 m0, s65, 0x4000
s_xor_b32 s66, s61, 0x180000
W 10
MA 96,48,136
G 40,20,66,0
MA 100,48,140
R v,176,10,48
T 4,25,0
T 6,25,4
MA 104,52,136
R v,180,10,52
MA 108,52,140
T 8,26,0
W 14
T 10,26,4
W 10
MA 112,56,136
G 41,20,66,1
MA 116,56,140
R v,184,11,48
T 12,27,0
T 14,27,4
MA 120,60,136
R v,188,11,52
MA 124,60,140
T 16,28,0
W 14
T 18,28,4
W 9
MA 64,0,144
G 42,20,66,2
MA 68,0,148
T 20,29,0
T 22,29,4
MA 72,4,144
T 24,30,0
MA 76,4,148
T 26,30,4
W 7
MA 80,8,144
G 43,20,66,3
MA 84,8,148
T 28,31,0
T 30,31,4
MA 88,12,144
T 32,24,16
MA 92,12,148
T 34,24,20
W 6
MA 96,16,144
T 36,25,16
MA 100,16,148
T 38,25,20
MA 104,20,144
T 40,26,16
MA 108,20,148
T 42,26,20
W 6
MA 112,24,144
T 44,27,16
MA 116,24,148
T 46,27,20
MA 120,28,144
T 48,28,16
MA 124,28,148
T 50,28,20
W 6
MA 64,32,152
T 52,29,16
MA 68,32,156
T 54,29,20
MA 72,36,152
T 56,30,16
MA 76,36,156
T 58,30,20
W 6
MA 80,40,152
T 60,31,16
MA 84,40,156
T 62,31,20
MA 88,44,152
s_waitcnt vmcnt(8)
s_barrier
T 0,24,32
MA 92,44,156
T 2,24,36
s_xor_b32 m0, s65, 0x8000
s_xor_b32 s66, s61, 0x1c0000
W 6
MA 96,48,152
G 40,20,66,0
MA 100,48,156
T 4,25,32
T 6,25,36
MA 104,52,152
G 41,20,66,1
MA 108,52,156
T 8,26,32
T 10,26,36
W 6
MA 112,56,152
G 42,20,66,2
MA 116,56,156
T 12,27,32
T 14,27,36
MA 120,60,152
G 43,20,66,3
T 16,28,32
MA 124,60,156
T 18,28,36
s_xor_b32 m0, s65, 0xc000
s_xor_b32 s66, s61, 0x200000
W 6
MA 64,0,160
G 40,20,66,0
MA 68,0,164
T 20,29,32
T 22,29,36
MA 72,4,160
G 41,20,66,1
MA 76,4,164
T 24,30,32
T 26,30,36
W 6
MA 80,8,160
G 42,20,66,2
MA 84,8,164
T 28,31,32
T 30,31,36
MA 88,12,160
G 43,20,66,3
T 32,24,48
MA 92,12,164
T 34,24,52
s_xor_b32 m0, s65, 0x10000
s_xor_b32 s66, s61, 0x240000
W 6
MA 96,16,160
G 40,20,66,0
MA 100,16,164
T 36,25,48
T 38,25,52
MA 104,20,160
G 41,20,66,1
MA 108,20,164
T 40,26,48
T 42,26,52
W 6
MA 112,24,160
G 42,20,66,2
MA 116,24,164
T 44,27,48
T 46,27,52
MA 120,28,160
G 43,20,66,3
MA 124,28,164
T 48,28,48
T 50,28,52
W 6
MA 64,32,168
s_waitcnt vmcnt(12)
s_barrier
T 52,29,48
MA 68,32,172
T 54,29,52
R v,192,8,0
s_xor_b32 m0, s65, 0x14000
s_xor_b32 s66, s60, 0x300
MA 72,36,168
G 36,8,66,0
MA 76,36,172
T 56,30,48
T 58,30,52
R v,196,8,4
W 8
MA 80,40,168
G 37,8,66,1
MA 84,40,172
T 60,31,48
T 62,31,52
R v,200,9,0
v_mov_b32 v61, 0
v_lshlrev_b32 v62, 3, v59
s_mov_b64 exec, 15
buffer_store_dword v61, v62, s[52:55], s5 offen sc1
s_mov_b64 exec, -1
MA 88,44,168
G 38,8,66,2
MA 92,44,172
R v,204,9,4
T 0,16,16
T 2,16,20
W 10
MA 96,48,168
R v,208,10,0
MA 100,48,172
T 4,17,16
T 6,17,20
MA 104,52,168
G 39,8,66,3
R v,212,10,4
MA 108,52,172
T 8,18,16
W 14
T 10,18,20
s_xor_b32 m0, s65, 0x18000
s_xor_b32 s66, s61, 0x280000
W 10
MA 112,56,168
G 40,20,66,0
MA 116,56,172
R v,216,11,0
T 12,19,16
T 14,19,20
MA 120,60,168
G 41,20,66,1
MA 124,60,172
R v,220,11,4
T 16,20,16
W 14
T 18,20,20
W 9
MA 64,0,176
T 20,21,16
MA 68,0,180
T 22,21,20
MA 72,4,176
G 42,20,66,2
MA 76,4,180
T 24,22,16
T 26,22,20
W 7
MA 80,8,176
G 43,20,66,3
MA 84,8,180
T 28,23,16
T 30,23,20
MA 88,12,176
s_waitcnt vmcnt(13) lgkmcnt(8)
s_barrier
T 32,16,32
MA 92,12,180
T 34,16,36
s_xor_b32 m0, s65, 0x1c000
s_xor_b32 s66, s61, 0x2c0000
W 6
MA 96,16,176
G 40,20,66,0
MA 100,16,180
T 36,17,32
T 38,17,36
MA 104,20,176
T 40,18,32
MA 108,20,180
T 42,18,36
W 6
MA 112,24,176
G 41,20,66,1
MA 116,24,180
T 44,19,32
T 46,19,36
MA 120,28,176
T 48,20,32
MA 124,28,180
T 50,20,36
W 6
MA 64,32,184
G 42,20,66,2
MA 68,32,188
T 52,21,32
T 54,21,36
MA 72,36,184
T 56,22,32
MA 76,36,188
T 58,22,36
W 6
MA 80,40,184
G 43,20,66,3
MA 84,40,188
T 60,23,32
T 62,23,36
MA 88,44,184
T 0,16,48
T 2,16,52
MA 92,44,188
s_xor_b32 m0, s65, 0x0
s_xor_b32 s66, s61, 0x300000
W 6
MA 96,48,184
G 40,20,66,0
MA 100,48,188
T 4,17,48
T 6,17,52
MA 104,52,184
T 8,18,48
MA 108,52,188
T 10,18,52
W 6
MA 112,56,184
G 41,20,66,1
MA 116,56,188
T 12,19,48
T 14,19,52
MA 120,60,184
T 16,20,48
MA 124,60,188
T 18,20,52
W 6
MA 64,0,192
G 42,20,66,2
MA 68,0,196
T 20,21,48
T 22,21,52
MA 72,4,192
T 24,22,48
MA 76,4,196
T 26,22,52
W 6
MA 80,8,192
G 43,20,66,3
MA 84,8,196
T 28,23,48
T 30,23,52
MA 88,12,192
s_waitcnt vmcnt(12)
s_barrier
s_xor_b32 m0, s65, 0x4000
s_xor_b32 s66, s61, 0x340000
MA 92,12,196
G 40,20,66,0
T 32,24,0
T 34,24,4
W 6
MA 96,16,192
G 41,20,66,1
MA 100,16,196
T 36,25,0
T 38,25,4
MA 104,20,192
G 42,20,66,2
MA 108,20,196
T 40,26,0
T 42,26,4
W 6
MA 112,24,192
G 43,20,66,3
MA 116,24,196
T 44,27,0
T 46,27,4
MA 120,28,192
s_xor_b32 m0, s65, 0x8000
s_xor_b32 s66, s61, 0x380000
MA 124,28,196
G 40,20,66,0
T 48,28,0
T 50,28,4
W 6
MA 64,32,200
G 41,20,66,1
MA 68,32,204
T 52,29,0
T 54,29,4
R v,224,12,16
MA 72,36,200
G 42,20,66,2
MA 76,36,204
T 56,30,0
T 58,30,4
R v,228,12,20
W 8
MA 80,40,200
G 43,20,66,3
MA 84,40,204
T 60,31,0
T 62,31,4
R v,232,13,16
MA 88,44,200
s_waitcnt vmcnt(12)
s_barrier
R v,236,13,20
MA 92,44,204
T 0,24,32
T 2,24,36
s_xor_b32 m0, s65, 0xc000
s_xor_b32 s66, s61, 0x3c0000
W 10
MA 96,48,200
G 40,20,66,0
MA 100,48,204
R v,240,14,16
T 4,25,32
T 6,25,36
MA 104,52,200
R v,244,14,20
MA 108,52,204
T 8,26,32
W 14
T 10,26,36
W 10
MA 112,56,200
G 41,20,66,1
MA 116,56,204
R v,248,15,16
T 12,27,32
T 14,27,36
MA 120,60,200
R v,252,15,20
MA 124,60,204
T 16,28,32
W 14
T 18,28,36
W 9
MA 64,0,208
G 42,20,66,2
MA 68,0,212
T 20,29,32
T 22,29,36
MA 72,4,208
T 24,30,32
MA 76,4,212
T 26,30,36
W 7
MA 80,8,208
G 43,20,66,3
MA 84,8,212
T 28,31,32
T 30,31,36
MA 88,12,208
T 32,24,48
MA 92,12,212
T 34,24,52
W 6
MA 96,16,208
T 36,25,48
MA 100,16,212
T 38,25,52
MA 104,20,208
T 40,26,48
MA 108,20,212
T 42,26,52
W 6
MA 112,24,208
T 44,27,48
MA 116,24,212
T 46,27,52
MA 120,28,208
T 48,28,48
MA 124,28,212
T 50,28,52
W 6
MA 64,32,216
T 52,29,48
MA 68,32,220
T 54,29,52
MA 72,36,216
T 56,30,48
MA 76,36,220
T 58,30,52
W 6
MA 80,40,216
T 60,31,48
MA 84,40,220
T 62,31,52
MA 88,44,216
s_waitcnt vmcnt(8)
s_barrier
T 0,16,0
MA 92,44,220
T 2,16,4
s_xor_b32 m0, s65, 0x10000
s_xor_b32 s66, s61, 0x200
W 6
MA 96,48,216
G 40,20,66,0
MA 100,48,220
T 4,17,0
T 6,17,4
MA 104,52,216
G 41,20,66,1
MA 108,52,220
T 8,18,0
T 10,18,4
v_mov_b32 v61, 1
v_mov_b32 v62, 0
s_mov_b64 exec, 1
buffer_atomic_add v61, v62, s[96:99], s86 offen sc1
s_mov_b64 exec, -1
s_mov_b32 s6, 0
W 6
MA 112,56,216
G 42,20,66,2
MA 116,56,220
T 12,19,0
T 14,19,4
MA 120,60,216
T 16,20,0
MA 124,60,220
T 18,20,4
W 6
MA 64,0,224
G 43,20,66,3
T 20,21,0
MA 68,0,228
T 22,21,4
s_xor_b32 m0, s65, 0x14000
s_xor_b32 s66, s61, 0x40200
MA 72,4,224
G 40,20,66,0
MA 76,4,228
T 24,22,0
T 26,22,4
W 6
MA 80,8,224
G 41,20,66,1
MA 84,8,228
T 28,23,0
T 30,23,4
MA 88,12,224
T 32,16,16
MA 92,12,228
T 34,16,20
W 6
MA 96,16,224
G 42,20,66,2
MA 100,16,228
T 36,17,16
T 38,17,20
MA 104,20,224
G 43,20,66,3
T 40,18,16
MA 108,20,228
T 42,18,20
s_xor_b32 m0, s65, 0x18000
s_xor_b32 s66, s61, 0x80200
W 6
MA 112,24,224
G 40,20,66,0
MA 116,24,228
T 44,19,16
T 46,19,20
MA 120,28,224
T 48,20,16
MA 124,28,228
T 50,20,20
W 6
MA 64,32,232
G 41,20,66,1
MA 68,32,236
T 52,21,16
T 54,21,20
MA 72,36,232
G 42,20,66,2
MA 76,36,236
T 56,22,16
T 58,22,20
W 6
MA 80,40,232
G 43,20,66,3
MA 84,40,236
T 60,23,16
T 62,23,20
MA 88,44,232
s_waitcnt vmcnt(13)
s_barrier
T 0,16,32
MA 92,44,236
T 2,16,36
s_xor_b32 m0, s65, 0x1c000
s_xor_b32 s66, s61, 0xc0200
W 6
MA 96,48,232
G 40,20,66,0
MA 100,48,236
T 4,17,32
T 6,17,36
MA 104,52,232
T 8,18,32
MA 108,52,236
T 10,18,36
W 6
MA 112,56,232
G 41,20,66,1
MA 116,56,236
T 12,19,32
T 14,19,36
MA 120,60,232
T 16,20,32
MA 124,60,236
T 18,20,36
W 6
MA 64,0,240
G 42,20,66,2
MA 68,0,244
T 20,21,32
T 22,21,36
MA 72,4,240
T 24,22,32
MA 76,4,244
T 26,22,36
W 6
MA 80,8,240
G 43,20,66,3
MA 84,8,244
T 28,23,32
T 30,23,36
MA 88,12,240
T 32,16,48
T 34,16,52
MA 92,12,244
s_xor_b32 m0, s65, 0x0
s_xor_b32 s66, s61, 0x100200
W 6
MA 96,16,240
G 40,20,66,0
MA 100,16,244
T 36,17,48
T 38,17,52
MA 104,20,240
T 40,18,48
MA 108,20,244
T 42,18,52
W 6
MA 112,24,240
G 41,20,66,1
MA 116,24,244
T 44,19,48
T 46,19,52
MA 120,28,240
T 48,20,48
MA 124,28,244
T 50,20,52
W 6
MA 64,32,248
G 42,20,66,2
MA 68,32,252
T 52,21,48
T 54,21,52
MA 72,36,248
T 56,22,48
MA 76,36,252
T 58,22,52
W 6
MA 80,40,248
G 43,20,66,3
MA 84,40,252
T 60,23,48
T 62,23,52
MA 88,44,248
s_waitcnt vmcnt(12)
s_barrier
T 0,24,0
MA 92,44,252
T 2,24,4
s_xor_b32 m0, s65, 0x4000
s_xor_b32 s66, s61, 0x140200
W 6
MA 96,48,248
G 40,20,66,0
MA 100,48,252
T 4,25,0
T 6,25,4
MA 104,52,248
T 8,26,0
MA 108,52,252
T 10,26,4
W 6
MA 112,56,248
G 41,20,66,1
MA 116,56,252
T 12,27,0
T 14,27,4
MA 120,60,248
T 16,28,0
MA 124,60,252
T 18,28,4
v_pk_mul_f32 v[64:65], v[64:65], s[74:75]
v_pk_mul_f32 v[66:67], v[66:67], s[74:75]
v_pk_mul_f32 v[68:69], v[68:69], s[74:75]
v_pk_mul_f32 v[70:71], v[70:71], s[74:75]
v_pk_mul_f32 v[72:73], v[72:73], s[74:75]
v_pk_mul_f32 v[74:75], v[74:75], s[74:75]
v_pk_mul_f32 v[76:77], v[76:77], s[74:75]
v_pk_mul_f32 v[78:79], v[78:79], s[74:75]
CV 64,64
CV 66,66
CV 68,68
CV 70,70
CV 72,72
CV 74,74
CV 76,76
CV 78,78
v_permlane32_swap_b32 v64, v72
v_permlane32_swap_b32 v66, v74
v_permlane32_swap_b32 v68, v76
v_permlane32_swap_b32 v70, v78
v_permlane16_swap_b32 v64, v72
v_permlane16_swap_b32 v66, v74
v_permlane16_swap_b32 v68, v76
v_permlane16_swap_b32 v70, v78
AW 64,64
AW 65,66
AW 66,72
AW 67,74
AW 68,68
AW 69,70
AW 70,76
AW 71,78
v_pk_mul_f32 v[80:81], v[80:81], s[74:75]
v_pk_mul_f32 v[82:83], v[82:83], s[74:75]
v_pk_mul_f32 v[84:85], v[84:85], s[74:75]
v_pk_mul_f32 v[86:87], v[86:87], s[74:75]
v_pk_mul_f32 v[88:89], v[88:89], s[74:75]
v_pk_mul_f32 v[90:91], v[90:91], s[74:75]
v_pk_mul_f32 v[92:93], v[92:93], s[74:75]
v_pk_mul_f32 v[94:95], v[94:95], s[74:75]
CV 80,80
CV 82,82
CV 84,84
CV 86,86
CV 88,88
CV 90,90
CV 92,92
CV 94,94
v_permlane32_swap_b32 v80, v88
v_permlane32_swap_b32 v82, v90
v_permlane32_swap_b32 v84, v92
v_permlane32_swap_b32 v86, v94
v_permlane16_swap_b32 v80, v88
v_permlane16_swap_b32 v82, v90
v_permlane16_swap_b32 v84, v92
v_permlane16_swap_b32 v86, v94
AW 72,80
AW 73,82
AW 74,88
AW 75,90
AW 76,84
AW 77,86
AW 78,92
AW 79,94
v_pk_mul_f32 v[96:97], v[96:97], s[74:75]
v_pk_mul_f32 v[98:99], v[98:99], s[74:75]
v_pk_mul_f32 v[100:101], v[100:101], s[74:75]
v_pk_mul_f32 v[102:103], v[102:103], s[74:75]
v_pk_mul_f32 v[104:105], v[104:105], s[74:75]
v_pk_mul_f32 v[106:107], v[106:107], s[74:75]
v_pk_mul_f32 v[108:109], v[108:109], s[74:75]
v_pk_mul_f32 v[110:111], v[110:111], s[74:75]
CV 96,96
CV 98,98
CV 100,100
CV 102,102
CV 104,104
CV 106,106
CV 108,108
CV 110,110
v_permlane32_swap_b32 v96, v104
v_permlane32_swap_b32 v98, v106
v_permlane32_swap_b32 v100, v108
v_permlane32_swap_b32 v102, v110
v_permlane16_swap_b32 v96, v104
v_permlane16_swap_b32 v98, v106
v_permlane16_swap_b32 v100, v108
v_permlane16_swap_b32 v102, v110
AW 80,96
AW 81,98
AW 82,104
AW 83,106
AW 84,100
AW 85,102
AW 86,108
AW 87,110
v_pk_mul_f32 v[112:113], v[112:113], s[74:75]
v_pk_mul_f32 v[114:115], v[114:115], s[74:75]
v_pk_mul_f32 v[116:117], v[116:117], s[74:75]
v_pk_mul_f32 v[118:119], v[118:119], s[74:75]
v_pk_mul_f32 v[120:121], v[120:121], s[74:75]
v_pk_mul_f32 v[122:123], v[122:123], s[74:75]
v_pk_mul_f32 v[124:125], v[124:125], s[74:75]
v_pk_mul_f32 v[126:127], v[126:127], s[74:75]
CV 112,112
CV 114,114
CV 116,116
CV 118,118
CV 120,120
CV 122,122
CV 124,124
CV 126,126
v_permlane32_swap_b32 v112, v120
v_permlane32_swap_b32 v114, v122
v_permlane32_swap_b32 v116, v124
v_permlane32_swap_b32 v118, v126
v_permlane16_swap_b32 v112, v120
v_permlane16_swap_b32 v114, v122
v_permlane16_swap_b32 v116, v124
v_permlane16_swap_b32 v118, v126
AW 88,112
AW 89,114
AW 90,120
AW 91,122
AW 92,116
AW 93,118
AW 94,124
AW 95,126
W 6
ZA 64,0,128
G 42,20,66,2
ZA 68,0,132
T 20,29,0
T 22,29,4
ZA 72,4,128
T 24,30,0
ZA 76,4,132
T 26,30,4
W 6
ZA 80,8,128
G 43,20,66,3
ZA 84,8,132
T 28,31,0
T 30,31,4
ZA 88,12,128
T 32,24,16
T 34,24,20
ZA 92,12,132
s_xor_b32 m0, s65, 0x8000
s_xor_b32 s66, s61, 0x180200
W 6
ZA 96,16,128
G 40,20,66,0
ZA 100,16,132
T 36,25,16
T 38,25,20
ZA 104,20,128
T 40,26,16
ZA 108,20,132
T 42,26,20
W 6
ZA 112,24,128
G 41,20,66,1
ZA 116,24,132
T 44,27,16
T 46,27,20
ZA 120,28,128
T 48,28,16
ZA 124,28,132
T 50,28,20
W 6
MA 64,32,136
G 42,20,66,2
MA 68,32,140
T 52,29,16
T 54,29,20
MA 72,36,136
T 56,30,16
MA 76,36,140
T 58,30,20
W 6
MA 80,40,136
G 43,20,66,3
MA 84,40,140
T 60,31,16
T 62,31,20
MA 88,44,136
s_waitcnt vmcnt(12)
s_barrier
T 0,24,32
MA 92,44,140
T 2,24,36
s_xor_b32 m0, s65, 0xc000
s_xor_b32 s66, s61, 0x1c0200
W 6
MA 96,48,136
G 40,20,66,0
MA 100,48,140
T 4,25,32
T 6,25,36
MA 104,52,136
T 8,26,32
MA 108,52,140
T 10,26,36
W 6
MA 112,56,136
G 41,20,66,1
MA 116,56,140
T 12,27,32
T 14,27,36
MA 120,60,136
T 16,28,32
MA 124,60,140
T 18,28,36
W 6
MA 64,0,144
G 42,20,66,2
MA 68,0,148
T 20,29,32
T 22,29,36
MA 72,4,144
T 24,30,32
MA 76,4,148
T 26,30,36
W 6
MA 80,8,144
G 43,20,66,3
MA 84,8,148
T 28,31,32
T 30,31,36
MA 88,12,144
T 32,24,48
T 34,24,52
MA 92,12,148
s_xor_b32 m0, s65, 0x10000
s_xor_b32 s66, s61, 0x200200
W 6
MA 96,16,144
G 40,20,66,0
MA 100,16,148
T 36,25,48
T 38,25,52
s_getpc_b64 s[88:89]
L_ct2_129:
s_and_b32 s89, s89, 0xffff
s_mov_b32 s90, L_code_end-L_ct2_129
s_mov_b32 s91, 0x20000
v_and_b32 v62, 0x70, v59
v_lshlrev_b32 v62, 3, v62
s_add_u32 s7, s1, 4096
buffer_load_dword v3, v62, s[88:91], s7 offen
MA 104,20,144
T 40,26,48
MA 108,20,148
T 42,26,52
W 6
MA 112,24,144
G 41,20,66,1
MA 116,24,148
T 44,27,48
T 46,27,52
MA 120,28,144
T 48,28,48
MA 124,28,148
T 50,28,52
W 6
MA 64,32,152
G 42,20,66,2
MA 68,32,156
T 52,29,48
T 54,29,52
MA 72,36,152
T 56,30,48
MA 76,36,156
T 58,30,52
W 6
MA 80,40,152
G 43,20,66,3
MA 84,40,156
T 60,31,48
T 62,31,52
MA 88,44,152
s_waitcnt vmcnt(13)
s_barrier
T 0,16,0
MA 92,44,156
T 2,16,4
s_xor_b32 m0, s65, 0x14000
s_xor_b32 s66, s61, 0x240200
W 6
MA 96,48,152
G 40,20,66,0
MA 100,48,156
T 4,17,0
T 6,17,4
MA 104,52,152
T 8,18,0
MA 108,52,156
T 10,18,4
W 6
MA 112,56,152
G 41,20,66,1
MA 116,56,156
T 12,19,0
T 14,19,4
MA 120,60,152
T 16,20,0
MA 124,60,156
T 18,20,4
W 6
MA 64,0,160
G 42,20,66,2
MA 68,0,164
T 20,21,0
T 22,21,4
MA 72,4,160
T 24,22,0
MA 76,4,164
T 26,22,4
W 6
MA 80,8,160
G 43,20,66,3
MA 84,8,164
T 28,23,0
T 30,23,4
MA 88,12,160
T 32,16,16
T 34,16,20
MA 92,12,164
s_xor_b32 m0, s65, 0x18000
s_xor_b32 s66, s61, 0x280200
W 6
MA 96,16,160
G 40,20,66,0
MA 100,16,164
T 36,17,16
T 38,17,20
MA 104,20,160
T 40,18,16
MA 108,20,164
T 42,18,20
W 6
MA 112,24,160
G 41,20,66,1
MA 116,24,164
T 44,19,16
T 46,19,20
MA 120,28,160
T 48,20,16
MA 124,28,164
T 50,20,20
W 6
MA 64,32,168
G 42,20,66,2
MA 68,32,172
T 52,21,16
T 54,21,20
MA 72,36,168
T 56,22,16
MA 76,36,172
T 58,22,20
W 6
MA 80,40,168
G 43,20,66,3
MA 84,40,172
T 60,23,16
T 62,23,20
MA 88,44,168
s_waitcnt vmcnt(13)
s_barrier
T 0,16,32
MA 92,44,172
T 2,16,36
s_xor_b32 m0, s65, 0x1c000
s_xor_b32 s66, s61, 0x2c0200
W 6
MA 96,48,168
G 40,20,66,0
MA 100,48,172
T 4,17,32
T 6,17,36
MA 104,52,168
T 8,18,32
MA 108,52,172
T 10,18,36
W 6
MA 112,56,168
G 41,20,66,1
MA 116,56,172
T 12,19,32
T 14,19,36
MA 120,60,168
T 16,20,32
MA 124,60,172
T 18,20,36
W 6
MA 64,0,176
G 42,20,66,2
MA 68,0,180
T 20,21,32
T 22,21,36
MA 72,4,176
T 24,22,32
MA 76,4,180
T 26,22,36
W 6
MA 80,8,176
G 43,20,66,3
MA 84,8,180
T 28,23,32
T 30,23,36
MA 88,12,176
T 32,16,48
T 34,16,52
MA 92,12,180
s_xor_b32 m0, s65, 0x0
s_xor_b32 s66, s61, 0x300200
W 6
MA 96,16,176
G 40,20,66,0
MA 100,16,180
T 36,17,48
T 38,17,52
MA 104,20,176
T 40,18,48
MA 108,20,180
T 42,18,52
W 6
MA 112,24,176
G 41,20,66,1
MA 116,24,180
T 44,19,48
T 46,19,52
MA 120,28,176
T 48,20,48
MA 124,28,180
T 50,20,52
W 6
MA 64,32,184
G 42,20,66,2
MA 68,32,188
T 52,21,48
T 54,21,52
MA 72,36,184
T 56,22,48
MA 76,36,188
T 58,22,52
W 6
MA 80,40,184
G 43,20,66,3
MA 84,40,188
T 60,23,48
T 62,23,52
MA 88,44,184
s_waitcnt vmcnt(12)
s_barrier
T 0,24,0
MA 92,44,188
T 2,24,4
s_xor_b32 m0, s65, 0x4000
s_xor_b32 s66, s61, 0x340200
W 6
MA 96,48,184
G 40,20,66,0
MA 100,48,188
T 4,25,0
T 6,25,4
MA 104,52,184
T 8,26,0
MA 108,52,188
T 10,26,4
W 6
MA 112,56,184
G 41,20,66,1
MA 116,56,188
T 12,27,0
T 14,27,4
MA 120,60,184
T 16,28,0
MA 124,60,188
T 18,28,4
W 6
MA 64,0,192
G 42,20,66,2
MA 68,0,196
T 20,29,0
T 22,29,4
MA 72,4,192
T 24,30,0
MA 76,4,196
T 26,30,4
W 6
MA 80,8,192
G 43,20,66,3
MA 84,8,196
T 28,31,0
T 30,31,4
MA 88,12,192
T 32,24,16
T 34,24,20
MA 92,12,196
s_xor_b32 m0, s65, 0x8000
s_xor_b32 s66, s61, 0x380200
W 6
MA 96,16,192
G 40,20,66,0
MA 100,16,196
T 36,25,16
T 38,25,20
MA 104,20,192
T 40,26,16
MA 108,20,196
T 42,26,20
W 6
MA 112,24,192
G 41,20,66,1
MA 116,24,196
T 44,27,16
T 46,27,20
MA 120,28,192
T 48,28,16
MA 124,28,196
T 50,28,20
W 6
MA 64,32,200
G 42,20,66,2
MA 68,32,204
T 52,29,16
T 54,29,20
MA 72,36,200
T 56,30,16
MA 76,36,204
T 58,30,20
W 6
MA 80,40,200
G 43,20,66,3
MA 84,40,204
T 60,31,16
T 62,31,20
MA 88,44,200
s_waitcnt vmcnt(12)
s_barrier
T 0,24,32
MA 92,44,204
T 2,24,36
s_xor_b32 m0, s65, 0xc000
s_xor_b32 s66, s61, 0x3c0200
W 6
MA 96,48,200
G 40,20,66,0
MA 100,48,204
T 4,25,32
T 6,25,36
MA 104,52,200
T 8,26,32
MA 108,52,204
T 10,26,36
W 6
MA 112,56,200
G 41,20,66,1
MA 116,56,204
T 12,27,32
T 14,27,36
MA 120,60,200
T 16,28,32
MA 124,60,204
T 18,28,36
W 6
MA 64,0,208
G 42,20,66,2
MA 68,0,212
T 20,29,32
T 22,29,36
MA 72,4,208
T 24,30,32
MA 76,4,212
T 26,30,36
W 6
MA 80,8,208
G 43,20,66,3
MA 84,8,212
T 28,31,32
T 30,31,36
MA 88,12,208
T 32,24,48
T 34,24,52
MA 92,12,212
s_xor_b32 m0, s65, 0x10000
s_xor_b32 s66, s60, 0x0
W 6
MA 96,16,208
G 36,28,66,0
MA 100,16,212
T 36,25,48
T 38,25,52
MA 104,20,208
T 40,26,48
MA 108,20,212
T 42,26,52
W 6
MA 112,24,208
G 37,28,66,1
MA 116,24,212
T 44,27,48
T 46,27,52
MA 120,28,208
T 48,28,48
MA 124,28,212
T 50,28,52
W 6
MA 64,32,216
G 38,28,66,2
MA 68,32,220
T 52,29,48
T 54,29,52
MA 72,36,216
T 56,30,48
MA 76,36,220
T 58,30,52
W 6
MA 80,40,216
G 39,28,66,3
MA 84,40,220
T 60,31,48
T 62,31,52
MA 88,44,216
s_waitcnt vmcnt(12)
s_barrier
T 0,16,0
MA 92,44,220
T 2,16,4
s_xor_b32 m0, s65, 0x14000
s_xor_b32 s66, s61, 0x0
W 6
MA 96,48,216
G 40,40,66,0
MA 100,48,220
T 4,17,0
T 6,17,4
MA 104,52,216
T 8,18,0
MA 108,52,220
T 10,18,4
W 6
MA 112,56,216
G 41,40,66,1
MA 116,56,220
T 12,19,0
T 14,19,4
MA 120,60,216
T 16,20,0
MA 124,60,220
T 18,20,4
W 6
MA 64,0,224
G 42,40,66,2
MA 68,0,228
T 20,21,0
T 22,21,4
MA 72,4,224
T 24,22,0
MA 76,4,228
T 26,22,4
W 6
MA 80,8,224
G 43,40,66,3
MA 84,8,228
T 28,23,0
T 30,23,4
MA 88,12,224
T 32,16,16
T 34,16,20
MA 92,12,228
s_xor_b32 m0, s65, 0x18000
s_xor_b32 s66, s61, 0x40000
W 6
MA 96,16,224
G 40,40,66,0
MA 100,16,228
T 36,17,16
T 38,17,20
MA 104,20,224
T 40,18,16
MA 108,20,228
T 42,18,20
W 6
MA 112,24,224
G 41,40,66,1
MA 116,24,228
T 44,19,16
T 46,19,20
MA 120,28,224
T 48,20,16
MA 124,28,228
T 50,20,20
W 6
MA 64,32,232
G 42,40,66,2
MA 68,32,236
T 52,21,16
T 54,21,20
MA 72,36,232
T 56,22,16
MA 76,36,236
T 58,22,20
W 6
MA 80,40,232
G 43,40,66,3
MA 84,40,236
T 60,23,16
T 62,23,20
MA 88,44,232
s_waitcnt vmcnt(12)
s_barrier
T 0,16,32
MA 92,44,236
T 2,16,36
s_xor_b32 m0, s65, 0x1c000
s_xor_b32 s66, s60, 0x100
W 6
MA 96,48,232
G 36,28,66,0
MA 100,48,236
T 4,17,32
T 6,17,36
MA 104,52,232
T 8,18,32
MA 108,52,236
T 10,18,36
W 6
MA 112,56,232
G 37,28,66,1
MA 116,56,236
T 12,19,32
T 14,19,36
MA 120,60,232
T 16,20,32
MA 124,60,236
T 18,20,36
W 6
MA 64,0,240
G 38,28,66,2
MA 68,0,244
T 20,21,32
T 22,21,36
MA 72,4,240
T 24,22,32
MA 76,4,244
T 26,22,36
W 6
MA 80,8,240
G 39,28,66,3
MA 84,8,244
T 28,23,32
T 30,23,36
MA 88,12,240
T 32,16,48
T 34,16,52
MA 92,12,244
s_xor_b32 m0, s65, 0x0
s_xor_b32 s66, s61, 0x80000
W 6
MA 96,16,240
G 40,40,66,0
MA 100,16,244
T 36,17,48
T 38,17,52
MA 104,20,240
T 40,18,48
MA 108,20,244
T 42,18,52
W 6
MA 112,24,240
G 41,40,66,1
MA 116,24,244
T 44,19,48
T 46,19,52
MA 120,28,240
T 48,20,48
MA 124,28,244
T 50,20,52
W 6
MA 64,32,248
G 42,40,66,2
MA 68,32,252
T 52,21,48
T 54,21,52
MA 72,36,248
T 56,22,48
MA 76,36,252
T 58,22,52
W 6
MA 80,40,248
G 43,40,66,3
MA 84,40,252
T 60,23,48
T 62,23,52
MA 88,44,248
MA 92,44,252
W 4
MA 96,48,248
MA 100,48,252
MA 104,52,248
MA 108,52,252
W 0
MA 112,56,248
MA 116,56,252
MA 120,60,248
MA 124,60,252
v_pk_mul_f32 v[64:65], v[64:65], s[74:75]
v_pk_mul_f32 v[66:67], v[66:67], s[74:75]
v_pk_mul_f32 v[68:69], v[68:69], s[74:75]
v_pk_mul_f32 v[70:71], v[70:71], s[74:75]
v_pk_mul_f32 v[72:73], v[72:73], s[74:75]
v_pk_mul_f32 v[74:75], v[74:75], s[74:75]
v_pk_mul_f32 v[76:77], v[76:77], s[74:75]
v_pk_mul_f32 v[78:79], v[78:79], s[74:75]
CV 64,64
CV 66,66
CV 68,68
CV 70,70
CV 72,72
CV 74,74
CV 76,76
CV 78,78
v_permlane32_swap_b32 v64, v72
v_permlane32_swap_b32 v66, v74
v_permlane32_swap_b32 v68, v76
v_permlane32_swap_b32 v70, v78
v_permlane16_swap_b32 v64, v72
v_permlane16_swap_b32 v66, v74
v_permlane16_swap_b32 v68, v76
v_permlane16_swap_b32 v70, v78
AW 96,64
AW 97,66
AW 98,72
AW 99,74
AW 100,68
AW 101,70
AW 102,76
AW 103,78
v_pk_mul_f32 v[80:81], v[80:81], s[74:75]
v_pk_mul_f32 v[82:83], v[82:83], s[74:75]
v_pk_mul_f32 v[84:85], v[84:85], s[74:75]
v_pk_mul_f32 v[86:87], v[86:87], s[74:75]
v_pk_mul_f32 v[88:89], v[88:89], s[74:75]
v_pk_mul_f32 v[90:91], v[90:91], s[74:75]
v_pk_mul_f32 v[92:93], v[92:93], s[74:75]
v_pk_mul_f32 v[94:95], v[94:95], s[74:75]
CV 80,80
CV 82,82
CV 84,84
CV 86,86
CV 88,88
CV 90,90
CV 92,92
CV 94,94
v_permlane32_swap_b32 v80, v88
v_permlane32_swap_b32 v82, v90
v_permlane32_swap_b32 v84, v92
v_permlane32_swap_b32 v86, v94
v_permlane16_swap_b32 v80, v88
v_permlane16_swap_b32 v82, v90
v_permlane16_swap_b32 v84, v92
v_permlane16_swap_b32 v86, v94
AW 104,80
AW 105,82
AW 106,88
AW 107,90
AW 108,84
AW 109,86
AW 110,92
AW 111,94
v_pk_mul_f32 v[96:97], v[96:97], s[74:75]
v_pk_mul_f32 v[98:99], v[98:99], s[74:75]
v_pk_mul_f32 v[100:101], v[100:101], s[74:75]
v_pk_mul_f32 v[102:103], v[102:103], s[74:75]
v_pk_mul_f32 v[104:105], v[104:105], s[74:75]
v_pk_mul_f32 v[106:107], v[106:107], s[74:75]
v_pk_mul_f32 v[108:109], v[108:109], s[74:75]
v_pk_mul_f32 v[110:111], v[110:111], s[74:75]
CV 96,96
CV 98,98
CV 100,100
CV 102,102
CV 104,104
CV 106,106
CV 108,108
CV 110,110
v_permlane32_swap_b32 v96, v104
v_permlane32_swap_b32 v98, v106
v_permlane32_swap_b32 v100, v108
v_permlane32_swap_b32 v102, v110
v_permlane16_swap_b32 v96, v104
v_permlane16_swap_b32 v98, v106
v_permlane16_swap_b32 v100, v108
v_permlane16_swap_b32 v102, v110
AW 112,96
AW 113,98
AW 114,104
AW 115,106
AW 116,100
AW 117,102
AW 118,108
AW 119,110
v_pk_mul_f32 v[112:113], v[112:113], s[74:75]
v_pk_mul_f32 v[114:115], v[114:115], s[74:75]
v_pk_mul_f32 v[116:117], v[116:117], s[74:75]
v_pk_mul_f32 v[118:119], v[118:119], s[74:75]
v_pk_mul_f32 v[120:121], v[120:121], s[74:75]
v_pk_mul_f32 v[122:123], v[122:123], s[74:75]
v_pk_mul_f32 v[124:125], v[124:125], s[74:75]
v_pk_mul_f32 v[126:127], v[126:127], s[74:75]
CV 112,112
CV 114,114
CV 116,116
CV 118,118
CV 120,120
CV 122,122
CV 124,124
CV 126,126
v_permlane32_swap_b32 v112, v120
v_permlane32_swap_b32 v114, v122
v_permlane32_swap_b32 v116, v124
v_permlane32_swap_b32 v118, v126
v_permlane16_swap_b32 v112, v120
v_permlane16_swap_b32 v114, v122
v_permlane16_swap_b32 v116, v124
v_permlane16_swap_b32 v118, v126
AW 120,112
AW 121,114
AW 122,120
AW 123,122
AW 124,116
AW 125,118
AW 126,124
AW 127,126
s_waitcnt vmcnt(12)
s_barrier
R v,128,12,0
R v,132,12,4
R v,136,13,0
R v,140,13,4
R v,144,14,0
R v,148,14,4
R v,152,15,0
R v,156,15,4
T 0,24,16
T 2,24,20
T 4,25,16
T 6,25,20
T 8,26,16
T 10,26,20
T 12,27,16
W 14
T 14,27,20
W 14
T 16,28,16
W 14
T 18,28,20
s_xor_b32 m0, s65, 0x4000
s_xor_b32 s66, s61, 0xc0000
G 40,40,66,0
G 41,40,66,1
G 42,40,66,2
W 6
ZA 64,0,128
G 43,40,66,3
s_xor_b32 m0, s65, 0x8000
s_xor_b32 s66, s61, 0x100000
ZA 68,0,132
G 40,40,66,0
G 41,40,66,1
T 20,29,16
T 22,29,20
ZA 72,4,128
G 42,40,66,2
G 43,40,66,3
s_xor_b32 m0, s65, 0xc000
ZA 76,4,132
s_xor_b32 s66, s61, 0x140000
G 40,40,66,0
T 24,30,16
T 26,30,20
W 6
ZA 80,8,128
G 41,40,66,1
G 42,40,66,2
ZA 84,8,132
G 43,40,66,3
T 28,31,16
T 30,31,20
ZA 88,12,128
s_waitcnt vmcnt(16)
s_barrier
T 32,24,32
ZA 92,12,132
T 34,24,36
s_xor_b32 m0, s65, 0x10000
s_xor_b32 s66, s60, 0x200
W 6
ZA 96,16,128
G 36,28,66,0
ZA 100,16,132
T 36,25,32
T 38,25,36
ZA 104,20,128
T 40,26,32
ZA 108,20,132
T 42,26,36
W 6
ZA 112,24,128
G 37,28,66,1
ZA 116,24,132
T 44,27,32
T 46,27,36
ZA 120,28,128
T 48,28,32
ZA 124,28,132
T 50,28,36
W 6
MA 64,32,136
G 38,28,66,2
MA 68,32,140
T 52,29,32
T 54,29,36
R v,160,12,48
MA 72,36,136
T 56,30,32
MA 76,36,140
T 58,30,36
R v,164,12,52
W 8
MA 80,40,136
G 39,28,66,3
MA 84,40,140
T 60,31,32
T 62,31,36
R v,168,13,48
MA 88,44,136
s_waitcnt vmcnt(12)
s_barrier
R v,172,13,52
MA 92,44,140
T 0,16,0
T 2,16,4
s_xor_b32 m0, s65, 0x14000
s_xor_b32 s66, s61, 0x180000
W 10
MA 96,48,136
G 40,40,66,0
MA 100,48,140
R v,176,14,48
T 4,17,0
T 6,17,4
MA 104,52,136
R v,180,14,52
MA 108,52,140
T 8,18,0
W 14
T 10,18,4
W 10
MA 112,56,136
G 41,40,66,1
MA 116,56,140
R v,184,15,48
T 12,19,0
T 14,19,4
MA 120,60,136
R v,188,15,52
MA 124,60,140
T 16,20,0
W 14
T 18,20,4
W 9
MA 64,0,144
G 42,40,66,2
MA 68,0,148
T 20,21,0
T 22,21,4
MA 72,4,144
T 24,22,0
MA 76,4,148
T 26,22,4
W 7
MA 80,8,144
G 43,40,66,3
MA 84,8,148
T 28,23,0
T 30,23,4
MA 88,12,144
T 32,16,16
MA 92,12,148
T 34,16,20
W 6
MA 96,16,144
T 36,17,16
MA 100,16,148
T 38,17,20
s_getpc_b64 s[88:89]
L_ct2_258:
s_and_b32 s89, s89, 0xffff
s_mov_b32 s90, L_code_end-L_ct2_258
s_mov_b32 s91, 0x20000
v_and_b32 v62, 0x70, v59
v_lshlrev_b32 v62, 3, v62
s_add_u32 s7, s1, 4096
buffer_load_dword v3, v62, s[88:91], s7 offen
MA 104,20,144
T 40,18,16
MA 108,20,148
T 42,18,20
W 6
MA 112,24,144
T 44,19,16
MA 116,24,148
T 46,19,20
MA 120,28,144
T 48,20,16
MA 124,28,148
T 50,20,20
W 6
MA 64,32,152
T 52,21,16
MA 68,32,156
T 54,21,20
MA 72,36,152
T 56,22,16
MA 76,36,156
T 58,22,20
W 6
MA 80,40,152
T 60,23,16
MA 84,40,156
T 62,23,20
MA 88,44,152
s_waitcnt vmcnt(9)
s_barrier
T 0,16,32
MA 92,44,156
T 2,16,36
s_xor_b32 m0, s65, 0x18000
s_xor_b32 s66, s61, 0x1c0000
W 6
MA 96,48,152
G 40,40,66,0
MA 100,48,156
T 4,17,32
T 6,17,36
MA 104,52,152
G 41,40,66,1
MA 108,52,156
T 8,18,32
T 10,18,36
W 6
MA 112,56,152
G 42,40,66,2
MA 116,56,156
T 12,19,32
T 14,19,36
MA 120,60,152
G 43,40,66,3
T 16,20,32
MA 124,60,156
T 18,20,36
s_xor_b32 m0, s65, 0x1c000
s_xor_b32 s66, s61, 0x200000
W 6
MA 64,0,160
G 40,40,66,0
MA 68,0,164
T 20,21,32
T 22,21,36
MA 72,4,160
G 41,40,66,1
MA 76,4,164
T 24,22,32
T 26,22,36
W 6
MA 80,8,160
G 42,40,66,2
MA 84,8,164
T 28,23,32
T 30,23,36
MA 88,12,160
G 43,40,66,3
T 32,16,48
MA 92,12,164
T 34,16,52
s_xor_b32 m0, s65, 0x0
s_xor_b32 s66, s61, 0x240000
W 6
MA 96,16,160
G 40,40,66,0
MA 100,16,164
T 36,17,48
T 38,17,52
MA 104,20,160
G 41,40,66,1
MA 108,20,164
T 40,18,48
T 42,18,52
W 6
MA 112,24,160
G 42,40,66,2
MA 116,24,164
T 44,19,48
T 46,19,52
MA 120,28,160
G 43,40,66,3
MA 124,28,164
T 48,20,48
T 50,20,52
W 6
MA 64,32,168
s_waitcnt vmcnt(13)
s_barrier
T 52,21,48
MA 68,32,172
T 54,21,52
R v,192,12,0
s_xor_b32 m0, s65, 0x4000
s_xor_b32 s66, s60, 0x300
MA 72,36,168
G 36,28,66,0
MA 76,36,172
T 56,22,48
T 58,22,52
R v,196,12,4
W 8
MA 80,40,168
G 37,28,66,1
MA 84,40,172
T 60,23,48
T 62,23,52
R v,200,13,0
MA 88,44,168
G 38,28,66,2
MA 92,44,172
R v,204,13,4
T 0,24,16
T 2,24,20
W 10
MA 96,48,168
R v,208,14,0
MA 100,48,172
T 4,25,16
T 6,25,20
MA 104,52,168
G 39,28,66,3
R v,212,14,4
MA 108,52,172
T 8,26,16
W 14
T 10,26,20
s_xor_b32 m0, s65, 0x8000
s_xor_b32 s66, s61, 0x280000
W 10
MA 112,56,168
G 40,40,66,0
MA 116,56,172
R v,216,15,0
T 12,27,16
T 14,27,20
MA 120,60,168
G 41,40,66,1
MA 124,60,172
R v,220,15,4
T 16,28,16
W 14
T 18,28,20
W 9
MA 64,0,176
T 20,29,16
MA 68,0,180
T 22,29,20
MA 72,4,176
G 42,40,66,2
MA 76,4,180
T 24,30,16
T 26,30,20
W 7
MA 80,8,176
G 43,40,66,3
MA 84,8,180
T 28,31,16
T 30,31,20
MA 88,12,176
s_waitcnt vmcnt(12) lgkmcnt(8)
s_barrier
T 32,24,32
MA 92,12,180
T 34,24,36
s_xor_b32 m0, s65, 0xc000
s_xor_b32 s66, s61, 0x2c0000
W 6
MA 96,16,176
G 40,40,66,0
MA 100,16,180
T 36,25,32
T 38,25,36
MA 104,20,176
T 40,26,32
MA 108,20,180
T 42,26,36
W 6
MA 112,24,176
G 41,40,66,1
MA 116,24,180
T 44,27,32
T 46,27,36
MA 120,28,176
T 48,28,32
MA 124,28,180
T 50,28,36
W 6
MA 64,32,184
G 42,40,66,2
MA 68,32,188
T 52,29,32
T 54,29,36
MA 72,36,184
T 56,30,32
MA 76,36,188
T 58,30,36
W 6
MA 80,40,184
G 43,40,66,3
MA 84,40,188
T 60,31,32
T 62,31,36
MA 88,44,184
T 0,24,48
T 2,24,52
MA 92,44,188
s_xor_b32 m0, s65, 0x10000
s_xor_b32 s66, s61, 0x300000
W 6
MA 96,48,184
G 40,40,66,0
MA 100,48,188
T 4,25,48
T 6,25,52
MA 104,52,184
T 8,26,48
MA 108,52,188
T 10,26,52
W 6
MA 112,56,184
G 41,40,66,1
MA 116,56,188
T 12,27,48
T 14,27,52
MA 120,60,184
T 16,28,48
MA 124,60,188
T 18,28,52
W 6
MA 64,0,192
G 42,40,66,2
MA 68,0,196
T 20,29,48
T 22,29,52
MA 72,4,192
T 24,30,48
MA 76,4,196
T 26,30,52
W 6
MA 80,8,192
G 43,40,66,3
MA 84,8,196
T 28,31,48
T 30,31,52
MA 88,12,192
s_waitcnt vmcnt(12)
s_barrier
s_xor_b32 m0, s65, 0x14000
s_xor_b32 s66, s61, 0x340000
MA 92,12,196
G 40,40,66,0
T 32,16,0
T 34,16,4
W 6
MA 96,16,192
G 41,40,66,1
MA 100,16,196
T 36,17,0
T 38,17,4
MA 104,20,192
G 42,40,66,2
MA 108,20,196
T 40,18,0
T 42,18,4
W 6
MA 112,24,192
G 43,40,66,3
MA 116,24,196
T 44,19,0
T 46,19,4
MA 120,28,192
s_xor_b32 m0, s65, 0x18000
s_xor_b32 s66, s61, 0x380000
MA 124,28,196
G 40,40,66,0
T 48,20,0
T 50,20,4
W 6
MA 64,32,200
G 41,40,66,1
MA 68,32,204
T 52,21,0
T 54,21,4
R v,224,8,16
MA 72,36,200
G 42,40,66,2
MA 76,36,204
T 56,22,0
T 58,22,4
R v,228,8,20
W 8
MA 80,40,200
G 43,40,66,3
MA 84,40,204
T 60,23,0
T 62,23,4
R v,232,9,16
MA 88,44,200
s_waitcnt vmcnt(12)
s_barrier
R v,236,9,20
MA 92,44,204
T 0,16,32
T 2,16,36
s_xor_b32 m0, s65, 0x1c000
s_xor_b32 s66, s61, 0x3c0000
W 10
MA 96,48,200
G 40,40,66,0
MA 100,48,204
R v,240,10,16
T 4,17,32
T 6,17,36
MA 104,52,200
R v,244,10,20
MA 108,52,204
T 8,18,32
W 14
T 10,18,36
W 10
MA 112,56,200
G 41,40,66,1
MA 116,56,204
R v,248,11,16
T 12,19,32
T 14,19,36
MA 120,60,200
R v,252,11,20
T 16,20,32
MA 124,60,204
W 14
T 18,20,36
v_xor_b32 v8, s69, v8
W 9
MA 64,0,208
G 42,40,66,2
MA 68,0,212
T 20,21,32
T 22,21,36
v_xor_b32 v9, s69, v9
MA 72,4,208
T 24,22,32
MA 76,4,212
T 26,22,36
v_xor_b32 v10, s69, v10
W 7
MA 80,8,208
G 43,40,66,3
MA 84,8,212
T 28,23,32
T 30,23,36
v_xor_b32 v11, s69, v11
MA 88,12,208
T 32,16,48
MA 92,12,212
T 34,16,52
v_xor_b32 v12, s69, v12
W 6
MA 96,16,208
T 36,17,48
MA 100,16,212
T 38,17,52
v_xor_b32 v13, s69, v13
MA 104,20,208
T 40,18,48
MA 108,20,212
T 42,18,52
v_xor_b32 v14, s69, v14
W 6
MA 112,24,208
T 44,19,48
MA 116,24,212
T 46,19,52
v_xor_b32 v15, s69, v15
MA 120,28,208
T 48,20,48
MA 124,28,212
T 50,20,52
W 6
MA 64,32,216
T 52,21,48
MA 68,32,220
T 54,21,52
MA 72,36,216
T 56,22,48
MA 76,36,220
T 58,22,52
W 6
MA 80,40,216
T 60,23,48
MA 84,40,220
T 62,23,52
MA 88,44,216
s_waitcnt vmcnt(8)
s_barrier
T 0,24,0
MA 92,44,220
T 2,24,4
s_xor_b32 m0, s65, 0x0
s_xor_b32 s66, s61, 0x200
W 6
MA 96,48,216
G 40,40,66,0
MA 100,48,220
T 4,25,0
T 6,25,4
MA 104,52,216
G 41,40,66,1
MA 108,52,220
T 8,26,0
T 10,26,4
W 6
MA 112,56,216
G 42,40,66,2
MA 116,56,220
T 12,27,0
T 14,27,4
MA 120,60,216
T 16,28,0
MA 124,60,220
T 18,28,4
W 6
MA 64,0,224
G 43,40,66,3
T 20,29,0
MA 68,0,228
T 22,29,4
s_xor_b32 m0, s65, 0x4000
s_xor_b32 s66, s61, 0x40200
MA 72,4,224
G 40,40,66,0
MA 76,4,228
T 24,30,0
T 26,30,4
W 6
MA 80,8,224
G 41,40,66,1
MA 84,8,228
T 28,31,0
T 30,31,4
MA 88,12,224
T 32,24,16
MA 92,12,228
T 34,24,20
W 6
MA 96,16,224
G 42,40,66,2
MA 100,16,228
T 36,25,16
T 38,25,20
MA 104,20,224
G 43,40,66,3
T 40,26,16
MA 108,20,228
T 42,26,20
s_xor_b32 m0, s65, 0x8000
s_xor_b32 s66, s61, 0x80200
W 6
MA 112,24,224
G 40,40,66,0
MA 116,24,228
T 44,27,16
T 46,27,20
MA 120,28,224
T 48,28,16
MA 124,28,228
T 50,28,20
W 6
MA 64,32,232
G 41,40,66,1
MA 68,32,236
T 52,29,16
T 54,29,20
MA 72,36,232
G 42,40,66,2
MA 76,36,236
T 56,30,16
T 58,30,20
W 6
MA 80,40,232
G 43,40,66,3
MA 84,40,236
T 60,31,16
T 62,31,20
MA 88,44,232
s_waitcnt vmcnt(12)
s_barrier
T 0,24,32
MA 92,44,236
T 2,24,36
s_xor_b32 m0, s65, 0xc000
s_xor_b32 s66, s61, 0xc0200
W 6
MA 96,48,232
G 40,40,66,0
MA 100,48,236
T 4,25,32
T 6,25,36
MA 104,52,232
T 8,26,32
MA 108,52,236
T 10,26,36
W 6
MA 112,56,232
G 41,40,66,1
MA 116,56,236
T 12,27,32
T 14,27,36
MA 120,60,232
T 16,28,32
MA 124,60,236
T 18,28,36
W 6
MA 64,0,240
G 42,40,66,2
MA 68,0,244
T 20,29,32
T 22,29,36
MA 72,4,240
T 24,30,32
MA 76,4,244
T 26,30,36
W 6
MA 80,8,240
G 43,40,66,3
MA 84,8,244
T 28,31,32
T 30,31,36
MA 88,12,240
T 32,24,48
T 34,24,52
MA 92,12,244
s_xor_b32 m0, s65, 0x10000
s_xor_b32 s66, s61, 0x100200
W 6
MA 96,16,240
G 40,40,66,0
MA 100,16,244
T 36,25,48
T 38,25,52
MA 104,20,240
T 40,26,48
MA 108,20,244
T 42,26,52
W 6
MA 112,24,240
G 41,40,66,1
MA 116,24,244
T 44,27,48
T 46,27,52
MA 120,28,240
T 48,28,48
MA 124,28,244
T 50,28,52
W 6
MA 64,32,248
G 42,40,66,2
MA 68,32,252
T 52,29,48
T 54,29,52
MA 72,36,248
T 56,30,48
MA 76,36,252
T 58,30,52
W 6
MA 80,40,248
G 43,40,66,3
MA 84,40,252
T 60,31,48
T 62,31,52
MA 88,44,248
s_waitcnt vmcnt(12)
s_barrier
T 0,16,0
MA 92,44,252
T 2,16,4
s_xor_b32 m0, s65, 0x14000
s_xor_b32 s66, s61, 0x140200
W 6
MA 96,48,248
G 40,40,66,0
MA 100,48,252
T 4,17,0
T 6,17,4
MA 104,52,248
T 8,18,0
MA 108,52,252
T 10,18,4
W 6
MA 112,56,248
G 41,40,66,1
MA 116,56,252
T 12,19,0
T 14,19,4
MA 120,60,248
T 16,20,0
MA 124,60,252
T 18,20,4
v_pk_mul_f32 v[64:65], v[64:65], s[74:75]
v_pk_mul_f32 v[66:67], v[66:67], s[74:75]
v_pk_mul_f32 v[68:69], v[68:69], s[74:75]
v_pk_mul_f32 v[70:71], v[70:71], s[74:75]
v_pk_mul_f32 v[72:73], v[72:73], s[74:75]
v_pk_mul_f32 v[74:75], v[74:75], s[74:75]
v_pk_mul_f32 v[76:77], v[76:77], s[74:75]
v_pk_mul_f32 v[78:79], v[78:79], s[74:75]
CV 64,64
CV 66,66
CV 68,68
CV 70,70
CV 72,72
CV 74,74
CV 76,76
CV 78,78
v_permlane32_swap_b32 v64, v72
v_permlane32_swap_b32 v66, v74
v_permlane32_swap_b32 v68, v76
v_permlane32_swap_b32 v70, v78
v_permlane16_swap_b32 v64, v72
v_permlane16_swap_b32 v66, v74
v_permlane16_swap_b32 v68, v76
v_permlane16_swap_b32 v70, v78
AW 128,64
AW 129,66
AW 130,72
AW 131,74
AW 132,68
AW 133,70
AW 134,76
AW 135,78
v_pk_mul_f32 v[80:81], v[80:81], s[74:75]
v_pk_mul_f32 v[82:83], v[82:83], s[74:75]
v_pk_mul_f32 v[84:85], v[84:85], s[74:75]
v_pk_mul_f32 v[86:87], v[86:87], s[74:75]
v_pk_mul_f32 v[88:89], v[88:89], s[74:75]
v_pk_mul_f32 v[90:91], v[90:91], s[74:75]
v_pk_mul_f32 v[92:93], v[92:93], s[74:75]
v_pk_mul_f32 v[94:95], v[94:95], s[74:75]
CV 80,80
CV 82,82
CV 84,84
CV 86,86
CV 88,88
CV 90,90
CV 92,92
CV 94,94
v_permlane32_swap_b32 v80, v88
v_permlane32_swap_b32 v82, v90
v_permlane32_swap_b32 v84, v92
v_permlane32_swap_b32 v86, v94
v_permlane16_swap_b32 v80, v88
v_permlane16_swap_b32 v82, v90
v_permlane16_swap_b32 v84, v92
v_permlane16_swap_b32 v86, v94
AW 136,80
AW 137,82
AW 138,88
AW 139,90
AW 140,84
AW 141,86
AW 142,92
AW 143,94
v_pk_mul_f32 v[96:97], v[96:97], s[74:75]
v_pk_mul_f32 v[98:99], v[98:99], s[74:75]
v_pk_mul_f32 v[100:101], v[100:101], s[74:75]
v_pk_mul_f32 v[102:103], v[102:103], s[74:75]
v_pk_mul_f32 v[104:105], v[104:105], s[74:75]
v_pk_mul_f32 v[106:107], v[106:107], s[74:75]
v_pk_mul_f32 v[108:109], v[108:109], s[74:75]
v_pk_mul_f32 v[110:111], v[110:111], s[74:75]
CV 96,96
CV 98,98
CV 100,100
CV 102,102
CV 104,104
CV 106,106
CV 108,108
CV 110,110
v_permlane32_swap_b32 v96, v104
v_permlane32_swap_b32 v98, v106
v_permlane32_swap_b32 v100, v108
v_permlane32_swap_b32 v102, v110
v_permlane16_swap_b32 v96, v104
v_permlane16_swap_b32 v98, v106
v_permlane16_swap_b32 v100, v108
v_permlane16_swap_b32 v102, v110
AW 144,96
AW 145,98
AW 146,104
AW 147,106
AW 148,100
AW 149,102
AW 150,108
AW 151,110
v_pk_mul_f32 v[112:113], v[112:113], s[74:75]
v_pk_mul_f32 v[114:115], v[114:115], s[74:75]
v_pk_mul_f32 v[116:117], v[116:117], s[74:75]
v_pk_mul_f32 v[118:119], v[118:119], s[74:75]
v_pk_mul_f32 v[120:121], v[120:121], s[74:75]
v_pk_mul_f32 v[122:123], v[122:123], s[74:75]
v_pk_mul_f32 v[124:125], v[124:125], s[74:75]
v_pk_mul_f32 v[126:127], v[126:127], s[74:75]
CV 112,112
CV 114,114
CV 116,116
CV 118,118
CV 120,120
CV 122,122
CV 124,124
CV 126,126
v_permlane32_swap_b32 v112, v120
v_permlane32_swap_b32 v114, v122
v_permlane32_swap_b32 v116, v124
v_permlane32_swap_b32 v118, v126
v_permlane16_swap_b32 v112, v120
v_permlane16_swap_b32 v114, v122
v_permlane16_swap_b32 v116, v124
v_permlane16_swap_b32 v118, v126
AW 152,112
AW 153,114
AW 154,120
AW 155,122
AW 156,116
AW 157,118
AW 158,124
AW 159,126
W 6
ZA 64,0,128
G 42,40,66,2
ZA 68,0,132
T 20,21,0
T 22,21,4
ZA 72,4,128
T 24,22,0
ZA 76,4,132
T 26,22,4
W 6
ZA 80,8,128
G 43,40,66,3
ZA 84,8,132
T 28,23,0
T 30,23,4
ZA 88,12,128
T 32,16,16
T 34,16,20
ZA 92,12,132
s_xor_b32 m0, s65, 0x18000
s_xor_b32 s66, s61, 0x180200
W 6
ZA 96,16,128
G 40,40,66,0
ZA 100,16,132
T 36,17,16
T 38,17,20
ZA 104,20,128
T 40,18,16
ZA 108,20,132
T 42,18,20
W 6
ZA 112,24,128
G 41,40,66,1
ZA 116,24,132
T 44,19,16
T 46,19,20
ZA 120,28,128
T 48,20,16
ZA 124,28,132
T 50,20,20
W 6
MA 64,32,136
G 42,40,66,2
MA 68,32,140
T 52,21,16
T 54,21,20
MA 72,36,136
T 56,22,16
MA 76,36,140
T 58,22,20
W 6
MA 80,40,136
G 43,40,66,3
MA 84,40,140
T 60,23,16
T 62,23,20
MA 88,44,136
s_waitcnt vmcnt(12)
s_barrier
T 0,16,32
MA 92,44,140
T 2,16,36
s_xor_b32 m0, s65, 0x1c000
s_xor_b32 s66, s61, 0x1c0200
W 6
MA 96,48,136
G 40,40,66,0
MA 100,48,140
T 4,17,32
T 6,17,36
MA 104,52,136
T 8,18,32
MA 108,52,140
T 10,18,36
W 6
MA 112,56,136
G 41,40,66,1
MA 116,56,140
T 12,19,32
T 14,19,36
MA 120,60,136
T 16,20,32
MA 124,60,140
T 18,20,36
W 6
MA 64,0,144
G 42,40,66,2
MA 68,0,148
T 20,21,32
T 22,21,36
MA 72,4,144
T 24,22,32
MA 76,4,148
T 26,22,36
W 6
MA 80,8,144
G 43,40,66,3
MA 84,8,148
T 28,23,32
T 30,23,36
MA 88,12,144
T 32,16,48
T 34,16,52
MA 92,12,148
s_xor_b32 m0, s65, 0x0
s_xor_b32 s66, s61, 0x200200
W 6
MA 96,16,144
G 40,40,66,0
MA 100,16,148
T 36,17,48
T 38,17,52
s_getpc_b64 s[88:89]
L_ct2_386:
s_and_b32 s89, s89, 0xffff
s_mov_b32 s90, L_code_end-L_ct2_386
s_mov_b32 s91, 0x20000
v_and_b32 v62, 0x70, v59
v_lshlrev_b32 v62, 3, v62
s_add_u32 s7, s1, 4096
buffer_load_dword v3, v62, s[88:91], s7 offen
MA 104,20,144
T 40,18,48
MA 108,20,148
T 42,18,52
W 6
MA 112,24,144
G 41,40,66,1
MA 116,24,148
T 44,19,48
T 46,19,52
MA 120,28,144
T 48,20,48
MA 124,28,148
T 50,20,52
W 6
MA 64,32,152
G 42,40,66,2
MA 68,32,156
T 52,21,48
T 54,21,52
MA 72,36,152
T 56,22,48
MA 76,36,156
T 58,22,52
W 6
MA 80,40,152
G 43,40,66,3
MA 84,40,156
T 60,23,48
T 62,23,52
MA 88,44,152
s_waitcnt vmcnt(13)
s_barrier
T 0,24,0
MA 92,44,156
T 2,24,4
s_xor_b32 m0, s65, 0x4000
s_xor_b32 s66, s61, 0x240200
W 6
MA 96,48,152
G 40,40,66,0
MA 100,48,156
T 4,25,0
T 6,25,4
MA 104,52,152
T 8,26,0
MA 108,52,156
T 10,26,4
W 6
MA 112,56,152
G 41,40,66,1
MA 116,56,156
T 12,27,0
T 14,27,4
MA 120,60,152
T 16,28,0
MA 124,60,156
T 18,28,4
W 6
MA 64,0,160
G 42,40,66,2
MA 68,0,164
T 20,29,0
T 22,29,4
MA 72,4,160
T 24,30,0
MA 76,4,164
T 26,30,4
W 6
MA 80,8,160
G 43,40,66,3
MA 84,8,164
T 28,31,0
T 30,31,4
MA 88,12,160
T 32,24,16
T 34,24,20
MA 92,12,164
s_xor_b32 m0, s65, 0x8000
s_xor_b32 s66, s61, 0x280200
W 6
MA 96,16,160
G 40,40,66,0
MA 100,16,164
T 36,25,16
T 38,25,20
MA 104,20,160
T 40,26,16
MA 108,20,164
T 42,26,20
W 6
MA 112,24,160
G 41,40,66,1
MA 116,24,164
T 44,27,16
T 46,27,20
MA 120,28,160
T 48,28,16
MA 124,28,164
T 50,28,20
W 6
MA 64,32,168
G 42,40,66,2
MA 68,32,172
T 52,29,16
T 54,29,20
MA 72,36,168
T 56,30,16
MA 76,36,172
T 58,30,20
W 6
MA 80,40,168
G 43,40,66,3
MA 84,40,172
T 60,31,16
T 62,31,20
MA 88,44,168
s_waitcnt vmcnt(13)
s_barrier
T 0,24,32
MA 92,44,172
T 2,24,36
s_xor_b32 m0, s65, 0xc000
s_xor_b32 s66, s61, 0x2c0200
W 6
MA 96,48,168
G 40,40,66,0
MA 100,48,172
T 4,25,32
T 6,25,36
MA 104,52,168
T 8,26,32
MA 108,52,172
T 10,26,36
W 6
MA 112,56,168
G 41,40,66,1
MA 116,56,172
T 12,27,32
T 14,27,36
MA 120,60,168
T 16,28,32
MA 124,60,172
T 18,28,36
W 6
MA 64,0,176
G 42,40,66,2
MA 68,0,180
T 20,29,32
T 22,29,36
MA 72,4,176
T 24,30,32
MA 76,4,180
T 26,30,36
W 6
MA 80,8,176
G 43,40,66,3
MA 84,8,180
T 28,31,32
T 30,31,36
MA 88,12,176
T 32,24,48
T 34,24,52
MA 92,12,180
s_xor_b32 m0, s65, 0x10000
s_xor_b32 s66, s61, 0x300200
W 6
MA 96,16,176
G 40,40,66,0
MA 100,16,180
T 36,25,48
T 38,25,52
MA 104,20,176
T 40,26,48
MA 108,20,180
T 42,26,52
W 6
MA 112,24,176
G 41,40,66,1
MA 116,24,180
T 44,27,48
T 46,27,52
MA 120,28,176
T 48,28,48
MA 124,28,180
T 50,28,52
W 6
MA 64,32,184
G 42,40,66,2
MA 68,32,188
T 52,29,48
T 54,29,52
MA 72,36,184
T 56,30,48
MA 76,36,188
T 58,30,52
W 6
MA 80,40,184
G 43,40,66,3
MA 84,40,188
T 60,31,48
T 62,31,52
MA 88,44,184
s_waitcnt vmcnt(12)
s_barrier
T 0,16,0
MA 92,44,188
T 2,16,4
s_xor_b32 m0, s65, 0x14000
s_xor_b32 s66, s61, 0x340200
W 6
MA 96,48,184
G 40,40,66,0
MA 100,48,188
T 4,17,0
T 6,17,4
MA 104,52,184
T 8,18,0
MA 108,52,188
T 10,18,4
W 6
MA 112,56,184
G 41,40,66,1
MA 116,56,188
T 12,19,0
T 14,19,4
MA 120,60,184
T 16,20,0
MA 124,60,188
T 18,20,4
W 6
MA 64,0,192
G 42,40,66,2
MA 68,0,196
T 20,21,0
T 22,21,4
MA 72,4,192
T 24,22,0
MA 76,4,196
T 26,22,4
W 6
MA 80,8,192
G 43,40,66,3
MA 84,8,196
T 28,23,0
T 30,23,4
MA 88,12,192
T 32,16,16
T 34,16,20
MA 92,12,196
s_xor_b32 m0, s65, 0x18000
s_xor_b32 s66, s61, 0x380200
W 6
MA 96,16,192
G 40,40,66,0
MA 100,16,196
T 36,17,16
T 38,17,20
MA 104,20,192
T 40,18,16
MA 108,20,196
T 42,18,20
W 6
MA 112,24,192
G 41,40,66,1
MA 116,24,196
T 44,19,16
T 46,19,20
MA 120,28,192
T 48,20,16
MA 124,28,196
T 50,20,20
W 6
MA 64,32,200
G 42,40,66,2
MA 68,32,204
T 52,21,16
T 54,21,20
MA 72,36,200
T 56,22,16
MA 76,36,204
T 58,22,20
W 6
MA 80,40,200
G 43,40,66,3
MA 84,40,204
T 60,23,16
T 62,23,20
MA 88,44,200
s_waitcnt vmcnt(12)
s_barrier
T 0,16,32
MA 92,44,204
T 2,16,36
s_xor_b32 m0, s65, 0x1c000
s_xor_b32 s66, s61, 0x3c0200
W 6
MA 96,48,200
G 40,40,66,0
MA 100,48,204
T 4,17,32
T 6,17,36
MA 104,52,200
T 8,18,32
MA 108,52,204
T 10,18,36
W 6
MA 112,56,200
G 41,40,66,1
MA 116,56,204
T 12,19,32
T 14,19,36
MA 120,60,200
T 16,20,32
MA 124,60,204
T 18,20,36
W 6
MA 64,0,208
G 42,40,66,2
MA 68,0,212
T 20,21,32
T 22,21,36
MA 72,4,208
T 24,22,32
MA 76,4,212
T 26,22,36
W 6
MA 80,8,208
G 43,40,66,3
MA 84,8,212
T 28,23,32
T 30,23,36
MA 88,12,208
T 32,16,48
T 34,16,52
MA 92,12,212
s_xor_b32 m0, s65, 0x0
s_xor_b32 s66, s64, 0x0
W 6
MA 96,16,208
G 48,48,66,0,nt
MA 100,16,212
T 36,17,48
T 38,17,52
MA 104,20,208
T 40,18,48
MA 108,20,212
T 42,18,52
W 6
MA 112,24,208
G 49,48,66,1,nt
MA 116,24,212
T 44,19,48
T 46,19,52
MA 120,28,208
T 48,20,48
MA 124,28,212
T 50,20,52
W 6
MA 64,32,216
G 50,48,66,2,nt
MA 68,32,220
T 52,21,48
T 54,21,52
MA 72,36,216
T 56,22,48
MA 76,36,220
T 58,22,52
W 6
MA 80,40,216
G 51,48,66,3,nt
MA 84,40,220
T 60,23,48
T 62,23,52
MA 88,44,216
s_waitcnt vmcnt(12)
s_barrier
T 0,24,0
MA 92,44,220
T 2,24,4
s_xor_b32 m0, s65, 0x4000
s_xor_b32 s66, s64, 0x10000
W 6
MA 96,48,216
G 48,48,66,0,nt
MA 100,48,220
T 4,25,0
T 6,25,4
MA 104,52,216
T 8,26,0
MA 108,52,220
T 10,26,4
W 6
MA 112,56,216
G 49,48,66,1,nt
MA 116,56,220
T 12,27,0
T 14,27,4
MA 120,60,216
T 16,28,0
MA 124,60,220
T 18,28,4
W 6
MA 64,0,224
G 50,48,66,2,nt
MA 68,0,228
T 20,29,0
T 22,29,4
MA 72,4,224
T 24,30,0
MA 76,4,228
T 26,30,4
W 6
MA 80,8,224
G 51,48,66,3,nt
MA 84,8,228
T 28,31,0
T 30,31,4
MA 88,12,224
T 32,24,16
T 34,24,20
MA 92,12,228
s_xor_b32 m0, s65, 0x8000
s_xor_b32 s66, s64, 0x2000
W 6
MA 96,16,224
G 48,48,66,0,nt
MA 100,16,228
T 36,25,16
T 38,25,20
MA 104,20,224
T 40,26,16
MA 108,20,228
T 42,26,20
W 6
MA 112,24,224
G 49,48,66,1,nt
MA 116,24,228
T 44,27,16
T 46,27,20
MA 120,28,224
T 48,28,16
MA 124,28,228
T 50,28,20
W 6
MA 64,32,232
G 50,48,66,2,nt
MA 68,32,236
T 52,29,16
T 54,29,20
MA 72,36,232
T 56,30,16
MA 76,36,236
T 58,30,20
W 6
MA 80,40,232
G 51,48,66,3,nt
MA 84,40,236
T 60,31,16
T 62,31,20
MA 88,44,232
s_waitcnt vmcnt(12)
s_barrier
MA 92,44,236
T 0,24,32
T 2,24,36
W 6
MA 96,48,232
T 4,25,32
MA 100,48,236
T 6,25,36
MA 104,52,232
T 8,26,32
MA 108,52,236
T 10,26,36
W 6
MA 112,56,232
T 12,27,32
MA 116,56,236
T 14,27,36
MA 120,60,232
T 16,28,32
MA 124,60,236
T 18,28,36
W 6
MA 64,0,240
T 20,29,32
MA 68,0,244
T 22,29,36
MA 72,4,240
T 24,30,32
MA 76,4,244
T 26,30,36
W 6
MA 80,8,240
T 28,31,32
MA 84,8,244
T 30,31,36
MA 88,12,240
T 32,24,48
MA 92,12,244
T 34,24,52
W 6
MA 96,16,240
T 36,25,48
MA 100,16,244
T 38,25,52
MA 104,20,240
T 40,26,48
MA 108,20,244
T 42,26,52
W 6
MA 112,24,240
T 44,27,48
MA 116,24,244
T 46,27,52
MA 120,28,240
T 48,28,48
MA 124,28,244
T 50,28,52
W 6
MA 64,32,248
T 52,29,48
MA 68,32,252
T 54,29,52
MA 72,36,248
T 56,30,48
MA 76,36,252
T 58,30,52
W 6
MA 80,40,248
T 60,31,48
T 62,31,52
MA 84,40,252
v_xor_b32 v16, s71, v16
v_xor_b32 v17, s71, v17
v_xor_b32 v18, s71, v18
MA 88,44,248
s_waitcnt vmcnt(8)
s_barrier
R a,0,8,0
v_xor_b32 v19, s71, v19
MA 92,44,252
v_xor_b32 v20, s71, v20
v_xor_b32 v21, s71, v21
s_xor_b32 m0, s65, 0xc000
s_xor_b32 s66, s64, 0x12000
W 5
MA 96,48,248
G 48,48,66,0,nt
MA 100,48,252
R a,4,9,0
v_xor_b32 v22, s71, v22
v_xor_b32 v23, s71, v23
MA 104,52,248
R a,8,10,0
v_xor_b32 v24, s71, v24
MA 108,52,252
v_xor_b32 v25, s71, v25
v_xor_b32 v26, s71, v26
W 3
MA 112,56,248
G 49,48,66,1,nt
R a,12,11,0
MA 116,56,252
v_xor_b32 v27, s71, v27
v_xor_b32 v28, s71, v28
v_xor_b32 v29, s71, v29
MA 120,60,248
R a,16,8,4
MA 124,60,252
v_xor_b32 v30, s71, v30
v_xor_b32 v31, s71, v31
v_pk_mul_f32 v[64:65], v[64:65], s[74:75]
v_pk_mul_f32 v[66:67], v[66:67], s[74:75]
v_pk_mul_f32 v[68:69], v[68:69], s[74:75]
v_pk_mul_f32 v[70:71], v[70:71], s[74:75]
v_pk_mul_f32 v[72:73], v[72:73], s[74:75]
v_pk_mul_f32 v[74:75], v[74:75], s[74:75]
v_pk_mul_f32 v[76:77], v[76:77], s[74:75]
v_pk_mul_f32 v[78:79], v[78:79], s[74:75]
CV 64,64
CV 66,66
CV 68,68
CV 70,70
CV 72,72
CV 74,74
CV 76,76
CV 78,78
v_permlane32_swap_b32 v64, v72
v_permlane32_swap_b32 v66, v74
v_permlane32_swap_b32 v68, v76
v_permlane32_swap_b32 v70, v78
v_permlane16_swap_b32 v64, v72
v_permlane16_swap_b32 v66, v74
v_permlane16_swap_b32 v68, v76
v_permlane16_swap_b32 v70, v78
AW 160,64
AW 161,66
AW 162,72
AW 163,74
AW 164,68
AW 165,70
AW 166,76
AW 167,78
v_pk_mul_f32 v[80:81], v[80:81], s[74:75]
v_pk_mul_f32 v[82:83], v[82:83], s[74:75]
v_pk_mul_f32 v[84:85], v[84:85], s[74:75]
v_pk_mul_f32 v[86:87], v[86:87], s[74:75]
v_pk_mul_f32 v[88:89], v[88:89], s[74:75]
v_pk_mul_f32 v[90:91], v[90:91], s[74:75]
v_pk_mul_f32 v[92:93], v[92:93], s[74:75]
v_pk_mul_f32 v[94:95], v[94:95], s[74:75]
CV 80,80
CV 82,82
CV 84,84
CV 86,86
CV 88,88
CV 90,90
CV 92,92
CV 94,94
v_permlane32_swap_b32 v80, v88
v_permlane32_swap_b32 v82, v90
v_permlane32_swap_b32 v84, v92
v_permlane32_swap_b32 v86, v94
v_permlane16_swap_b32 v80, v88
v_permlane16_swap_b32 v82, v90
v_permlane16_swap_b32 v84, v92
v_permlane16_swap_b32 v86, v94
AW 168,80
AW 169,82
AW 170,88
AW 171,90
AW 172,84
AW 173,86
AW 174,92
AW 175,94
v_pk_mul_f32 v[96:97], v[96:97], s[74:75]
v_pk_mul_f32 v[98:99], v[98:99], s[74:75]
v_pk_mul_f32 v[100:101], v[100:101], s[74:75]
v_pk_mul_f32 v[102:103], v[102:103], s[74:75]
v_pk_mul_f32 v[104:105], v[104:105], s[74:75]
v_pk_mul_f32 v[106:107], v[106:107], s[74:75]
v_pk_mul_f32 v[108:109], v[108:109], s[74:75]
v_pk_mul_f32 v[110:111], v[110:111], s[74:75]
CV 96,96
CV 98,98
CV 100,100
CV 102,102
CV 104,104
CV 106,106
CV 108,108
CV 110,110
v_permlane32_swap_b32 v96, v104
v_permlane32_swap_b32 v98, v106
v_permlane32_swap_b32 v100, v108
v_permlane32_swap_b32 v102, v110
v_permlane16_swap_b32 v96, v104
v_permlane16_swap_b32 v98, v106
v_permlane16_swap_b32 v100, v108
v_permlane16_swap_b32 v102, v110
AW 176,96
AW 177,98
AW 178,104
AW 179,106
AW 180,100
AW 181,102
AW 182,108
AW 183,110
v_pk_mul_f32 v[112:113], v[112:113], s[74:75]
v_pk_mul_f32 v[114:115], v[114:115], s[74:75]
v_pk_mul_f32 v[116:117], v[116:117], s[74:75]
v_pk_mul_f32 v[118:119], v[118:119], s[74:75]
v_pk_mul_f32 v[120:121], v[120:121], s[74:75]
v_pk_mul_f32 v[122:123], v[122:123], s[74:75]
v_pk_mul_f32 v[124:125], v[124:125], s[74:75]
v_pk_mul_f32 v[126:127], v[126:127], s[74:75]
CV 112,112
CV 114,114
CV 116,116
CV 118,118
CV 120,120
CV 122,122
CV 124,124
CV 126,126
v_permlane32_swap_b32 v112, v120
v_permlane32_swap_b32 v114, v122
v_permlane32_swap_b32 v116, v124
v_permlane32_swap_b32 v118, v126
v_permlane16_swap_b32 v112, v120
v_permlane16_swap_b32 v114, v122
v_permlane16_swap_b32 v116, v124
v_permlane16_swap_b32 v118, v126
AW 184,112
AW 185,114
AW 186,120
AW 187,122
AW 188,116
AW 189,118
AW 190,124
AW 191,126
W 3
ZB 64,0,64
G 50,48,66,2,nt
ZB 68,0,68
R a,20,9,4
MB 64,4,72
R a,24,10,4
MB 68,4,76
W 3
MB 64,8,80
G 51,48,66,3,nt
MB 68,8,84
R a,28,11,4
MB 64,12,88
MB 68,12,92
W 2
ZB 72,16,64
ZB 76,16,68
MB 72,20,72
MB 76,20,76
W 0
MB 72,24,80
E 64
MB 76,24,84
MB 72,28,88
E 65
MB 76,28,92
CV 96,64
E 66
T 32,16,0
E 67
T 34,16,4
T 36,17,0
CV 97,66
E 68
T 38,17,4
E 69
T 40,18,0
CV 100,68
E 70
T 42,18,4
T 44,19,0
E 71
T 46,19,4
CV 101,70
E 72
T 48,20,0
E 73
T 50,20,4
T 52,21,0
CV 98,72
E 74
ZB 80,0,96
T 54,21,4
ZB 84,0,100
E 75
MB 80,4,104
T 56,22,0
CV 99,74
MB 84,4,108
E 76
MB 80,8,112
T 58,22,4
T 60,23,0
MB 84,8,116
E 77
MB 80,12,120
W 14
T 62,23,4
CV 102,76
MB 84,12,124
E 78
s_getpc_b64 s[88:89]
L_ct2_514:
s_and_b32 s89, s89, 0xffff
s_mov_b32 s90, L_code_end-L_ct2_514
s_mov_b32 s91, 0x20000
v_and_b32 v62, 0x70, v59
v_lshlrev_b32 v62, 3, v62
s_add_u32 s7, s1, 4096
buffer_load_dword v3, v62, s[88:91], s7 offen
ZB 88,16,96
E 79
ZB 92,16,100
MB 88,20,104
CV 103,78
MB 92,20,108
MB 88,24,112
E 80
MB 92,24,116
MB 88,28,120
E 81
MB 92,28,124
W 12
ZA 128,32,96
s_waitcnt vmcnt(9) lgkmcnt(0)
s_barrier
R a,0,8,16
ZA 132,32,100
CV 104,80
E 82
ZA 136,36,96
R a,4,9,16
ZA 140,36,100
E 83
ZA 144,40,96
R a,8,10,16
CV 105,82
ZA 148,40,100
E 84
ZA 152,44,96
R a,12,11,16
ZA 156,44,100
E 85
ZA 160,48,96
R a,16,8,20
CV 108,84
ZA 164,48,100
E 86
ZA 168,52,96
R a,20,9,20
ZA 172,52,100
E 87
ZA 176,56,96
R a,24,10,20
CV 109,86
ZA 180,56,100
E 88
ZA 184,60,96
R a,28,11,20
ZA 188,60,100
E 89
ZD 112,52,96
CV 106,88
E 90
ZD 116,52,100
s_xor_b32 m0, s65, 0x10000
s_xor_b32 s66, s64, 0x1000
W 6
ZB 64,0,64
G 48,48,66,0,nt
ZB 68,0,68
E 91
MB 64,4,72
CV 107,90
MB 68,4,76
E 92
W 4
MB 64,8,80
G 49,48,66,1,nt
MB 68,8,84
E 93
MB 64,12,88
CV 110,92
MB 68,12,92
E 94
W 2
ZB 72,16,64
G 50,48,66,2,nt
ZB 76,16,68
E 95
MB 72,20,72
CV 111,94
MB 76,20,76
W 0
MB 72,24,80
G 51,48,66,3,nt
MB 76,24,84
E 64
MB 72,28,88
E 65
MB 76,28,92
ZA 192,32,104
CV 96,64
ZA 196,32,108
E 66
ZA 200,36,104
T 32,16,16
ZA 204,36,108
E 67
ZA 208,40,104
T 34,16,20
T 36,17,16
ZA 212,40,108
CV 97,66
E 68
ZA 216,44,104
T 38,17,20
ZA 220,44,108
E 69
ZA 224,48,104
T 40,18,16
CV 100,68
ZA 228,48,108
E 70
ZA 232,52,104
T 42,18,20
T 44,19,16
ZA 236,52,108
E 71
ZA 240,56,104
T 46,19,20
CV 101,70
ZA 244,56,108
E 72
ZA 248,60,104
T 48,20,16
ZA 252,60,108
E 73
ZD 120,52,104
T 50,20,20
T 52,21,16
ZD 124,52,108
CV 98,72
E 74
ZB 80,0,96
T 54,21,20
ZB 84,0,100
E 75
MB 80,4,104
T 56,22,16
CV 99,74
MB 84,4,108
E 76
MB 80,8,112
T 58,22,20
T 60,23,16
MB 84,8,116
E 77
MB 80,12,120
W 14
T 62,23,20
CV 102,76
MB 84,12,124
E 78
ZB 88,16,96
E 79
ZB 92,16,100
MB 88,20,104
CV 103,78
MB 92,20,108
MB 88,24,112
E 80
MB 92,24,116
MB 88,28,120
E 81
MB 92,28,124
W 12
MA 128,32,96
s_waitcnt vmcnt(9) lgkmcnt(0)
s_barrier
R a,0,8,32
MA 132,32,100
CV 104,80
E 82
MA 136,36,96
R a,4,9,32
MA 140,36,100
E 83
MA 144,40,96
R a,8,10,32
CV 105,82
MA 148,40,100
E 84
MA 152,44,96
R a,12,11,32
MA 156,44,100
E 85
MA 160,48,96
R a,16,8,36
CV 108,84
MA 164,48,100
E 86
MA 168,52,96
R a,20,9,36
MA 172,52,100
E 87
MA 176,56,96
R a,24,10,36
CV 109,86
MA 180,56,100
E 88
MA 184,60,96
R a,28,11,36
MA 188,60,100
E 89
MD 112,52,96
CV 106,88
E 90
MD 116,52,100
s_xor_b32 m0, s65, 0x14000
s_xor_b32 s66, s64, 0x11000
W 6
ZB 64,0,64
G 48,48,66,0,nt
ZB 68,0,68
E 91
MB 64,4,72
CV 107,90
MB 68,4,76
E 92
W 4
MB 64,8,80
G 49,48,66,1,nt
MB 68,8,84
E 93
MB 64,12,88
CV 110,92
MB 68,12,92
E 94
W 2
ZB 72,16,64
G 50,48,66,2,nt
ZB 76,16,68
E 95
MB 72,20,72
CV 111,94
MB 76,20,76
W 0
MB 72,24,80
G 51,48,66,3,nt
MB 76,24,84
E 64
MB 72,28,88
E 65
MB 76,28,92
MA 192,32,104
CV 96,64
MA 196,32,108
E 66
MA 200,36,104
T 32,16,32
MA 204,36,108
E 67
MA 208,40,104
T 34,16,36
T 36,17,32
MA 212,40,108
CV 97,66
E 68
MA 216,44,104
T 38,17,36
MA 220,44,108
E 69
MA 224,48,104
T 40,18,32
CV 100,68
MA 228,48,108
E 70
MA 232,52,104
T 42,18,36
T 44,19,32
MA 236,52,108
E 71
MA 240,56,104
T 46,19,36
CV 101,70
MA 244,56,108
E 72
MA 248,60,104
T 48,20,32
MA 252,60,108
E 73
MD 120,52,104
T 50,20,36
T 52,21,32
MD 124,52,108
CV 98,72
E 74
ZB 80,0,96
T 54,21,36
ZB 84,0,100
E 75
MB 80,4,104
T 56,22,32
CV 99,74
MB 84,4,108
E 76
MB 80,8,112
T 58,22,36
T 60,23,32
MB 84,8,116
E 77
MB 80,12,120
W 14
T 62,23,36
CV 102,76
MB 84,12,124
E 78
ZB 88,16,96
E 79
ZB 92,16,100
MB 88,20,104
CV 103,78
MB 92,20,108
MB 88,24,112
E 80
MB 92,24,116
MB 88,28,120
E 81
MB 92,28,124
W 12
MA 128,32,96
s_waitcnt vmcnt(9) lgkmcnt(0)
s_barrier
R a,0,8,48
MA 132,32,100
CV 104,80
E 82
MA 136,36,96
R a,4,9,48
MA 140,36,100
E 83
MA 144,40,96
R a,8,10,48
CV 105,82
MA 148,40,100
E 84
MA 152,44,96
R a,12,11,48
MA 156,44,100
E 85
MA 160,48,96
R a,16,8,52
CV 108,84
MA 164,48,100
E 86
MA 168,52,96
R a,20,9,52
MA 172,52,100
E 87
MA 176,56,96
R a,24,10,52
CV 109,86
MA 180,56,100
E 88
MA 184,60,96
R a,28,11,52
MA 188,60,100
E 89
MD 112,52,96
CV 106,88
E 90
MD 116,52,100
s_xor_b32 m0, s65, 0x18000
s_xor_b32 s66, s64, 0x3000
W 6
ZB 64,0,64
G 48,48,66,0,nt
ZB 68,0,68
E 91
MB 64,4,72
CV 107,90
MB 68,4,76
E 92
W 4
MB 64,8,80
G 49,48,66,1,nt
MB 68,8,84
E 93
MB 64,12,88
CV 110,92
MB 68,12,92
E 94
W 2
ZB 72,16,64
G 50,48,66,2,nt
ZB 76,16,68
E 95
MB 72,20,72
CV 111,94
MB 76,20,76
W 0
MB 72,24,80
G 51,48,66,3,nt
MB 76,24,84
E 64
MB 72,28,88
E 65
MB 76,28,92
MA 192,32,104
CV 96,64
MA 196,32,108
E 66
MA 200,36,104
T 32,16,48
MA 204,36,108
E 67
MA 208,40,104
T 34,16,52
T 36,17,48
MA 212,40,108
CV 97,66
E 68
MA 216,44,104
T 38,17,52
MA 220,44,108
E 69
MA 224,48,104
T 40,18,48
CV 100,68
MA 228,48,108
E 70
MA 232,52,104
T 42,18,52
T 44,19,48
MA 236,52,108
E 71
MA 240,56,104
T 46,19,52
CV 101,70
MA 244,56,108
E 72
MA 248,60,104
T 48,20,48
MA 252,60,108
E 73
MD 120,52,104
T 50,20,52
T 52,21,48
MD 124,52,108
CV 98,72
E 74
ZB 80,0,96
T 54,21,52
ZB 84,0,100
E 75
MB 80,4,104
T 56,22,48
CV 99,74
MB 84,4,108
E 76
MB 80,8,112
T 58,22,52
T 60,23,48
MB 84,8,116
E 77
MB 80,12,120
W 14
T 62,23,52
CV 102,76
MB 84,12,124
E 78
ZB 88,16,96
E 79
ZB 92,16,100
MB 88,20,104
CV 103,78
MB 92,20,108
MB 88,24,112
E 80
MB 92,24,116
MB 88,28,120
E 81
MB 92,28,124
W 12
MA 128,32,96
s_waitcnt vmcnt(8) lgkmcnt(0)
s_barrier
R a,0,12,0
MA 132,32,100
CV 104,80
E 82
MA 136,36,96
R a,4,13,0
MA 140,36,100
E 83
MA 144,40,96
R a,8,14,0
CV 105,82
MA 148,40,100
E 84
MA 152,44,96
R a,12,15,0
MA 156,44,100
E 85
MA 160,48,96
R a,16,12,4
CV 108,84
MA 164,48,100
E 86
MA 168,52,96
R a,20,13,4
MA 172,52,100
E 87
MA 176,56,96
R a,24,14,4
CV 109,86
MA 180,56,100
E 88
MA 184,60,96
R a,28,15,4
MA 188,60,100
E 89
MD 112,52,96
CV 106,88
E 90
MD 116,52,100
s_xor_b32 m0, s65, 0x1c000
s_xor_b32 s66, s64, 0x13000
W 6
ZB 64,0,64
G 48,48,66,0,nt
ZB 68,0,68
E 91
MB 64,4,72
CV 107,90
MB 68,4,76
E 92
W 4
MB 64,8,80
G 49,48,66,1,nt
MB 68,8,84
E 93
MB 64,12,88
CV 110,92
MB 68,12,92
E 94
W 2
ZB 72,16,64
G 50,48,66,2,nt
ZB 76,16,68
E 95
MB 72,20,72
CV 111,94
MB 76,20,76
W 0
MB 72,24,80
G 51,48,66,3,nt
MB 76,24,84
E 64
MB 72,28,88
E 65
MB 76,28,92
MA 192,32,104
CV 96,64
MA 196,32,108
E 66
MA 200,36,104
T 32,24,0
MA 204,36,108
E 67
MA 208,40,104
T 34,24,4
T 36,25,0
MA 212,40,108
CV 97,66
E 68
MA 216,44,104
T 38,25,4
MA 220,44,108
E 69
MA 224,48,104
T 40,26,0
CV 100,68
MA 228,48,108
E 70
MA 232,52,104
T 42,26,4
T 44,27,0
MA 236,52,108
E 71
MA 240,56,104
T 46,27,4
CV 101,70
MA 244,56,108
E 72
MA 248,60,104
T 48,28,0
MA 252,60,108
E 73
MD 120,52,104
T 50,28,4
T 52,29,0
MD 124,52,108
CV 98,72
E 74
ZB 80,0,96
T 54,29,4
ZB 84,0,100
E 75
MB 80,4,104
T 56,30,0
CV 99,74
MB 84,4,108
E 76
MB 80,8,112
T 58,30,4
T 60,31,0
MB 84,8,116
E 77
MB 80,12,120
W 14
T 62,31,4
CV 102,76
MB 84,12,124
E 78
ZB 88,16,96
E 79
ZB 92,16,100
MB 88,20,104
CV 103,78
MB 92,20,108
MB 88,24,112
E 80
MB 92,24,116
MB 88,28,120
E 81
MB 92,28,124
W 12
MA 128,32,96
s_waitcnt vmcnt(8) lgkmcnt(0)
s_barrier
R a,0,12,16
MA 132,32,100
CV 104,80
E 82
MA 136,36,96
R a,4,13,16
MA 140,36,100
E 83
MA 144,40,96
R a,8,14,16
CV 105,82
MA 148,40,100
E 84
MA 152,44,96
R a,12,15,16
MA 156,44,100
E 85
MA 160,48,96
R a,16,12,20
CV 108,84
MA 164,48,100
E 86
MA 168,52,96
R a,20,13,20
MA 172,52,100
E 87
MA 176,56,96
R a,24,14,20
CV 109,86
MA 180,56,100
E 88
MA 184,60,96
R a,28,15,20
MA 188,60,100
E 89
MD 112,52,96
CV 106,88
E 90
MD 116,52,100
s_xor_b32 m0, s65, 0x0
s_xor_b32 s66, s64, 0x4000
W 6
ZB 64,0,64
G 48,48,66,0,nt
ZB 68,0,68
E 91
MB 64,4,72
CV 107,90
MB 68,4,76
E 92
W 4
MB 64,8,80
G 49,48,66,1,nt
MB 68,8,84
E 93
MB 64,12,88
CV 110,92
MB 68,12,92
E 94
W 2
ZB 72,16,64
G 50,48,66,2,nt
ZB 76,16,68
E 95
MB 72,20,72
CV 111,94
MB 76,20,76
W 0
MB 72,24,80
G 51,48,66,3,nt
MB 76,24,84
E 64
MB 72,28,88
E 65
MB 76,28,92
MA 192,32,104
CV 96,64
MA 196,32,108
E 66
MA 200,36,104
T 32,24,16
MA 204,36,108
E 67
MA 208,40,104
T 34,24,20
T 36,25,16
MA 212,40,108
CV 97,66
E 68
MA 216,44,104
T 38,25,20
MA 220,44,108
E 69
MA 224,48,104
T 40,26,16
CV 100,68
MA 228,48,108
E 70
MA 232,52,104
T 42,26,20
T 44,27,16
MA 236,52,108
E 71
MA 240,56,104
T 46,27,20
CV 101,70
MA 244,56,108
E 72
MA 248,60,104
T 48,28,16
MA 252,60,108
E 73
MD 120,52,104
T 50,28,20
T 52,29,16
MD 124,52,108
CV 98,72
E 74
ZB 80,0,96
T 54,29,20
ZB 84,0,100
E 75
MB 80,4,104
T 56,30,16
CV 99,74
MB 84,4,108
E 76
MB 80,8,112
T 58,30,20
T 60,31,16
MB 84,8,116
E 77
MB 80,12,120
W 14
T 62,31,20
CV 102,76
MB 84,12,124
E 78
ZB 88,16,96
E 79
ZB 92,16,100
MB 88,20,104
CV 103,78
MB 92,20,108
MB 88,24,112
E 80
MB 92,24,116
MB 88,28,120
E 81
MB 92,28,124
W 12
MA 128,32,96
s_waitcnt vmcnt(8) lgkmcnt(0)
s_barrier
R a,0,12,32
MA 132,32,100
CV 104,80
E 82
MA 136,36,96
R a,4,13,32
MA 140,36,100
E 83
MA 144,40,96
R a,8,14,32
CV 105,82
MA 148,40,100
E 84
MA 152,44,96
R a,12,15,32
MA 156,44,100
E 85
MA 160,48,96
R a,16,12,36
CV 108,84
MA 164,48,100
E 86
MA 168,52,96
R a,20,13,36
MA 172,52,100
E 87
MA 176,56,96
R a,24,14,36
CV 109,86
MA 180,56,100
E 88
MA 184,60,96
R a,28,15,36
MA 188,60,100
E 89
MD 112,52,96
CV 106,88
E 90
MD 116,52,100
s_xor_b32 m0, s65, 0x4000
s_xor_b32 s66, s64, 0x14000
W 6
ZB 64,0,64
G 48,48,66,0,nt
ZB 68,0,68
E 91
MB 64,4,72
CV 107,90
MB 68,4,76
E 92
W 4
MB 64,8,80
G 49,48,66,1,nt
MB 68,8,84
E 93
MB 64,12,88
CV 110,92
MB 68,12,92
E 94
W 2
ZB 72,16,64
G 50,48,66,2,nt
ZB 76,16,68
E 95
MB 72,20,72
CV 111,94
MB 76,20,76
W 0
MB 72,24,80
G 51,48,66,3,nt
MB 76,24,84
E 64
MB 72,28,88
E 65
MB 76,28,92
MA 192,32,104
CV 96,64
MA 196,32,108
E 66
MA 200,36,104
T 32,24,32
MA 204,36,108
E 67
MA 208,40,104
T 34,24,36
T 36,25,32
MA 212,40,108
CV 97,66
E 68
MA 216,44,104
T 38,25,36
MA 220,44,108
E 69
MA 224,48,104
T 40,26,32
CV 100,68
MA 228,48,108
E 70
MA 232,52,104
T 42,26,36
T 44,27,32
MA 236,52,108
E 71
MA 240,56,104
T 46,27,36
CV 101,70
MA 244,56,108
E 72
MA 248,60,104
T 48,28,32
MA 252,60,108
E 73
MD 120,52,104
T 50,28,36
T 52,29,32
MD 124,52,108
CV 98,72
E 74
ZB 80,0,96
T 54,29,36
ZB 84,0,100
E 75
MB 80,4,104
T 56,30,32
CV 99,74
MB 84,4,108
E 76
MB 80,8,112
T 58,30,36
T 60,31,32
MB 84,8,116
E 77
MB 80,12,120
W 14
T 62,31,36
CV 102,76
MB 84,12,124
E 78
ZB 88,16,96
E 79
ZB 92,16,100
MB 88,20,104
CV 103,78
MB 92,20,108
MB 88,24,112
E 80
MB 92,24,116
MB 88,28,120
E 81
MB 92,28,124
W 12
MA 128,32,96
s_waitcnt vmcnt(8) lgkmcnt(0)
s_barrier
R a,0,12,48
MA 132,32,100
CV 104,80
E 82
MA 136,36,96
R a,4,13,48
MA 140,36,100
E 83
MA 144,40,96
R a,8,14,48
CV 105,82
MA 148,40,100
E 84
MA 152,44,96
R a,12,15,48
MA 156,44,100
E 85
MA 160,48,96
R a,16,12,52
CV 108,84
MA 164,48,100
E 86
MA 168,52,96
R a,20,13,52
MA 172,52,100
E 87
MA 176,56,96
R a,24,14,52
CV 109,86
MA 180,56,100
E 88
MA 184,60,96
R a,28,15,52
MA 188,60,100
E 89
MD 112,52,96
CV 106,88
E 90
MD 116,52,100
s_xor_b32 m0, s65, 0x8000
s_xor_b32 s66, s64, 0x6000
W 6
ZB 64,0,64
G 48,48,66,0,nt
ZB 68,0,68
E 91
MB 64,4,72
CV 107,90
MB 68,4,76
E 92
W 4
MB 64,8,80
G 49,48,66,1,nt
MB 68,8,84
E 93
MB 64,12,88
CV 110,92
MB 68,12,92
E 94
W 2
ZB 72,16,64
G 50,48,66,2,nt
ZB 76,16,68
E 95
MB 72,20,72
CV 111,94
MB 76,20,76
W 0
MB 72,24,80
G 51,48,66,3,nt
MB 76,24,84
E 64
MB 72,28,88
E 65
MB 76,28,92
MA 192,32,104
CV 96,64
MA 196,32,108
E 66
MA 200,36,104
T 32,24,48
MA 204,36,108
E 67
MA 208,40,104
T 34,24,52
T 36,25,48
MA 212,40,108
CV 97,66
E 68
MA 216,44,104
T 38,25,52
MA 220,44,108
E 69
MA 224,48,104
T 40,26,48
CV 100,68
MA 228,48,108
E 70
MA 232,52,104
T 42,26,52
T 44,27,48
MA 236,52,108
E 71
MA 240,56,104
T 46,27,52
CV 101,70
MA 244,56,108
E 72
MA 248,60,104
T 48,28,48
MA 252,60,108
E 73
MD 120,52,104
T 50,28,52
T 52,29,48
MD 124,52,108
CV 98,72
E 74
ZB 80,0,96
T 54,29,52
ZB 84,0,100
E 75
MB 80,4,104
T 56,30,48
CV 99,74
MB 84,4,108
E 76
MB 80,8,112
T 58,30,52
T 60,31,48
MB 84,8,116
E 77
MB 80,12,120
W 14
T 62,31,52
CV 102,76
MB 84,12,124
E 78
ZB 88,16,96
E 79
ZB 92,16,100
MB 88,20,104
CV 103,78
MB 92,20,108
MB 88,24,112
E 80
MB 92,24,116
MB 88,28,120
E 81
MB 92,28,124
W 12
MA 128,32,96
s_waitcnt vmcnt(8) lgkmcnt(0)
s_barrier
R a,0,8,0
MA 132,32,100
CV 104,80
E 82
MA 136,36,96
R a,4,9,0
MA 140,36,100
E 83
MA 144,40,96
R a,8,10,0
CV 105,82
MA 148,40,100
E 84
MA 152,44,96
R a,12,11,0
MA 156,44,100
E 85
MA 160,48,96
R a,16,8,4
CV 108,84
MA 164,48,100
E 86
MA 168,52,96
R a,20,9,4
MA 172,52,100
E 87
MA 176,56,96
R a,24,10,4
CV 109,86
MA 180,56,100
E 88
MA 184,60,96
R a,28,11,4
MA 188,60,100
E 89
MD 112,52,96
CV 106,88
E 90
MD 116,52,100
s_xor_b32 m0, s65, 0xc000
s_xor_b32 s66, s64, 0x16000
W 6
ZB 64,0,64
G 48,48,66,0,nt
ZB 68,0,68
E 91
MB 64,4,72
CV 107,90
MB 68,4,76
E 92
W 4
MB 64,8,80
G 49,48,66,1,nt
MB 68,8,84
E 93
MB 64,12,88
CV 110,92
MB 68,12,92
E 94
W 2
ZB 72,16,64
G 50,48,66,2,nt
ZB 76,16,68
E 95
MB 72,20,72
CV 111,94
MB 76,20,76
W 0
MB 72,24,80
G 51,48,66,3,nt
MB 76,24,84
E 64
MB 72,28,88
E 65
MB 76,28,92
MA 192,32,104
CV 96,64
MA 196,32,108
E 66
MA 200,36,104
T 32,16,0
MA 204,36,108
E 67
MA 208,40,104
T 34,16,4
T 36,17,0
MA 212,40,108
CV 97,66
E 68
MA 216,44,104
T 38,17,4
MA 220,44,108
E 69
MA 224,48,104
T 40,18,0
CV 100,68
MA 228,48,108
E 70
MA 232,52,104
T 42,18,4
T 44,19,0
MA 236,52,108
E 71
MA 240,56,104
T 46,19,4
CV 101,70
MA 244,56,108
E 72
MA 248,60,104
T 48,20,0
MA 252,60,108
E 73
MD 120,52,104
T 50,20,4
T 52,21,0
MD 124,52,108
CV 98,72
E 74
ZB 80,0,96
T 54,21,4
ZB 84,0,100
E 75
MB 80,4,104
T 56,22,0
CV 99,74
MB 84,4,108
E 76
MB 80,8,112
T 58,22,4
T 60,23,0
MB 84,8,116
E 77
MB 80,12,120
W 14
T 62,23,4
CV 102,76
MB 84,12,124
E 78
ZB 88,16,96
E 79
ZB 92,16,100
MB 88,20,104
CV 103,78
MB 92,20,108
MB 88,24,112
E 80
MB 92,24,116
MB 88,28,120
E 81
MB 92,28,124
W 12
MA 128,32,96
s_waitcnt vmcnt(8) lgkmcnt(0)
s_barrier
R a,0,8,16
MA 132,32,100
CV 104,80
E 82
MA 136,36,96
R a,4,9,16
MA 140,36,100
E 83
MA 144,40,96
R a,8,10,16
CV 105,82
MA 148,40,100
E 84
MA 152,44,96
R a,12,11,16
MA 156,44,100
E 85
MA 160,48,96
R a,16,8,20
CV 108,84
MA 164,48,100
E 86
MA 168,52,96
R a,20,9,20
MA 172,52,100
E 87
MA 176,56,96
R a,24,10,20
CV 109,86
MA 180,56,100
E 88
MA 184,60,96
R a,28,11,20
MA 188,60,100
E 89
MD 112,52,96
CV 106,88
E 90
MD 116,52,100
s_xor_b32 m0, s65, 0x10000
s_xor_b32 s66, s64, 0x5000
W 6
ZB 64,0,64
G 48,48,66,0,nt
ZB 68,0,68
E 91
MB 64,4,72
CV 107,90
MB 68,4,76
E 92
W 4
MB 64,8,80
G 49,48,66,1,nt
MB 68,8,84
E 93
MB 64,12,88
CV 110,92
MB 68,12,92
E 94
W 2
ZB 72,16,64
G 50,48,66,2,nt
ZB 76,16,68
E 95
MB 72,20,72
CV 111,94
MB 76,20,76
W 0
MB 72,24,80
G 51,48,66,3,nt
MB 76,24,84
E 64
MB 72,28,88
E 65
MB 76,28,92
MA 192,32,104
CV 96,64
MA 196,32,108
E 66
MA 200,36,104
T 32,16,16
MA 204,36,108
E 67
MA 208,40,104
T 34,16,20
T 36,17,16
MA 212,40,108
CV 97,66
E 68
MA 216,44,104
T 38,17,20
MA 220,44,108
E 69
MA 224,48,104
T 40,18,16
CV 100,68
MA 228,48,108
E 70
MA 232,52,104
T 42,18,20
T 44,19,16
MA 236,52,108
E 71
MA 240,56,104
T 46,19,20
CV 101,70
MA 244,56,108
E 72
MA 248,60,104
T 48,20,16
MA 252,60,108
E 73
MD 120,52,104
T 50,20,20
T 52,21,16
MD 124,52,108
CV 98,72
E 74
ZB 80,0,96
T 54,21,20
ZB 84,0,100
E 75
MB 80,4,104
T 56,22,16
CV 99,74
MB 84,4,108
E 76
MB 80,8,112
T 58,22,20
T 60,23,16
MB 84,8,116
E 77
MB 80,12,120
W 14
T 62,23,20
CV 102,76
MB 84,12,124
E 78
ZB 88,16,96
E 79
ZB 92,16,100
MB 88,20,104
CV 103,78
MB 92,20,108
MB 88,24,112
E 80
MB 92,24,116
MB 88,28,120
E 81
MB 92,28,124
W 12
MA 128,32,96
s_waitcnt vmcnt(8) lgkmcnt(0)
s_barrier
R a,0,8,32
MA 132,32,100
CV 104,80
E 82
MA 136,36,96
R a,4,9,32
MA 140,36,100
E 83
MA 144,40,96
R a,8,10,32
CV 105,82
MA 148,40,100
E 84
MA 152,44,96
R a,12,11,32
MA 156,44,100
E 85
MA 160,48,96
R a,16,8,36
CV 108,84
MA 164,48,100
E 86
MA 168,52,96
R a,20,9,36
MA 172,52,100
E 87
MA 176,56,96
R a,24,10,36
CV 109,86
MA 180,56,100
E 88
MA 184,60,96
R a,28,11,36
MA 188,60,100
E 89
MD 112,52,96
CV 106,88
E 90
MD 116,52,100
s_xor_b32 m0, s65, 0x14000
s_xor_b32 s66, s64, 0x15000
W 6
ZB 64,0,64
G 48,48,66,0,nt
ZB 68,0,68
E 91
MB 64,4,72
CV 107,90
MB 68,4,76
E 92
W 4
MB 64,8,80
G 49,48,66,1,nt
MB 68,8,84
E 93
MB 64,12,88
CV 110,92
MB 68,12,92
E 94
W 2
ZB 72,16,64
G 50,48,66,2,nt
ZB 76,16,68
E 95
MB 72,20,72
CV 111,94
MB 76,20,76
W 0
MB 72,24,80
G 51,48,66,3,nt
MB 76,24,84
E 64
MB 72,28,88
E 65
MB 76,28,92
MA 192,32,104
CV 96,64
MA 196,32,108
E 66
MA 200,36,104
T 32,16,32
MA 204,36,108
E 67
MA 208,40,104
T 34,16,36
T 36,17,32
MA 212,40,108
CV 97,66
E 68
MA 216,44,104
T 38,17,36
MA 220,44,108
E 69
MA 224,48,104
T 40,18,32
CV 100,68
MA 228,48,108
E 70
MA 232,52,104
T 42,18,36
T 44,19,32
MA 236,52,108
E 71
MA 240,56,104
T 46,19,36
CV 101,70
MA 244,56,108
E 72
MA 248,60,104
T 48,20,32
MA 252,60,108
E 73
MD 120,52,104
T 50,20,36
T 52,21,32
MD 124,52,108
CV 98,72
E 74
ZB 80,0,96
T 54,21,36
ZB 84,0,100
E 75
MB 80,4,104
T 56,22,32
CV 99,74
MB 84,4,108
E 76
MB 80,8,112
T 58,22,36
T 60,23,32
MB 84,8,116
E 77
MB 80,12,120
W 14
T 62,23,36
CV 102,76
MB 84,12,124
E 78
ZB 88,16,96
E 79
ZB 92,16,100
MB 88,20,104
CV 103,78
MB 92,20,108
MB 88,24,112
E 80
MB 92,24,116
MB 88,28,120
E 81
MB 92,28,124
W 12
MA 128,32,96
s_waitcnt vmcnt(8) lgkmcnt(0)
s_barrier
R a,0,8,48
MA 132,32,100
CV 104,80
E 82
MA 136,36,96
R a,4,9,48
MA 140,36,100
E 83
MA 144,40,96
R a,8,10,48
CV 105,82
MA 148,40,100
E 84
MA 152,44,96
R a,12,11,48
MA 156,44,100
E 85
MA 160,48,96
R a,16,8,52
CV 108,84
MA 164,48,100
E 86
MA 168,52,96
R a,20,9,52
MA 172,52,100
E 87
MA 176,56,96
R a,24,10,52
CV 109,86
MA 180,56,100
E 88
MA 184,60,96
R a,28,11,52
MA 188,60,100
E 89
MD 112,52,96
CV 106,88
E 90
MD 116,52,100
s_xor_b32 m0, s65, 0x18000
s_xor_b32 s66, s64, 0x7000
W 6
ZB 64,0,64
G 48,48,66,0,nt
ZB 68,0,68
E 91
MB 64,4,72
CV 107,90
MB 68,4,76
E 92
W 4
MB 64,8,80
G 49,48,66,1,nt
MB 68,8,84
E 93
MB 64,12,88
CV 110,92
MB 68,12,92
E 94
W 2
ZB 72,16,64
G 50,48,66,2,nt
ZB 76,16,68
E 95
MB 72,20,72
CV 111,94
MB 76,20,76
W 0
MB 72,24,80
G 51,48,66,3,nt
MB 76,24,84
E 64
MB 72,28,88
E 65
MB 76,28,92
MA 192,32,104
CV 96,64
MA 196,32,108
E 66
MA 200,36,104
T 32,16,48
MA 204,36,108
E 67
MA 208,40,104
T 34,16,52
T 36,17,48
MA 212,40,108
CV 97,66
E 68
MA 216,44,104
T 38,17,52
MA 220,44,108
E 69
MA 224,48,104
T 40,18,48
CV 100,68
MA 228,48,108
E 70
MA 232,52,104
T 42,18,52
T 44,19,48
MA 236,52,108
E 71
MA 240,56,104
T 46,19,52
CV 101,70
MA 244,56,108
E 72
MA 248,60,104
T 48,20,48
MA 252,60,108
E 73
MD 120,52,104
T 50,20,52
T 52,21,48
MD 124,52,108
CV 98,72
E 74
ZB 80,0,96
T 54,21,52
ZB 84,0,100
E 75
MB 80,4,104
T 56,22,48
CV 99,74
MB 84,4,108
E 76
MB 80,8,112
T 58,22,52
T 60,23,48
MB 84,8,116
E 77
MB 80,12,120
W 14
T 62,23,52
CV 102,76
MB 84,12,124
E 78
ZB 88,16,96
E 79
ZB 92,16,100
MB 88,20,104
CV 103,78
MB 92,20,108
MB 88,24,112
E 80
MB 92,24,116
MB 88,28,120
E 81
MB 92,28,124
W 12
MA 128,32,96
s_waitcnt vmcnt(8) lgkmcnt(0)
s_barrier
R a,0,12,0
MA 132,32,100
CV 104,80
E 82
MA 136,36,96
R a,4,13,0
MA 140,36,100
E 83
MA 144,40,96
R a,8,14,0
CV 105,82
MA 148,40,100
E 84
MA 152,44,96
R a,12,15,0
MA 156,44,100
E 85
MA 160,48,96
R a,16,12,4
CV 108,84
MA 164,48,100
E 86
MA 168,52,96
R a,20,13,4
MA 172,52,100
E 87
MA 176,56,96
R a,24,14,4
CV 109,86
MA 180,56,100
E 88
MA 184,60,96
R a,28,15,4
MA 188,60,100
E 89
MD 112,52,96
CV 106,88
E 90
MD 116,52,100
s_xor_b32 m0, s65, 0x1c000
s_xor_b32 s66, s64, 0x17000
W 6
ZB 64,0,64
G 48,48,66,0,nt
ZB 68,0,68
E 91
MB 64,4,72
CV 107,90
MB 68,4,76
E 92
W 4
MB 64,8,80
G 49,48,66,1,nt
MB 68,8,84
E 93
MB 64,12,88
CV 110,92
MB 68,12,92
E 94
W 2
ZB 72,16,64
G 50,48,66,2,nt
ZB 76,16,68
E 95
MB 72,20,72
CV 111,94
MB 76,20,76
W 0
MB 72,24,80
G 51,48,66,3,nt
MB 76,24,84
E 64
MB 72,28,88
E 65
MB 76,28,92
s_xor_b32 m0, s65, 0x0
s_xor_b32 s66, s62, 0x0
MA 192,32,104
G 44,24,66,0
MA 196,32,108
CV 96,64
E 66
MA 200,36,104
T 32,24,0
MA 204,36,108
E 67
MA 208,40,104
G 45,24,66,1
T 34,24,4
MA 212,40,108
T 36,25,0
CV 97,66
E 68
MA 216,44,104
T 38,25,4
MA 220,44,108
E 69
MA 224,48,104
G 46,24,66,2
T 40,26,0
MA 228,48,108
CV 100,68
E 70
MA 232,52,104
T 42,26,4
T 44,27,0
MA 236,52,108
E 71
MA 240,56,104
G 47,24,66,3
T 46,27,4
MA 244,56,108
CV 101,70
E 72
MA 248,60,104
T 48,28,0
MA 252,60,108
E 73
MD 120,52,104
T 50,28,4
T 52,29,0
MD 124,52,108
CV 98,72
E 74
ZB 80,0,96
T 54,29,4
ZB 84,0,100
E 75
MB 80,4,104
T 56,30,0
CV 99,74
MB 84,4,108
E 76
MB 80,8,112
T 58,30,4
T 60,31,0
MB 84,8,116
E 77
MB 80,12,120
W 14
T 62,31,4
CV 102,76
MB 84,12,124
E 78
ZB 88,16,96
E 79
ZB 92,16,100
MB 88,20,104
CV 103,78
MB 92,20,108
MB 88,24,112
E 80
MB 92,24,116
MB 88,28,120
E 81
MB 92,28,124
W 12
MA 128,32,96
s_waitcnt vmcnt(12) lgkmcnt(0)
s_barrier
R a,0,12,16
MA 132,32,100
CV 104,80
E 82
MA 136,36,96
R a,4,13,16
MA 140,36,100
E 83
MA 144,40,96
R a,8,14,16
CV 105,82
MA 148,40,100
E 84
MA 152,44,96
R a,12,15,16
MA 156,44,100
E 85
MA 160,48,96
R a,16,12,20
CV 108,84
MA 164,48,100
E 86
MA 168,52,96
R a,20,13,20
MA 172,52,100
E 87
MA 176,56,96
R a,24,14,20
CV 109,86
MA 180,56,100
E 88
MA 184,60,96
R a,28,15,20
MA 188,60,100
E 89
MD 112,52,96
CV 106,88
E 90
MD 116,52,100
s_xor_b32 m0, s65, 0x4000
s_xor_b32 s66, s62, 0x8000
W 6
ZB 64,0,64
G 44,24,66,0
ZB 68,0,68
E 91
MB 64,4,72
CV 107,90
MB 68,4,76
E 92
W 4
MB 64,8,80
G 45,24,66,1
MB 68,8,84
E 93
MB 64,12,88
CV 110,92
MB 68,12,92
E 94
W 2
ZB 72,16,64
G 46,24,66,2
ZB 76,16,68
E 95
MB 72,20,72
CV 111,94
MB 76,20,76
W 0
MB 72,24,80
G 47,24,66,3
MB 76,24,84
E 64
MB 72,28,88
E 65
MB 76,28,92
s_xor_b32 m0, s65, 0x8000
s_xor_b32 s66, s62, 0x10000
MA 192,32,104
G 44,24,66,0
MA 196,32,108
CV 96,64
E 66
MA 200,36,104
T 32,24,16
MA 204,36,108
E 67
MA 208,40,104
G 45,24,66,1
T 34,24,20
MA 212,40,108
T 36,25,16
CV 97,66
E 68
MA 216,44,104
T 38,25,20
MA 220,44,108
E 69
MA 224,48,104
G 46,24,66,2
T 40,26,16
MA 228,48,108
CV 100,68
E 70
MA 232,52,104
T 42,26,20
T 44,27,16
MA 236,52,108
E 71
MA 240,56,104
G 47,24,66,3
T 46,27,20
MA 244,56,108
CV 101,70
E 72
MA 248,60,104
T 48,28,16
MA 252,60,108
E 73
MD 120,52,104
T 50,28,20
T 52,29,16
MD 124,52,108
CV 98,72
E 74
ZB 80,0,96
T 54,29,20
ZB 84,0,100
E 75
MB 80,4,104
T 56,30,16
CV 99,74
MB 84,4,108
E 76
MB 80,8,112
T 58,30,20
T 60,31,16
MB 84,8,116
E 77
MB 80,12,120
W 14
T 62,31,20
CV 102,76
MB 84,12,124
E 78
ZB 88,16,96
E 79
ZB 92,16,100
MB 88,20,104
CV 103,78
MB 92,20,108
MB 88,24,112
E 80
MB 92,24,116
MB 88,28,120
E 81
MB 92,28,124
W 12
MA 128,32,96
s_waitcnt vmcnt(16) lgkmcnt(0)
s_barrier
R a,0,12,32
MA 132,32,100
CV 104,80
E 82
MA 136,36,96
R a,4,13,32
MA 140,36,100
E 83
MA 144,40,96
R a,8,14,32
CV 105,82
MA 148,40,100
E 84
MA 152,44,96
R a,12,15,32
MA 156,44,100
E 85
MA 160,48,96
R a,16,12,36
CV 108,84
MA 164,48,100
E 86
MA 168,52,96
R a,20,13,36
MA 172,52,100
E 87
MA 176,56,96
R a,24,14,36
CV 109,86
MA 180,56,100
E 88
MA 184,60,96
R a,28,15,36
MA 188,60,100
E 89
MD 112,52,96
CV 106,88
E 90
MD 116,52,100
s_xor_b32 m0, s65, 0xc000
s_xor_b32 s66, s62, 0x18000
W 6
ZB 64,0,64
G 44,24,66,0
ZB 68,0,68
E 91
MB 64,4,72
CV 107,90
MB 68,4,76
E 92
W 4
MB 64,8,80
G 45,24,66,1
MB 68,8,84
E 93
MB 64,12,88
CV 110,92
MB 68,12,92
E 94
W 2
ZB 72,16,64
G 46,24,66,2
ZB 76,16,68
E 95
MB 72,20,72
CV 111,94
MB 76,20,76
W 0
MB 72,24,80
G 47,24,66,3
MB 76,24,84
E 64
MB 72,28,88
E 65
MB 76,28,92
s_xor_b32 m0, s65, 0x10000
s_xor_b32 s66, s62, 0x20000
MA 192,32,104
G 44,24,66,0
MA 196,32,108
CV 96,64
E 66
MA 200,36,104
T 32,24,32
MA 204,36,108
E 67
MA 208,40,104
G 45,24,66,1
T 34,24,36
MA 212,40,108
T 36,25,32
CV 97,66
E 68
MA 216,44,104
T 38,25,36
MA 220,44,108
E 69
MA 224,48,104
G 46,24,66,2
T 40,26,32
MA 228,48,108
CV 100,68
E 70
MA 232,52,104
T 42,26,36
T 44,27,32
MA 236,52,108
E 71
MA 240,56,104
G 47,24,66,3
T 46,27,36
MA 244,56,108
CV 101,70
E 72
MA 248,60,104
T 48,28,32
MA 252,60,108
E 73
MD 120,52,104
T 50,28,36
T 52,29,32
MD 124,52,108
CV 98,72
E 74
ZB 80,0,96
T 54,29,36
ZB 84,0,100
E 75
MB 80,4,104
T 56,30,32
CV 99,74
MB 84,4,108
E 76
MB 80,8,112
T 58,30,36
T 60,31,32
MB 84,8,116
E 77
MB 80,12,120
W 14
T 62,31,36
CV 102,76
MB 84,12,124
E 78
ZB 88,16,96
E 79
ZB 92,16,100
MB 88,20,104
CV 103,78
MB 92,20,108
MB 88,24,112
E 80
MB 92,24,116
MB 88,28,120
E 81
MB 92,28,124
W 12
MA 128,32,96
s_waitcnt vmcnt(20) lgkmcnt(0)
s_barrier
R a,0,12,48
MA 132,32,100
CV 104,80
E 82
MA 136,36,96
R a,4,13,48
MA 140,36,100
E 83
MA 144,40,96
R a,8,14,48
CV 105,82
MA 148,40,100
E 84
MA 152,44,96
R a,12,15,48
MA 156,44,100
E 85
MA 160,48,96
R a,16,12,52
CV 108,84
MA 164,48,100
E 86
MA 168,52,96
R a,20,13,52
MA 172,52,100
E 87
MA 176,56,96
R a,24,14,52
CV 109,86
MA 180,56,100
E 88
MA 184,60,96
R a,28,15,52
v_xor_b32 v8, s68, v8
MA 188,60,100
E 89
MD 112,52,96
CV 106,88
v_xor_b32 v9, s68, v9
MD 116,52,100
E 90
s_xor_b32 m0, s65, 0x14000
s_xor_b32 s66, s62, 0x28000
W 6
ZB 64,0,64
G 44,24,66,0
ZB 68,0,68
v_xor_b32 v10, s68, v10
E 91
MB 64,4,72
CV 107,90
v_xor_b32 v11, s68, v11
MB 68,4,76
E 92
W 4
MB 64,8,80
G 45,24,66,1
MB 68,8,84
v_xor_b32 v12, s68, v12
E 93
MB 64,12,88
CV 110,92
v_xor_b32 v13, s68, v13
MB 68,12,92
E 94
W 2
ZB 72,16,64
G 46,24,66,2
ZB 76,16,68
v_xor_b32 v14, s68, v14
E 95
MB 72,20,72
CV 111,94
MB 76,20,76
v_xor_b32 v15, s68, v15
W 0
MB 72,24,80
G 47,24,66,3
MB 76,24,84
E 64
MB 72,28,88
E 65
MB 76,28,92
s_xor_b32 m0, s65, 0x18000
s_xor_b32 s66, s62, 0x30000
MA 192,32,104
G 44,24,66,0
MA 196,32,108
CV 96,64
E 66
MA 200,36,104
T 32,24,48
MA 204,36,108
E 67
MA 208,40,104
G 45,24,66,1
T 34,24,52
MA 212,40,108
T 36,25,48
CV 97,66
E 68
MA 216,44,104
T 38,25,52
MA 220,44,108
E 69
MA 224,48,104
G 46,24,66,2
T 40,26,48
MA 228,48,108
CV 100,68
E 70
MA 232,52,104
T 42,26,52
T 44,27,48
MA 236,52,108
E 71
MA 240,56,104
G 47,24,66,3
T 46,27,52
MA 244,56,108
CV 101,70
E 72
MA 248,60,104
T 48,28,48
MA 252,60,108
E 73
MD 120,52,104
T 50,28,52
T 52,29,48
MD 124,52,108
CV 98,72
E 74
ZB 80,0,96
T 54,29,52
ZB 84,0,100
E 75
MB 80,4,104
T 56,30,48
CV 99,74
MB 84,4,108
E 76
MB 80,8,112
T 58,30,52
T 60,31,48
MB 84,8,116
E 77
MB 80,12,120
W 14
T 62,31,52
CV 102,76
v_xor_b32 v16, s71, v16
MB 84,12,124
v_xor_b32 v17, s71, v17
E 78
ZB 88,16,96
v_xor_b32 v18, s71, v18
v_xor_b32 v19, s71, v19
ZB 92,16,100
E 79
MB 88,20,104
CV 103,78
MB 92,20,108
v_xor_b32 v20, s71, v20
v_xor_b32 v21, s71, v21
MB 88,24,112
v_xor_b32 v22, s71, v22
v_xor_b32 v23, s71, v23
MB 92,24,116
E 80
MB 88,28,120
v_xor_b32 v24, s71, v24
v_xor_b32 v25, s71, v25
MB 92,28,124
E 81
W 12
MA 128,32,96
CV 104,80
v_xor_b32 v26, s71, v26
MA 132,32,100
v_xor_b32 v27, s71, v27
E 82
MA 136,36,96
v_xor_b32 v28, s71, v28
v_xor_b32 v29, s71, v29
MA 140,36,100
E 83
W 8
MA 144,40,96
CV 105,82
v_xor_b32 v30, s71, v30
MA 148,40,100
v_xor_b32 v31, s71, v31
E 84
MA 152,44,96
E 85
MA 156,44,100
W 4
MA 160,48,96
CV 108,84
MA 164,48,100
E 86
MA 168,52,96
E 87
MA 172,52,100
W 0
MA 176,56,96
CV 109,86
MA 180,56,100
E 88
MA 184,60,96
E 89
MA 188,60,100
MD 112,52,96
CV 106,88
MD 116,52,100
E 90
E 91
s_nop 0
CV 107,90
E 92
E 93
s_nop 0
CV 110,92
E 94
E 95
s_nop 0
CV 111,94
MA 192,32,104
s_nop 0
MA 196,32,108
MA 200,36,104
MA 204,36,108
MA 208,40,104
MA 212,40,108
MA 216,44,104
MA 220,44,108
MA 224,48,104
s_waitcnt vmcnt(20)
s_barrier
T 0,16,0
MA 228,48,108
T 2,16,4
s_xor_b32 m0, s65, 0x1c000
s_xor_b32 s66, s62, 0x38000
MA 232,52,104
G 44,24,66,0
MA 236,52,108
T 4,17,0
T 6,17,4
MA 240,56,104
T 8,18,0
MA 244,56,108
T 10,18,4
MA 248,60,104
G 45,24,66,1
MA 252,60,108
T 12,19,0
T 14,19,4
MD 120,52,104
T 16,20,0
MD 124,52,108
T 18,20,4
v_mov_b32 v60, v112
v_mov_b32 v61, v116
v_cmp_nle_f32 vcc, s76, v60
v_cmp_nge_f32 s[82:83], s77, v60
v_cmp_nle_f32 s[84:85], s76, v61
v_cmp_nge_f32 s[90:91], s77, v61
s_nop 1
s_or_b64 vcc, vcc, s[82:83]
s_or_b64 vcc, vcc, s[84:85]
s_or_b64 vcc, vcc, s[90:91]
s_cbranch_scc1 L_slow_c2A0
L_back_c2A0:
v_rcp_f32 v0, v60
v_rcp_f32 v1, v61
s_nop 0
v_pk_mul_f32 v[128:129], v[128:129], v[0:1] op_sel_hi:[1,0]
v_pk_mul_f32 v[130:131], v[130:131], v[0:1] op_sel_hi:[1,0]
v_pk_mul_f32 v[132:133], v[132:133], v[0:1] op_sel:[0,1]
v_pk_mul_f32 v[134:135], v[134:135], v[0:1] op_sel:[0,1]
v_pk_mul_f32 v[136:137], v[136:137], v[0:1] op_sel_hi:[1,0]
v_pk_mul_f32 v[138:139], v[138:139], v[0:1] op_sel_hi:[1,0]
v_pk_mul_f32 v[140:141], v[140:141], v[0:1] op_sel:[0,1]
v_pk_mul_f32 v[142:143], v[142:143], v[0:1] op_sel:[0,1]
CV 128,128
CV 130,130
CV 132,132
CV 134,134
CV 136,136
CV 138,138
CV 140,140
CV 142,142
AW 64,128
AW 65,130
AW 68,132
AW 69,134
AW 66,136
AW 67,138
AW 70,140
AW 71,142
v_pk_mul_f32 v[144:145], v[144:145], v[0:1] op_sel_hi:[1,0]
v_pk_mul_f32 v[146:147], v[146:147], v[0:1] op_sel_hi:[1,0]
v_pk_mul_f32 v[148:149], v[148:149], v[0:1] op_sel:[0,1]
v_pk_mul_f32 v[150:151], v[150:151], v[0:1] op_sel:[0,1]
v_pk_mul_f32 v[152:153], v[152:153], v[0:1] op_sel_hi:[1,0]
v_pk_mul_f32 v[154:155], v[154:155], v[0:1] op_sel_hi:[1,0]
v_pk_mul_f32 v[156:157], v[156:157], v[0:1] op_sel:[0,1]
v_pk_mul_f32 v[158:159], v[158:159], v[0:1] op_sel:[0,1]
CV 144,144
CV 146,146
CV 148,148
CV 150,150
CV 152,152
CV 154,154
CV 156,156
CV 158,158
AW 72,144
AW 73,146
AW 76,148
AW 77,150
AW 74,152
AW 75,154
AW 78,156
AW 79,158
v_pk_mul_f32 v[160:161], v[160:161], v[0:1] op_sel_hi:[1,0]
v_pk_mul_f32 v[162:163], v[162:163], v[0:1] op_sel_hi:[1,0]
v_pk_mul_f32 v[164:165], v[164:165], v[0:1] op_sel:[0,1]
v_pk_mul_f32 v[166:167], v[166:167], v[0:1] op_sel:[0,1]
v_pk_mul_f32 v[168:169], v[168:169], v[0:1] op_sel_hi:[1,0]
v_pk_mul_f32 v[170:171], v[170:171], v[0:1] op_sel_hi:[1,0]
v_pk_mul_f32 v[172:173], v[172:173], v[0:1] op_sel:[0,1]
v_pk_mul_f32 v[174:175], v[174:175], v[0:1] op_sel:[0,1]
CV 160,160
CV 162,162
CV 164,164
CV 166,166
CV 168,168
CV 170,170
CV 172,172
CV 174,174
AW 80,160
AW 81,162
AW 84,164
AW 85,166
AW 82,168
AW 83,170
AW 86,172
AW 87,174
v_pk_mul_f32 v[176:177], v[176:177], v[0:1] op_sel_hi:[1,0]
v_pk_mul_f32 v[178:179], v[178:179], v[0:1] op_sel_hi:[1,0]
v_pk_mul_f32 v[180:181], v[180:181], v[0:1] op_sel:[0,1]
v_pk_mul_f32 v[182:183], v[182:183], v[0:1] op_sel:[0,1]
v_pk_mul_f32 v[184:185], v[184:185], v[0:1] op_sel_hi:[1,0]
v_pk_mul_f32 v[186:187], v[186:187], v[0:1] op_sel_hi:[1,0]
v_pk_mul_f32 v[188:189], v[188:189], v[0:1] op_sel:[0,1]
v_pk_mul_f32 v[190:191], v[190:191], v[0:1] op_sel:[0,1]
CV 176,176
CV 178,178
CV 180,180
CV 182,182
CV 184,184
CV 186,186
CV 188,188
CV 190,190
AW 88,176
AW 89,178
AW 92,180
AW 93,182
AW 90,184
AW 91,186
AW 94,188
AW 95,190
v_mov_b32 v60, v120
v_mov_b32 v61, v124
v_cmp_nle_f32 vcc, s76, v60
v_cmp_nge_f32 s[82:83], s77, v60
v_cmp_nle_f32 s[84:85], s76, v61
v_cmp_nge_f32 s[90:91], s77, v61
s_nop 1
s_or_b64 vcc, vcc, s[82:83]
s_or_b64 vcc, vcc, s[84:85]
s_or_b64 vcc, vcc, s[90:91]
s_cbranch_scc1 L_slow_c2A1
L_back_c2A1:
v_rcp_f32 v0, v60
v_rcp_f32 v1, v61
W 6
ZB 128,0,64
G 46,24,66,2
T 20,21,0
ZB 132,0,68
T 22,21,4
ds_write_b128 v58, a[64:67] offset:0
v_mul_f32 v192, v0, v192
ZB 136,4,64
T 24,22,0
T 26,22,4
ds_write_b128 v58, a[68:71] offset:1024
ZB 140,4,68
v_mul_f32 v193, v0, v193
v_mul_f32 v194, v0, v194
v_mul_f32 v195, v0, v195
W 8
ZB 144,8,64
G 47,24,66,3
T 28,23,0
ZB 148,8,68
T 30,23,4
ds_write_b128 v58, a[72:75] offset:2048
CV 192,192
ZB 152,12,64
T 32,16,16
T 34,16,20
ZB 156,12,68
ds_write_b128 v58, a[76:79] offset:3072
CV 194,194
AW 96,192
W 10
ZB 160,16,64
T 36,17,16
T 38,17,20
ZB 164,16,68
ds_write_b128 v58, a[80:83] offset:4096
AW 97,194
v_mul_f32 v196, v1, v196
ZB 168,20,64
T 40,18,16
T 42,18,20
W 14
ds_write_b128 v58, a[84:87] offset:5120
ZB 172,20,68
v_mul_f32 v197, v1, v197
v_mul_f32 v198, v1, v198
v_mul_f32 v199, v1, v199
W 10
ZB 176,24,64
T 44,19,16
T 46,19,20
ZB 180,24,68
ds_write_b128 v58, a[88:91] offset:6144
CV 196,196
CV 198,198
ZB 184,28,64
T 48,20,16
T 50,20,20
W 14
ds_write_b128 v58, a[92:95] offset:7168
ZB 188,28,68
AW 100,196
AW 101,198
v_mul_f32 v200, v0, v200
W 10
MB 128,32,72
T 52,21,16
T 54,21,20
MB 132,32,76
v_mul_f32 v201, v0, v201
v_mul_f32 v202, v0, v202
v_mul_f32 v203, v0, v203
MB 136,36,72
T 56,22,16
T 58,22,20
MB 140,36,76
CV 200,200
CV 202,202
AW 98,200
W 8
MB 144,40,72
T 60,23,16
T 62,23,20
MB 148,40,76
AW 99,202
v_mul_f32 v204, v1, v204
v_mul_f32 v205, v1, v205
MB 152,44,72
s_waitcnt vmcnt(16) lgkmcnt(6)
s_barrier
T 0,16,32
MB 156,44,76
T 2,16,36
R a,192,2,0
s_xor_b32 m0, s65, 0x0
s_xor_b32 s66, s62, 0x100
MB 160,48,72
G 44,24,66,0
T 4,17,32
MB 164,48,76
T 6,17,36
R a,196,2,1
v_mul_f32 v206, v1, v206
W 10
MB 168,52,72
T 8,18,32
T 10,18,36
MB 172,52,76
R a,200,2,2
v_mul_f32 v207, v1, v207
CV 204,204
W 9
MB 176,56,72
G 45,24,66,1
T 12,19,32
MB 180,56,76
T 14,19,36
R a,204,2,3
CV 206,206
MB 184,60,72
T 16,20,32
T 18,20,36
R a,208,2,4
MB 188,60,76
AW 102,204
AW 103,206
v_mul_f32 v208, v0, v208
W 10
MB 128,0,80
G 46,24,66,2
T 20,21,32
MB 132,0,84
T 22,21,36
R a,212,2,5
v_mul_f32 v209, v0, v209
MB 136,4,80
T 24,22,32
T 26,22,36
MB 140,4,84
W 14
R a,216,2,6
v_mul_f32 v210, v0, v210
v_mul_f32 v211, v0, v211
W 10
MB 144,8,80
G 47,24,66,3
T 28,23,32
MB 148,8,84
T 30,23,36
R a,220,2,7
CV 208,208
MB 152,12,80
T 32,16,48
T 34,16,52
MB 156,12,84
CV 210,210
AW 104,208
AW 105,210
W 9
MB 160,16,80
T 36,17,48
T 38,17,52
MB 164,16,84
v_mul_f32 v212, v1, v212
v_mul_f32 v213, v1, v213
v_mul_f32 v214, v1, v214
s_getpc_b64 s[88:89]
L_ct2_1075:
s_and_b32 s89, s89, 0xffff
s_mov_b32 s90, L_code_end-L_ct2_1075
s_mov_b32 s91, 0x20000
v_and_b32 v62, 0x70, v59
v_lshlrev_b32 v62, 3, v62
s_add_u32 s7, s1, 4096
buffer_load_dword v3, v62, s[88:91], s7 offen
MB 168,20,80
T 40,18,48
T 42,18,52
MB 172,20,84
v_mul_f32 v215, v1, v215
CV 212,212
CV 214,214
W 7
MB 176,24,80
T 44,19,48
T 46,19,52
AW 108,212
MB 180,24,84
AW 109,214
v_mul_f32 v216, v0, v216
v_mul_f32 v217, v0, v217
MB 184,28,80
T 48,20,48
T 50,20,52
MB 188,28,84
v_mul_f32 v218, v0, v218
v_mul_f32 v219, v0, v219
CV 216,216
W 6
MB 128,32,88
T 52,21,48
T 54,21,52
MB 132,32,92
CV 218,218
AW 106,216
AW 107,218
MB 136,36,88
T 56,22,48
T 58,22,52
MB 140,36,92
v_mul_f32 v220, v1, v220
v_mul_f32 v221, v1, v221
v_mul_f32 v222, v1, v222
W 6
MB 144,40,88
T 60,23,48
T 62,23,52
MB 148,40,92
v_mul_f32 v223, v1, v223
CV 220,220
CV 222,222
MB 152,44,88
s_waitcnt vmcnt(13)
s_barrier
T 0,24,0
MB 156,44,92
T 2,24,4
s_xor_b32 m0, s65, 0x4000
s_xor_b32 s66, s62, 0x8100
W 6
MB 160,48,88
G 44,24,66,0
T 4,25,0
MB 164,48,92
T 6,25,4
AW 110,220
AW 111,222
MB 168,52,88
T 8,26,0
T 10,26,4
MB 172,52,92
v_mul_f32 v224, v0, v224
v_mul_f32 v225, v0, v225
v_mul_f32 v226, v0, v226
W 6
MB 176,56,88
G 45,24,66,1
T 12,27,0
MB 180,56,92
T 14,27,4
v_mul_f32 v227, v0, v227
CV 224,224
MB 184,60,88
T 16,28,0
T 18,28,4
MB 188,60,92
CV 226,226
AW 112,224
AW 113,226
W 6
MB 128,0,192
G 46,24,66,2
T 20,29,0
MB 132,0,196
T 22,29,4
v_mul_f32 v228, v1, v228
v_mul_f32 v229, v1, v229
MB 136,4,192
T 24,30,0
T 26,30,4
MB 140,4,196
v_mul_f32 v230, v1, v230
v_mul_f32 v231, v1, v231
CV 228,228
W 6
MB 144,8,192
G 47,24,66,3
T 28,31,0
MB 148,8,196
T 30,31,4
CV 230,230
AW 116,228
MB 152,12,192
T 32,24,16
T 34,24,20
MB 156,12,196
AW 117,230
s_xor_b32 m0, s65, 0x8000
s_xor_b32 s66, s62, 0x10100
W 6
MB 160,16,192
G 44,24,66,0
T 36,25,16
MB 164,16,196
T 38,25,20
v_mul_f32 v232, v0, v232
v_mul_f32 v233, v0, v233
MB 168,20,192
T 40,26,16
T 42,26,20
MB 172,20,196
v_mul_f32 v234, v0, v234
v_mul_f32 v235, v0, v235
CV 232,232
W 6
MB 176,24,192
G 45,24,66,1
T 44,27,16
MB 180,24,196
T 46,27,20
CV 234,234
AW 114,232
MB 184,28,192
T 48,28,16
T 50,28,20
MB 188,28,196
AW 115,234
v_mul_f32 v236, v1, v236
v_mul_f32 v237, v1, v237
W 6
MB 128,32,200
G 46,24,66,2
MB 132,32,204
T 52,29,16
T 54,29,20
v_mul_f32 v238, v1, v238
MB 136,36,200
T 56,30,16
T 58,30,20
v_mul_f32 v239, v1, v239
MB 140,36,204
CV 236,236
CV 238,238
AW 118,236
W 6
MB 144,40,200
G 47,24,66,3
MB 148,40,204
T 60,31,16
T 62,31,20
AW 119,238
MB 152,44,200
s_waitcnt vmcnt(13)
s_barrier
T 0,24,32
MB 156,44,204
T 2,24,36
s_xor_b32 m0, s65, 0xc000
s_xor_b32 s66, s62, 0x18100
W 6
MB 160,48,200
G 44,24,66,0
T 4,25,32
MB 164,48,204
T 6,25,36
v_mul_f32 v240, v0, v240
v_mul_f32 v241, v0, v241
MB 168,52,200
T 8,26,32
T 10,26,36
MB 172,52,204
v_mul_f32 v242, v0, v242
v_mul_f32 v243, v0, v243
CV 240,240
W 6
MB 176,56,200
G 45,24,66,1
T 12,27,32
MB 180,56,204
T 14,27,36
CV 242,242
AW 120,240
MB 184,60,200
T 16,28,32
T 18,28,36
MB 188,60,204
AW 121,242
v_mul_f32 v244, v1, v244
v_mul_f32 v245, v1, v245
W 6
MB 128,0,208
G 46,24,66,2
T 20,29,32
MB 132,0,212
T 22,29,36
v_mul_f32 v246, v1, v246
v_mul_f32 v247, v1, v247
MB 136,4,208
T 24,30,32
T 26,30,36
MB 140,4,212
CV 244,244
CV 246,246
AW 124,244
W 6
MB 144,8,208
G 47,24,66,3
MB 148,8,212
T 28,31,32
T 30,31,36
AW 125,246
MB 152,12,208
T 32,24,48
T 34,24,52
v_mul_f32 v248, v0, v248
MB 156,12,212
v_mul_f32 v249, v0, v249
s_xor_b32 m0, s65, 0x10000
s_xor_b32 s66, s62, 0x20100
W 6
MB 160,16,208
G 44,24,66,0
T 36,25,48
MB 164,16,212
T 38,25,52
v_mul_f32 v250, v0, v250
v_mul_f32 v251, v0, v251
MB 168,20,208
T 40,26,48
T 42,26,52
MB 172,20,212
CV 248,248
CV 250,250
AW 122,248
W 6
MB 176,24,208
G 45,24,66,1
MB 180,24,212
T 44,27,48
T 46,27,52
AW 123,250
MB 184,28,208
T 48,28,48
T 50,28,52
v_mul_f32 v252, v1, v252
MB 188,28,212
v_mul_f32 v253, v1, v253
v_mul_f32 v254, v1, v254
v_mul_f32 v255, v1, v255
W 6
MB 128,32,216
G 46,24,66,2
MB 132,32,220
T 52,29,48
T 54,29,52
CV 252,252
MB 136,36,216
T 56,30,48
T 58,30,52
MB 140,36,220
CV 254,254
AW 126,252
AW 127,254
W 6
MB 144,40,216
G 47,24,66,3
MB 148,40,220
T 60,31,48
T 62,31,52
MB 152,44,216
s_waitcnt vmcnt(12)
s_barrier
T 0,16,0
MB 156,44,220
T 2,16,4
s_xor_b32 m0, s65, 0x14000
s_xor_b32 s66, s62, 0x28100
W 6
MB 160,48,216
G 44,24,66,0
MB 164,48,220
T 4,17,0
T 6,17,4
MB 168,52,216
T 8,18,0
MB 172,52,220
T 10,18,4
W 6
MB 176,56,216
G 45,24,66,1
MB 180,56,220
T 12,19,0
T 14,19,4
MB 184,60,216
T 16,20,0
MB 188,60,220
T 18,20,4
W 6
ZB 192,0,64
G 46,24,66,2
ZB 196,0,68
T 20,21,0
T 22,21,4
ZB 200,4,64
T 24,22,0
ZB 204,4,68
T 26,22,4
W 6
ZB 208,8,64
G 47,24,66,3
ZB 212,8,68
T 28,23,0
T 30,23,4
ZB 216,12,64
T 32,16,16
T 34,16,20
ZB 220,12,68
s_xor_b32 m0, s65, 0x18000
s_xor_b32 s66, s62, 0x30100
W 6
ZB 224,16,64
G 44,24,66,0
ZB 228,16,68
T 36,17,16
T 38,17,20
ZB 232,20,64
T 40,18,16
ZB 236,20,68
T 42,18,20
W 6
ZB 240,24,64
G 45,24,66,1
ZB 244,24,68
T 44,19,16
T 46,19,20
ZB 248,28,64
T 48,20,16
ZB 252,28,68
T 50,20,20
W 6
MB 192,32,72
G 46,24,66,2
MB 196,32,76
T 52,21,16
T 54,21,20
MB 200,36,72
T 56,22,16
MB 204,36,76
T 58,22,20
W 6
MB 208,40,72
G 47,24,66,3
MB 212,40,76
T 60,23,16
T 62,23,20
MB 216,44,72
s_waitcnt vmcnt(12)
s_barrier
T 0,16,32
MB 220,44,76
T 2,16,36
s_xor_b32 m0, s65, 0x1c000
s_xor_b32 s66, s62, 0x38100
W 6
MB 224,48,72
G 44,24,66,0
MB 228,48,76
T 4,17,32
T 6,17,36
MB 232,52,72
T 8,18,32
MB 236,52,76
T 10,18,36
W 6
MB 240,56,72
G 45,24,66,1
MB 244,56,76
T 12,19,32
T 14,19,36
MB 248,60,72
T 16,20,32
MB 252,60,76
T 18,20,36
W 6
MB 192,0,80
G 46,24,66,2
MB 196,0,84
T 20,21,32
T 22,21,36
MB 200,4,80
T 24,22,32
MB 204,4,84
T 26,22,36
W 6
MB 208,8,80
G 47,24,66,3
MB 212,8,84
T 28,23,32
T 30,23,36
MB 216,12,80
T 32,16,48
T 34,16,52
MB 220,12,84
s_xor_b32 m0, s65, 0x0
s_xor_b32 s66, s62, 0x40000
W 6
MB 224,16,80
G 44,24,66,0
MB 228,16,84
T 36,17,48
T 38,17,52
MB 232,20,80
T 40,18,48
MB 236,20,84
T 42,18,52
W 6
MB 240,24,80
G 45,24,66,1
MB 244,24,84
T 44,19,48
T 46,19,52
MB 248,28,80
T 48,20,48
MB 252,28,84
T 50,20,52
W 6
MB 192,32,88
G 46,24,66,2
MB 196,32,92
T 52,21,48
T 54,21,52
MB 200,36,88
T 56,22,48
MB 204,36,92
T 58,22,52
W 6
MB 208,40,88
G 47,24,66,3
MB 212,40,92
T 60,23,48
T 62,23,52
MB 216,44,88
s_waitcnt vmcnt(12)
s_barrier
T 0,24,0
MB 220,44,92
T 2,24,4
s_xor_b32 m0, s65, 0x4000
s_xor_b32 s66, s62, 0x48000
W 6
MB 224,48,88
G 44,24,66,0
MB 228,48,92
T 4,25,0
T 6,25,4
MB 232,52,88
T 8,26,0
MB 236,52,92
T 10,26,4
W 6
MB 240,56,88
G 45,24,66,1
MB 244,56,92
T 12,27,0
T 14,27,4
MB 248,60,88
T 16,28,0
MB 252,60,92
T 18,28,4
W 6
MB 192,0,192
G 46,24,66,2
MB 196,0,196
T 20,29,0
T 22,29,4
MB 200,4,192
T 24,30,0
MB 204,4,196
T 26,30,4
W 6
MB 208,8,192
G 47,24,66,3
MB 212,8,196
T 28,31,0
T 30,31,4
MB 216,12,192
T 32,24,16
T 34,24,20
MB 220,12,196
s_xor_b32 m0, s65, 0x8000
s_xor_b32 s66, s62, 0x50000
W 6
MB 224,16,192
G 44,24,66,0
MB 228,16,196
T 36,25,16
T 38,25,20
MB 232,20,192
T 40,26,16
MB 236,20,196
T 42,26,20
W 6
MB 240,24,192
G 45,24,66,1
MB 244,24,196
T 44,27,16
T 46,27,20
MB 248,28,192
T 48,28,16
MB 252,28,196
T 50,28,20
W 6
MB 192,32,200
G 46,24,66,2
MB 196,32,204
T 52,29,16
T 54,29,20
MB 200,36,200
T 56,30,16
MB 204,36,204
T 58,30,20
W 6
MB 208,40,200
G 47,24,66,3
MB 212,40,204
T 60,31,16
T 62,31,20
MB 216,44,200
s_waitcnt vmcnt(12)
s_barrier
T 0,24,32
MB 220,44,204
T 2,24,36
s_xor_b32 m0, s65, 0xc000
s_xor_b32 s66, s62, 0x58000
W 6
MB 224,48,200
G 44,24,66,0
MB 228,48,204
T 4,25,32
T 6,25,36
MB 232,52,200
T 8,26,32
MB 236,52,204
T 10,26,36
W 6
MB 240,56,200
G 45,24,66,1
MB 244,56,204
T 12,27,32
T 14,27,36
MB 248,60,200
T 16,28,32
MB 252,60,204
T 18,28,36
W 6
MB 192,0,208
G 46,24,66,2
MB 196,0,212
T 20,29,32
T 22,29,36
MB 200,4,208
T 24,30,32
MB 204,4,212
T 26,30,36
W 6
MB 208,8,208
G 47,24,66,3
MB 212,8,212
T 28,31,32
T 30,31,36
MB 216,12,208
T 32,24,48
T 34,24,52
MB 220,12,212
s_xor_b32 m0, s65, 0x10000
s_xor_b32 s66, s62, 0x60000
W 6
MB 224,16,208
G 44,24,66,0
MB 228,16,212
T 36,25,48
T 38,25,52
MB 232,20,208
T 40,26,48
MB 236,20,212
T 42,26,52
W 6
MB 240,24,208
G 45,24,66,1
MB 244,24,212
T 44,27,48
T 46,27,52
MB 248,28,208
T 48,28,48
MB 252,28,212
T 50,28,52
W 6
MB 192,32,216
G 46,24,66,2
MB 196,32,220
T 52,29,48
T 54,29,52
MB 200,36,216
T 56,30,48
MB 204,36,220
T 58,30,52
W 6
MB 208,40,216
G 47,24,66,3
MB 212,40,220
T 60,31,48
T 62,31,52
MB 216,44,216
s_waitcnt vmcnt(12)
s_barrier
T 0,16,0
MB 220,44,220
T 2,16,4
s_xor_b32 m0, s65, 0x14000
s_xor_b32 s66, s62, 0x68000
W 6
MB 224,48,216
G 44,24,66,0
MB 228,48,220
T 4,17,0
T 6,17,4
MB 232,52,216
T 8,18,0
MB 236,52,220
T 10,18,4
W 6
MB 240,56,216
G 45,24,66,1
MB 244,56,220
T 12,19,0
T 14,19,4
MB 248,60,216
T 16,20,0
MB 252,60,220
T 18,20,4
W 6
MB 128,0,96
G 46,24,66,2
MB 132,0,100
T 20,21,0
T 22,21,4
ds_write_b128 v58, a[96:99] offset:0
MB 136,4,96
T 24,22,0
MB 140,4,100
T 26,22,4
ds_write_b128 v58, a[100:103] offset:1024
W 8
MB 144,8,96
G 47,24,66,3
MB 148,8,100
T 28,23,0
T 30,23,4
ds_write_b128 v58, a[104:107] offset:2048
MB 152,12,96
T 32,16,16
T 34,16,20
MB 156,12,100
ds_write_b128 v58, a[108:111] offset:3072
s_xor_b32 m0, s65, 0x18000
s_xor_b32 s66, s62, 0x70000
W 10
MB 160,16,96
G 44,24,66,0
MB 164,16,100
T 36,17,16
T 38,17,20
ds_write_b128 v58, a[112:115] offset:4096
MB 168,20,96
T 40,18,16
MB 172,20,100
T 42,18,20
W 14
ds_write_b128 v58, a[116:119] offset:5120
W 10
MB 176,24,96
G 45,24,66,1
MB 180,24,100
T 44,19,16
T 46,19,20
ds_write_b128 v58, a[120:123] offset:6144
MB 184,28,96
T 48,20,16
MB 188,28,100
T 50,20,20
W 14
ds_write_b128 v58, a[124:127] offset:7168
W 10
MB 128,32,104
G 46,24,66,2
MB 132,32,108
T 52,21,16
T 54,21,20
MB 136,36,104
T 56,22,16
MB 140,36,108
T 58,22,20
W 8
MB 144,40,104
G 47,24,66,3
MB 148,40,108
T 60,23,16
T 62,23,20
MB 152,44,104
s_waitcnt vmcnt(12) lgkmcnt(6)
s_barrier
T 0,16,32
MB 156,44,108
T 2,16,36
R a,224,2,0
s_xor_b32 m0, s65, 0x1c000
s_xor_b32 s66, s62, 0x78000
MB 160,48,104
G 44,24,66,0
MB 164,48,108
T 4,17,32
T 6,17,36
R a,228,2,1
W 10
MB 168,52,104
T 8,18,32
MB 172,52,108
T 10,18,36
R a,232,2,2
W 9
MB 176,56,104
G 45,24,66,1
MB 180,56,108
T 12,19,32
T 14,19,36
R a,236,2,3
MB 184,60,104
T 16,20,32
MB 188,60,108
T 18,20,36
R a,240,2,4
W 10
MB 128,0,112
G 46,24,66,2
MB 132,0,116
T 20,21,32
T 22,21,36
R a,244,2,5
MB 136,4,112
T 24,22,32
MB 140,4,116
T 26,22,36
W 14
R a,248,2,6
W 10
MB 144,8,112
G 47,24,66,3
MB 148,8,116
T 28,23,32
T 30,23,36
R a,252,2,7
MB 152,12,112
T 32,16,48
T 34,16,52
MB 156,12,116
s_xor_b32 m0, s65, 0x0
s_xor_b32 s66, s62, 0x40100
W 9
MB 160,16,112
G 44,24,66,0
MB 164,16,116
T 36,17,48
T 38,17,52
s_getpc_b64 s[88:89]
L_ct2_1203:
s_and_b32 s89, s89, 0xffff
s_mov_b32 s90, L_code_end-L_ct2_1203
s_mov_b32 s91, 0x20000
v_and_b32 v62, 0x70, v59
v_lshlrev_b32 v62, 3, v62
s_add_u32 s7, s1, 4096
buffer_load_dword v3, v62, s[88:91], s7 offen
MB 168,20,112
T 40,18,48
MB 172,20,116
T 42,18,52
W 7
MB 176,24,112
G 45,24,66,1
MB 180,24,116
T 44,19,48
T 46,19,52
MB 184,28,112
T 48,20,48
MB 188,28,116
T 50,20,52
W 6
MB 128,32,120
G 46,24,66,2
MB 132,32,124
T 52,21,48
T 54,21,52
MB 136,36,120
T 56,22,48
MB 140,36,124
T 58,22,52
W 6
MB 144,40,120
G 47,24,66,3
MB 148,40,124
T 60,23,48
T 62,23,52
MB 152,44,120
s_waitcnt vmcnt(13)
s_barrier
T 0,24,0
MB 156,44,124
T 2,24,4
s_xor_b32 m0, s65, 0x4000
s_xor_b32 s66, s62, 0x48100
W 6
MB 160,48,120
G 44,24,66,0
MB 164,48,124
T 4,25,0
T 6,25,4
MB 168,52,120
T 8,26,0
MB 172,52,124
T 10,26,4
W 6
MB 176,56,120
G 45,24,66,1
MB 180,56,124
T 12,27,0
T 14,27,4
MB 184,60,120
T 16,28,0
MB 188,60,124
T 18,28,4
W 6
MB 128,0,224
G 46,24,66,2
MB 132,0,228
T 20,29,0
T 22,29,4
MB 136,4,224
T 24,30,0
MB 140,4,228
T 26,30,4
W 6
MB 144,8,224
G 47,24,66,3
MB 148,8,228
T 28,31,0
T 30,31,4
MB 152,12,224
T 32,24,16
T 34,24,20
MB 156,12,228
s_xor_b32 m0, s65, 0x8000
s_xor_b32 s66, s62, 0x50100
W 6
MB 160,16,224
G 44,24,66,0
MB 164,16,228
T 36,25,16
T 38,25,20
MB 168,20,224
T 40,26,16
MB 172,20,228
T 42,26,20
W 6
MB 176,24,224
G 45,24,66,1
MB 180,24,228
T 44,27,16
T 46,27,20
MB 184,28,224
T 48,28,16
MB 188,28,228
T 50,28,20
W 6
MB 128,32,232
G 46,24,66,2
MB 132,32,236
T 52,29,16
T 54,29,20
MB 136,36,232
T 56,30,16
MB 140,36,236
T 58,30,20
W 6
MB 144,40,232
G 47,24,66,3
MB 148,40,236
T 60,31,16
T 62,31,20
MB 152,44,232
s_waitcnt vmcnt(13)
s_barrier
T 0,24,32
MB 156,44,236
T 2,24,36
s_xor_b32 m0, s65, 0xc000
s_xor_b32 s66, s62, 0x58100
W 6
MB 160,48,232
G 44,24,66,0
MB 164,48,236
T 4,25,32
T 6,25,36
MB 168,52,232
T 8,26,32
MB 172,52,236
T 10,26,36
W 6
MB 176,56,232
G 45,24,66,1
MB 180,56,236
T 12,27,32
T 14,27,36
MB 184,60,232
T 16,28,32
MB 188,60,236
T 18,28,36
W 6
MB 128,0,240
G 46,24,66,2
MB 132,0,244
T 20,29,32
T 22,29,36
MB 136,4,240
T 24,30,32
MB 140,4,244
T 26,30,36
W 6
MB 144,8,240
G 47,24,66,3
MB 148,8,244
T 28,31,32
T 30,31,36
MB 152,12,240
T 32,24,48
T 34,24,52
MB 156,12,244
s_xor_b32 m0, s65, 0x10000
s_xor_b32 s66, s62, 0x60100
W 6
MB 160,16,240
G 44,24,66,0
MB 164,16,244
T 36,25,48
T 38,25,52
MB 168,20,240
T 40,26,48
MB 172,20,244
T 42,26,52
W 6
MB 176,24,240
G 45,24,66,1
MB 180,24,244
T 44,27,48
T 46,27,52
MB 184,28,240
T 48,28,48
MB 188,28,244
T 50,28,52
W 6
MB 128,32,248
G 46,24,66,2
MB 132,32,252
T 52,29,48
T 54,29,52
MB 136,36,248
T 56,30,48
MB 140,36,252
T 58,30,52
W 6
MB 144,40,248
G 47,24,66,3
MB 148,40,252
T 60,31,48
T 62,31,52
MB 152,44,248
s_waitcnt vmcnt(12)
s_barrier
T 0,16,0
MB 156,44,252
T 2,16,4
s_xor_b32 m0, s65, 0x14000
s_xor_b32 s66, s62, 0x68100
W 6
MB 160,48,248
G 44,24,66,0
MB 164,48,252
T 4,17,0
T 6,17,4
MB 168,52,248
T 8,18,0
MB 172,52,252
T 10,18,4
W 6
MB 176,56,248
G 45,24,66,1
MB 180,56,252
T 12,19,0
T 14,19,4
MB 184,60,248
T 16,20,0
MB 188,60,252
T 18,20,4
W 6
MB 192,0,96
G 46,24,66,2
MB 196,0,100
T 20,21,0
T 22,21,4
MB 200,4,96
T 24,22,0
MB 204,4,100
T 26,22,4
W 6
MB 208,8,96
G 47,24,66,3
MB 212,8,100
T 28,23,0
T 30,23,4
MB 216,12,96
T 32,16,16
T 34,16,20
CV 68,132
MB 220,12,100
CV 69,134
s_xor_b32 m0, s65, 0x18000
s_xor_b32 s66, s62, 0x70100
W 6
MB 224,16,96
G 44,24,66,0
MB 228,16,100
T 36,17,16
T 38,17,20
CV 70,140
MB 232,20,96
T 40,18,16
T 42,18,20
MB 236,20,100
CV 71,142
s_xor_b32 s79, s67, 0x11000
W 6
MB 240,24,96
G 45,24,66,1
T 44,19,16
MB 244,24,100
T 46,19,20
buffer_store_dwordx4 v[68:71], v59, s[52:55], s79 offen sc1
MB 248,28,96
T 48,20,16
T 50,20,20
MB 252,28,100
CV 72,144
CV 73,146
W 6
MB 192,32,104
G 46,24,66,2
MB 196,32,108
T 52,21,16
T 54,21,20
CV 74,152
MB 200,36,104
T 56,22,16
T 58,22,20
MB 204,36,108
CV 75,154
s_xor_b32 s79, s67, 0x22000
W 6
MB 208,40,104
G 47,24,66,3
T 60,23,16
MB 212,40,108
T 62,23,20
buffer_store_dwordx4 v[72:75], v59, s[52:55], s79 offen sc1
MB 216,44,104
s_waitcnt vmcnt(14)
s_barrier
T 0,16,32
T 2,16,36
MB 220,44,108
CV 76,148
CV 77,150
s_xor_b32 m0, s65, 0x1c000
s_xor_b32 s66, s62, 0x78100
W 6
MB 224,48,104
G 44,24,66,0
MB 228,48,108
T 4,17,32
T 6,17,36
CV 78,156
MB 232,52,104
T 8,18,32
T 10,18,36
MB 236,52,108
CV 79,158
s_xor_b32 s79, s67, 0x33000
W 6
MB 240,56,104
G 45,24,66,1
T 12,19,32
MB 244,56,108
T 14,19,36
buffer_store_dwordx4 v[76:79], v59, s[52:55], s79 offen sc1
MB 248,60,104
T 16,20,32
T 18,20,36
MB 252,60,108
CV 80,160
CV 81,162
W 6
MB 192,0,112
G 46,24,66,2
MB 196,0,116
T 20,21,32
T 22,21,36
CV 82,168
MB 200,4,112
T 24,22,32
T 26,22,36
MB 204,4,116
CV 83,170
s_xor_b32 s79, s67, 0x44000
W 6
MB 208,8,112
G 47,24,66,3
T 28,23,32
MB 212,8,116
T 30,23,36
buffer_store_dwordx4 v[80:83], v59, s[52:55], s79 offen sc1
MB 216,12,112
T 32,16,48
T 34,16,52
CV 84,164
MB 220,12,116
CV 85,166
s_xor_b32 m0, s65, 0x0
s_xor_b32 s66, s63, 0x0
W 6
MB 224,16,112
G 32,32,66,0,nt
MB 228,16,116
T 36,17,48
T 38,17,52
CV 86,172
MB 232,20,112
T 40,18,48
T 42,18,52
MB 236,20,116
CV 87,174
s_xor_b32 s79, s67, 0x55000
W 6
MB 240,24,112
G 33,32,66,1,nt
T 44,19,48
MB 244,24,116
T 46,19,52
buffer_store_dwordx4 v[84:87], v59, s[52:55], s79 offen sc1
MB 248,28,112
T 48,20,48
T 50,20,52
MB 252,28,116
CV 88,176
CV 89,178
W 6
MB 192,32,120
G 34,32,66,2,nt
MB 196,32,124
T 52,21,48
T 54,21,52
CV 90,184
MB 200,36,120
T 56,22,48
T 58,22,52
MB 204,36,124
CV 91,186
s_xor_b32 s79, s67, 0x66000
W 6
MB 208,40,120
G 35,32,66,3,nt
T 60,23,48
MB 212,40,124
T 62,23,52
buffer_store_dwordx4 v[88:91], v59, s[52:55], s79 offen sc1
MB 216,44,120
s_waitcnt vmcnt(18)
s_barrier
T 0,24,0
T 2,24,4
MB 220,44,124
CV 92,180
CV 93,182
s_xor_b32 m0, s65, 0x4000
s_xor_b32 s66, s63, 0x10000
W 6
MB 224,48,120
G 32,32,66,0,nt
MB 228,48,124
T 4,25,0
T 6,25,4
CV 94,188
MB 232,52,120
T 8,26,0
T 10,26,4
MB 236,52,124
CV 95,190
s_xor_b32 s79, s67, 0x77000
W 6
MB 240,56,120
G 33,32,66,1,nt
T 12,27,0
MB 244,56,124
T 14,27,4
buffer_store_dwordx4 v[92:95], v59, s[52:55], s79 offen sc1
MB 248,60,120
T 16,28,0
MB 252,60,124
T 18,28,4
CV 36,128
W 6
MB 192,0,224
G 34,32,66,2,nt
MB 196,0,228
T 20,29,0
T 22,29,4
CV 37,130
MB 200,4,224
T 24,30,0
MB 204,4,228
T 26,30,4
CV 38,136
W 6
MB 208,8,224
G 35,32,66,3,nt
MB 212,8,228
T 28,31,0
T 30,31,4
CV 39,138
MB 216,12,224
T 32,24,16
T 34,24,20
MB 220,12,228
s_xor_b32 m0, s65, 0x8000
s_xor_b32 s66, s63, 0x0
W 6
MB 224,16,224
G 56,36,66,0,nt
MB 228,16,228
T 36,25,16
T 38,25,20
MB 232,20,224
T 40,26,16
MB 236,20,228
T 42,26,20
W 6
MB 240,24,224
G 57,36,66,1,nt
MB 244,24,228
T 44,27,16
T 46,27,20
MB 248,28,224
T 48,28,16
MB 252,28,228
T 50,28,20
W 6
MB 192,32,232
G 56,36,66,2,nt
MB 196,32,236
T 52,29,16
T 54,29,20
MB 200,36,232
T 56,30,16
MB 204,36,236
T 58,30,20
W 6
MB 208,40,232
G 57,36,66,3,nt
MB 212,40,236
T 60,31,16
T 62,31,20
MB 216,44,232
s_waitcnt vmcnt(16)
s_barrier
T 0,24,32
MB 220,44,236
T 2,24,36
s_xor_b32 m0, s65, 0xc000
s_xor_b32 s66, s63, 0x4000
W 6
MB 224,48,232
G 32,32,66,0,nt
MB 228,48,236
T 4,25,32
T 6,25,36
MB 232,52,232
T 8,26,32
MB 236,52,236
T 10,26,36
W 6
MB 240,56,232
G 33,32,66,1,nt
MB 244,56,236
T 12,27,32
T 14,27,36
MB 248,60,232
T 16,28,32
MB 252,60,236
T 18,28,36
W 6
MB 192,0,240
G 34,32,66,2,nt
MB 196,0,244
T 20,29,32
T 22,29,36
MB 200,4,240
T 24,30,32
MB 204,4,244
T 26,30,36
W 6
MB 208,8,240
G 35,32,66,3,nt
MB 212,8,244
T 28,31,32
T 30,31,36
MB 216,12,240
T 32,24,48
MB 220,12,244
T 34,24,52
W 6
MB 224,16,240
T 36,25,48
MB 228,16,244
T 38,25,52
MB 232,20,240
T 40,26,48
MB 236,20,244
T 42,26,52
W 6
MB 240,24,240
T 44,27,48
MB 244,24,244
T 46,27,52
MB 248,28,240
T 48,28,48
MB 252,28,244
T 50,28,52
W 6
MB 192,32,248
T 52,29,48
MB 196,32,252
T 54,29,52
MB 200,36,248
T 56,30,48
MB 204,36,252
T 58,30,52
W 6
MB 208,40,248
T 60,31,48
MB 212,40,252
T 62,31,52
MB 216,44,248
s_waitcnt vmcnt(14)
s_barrier
MB 220,44,252
R a,0,8,0
s_xor_b32 m0, s65, 0x10000
s_xor_b32 s66, s63, 0x10000
W 5
MB 224,48,248
G 56,36,66,0,nt
MB 228,48,252
R a,4,9,0
MB 232,52,248
R a,8,10,0
MB 236,52,252
W 3
MB 240,56,248
G 57,36,66,1,nt
MB 244,56,252
R a,12,11,0
MB 248,60,248
R a,16,8,4
MB 252,60,252
CV 100,196
CV 101,198
CV 102,204
CV 103,206
s_xor_b32 s79, s67, 0x19000
buffer_store_dwordx4 v[100:103], v59, s[52:55], s79 offen sc1
CV 104,208
CV 105,210
CV 106,216
CV 107,218
s_xor_b32 s79, s67, 0x2a000
buffer_store_dwordx4 v[104:107], v59, s[52:55], s79 offen sc1
CV 108,212
CV 109,214
CV 110,220
CV 111,222
s_xor_b32 s79, s67, 0x3b000
buffer_store_dwordx4 v[108:111], v59, s[52:55], s79 offen sc1
CV 112,224
CV 113,226
CV 114,232
CV 115,234
s_xor_b32 s79, s67, 0x4c000
buffer_store_dwordx4 v[112:115], v59, s[52:55], s79 offen sc1
CV 116,228
CV 117,230
CV 118,236
CV 119,238
s_xor_b32 s79, s67, 0x5d000
buffer_store_dwordx4 v[116:119], v59, s[52:55], s79 offen sc1
CV 120,240
CV 121,242
CV 122,248
CV 123,250
s_xor_b32 s79, s67, 0x6e000
buffer_store_dwordx4 v[120:123], v59, s[52:55], s79 offen sc1
CV 124,244
CV 125,246
CV 126,252
CV 127,254
s_xor_b32 s79, s67, 0x7f000
buffer_store_dwordx4 v[124:127], v59, s[52:55], s79 offen sc1
CV 40,192
CV 41,194
CV 42,200
CV 43,202
W 3
ZB 64,0,128
G 56,36,66,2,nt
ZB 68,0,132
R a,20,9,4
MB 64,4,136
R a,24,10,4
MB 68,4,140
W 3
MB 64,8,144
G 57,36,66,3,nt
MB 68,8,148
R a,28,11,4
MB 64,12,152
MB 68,12,156
W 2
ZB 72,16,128
ZB 76,16,132
MB 72,20,136
MB 76,20,140
W 0
MB 72,24,144
E 64
MB 76,24,148
MB 72,28,152
E 65
MB 76,28,156
CV 96,64
E 66
E 67
s_nop 0
CV 97,66
E 68
s_waitcnt vmcnt(19)
s_barrier
R a,0,8,16
E 69
s_xor_b32 m0, s65, 0x14000
s_xor_b32 s66, s63, 0x14000
R a,4,9,16
G 32,32,66,0,nt
CV 100,68
E 70
R a,8,10,16
E 71
R a,12,11,16
G 33,32,66,1,nt
CV 101,70
E 72
R a,16,8,20
E 73
W 3
ZB 80,0,128
G 34,32,66,2,nt
R a,20,9,20
ZB 84,0,132
CV 98,72
E 74
v_mov_b32 v61, 1
v_mov_b32 v62, 0
s_mov_b64 exec, 1
buffer_store_dword v61, v62, s[52:55], s5 offen offset:0 sc1
s_mov_b64 exec, -1
MB 80,4,136
R a,24,10,20
MB 84,4,140
E 75
W 3
MB 80,8,144
G 35,32,66,3,nt
R a,28,11,20
MB 84,8,148
CV 99,74
E 76
MB 80,12,152
s_waitcnt vmcnt(20)
s_barrier
T 32,16,32
T 34,16,36
MB 84,12,156
E 77
s_xor_b32 m0, s65, 0x18000
s_xor_b32 s66, s63, 0x4000
W 4
ZB 88,16,128
G 56,36,66,0,nt
T 36,17,32
ZB 92,16,132
T 38,17,36
CV 102,76
E 78
s_getpc_b64 s[88:89]
L_ct2_1331:
s_and_b32 s89, s89, 0xffff
s_mov_b32 s90, L_code_end-L_ct2_1331
s_mov_b32 s91, 0x20000
v_and_b32 v62, 0x70, v59
v_lshlrev_b32 v62, 3, v62
s_add_u32 s7, s1, 4096
buffer_load_dword v3, v62, s[88:91], s7 offen
MB 88,20,136
T 40,18,32
T 42,18,36
MB 92,20,140
E 79
W 6
MB 88,24,144
G 57,36,66,1,nt
T 44,19,32
MB 92,24,148
T 46,19,36
CV 103,78
E 80
MB 88,28,152
T 48,20,32
T 50,20,36
MB 92,28,156
E 81
W 6
ZA 128,32,96
G 56,36,66,2,nt
T 52,21,32
ZA 132,32,100
T 54,21,36
CV 104,80
E 82
ZA 136,36,96
T 56,22,32
T 58,22,36
ZA 140,36,100
E 83
W 6
ZA 144,40,96
G 57,36,66,3,nt
T 60,23,32
ZA 148,40,100
T 62,23,36
CV 105,82
E 84
ZA 152,44,96
E 85
ZA 156,44,100
W 4
ZA 160,48,96
s_waitcnt vmcnt(21)
s_barrier
R a,0,8,48
CV 108,84
ZA 164,48,100
E 86
s_xor_b32 m0, s65, 0x1c000
s_xor_b32 s66, s63, 0x1000
ZA 168,52,96
G 32,32,66,0,nt
ZA 172,52,100
R a,4,9,48
E 87
W 2
ZA 176,56,96
R a,8,10,48
CV 109,86
ZA 180,56,100
E 88
ZA 184,60,96
G 33,32,66,1,nt
ZA 188,60,100
R a,12,11,48
E 89
ZD 112,52,96
R a,16,8,52
CV 106,88
ZD 116,52,100
E 90
W 3
ZB 64,0,128
G 34,32,66,2,nt
ZB 68,0,132
R a,20,9,52
E 91
MB 64,4,136
R a,24,10,52
CV 107,90
MB 68,4,140
E 92
W 3
MB 64,8,144
G 35,32,66,3,nt
MB 68,8,148
R a,28,11,52
E 93
MB 64,12,152
s_waitcnt vmcnt(14)
s_barrier
T 32,24,0
T 34,24,4
MB 68,12,156
CV 110,92
E 94
s_xor_b32 m0, s65, 0x0
s_xor_b32 s66, s63, 0x14000
W 4
ZB 72,16,128
G 56,36,66,0,nt
T 36,25,0
ZB 76,16,132
T 38,25,4
E 95
MB 72,20,136
T 40,26,0
MB 76,20,140
T 42,26,4
CV 111,94
W 6
MB 72,24,144
G 57,36,66,1,nt
T 44,27,0
MB 76,24,148
T 46,27,4
E 64
MB 72,28,152
T 48,28,0
T 50,28,4
MB 76,28,156
E 65
W 6
MA 128,32,104
G 56,36,66,2,nt
T 52,29,0
MA 132,32,108
T 54,29,4
CV 96,64
E 66
MA 136,36,104
T 56,30,0
T 58,30,4
MA 140,36,108
E 67
W 6
MA 144,40,104
G 57,36,66,3,nt
T 60,31,0
MA 148,40,108
T 62,31,4
CV 97,66
E 68
MA 152,44,104
E 69
MA 156,44,108
W 4
MA 160,48,104
s_waitcnt vmcnt(13)
s_barrier
R a,0,12,16
CV 100,68
MA 164,48,108
E 70
s_xor_b32 m0, s65, 0x4000
s_xor_b32 s66, s63, 0x11000
MA 168,52,104
G 32,32,66,0,nt
MA 172,52,108
R a,4,13,16
E 71
W 2
MA 176,56,104
R a,8,14,16
CV 101,70
MA 180,56,108
E 72
MA 184,60,104
G 33,32,66,1,nt
MA 188,60,108
R a,12,15,16
E 73
v_mov_b32 v61, 1
v_mov_b32 v62, 0
s_mov_b64 exec, 1
buffer_store_dword v61, v62, s[52:55], s5 offen offset:128 sc1
s_mov_b64 exec, -1
MD 112,52,104
R a,16,12,20
CV 98,72
MD 116,52,108
E 74
W 3
ZB 80,0,128
G 34,32,66,2,nt
ZB 84,0,132
R a,20,13,20
E 75
MB 80,4,136
R a,24,14,20
CV 99,74
MB 84,4,140
E 76
W 3
MB 80,8,144
G 35,32,66,3,nt
MB 84,8,148
R a,28,15,20
E 77
MB 80,12,152
s_waitcnt vmcnt(13)
s_barrier
T 32,24,32
T 34,24,36
MB 84,12,156
CV 102,76
E 78
s_xor_b32 m0, s65, 0x8000
s_xor_b32 s66, s63, 0x1000
W 4
ZB 88,16,128
G 56,36,66,0,nt
T 36,25,32
ZB 92,16,132
T 38,25,36
E 79
MB 88,20,136
T 40,26,32
MB 92,20,140
T 42,26,36
CV 103,78
W 6
MB 88,24,144
G 57,36,66,1,nt
T 44,27,32
MB 92,24,148
T 46,27,36
E 80
MB 88,28,152
T 48,28,32
T 50,28,36
MB 92,28,156
E 81
W 6
MA 128,32,96
G 56,36,66,2,nt
T 52,29,32
MA 132,32,100
T 54,29,36
CV 104,80
E 82
MA 136,36,96
T 56,30,32
T 58,30,36
MA 140,36,100
E 83
W 6
MA 144,40,96
G 57,36,66,3,nt
T 60,31,32
MA 148,40,100
T 62,31,36
CV 105,82
E 84
MA 152,44,96
E 85
MA 156,44,100
W 4
MA 160,48,96
s_waitcnt vmcnt(13)
s_barrier
R a,0,12,48
CV 108,84
MA 164,48,100
E 86
s_xor_b32 m0, s65, 0xc000
s_xor_b32 s66, s63, 0x5000
MA 168,52,96
G 32,32,66,0,nt
MA 172,52,100
R a,4,13,48
E 87
W 2
MA 176,56,96
R a,8,14,48
CV 109,86
MA 180,56,100
E 88
MA 184,60,96
G 33,32,66,1,nt
MA 188,60,100
R a,12,15,48
E 89
MD 112,52,96
R a,16,12,52
CV 106,88
MD 116,52,100
E 90
W 3
ZB 64,0,128
G 34,32,66,2,nt
ZB 68,0,132
R a,20,13,52
E 91
MB 64,4,136
R a,24,14,52
CV 107,90
MB 68,4,140
E 92
W 3
MB 64,8,144
G 35,32,66,3,nt
MB 68,8,148
R a,28,15,52
E 93
MB 64,12,152
s_waitcnt vmcnt(13)
s_barrier
T 32,16,0
T 34,16,4
MB 68,12,156
CV 110,92
E 94
s_xor_b32 m0, s65, 0x10000
s_xor_b32 s66, s63, 0x11000
W 4
ZB 72,16,128
G 56,36,66,0,nt
T 36,17,0
ZB 76,16,132
T 38,17,4
E 95
MB 72,20,136
T 40,18,0
MB 76,20,140
T 42,18,4
CV 111,94
W 6
MB 72,24,144
G 57,36,66,1,nt
T 44,19,0
MB 76,24,148
T 46,19,4
E 64
MB 72,28,152
T 48,20,0
T 50,20,4
MB 76,28,156
E 65
W 6
MA 128,32,104
G 56,36,66,2,nt
T 52,21,0
MA 132,32,108
T 54,21,4
CV 96,64
E 66
MA 136,36,104
T 56,22,0
T 58,22,4
MA 140,36,108
E 67
W 6
MA 144,40,104
G 57,36,66,3,nt
T 60,23,0
MA 148,40,108
T 62,23,4
CV 97,66
E 68
MA 152,44,104
E 69
MA 156,44,108
W 4
MA 160,48,104
s_waitcnt vmcnt(12)
s_barrier
R a,0,8,16
CV 100,68
MA 164,48,108
E 70
s_xor_b32 m0, s65, 0x14000
s_xor_b32 s66, s63, 0x15000
MA 168,52,104
G 32,32,66,0,nt
MA 172,52,108
R a,4,9,16
E 71
W 2
MA 176,56,104
R a,8,10,16
CV 101,70
MA 180,56,108
E 72
MA 184,60,104
G 33,32,66,1,nt
MA 188,60,108
R a,12,11,16
E 73
MD 112,52,104
R a,16,8,20
CV 98,72
MD 116,52,108
E 74
W 3
ZB 80,0,128
G 34,32,66,2,nt
ZB 84,0,132
R a,20,9,20
E 75
MB 80,4,136
R a,24,10,20
CV 99,74
MB 84,4,140
E 76
W 3
MB 80,8,144
G 35,32,66,3,nt
MB 84,8,148
R a,28,11,20
E 77
MB 80,12,152
s_waitcnt vmcnt(12)
s_barrier
T 32,16,32
T 34,16,36
MB 84,12,156
CV 102,76
E 78
s_xor_b32 m0, s65, 0x18000
s_xor_b32 s66, s63, 0x5000
W 4
ZB 88,16,128
G 56,36,66,0,nt
T 36,17,32
ZB 92,16,132
T 38,17,36
E 79
MB 88,20,136
T 40,18,32
MB 92,20,140
T 42,18,36
CV 103,78
W 6
MB 88,24,144
G 57,36,66,1,nt
T 44,19,32
MB 92,24,148
T 46,19,36
E 80
MB 88,28,152
T 48,20,32
T 50,20,36
MB 92,28,156
E 81
W 6
MA 128,32,96
G 56,36,66,2,nt
T 52,21,32
MA 132,32,100
T 54,21,36
CV 104,80
E 82
MA 136,36,96
T 56,22,32
T 58,22,36
MA 140,36,100
E 83
W 6
MA 144,40,96
G 57,36,66,3,nt
T 60,23,32
MA 148,40,100
T 62,23,36
CV 105,82
E 84
MA 152,44,96
E 85
MA 156,44,100
W 4
MA 160,48,96
s_waitcnt vmcnt(12)
s_barrier
R a,0,8,48
CV 108,84
MA 164,48,100
E 86
s_xor_b32 m0, s65, 0x1c000
s_xor_b32 s66, s63, 0x2000
MA 168,52,96
G 32,32,66,0,nt
MA 172,52,100
R a,4,9,48
E 87
W 2
MA 176,56,96
R a,8,10,48
CV 109,86
MA 180,56,100
E 88
MA 184,60,96
G 33,32,66,1,nt
MA 188,60,100
R a,12,11,48
E 89
MD 112,52,96
R a,16,8,52
CV 106,88
MD 116,52,100
E 90
W 3
ZB 64,0,128
G 34,32,66,2,nt
ZB 68,0,132
R a,20,9,52
E 91
MB 64,4,136
R a,24,10,52
CV 107,90
MB 68,4,140
E 92
W 3
MB 64,8,144
G 35,32,66,3,nt
MB 68,8,148
R a,28,11,52
E 93
MB 64,12,152
s_waitcnt vmcnt(12)
s_barrier
T 32,24,0
T 34,24,4
MB 68,12,156
CV 110,92
E 94
s_xor_b32 m0, s65, 0x0
s_xor_b32 s66, s63, 0x15000
W 4
ZB 72,16,128
G 56,36,66,0,nt
T 36,25,0
ZB 76,16,132
T 38,25,4
E 95
MB 72,20,136
T 40,26,0
MB 76,20,140
T 42,26,4
CV 111,94
W 6
MB 72,24,144
G 57,36,66,1,nt
T 44,27,0
MB 76,24,148
T 46,27,4
E 64
MB 72,28,152
T 48,28,0
T 50,28,4
MB 76,28,156
E 65
W 6
MA 128,32,104
G 56,36,66,2,nt
T 52,29,0
MA 132,32,108
T 54,29,4
CV 96,64
E 66
MA 136,36,104
T 56,30,0
T 58,30,4
MA 140,36,108
E 67
W 6
MA 144,40,104
G 57,36,66,3,nt
T 60,31,0
MA 148,40,108
T 62,31,4
CV 97,66
E 68
MA 152,44,104
E 69
MA 156,44,108
W 4
MA 160,48,104
s_waitcnt vmcnt(12)
s_barrier
R a,0,12,16
CV 100,68
MA 164,48,108
E 70
s_xor_b32 m0, s65, 0x4000
s_xor_b32 s66, s63, 0x12000
MA 168,52,104
G 32,32,66,0,nt
MA 172,52,108
R a,4,13,16
E 71
W 2
MA 176,56,104
R a,8,14,16
CV 101,70
MA 180,56,108
E 72
MA 184,60,104
G 33,32,66,1,nt
MA 188,60,108
R a,12,15,16
E 73
MD 112,52,104
R a,16,12,20
CV 98,72
MD 116,52,108
E 74
W 3
ZB 80,0,128
G 34,32,66,2,nt
ZB 84,0,132
R a,20,13,20
E 75
MB 80,4,136
R a,24,14,20
CV 99,74
MB 84,4,140
E 76
W 3
MB 80,8,144
G 35,32,66,3,nt
MB 84,8,148
R a,28,15,20
E 77
MB 80,12,152
s_waitcnt vmcnt(12)
s_barrier
T 32,24,32
T 34,24,36
MB 84,12,156
CV 102,76
E 78
s_xor_b32 m0, s65, 0x8000
s_xor_b32 s66, s63, 0x2000
W 4
ZB 88,16,128
G 56,36,66,0,nt
T 36,25,32
ZB 92,16,132
T 38,25,36
E 79
MB 88,20,136
T 40,26,32
MB 92,20,140
T 42,26,36
CV 103,78
W 6
MB 88,24,144
G 57,36,66,1,nt
T 44,27,32
MB 92,24,148
T 46,27,36
E 80
MB 88,28,152
T 48,28,32
T 50,28,36
MB 92,28,156
E 81
W 6
MA 128,32,96
G 56,36,66,2,nt
T 52,29,32
MA 132,32,100
T 54,29,36
CV 104,80
E 82
MA 136,36,96
T 56,30,32
T 58,30,36
MA 140,36,100
E 83
W 6
MA 144,40,96
G 57,36,66,3,nt
T 60,31,32
MA 148,40,100
T 62,31,36
CV 105,82
E 84
MA 152,44,96
E 85
MA 156,44,100
W 4
MA 160,48,96
s_waitcnt vmcnt(12)
s_barrier
R a,0,12,48
CV 108,84
MA 164,48,100
E 86
s_xor_b32 m0, s65, 0xc000
s_xor_b32 s66, s63, 0x6000
MA 168,52,96
G 32,32,66,0,nt
MA 172,52,100
R a,4,13,48
E 87
W 2
MA 176,56,96
R a,8,14,48
CV 109,86
MA 180,56,100
E 88
MA 184,60,96
G 33,32,66,1,nt
MA 188,60,100
R a,12,15,48
E 89
MD 112,52,96
R a,16,12,52
CV 106,88
MD 116,52,100
E 90
W 3
ZB 64,0,128
G 34,32,66,2,nt
ZB 68,0,132
R a,20,13,52
E 91
MB 64,4,136
R a,24,14,52
CV 107,90
MB 68,4,140
E 92
W 3
MB 64,8,144
G 35,32,66,3,nt
MB 68,8,148
R a,28,15,52
E 93
MB 64,12,152
s_waitcnt vmcnt(12)
s_barrier
T 32,16,0
T 34,16,4
MB 68,12,156
CV 110,92
E 94
s_xor_b32 m0, s65, 0x10000
s_xor_b32 s66, s63, 0x12000
W 4
ZB 72,16,128
G 56,36,66,0,nt
T 36,17,0
ZB 76,16,132
T 38,17,4
E 95
MB 72,20,136
T 40,18,0
MB 76,20,140
T 42,18,4
CV 111,94
W 6
MB 72,24,144
G 57,36,66,1,nt
T 44,19,0
MB 76,24,148
T 46,19,4
E 64
MB 72,28,152
T 48,20,0
T 50,20,4
MB 76,28,156
E 65
W 6
MA 128,32,104
G 56,36,66,2,nt
T 52,21,0
MA 132,32,108
T 54,21,4
CV 96,64
E 66
MA 136,36,104
T 56,22,0
T 58,22,4
MA 140,36,108
E 67
W 6
MA 144,40,104
G 57,36,66,3,nt
T 60,23,0
MA 148,40,108
T 62,23,4
CV 97,66
E 68
MA 152,44,104
E 69
MA 156,44,108
W 4
MA 160,48,104
s_waitcnt vmcnt(12)
s_barrier
R a,0,8,16
CV 100,68
MA 164,48,108
E 70
s_xor_b32 m0, s65, 0x14000
s_xor_b32 s66, s63, 0x16000
MA 168,52,104
G 32,32,66,0,nt
MA 172,52,108
R a,4,9,16
E 71
W 2
MA 176,56,104
R a,8,10,16
CV 101,70
MA 180,56,108
E 72
MA 184,60,104
G 33,32,66,1,nt
MA 188,60,108
R a,12,11,16
E 73
MD 112,52,104
R a,16,8,20
CV 98,72
MD 116,52,108
E 74
W 3
ZB 80,0,128
G 34,32,66,2,nt
ZB 84,0,132
R a,20,9,20
E 75
MB 80,4,136
R a,24,10,20
CV 99,74
MB 84,4,140
E 76
W 3
MB 80,8,144
G 35,32,66,3,nt
MB 84,8,148
R a,28,11,20
E 77
MB 80,12,152
s_waitcnt vmcnt(12)
s_barrier
T 32,16,32
T 34,16,36
MB 84,12,156
CV 102,76
E 78
s_xor_b32 m0, s65, 0x18000
s_xor_b32 s66, s63, 0x6000
W 4
ZB 88,16,128
G 56,36,66,0,nt
T 36,17,32
ZB 92,16,132
T 38,17,36
E 79
MB 88,20,136
T 40,18,32
MB 92,20,140
T 42,18,36
CV 103,78
W 6
MB 88,24,144
G 57,36,66,1,nt
T 44,19,32
MB 92,24,148
T 46,19,36
E 80
MB 88,28,152
T 48,20,32
T 50,20,36
MB 92,28,156
E 81
W 6
MA 128,32,96
G 56,36,66,2,nt
T 52,21,32
MA 132,32,100
T 54,21,36
CV 104,80
E 82
MA 136,36,96
T 56,22,32
T 58,22,36
MA 140,36,100
E 83
W 6
MA 144,40,96
G 57,36,66,3,nt
T 60,23,32
MA 148,40,100
T 62,23,36
CV 105,82
E 84
MA 152,44,96
E 85
MA 156,44,100
W 4
MA 160,48,96
s_waitcnt vmcnt(12)
s_barrier
R a,0,8,48
CV 108,84
MA 164,48,100
E 86
s_xor_b32 m0, s65, 0x1c000
s_xor_b32 s66, s63, 0x3000
MA 168,52,96
G 32,32,66,0,nt
MA 172,52,100
R a,4,9,48
E 87
W 2
MA 176,56,96
R a,8,10,48
CV 109,86
MA 180,56,100
E 88
MA 184,60,96
G 33,32,66,1,nt
MA 188,60,100
R a,12,11,48
E 89
MD 112,52,96
R a,16,8,52
CV 106,88
MD 116,52,100
E 90
W 3
ZB 64,0,128
G 34,32,66,2,nt
ZB 68,0,132
R a,20,9,52
E 91
MB 64,4,136
R a,24,10,52
CV 107,90
MB 68,4,140
E 92
W 3
MB 64,8,144
G 35,32,66,3,nt
MB 68,8,148
R a,28,11,52
E 93
MB 64,12,152
s_waitcnt vmcnt(12)
s_barrier
T 32,24,0
T 34,24,4
MB 68,12,156
CV 110,92
E 94
s_xor_b32 m0, s65, 0x0
s_xor_b32 s66, s63, 0x16000
W 4
ZB 72,16,128
G 56,36,66,0,nt
T 36,25,0
ZB 76,16,132
T 38,25,4
E 95
MB 72,20,136
T 40,26,0
MB 76,20,140
T 42,26,4
CV 111,94
W 6
MB 72,24,144
G 57,36,66,1,nt
T 44,27,0
MB 76,24,148
T 46,27,4
E 64
MB 72,28,152
T 48,28,0
T 50,28,4
MB 76,28,156
E 65
W 6
MA 128,32,104
G 56,36,66,2,nt
T 52,29,0
MA 132,32,108
T 54,29,4
CV 96,64
E 66
MA 136,36,104
T 56,30,0
T 58,30,4
MA 140,36,108
E 67
W 6
MA 144,40,104
G 57,36,66,3,nt
T 60,31,0
MA 148,40,108
T 62,31,4
CV 97,66
E 68
MA 152,44,104
E 69
MA 156,44,108
W 4
MA 160,48,104
s_waitcnt vmcnt(12)
s_barrier
R a,0,12,16
CV 100,68
MA 164,48,108
E 70
s_xor_b32 m0, s65, 0x4000
s_xor_b32 s66, s63, 0x13000
MA 168,52,104
G 32,32,66,0,nt
MA 172,52,108
R a,4,13,16
E 71
W 2
MA 176,56,104
R a,8,14,16
CV 101,70
MA 180,56,108
E 72
MA 184,60,104
G 33,32,66,1,nt
MA 188,60,108
R a,12,15,16
E 73
MD 112,52,104
R a,16,12,20
CV 98,72
MD 116,52,108
E 74
W 3
ZB 80,0,128
G 34,32,66,2,nt
ZB 84,0,132
R a,20,13,20
E 75
MB 80,4,136
R a,24,14,20
CV 99,74
MB 84,4,140
E 76
W 3
MB 80,8,144
G 35,32,66,3,nt
MB 84,8,148
R a,28,15,20
E 77
MB 80,12,152
s_waitcnt vmcnt(12)
s_barrier
T 32,24,32
T 34,24,36
MB 84,12,156
CV 102,76
E 78
s_xor_b32 m0, s65, 0x8000
s_xor_b32 s66, s63, 0x3000
W 4
ZB 88,16,128
G 56,36,66,0,nt
T 36,25,32
ZB 92,16,132
T 38,25,36
E 79
MB 88,20,136
T 40,26,32
MB 92,20,140
T 42,26,36
CV 103,78
W 6
MB 88,24,144
G 57,36,66,1,nt
T 44,27,32
MB 92,24,148
T 46,27,36
E 80
MB 88,28,152
T 48,28,32
T 50,28,36
MB 92,28,156
E 81
W 6
MA 128,32,96
G 56,36,66,2,nt
T 52,29,32
MA 132,32,100
T 54,29,36
CV 104,80
E 82
MA 136,36,96
T 56,30,32
T 58,30,36
MA 140,36,100
E 83
W 6
MA 144,40,96
G 57,36,66,3,nt
T 60,31,32
MA 148,40,100
T 62,31,36
CV 105,82
E 84
MA 152,44,96
E 85
MA 156,44,100
W 4
MA 160,48,96
s_waitcnt vmcnt(12)
s_barrier
R a,0,12,48
CV 108,84
MA 164,48,100
E 86
s_xor_b32 m0, s65, 0xc000
s_xor_b32 s66, s63, 0x7000
MA 168,52,96
G 32,32,66,0,nt
MA 172,52,100
R a,4,13,48
E 87
W 2
MA 176,56,96
R a,8,14,48
CV 109,86
MA 180,56,100
E 88
MA 184,60,96
G 33,32,66,1,nt
MA 188,60,100
R a,12,15,48
E 89
MD 112,52,96
R a,16,12,52
CV 106,88
MD 116,52,100
E 90
W 3
ZB 64,0,128
G 34,32,66,2,nt
ZB 68,0,132
R a,20,13,52
E 91
MB 64,4,136
R a,24,14,52
CV 107,90
MB 68,4,140
E 92
W 3
MB 64,8,144
G 35,32,66,3,nt
MB 68,8,148
R a,28,15,52
E 93
MB 64,12,152
s_waitcnt vmcnt(12)
s_barrier
T 32,16,0
T 34,16,4
MB 68,12,156
CV 110,92
E 94
s_xor_b32 m0, s65, 0x10000
s_xor_b32 s66, s63, 0x13000
W 4
ZB 72,16,128
G 56,36,66,0,nt
T 36,17,0
ZB 76,16,132
T 38,17,4
E 95
MB 72,20,136
T 40,18,0
MB 76,20,140
T 42,18,4
CV 111,94
W 6
MB 72,24,144
G 57,36,66,1,nt
T 44,19,0
MB 76,24,148
T 46,19,4
E 64
MB 72,28,152
T 48,20,0
T 50,20,4
MB 76,28,156
E 65
W 6
MA 128,32,104
G 56,36,66,2,nt
T 52,21,0
MA 132,32,108
T 54,21,4
CV 96,64
E 66
MA 136,36,104
T 56,22,0
T 58,22,4
MA 140,36,108
E 67
W 6
MA 144,40,104
G 57,36,66,3,nt
T 60,23,0
MA 148,40,108
T 62,23,4
CV 97,66
E 68
MA 152,44,104
E 69
MA 156,44,108
W 4
MA 160,48,104
s_waitcnt vmcnt(12)
s_barrier
R a,0,8,16
CV 100,68
MA 164,48,108
E 70
s_xor_b32 m0, s65, 0x14000
s_xor_b32 s66, s63, 0x17000
MA 168,52,104
G 32,32,66,0,nt
MA 172,52,108
R a,4,9,16
E 71
W 2
MA 176,56,104
R a,8,10,16
CV 101,70
MA 180,56,108
E 72
MA 184,60,104
G 33,32,66,1,nt
MA 188,60,108
R a,12,11,16
E 73
MD 112,52,104
R a,16,8,20
CV 98,72
MD 116,52,108
E 74
W 3
ZB 80,0,128
G 34,32,66,2,nt
ZB 84,0,132
R a,20,9,20
E 75
MB 80,4,136
R a,24,10,20
CV 99,74
MB 84,4,140
E 76
W 3
MB 80,8,144
G 35,32,66,3,nt
MB 84,8,148
R a,28,11,20
E 77
MB 80,12,152
s_waitcnt vmcnt(12)
s_barrier
T 32,16,32
T 34,16,36
MB 84,12,156
CV 102,76
E 78
s_xor_b32 m0, s65, 0x18000
s_xor_b32 s66, s63, 0x7000
W 4
ZB 88,16,128
G 56,36,66,0,nt
T 36,17,32
ZB 92,16,132
T 38,17,36
E 79
MB 88,20,136
T 40,18,32
MB 92,20,140
T 42,18,36
CV 103,78
W 6
MB 88,24,144
G 57,36,66,1,nt
T 44,19,32
MB 92,24,148
T 46,19,36
E 80
MB 88,28,152
T 48,20,32
T 50,20,36
MB 92,28,156
E 81
W 6
MA 128,32,96
G 56,36,66,2,nt
T 52,21,32
MA 132,32,100
T 54,21,36
CV 104,80
E 82
MA 136,36,96
T 56,22,32
T 58,22,36
MA 140,36,100
E 83
W 6
MA 144,40,96
G 57,36,66,3,nt
T 60,23,32
MA 148,40,100
T 62,23,36
CV 105,82
E 84
MA 152,44,96
E 85
MA 156,44,100
W 4
MA 160,48,96
s_waitcnt vmcnt(12)
s_barrier
R a,0,8,48
CV 108,84
MA 164,48,100
E 86
s_xor_b32 m0, s65, 0x1c000
s_xor_b32 s66, s63, 0x17000
MA 168,52,96
G 56,36,66,0,nt
MA 172,52,100
R a,4,9,48
E 87
W 2
MA 176,56,96
R a,8,10,48
CV 109,86
MA 180,56,100
E 88
MA 184,60,96
G 57,36,66,1,nt
MA 188,60,100
R a,12,11,48
E 89
MD 112,52,96
R a,16,8,52
CV 106,88
MD 116,52,100
E 90
W 3
ZB 64,0,128
G 56,36,66,2,nt
ZB 68,0,132
R a,20,9,52
E 91
MB 64,4,136
R a,24,10,52
CV 107,90
MB 68,4,140
E 92
W 3
MB 64,8,144
G 57,36,66,3,nt
MB 68,8,148
R a,28,11,52
E 93
MB 64,12,152
s_waitcnt vmcnt(12)
s_barrier
T 32,24,0
T 34,24,4
MB 68,12,156
CV 110,92
E 94
s_xor_b32 m0, s65, 0x0
s_xor_b32 s66, s63, 0x40000
W 4
ZB 72,16,128
G 32,32,66,0,nt
T 36,25,0
ZB 76,16,132
T 38,25,4
E 95
MB 72,20,136
T 40,26,0
MB 76,20,140
T 42,26,4
CV 111,94
W 6
MB 72,24,144
G 33,32,66,1,nt
T 44,27,0
MB 76,24,148
T 46,27,4
E 64
MB 72,28,152
T 48,28,0
T 50,28,4
MB 76,28,156
E 65
W 6
MA 128,32,104
G 34,32,66,2,nt
T 52,29,0
MA 132,32,108
T 54,29,4
CV 96,64
E 66
MA 136,36,104
T 56,30,0
T 58,30,4
MA 140,36,108
E 67
W 6
MA 144,40,104
G 35,32,66,3,nt
T 60,31,0
MA 148,40,108
T 62,31,4
CV 97,66
E 68
MA 152,44,104
E 69
MA 156,44,108
W 4
MA 160,48,104
s_waitcnt vmcnt(12)
s_barrier
R a,0,12,16
CV 100,68
MA 164,48,108
E 70
s_xor_b32 m0, s65, 0x4000
s_xor_b32 s66, s63, 0x50000
MA 168,52,104
G 32,32,66,0,nt
MA 172,52,108
R a,4,13,16
E 71
W 2
MA 176,56,104
R a,8,14,16
CV 101,70
MA 180,56,108
E 72
MA 184,60,104
G 33,32,66,1,nt
MA 188,60,108
R a,12,15,16
E 73
MD 112,52,104
R a,16,12,20
CV 98,72
MD 116,52,108
E 74
W 3
ZB 80,0,128
G 34,32,66,2,nt
ZB 84,0,132
R a,20,13,20
E 75
MB 80,4,136
R a,24,14,20
CV 99,74
MB 84,4,140
E 76
W 3
MB 80,8,144
G 35,32,66,3,nt
MB 84,8,148
R a,28,15,20
E 77
MB 80,12,152
s_waitcnt vmcnt(12)
s_barrier
T 32,24,32
T 34,24,36
MB 84,12,156
CV 102,76
E 78
s_xor_b32 m0, s65, 0x8000
s_xor_b32 s66, s63, 0x40000
W 4
ZB 88,16,128
G 56,36,66,0,nt
T 36,25,32
ZB 92,16,132
T 38,25,36
E 79
MB 88,20,136
T 40,26,32
MB 92,20,140
T 42,26,36
CV 103,78
W 6
MB 88,24,144
G 57,36,66,1,nt
T 44,27,32
MB 92,24,148
T 46,27,36
E 80
MB 88,28,152
T 48,28,32
T 50,28,36
MB 92,28,156
E 81
W 6
MA 128,32,96
G 56,36,66,2,nt
T 52,29,32
MA 132,32,100
T 54,29,36
CV 104,80
E 82
MA 136,36,96
T 56,30,32
T 58,30,36
MA 140,36,100
E 83
W 6
MA 144,40,96
G 57,36,66,3,nt
T 60,31,32
MA 148,40,100
T 62,31,36
CV 105,82
E 84
MA 152,44,96
E 85
MA 156,44,100
W 4
MA 160,48,96
CV 108,84
MA 164,48,100
E 86
MA 168,52,96
E 87
MA 172,52,100
W 0
MA 176,56,96
CV 109,86
MA 180,56,100
E 88
MA 184,60,96
E 89
MA 188,60,100
MD 112,52,96
CV 106,88
MD 116,52,100
E 90
E 91
s_nop 0
CV 107,90
E 92
E 93
s_waitcnt vmcnt(12)
s_barrier
T 32,24,48
T 34,24,52
CV 110,92
E 94
s_xor_b32 m0, s65, 0xc000
s_xor_b32 s66, s63, 0x44000
T 36,25,48
T 38,25,52
G 32,32,66,0,nt
E 95
T 40,26,48
T 42,26,52
CV 111,94
T 44,27,48
T 46,27,52
G 33,32,66,1,nt
T 48,28,48
T 50,28,52
W 6
MA 128,32,104
G 34,32,66,2,nt
MA 132,32,108
T 52,29,48
T 54,29,52
MA 136,36,104
T 56,30,48
MA 140,36,108
T 58,30,52
W 6
MA 144,40,104
G 35,32,66,3,nt
MA 148,40,108
T 60,31,48
T 62,31,52
MA 152,44,104
MA 156,44,108
W 4
MA 160,48,104
s_waitcnt vmcnt(12)
s_barrier
MA 164,48,108
R a,0,8,0
s_xor_b32 m0, s65, 0x10000
s_xor_b32 s66, s63, 0x50000
MA 168,52,104
G 56,36,66,0,nt
MA 172,52,108
R a,4,9,0
W 2
MA 176,56,104
R a,8,10,0
MA 180,56,108
MA 184,60,104
G 57,36,66,1,nt
MA 188,60,108
R a,12,11,0
MD 112,52,104
R a,16,8,4
MD 116,52,108
s_nop 5
v_mov_b32 v60, v112
s_nop 0
v_mov_b32 v61, v116
v_cmp_nle_f32 vcc, s76, v60
v_cmp_nge_f32 s[82:83], s77, v60
v_cmp_nle_f32 s[84:85], s76, v61
v_cmp_nge_f32 s[90:91], s77, v61
s_nop 1
s_or_b64 vcc, vcc, s[82:83]
s_or_b64 vcc, vcc, s[84:85]
s_or_b64 vcc, vcc, s[90:91]
s_cbranch_scc1 L_slow_c2B0
L_back_c2B0:
v_rcp_f32 v0, v60
v_rcp_f32 v1, v61
s_nop 0
v_pk_mul_f32 v[128:129], v[128:129], v[0:1] op_sel_hi:[1,0]
v_pk_mul_f32 v[130:131], v[130:131], v[0:1] op_sel_hi:[1,0]
v_pk_mul_f32 v[132:133], v[132:133], v[0:1] op_sel:[0,1]
v_pk_mul_f32 v[134:135], v[134:135], v[0:1] op_sel:[0,1]
v_pk_mul_f32 v[136:137], v[136:137], v[0:1] op_sel_hi:[1,0]
v_pk_mul_f32 v[138:139], v[138:139], v[0:1] op_sel_hi:[1,0]
v_pk_mul_f32 v[140:141], v[140:141], v[0:1] op_sel:[0,1]
v_pk_mul_f32 v[142:143], v[142:143], v[0:1] op_sel:[0,1]
CV 128,128
CV 130,130
CV 132,132
CV 134,134
CV 136,136
CV 138,138
CV 140,140
CV 142,142
AW 128,128
AW 129,130
AW 132,132
AW 133,134
AW 130,136
AW 131,138
AW 134,140
AW 135,142
v_pk_mul_f32 v[144:145], v[144:145], v[0:1] op_sel_hi:[1,0]
v_pk_mul_f32 v[146:147], v[146:147], v[0:1] op_sel_hi:[1,0]
v_pk_mul_f32 v[148:149], v[148:149], v[0:1] op_sel:[0,1]
v_pk_mul_f32 v[150:151], v[150:151], v[0:1] op_sel:[0,1]
v_pk_mul_f32 v[152:153], v[152:153], v[0:1] op_sel_hi:[1,0]
v_pk_mul_f32 v[154:155], v[154:155], v[0:1] op_sel_hi:[1,0]
v_pk_mul_f32 v[156:157], v[156:157], v[0:1] op_sel:[0,1]
v_pk_mul_f32 v[158:159], v[158:159], v[0:1] op_sel:[0,1]
CV 144,144
CV 146,146
CV 148,148
CV 150,150
CV 152,152
CV 154,154
CV 156,156
CV 158,158
AW 136,144
AW 137,146
AW 140,148
AW 141,150
AW 138,152
AW 139,154
AW 142,156
AW 143,158
v_pk_mul_f32 v[160:161], v[160:161], v[0:1] op_sel_hi:[1,0]
v_pk_mul_f32 v[162:163], v[162:163], v[0:1] op_sel_hi:[1,0]
v_pk_mul_f32 v[164:165], v[164:165], v[0:1] op_sel:[0,1]
v_pk_mul_f32 v[166:167], v[166:167], v[0:1] op_sel:[0,1]
v_pk_mul_f32 v[168:169], v[168:169], v[0:1] op_sel_hi:[1,0]
v_pk_mul_f32 v[170:171], v[170:171], v[0:1] op_sel_hi:[1,0]
v_pk_mul_f32 v[172:173], v[172:173], v[0:1] op_sel:[0,1]
v_pk_mul_f32 v[174:175], v[174:175], v[0:1] op_sel:[0,1]
CV 160,160
CV 162,162
CV 164,164
CV 166,166
CV 168,168
CV 170,170
CV 172,172
CV 174,174
AW 144,160
AW 145,162
AW 148,164
AW 149,166
AW 146,168
AW 147,170
AW 150,172
AW 151,174
v_pk_mul_f32 v[176:177], v[176:177], v[0:1] op_sel_hi:[1,0]
v_pk_mul_f32 v[178:179], v[178:179], v[0:1] op_sel_hi:[1,0]
v_pk_mul_f32 v[180:181], v[180:181], v[0:1] op_sel:[0,1]
v_pk_mul_f32 v[182:183], v[182:183], v[0:1] op_sel:[0,1]
v_pk_mul_f32 v[184:185], v[184:185], v[0:1] op_sel_hi:[1,0]
v_pk_mul_f32 v[186:187], v[186:187], v[0:1] op_sel_hi:[1,0]
v_pk_mul_f32 v[188:189], v[188:189], v[0:1] op_sel:[0,1]
v_pk_mul_f32 v[190:191], v[190:191], v[0:1] op_sel:[0,1]
CV 176,176
CV 178,178
CV 180,180
CV 182,182
CV 184,184
CV 186,186
CV 188,188
CV 190,190
AW 152,176
AW 153,178
AW 156,180
AW 157,182
AW 154,184
AW 155,186
AW 158,188
AW 159,190
W 3
ZB 64,0,160
G 56,36,66,2,nt
ZB 68,0,164
R a,20,9,4
MB 64,4,168
R a,24,10,4
MB 68,4,172
W 3
MB 64,8,176
G 57,36,66,3,nt
MB 68,8,180
R a,28,11,4
MB 64,12,184
MB 68,12,188
W 2
ZB 72,16,160
ZB 76,16,164
MB 72,20,168
MB 76,20,172
W 0
MB 72,24,176
E 64
MB 76,24,180
MB 72,28,184
E 65
MB 76,28,188
CV 96,64
E 66
E 67
s_nop 0
CV 97,66
E 68
s_waitcnt vmcnt(12)
s_barrier
R a,0,8,16
E 69
s_xor_b32 m0, s65, 0x14000
s_xor_b32 s66, s63, 0x54000
R a,4,9,16
G 32,32,66,0,nt
CV 100,68
E 70
R a,8,10,16
E 71
R a,12,11,16
G 33,32,66,1,nt
CV 101,70
E 72
R a,16,8,20
E 73
W 3
ZB 80,0,160
G 34,32,66,2,nt
R a,20,9,20
ZB 84,0,164
CV 98,72
E 74
MB 80,4,168
R a,24,10,20
MB 84,4,172
E 75
W 3
MB 80,8,176
G 35,32,66,3,nt
R a,28,11,20
MB 84,8,180
CV 99,74
E 76
MB 80,12,184
s_waitcnt vmcnt(12)
s_barrier
T 32,16,32
T 34,16,36
MB 84,12,188
E 77
s_xor_b32 m0, s65, 0x18000
s_xor_b32 s66, s63, 0x44000
W 4
ZB 88,16,160
G 56,36,66,0,nt
T 36,17,32
ZB 92,16,164
T 38,17,36
CV 102,76
E 78
s_getpc_b64 s[88:89]
L_ct2_1619:
s_and_b32 s89, s89, 0xffff
s_mov_b32 s90, L_code_end-L_ct2_1619
s_mov_b32 s91, 0x20000
v_and_b32 v62, 0x70, v59
v_lshlrev_b32 v62, 3, v62
s_add_u32 s7, s1, 4096
buffer_load_dword v3, v62, s[88:91], s7 offen
MB 88,20,168
T 40,18,32
T 42,18,36
MB 92,20,172
E 79
W 6
MB 88,24,176
G 57,36,66,1,nt
T 44,19,32
MB 92,24,180
T 46,19,36
CV 103,78
E 80
MB 88,28,184
T 48,20,32
T 50,20,36
MB 92,28,188
E 81
W 6
ZC 192,32,96
G 56,36,66,2,nt
T 52,21,32
ZC 196,32,100
T 54,21,36
CV 104,80
E 82
ZC 200,36,96
T 56,22,32
T 58,22,36
ZC 204,36,100
E 83
W 6
ZC 208,40,96
G 57,36,66,3,nt
T 60,23,32
ZC 212,40,100
T 62,23,36
CV 105,82
E 84
ZC 216,44,96
E 85
ZC 220,44,100
W 4
ZC 64,48,96
s_waitcnt vmcnt(13)
s_barrier
R a,0,8,48
CV 108,84
ZC 68,48,100
E 86
s_xor_b32 m0, s65, 0x1c000
s_xor_b32 s66, s63, 0x41000
ZC 72,52,96
G 32,32,66,0,nt
ZC 76,52,100
R a,4,9,48
E 87
W 2
ZC 80,56,96
R a,8,10,48
CV 109,86
ZC 84,56,100
E 88
ZC 88,60,96
G 33,32,66,1,nt
ZC 92,60,100
R a,12,11,48
E 89
ZD 112,52,96
R a,16,8,52
CV 106,88
ZD 116,52,100
E 90
W 3
ZB 64,0,160
G 34,32,66,2,nt
ZB 68,0,164
R a,20,9,52
E 91
MB 64,4,168
R a,24,10,52
CV 107,90
MB 68,4,172
E 92
W 3
MB 64,8,176
G 35,32,66,3,nt
MB 68,8,180
R a,28,11,52
E 93
MB 64,12,184
s_waitcnt vmcnt(13)
s_barrier
T 32,24,0
T 34,24,4
MB 68,12,188
CV 110,92
E 94
s_xor_b32 m0, s65, 0x0
s_xor_b32 s66, s63, 0x54000
W 4
ZB 72,16,160
G 56,36,66,0,nt
T 36,25,0
ZB 76,16,164
T 38,25,4
E 95
MB 72,20,168
T 40,26,0
MB 76,20,172
T 42,26,4
CV 111,94
W 6
MB 72,24,176
G 57,36,66,1,nt
T 44,27,0
MB 76,24,180
T 46,27,4
E 64
MB 72,28,184
T 48,28,0
T 50,28,4
MB 76,28,188
E 65
W 6
MC 192,32,104
G 56,36,66,2,nt
T 52,29,0
MC 196,32,108
T 54,29,4
CV 96,64
E 66
MC 200,36,104
T 56,30,0
T 58,30,4
MC 204,36,108
E 67
W 6
MC 208,40,104
G 57,36,66,3,nt
T 60,31,0
MC 212,40,108
T 62,31,4
CV 97,66
E 68
MC 216,44,104
E 69
MC 220,44,108
W 4
MC 64,48,104
s_waitcnt vmcnt(13)
s_barrier
R a,0,12,16
CV 100,68
MC 68,48,108
E 70
s_xor_b32 m0, s65, 0x4000
s_xor_b32 s66, s63, 0x51000
MC 72,52,104
G 32,32,66,0,nt
MC 76,52,108
R a,4,13,16
E 71
W 2
MC 80,56,104
R a,8,14,16
CV 101,70
MC 84,56,108
E 72
MC 88,60,104
G 33,32,66,1,nt
MC 92,60,108
R a,12,15,16
E 73
MD 112,52,104
R a,16,12,20
CV 98,72
MD 116,52,108
E 74
W 3
ZB 80,0,160
G 34,32,66,2,nt
ZB 84,0,164
R a,20,13,20
E 75
MB 80,4,168
R a,24,14,20
CV 99,74
MB 84,4,172
E 76
W 3
MB 80,8,176
G 35,32,66,3,nt
MB 84,8,180
R a,28,15,20
E 77
MB 80,12,184
s_waitcnt vmcnt(12)
s_barrier
T 32,24,32
T 34,24,36
MB 84,12,188
CV 102,76
E 78
s_xor_b32 m0, s65, 0x8000
s_xor_b32 s66, s63, 0x41000
W 4
ZB 88,16,160
G 56,36,66,0,nt
T 36,25,32
ZB 92,16,164
T 38,25,36
E 79
MB 88,20,168
T 40,26,32
MB 92,20,172
T 42,26,36
CV 103,78
W 6
MB 88,24,176
G 57,36,66,1,nt
T 44,27,32
MB 92,24,180
T 46,27,36
E 80
MB 88,28,184
T 48,28,32
T 50,28,36
MB 92,28,188
E 81
W 6
MC 192,32,96
G 56,36,66,2,nt
T 52,29,32
MC 196,32,100
T 54,29,36
CV 104,80
E 82
MC 200,36,96
T 56,30,32
T 58,30,36
MC 204,36,100
E 83
W 6
MC 208,40,96
G 57,36,66,3,nt
T 60,31,32
MC 212,40,100
T 62,31,36
CV 105,82
E 84
MC 216,44,96
E 85
MC 220,44,100
W 4
MC 64,48,96
s_waitcnt vmcnt(12)
s_barrier
R a,0,12,48
CV 108,84
MC 68,48,100
E 86
s_xor_b32 m0, s65, 0xc000
s_xor_b32 s66, s63, 0x45000
MC 72,52,96
G 32,32,66,0,nt
MC 76,52,100
R a,4,13,48
E 87
W 2
MC 80,56,96
R a,8,14,48
CV 109,86
MC 84,56,100
E 88
MC 88,60,96
G 33,32,66,1,nt
MC 92,60,100
R a,12,15,48
E 89
MD 112,52,96
R a,16,12,52
CV 106,88
MD 116,52,100
E 90
W 3
ZB 64,0,160
G 34,32,66,2,nt
ZB 68,0,164
R a,20,13,52
E 91
MB 64,4,168
R a,24,14,52
CV 107,90
MB 68,4,172
E 92
W 3
MB 64,8,176
G 35,32,66,3,nt
MB 68,8,180
R a,28,15,52
E 93
MB 64,12,184
s_waitcnt vmcnt(12)
s_barrier
T 32,16,0
T 34,16,4
MB 68,12,188
CV 110,92
E 94
s_xor_b32 m0, s65, 0x10000
s_xor_b32 s66, s63, 0x51000
W 4
ZB 72,16,160
G 56,36,66,0,nt
T 36,17,0
ZB 76,16,164
T 38,17,4
E 95
MB 72,20,168
T 40,18,0
MB 76,20,172
T 42,18,4
CV 111,94
W 6
MB 72,24,176
G 57,36,66,1,nt
T 44,19,0
MB 76,24,180
T 46,19,4
E 64
MB 72,28,184
T 48,20,0
T 50,20,4
MB 76,28,188
E 65
W 6
MC 192,32,104
G 56,36,66,2,nt
T 52,21,0
MC 196,32,108
T 54,21,4
CV 96,64
E 66
MC 200,36,104
T 56,22,0
T 58,22,4
MC 204,36,108
E 67
W 6
MC 208,40,104
G 57,36,66,3,nt
T 60,23,0
MC 212,40,108
T 62,23,4
CV 97,66
E 68
MC 216,44,104
E 69
MC 220,44,108
W 4
MC 64,48,104
s_waitcnt vmcnt(12)
s_barrier
R a,0,8,16
CV 100,68
MC 68,48,108
E 70
s_xor_b32 m0, s65, 0x14000
s_xor_b32 s66, s63, 0x55000
MC 72,52,104
G 32,32,66,0,nt
MC 76,52,108
R a,4,9,16
E 71
W 2
MC 80,56,104
R a,8,10,16
CV 101,70
MC 84,56,108
E 72
MC 88,60,104
G 33,32,66,1,nt
MC 92,60,108
R a,12,11,16
E 73
MD 112,52,104
R a,16,8,20
CV 98,72
MD 116,52,108
E 74
W 3
ZB 80,0,160
G 34,32,66,2,nt
ZB 84,0,164
R a,20,9,20
E 75
MB 80,4,168
R a,24,10,20
CV 99,74
MB 84,4,172
E 76
W 3
MB 80,8,176
G 35,32,66,3,nt
MB 84,8,180
R a,28,11,20
E 77
MB 80,12,184
s_waitcnt vmcnt(12)
s_barrier
T 32,16,32
T 34,16,36
MB 84,12,188
CV 102,76
E 78
s_xor_b32 m0, s65, 0x18000
s_xor_b32 s66, s63, 0x45000
W 4
ZB 88,16,160
G 56,36,66,0,nt
T 36,17,32
ZB 92,16,164
T 38,17,36
E 79
MB 88,20,168
T 40,18,32
MB 92,20,172
T 42,18,36
CV 103,78
W 6
MB 88,24,176
G 57,36,66,1,nt
T 44,19,32
MB 92,24,180
T 46,19,36
E 80
MB 88,28,184
T 48,20,32
T 50,20,36
MB 92,28,188
E 81
W 6
MC 192,32,96
G 56,36,66,2,nt
T 52,21,32
MC 196,32,100
T 54,21,36
CV 104,80
E 82
MC 200,36,96
T 56,22,32
T 58,22,36
MC 204,36,100
E 83
W 6
MC 208,40,96
G 57,36,66,3,nt
T 60,23,32
MC 212,40,100
T 62,23,36
CV 105,82
E 84
MC 216,44,96
E 85
MC 220,44,100
W 4
MC 64,48,96
s_waitcnt vmcnt(12)
s_barrier
R a,0,8,48
CV 108,84
MC 68,48,100
E 86
s_xor_b32 m0, s65, 0x1c000
s_xor_b32 s66, s63, 0x42000
MC 72,52,96
G 32,32,66,0,nt
MC 76,52,100
R a,4,9,48
E 87
W 2
MC 80,56,96
R a,8,10,48
CV 109,86
MC 84,56,100
E 88
MC 88,60,96
G 33,32,66,1,nt
MC 92,60,100
R a,12,11,48
E 89
MD 112,52,96
R a,16,8,52
CV 106,88
MD 116,52,100
E 90
W 3
ZB 64,0,160
G 34,32,66,2,nt
ZB 68,0,164
R a,20,9,52
E 91
MB 64,4,168
R a,24,10,52
CV 107,90
MB 68,4,172
E 92
W 3
MB 64,8,176
G 35,32,66,3,nt
MB 68,8,180
R a,28,11,52
E 93
MB 64,12,184
s_waitcnt vmcnt(12)
s_barrier
T 32,24,0
T 34,24,4
MB 68,12,188
CV 110,92
E 94
s_xor_b32 m0, s65, 0x0
s_xor_b32 s66, s63, 0x55000
W 4
ZB 72,16,160
G 56,36,66,0,nt
T 36,25,0
ZB 76,16,164
T 38,25,4
E 95
MB 72,20,168
T 40,26,0
MB 76,20,172
T 42,26,4
CV 111,94
W 6
MB 72,24,176
G 57,36,66,1,nt
T 44,27,0
MB 76,24,180
T 46,27,4
E 64
MB 72,28,184
T 48,28,0
T 50,28,4
MB 76,28,188
E 65
W 6
MC 192,32,104
G 56,36,66,2,nt
T 52,29,0
MC 196,32,108
T 54,29,4
CV 96,64
E 66
MC 200,36,104
T 56,30,0
T 58,30,4
MC 204,36,108
E 67
W 6
MC 208,40,104
G 57,36,66,3,nt
T 60,31,0
MC 212,40,108
T 62,31,4
CV 97,66
E 68
MC 216,44,104
E 69
MC 220,44,108
W 4
MC 64,48,104
s_waitcnt vmcnt(12)
s_barrier
R a,0,12,16
CV 100,68
MC 68,48,108
E 70
s_xor_b32 m0, s65, 0x4000
s_xor_b32 s66, s63, 0x52000
MC 72,52,104
G 32,32,66,0,nt
MC 76,52,108
R a,4,13,16
E 71
W 2
MC 80,56,104
R a,8,14,16
CV 101,70
MC 84,56,108
E 72
MC 88,60,104
G 33,32,66,1,nt
MC 92,60,108
R a,12,15,16
E 73
MD 112,52,104
R a,16,12,20
CV 98,72
MD 116,52,108
E 74
W 3
ZB 80,0,160
G 34,32,66,2,nt
ZB 84,0,164
R a,20,13,20
E 75
MB 80,4,168
R a,24,14,20
CV 99,74
MB 84,4,172
E 76
W 3
MB 80,8,176
G 35,32,66,3,nt
MB 84,8,180
R a,28,15,20
E 77
MB 80,12,184
s_waitcnt vmcnt(12)
s_barrier
T 32,24,32
T 34,24,36
MB 84,12,188
CV 102,76
E 78
s_xor_b32 m0, s65, 0x8000
s_xor_b32 s66, s63, 0x42000
W 4
ZB 88,16,160
G 56,36,66,0,nt
T 36,25,32
ZB 92,16,164
T 38,25,36
E 79
MB 88,20,168
T 40,26,32
MB 92,20,172
T 42,26,36
CV 103,78
W 6
MB 88,24,176
G 57,36,66,1,nt
T 44,27,32
MB 92,24,180
T 46,27,36
E 80
MB 88,28,184
T 48,28,32
T 50,28,36
MB 92,28,188
E 81
W 6
MC 192,32,96
G 56,36,66,2,nt
T 52,29,32
MC 196,32,100
T 54,29,36
CV 104,80
E 82
MC 200,36,96
T 56,30,32
T 58,30,36
MC 204,36,100
E 83
W 6
MC 208,40,96
G 57,36,66,3,nt
T 60,31,32
MC 212,40,100
T 62,31,36
CV 105,82
E 84
MC 216,44,96
E 85
MC 220,44,100
W 4
MC 64,48,96
s_waitcnt vmcnt(12)
s_barrier
R a,0,12,48
CV 108,84
MC 68,48,100
E 86
s_xor_b32 m0, s65, 0xc000
s_xor_b32 s66, s63, 0x52000
MC 72,52,96
G 56,36,66,0,nt
MC 76,52,100
R a,4,13,48
E 87
W 2
MC 80,56,96
R a,8,14,48
CV 109,86
MC 84,56,100
E 88
MC 88,60,96
G 57,36,66,1,nt
MC 92,60,100
R a,12,15,48
E 89
MD 112,52,96
R a,16,12,52
CV 106,88
MD 116,52,100
E 90
W 3
ZB 64,0,160
G 56,36,66,2,nt
ZB 68,0,164
R a,20,13,52
E 91
MB 64,4,168
R a,24,14,52
CV 107,90
MB 68,4,172
E 92
W 3
MB 64,8,176
G 57,36,66,3,nt
MB 68,8,180
R a,28,15,52
E 93
MB 64,12,184
s_waitcnt vmcnt(12)
s_barrier
T 32,16,0
T 34,16,4
MB 68,12,188
CV 110,92
E 94
s_xor_b32 m0, s65, 0x10000
s_xor_b32 s66, s62, 0x0
W 4
ZB 72,16,160
G 44,44,66,0
T 36,17,0
ZB 76,16,164
T 38,17,4
E 95
MB 72,20,168
T 40,18,0
MB 76,20,172
T 42,18,4
CV 111,94
W 6
MB 72,24,176
G 45,44,66,1
T 44,19,0
MB 76,24,180
T 46,19,4
E 64
MB 72,28,184
T 48,20,0
T 50,20,4
MB 76,28,188
E 65
W 6
MC 192,32,104
G 46,44,66,2
T 52,21,0
MC 196,32,108
T 54,21,4
CV 96,64
E 66
MC 200,36,104
T 56,22,0
T 58,22,4
MC 204,36,108
E 67
W 6
MC 208,40,104
G 47,44,66,3
T 60,23,0
MC 212,40,108
T 62,23,4
CV 97,66
E 68
MC 216,44,104
E 69
MC 220,44,108
W 4
MC 64,48,104
s_waitcnt vmcnt(12)
s_barrier
R a,0,8,16
CV 100,68
MC 68,48,108
E 70
s_xor_b32 m0, s65, 0x14000
s_xor_b32 s66, s62, 0x8000
MC 72,52,104
G 44,44,66,0
MC 76,52,108
R a,4,9,16
E 71
W 2
MC 80,56,104
R a,8,10,16
CV 101,70
MC 84,56,108
E 72
MC 88,60,104
G 45,44,66,1
MC 92,60,108
R a,12,11,16
E 73
MD 112,52,104
R a,16,8,20
CV 98,72
MD 116,52,108
E 74
W 3
ZB 80,0,160
G 46,44,66,2
ZB 84,0,164
R a,20,9,20
E 75
MB 80,4,168
R a,24,10,20
CV 99,74
MB 84,4,172
E 76
W 3
MB 80,8,176
G 47,44,66,3
MB 84,8,180
R a,28,11,20
E 77
MB 80,12,184
s_waitcnt vmcnt(12)
s_barrier
T 32,16,32
T 34,16,36
MB 84,12,188
CV 102,76
E 78
s_xor_b32 m0, s65, 0x18000
s_xor_b32 s66, s62, 0x10000
W 4
ZB 88,16,160
G 44,44,66,0
T 36,17,32
ZB 92,16,164
T 38,17,36
E 79
MB 88,20,168
T 40,18,32
MB 92,20,172
T 42,18,36
CV 103,78
W 6
MB 88,24,176
G 45,44,66,1
T 44,19,32
MB 92,24,180
T 46,19,36
E 80
MB 88,28,184
T 48,20,32
T 50,20,36
MB 92,28,188
E 81
W 6
MC 192,32,96
G 46,44,66,2
T 52,21,32
MC 196,32,100
T 54,21,36
CV 104,80
E 82
MC 200,36,96
T 56,22,32
T 58,22,36
MC 204,36,100
E 83
W 6
MC 208,40,96
G 47,44,66,3
T 60,23,32
MC 212,40,100
T 62,23,36
CV 105,82
E 84
MC 216,44,96
E 85
MC 220,44,100
W 4
MC 64,48,96
CV 108,84
MC 68,48,100
E 86
MC 72,52,96
E 87
MC 76,52,100
W 0
MC 80,56,96
CV 109,86
MC 84,56,100
E 88
MC 88,60,96
E 89
MC 92,60,100
MD 112,52,96
CV 106,88
MD 116,52,100
E 90
E 91
s_nop 0
CV 107,90
E 92
E 93
s_waitcnt vmcnt(12)
s_barrier
T 32,16,48
T 34,16,52
CV 110,92
E 94
s_xor_b32 m0, s65, 0x1c000
s_xor_b32 s66, s62, 0x18000
T 36,17,48
T 38,17,52
G 44,44,66,0
E 95
T 40,18,48
T 42,18,52
CV 111,94
T 44,19,48
T 46,19,52
G 45,44,66,1
T 48,20,48
T 50,20,52
W 6
MC 192,32,104
G 46,44,66,2
MC 196,32,108
T 52,21,48
T 54,21,52
MC 200,36,104
T 56,22,48
MC 204,36,108
T 58,22,52
W 6
MC 208,40,104
G 47,44,66,3
MC 212,40,108
T 60,23,48
T 62,23,52
MC 216,44,104
MC 220,44,108
W 4
MC 64,48,104
s_waitcnt vmcnt(8)
s_barrier
T 0,24,0
MC 68,48,108
T 2,24,4
s_xor_b32 m0, s65, 0x0
s_xor_b32 s66, s62, 0x20000
MC 72,52,104
G 44,44,66,0
MC 76,52,108
T 4,25,0
T 6,25,4
W 4
MC 80,56,104
G 45,44,66,1
MC 84,56,108
T 8,26,0
T 10,26,4
MC 88,60,104
G 46,44,66,2
MC 92,60,108
T 12,27,0
T 14,27,4
MD 112,52,104
T 16,28,0
MD 116,52,108
T 18,28,4
s_nop 4
v_mov_b32 v6, v112
s_nop 0
v_mov_b32 v7, v116
W 6
ZB 128,0,128
G 47,44,66,3
T 20,29,0
ZB 132,0,132
T 22,29,4
ds_write_b128 v58, a[128:131] offset:0
s_xor_b32 m0, s65, 0x4000
s_xor_b32 s66, s62, 0x28000
ZB 136,4,128
G 44,44,66,0
ZB 140,4,132
T 24,30,0
T 26,30,4
ds_write_b128 v58, a[132:135] offset:1024
W 8
ZB 144,8,128
G 45,44,66,1
ZB 148,8,132
T 28,31,0
T 30,31,4
ds_write_b128 v58, a[136:139] offset:2048
ZB 152,12,128
T 32,24,16
ZB 156,12,132
T 34,24,20
ds_write_b128 v58, a[140:143] offset:3072
W 10
ZB 160,16,128
G 46,44,66,2
ZB 164,16,132
T 36,25,16
T 38,25,20
ds_write_b128 v58, a[144:147] offset:4096
ZB 168,20,128
G 47,44,66,3
T 40,26,16
ZB 172,20,132
T 42,26,20
W 14
ds_write_b128 v58, a[148:151] offset:5120
s_xor_b32 m0, s65, 0x8000
s_xor_b32 s66, s62, 0x30000
W 10
ZB 176,24,128
G 44,44,66,0
ZB 180,24,132
T 44,27,16
T 46,27,20
ds_write_b128 v58, a[152:155] offset:6144
ZB 184,28,128
T 48,28,16
ZB 188,28,132
T 50,28,20
W 14
ds_write_b128 v58, a[156:159] offset:7168
W 10
MB 128,32,136
G 45,44,66,1
MB 132,32,140
T 52,29,16
T 54,29,20
MB 136,36,136
G 46,44,66,2
MB 140,36,140
T 56,30,16
T 58,30,20
W 8
MB 144,40,136
G 47,44,66,3
MB 148,40,140
T 60,31,16
T 62,31,20
MB 152,44,136
s_waitcnt vmcnt(12) lgkmcnt(6)
s_barrier
T 0,24,32
MB 156,44,140
T 2,24,36
R a,224,2,0
s_xor_b32 m0, s65, 0xc000
s_xor_b32 s66, s62, 0x38000
MB 160,48,136
G 44,44,66,0
MB 164,48,140
T 4,25,32
T 6,25,36
R a,228,2,1
W 10
MB 168,52,136
T 8,26,32
MB 172,52,140
T 10,26,36
R a,232,2,2
W 9
MB 176,56,136
G 45,44,66,1
MB 180,56,140
T 12,27,32
T 14,27,36
R a,236,2,3
MB 184,60,136
T 16,28,32
MB 188,60,140
T 18,28,36
R a,240,2,4
W 10
MB 128,0,144
G 46,44,66,2
MB 132,0,148
T 20,29,32
T 22,29,36
R a,244,2,5
MB 136,4,144
T 24,30,32
MB 140,4,148
T 26,30,36
W 14
R a,248,2,6
W 10
MB 144,8,144
G 47,44,66,3
MB 148,8,148
T 28,31,32
T 30,31,36
R a,252,2,7
MB 152,12,144
T 32,24,48
T 34,24,52
MB 156,12,148
s_xor_b32 m0, s65, 0x10000
s_xor_b32 s66, s62, 0x100
W 9
MB 160,16,144
G 44,44,66,0
MB 164,16,148
T 36,25,48
T 38,25,52
s_getpc_b64 s[88:89]
L_ct2_1805:
s_and_b32 s89, s89, 0xffff
s_mov_b32 s90, L_code_end-L_ct2_1805
s_mov_b32 s91, 0x20000
v_and_b32 v62, 0x70, v59
v_lshlrev_b32 v62, 3, v62
s_add_u32 s7, s1, 4096
buffer_load_dword v3, v62, s[88:91], s7 offen
MB 168,20,144
T 40,26,48
MB 172,20,148
T 42,26,52
W 7
MB 176,24,144
G 45,44,66,1
MB 180,24,148
T 44,27,48
T 46,27,52
MB 184,28,144
T 48,28,48
MB 188,28,148
T 50,28,52
W 6
MB 128,32,152
G 46,44,66,2
MB 132,32,156
T 52,29,48
T 54,29,52
MB 136,36,152
T 56,30,48
MB 140,36,156
T 58,30,52
W 6
MB 144,40,152
G 47,44,66,3
MB 148,40,156
T 60,31,48
T 62,31,52
MB 152,44,152
s_waitcnt vmcnt(13)
s_barrier
T 0,16,0
MB 156,44,156
T 2,16,4
s_xor_b32 m0, s65, 0x14000
s_xor_b32 s66, s62, 0x8100
W 6
MB 160,48,152
G 44,44,66,0
MB 164,48,156
T 4,17,0
T 6,17,4
MB 168,52,152
T 8,18,0
MB 172,52,156
T 10,18,4
W 6
MB 176,56,152
G 45,44,66,1
MB 180,56,156
T 12,19,0
T 14,19,4
MB 184,60,152
T 16,20,0
MB 188,60,156
T 18,20,4
W 6
MB 128,0,224
G 46,44,66,2
MB 132,0,228
T 20,21,0
T 22,21,4
MB 136,4,224
T 24,22,0
MB 140,4,228
T 26,22,4
W 6
MB 144,8,224
G 47,44,66,3
MB 148,8,228
T 28,23,0
T 30,23,4
MB 152,12,224
T 32,16,16
T 34,16,20
MB 156,12,228
s_xor_b32 m0, s65, 0x18000
s_xor_b32 s66, s62, 0x10100
W 6
MB 160,16,224
G 44,44,66,0
MB 164,16,228
T 36,17,16
T 38,17,20
MB 168,20,224
T 40,18,16
MB 172,20,228
T 42,18,20
W 6
MB 176,24,224
G 45,44,66,1
MB 180,24,228
T 44,19,16
T 46,19,20
MB 184,28,224
T 48,20,16
MB 188,28,228
T 50,20,20
W 6
MB 128,32,232
G 46,44,66,2
MB 132,32,236
T 52,21,16
T 54,21,20
MB 136,36,232
T 56,22,16
MB 140,36,236
T 58,22,20
W 6
MB 144,40,232
G 47,44,66,3
MB 148,40,236
T 60,23,16
T 62,23,20
MB 152,44,232
s_waitcnt vmcnt(13)
s_barrier
T 0,16,32
MB 156,44,236
T 2,16,36
s_xor_b32 m0, s65, 0x1c000
s_xor_b32 s66, s62, 0x18100
W 6
MB 160,48,232
G 44,44,66,0
MB 164,48,236
T 4,17,32
T 6,17,36
MB 168,52,232
T 8,18,32
MB 172,52,236
T 10,18,36
W 6
MB 176,56,232
G 45,44,66,1
MB 180,56,236
T 12,19,32
T 14,19,36
MB 184,60,232
T 16,20,32
MB 188,60,236
T 18,20,36
W 6
MB 128,0,240
G 46,44,66,2
MB 132,0,244
T 20,21,32
T 22,21,36
MB 136,4,240
T 24,22,32
MB 140,4,244
T 26,22,36
W 6
MB 144,8,240
G 47,44,66,3
MB 148,8,244
T 28,23,32
T 30,23,36
MB 152,12,240
T 32,16,48
T 34,16,52
MB 156,12,244
s_xor_b32 m0, s65, 0x0
s_xor_b32 s66, s62, 0x20100
W 6
MB 160,16,240
G 44,44,66,0
MB 164,16,244
T 36,17,48
T 38,17,52
MB 168,20,240
T 40,18,48
MB 172,20,244
T 42,18,52
W 6
MB 176,24,240
G 45,44,66,1
MB 180,24,244
T 44,19,48
T 46,19,52
MB 184,28,240
T 48,20,48
MB 188,28,244
T 50,20,52
W 6
MB 128,32,248
G 46,44,66,2
MB 132,32,252
T 52,21,48
T 54,21,52
MB 136,36,248
T 56,22,48
MB 140,36,252
T 58,22,52
W 6
MB 144,40,248
G 47,44,66,3
MB 148,40,252
T 60,23,48
T 62,23,52
MB 152,44,248
s_waitcnt vmcnt(12)
s_barrier
T 0,24,0
MB 156,44,252
T 2,24,4
s_xor_b32 m0, s65, 0x4000
s_xor_b32 s66, s62, 0x28100
W 6
MB 160,48,248
G 44,44,66,0
MB 164,48,252
T 4,25,0
T 6,25,4
MB 168,52,248
T 8,26,0
MB 172,52,252
T 10,26,4
W 6
MB 176,56,248
G 45,44,66,1
MB 180,56,252
T 12,27,0
T 14,27,4
MB 184,60,248
T 16,28,0
MB 188,60,252
T 18,28,4
W 6
ZB 192,0,128
G 46,44,66,2
ZB 196,0,132
T 20,29,0
T 22,29,4
ZB 200,4,128
T 24,30,0
ZB 204,4,132
T 26,30,4
W 6
ZB 208,8,128
G 47,44,66,3
ZB 212,8,132
T 28,31,0
T 30,31,4
ZB 216,12,128
T 32,24,16
T 34,24,20
ZB 220,12,132
s_xor_b32 m0, s65, 0x8000
s_xor_b32 s66, s62, 0x30100
W 6
ZB 224,16,128
G 44,44,66,0
ZB 228,16,132
T 36,25,16
T 38,25,20
ZB 232,20,128
T 40,26,16
ZB 236,20,132
T 42,26,20
W 6
ZB 240,24,128
G 45,44,66,1
ZB 244,24,132
T 44,27,16
T 46,27,20
ZB 248,28,128
T 48,28,16
ZB 252,28,132
T 50,28,20
W 6
MB 192,32,136
G 46,44,66,2
MB 196,32,140
T 52,29,16
T 54,29,20
MB 200,36,136
T 56,30,16
MB 204,36,140
T 58,30,20
W 6
MB 208,40,136
G 47,44,66,3
MB 212,40,140
T 60,31,16
T 62,31,20
MB 216,44,136
s_waitcnt vmcnt(12)
s_barrier
T 0,24,32
MB 220,44,140
T 2,24,36
s_xor_b32 m0, s65, 0xc000
s_xor_b32 s66, s62, 0x38100
W 6
MB 224,48,136
G 44,44,66,0
MB 228,48,140
T 4,25,32
T 6,25,36
MB 232,52,136
T 8,26,32
MB 236,52,140
T 10,26,36
W 6
MB 240,56,136
G 45,44,66,1
MB 244,56,140
T 12,27,32
T 14,27,36
MB 248,60,136
T 16,28,32
MB 252,60,140
T 18,28,36
W 6
MB 192,0,144
G 46,44,66,2
MB 196,0,148
T 20,29,32
T 22,29,36
MB 200,4,144
T 24,30,32
MB 204,4,148
T 26,30,36
W 6
MB 208,8,144
G 47,44,66,3
MB 212,8,148
T 28,31,32
T 30,31,36
MB 216,12,144
T 32,24,48
T 34,24,52
MB 220,12,148
s_xor_b32 m0, s65, 0x10000
s_xor_b32 s66, s63, 0x46000
W 6
MB 224,16,144
G 32,32,66,0,nt
MB 228,16,148
T 36,25,48
T 38,25,52
MB 232,20,144
T 40,26,48
MB 236,20,148
T 42,26,52
W 6
MB 240,24,144
G 33,32,66,1,nt
MB 244,24,148
T 44,27,48
T 46,27,52
MB 248,28,144
T 48,28,48
MB 252,28,148
T 50,28,52
W 6
MB 192,32,152
G 34,32,66,2,nt
MB 196,32,156
T 52,29,48
T 54,29,52
MB 200,36,152
T 56,30,48
MB 204,36,156
T 58,30,52
W 6
MB 208,40,152
G 35,32,66,3,nt
MB 212,40,156
T 60,31,48
T 62,31,52
MB 216,44,152
s_waitcnt vmcnt(12)
s_barrier
T 0,16,0
MB 220,44,156
T 2,16,4
s_xor_b32 m0, s65, 0x14000
s_xor_b32 s66, s63, 0x56000
W 6
MB 224,48,152
G 32,32,66,0,nt
MB 228,48,156
T 4,17,0
T 6,17,4
MB 232,52,152
T 8,18,0
MB 236,52,156
T 10,18,4
W 6
MB 240,56,152
G 33,32,66,1,nt
MB 244,56,156
T 12,19,0
T 14,19,4
MB 248,60,152
T 16,20,0
MB 252,60,156
T 18,20,4
W 6
MB 192,0,224
G 34,32,66,2,nt
MB 196,0,228
T 20,21,0
T 22,21,4
MB 200,4,224
T 24,22,0
MB 204,4,228
T 26,22,4
W 6
MB 208,8,224
G 35,32,66,3,nt
MB 212,8,228
T 28,23,0
T 30,23,4
MB 216,12,224
T 32,16,16
T 34,16,20
MB 220,12,228
s_xor_b32 m0, s65, 0x18000
s_xor_b32 s66, s63, 0x46000
W 6
MB 224,16,224
G 56,36,66,0,nt
MB 228,16,228
T 36,17,16
T 38,17,20
MB 232,20,224
T 40,18,16
MB 236,20,228
T 42,18,20
W 6
MB 240,24,224
G 57,36,66,1,nt
MB 244,24,228
T 44,19,16
T 46,19,20
MB 248,28,224
T 48,20,16
MB 252,28,228
T 50,20,20
W 6
MB 192,32,232
G 56,36,66,2,nt
MB 196,32,236
T 52,21,16
T 54,21,20
MB 200,36,232
T 56,22,16
MB 204,36,236
T 58,22,20
W 6
MB 208,40,232
G 57,36,66,3,nt
MB 212,40,236
T 60,23,16
T 62,23,20
MB 216,44,232
s_waitcnt vmcnt(12)
s_barrier
T 0,16,32
MB 220,44,236
T 2,16,36
s_xor_b32 m0, s65, 0x1c000
s_xor_b32 s66, s63, 0x43000
W 6
MB 224,48,232
G 32,32,66,0,nt
MB 228,48,236
T 4,17,32
T 6,17,36
MB 232,52,232
T 8,18,32
MB 236,52,236
T 10,18,36
W 6
MB 240,56,232
G 33,32,66,1,nt
MB 244,56,236
T 12,19,32
T 14,19,36
MB 248,60,232
T 16,20,32
MB 252,60,236
T 18,20,36
W 6
MB 192,0,240
G 34,32,66,2,nt
MB 196,0,244
T 20,21,32
T 22,21,36
MB 200,4,240
T 24,22,32
MB 204,4,244
T 26,22,36
W 6
MB 208,8,240
G 35,32,66,3,nt
MB 212,8,244
T 28,23,32
T 30,23,36
MB 216,12,240
T 32,16,48
MB 220,12,244
T 34,16,52
W 6
MB 224,16,240
T 36,17,48
MB 228,16,244
T 38,17,52
MB 232,20,240
T 40,18,48
MB 236,20,244
T 42,18,52
W 6
MB 240,24,240
T 44,19,48
MB 244,24,244
T 46,19,52
MB 248,28,240
T 48,20,48
MB 252,28,244
T 50,20,52
W 6
MB 192,32,248
T 52,21,48
MB 196,32,252
T 54,21,52
MB 200,36,248
T 56,22,48
MB 204,36,252
T 58,22,52
W 6
MB 208,40,248
T 60,23,48
MB 212,40,252
T 62,23,52
MB 216,44,248
s_waitcnt vmcnt(12)
s_barrier
MB 220,44,252
R a,0,12,0
s_xor_b32 m0, s65, 0x0
s_xor_b32 s66, s63, 0x56000
W 5
MB 224,48,248
G 56,36,66,0,nt
MB 228,48,252
R a,4,13,0
MB 232,52,248
R a,8,14,0
MB 236,52,252
W 3
MB 240,56,248
G 57,36,66,1,nt
MB 244,56,252
R a,12,15,0
MB 248,60,248
R a,16,12,4
MB 252,60,252
W 3
ZB 64,0,160
G 56,36,66,2,nt
ZB 68,0,164
R a,20,13,4
MB 64,4,168
R a,24,14,4
MB 68,4,172
W 3
MB 64,8,176
G 57,36,66,3,nt
MB 68,8,180
R a,28,15,4
MB 64,12,184
MB 68,12,188
W 2
ZB 72,16,160
ZB 76,16,164
MB 72,20,168
MB 76,20,172
W 0
MB 72,24,176
E 64
MB 76,24,180
MB 72,28,184
E 65
MB 76,28,188
CV 96,64
E 66
E 67
s_nop 0
CV 97,66
E 68
s_waitcnt vmcnt(12)
s_barrier
R a,0,12,16
E 69
s_xor_b32 m0, s65, 0x4000
s_xor_b32 s66, s63, 0x53000
R a,4,13,16
G 32,32,66,0,nt
CV 100,68
E 70
R a,8,14,16
E 71
R a,12,15,16
G 33,32,66,1,nt
CV 101,70
E 72
R a,16,12,20
E 73
W 3
ZB 80,0,160
G 34,32,66,2,nt
R a,20,13,20
ZB 84,0,164
CV 98,72
E 74
MB 80,4,168
R a,24,14,20
MB 84,4,172
E 75
W 3
MB 80,8,176
G 35,32,66,3,nt
R a,28,15,20
MB 84,8,180
CV 99,74
E 76
MB 80,12,184
s_waitcnt vmcnt(12)
s_barrier
T 32,24,32
T 34,24,36
MB 84,12,188
E 77
s_xor_b32 m0, s65, 0x8000
s_xor_b32 s66, s63, 0x43000
W 4
ZB 88,16,160
G 56,36,66,0,nt
T 36,25,32
ZB 92,16,164
T 38,25,36
CV 102,76
E 78
s_getpc_b64 s[88:89]
L_ct2_1933:
s_and_b32 s89, s89, 0xffff
s_mov_b32 s90, L_code_end-L_ct2_1933
s_mov_b32 s91, 0x20000
v_and_b32 v62, 0x70, v59
v_lshlrev_b32 v62, 3, v62
s_add_u32 s7, s1, 4096
buffer_load_dword v3, v62, s[88:91], s7 offen
MB 88,20,168
T 40,26,32
T 42,26,36
MB 92,20,172
E 79
W 6
MB 88,24,176
G 57,36,66,1,nt
T 44,27,32
MB 92,24,180
T 46,27,36
CV 103,78
E 80
MB 88,28,184
T 48,28,32
T 50,28,36
MB 92,28,188
E 81
W 6
MC 192,32,96
G 56,36,66,2,nt
T 52,29,32
MC 196,32,100
T 54,29,36
CV 104,80
E 82
MC 200,36,96
T 56,30,32
T 58,30,36
MC 204,36,100
E 83
W 6
MC 208,40,96
G 57,36,66,3,nt
T 60,31,32
MC 212,40,100
T 62,31,36
CV 105,82
E 84
MC 216,44,96
E 85
MC 220,44,100
W 4
MC 64,48,96
s_waitcnt vmcnt(13)
s_barrier
R a,0,12,48
CV 108,84
MC 68,48,100
E 86
s_xor_b32 m0, s65, 0xc000
s_xor_b32 s66, s63, 0x47000
MC 72,52,96
G 32,32,66,0,nt
MC 76,52,100
R a,4,13,48
E 87
W 2
MC 80,56,96
R a,8,14,48
CV 109,86
MC 84,56,100
E 88
MC 88,60,96
G 33,32,66,1,nt
MC 92,60,100
R a,12,15,48
E 89
ZD 112,52,96
R a,16,12,52
CV 106,88
ZD 116,52,100
E 90
W 3
ZB 64,0,160
G 34,32,66,2,nt
ZB 68,0,164
R a,20,13,52
E 91
MB 64,4,168
R a,24,14,52
CV 107,90
MB 68,4,172
E 92
W 3
MB 64,8,176
G 35,32,66,3,nt
MB 68,8,180
R a,28,15,52
E 93
MB 64,12,184
s_waitcnt vmcnt(13)
s_barrier
T 32,16,0
T 34,16,4
MB 68,12,188
CV 110,92
E 94
s_xor_b32 m0, s65, 0x10000
s_xor_b32 s66, s63, 0x53000
W 4
ZB 72,16,160
G 56,36,66,0,nt
T 36,17,0
ZB 76,16,164
T 38,17,4
E 95
MB 72,20,168
T 40,18,0
MB 76,20,172
T 42,18,4
CV 111,94
W 6
MB 72,24,176
G 57,36,66,1,nt
T 44,19,0
MB 76,24,180
T 46,19,4
E 64
MB 72,28,184
T 48,20,0
T 50,20,4
MB 76,28,188
E 65
W 6
MC 192,32,104
G 56,36,66,2,nt
T 52,21,0
MC 196,32,108
T 54,21,4
CV 96,64
E 66
MC 200,36,104
T 56,22,0
T 58,22,4
MC 204,36,108
E 67
W 6
MC 208,40,104
G 57,36,66,3,nt
T 60,23,0
MC 212,40,108
T 62,23,4
CV 97,66
E 68
MC 216,44,104
E 69
MC 220,44,108
W 4
MC 64,48,104
s_waitcnt vmcnt(13)
s_barrier
R a,0,8,16
CV 100,68
MC 68,48,108
E 70
s_xor_b32 m0, s65, 0x14000
s_xor_b32 s66, s63, 0x57000
MC 72,52,104
G 32,32,66,0,nt
MC 76,52,108
R a,4,9,16
E 71
W 2
MC 80,56,104
R a,8,10,16
CV 101,70
MC 84,56,108
E 72
MC 88,60,104
G 33,32,66,1,nt
MC 92,60,108
R a,12,11,16
E 73
MD 112,52,104
R a,16,8,20
CV 98,72
MD 116,52,108
E 74
W 3
ZB 80,0,160
G 34,32,66,2,nt
ZB 84,0,164
R a,20,9,20
E 75
MB 80,4,168
R a,24,10,20
CV 99,74
MB 84,4,172
E 76
W 3
MB 80,8,176
G 35,32,66,3,nt
MB 84,8,180
R a,28,11,20
E 77
MB 80,12,184
s_waitcnt vmcnt(12)
s_barrier
T 32,16,32
T 34,16,36
MB 84,12,188
CV 102,76
E 78
s_xor_b32 m0, s65, 0x18000
s_xor_b32 s66, s63, 0x47000
W 4
ZB 88,16,160
G 56,36,66,0,nt
T 36,17,32
ZB 92,16,164
T 38,17,36
E 79
MB 88,20,168
T 40,18,32
MB 92,20,172
T 42,18,36
CV 103,78
W 6
MB 88,24,176
G 57,36,66,1,nt
T 44,19,32
MB 92,24,180
T 46,19,36
E 80
MB 88,28,184
T 48,20,32
T 50,20,36
MB 92,28,188
E 81
W 6
MC 192,32,96
G 56,36,66,2,nt
T 52,21,32
MC 196,32,100
T 54,21,36
CV 104,80
E 82
MC 200,36,96
T 56,22,32
T 58,22,36
MC 204,36,100
E 83
W 6
MC 208,40,96
G 57,36,66,3,nt
T 60,23,32
MC 212,40,100
T 62,23,36
CV 105,82
E 84
MC 216,44,96
E 85
MC 220,44,100
W 4
MC 64,48,96
s_waitcnt vmcnt(12)
s_barrier
R a,0,8,48
CV 108,84
MC 68,48,100
E 86
s_xor_b32 m0, s65, 0x1c000
s_xor_b32 s66, s63, 0x57000
MC 72,52,96
G 56,36,66,0,nt
MC 76,52,100
R a,4,9,48
E 87
W 2
MC 80,56,96
R a,8,10,48
CV 109,86
MC 84,56,100
E 88
MC 88,60,96
G 57,36,66,1,nt
MC 92,60,100
R a,12,11,48
E 89
MD 112,52,96
R a,16,8,52
CV 106,88
MD 116,52,100
E 90
W 3
ZB 64,0,160
G 56,36,66,2,nt
ZB 68,0,164
R a,20,9,52
E 91
MB 64,4,168
R a,24,10,52
CV 107,90
MB 68,4,172
E 92
W 3
MB 64,8,176
G 57,36,66,3,nt
MB 68,8,180
R a,28,11,52
E 93
MB 64,12,184
s_waitcnt vmcnt(12)
s_barrier
T 32,24,0
T 34,24,4
MB 68,12,188
CV 110,92
E 94
s_xor_b32 m0, s65, 0x0
s_xor_b32 s66, s62, 0x40000
W 4
ZB 72,16,160
G 44,44,66,0
T 36,25,0
ZB 76,16,164
T 38,25,4
E 95
MB 72,20,168
T 40,26,0
MB 76,20,172
T 42,26,4
CV 111,94
W 6
MB 72,24,176
G 45,44,66,1
T 44,27,0
MB 76,24,180
T 46,27,4
E 64
MB 72,28,184
T 48,28,0
T 50,28,4
MB 76,28,188
E 65
W 6
MC 192,32,104
G 46,44,66,2
T 52,29,0
MC 196,32,108
T 54,29,4
CV 96,64
E 66
MC 200,36,104
T 56,30,0
T 58,30,4
MC 204,36,108
E 67
W 6
MC 208,40,104
G 47,44,66,3
T 60,31,0
MC 212,40,108
T 62,31,4
CV 97,66
E 68
MC 216,44,104
E 69
MC 220,44,108
v_mov_b32 v62, 0
buffer_load_dword v4, v62, s[96:99], s87 offen sc1
W 4
MC 64,48,104
s_waitcnt vmcnt(13)
s_barrier
R a,0,12,16
CV 100,68
MC 68,48,108
E 70
s_xor_b32 m0, s65, 0x4000
s_xor_b32 s66, s62, 0x48000
MC 72,52,104
G 44,44,66,0
MC 76,52,108
R a,4,13,16
E 71
W 2
MC 80,56,104
R a,8,14,16
CV 101,70
MC 84,56,108
E 72
MC 88,60,104
G 45,44,66,1
MC 92,60,108
R a,12,15,16
E 73
MD 112,52,104
R a,16,12,20
CV 98,72
MD 116,52,108
E 74
W 3
ZB 80,0,160
G 46,44,66,2
ZB 84,0,164
R a,20,13,20
E 75
MB 80,4,168
R a,24,14,20
CV 99,74
MB 84,4,172
E 76
W 3
MB 80,8,176
G 47,44,66,3
MB 84,8,180
R a,28,15,20
E 77
MB 80,12,184
s_waitcnt vmcnt(13)
s_barrier
T 32,24,32
T 34,24,36
MB 84,12,188
CV 102,76
E 78
s_xor_b32 m0, s65, 0x8000
s_xor_b32 s66, s62, 0x50000
W 4
ZB 88,16,160
G 44,44,66,0
T 36,25,32
ZB 92,16,164
T 38,25,36
E 79
MB 88,20,168
T 40,26,32
MB 92,20,172
T 42,26,36
CV 103,78
W 6
MB 88,24,176
G 45,44,66,1
T 44,27,32
MB 92,24,180
T 46,27,36
E 80
MB 88,28,184
T 48,28,32
T 50,28,36
MB 92,28,188
E 81
W 6
MC 192,32,96
G 46,44,66,2
T 52,29,32
MC 196,32,100
T 54,29,36
CV 104,80
E 82
MC 200,36,96
T 56,30,32
T 58,30,36
MC 204,36,100
E 83
W 6
MC 208,40,96
G 47,44,66,3
T 60,31,32
MC 212,40,100
T 62,31,36
CV 105,82
E 84
MC 216,44,96
E 85
MC 220,44,100
W 4
MC 64,48,96
CV 108,84
MC 68,48,100
E 86
MC 72,52,96
E 87
MC 76,52,100
W 0
MC 80,56,96
CV 109,86
MC 84,56,100
E 88
MC 88,60,96
E 89
MC 92,60,100
MD 112,52,96
CV 106,88
MD 116,52,100
E 90
E 91
s_nop 0
CV 107,90
E 92
E 93
s_waitcnt vmcnt(13)
s_barrier
T 32,24,48
T 34,24,52
CV 110,92
E 94
s_xor_b32 m0, s65, 0xc000
s_xor_b32 s66, s62, 0x58000
T 36,25,48
T 38,25,52
G 44,44,66,0
E 95
T 40,26,48
T 42,26,52
CV 111,94
T 44,27,48
T 46,27,52
G 45,44,66,1
T 48,28,48
T 50,28,52
W 6
MC 192,32,104
G 46,44,66,2
MC 196,32,108
T 52,29,48
T 54,29,52
MC 200,36,104
T 56,30,48
MC 204,36,108
T 58,30,52
W 6
MC 208,40,104
G 47,44,66,3
MC 212,40,108
T 60,31,48
T 62,31,52
MC 216,44,104
MC 220,44,108
W 4
MC 64,48,104
s_waitcnt vmcnt(8)
s_barrier
T 0,16,0
MC 68,48,108
T 2,16,4
s_xor_b32 m0, s65, 0x10000
s_xor_b32 s66, s62, 0x60000
MC 72,52,104
G 44,44,66,0
MC 76,52,108
T 4,17,0
T 6,17,4
W 4
MC 80,56,104
G 45,44,66,1
MC 84,56,108
T 8,18,0
T 10,18,4
MC 88,60,104
G 46,44,66,2
MC 92,60,108
T 12,19,0
T 14,19,4
MD 112,52,104
T 16,20,0
MD 116,52,108
T 18,20,4
s_nop 4
v_add_f32 v60, v112, v6
s_nop 0
v_add_f32 v61, v116, v7
v_cmp_nle_f32 vcc, s76, v60
v_cmp_nge_f32 s[82:83], s77, v60
v_cmp_nle_f32 s[84:85], s76, v61
v_cmp_nge_f32 s[90:91], s77, v61
s_nop 1
s_or_b64 vcc, vcc, s[82:83]
s_or_b64 vcc, vcc, s[84:85]
s_or_b64 vcc, vcc, s[90:91]
s_cbranch_scc1 L_slow_c2B1
L_back_c2B1:
v_rcp_f32 v0, v60
v_rcp_f32 v1, v61
AR 112,192
AR 113,193
AR 114,194
AR 115,195
AR 116,196
AR 117,197
AR 118,198
AR 119,199
AR 120,200
AR 121,201
AR 122,202
AR 123,203
AR 124,204
AR 125,205
AR 126,206
AR 127,207
v_pk_mul_f32 v[112:113], v[112:113], v[0:1] op_sel_hi:[1,0]
v_pk_mul_f32 v[114:115], v[114:115], v[0:1] op_sel_hi:[1,0]
v_pk_mul_f32 v[116:117], v[116:117], v[0:1] op_sel:[0,1]
v_pk_mul_f32 v[118:119], v[118:119], v[0:1] op_sel:[0,1]
v_pk_mul_f32 v[120:121], v[120:121], v[0:1] op_sel_hi:[1,0]
v_pk_mul_f32 v[122:123], v[122:123], v[0:1] op_sel_hi:[1,0]
v_pk_mul_f32 v[124:125], v[124:125], v[0:1] op_sel:[0,1]
v_pk_mul_f32 v[126:127], v[126:127], v[0:1] op_sel:[0,1]
CV 112,112
CV 114,114
CV 116,116
CV 118,118
CV 120,120
CV 122,122
CV 124,124
CV 126,126
AW 160,112
AW 161,114
AW 164,116
AW 165,118
AW 162,120
AW 163,122
AW 166,124
AW 167,126
AR 112,208
AR 113,209
AR 114,210
AR 115,211
AR 116,212
AR 117,213
AR 118,214
AR 119,215
AR 120,216
AR 121,217
AR 122,218
AR 123,219
AR 124,220
AR 125,221
AR 126,222
AR 127,223
v_pk_mul_f32 v[112:113], v[112:113], v[0:1] op_sel_hi:[1,0]
v_pk_mul_f32 v[114:115], v[114:115], v[0:1] op_sel_hi:[1,0]
v_pk_mul_f32 v[116:117], v[116:117], v[0:1] op_sel:[0,1]
v_pk_mul_f32 v[118:119], v[118:119], v[0:1] op_sel:[0,1]
v_pk_mul_f32 v[120:121], v[120:121], v[0:1] op_sel_hi:[1,0]
v_pk_mul_f32 v[122:123], v[122:123], v[0:1] op_sel_hi:[1,0]
v_pk_mul_f32 v[124:125], v[124:125], v[0:1] op_sel:[0,1]
v_pk_mul_f32 v[126:127], v[126:127], v[0:1] op_sel:[0,1]
CV 112,112
CV 114,114
CV 116,116
CV 118,118
CV 120,120
CV 122,122
CV 124,124
CV 126,126
AW 168,112
AW 169,114
AW 172,116
AW 173,118
AW 170,120
AW 171,122
AW 174,124
AW 175,126
AR 112,64
AR 113,65
AR 114,66
AR 115,67
AR 116,68
AR 117,69
AR 118,70
AR 119,71
AR 120,72
AR 121,73
AR 122,74
AR 123,75
AR 124,76
AR 125,77
AR 126,78
AR 127,79
v_pk_mul_f32 v[112:113], v[112:113], v[0:1] op_sel_hi:[1,0]
v_pk_mul_f32 v[114:115], v[114:115], v[0:1] op_sel_hi:[1,0]
v_pk_mul_f32 v[116:117], v[116:117], v[0:1] op_sel:[0,1]
v_pk_mul_f32 v[118:119], v[118:119], v[0:1] op_sel:[0,1]
v_pk_mul_f32 v[120:121], v[120:121], v[0:1] op_sel_hi:[1,0]
v_pk_mul_f32 v[122:123], v[122:123], v[0:1] op_sel_hi:[1,0]
v_pk_mul_f32 v[124:125], v[124:125], v[0:1] op_sel:[0,1]
v_pk_mul_f32 v[126:127], v[126:127], v[0:1] op_sel:[0,1]
CV 112,112
CV 114,114
CV 116,116
CV 118,118
CV 120,120
CV 122,122
CV 124,124
CV 126,126
AW 176,112
AW 177,114
AW 180,116
AW 181,118
AW 178,120
AW 179,122
AW 182,124
AW 183,126
AR 112,80
AR 113,81
AR 114,82
AR 115,83
AR 116,84
AR 117,85
AR 118,86
AR 119,87
AR 120,88
AR 121,89
AR 122,90
AR 123,91
AR 124,92
AR 125,93
AR 126,94
AR 127,95
v_pk_mul_f32 v[112:113], v[112:113], v[0:1] op_sel_hi:[1,0]
v_pk_mul_f32 v[114:115], v[114:115], v[0:1] op_sel_hi:[1,0]
v_pk_mul_f32 v[116:117], v[116:117], v[0:1] op_sel:[0,1]
v_pk_mul_f32 v[118:119], v[118:119], v[0:1] op_sel:[0,1]
v_pk_mul_f32 v[120:121], v[120:121], v[0:1] op_sel_hi:[1,0]
v_pk_mul_f32 v[122:123], v[122:123], v[0:1] op_sel_hi:[1,0]
v_pk_mul_f32 v[124:125], v[124:125], v[0:1] op_sel:[0,1]
v_pk_mul_f32 v[126:127], v[126:127], v[0:1] op_sel:[0,1]
CV 112,112
CV 114,114
CV 116,116
CV 118,118
CV 120,120
CV 122,122
CV 124,124
CV 126,126
AW 184,112
AW 185,114
AW 188,116
AW 189,118
AW 186,120
AW 187,122
AW 190,124
AW 191,126
W 6
MB 128,0,160
G 47,44,66,3
T 20,21,0
MB 132,0,164
T 22,21,4
ds_write_b128 v58, a[160:163] offset:0
s_xor_b32 m0, s65, 0x14000
s_xor_b32 s66, s62, 0x68000
s_and_b32 s7, s2, 7
v_bfe_u32 v7, v59, 4, 3
v_max_u32 v7, 1, v7
v_xor_b32 v7, s7, v7
v_lshlrev_b32 v7, 2, v7
MB 136,4,160
G 44,44,66,0
MB 140,4,164
T 24,22,0
T 26,22,4
ds_write_b128 v58, a[164:167] offset:1024
W 8
MB 144,8,160
G 45,44,66,1
MB 148,8,164
T 28,23,0
T 30,23,4
ds_write_b128 v58, a[168:171] offset:2048
v_and_b32 v6, 0xf0, v59
v_lshlrev_b32 v6, 7, v6
v_lshrrev_b32 v62, 8, v59
v_lshl_add_u32 v6, v62, 4, v6
MB 152,12,160
T 32,16,16
MB 156,12,164
T 34,16,20
ds_write_b128 v58, a[172:175] offset:3072
W 10
MB 160,16,160
G 46,44,66,2
MB 164,16,164
T 36,17,16
T 38,17,20
ds_write_b128 v58, a[176:179] offset:4096
MB 168,20,160
G 47,44,66,3
T 40,18,16
MB 172,20,164
T 42,18,20
W 14
ds_write_b128 v58, a[180:183] offset:5120
s_xor_b32 m0, s65, 0x18000
s_xor_b32 s66, s62, 0x70000
W 10
MB 176,24,160
G 44,44,66,0
MB 180,24,164
T 44,19,16
T 46,19,20
ds_write_b128 v58, a[184:187] offset:6144
MB 184,28,160
T 48,20,16
MB 188,28,164
T 50,20,20
W 14
ds_write_b128 v58, a[188:191] offset:7168
W 10
MB 128,32,168
G 45,44,66,1
MB 132,32,172
T 52,21,16
T 54,21,20
L_ci_c2:
v_cmp_gt_u32 vcc, 8, v4
s_nop 3
s_or_b64 vcc, vcc, vcc
s_cbranch_scc1 L_wi_c2
L_gi_c2:
MB 136,36,168
G 46,44,66,2
MB 140,36,172
T 56,22,16
T 58,22,20
W 8
MB 144,40,168
G 47,44,66,3
MB 148,40,172
T 60,23,16
T 62,23,20
MB 152,44,168
s_waitcnt vmcnt(12) lgkmcnt(6)
s_barrier
T 0,16,32
MB 156,44,172
T 2,16,36
R a,96,2,0
s_xor_b32 m0, s65, 0x1c000
s_xor_b32 s66, s62, 0x78000
MB 160,48,168
G 44,44,66,0
MB 164,48,172
T 4,17,32
T 6,17,36
R a,100,2,1
W 10
MB 168,52,168
T 8,18,32
MB 172,52,172
T 10,18,36
R a,104,2,2
W 9
MB 176,56,168
G 45,44,66,1
MB 180,56,172
T 12,19,32
T 14,19,36
R a,108,2,3
MB 184,60,168
T 16,20,32
MB 188,60,172
T 18,20,36
R a,112,2,4
W 10
MB 128,0,176
G 46,44,66,2
MB 132,0,180
T 20,21,32
T 22,21,36
R a,116,2,5
MB 136,4,176
T 24,22,32
MB 140,4,180
T 26,22,36
W 14
R a,120,2,6
W 10
MB 144,8,176
G 47,44,66,3
MB 148,8,180
T 28,23,32
T 30,23,36
R a,124,2,7
MB 152,12,176
T 32,16,48
T 34,16,52
MB 156,12,180
s_xor_b32 m0, s65, 0x0
s_xor_b32 s66, s62, 0x40100
W 9
MB 160,16,176
G 44,44,66,0
MB 164,16,180
T 36,17,48
T 38,17,52
MB 168,20,176
T 40,18,48
MB 172,20,180
T 42,18,52
W 7
MB 176,24,176
G 45,44,66,1
MB 180,24,180
T 44,19,48
T 46,19,52
MB 184,28,176
T 48,20,48
MB 188,28,180
T 50,20,52
W 6
MB 128,32,184
G 46,44,66,2
MB 132,32,188
T 52,21,48
T 54,21,52
buffer_load_dword v3, v7, s[52:55], s72 offen offset:0 sc1
buffer_load_dword v4, v7, s[52:55], s72 offen offset:128 sc1
MB 136,36,184
T 56,22,48
MB 140,36,188
T 58,22,52
W 6
MB 144,40,184
G 47,44,66,3
MB 148,40,188
T 60,23,48
T 62,23,52
MB 152,44,184
s_waitcnt vmcnt(14)
s_barrier
T 0,24,0
MB 156,44,188
T 2,24,4
s_xor_b32 m0, s65, 0x4000
s_xor_b32 s66, s62, 0x48100
W 6
MB 160,48,184
G 44,44,66,0
MB 164,48,188
T 4,25,0
T 6,25,4
MB 168,52,184
T 8,26,0
MB 172,52,188
T 10,26,4
W 6
MB 176,56,184
G 45,44,66,1
MB 180,56,188
T 12,27,0
T 14,27,4
MB 184,60,184
T 16,28,0
MB 188,60,188
T 18,28,4
W 6
MB 128,0,96
G 46,44,66,2
MB 132,0,100
T 20,29,0
T 22,29,4
MB 136,4,96
T 24,30,0
MB 140,4,100
T 26,30,4
W 6
MB 144,8,96
G 47,44,66,3
MB 148,8,100
T 28,31,0
T 30,31,4
MB 152,12,96
T 32,24,16
T 34,24,20
MB 156,12,100
s_xor_b32 m0, s65, 0x8000
s_xor_b32 s66, s62, 0x50100
W 6
MB 160,16,96
G 44,44,66,0
MB 164,16,100
T 36,25,16
T 38,25,20
MB 168,20,96
T 40,26,16
MB 172,20,100
T 42,26,20
W 6
MB 176,24,96
G 45,44,66,1
MB 180,24,100
T 44,27,16
T 46,27,20
MB 184,28,96
T 48,28,16
MB 188,28,100
T 50,28,20
W 6
MB 128,32,104
G 46,44,66,2
MB 132,32,108
T 52,29,16
T 54,29,20
MB 136,36,104
T 56,30,16
MB 140,36,108
T 58,30,20
W 6
MB 144,40,104
G 47,44,66,3
MB 148,40,108
T 60,31,16
T 62,31,20
MB 152,44,104
s_waitcnt vmcnt(14)
s_barrier
T 0,24,32
MB 156,44,108
T 2,24,36
s_xor_b32 m0, s65, 0xc000
s_xor_b32 s66, s62, 0x58100
W 6
MB 160,48,104
G 44,44,66,0
MB 164,48,108
T 4,25,32
T 6,25,36
MB 168,52,104
T 8,26,32
MB 172,52,108
T 10,26,36
W 6
MB 176,56,104
G 45,44,66,1
MB 180,56,108
T 12,27,32
T 14,27,36
MB 184,60,104
T 16,28,32
MB 188,60,108
T 18,28,36
W 6
MB 128,0,112
G 46,44,66,2
MB 132,0,116
T 20,29,32
T 22,29,36
MB 136,4,112
T 24,30,32
MB 140,4,116
T 26,30,36
W 6
MB 144,8,112
G 47,44,66,3
MB 148,8,116
T 28,31,32
T 30,31,36
MB 152,12,112
T 32,24,48
T 34,24,52
MB 156,12,116
s_xor_b32 m0, s65, 0x10000
s_xor_b32 s66, s62, 0x60100
W 6
MB 160,16,112
G 44,44,66,0
MB 164,16,116
T 36,25,48
T 38,25,52
MB 168,20,112
T 40,26,48
MB 172,20,116
T 42,26,52
W 6
MB 176,24,112
G 45,44,66,1
MB 180,24,116
T 44,27,48
T 46,27,52
MB 184,28,112
T 48,28,48
MB 188,28,116
T 50,28,52
W 6
MB 128,32,120
G 46,44,66,2
MB 132,32,124
T 52,29,48
T 54,29,52
MB 136,36,120
T 56,30,48
MB 140,36,124
T 58,30,52
W 6
MB 144,40,120
G 47,44,66,3
MB 148,40,124
T 60,31,48
T 62,31,52
MB 152,44,120
s_waitcnt vmcnt(12)
s_barrier
T 0,16,0
MB 156,44,124
T 2,16,4
s_xor_b32 m0, s65, 0x14000
s_xor_b32 s66, s62, 0x68100
W 6
MB 160,48,120
G 44,44,66,0
MB 164,48,124
T 4,17,0
T 6,17,4
MB 168,52,120
T 8,18,0
MB 172,52,124
T 10,18,4
W 6
MB 176,56,120
G 45,44,66,1
MB 180,56,124
T 12,19,0
T 14,19,4
MB 184,60,120
T 16,20,0
MB 188,60,124
T 18,20,4
W 6
MB 192,0,160
G 46,44,66,2
MB 196,0,164
T 20,21,0
T 22,21,4
MB 200,4,160
T 24,22,0
MB 204,4,164
T 26,22,4
W 6
MB 208,8,160
G 47,44,66,3
MB 212,8,164
T 28,23,0
T 30,23,4
MB 216,12,160
T 32,16,16
T 34,16,20
CV 68,132
MB 220,12,164
CV 69,134
CV 70,140
s_xor_b32 m0, s65, 0x18000
s_xor_b32 s66, s62, 0x70100
W 6
MB 224,16,160
G 44,44,66,0
T 36,17,16
T 38,17,20
MB 228,16,164
CV 71,142
s_xor_b32 s79, s67, 0x1011000
buffer_store_dwordx4 v[68:71], v59, s[52:55], s79 offen sc1
MB 232,20,160
T 40,18,16
T 42,18,20
MB 236,20,164
CV 72,144
CV 73,146
CV 74,152
W 6
MB 240,24,160
G 45,44,66,1
T 44,19,16
T 46,19,20
MB 244,24,164
CV 75,154
s_xor_b32 s79, s67, 0x1022000
buffer_store_dwordx4 v[72:75], v59, s[52:55], s79 offen sc1
MB 248,28,160
T 48,20,16
T 50,20,20
MB 252,28,164
CV 76,148
CV 77,150
CV 78,156
W 6
MB 192,32,168
G 46,44,66,2
T 52,21,16
T 54,21,20
MB 196,32,172
CV 79,158
s_xor_b32 s79, s67, 0x1033000
buffer_store_dwordx4 v[76:79], v59, s[52:55], s79 offen sc1
L_ce_c2:
v_cmp_ne_u32 vcc, 1, v3
v_cmp_ne_u32 s[82:83], 1, v4
s_nop 3
s_or_b64 vcc, vcc, s[82:83]
s_cbranch_scc1 L_we_c2
L_ge_c2:
MB 200,36,168
T 56,22,16
T 58,22,20
MB 204,36,172
CV 80,160
CV 81,162
CV 82,168
W 6
MB 208,40,168
G 47,44,66,3
T 60,23,16
T 62,23,20
MB 212,40,172
CV 83,170
s_xor_b32 s79, s67, 0x1044000
buffer_store_dwordx4 v[80:83], v59, s[52:55], s79 offen sc1
MB 216,44,168
s_waitcnt vmcnt(16)
s_barrier
T 0,16,32
T 2,16,36
MB 220,44,172
CV 84,164
CV 85,166
CV 86,172
s_xor_b32 m0, s65, 0x1c000
s_xor_b32 s66, s62, 0x78100
W 6
MB 224,48,168
G 44,44,66,0
T 4,17,32
T 6,17,36
MB 228,48,172
CV 87,174
s_xor_b32 s79, s67, 0x1055000
buffer_store_dwordx4 v[84:87], v59, s[52:55], s79 offen sc1
MB 232,52,168
T 8,18,32
T 10,18,36
MB 236,52,172
CV 88,176
CV 89,178
CV 90,184
W 6
MB 240,56,168
G 45,44,66,1
T 12,19,32
T 14,19,36
MB 244,56,172
CV 91,186
s_xor_b32 s79, s67, 0x1066000
buffer_store_dwordx4 v[88:91], v59, s[52:55], s79 offen sc1
MB 248,60,168
T 16,20,32
T 18,20,36
MB 252,60,172
CV 92,180
CV 93,182
CV 94,188
W 6
MB 192,0,176
G 46,44,66,2
T 20,21,32
T 22,21,36
MB 196,0,180
CV 95,190
s_xor_b32 s79, s67, 0x1077000
buffer_store_dwordx4 v[92:95], v59, s[52:55], s79 offen sc1
MB 200,4,176
T 24,22,32
T 26,22,36
MB 204,4,180
CV 64,128
CV 65,130
W 6
MB 208,8,176
G 47,44,66,3
T 28,23,32
MB 212,8,180
T 30,23,36
CV 66,136
CV 67,138
MB 216,12,176
T 32,16,48
MB 220,12,180
T 34,16,52
W 6
MB 224,16,176
s_xor_b32 s80, s67, 0x1000
buffer_load_dwordx4 v[132:135], v59, s[52:55], s80 offen sc1
MB 228,16,180
T 36,17,48
T 38,17,52
MB 232,20,176
T 40,18,48
MB 236,20,180
T 42,18,52
W 6
MB 240,24,176
T 44,19,48
MB 244,24,180
T 46,19,52
MB 248,28,176
T 48,20,48
MB 252,28,180
T 50,20,52
W 6
MB 192,32,184
T 52,21,48
MB 196,32,188
T 54,21,52
MB 200,36,184
T 56,22,48
MB 204,36,188
T 58,22,52
W 6
MB 208,40,184
s_xor_b32 s80, s67, 0x2000
buffer_load_dwordx4 v[136:139], v59, s[52:55], s80 offen sc1
MB 212,40,188
T 60,23,48
T 62,23,52
MB 216,44,184
s_waitcnt vmcnt(17)
s_barrier
MB 220,44,188
T 0,24,0
T 2,24,4
W 6
MB 224,48,184
T 4,25,0
MB 228,48,188
T 6,25,4
MB 232,52,184
T 8,26,0
MB 236,52,188
T 10,26,4
W 6
MB 240,56,184
T 12,27,0
MB 244,56,188
T 14,27,4
MB 248,60,184
T 16,28,0
MB 252,60,188
T 18,28,4
W 6
MB 192,0,96
s_xor_b32 s80, s67, 0x3000
buffer_load_dwordx4 v[140:143], v59, s[52:55], s80 offen sc1
MB 196,0,100
T 20,29,0
T 22,29,4
MB 200,4,96
T 24,30,0
MB 204,4,100
T 26,30,4
W 6
MB 208,8,96
T 28,31,0
MB 212,8,100
T 30,31,4
MB 216,12,96
T 32,24,16
MB 220,12,100
T 34,24,20
W 6
MB 224,16,96
T 36,25,16
MB 228,16,100
T 38,25,20
MB 232,20,96
T 40,26,16
MB 236,20,100
T 42,26,20
W 6
MB 240,24,96
s_xor_b32 s80, s67, 0x4000
buffer_load_dwordx4 v[144:147], v59, s[52:55], s80 offen sc1
MB 244,24,100
T 44,27,16
T 46,27,20
MB 248,28,96
T 48,28,16
MB 252,28,100
T 50,28,20
W 6
MB 192,32,104
T 52,29,16
MB 196,32,108
T 54,29,20
MB 200,36,104
T 56,30,16
MB 204,36,108
T 58,30,20
W 6
MB 208,40,104
T 60,31,16
MB 212,40,108
T 62,31,20
MB 216,44,104
s_waitcnt vmcnt(4)
s_barrier
MB 220,44,108
T 0,24,32
T 2,24,36
W 6
MB 224,48,104
T 4,25,32
MB 228,48,108
T 6,25,36
MB 232,52,104
s_xor_b32 s80, s67, 0x5000
buffer_load_dwordx4 v[148:151], v59, s[52:55], s80 offen sc1
MB 236,52,108
T 8,26,32
T 10,26,36
W 6
MB 240,56,104
T 12,27,32
MB 244,56,108
T 14,27,36
MB 248,60,104
T 16,28,32
MB 252,60,108
T 18,28,36
W 6
MB 192,0,112
T 20,29,32
MB 196,0,116
T 22,29,36
MB 200,4,112
T 24,30,32
MB 204,4,116
T 26,30,36
W 6
MB 208,8,112
T 28,31,32
MB 212,8,116
T 30,31,36
MB 216,12,112
s_xor_b32 s80, s67, 0x6000
buffer_load_dwordx4 v[152:155], v59, s[52:55], s80 offen sc1
MB 220,12,116
T 32,24,48
T 34,24,52
W 6
MB 224,16,112
T 36,25,48
MB 228,16,116
T 38,25,52
MB 232,20,112
T 40,26,48
MB 236,20,116
T 42,26,52
W 6
MB 240,24,112
T 44,27,48
MB 244,24,116
T 46,27,52
MB 248,28,112
T 48,28,48
MB 252,28,116
T 50,28,52
W 6
MB 192,32,120
T 52,29,48
MB 196,32,124
T 54,29,52
MB 200,36,120
s_xor_b32 s80, s67, 0x7000
buffer_load_dwordx4 v[156:159], v59, s[52:55], s80 offen sc1
MB 204,36,124
T 56,30,48
T 58,30,52
W 6
MB 208,40,120
T 60,31,48
MB 212,40,124
T 62,31,52
MB 216,44,120
MB 220,44,124
W 4
MB 224,48,120
MB 228,48,124
MB 232,52,120
MB 236,52,124
W 0
MB 240,56,120
MB 244,56,124
v_mov_b32 v61, 1
v_mov_b32 v62, 0
s_mov_b64 exec, 1
buffer_store_dword v61, v62, s[52:55], s5 offen offset:256 sc1
s_mov_b64 exec, -1
MB 248,60,120
MB 252,60,124
CV 100,196
CV 101,198
CV 102,204
CV 103,206
s_xor_b32 s79, s67, 0x1019000
buffer_store_dwordx4 v[100:103], v59, s[52:55], s79 offen sc1
CV 104,208
CV 105,210
CV 106,216
CV 107,218
s_xor_b32 s79, s67, 0x102a000
buffer_store_dwordx4 v[104:107], v59, s[52:55], s79 offen sc1
CV 108,212
CV 109,214
CV 110,220
CV 111,222
s_xor_b32 s79, s67, 0x103b000
buffer_store_dwordx4 v[108:111], v59, s[52:55], s79 offen sc1
CV 112,224
CV 113,226
CV 114,232
CV 115,234
s_xor_b32 s79, s67, 0x104c000
buffer_store_dwordx4 v[112:115], v59, s[52:55], s79 offen sc1
CV 116,228
CV 117,230
CV 118,236
CV 119,238
s_xor_b32 s79, s67, 0x105d000
buffer_store_dwordx4 v[116:119], v59, s[52:55], s79 offen sc1
CV 120,240
CV 121,242
CV 122,248
CV 123,250
s_xor_b32 s79, s67, 0x106e000
buffer_store_dwordx4 v[120:123], v59, s[52:55], s79 offen sc1
CV 124,244
CV 125,246
CV 126,252
CV 127,254
s_xor_b32 s79, s67, 0x107f000
buffer_store_dwordx4 v[124:127], v59, s[52:55], s79 offen sc1
CV 96,192
CV 97,194
CV 98,200
CV 99,202
buffer_load_dword v0, v7, s[52:55], s72 offen offset:256 sc1
UP 68,36
UH 69,36
UP 70,37
UH 71,37
UP 72,38
UH 73,38
UP 74,39
UH 75,39
s_waitcnt vmcnt(15)
UP 76,132
UH 77,132
UP 78,133
UH 79,133
UP 80,134
UH 81,134
UP 82,135
UH 83,135
PA 68,76
PA 70,78
PA 72,80
PA 74,82
s_waitcnt vmcnt(14)
UP 76,136
UH 77,136
UP 78,137
UH 79,137
UP 80,138
UH 81,138
UP 82,139
UH 83,139
PA 68,76
PA 70,78
PA 72,80
PA 74,82
s_waitcnt vmcnt(13)
UP 76,140
UH 77,140
UP 78,141
UH 79,141
UP 80,142
UH 81,142
UP 82,143
UH 83,143
PA 68,76
PA 70,78
PA 72,80
PA 74,82
s_waitcnt vmcnt(12)
UP 76,144
UH 77,144
UP 78,145
UH 79,145
UP 80,146
UH 81,146
UP 82,147
UH 83,147
PA 68,76
PA 70,78
PA 72,80
PA 74,82
s_waitcnt vmcnt(11)
UP 76,148
UH 77,148
UP 78,149
UH 79,149
UP 80,150
UH 81,150
UP 82,151
UH 83,151
PA 68,76
PA 70,78
PA 72,80
PA 74,82
s_waitcnt vmcnt(10)
UP 76,152
UH 77,152
UP 78,153
UH 79,153
UP 80,154
UH 81,154
UP 82,155
UH 83,155
PA 68,76
PA 70,78
PA 72,80
PA 74,82
s_waitcnt vmcnt(9)
UP 76,156
UH 77,156
UP 78,157
UH 79,157
UP 80,158
UH 81,158
UP 82,159
UH 83,159
PA 68,76
PA 70,78
PA 72,80
PA 74,82
CV 128,68
CV 129,70
CV 130,72
CV 131,74
s_nop 0
v_permlane32_swap_b32 v128, v130
v_permlane32_swap_b32 v129, v131
s_nop 0
v_permlane16_swap_b32 v128, v130
v_permlane16_swap_b32 v129, v131
s_xor_b32 s80, s4, 0x0
buffer_store_dwordx4 v[128:131], v6, s[56:59], s80 offen
s_waitcnt vmcnt(2)
v_mov_b32 v61, 1
v_mov_b32 v62, 0
s_mov_b64 exec, 1
buffer_store_dword v61, v62, s[52:55], s5 offen offset:384 sc1
s_mov_b64 exec, -1
s_xor_b32 s80, s67, 0x9000
buffer_load_dwordx4 v[164:167], v59, s[52:55], s80 offen sc1
s_xor_b32 s80, s67, 0xa000
buffer_load_dwordx4 v[168:171], v59, s[52:55], s80 offen sc1
s_xor_b32 s80, s67, 0xb000
buffer_load_dwordx4 v[172:175], v59, s[52:55], s80 offen sc1
s_xor_b32 s80, s67, 0xc000
buffer_load_dwordx4 v[176:179], v59, s[52:55], s80 offen sc1
s_xor_b32 s80, s67, 0xd000
buffer_load_dwordx4 v[180:183], v59, s[52:55], s80 offen sc1
s_xor_b32 s80, s67, 0xe000
buffer_load_dwordx4 v[184:187], v59, s[52:55], s80 offen sc1
s_xor_b32 s80, s67, 0xf000
buffer_load_dwordx4 v[188:191], v59, s[52:55], s80 offen sc1
L_cm_c2:
s_waitcnt vmcnt(9)
v_cmp_ne_u32 vcc, 1, v0
s_nop 3
s_or_b64 vcc, vcc, vcc
s_cbranch_scc1 L_wm_c2
L_gm_c2:
s_xor_b32 s80, s67, 0x1001000
buffer_load_dwordx4 v[196:199], v59, s[52:55], s80 offen sc1
s_xor_b32 s80, s67, 0x1002000
buffer_load_dwordx4 v[200:203], v59, s[52:55], s80 offen sc1
s_xor_b32 s80, s67, 0x1003000
buffer_load_dwordx4 v[204:207], v59, s[52:55], s80 offen sc1
s_xor_b32 s80, s67, 0x1004000
buffer_load_dwordx4 v[208:211], v59, s[52:55], s80 offen sc1
s_xor_b32 s80, s67, 0x1005000
buffer_load_dwordx4 v[212:215], v59, s[52:55], s80 offen sc1
s_xor_b32 s80, s67, 0x1006000
buffer_load_dwordx4 v[216:219], v59, s[52:55], s80 offen sc1
s_xor_b32 s80, s67, 0x1007000
buffer_load_dwordx4 v[220:223], v59, s[52:55], s80 offen sc1
buffer_load_dword v4, v7, s[52:55], s72 offen offset:384 sc1
UP 68,40
UH 69,40
UP 70,41
UH 71,41
UP 72,42
UH 73,42
UP 74,43
UH 75,43
s_waitcnt vmcnt(14)
UP 76,164
UH 77,164
UP 78,165
UH 79,165
UP 80,166
UH 81,166
UP 82,167
UH 83,167
PA 68,76
PA 70,78
PA 72,80
PA 74,82
s_waitcnt vmcnt(13)
UP 76,168
UH 77,168
UP 78,169
UH 79,169
UP 80,170
UH 81,170
UP 82,171
UH 83,171
PA 68,76
PA 70,78
PA 72,80
PA 74,82
s_waitcnt vmcnt(12)
UP 76,172
UH 77,172
UP 78,173
UH 79,173
UP 80,174
UH 81,174
UP 82,175
UH 83,175
PA 68,76
PA 70,78
PA 72,80
PA 74,82
s_waitcnt vmcnt(11)
UP 76,176
UH 77,176
UP 78,177
UH 79,177
UP 80,178
UH 81,178
UP 82,179
UH 83,179
PA 68,76
PA 70,78
PA 72,80
PA 74,82
s_waitcnt vmcnt(10)
UP 76,180
UH 77,180
UP 78,181
UH 79,181
UP 80,182
UH 81,182
UP 82,183
UH 83,183
PA 68,76
PA 70,78
PA 72,80
PA 74,82
s_waitcnt vmcnt(9)
UP 76,184
UH 77,184
UP 78,185
UH 79,185
UP 80,186
UH 81,186
UP 82,187
UH 83,187
PA 68,76
PA 70,78
PA 72,80
PA 74,82
s_waitcnt vmcnt(8)
UP 76,188
UH 77,188
UP 78,189
UH 79,189
UP 80,190
UH 81,190
UP 82,191
UH 83,191
PA 68,76
PA 70,78
PA 72,80
PA 74,82
CV 160,68
CV 161,70
CV 162,72
CV 163,74
s_nop 0
v_permlane32_swap_b32 v160, v162
v_permlane32_swap_b32 v161, v163
s_nop 0
v_permlane16_swap_b32 v160, v162
v_permlane16_swap_b32 v161, v163
s_xor_b32 s80, s4, 0x100
buffer_store_dwordx4 v[160:163], v6, s[56:59], s80 offen
L_cl_c2:
s_waitcnt vmcnt(1)
v_cmp_ne_u32 vcc, 1, v4
s_nop 3
s_or_b64 vcc, vcc, vcc
s_cbranch_scc1 L_wl_c2
L_gl_c2:
s_xor_b32 s80, s67, 0x1009000
buffer_load_dwordx4 v[228:231], v59, s[52:55], s80 offen sc1
s_xor_b32 s80, s67, 0x100a000
buffer_load_dwordx4 v[232:235], v59, s[52:55], s80 offen sc1
s_xor_b32 s80, s67, 0x100b000
buffer_load_dwordx4 v[236:239], v59, s[52:55], s80 offen sc1
s_xor_b32 s80, s67, 0x100c000
buffer_load_dwordx4 v[240:243], v59, s[52:55], s80 offen sc1
s_xor_b32 s80, s67, 0x100d000
buffer_load_dwordx4 v[244:247], v59, s[52:55], s80 offen sc1
s_xor_b32 s80, s67, 0x100e000
buffer_load_dwordx4 v[248:251], v59, s[52:55], s80 offen sc1
s_xor_b32 s80, s67, 0x100f000
buffer_load_dwordx4 v[252:255], v59, s[52:55], s80 offen sc1
UP 68,64
UH 69,64
UP 70,65
UH 71,65
UP 72,66
UH 73,66
UP 74,67
UH 75,67
UP 76,196
UH 77,196
UP 78,197
UH 79,197
UP 80,198
UH 81,198
UP 82,199
UH 83,199
PA 68,76
PA 70,78
PA 72,80
PA 74,82
UP 76,200
UH 77,200
UP 78,201
UH 79,201
UP 80,202
UH 81,202
UP 82,203
UH 83,203
PA 68,76
PA 70,78
PA 72,80
PA 74,82
UP 76,204
UH 77,204
UP 78,205
UH 79,205
UP 80,206
UH 81,206
UP 82,207
UH 83,207
PA 68,76
PA 70,78
PA 72,80
PA 74,82
UP 76,208
UH 77,208
UP 78,209
UH 79,209
UP 80,210
UH 81,210
UP 82,211
UH 83,211
PA 68,76
PA 70,78
PA 72,80
PA 74,82
UP 76,212
UH 77,212
UP 78,213
UH 79,213
UP 80,214
UH 81,214
UP 82,215
UH 83,215
PA 68,76
PA 70,78
PA 72,80
PA 74,82
UP 76,216
UH 77,216
UP 78,217
UH 79,217
UP 80,218
UH 81,218
UP 82,219
UH 83,219
PA 68,76
PA 70,78
PA 72,80
PA 74,82
UP 76,220
UH 77,220
UP 78,221
UH 79,221
UP 80,222
UH 81,222
UP 82,223
UH 83,223
PA 68,76
PA 70,78
PA 72,80
PA 74,82
CV 192,68
CV 193,70
CV 194,72
CV 195,74
s_nop 0
v_permlane32_swap_b32 v192, v194
v_permlane32_swap_b32 v193, v195
s_nop 0
v_permlane16_swap_b32 v192, v194
v_permlane16_swap_b32 v193, v195
s_xor_b32 s80, s4, 0x400
buffer_store_dwordx4 v[192:195], v6, s[56:59], s80 offen
UP 68,96
UH 69,96
UP 70,97
UH 71,97
UP 72,98
UH 73,98
UP 74,99
UH 75,99
s_waitcnt vmcnt(7)
UP 76,228
UH 77,228
UP 78,229
UH 79,229
UP 80,230
UH 81,230
UP 82,231
UH 83,231
PA 68,76
PA 70,78
PA 72,80
PA 74,82
s_waitcnt vmcnt(6)
UP 76,232
UH 77,232
UP 78,233
UH 79,233
UP 80,234
UH 81,234
UP 82,235
UH 83,235
PA 68,76
PA 70,78
PA 72,80
PA 74,82
s_waitcnt vmcnt(5)
UP 76,236
UH 77,236
UP 78,237
UH 79,237
UP 80,238
UH 81,238
UP 82,239
UH 83,239
PA 68,76
PA 70,78
PA 72,80
PA 74,82
s_waitcnt vmcnt(4)
UP 76,240
UH 77,240
UP 78,241
UH 79,241
UP 80,242
UH 81,242
UP 82,243
UH 83,243
PA 68,76
PA 70,78
PA 72,80
PA 74,82
s_waitcnt vmcnt(3)
UP 76,244
UH 77,244
UP 78,245
UH 79,245
UP 80,246
UH 81,246
UP 82,247
UH 83,247
PA 68,76
PA 70,78
PA 72,80
PA 74,82
s_waitcnt vmcnt(2)
UP 76,248
UH 77,248
UP 78,249
UH 79,249
UP 80,250
UH 81,250
UP 82,251
UH 83,251
PA 68,76
PA 70,78
PA 72,80
PA 74,82
s_waitcnt vmcnt(1)
UP 76,252
UH 77,252
UP 78,253
UH 79,253
UP 80,254
UH 81,254
UP 82,255
UH 83,255
PA 68,76
PA 70,78
PA 72,80
PA 74,82
CV 224,68
CV 225,70
CV 226,72
CV 227,74
s_nop 0
v_permlane32_swap_b32 v224, v226
v_permlane32_swap_b32 v225, v227
s_nop 0
v_permlane16_swap_b32 v224, v226
v_permlane16_swap_b32 v225, v227
s_xor_b32 s80, s4, 0x500
buffer_store_dwordx4 v[224:227], v6, s[56:59], s80 offen
s_endpgm
L_slow_c2A0:
s_waitcnt vmcnt(0) lgkmcnt(0)
s_nop 15
s_mov_b32 s93, m0
s_andn2_b32 s80, s64, 0x1ff00
s_xor_b32 s80, s80, 0x0
v_mov_b32 v62, 0xff800000
v_mov_b32 v63, 0xff800000
s_mov_b32 s94, s80
s_mov_b32 s81, 0
L_slow1_c2A0:
s_add_u32 m0, s78, 0
s_add_u32 s92, s94, 0
G 32,12,92,0
G 33,12,92,1
G 34,12,92,2
G 35,12,92,3
s_add_u32 m0, s78, 4096
s_add_u32 s92, s94, 512
G 32,12,92,0
G 33,12,92,1
G 34,12,92,2
G 35,12,92,3
s_waitcnt vmcnt(0)
v_and_b32 v0, 0x1fff, v8
v_add_u32 v0, s78, v0
R a,32,0,0
R a,48,0,4
v_and_b32 v0, 0x1fff, v9
v_add_u32 v0, s78, v0
R a,36,0,0
R a,52,0,4
v_and_b32 v0, 0x1fff, v10
v_add_u32 v0, s78, v0
R a,40,0,0
R a,56,0,4
v_and_b32 v0, 0x1fff, v11
v_add_u32 v0, s78, v0
R a,44,0,0
R a,60,0,4
W 7
ZB 64,32,64
ZB 68,32,68
W 5
MB 64,36,72
MB 68,36,76
W 3
MB 64,40,80
MB 68,40,84
W 1
MB 64,44,88
MB 68,44,92
ZB 72,48,64
ZB 76,48,68
MB 72,52,72
MB 76,52,76
MB 72,56,80
MB 76,56,84
W 0
MB 72,60,88
MB 76,60,92
v_max_f32 v62, v62, v64
v_max_f32 v62, v62, v65
v_max_f32 v62, v62, v66
v_max_f32 v62, v62, v67
v_max_f32 v63, v63, v68
v_max_f32 v63, v63, v69
v_max_f32 v63, v63, v70
v_max_f32 v63, v63, v71
v_max_f32 v62, v62, v72
v_max_f32 v62, v62, v73
v_max_f32 v62, v62, v74
v_max_f32 v62, v62, v75
v_max_f32 v63, v63, v76
v_max_f32 v63, v63, v77
v_max_f32 v63, v63, v78
v_max_f32 v63, v63, v79
s_or_b32 s81, s81, 0x7ffe8fff
s_add_u32 s81, s81, 1
s_and_b32 s81, s81, 0x17000
s_add_u32 s94, s80, s81
s_cmp_lg_u32 s81, 0
s_cbranch_scc1 L_slow1_c2A0
v_mov_b32 v1, v62
s_nop 1
v_permlane32_swap_b32 v1, v62
v_max_f32 v62, v62, v1
v_mov_b32 v1, v62
s_nop 1
v_permlane16_swap_b32 v1, v62
v_max_f32 v62, v62, v1
v_mov_b32 v1, v63
s_nop 1
v_permlane32_swap_b32 v1, v63
v_max_f32 v63, v63, v1
v_mov_b32 v1, v63
s_nop 1
v_permlane16_swap_b32 v1, v63
v_max_f32 v63, v63, v1
v_mov_b32 v60, 0
v_mov_b32 v61, 0
v_mov_b32 v128, 0
v_mov_b32 v129, 0
v_mov_b32 v130, 0
v_mov_b32 v131, 0
v_mov_b32 v132, 0
v_mov_b32 v133, 0
v_mov_b32 v134, 0
v_mov_b32 v135, 0
v_mov_b32 v136, 0
v_mov_b32 v137, 0
v_mov_b32 v138, 0
v_mov_b32 v139, 0
v_mov_b32 v140, 0
v_mov_b32 v141, 0
v_mov_b32 v142, 0
v_mov_b32 v143, 0
v_mov_b32 v144, 0
v_mov_b32 v145, 0
v_mov_b32 v146, 0
v_mov_b32 v147, 0
v_mov_b32 v148, 0
v_mov_b32 v149, 0
v_mov_b32 v150, 0
v_mov_b32 v151, 0
v_mov_b32 v152, 0
v_mov_b32 v153, 0
v_mov_b32 v154, 0
v_mov_b32 v155, 0
v_mov_b32 v156, 0
v_mov_b32 v157, 0
v_mov_b32 v158, 0
v_mov_b32 v159, 0
v_mov_b32 v160, 0
v_mov_b32 v161, 0
v_mov_b32 v162, 0
v_mov_b32 v163, 0
v_mov_b32 v164, 0
v_mov_b32 v165, 0
v_mov_b32 v166, 0
v_mov_b32 v167, 0
v_mov_b32 v168, 0
v_mov_b32 v169, 0
v_mov_b32 v170, 0
v_mov_b32 v171, 0
v_mov_b32 v172, 0
v_mov_b32 v173, 0
v_mov_b32 v174, 0
v_mov_b32 v175, 0
v_mov_b32 v176, 0
v_mov_b32 v177, 0
v_mov_b32 v178, 0
v_mov_b32 v179, 0
v_mov_b32 v180, 0
v_mov_b32 v181, 0
v_mov_b32 v182, 0
v_mov_b32 v183, 0
v_mov_b32 v184, 0
v_mov_b32 v185, 0
v_mov_b32 v186, 0
v_mov_b32 v187, 0
v_mov_b32 v188, 0
v_mov_b32 v189, 0
v_mov_b32 v190, 0
v_mov_b32 v191, 0
s_mov_b32 s94, s80
s_mov_b32 s81, 0
s_nop 4
L_slow2_c2A0:
s_add_u32 m0, s78, 0
s_add_u32 s92, s94, 0
G 32,12,92,0
G 33,12,92,1
G 34,12,92,2
G 35,12,92,3
s_add_u32 m0, s78, 4096
s_add_u32 s92, s94, 512
G 32,12,92,0
G 33,12,92,1
G 34,12,92,2
G 35,12,92,3
s_waitcnt vmcnt(0)
v_and_b32 v0, 0x1fff, v8
v_add_u32 v0, s78, v0
R a,32,0,0
R a,48,0,4
v_and_b32 v0, 0x1fff, v9
v_add_u32 v0, s78, v0
R a,36,0,0
R a,52,0,4
v_and_b32 v0, 0x1fff, v10
v_add_u32 v0, s78, v0
R a,40,0,0
R a,56,0,4
v_and_b32 v0, 0x1fff, v11
v_add_u32 v0, s78, v0
R a,44,0,0
R a,60,0,4
W 7
ZB 64,32,64
ZB 68,32,68
W 5
MB 64,36,72
MB 68,36,76
W 3
MB 64,40,80
MB 68,40,84
W 1
MB 64,44,88
MB 68,44,92
ZB 72,48,64
ZB 76,48,68
MB 72,52,72
MB 76,52,76
MB 72,56,80
MB 76,56,84
W 0
MB 72,60,88
MB 76,60,92
v_sub_f32 v64, v64, v62
v_sub_f32 v65, v65, v62
v_sub_f32 v66, v66, v62
v_sub_f32 v67, v67, v62
v_sub_f32 v68, v68, v63
v_sub_f32 v69, v69, v63
v_sub_f32 v70, v70, v63
v_sub_f32 v71, v71, v63
v_sub_f32 v72, v72, v62
v_sub_f32 v73, v73, v62
v_sub_f32 v74, v74, v62
v_sub_f32 v75, v75, v62
v_sub_f32 v76, v76, v63
v_sub_f32 v77, v77, v63
v_sub_f32 v78, v78, v63
v_sub_f32 v79, v79, v63
E 64
E 65
E 66
E 67
E 68
E 69
E 70
E 71
E 72
E 73
E 74
E 75
E 76
E 77
E 78
E 79
v_add_f32 v60, v60, v64
v_add_f32 v60, v60, v65
v_add_f32 v60, v60, v66
v_add_f32 v60, v60, v67
v_add_f32 v61, v61, v68
v_add_f32 v61, v61, v69
v_add_f32 v61, v61, v70
v_add_f32 v61, v61, v71
v_add_f32 v60, v60, v72
v_add_f32 v60, v60, v73
v_add_f32 v60, v60, v74
v_add_f32 v60, v60, v75
v_add_f32 v61, v61, v76
v_add_f32 v61, v61, v77
v_add_f32 v61, v61, v78
v_add_f32 v61, v61, v79
CV 96,64
CV 97,66
CV 100,68
CV 101,70
CV 98,72
CV 99,74
CV 102,76
CV 103,78
s_add_u32 m0, s78, 0
s_add_u32 s92, s94, 0
G 56,16,92,0
G 57,16,92,1
G 56,16,92,2
G 57,16,92,3
s_add_u32 m0, s78, 4096
s_add_u32 s92, s94, 512
G 56,16,92,0
G 57,16,92,1
G 56,16,92,2
G 57,16,92,3
s_waitcnt vmcnt(0)
v_and_b32 v0, 0x1fff, v16
v_add_u32 v0, s78, v0
T 32,0,0
T 34,0,4
v_and_b32 v0, 0x1fff, v17
v_add_u32 v0, s78, v0
T 36,0,0
T 38,0,4
v_and_b32 v0, 0x1fff, v18
v_add_u32 v0, s78, v0
T 40,0,0
T 42,0,4
v_and_b32 v0, 0x1fff, v19
v_add_u32 v0, s78, v0
T 44,0,0
T 46,0,4
v_and_b32 v0, 0x1fff, v20
v_add_u32 v0, s78, v0
T 48,0,0
T 50,0,4
v_and_b32 v0, 0x1fff, v21
v_add_u32 v0, s78, v0
T 52,0,0
T 54,0,4
v_and_b32 v0, 0x1fff, v22
v_add_u32 v0, s78, v0
T 56,0,0
T 58,0,4
v_and_b32 v0, 0x1fff, v23
v_add_u32 v0, s78, v0
T 60,0,0
W 14
T 62,0,4
W 14
MA 128,32,96
MA 132,32,100
W 12
MA 136,36,96
MA 140,36,100
W 10
MA 144,40,96
MA 148,40,100
W 8
MA 152,44,96
MA 156,44,100
W 6
MA 160,48,96
MA 164,48,100
W 4
MA 168,52,96
MA 172,52,100
W 2
MA 176,56,96
MA 180,56,100
W 0
MA 184,60,96
MA 188,60,100
s_nop 15
s_or_b32 s81, s81, 0x7ffe8fff
s_add_u32 s81, s81, 1
s_and_b32 s81, s81, 0x17000
s_add_u32 s94, s80, s81
s_cmp_lg_u32 s81, 0
s_cbranch_scc1 L_slow2_c2A0
v_mov_b32 v1, v60
s_nop 1
v_permlane32_swap_b32 v1, v60
v_add_f32 v60, v60, v1
v_mov_b32 v1, v60
s_nop 1
v_permlane16_swap_b32 v1, v60
v_add_f32 v60, v60, v1
v_mov_b32 v1, v61
s_nop 1
v_permlane32_swap_b32 v1, v61
v_add_f32 v61, v61, v1
v_mov_b32 v1, v61
s_nop 1
v_permlane16_swap_b32 v1, v61
v_add_f32 v61, v61, v1
s_mov_b32 m0, s93
s_nop 4
s_branch L_back_c2A0
L_slow_c2A1:
s_waitcnt vmcnt(0) lgkmcnt(0)
s_nop 15
s_mov_b32 s93, m0
s_andn2_b32 s80, s64, 0x1ff00
s_xor_b32 s80, s80, 0x0
v_mov_b32 v62, 0xff800000
v_mov_b32 v63, 0xff800000
s_mov_b32 s94, s80
s_mov_b32 s81, 0
L_slow1_c2A1:
s_add_u32 m0, s78, 0
s_add_u32 s92, s94, 0
G 32,12,92,0
G 33,12,92,1
G 34,12,92,2
G 35,12,92,3
s_add_u32 m0, s78, 4096
s_add_u32 s92, s94, 512
G 32,12,92,0
G 33,12,92,1
G 34,12,92,2
G 35,12,92,3
s_waitcnt vmcnt(0)
v_and_b32 v0, 0x1fff, v8
v_add_u32 v0, s78, v0
R a,32,0,0
R a,48,0,4
v_and_b32 v0, 0x1fff, v9
v_add_u32 v0, s78, v0
R a,36,0,0
R a,52,0,4
v_and_b32 v0, 0x1fff, v10
v_add_u32 v0, s78, v0
R a,40,0,0
R a,56,0,4
v_and_b32 v0, 0x1fff, v11
v_add_u32 v0, s78, v0
R a,44,0,0
R a,60,0,4
W 7
ZB 64,32,96
ZB 68,32,100
W 5
MB 64,36,104
MB 68,36,108
W 3
MB 64,40,112
MB 68,40,116
W 1
MB 64,44,120
MB 68,44,124
ZB 72,48,96
ZB 76,48,100
MB 72,52,104
MB 76,52,108
MB 72,56,112
MB 76,56,116
W 0
MB 72,60,120
MB 76,60,124
v_max_f32 v62, v62, v64
v_max_f32 v62, v62, v65
v_max_f32 v62, v62, v66
v_max_f32 v62, v62, v67
v_max_f32 v63, v63, v68
v_max_f32 v63, v63, v69
v_max_f32 v63, v63, v70
v_max_f32 v63, v63, v71
v_max_f32 v62, v62, v72
v_max_f32 v62, v62, v73
v_max_f32 v62, v62, v74
v_max_f32 v62, v62, v75
v_max_f32 v63, v63, v76
v_max_f32 v63, v63, v77
v_max_f32 v63, v63, v78
v_max_f32 v63, v63, v79
s_or_b32 s81, s81, 0x7ffe8fff
s_add_u32 s81, s81, 1
s_and_b32 s81, s81, 0x17000
s_add_u32 s94, s80, s81
s_cmp_lg_u32 s81, 0
s_cbranch_scc1 L_slow1_c2A1
v_mov_b32 v1, v62
s_nop 1
v_permlane32_swap_b32 v1, v62
v_max_f32 v62, v62, v1
v_mov_b32 v1, v62
s_nop 1
v_permlane16_swap_b32 v1, v62
v_max_f32 v62, v62, v1
v_mov_b32 v1, v63
s_nop 1
v_permlane32_swap_b32 v1, v63
v_max_f32 v63, v63, v1
v_mov_b32 v1, v63
s_nop 1
v_permlane16_swap_b32 v1, v63
v_max_f32 v63, v63, v1
v_mov_b32 v60, 0
v_mov_b32 v61, 0
v_mov_b32 v192, 0
v_mov_b32 v193, 0
v_mov_b32 v194, 0
v_mov_b32 v195, 0
v_mov_b32 v196, 0
v_mov_b32 v197, 0
v_mov_b32 v198, 0
v_mov_b32 v199, 0
v_mov_b32 v200, 0
v_mov_b32 v201, 0
v_mov_b32 v202, 0
v_mov_b32 v203, 0
v_mov_b32 v204, 0
v_mov_b32 v205, 0
v_mov_b32 v206, 0
v_mov_b32 v207, 0
v_mov_b32 v208, 0
v_mov_b32 v209, 0
v_mov_b32 v210, 0
v_mov_b32 v211, 0
v_mov_b32 v212, 0
v_mov_b32 v213, 0
v_mov_b32 v214, 0
v_mov_b32 v215, 0
v_mov_b32 v216, 0
v_mov_b32 v217, 0
v_mov_b32 v218, 0
v_mov_b32 v219, 0
v_mov_b32 v220, 0
v_mov_b32 v221, 0
v_mov_b32 v222, 0
v_mov_b32 v223, 0
v_mov_b32 v224, 0
v_mov_b32 v225, 0
v_mov_b32 v226, 0
v_mov_b32 v227, 0
v_mov_b32 v228, 0
v_mov_b32 v229, 0
v_mov_b32 v230, 0
v_mov_b32 v231, 0
v_mov_b32 v232, 0
v_mov_b32 v233, 0
v_mov_b32 v234, 0
v_mov_b32 v235, 0
v_mov_b32 v236, 0
v_mov_b32 v237, 0
v_mov_b32 v238, 0
v_mov_b32 v239, 0
v_mov_b32 v240, 0
v_mov_b32 v241, 0
v_mov_b32 v242, 0
v_mov_b32 v243, 0
v_mov_b32 v244, 0
v_mov_b32 v245, 0
v_mov_b32 v246, 0
v_mov_b32 v247, 0
v_mov_b32 v248, 0
v_mov_b32 v249, 0
v_mov_b32 v250, 0
v_mov_b32 v251, 0
v_mov_b32 v252, 0
v_mov_b32 v253, 0
v_mov_b32 v254, 0
v_mov_b32 v255, 0
s_mov_b32 s94, s80
s_mov_b32 s81, 0
s_nop 4
L_slow2_c2A1:
s_add_u32 m0, s78, 0
s_add_u32 s92, s94, 0
G 32,12,92,0
G 33,12,92,1
G 34,12,92,2
G 35,12,92,3
s_add_u32 m0, s78, 4096
s_add_u32 s92, s94, 512
G 32,12,92,0
G 33,12,92,1
G 34,12,92,2
G 35,12,92,3
s_waitcnt vmcnt(0)
v_and_b32 v0, 0x1fff, v8
v_add_u32 v0, s78, v0
R a,32,0,0
R a,48,0,4
v_and_b32 v0, 0x1fff, v9
v_add_u32 v0, s78, v0
R a,36,0,0
R a,52,0,4
v_and_b32 v0, 0x1fff, v10
v_add_u32 v0, s78, v0
R a,40,0,0
R a,56,0,4
v_and_b32 v0, 0x1fff, v11
v_add_u32 v0, s78, v0
R a,44,0,0
R a,60,0,4
W 7
ZB 64,32,96
ZB 68,32,100
W 5
MB 64,36,104
MB 68,36,108
W 3
MB 64,40,112
MB 68,40,116
W 1
MB 64,44,120
MB 68,44,124
ZB 72,48,96
ZB 76,48,100
MB 72,52,104
MB 76,52,108
MB 72,56,112
MB 76,56,116
W 0
MB 72,60,120
MB 76,60,124
v_sub_f32 v64, v64, v62
v_sub_f32 v65, v65, v62
v_sub_f32 v66, v66, v62
v_sub_f32 v67, v67, v62
v_sub_f32 v68, v68, v63
v_sub_f32 v69, v69, v63
v_sub_f32 v70, v70, v63
v_sub_f32 v71, v71, v63
v_sub_f32 v72, v72, v62
v_sub_f32 v73, v73, v62
v_sub_f32 v74, v74, v62
v_sub_f32 v75, v75, v62
v_sub_f32 v76, v76, v63
v_sub_f32 v77, v77, v63
v_sub_f32 v78, v78, v63
v_sub_f32 v79, v79, v63
E 64
E 65
E 66
E 67
E 68
E 69
E 70
E 71
E 72
E 73
E 74
E 75
E 76
E 77
E 78
E 79
v_add_f32 v60, v60, v64
v_add_f32 v60, v60, v65
v_add_f32 v60, v60, v66
v_add_f32 v60, v60, v67
v_add_f32 v61, v61, v68
v_add_f32 v61, v61, v69
v_add_f32 v61, v61, v70
v_add_f32 v61, v61, v71
v_add_f32 v60, v60, v72
v_add_f32 v60, v60, v73
v_add_f32 v60, v60, v74
v_add_f32 v60, v60, v75
v_add_f32 v61, v61, v76
v_add_f32 v61, v61, v77
v_add_f32 v61, v61, v78
v_add_f32 v61, v61, v79
CV 96,64
CV 97,66
CV 100,68
CV 101,70
CV 98,72
CV 99,74
CV 102,76
CV 103,78
s_add_u32 m0, s78, 0
s_add_u32 s92, s94, 0
G 56,16,92,0
G 57,16,92,1
G 56,16,92,2
G 57,16,92,3
s_add_u32 m0, s78, 4096
s_add_u32 s92, s94, 512
G 56,16,92,0
G 57,16,92,1
G 56,16,92,2
G 57,16,92,3
s_waitcnt vmcnt(0)
v_and_b32 v0, 0x1fff, v16
v_add_u32 v0, s78, v0
T 32,0,0
T 34,0,4
v_and_b32 v0, 0x1fff, v17
v_add_u32 v0, s78, v0
T 36,0,0
T 38,0,4
v_and_b32 v0, 0x1fff, v18
v_add_u32 v0, s78, v0
T 40,0,0
T 42,0,4
v_and_b32 v0, 0x1fff, v19
v_add_u32 v0, s78, v0
T 44,0,0
T 46,0,4
v_and_b32 v0, 0x1fff, v20
v_add_u32 v0, s78, v0
T 48,0,0
T 50,0,4
v_and_b32 v0, 0x1fff, v21
v_add_u32 v0, s78, v0
T 52,0,0
T 54,0,4
v_and_b32 v0, 0x1fff, v22
v_add_u32 v0, s78, v0
T 56,0,0
T 58,0,4
v_and_b32 v0, 0x1fff, v23
v_add_u32 v0, s78, v0
T 60,0,0
W 14
T 62,0,4
W 14
MA 192,32,96
MA 196,32,100
W 12
MA 200,36,96
MA 204,36,100
W 10
MA 208,40,96
MA 212,40,100
W 8
MA 216,44,96
MA 220,44,100
W 6
MA 224,48,96
MA 228,48,100
W 4
MA 232,52,96
MA 236,52,100
W 2
MA 240,56,96
MA 244,56,100
W 0
MA 248,60,96
MA 252,60,100
s_nop 15
s_or_b32 s81, s81, 0x7ffe8fff
s_add_u32 s81, s81, 1
s_and_b32 s81, s81, 0x17000
s_add_u32 s94, s80, s81
s_cmp_lg_u32 s81, 0
s_cbranch_scc1 L_slow2_c2A1
v_mov_b32 v1, v60
s_nop 1
v_permlane32_swap_b32 v1, v60
v_add_f32 v60, v60, v1
v_mov_b32 v1, v60
s_nop 1
v_permlane16_swap_b32 v1, v60
v_add_f32 v60, v60, v1
v_mov_b32 v1, v61
s_nop 1
v_permlane32_swap_b32 v1, v61
v_add_f32 v61, v61, v1
v_mov_b32 v1, v61
s_nop 1
v_permlane16_swap_b32 v1, v61
v_add_f32 v61, v61, v1
s_mov_b32 m0, s93
s_nop 4
s_branch L_back_c2A1
L_slow_c2B0:
s_waitcnt vmcnt(0) lgkmcnt(0)
s_nop 15
s_mov_b32 s93, m0
s_andn2_b32 s80, s63, 0x1ff00
s_xor_b32 s80, s80, 0x0
v_mov_b32 v62, 0xff800000
v_mov_b32 v63, 0xff800000
s_mov_b32 s94, s80
s_mov_b32 s81, 0
L_slow1_c2B0:
s_add_u32 m0, s78, 0
s_add_u32 s92, s94, 0
G 32,32,92,0
G 33,32,92,1
G 34,32,92,2
G 35,32,92,3
s_add_u32 m0, s78, 4096
s_add_u32 s92, s94, 512
G 32,32,92,0
G 33,32,92,1
G 34,32,92,2
G 35,32,92,3
s_waitcnt vmcnt(0)
v_and_b32 v0, 0x1fff, v8
v_add_u32 v0, s78, v0
R a,32,0,0
R a,48,0,4
v_and_b32 v0, 0x1fff, v9
v_add_u32 v0, s78, v0
R a,36,0,0
R a,52,0,4
v_and_b32 v0, 0x1fff, v10
v_add_u32 v0, s78, v0
R a,40,0,0
R a,56,0,4
v_and_b32 v0, 0x1fff, v11
v_add_u32 v0, s78, v0
R a,44,0,0
R a,60,0,4
W 7
ZB 64,32,128
ZB 68,32,132
W 5
MB 64,36,136
MB 68,36,140
W 3
MB 64,40,144
MB 68,40,148
W 1
MB 64,44,152
MB 68,44,156
ZB 72,48,128
ZB 76,48,132
MB 72,52,136
MB 76,52,140
MB 72,56,144
MB 76,56,148
W 0
MB 72,60,152
MB 76,60,156
v_max_f32 v62, v62, v64
v_max_f32 v62, v62, v65
v_max_f32 v62, v62, v66
v_max_f32 v62, v62, v67
v_max_f32 v63, v63, v68
v_max_f32 v63, v63, v69
v_max_f32 v63, v63, v70
v_max_f32 v63, v63, v71
v_max_f32 v62, v62, v72
v_max_f32 v62, v62, v73
v_max_f32 v62, v62, v74
v_max_f32 v62, v62, v75
v_max_f32 v63, v63, v76
v_max_f32 v63, v63, v77
v_max_f32 v63, v63, v78
v_max_f32 v63, v63, v79
s_or_b32 s81, s81, 0x7ffe8fff
s_add_u32 s81, s81, 1
s_and_b32 s81, s81, 0x17000
s_add_u32 s94, s80, s81
s_cmp_lg_u32 s81, 0
s_cbranch_scc1 L_slow1_c2B0
v_mov_b32 v1, v62
s_nop 1
v_permlane32_swap_b32 v1, v62
v_max_f32 v62, v62, v1
v_mov_b32 v1, v62
s_nop 1
v_permlane16_swap_b32 v1, v62
v_max_f32 v62, v62, v1
v_mov_b32 v1, v63
s_nop 1
v_permlane32_swap_b32 v1, v63
v_max_f32 v63, v63, v1
v_mov_b32 v1, v63
s_nop 1
v_permlane16_swap_b32 v1, v63
v_max_f32 v63, v63, v1
v_mov_b32 v60, 0
v_mov_b32 v61, 0
v_mov_b32 v128, 0
v_mov_b32 v129, 0
v_mov_b32 v130, 0
v_mov_b32 v131, 0
v_mov_b32 v132, 0
v_mov_b32 v133, 0
v_mov_b32 v134, 0
v_mov_b32 v135, 0
v_mov_b32 v136, 0
v_mov_b32 v137, 0
v_mov_b32 v138, 0
v_mov_b32 v139, 0
v_mov_b32 v140, 0
v_mov_b32 v141, 0
v_mov_b32 v142, 0
v_mov_b32 v143, 0
v_mov_b32 v144, 0
v_mov_b32 v145, 0
v_mov_b32 v146, 0
v_mov_b32 v147, 0
v_mov_b32 v148, 0
v_mov_b32 v149, 0
v_mov_b32 v150, 0
v_mov_b32 v151, 0
v_mov_b32 v152, 0
v_mov_b32 v153, 0
v_mov_b32 v154, 0
v_mov_b32 v155, 0
v_mov_b32 v156, 0
v_mov_b32 v157, 0
v_mov_b32 v158, 0
v_mov_b32 v159, 0
v_mov_b32 v160, 0
v_mov_b32 v161, 0
v_mov_b32 v162, 0
v_mov_b32 v163, 0
v_mov_b32 v164, 0
v_mov_b32 v165, 0
v_mov_b32 v166, 0
v_mov_b32 v167, 0
v_mov_b32 v168, 0
v_mov_b32 v169, 0
v_mov_b32 v170, 0
v_mov_b32 v171, 0
v_mov_b32 v172, 0
v_mov_b32 v173, 0
v_mov_b32 v174, 0
v_mov_b32 v175, 0
v_mov_b32 v176, 0
v_mov_b32 v177, 0
v_mov_b32 v178, 0
v_mov_b32 v179, 0
v_mov_b32 v180, 0
v_mov_b32 v181, 0
v_mov_b32 v182, 0
v_mov_b32 v183, 0
v_mov_b32 v184, 0
v_mov_b32 v185, 0
v_mov_b32 v186, 0
v_mov_b32 v187, 0
v_mov_b32 v188, 0
v_mov_b32 v189, 0
v_mov_b32 v190, 0
v_mov_b32 v191, 0
s_mov_b32 s94, s80
s_mov_b32 s81, 0
s_nop 4
L_slow2_c2B0:
s_add_u32 m0, s78, 0
s_add_u32 s92, s94, 0
G 32,32,92,0
G 33,32,92,1
G 34,32,92,2
G 35,32,92,3
s_add_u32 m0, s78, 4096
s_add_u32 s92, s94, 512
G 32,32,92,0
G 33,32,92,1
G 34,32,92,2
G 35,32,92,3
s_waitcnt vmcnt(0)
v_and_b32 v0, 0x1fff, v8
v_add_u32 v0, s78, v0
R a,32,0,0
R a,48,0,4
v_and_b32 v0, 0x1fff, v9
v_add_u32 v0, s78, v0
R a,36,0,0
R a,52,0,4
v_and_b32 v0, 0x1fff, v10
v_add_u32 v0, s78, v0
R a,40,0,0
R a,56,0,4
v_and_b32 v0, 0x1fff, v11
v_add_u32 v0, s78, v0
R a,44,0,0
R a,60,0,4
W 7
ZB 64,32,128
ZB 68,32,132
W 5
MB 64,36,136
MB 68,36,140
W 3
MB 64,40,144
MB 68,40,148
W 1
MB 64,44,152
MB 68,44,156
ZB 72,48,128
ZB 76,48,132
MB 72,52,136
MB 76,52,140
MB 72,56,144
MB 76,56,148
W 0
MB 72,60,152
MB 76,60,156
v_sub_f32 v64, v64, v62
v_sub_f32 v65, v65, v62
v_sub_f32 v66, v66, v62
v_sub_f32 v67, v67, v62
v_sub_f32 v68, v68, v63
v_sub_f32 v69, v69, v63
v_sub_f32 v70, v70, v63
v_sub_f32 v71, v71, v63
v_sub_f32 v72, v72, v62
v_sub_f32 v73, v73, v62
v_sub_f32 v74, v74, v62
v_sub_f32 v75, v75, v62
v_sub_f32 v76, v76, v63
v_sub_f32 v77, v77, v63
v_sub_f32 v78, v78, v63
v_sub_f32 v79, v79, v63
E 64
E 65
E 66
E 67
E 68
E 69
E 70
E 71
E 72
E 73
E 74
E 75
E 76
E 77
E 78
E 79
v_add_f32 v60, v60, v64
v_add_f32 v60, v60, v65
v_add_f32 v60, v60, v66
v_add_f32 v60, v60, v67
v_add_f32 v61, v61, v68
v_add_f32 v61, v61, v69
v_add_f32 v61, v61, v70
v_add_f32 v61, v61, v71
v_add_f32 v60, v60, v72
v_add_f32 v60, v60, v73
v_add_f32 v60, v60, v74
v_add_f32 v60, v60, v75
v_add_f32 v61, v61, v76
v_add_f32 v61, v61, v77
v_add_f32 v61, v61, v78
v_add_f32 v61, v61, v79
CV 96,64
CV 97,66
CV 100,68
CV 101,70
CV 98,72
CV 99,74
CV 102,76
CV 103,78
s_add_u32 m0, s78, 0
s_add_u32 s92, s94, 0
G 56,36,92,0
G 57,36,92,1
G 56,36,92,2
G 57,36,92,3
s_add_u32 m0, s78, 4096
s_add_u32 s92, s94, 512
G 56,36,92,0
G 57,36,92,1
G 56,36,92,2
G 57,36,92,3
s_waitcnt vmcnt(0)
v_and_b32 v0, 0x1fff, v16
v_add_u32 v0, s78, v0
T 32,0,0
T 34,0,4
v_and_b32 v0, 0x1fff, v17
v_add_u32 v0, s78, v0
T 36,0,0
T 38,0,4
v_and_b32 v0, 0x1fff, v18
v_add_u32 v0, s78, v0
T 40,0,0
T 42,0,4
v_and_b32 v0, 0x1fff, v19
v_add_u32 v0, s78, v0
T 44,0,0
T 46,0,4
v_and_b32 v0, 0x1fff, v20
v_add_u32 v0, s78, v0
T 48,0,0
T 50,0,4
v_and_b32 v0, 0x1fff, v21
v_add_u32 v0, s78, v0
T 52,0,0
T 54,0,4
v_and_b32 v0, 0x1fff, v22
v_add_u32 v0, s78, v0
T 56,0,0
T 58,0,4
v_and_b32 v0, 0x1fff, v23
v_add_u32 v0, s78, v0
T 60,0,0
W 14
T 62,0,4
W 14
MA 128,32,96
MA 132,32,100
W 12
MA 136,36,96
MA 140,36,100
W 10
MA 144,40,96
MA 148,40,100
W 8
MA 152,44,96
MA 156,44,100
W 6
MA 160,48,96
MA 164,48,100
W 4
MA 168,52,96
MA 172,52,100
W 2
MA 176,56,96
MA 180,56,100
W 0
MA 184,60,96
MA 188,60,100
s_nop 15
s_or_b32 s81, s81, 0x7ffe8fff
s_add_u32 s81, s81, 1
s_and_b32 s81, s81, 0x17000
s_add_u32 s94, s80, s81
s_cmp_lg_u32 s81, 0
s_cbranch_scc1 L_slow2_c2B0
v_mov_b32 v1, v60
s_nop 1
v_permlane32_swap_b32 v1, v60
v_add_f32 v60, v60, v1
v_mov_b32 v1, v60
s_nop 1
v_permlane16_swap_b32 v1, v60
v_add_f32 v60, v60, v1
v_mov_b32 v1, v61
s_nop 1
v_permlane32_swap_b32 v1, v61
v_add_f32 v61, v61, v1
v_mov_b32 v1, v61
s_nop 1
v_permlane16_swap_b32 v1, v61
v_add_f32 v61, v61, v1
s_mov_b32 m0, s93
s_nop 4
s_branch L_back_c2B0
L_slow_c2B1:
s_waitcnt vmcnt(0) lgkmcnt(0)
s_nop 15
s_mov_b32 s93, m0
s_andn2_b32 s80, s63, 0x1ff00
s_xor_b32 s80, s80, 0x40000
v_mov_b32 v62, 0xff800000
v_mov_b32 v63, 0xff800000
s_mov_b32 s94, s80
s_mov_b32 s81, 0
L_slow1_c2B1:
s_add_u32 m0, s78, 0
s_add_u32 s92, s94, 0
G 32,32,92,0
G 33,32,92,1
G 34,32,92,2
G 35,32,92,3
s_add_u32 m0, s78, 4096
s_add_u32 s92, s94, 512
G 32,32,92,0
G 33,32,92,1
G 34,32,92,2
G 35,32,92,3
s_waitcnt vmcnt(0)
v_and_b32 v0, 0x1fff, v8
v_add_u32 v0, s78, v0
R a,32,0,0
R a,48,0,4
v_and_b32 v0, 0x1fff, v9
v_add_u32 v0, s78, v0
R a,36,0,0
R a,52,0,4
v_and_b32 v0, 0x1fff, v10
v_add_u32 v0, s78, v0
R a,40,0,0
R a,56,0,4
v_and_b32 v0, 0x1fff, v11
v_add_u32 v0, s78, v0
R a,44,0,0
R a,60,0,4
W 7
ZB 64,32,160
ZB 68,32,164
W 5
MB 64,36,168
MB 68,36,172
W 3
MB 64,40,176
MB 68,40,180
W 1
MB 64,44,184
MB 68,44,188
ZB 72,48,160
ZB 76,48,164
MB 72,52,168
MB 76,52,172
MB 72,56,176
MB 76,56,180
W 0
MB 72,60,184
MB 76,60,188
v_max_f32 v62, v62, v64
v_max_f32 v62, v62, v65
v_max_f32 v62, v62, v66
v_max_f32 v62, v62, v67
v_max_f32 v63, v63, v68
v_max_f32 v63, v63, v69
v_max_f32 v63, v63, v70
v_max_f32 v63, v63, v71
v_max_f32 v62, v62, v72
v_max_f32 v62, v62, v73
v_max_f32 v62, v62, v74
v_max_f32 v62, v62, v75
v_max_f32 v63, v63, v76
v_max_f32 v63, v63, v77
v_max_f32 v63, v63, v78
v_max_f32 v63, v63, v79
s_or_b32 s81, s81, 0x7ffe8fff
s_add_u32 s81, s81, 1
s_and_b32 s81, s81, 0x17000
s_add_u32 s94, s80, s81
s_cmp_lg_u32 s81, 0
s_cbranch_scc1 L_slow1_c2B1
v_mov_b32 v1, v62
s_nop 1
v_permlane32_swap_b32 v1, v62
v_max_f32 v62, v62, v1
v_mov_b32 v1, v62
s_nop 1
v_permlane16_swap_b32 v1, v62
v_max_f32 v62, v62, v1
v_mov_b32 v1, v63
s_nop 1
v_permlane32_swap_b32 v1, v63
v_max_f32 v63, v63, v1
v_mov_b32 v1, v63
s_nop 1
v_permlane16_swap_b32 v1, v63
v_max_f32 v63, v63, v1
v_mov_b32 v60, 0
v_mov_b32 v61, 0
v_accvgpr_write_b32 a192, 0
v_accvgpr_write_b32 a193, 0
v_accvgpr_write_b32 a194, 0
v_accvgpr_write_b32 a195, 0
v_accvgpr_write_b32 a196, 0
v_accvgpr_write_b32 a197, 0
v_accvgpr_write_b32 a198, 0
v_accvgpr_write_b32 a199, 0
v_accvgpr_write_b32 a200, 0
v_accvgpr_write_b32 a201, 0
v_accvgpr_write_b32 a202, 0
v_accvgpr_write_b32 a203, 0
v_accvgpr_write_b32 a204, 0
v_accvgpr_write_b32 a205, 0
v_accvgpr_write_b32 a206, 0
v_accvgpr_write_b32 a207, 0
v_accvgpr_write_b32 a208, 0
v_accvgpr_write_b32 a209, 0
v_accvgpr_write_b32 a210, 0
v_accvgpr_write_b32 a211, 0
v_accvgpr_write_b32 a212, 0
v_accvgpr_write_b32 a213, 0
v_accvgpr_write_b32 a214, 0
v_accvgpr_write_b32 a215, 0
v_accvgpr_write_b32 a216, 0
v_accvgpr_write_b32 a217, 0
v_accvgpr_write_b32 a218, 0
v_accvgpr_write_b32 a219, 0
v_accvgpr_write_b32 a220, 0
v_accvgpr_write_b32 a221, 0
v_accvgpr_write_b32 a222, 0
v_accvgpr_write_b32 a223, 0
v_accvgpr_write_b32 a64, 0
v_accvgpr_write_b32 a65, 0
v_accvgpr_write_b32 a66, 0
v_accvgpr_write_b32 a67, 0
v_accvgpr_write_b32 a68, 0
v_accvgpr_write_b32 a69, 0
v_accvgpr_write_b32 a70, 0
v_accvgpr_write_b32 a71, 0
v_accvgpr_write_b32 a72, 0
v_accvgpr_write_b32 a73, 0
v_accvgpr_write_b32 a74, 0
v_accvgpr_write_b32 a75, 0
v_accvgpr_write_b32 a76, 0
v_accvgpr_write_b32 a77, 0
v_accvgpr_write_b32 a78, 0
v_accvgpr_write_b32 a79, 0
v_accvgpr_write_b32 a80, 0
v_accvgpr_write_b32 a81, 0
v_accvgpr_write_b32 a82, 0
v_accvgpr_write_b32 a83, 0
v_accvgpr_write_b32 a84, 0
v_accvgpr_write_b32 a85, 0
v_accvgpr_write_b32 a86, 0
v_accvgpr_write_b32 a87, 0
v_accvgpr_write_b32 a88, 0
v_accvgpr_write_b32 a89, 0
v_accvgpr_write_b32 a90, 0
v_accvgpr_write_b32 a91, 0
v_accvgpr_write_b32 a92, 0
v_accvgpr_write_b32 a93, 0
v_accvgpr_write_b32 a94, 0
v_accvgpr_write_b32 a95, 0
s_mov_b32 s94, s80
s_mov_b32 s81, 0
s_nop 4
L_slow2_c2B1:
s_add_u32 m0, s78, 0
s_add_u32 s92, s94, 0
G 32,32,92,0
G 33,32,92,1
G 34,32,92,2
G 35,32,92,3
s_add_u32 m0, s78, 4096
s_add_u32 s92, s94, 512
G 32,32,92,0
G 33,32,92,1
G 34,32,92,2
G 35,32,92,3
s_waitcnt vmcnt(0)
v_and_b32 v0, 0x1fff, v8
v_add_u32 v0, s78, v0
R a,32,0,0
R a,48,0,4
v_and_b32 v0, 0x1fff, v9
v_add_u32 v0, s78, v0
R a,36,0,0
R a,52,0,4
v_and_b32 v0, 0x1fff, v10
v_add_u32 v0, s78, v0
R a,40,0,0
R a,56,0,4
v_and_b32 v0, 0x1fff, v11
v_add_u32 v0, s78, v0
R a,44,0,0
R a,60,0,4
W 7
ZB 64,32,160
ZB 68,32,164
W 5
MB 64,36,168
MB 68,36,172
W 3
MB 64,40,176
MB 68,40,180
W 1
MB 64,44,184
MB 68,44,188
ZB 72,48,160
ZB 76,48,164
MB 72,52,168
MB 76,52,172
MB 72,56,176
MB 76,56,180
W 0
MB 72,60,184
MB 76,60,188
v_sub_f32 v64, v64, v62
v_sub_f32 v65, v65, v62
v_sub_f32 v66, v66, v62
v_sub_f32 v67, v67, v62
v_sub_f32 v68, v68, v63
v_sub_f32 v69, v69, v63
v_sub_f32 v70, v70, v63
v_sub_f32 v71, v71, v63
v_sub_f32 v72, v72, v62
v_sub_f32 v73, v73, v62
v_sub_f32 v74, v74, v62
v_sub_f32 v75, v75, v62
v_sub_f32 v76, v76, v63
v_sub_f32 v77, v77, v63
v_sub_f32 v78, v78, v63
v_sub_f32 v79, v79, v63
E 64
E 65
E 66
E 67
E 68
E 69
E 70
E 71
E 72
E 73
E 74
E 75
E 76
E 77
E 78
E 79
v_add_f32 v60, v60, v64
v_add_f32 v60, v60, v65
v_add_f32 v60, v60, v66
v_add_f32 v60, v60, v67
v_add_f32 v61, v61, v68
v_add_f32 v61, v61, v69
v_add_f32 v61, v61, v70
v_add_f32 v61, v61, v71
v_add_f32 v60, v60, v72
v_add_f32 v60, v60, v73
v_add_f32 v60, v60, v74
v_add_f32 v60, v60, v75
v_add_f32 v61, v61, v76
v_add_f32 v61, v61, v77
v_add_f32 v61, v61, v78
v_add_f32 v61, v61, v79
CV 96,64
CV 97,66
CV 100,68
CV 101,70
CV 98,72
CV 99,74
CV 102,76
CV 103,78
s_add_u32 m0, s78, 0
s_add_u32 s92, s94, 0
G 56,36,92,0
G 57,36,92,1
G 56,36,92,2
G 57,36,92,3
s_add_u32 m0, s78, 4096
s_add_u32 s92, s94, 512
G 56,36,92,0
G 57,36,92,1
G 56,36,92,2
G 57,36,92,3
s_waitcnt vmcnt(0)
v_and_b32 v0, 0x1fff, v16
v_add_u32 v0, s78, v0
T 32,0,0
T 34,0,4
v_and_b32 v0, 0x1fff, v17
v_add_u32 v0, s78, v0
T 36,0,0
T 38,0,4
v_and_b32 v0, 0x1fff, v18
v_add_u32 v0, s78, v0
T 40,0,0
T 42,0,4
v_and_b32 v0, 0x1fff, v19
v_add_u32 v0, s78, v0
T 44,0,0
T 46,0,4
v_and_b32 v0, 0x1fff, v20
v_add_u32 v0, s78, v0
T 48,0,0
T 50,0,4
v_and_b32 v0, 0x1fff, v21
v_add_u32 v0, s78, v0
T 52,0,0
T 54,0,4
v_and_b32 v0, 0x1fff, v22
v_add_u32 v0, s78, v0
T 56,0,0
T 58,0,4
v_and_b32 v0, 0x1fff, v23
v_add_u32 v0, s78, v0
T 60,0,0
W 14
T 62,0,4
W 14
MC 192,32,96
MC 196,32,100
W 12
MC 200,36,96
MC 204,36,100
W 10
MC 208,40,96
MC 212,40,100
W 8
MC 216,44,96
MC 220,44,100
W 6
MC 64,48,96
MC 68,48,100
W 4
MC 72,52,96
MC 76,52,100
W 2
MC 80,56,96
MC 84,56,100
W 0
MC 88,60,96
MC 92,60,100
s_nop 15
s_or_b32 s81, s81, 0x7ffe8fff
s_add_u32 s81, s81, 1
s_and_b32 s81, s81, 0x17000
s_add_u32 s94, s80, s81
s_cmp_lg_u32 s81, 0
s_cbranch_scc1 L_slow2_c2B1
v_mov_b32 v1, v60
s_nop 1
v_permlane32_swap_b32 v1, v60
v_add_f32 v60, v60, v1
v_mov_b32 v1, v60
s_nop 1
v_permlane16_swap_b32 v1, v60
v_add_f32 v60, v60, v1
v_mov_b32 v1, v61
s_nop 1
v_permlane32_swap_b32 v1, v61
v_add_f32 v61, v61, v1
v_mov_b32 v1, v61
s_nop 1
v_permlane16_swap_b32 v1, v61
v_add_f32 v61, v61, v1
s_mov_b32 m0, s93
s_nop 4
s_branch L_back_c2B1
L_wi_c2:
s_sleep 6
v_mov_b32 v62, 0
buffer_load_dword v4, v62, s[96:99], s87 offen sc1
s_waitcnt vmcnt(0)
s_add_u32 s6, s6, 1
s_cmp_ge_u32 s6, 0x100000
s_cbranch_scc1 L_gi_c2
s_branch L_ci_c2
L_we_c2:
s_sleep 6
buffer_load_dword v3, v7, s[52:55], s72 offen offset:0 sc1
buffer_load_dword v4, v7, s[52:55], s72 offen offset:128 sc1
s_waitcnt vmcnt(0)
s_add_u32 s6, s6, 1
s_cmp_ge_u32 s6, 0x100000
s_cbranch_scc1 L_ge_c2
s_branch L_ce_c2
L_wm_c2:
s_sleep 6
buffer_load_dword v0, v7, s[52:55], s72 offen offset:256 sc1
s_waitcnt vmcnt(0)
s_add_u32 s6, s6, 1
s_cmp_ge_u32 s6, 0x100000
s_cbranch_scc1 L_gm_c2
s_branch L_cm_c2
L_wl_c2:
s_sleep 6
buffer_load_dword v4, v7, s[52:55], s72 offen offset:384 sc1
s_waitcnt vmcnt(0)
s_add_u32 s6, s6, 1
s_cmp_ge_u32 s6, 0x100000
s_cbranch_scc1 L_gl_c2
s_branch L_cl_c2
.p2align 6
L_prog3:
s_waitcnt vmcnt(12)
s_barrier
R v,128,8,0
R v,132,8,4
R v,136,9,0
R v,140,9,4
R v,144,10,0
R v,148,10,4
R v,152,11,0
R v,156,11,4
T 0,16,16
T 2,16,20
T 4,17,16
T 6,17,20
T 8,18,16
T 10,18,20
T 12,19,16
W 14
T 14,19,20
W 14
T 16,20,16
W 14
T 18,20,20
s_xor_b32 m0, s65, 0x14000
s_xor_b32 s66, s61, 0xc0000
G 40,40,66,0
G 41,40,66,1
W 6
ZA 64,0,128
G 42,40,66,2
ZA 68,0,132
G 43,40,66,3
T 20,21,16
T 22,21,20
ZA 72,4,128
s_xor_b32 m0, s65, 0x18000
s_xor_b32 s66, s61, 0x100000
G 40,40,66,0
ZA 76,4,132
G 41,40,66,1
T 24,22,16
T 26,22,20
W 6
ZA 80,8,128
G 42,40,66,2
ZA 84,8,132
G 43,40,66,3
T 28,23,16
T 30,23,20
ZA 88,12,128
s_waitcnt vmcnt(16)
s_barrier
T 32,16,32
ZA 92,12,132
T 34,16,36
s_xor_b32 m0, s65, 0x1c000
s_xor_b32 s66, s61, 0x140000
W 6
ZA 96,16,128
G 40,40,66,0
ZA 100,16,132
T 36,17,32
T 38,17,36
ZA 104,20,128
G 41,40,66,1
ZA 108,20,132
T 40,18,32
T 42,18,36
W 6
ZA 112,24,128
G 42,40,66,2
ZA 116,24,132
T 44,19,32
T 46,19,36
ZA 120,28,128
G 43,40,66,3
ZA 124,28,132
T 48,20,32
T 50,20,36
W 6
MA 64,32,136
s_waitcnt vmcnt(16)
s_barrier
s_xor_b32 m0, s65, 0x0
s_xor_b32 s66, s60, 0x200
G 36,28,66,0
MA 68,32,140
G 37,28,66,1
T 52,21,32
T 54,21,36
R v,160,8,48
MA 72,36,136
G 38,28,66,2
MA 76,36,140
T 56,22,32
T 58,22,36
R v,164,8,52
W 8
MA 80,40,136
G 39,28,66,3
MA 84,40,140
T 60,23,32
T 62,23,36
R v,168,9,48
MA 88,44,136
s_waitcnt vmcnt(16)
s_barrier
MA 92,44,140
R v,172,9,52
T 0,24,0
T 2,24,4
W 10
MA 96,48,136
R v,176,10,48
MA 100,48,140
T 4,25,0
T 6,25,4
MA 104,52,136
R v,180,10,52
MA 108,52,140
T 8,26,0
W 14
T 10,26,4
W 10
MA 112,56,136
R v,184,11,48
MA 116,56,140
T 12,27,0
T 14,27,4
MA 120,60,136
R v,188,11,52
MA 124,60,140
T 16,28,0
W 14
T 18,28,4
W 9
MA 64,0,144
T 20,29,0
MA 68,0,148
T 22,29,4
MA 72,4,144
T 24,30,0
MA 76,4,148
T 26,30,4
W 7
MA 80,8,144
T 28,31,0
MA 84,8,148
T 30,31,4
MA 88,12,144
s_waitcnt vmcnt(12) lgkmcnt(8)
s_barrier
s_xor_b32 m0, s65, 0x4000
s_xor_b32 s66, s61, 0x180000
MA 92,12,148
G 40,40,66,0
T 32,24,16
T 34,24,20
W 6
MA 96,16,144
G 41,40,66,1
MA 100,16,148
T 36,25,16
T 38,25,20
MA 104,20,144
G 42,40,66,2
MA 108,20,148
T 40,26,16
T 42,26,20
v_mov_b32 v61, 0
v_lshlrev_b32 v62, 3, v59
s_mov_b64 exec, 15
buffer_store_dword v61, v62, s[52:55], s5 offen sc1
s_mov_b64 exec, -1
W 6
MA 112,24,144
G 43,40,66,3
MA 116,24,148
T 44,27,16
T 46,27,20
MA 120,28,144
s_xor_b32 m0, s65, 0x8000
s_xor_b32 s66, s61, 0x1c0000
MA 124,28,148
G 40,40,66,0
T 48,28,16
T 50,28,20
W 6
MA 64,32,152
G 41,40,66,1
MA 68,32,156
T 52,29,16
T 54,29,20
MA 72,36,152
G 42,40,66,2
MA 76,36,156
T 56,30,16
T 58,30,20
W 6
MA 80,40,152
G 43,40,66,3
MA 84,40,156
T 60,31,16
T 62,31,20
MA 88,44,152
s_waitcnt vmcnt(17)
s_barrier
T 0,24,32
MA 92,44,156
T 2,24,36
s_xor_b32 m0, s65, 0xc000
s_xor_b32 s66, s61, 0x200000
W 6
MA 96,48,152
G 40,40,66,0
MA 100,48,156
T 4,25,32
T 6,25,36
MA 104,52,152
T 8,26,32
MA 108,52,156
T 10,26,36
W 6
MA 112,56,152
G 41,40,66,1
MA 116,56,156
T 12,27,32
T 14,27,36
MA 120,60,152
T 16,28,32
MA 124,60,156
T 18,28,36
W 6
MA 64,0,160
G 42,40,66,2
MA 68,0,164
T 20,29,32
T 22,29,36
MA 72,4,160
T 24,30,32
MA 76,4,164
T 26,30,36
W 6
MA 80,8,160
G 43,40,66,3
MA 84,8,164
T 28,31,32
T 30,31,36
MA 88,12,160
s_waitcnt vmcnt(17)
s_barrier
T 32,24,48
MA 92,12,164
T 34,24,52
s_xor_b32 m0, s65, 0x10000
s_xor_b32 s66, s61, 0x240000
W 6
MA 96,16,160
G 40,40,66,0
MA 100,16,164
T 36,25,48
T 38,25,52
MA 104,20,160
G 41,40,66,1
MA 108,20,164
T 40,26,48
T 42,26,52
W 6
MA 112,24,160
G 42,40,66,2
MA 116,24,164
T 44,27,48
T 46,27,52
MA 120,28,160
G 43,40,66,3
MA 124,28,164
T 48,28,48
T 50,28,52
W 6
MA 64,32,168
s_waitcnt vmcnt(17)
s_barrier
s_xor_b32 m0, s65, 0x14000
s_xor_b32 s66, s60, 0x300
G 36,28,66,0
MA 68,32,172
G 37,28,66,1
T 52,29,48
T 54,29,52
R v,192,8,0
MA 72,36,168
G 38,28,66,2
MA 76,36,172
T 56,30,48
T 58,30,52
R v,196,8,4
W 8
MA 80,40,168
G 39,28,66,3
MA 84,40,172
T 60,31,48
T 62,31,52
R v,200,9,0
MA 88,44,168
s_waitcnt vmcnt(16)
s_barrier
MA 92,44,172
R v,204,9,4
T 0,16,16
T 2,16,20
W 10
MA 96,48,168
R v,208,10,0
MA 100,48,172
T 4,17,16
T 6,17,20
MA 104,52,168
R v,212,10,4
MA 108,52,172
T 8,18,16
W 14
T 10,18,20
W 10
MA 112,56,168
R v,216,11,0
MA 116,56,172
T 12,19,16
T 14,19,20
MA 120,60,168
R v,220,11,4
MA 124,60,172
T 16,20,16
W 14
T 18,20,20
W 9
MA 64,0,176
T 20,21,16
MA 68,0,180
T 22,21,20
MA 72,4,176
T 24,22,16
MA 76,4,180
T 26,22,20
W 7
MA 80,8,176
T 28,23,16
MA 84,8,180
T 30,23,20
MA 88,12,176
s_waitcnt vmcnt(12) lgkmcnt(8)
s_barrier
s_xor_b32 m0, s65, 0x18000
s_xor_b32 s66, s61, 0x280000
MA 92,12,180
G 40,40,66,0
T 32,16,32
T 34,16,36
W 6
MA 96,16,176
G 41,40,66,1
MA 100,16,180
T 36,17,32
T 38,17,36
MA 104,20,176
G 42,40,66,2
MA 108,20,180
T 40,18,32
T 42,18,36
W 6
MA 112,24,176
G 43,40,66,3
MA 116,24,180
T 44,19,32
T 46,19,36
MA 120,28,176
s_xor_b32 m0, s65, 0x1c000
s_xor_b32 s66, s61, 0x2c0000
MA 124,28,180
G 40,40,66,0
T 48,20,32
T 50,20,36
W 6
MA 64,32,184
G 41,40,66,1
MA 68,32,188
T 52,21,32
T 54,21,36
MA 72,36,184
G 42,40,66,2
MA 76,36,188
T 56,22,32
T 58,22,36
W 6
MA 80,40,184
G 43,40,66,3
MA 84,40,188
T 60,23,32
T 62,23,36
MA 88,44,184
s_waitcnt vmcnt(16)
s_barrier
T 0,16,48
MA 92,44,188
T 2,16,52
s_xor_b32 m0, s65, 0x0
s_xor_b32 s66, s61, 0x300000
W 6
MA 96,48,184
G 40,40,66,0
MA 100,48,188
T 4,17,48
T 6,17,52
MA 104,52,184
T 8,18,48
MA 108,52,188
T 10,18,52
W 6
MA 112,56,184
G 41,40,66,1
MA 116,56,188
T 12,19,48
T 14,19,52
MA 120,60,184
T 16,20,48
MA 124,60,188
T 18,20,52
W 6
MA 64,0,192
G 42,40,66,2
MA 68,0,196
T 20,21,48
T 22,21,52
MA 72,4,192
T 24,22,48
MA 76,4,196
T 26,22,52
W 6
MA 80,8,192
G 43,40,66,3
MA 84,8,196
T 28,23,48
T 30,23,52
MA 88,12,192
s_waitcnt vmcnt(16)
s_barrier
T 32,24,0
MA 92,12,196
T 34,24,4
s_xor_b32 m0, s65, 0x4000
s_xor_b32 s66, s61, 0x340000
W 6
MA 96,16,192
G 40,40,66,0
MA 100,16,196
T 36,25,0
T 38,25,4
MA 104,20,192
G 41,40,66,1
MA 108,20,196
T 40,26,0
T 42,26,4
v_mov_b32 v61, 1
v_mov_b32 v62, 0
s_mov_b64 exec, 1
buffer_atomic_add v61, v62, s[96:99], s86 offen sc1
s_mov_b64 exec, -1
s_mov_b32 s6, 0
W 6
MA 112,24,192
G 42,40,66,2
MA 116,24,196
T 44,27,0
T 46,27,4
MA 120,28,192
G 43,40,66,3
MA 124,28,196
T 48,28,0
T 50,28,4
W 6
MA 64,32,200
s_waitcnt vmcnt(17)
s_barrier
s_xor_b32 m0, s65, 0x8000
s_xor_b32 s66, s61, 0x380000
G 40,40,66,0
MA 68,32,204
G 41,40,66,1
T 52,29,0
T 54,29,4
R v,224,12,16
MA 72,36,200
G 42,40,66,2
MA 76,36,204
T 56,30,0
T 58,30,4
R v,228,12,20
W 8
MA 80,40,200
G 43,40,66,3
MA 84,40,204
T 60,31,0
T 62,31,4
R v,232,13,16
MA 88,44,200
s_waitcnt vmcnt(17)
s_barrier
MA 92,44,204
R v,236,13,20
T 0,24,32
T 2,24,36
W 10
MA 96,48,200
R v,240,14,16
MA 100,48,204
T 4,25,32
T 6,25,36
MA 104,52,200
R v,244,14,20
MA 108,52,204
T 8,26,32
W 14
T 10,26,36
W 10
MA 112,56,200
R v,248,15,16
MA 116,56,204
T 12,27,32
T 14,27,36
MA 120,60,200
R v,252,15,20
T 16,28,32
MA 124,60,204
W 14
T 18,28,36
v_xor_b32 v8, s70, v8
W 9
MA 64,0,208
T 20,29,32
MA 68,0,212
T 22,29,36
v_xor_b32 v9, s70, v9
MA 72,4,208
T 24,30,32
MA 76,4,212
T 26,30,36
v_xor_b32 v10, s70, v10
W 7
MA 80,8,208
T 28,31,32
MA 84,8,212
T 30,31,36
v_xor_b32 v11, s70, v11
MA 88,12,208
s_waitcnt vmcnt(13) lgkmcnt(8)
s_barrier
s_xor_b32 m0, s65, 0xc000
s_xor_b32 s66, s61, 0x3c0000
MA 92,12,212
G 40,40,66,0
T 32,24,48
T 34,24,52
v_xor_b32 v12, s70, v12
W 6
MA 96,16,208
G 41,40,66,1
MA 100,16,212
T 36,25,48
T 38,25,52
v_xor_b32 v13, s70, v13
MA 104,20,208
G 42,40,66,2
MA 108,20,212
T 40,26,48
T 42,26,52
v_xor_b32 v14, s70, v14
W 6
MA 112,24,208
G 43,40,66,3
MA 116,24,212
T 44,27,48
T 46,27,52
v_xor_b32 v15, s70, v15
MA 120,28,208
s_xor_b32 m0, s65, 0x10000
s_xor_b32 s66, s63, 0x0
MA 124,28,212
G 32,32,66,0,nt
T 48,28,48
T 50,28,52
W 6
MA 64,32,216
G 33,32,66,1,nt
MA 68,32,220
T 52,29,48
T 54,29,52
MA 72,36,216
G 34,32,66,2,nt
MA 76,36,220
T 56,30,48
T 58,30,52
W 6
MA 80,40,216
G 35,32,66,3,nt
MA 84,40,220
T 60,31,48
T 62,31,52
MA 88,44,216
s_waitcnt vmcnt(17)
s_barrier
T 0,16,0
MA 92,44,220
T 2,16,4
s_xor_b32 m0, s65, 0x14000
s_xor_b32 s66, s63, 0x10000
W 6
MA 96,48,216
G 32,32,66,0,nt
MA 100,48,220
T 4,17,0
T 6,17,4
MA 104,52,216
T 8,18,0
MA 108,52,220
T 10,18,4
W 6
MA 112,56,216
G 33,32,66,1,nt
MA 116,56,220
T 12,19,0
T 14,19,4
MA 120,60,216
T 16,20,0
MA 124,60,220
T 18,20,4
W 6
MA 64,0,224
G 34,32,66,2,nt
MA 68,0,228
T 20,21,0
T 22,21,4
MA 72,4,224
T 24,22,0
MA 76,4,228
T 26,22,4
W 6
MA 80,8,224
G 35,32,66,3,nt
MA 84,8,228
T 28,23,0
T 30,23,4
MA 88,12,224
s_waitcnt vmcnt(16)
s_barrier
T 32,16,16
MA 92,12,228
T 34,16,20
s_xor_b32 m0, s65, 0x18000
s_xor_b32 s66, s63, 0x0
W 6
MA 96,16,224
G 56,36,66,0,nt
MA 100,16,228
T 36,17,16
T 38,17,20
MA 104,20,224
T 40,18,16
MA 108,20,228
T 42,18,20
W 6
MA 112,24,224
G 57,36,66,1,nt
MA 116,24,228
T 44,19,16
T 46,19,20
MA 120,28,224
T 48,20,16
MA 124,28,228
T 50,20,20
W 6
MA 64,32,232
G 56,36,66,2,nt
MA 68,32,236
T 52,21,16
T 54,21,20
MA 72,36,232
T 56,22,16
MA 76,36,236
T 58,22,20
W 6
MA 80,40,232
G 57,36,66,3,nt
MA 84,40,236
T 60,23,16
T 62,23,20
MA 88,44,232
s_waitcnt vmcnt(16)
s_barrier
T 0,16,32
MA 92,44,236
T 2,16,36
s_xor_b32 m0, s65, 0x1c000
s_xor_b32 s66, s63, 0x4000
W 6
MA 96,48,232
G 32,32,66,0,nt
MA 100,48,236
T 4,17,32
T 6,17,36
MA 104,52,232
T 8,18,32
MA 108,52,236
T 10,18,36
W 6
MA 112,56,232
G 33,32,66,1,nt
MA 116,56,236
T 12,19,32
T 14,19,36
MA 120,60,232
T 16,20,32
MA 124,60,236
T 18,20,36
W 6
MA 64,0,240
G 34,32,66,2,nt
MA 68,0,244
T 20,21,32
T 22,21,36
MA 72,4,240
T 24,22,32
MA 76,4,244
T 26,22,36
W 6
MA 80,8,240
G 35,32,66,3,nt
MA 84,8,244
T 28,23,32
T 30,23,36
MA 88,12,240
s_waitcnt vmcnt(16)
s_barrier
MA 92,12,244
T 32,16,48
T 34,16,52
W 6
MA 96,16,240
T 36,17,48
MA 100,16,244
T 38,17,52
MA 104,20,240
T 40,18,48
MA 108,20,244
T 42,18,52
W 6
MA 112,24,240
T 44,19,48
MA 116,24,244
T 46,19,52
MA 120,28,240
T 48,20,48
MA 124,28,244
T 50,20,52
W 6
MA 64,32,248
T 52,21,48
MA 68,32,252
T 54,21,52
MA 72,36,248
T 56,22,48
MA 76,36,252
T 58,22,52
W 6
MA 80,40,248
T 60,23,48
MA 84,40,252
T 62,23,52
MA 88,44,248
s_waitcnt vmcnt(12)
s_barrier
MA 92,44,252
R a,0,12,0
s_xor_b32 m0, s65, 0x0
s_xor_b32 s66, s63, 0x10000
W 5
MA 96,48,248
G 56,36,66,0,nt
MA 100,48,252
R a,4,13,0
MA 104,52,248
R a,8,14,0
MA 108,52,252
W 3
MA 112,56,248
G 57,36,66,1,nt
MA 116,56,252
R a,12,15,0
MA 120,60,248
R a,16,12,4
MA 124,60,252
v_pk_mul_f32 v[64:65], v[64:65], s[74:75]
v_pk_mul_f32 v[66:67], v[66:67], s[74:75]
v_pk_mul_f32 v[68:69], v[68:69], s[74:75]
v_pk_mul_f32 v[70:71], v[70:71], s[74:75]
v_pk_mul_f32 v[72:73], v[72:73], s[74:75]
v_pk_mul_f32 v[74:75], v[74:75], s[74:75]
v_pk_mul_f32 v[76:77], v[76:77], s[74:75]
v_pk_mul_f32 v[78:79], v[78:79], s[74:75]
CV 64,64
CV 66,66
CV 68,68
CV 70,70
CV 72,72
CV 74,74
CV 76,76
CV 78,78
v_permlane32_swap_b32 v64, v72
v_permlane32_swap_b32 v66, v74
v_permlane32_swap_b32 v68, v76
v_permlane32_swap_b32 v70, v78
v_permlane16_swap_b32 v64, v72
v_permlane16_swap_b32 v66, v74
v_permlane16_swap_b32 v68, v76
v_permlane16_swap_b32 v70, v78
AW 64,64
AW 65,66
AW 66,72
AW 67,74
AW 68,68
AW 69,70
AW 70,76
AW 71,78
v_pk_mul_f32 v[80:81], v[80:81], s[74:75]
v_pk_mul_f32 v[82:83], v[82:83], s[74:75]
v_pk_mul_f32 v[84:85], v[84:85], s[74:75]
v_pk_mul_f32 v[86:87], v[86:87], s[74:75]
v_pk_mul_f32 v[88:89], v[88:89], s[74:75]
v_pk_mul_f32 v[90:91], v[90:91], s[74:75]
v_pk_mul_f32 v[92:93], v[92:93], s[74:75]
v_pk_mul_f32 v[94:95], v[94:95], s[74:75]
CV 80,80
CV 82,82
CV 84,84
CV 86,86
CV 88,88
CV 90,90
CV 92,92
CV 94,94
v_permlane32_swap_b32 v80, v88
v_permlane32_swap_b32 v82, v90
v_permlane32_swap_b32 v84, v92
v_permlane32_swap_b32 v86, v94
v_permlane16_swap_b32 v80, v88
v_permlane16_swap_b32 v82, v90
v_permlane16_swap_b32 v84, v92
v_permlane16_swap_b32 v86, v94
AW 72,80
AW 73,82
AW 74,88
AW 75,90
AW 76,84
AW 77,86
AW 78,92
AW 79,94
v_pk_mul_f32 v[96:97], v[96:97], s[74:75]
v_pk_mul_f32 v[98:99], v[98:99], s[74:75]
v_pk_mul_f32 v[100:101], v[100:101], s[74:75]
v_pk_mul_f32 v[102:103], v[102:103], s[74:75]
v_pk_mul_f32 v[104:105], v[104:105], s[74:75]
v_pk_mul_f32 v[106:107], v[106:107], s[74:75]
v_pk_mul_f32 v[108:109], v[108:109], s[74:75]
v_pk_mul_f32 v[110:111], v[110:111], s[74:75]
CV 96,96
CV 98,98
CV 100,100
CV 102,102
CV 104,104
CV 106,106
CV 108,108
CV 110,110
v_permlane32_swap_b32 v96, v104
v_permlane32_swap_b32 v98, v106
v_permlane32_swap_b32 v100, v108
v_permlane32_swap_b32 v102, v110
v_permlane16_swap_b32 v96, v104
v_permlane16_swap_b32 v98, v106
v_permlane16_swap_b32 v100, v108
v_permlane16_swap_b32 v102, v110
AW 80,96
AW 81,98
AW 82,104
AW 83,106
AW 84,100
AW 85,102
AW 86,108
AW 87,110
v_pk_mul_f32 v[112:113], v[112:113], s[74:75]
v_pk_mul_f32 v[114:115], v[114:115], s[74:75]
v_pk_mul_f32 v[116:117], v[116:117], s[74:75]
v_pk_mul_f32 v[118:119], v[118:119], s[74:75]
v_pk_mul_f32 v[120:121], v[120:121], s[74:75]
v_pk_mul_f32 v[122:123], v[122:123], s[74:75]
v_pk_mul_f32 v[124:125], v[124:125], s[74:75]
v_pk_mul_f32 v[126:127], v[126:127], s[74:75]
CV 112,112
CV 114,114
CV 116,116
CV 118,118
CV 120,120
CV 122,122
CV 124,124
CV 126,126
v_permlane32_swap_b32 v112, v120
v_permlane32_swap_b32 v114, v122
v_permlane32_swap_b32 v116, v124
v_permlane32_swap_b32 v118, v126
v_permlane16_swap_b32 v112, v120
v_permlane16_swap_b32 v114, v122
v_permlane16_swap_b32 v116, v124
v_permlane16_swap_b32 v118, v126
AW 88,112
AW 89,114
AW 90,120
AW 91,122
AW 92,116
AW 93,118
AW 94,124
AW 95,126
W 3
ZB 64,0,64
G 56,36,66,2,nt
ZB 68,0,68
R a,20,13,4
MB 64,4,72
R a,24,14,4
MB 68,4,76
W 3
MB 64,8,80
G 57,36,66,3,nt
MB 68,8,84
R a,28,15,4
MB 64,12,88
MB 68,12,92
W 2
ZB 72,16,64
ZB 76,16,68
MB 72,20,72
MB 76,20,76
W 0
MB 72,24,80
E 64
MB 76,24,84
MB 72,28,88
E 65
MB 76,28,92
CV 96,64
E 66
E 67
s_nop 0
CV 97,66
E 68
s_waitcnt vmcnt(12)
s_barrier
R a,0,12,16
E 69
s_xor_b32 m0, s65, 0x4000
s_xor_b32 s66, s63, 0x14000
R a,4,13,16
G 32,32,66,0,nt
CV 100,68
E 70
R a,8,14,16
E 71
R a,12,15,16
G 33,32,66,1,nt
CV 101,70
E 72
R a,16,12,20
E 73
W 3
ZB 80,0,64
G 34,32,66,2,nt
R a,20,13,20
ZB 84,0,68
CV 98,72
E 74
MB 80,4,72
R a,24,14,20
MB 84,4,76
E 75
W 3
MB 80,8,80
G 35,32,66,3,nt
R a,28,15,20
MB 84,8,84
CV 99,74
E 76
MB 80,12,88
s_waitcnt vmcnt(12)
s_barrier
T 32,24,32
T 34,24,36
MB 84,12,92
E 77
s_xor_b32 m0, s65, 0x8000
s_xor_b32 s66, s63, 0x4000
W 4
ZB 88,16,64
G 56,36,66,0,nt
T 36,25,32
ZB 92,16,68
T 38,25,36
CV 102,76
E 78
s_getpc_b64 s[88:89]
L_ct3_129:
s_and_b32 s89, s89, 0xffff
s_mov_b32 s90, L_code_end-L_ct3_129
s_mov_b32 s91, 0x20000
v_and_b32 v62, 0x70, v59
v_lshlrev_b32 v62, 3, v62
s_add_u32 s7, s1, 4096
buffer_load_dword v3, v62, s[88:91], s7 offen
MB 88,20,72
T 40,26,32
T 42,26,36
MB 92,20,76
E 79
W 6
MB 88,24,80
G 57,36,66,1,nt
T 44,27,32
MB 92,24,84
T 46,27,36
CV 103,78
E 80
MB 88,28,88
T 48,28,32
T 50,28,36
MB 92,28,92
E 81
W 6
ZC 96,32,96
G 56,36,66,2,nt
T 52,29,32
ZC 100,32,100
T 54,29,36
CV 104,80
E 82
ZC 104,36,96
T 56,30,32
T 58,30,36
ZC 108,36,100
E 83
W 6
ZC 112,40,96
G 57,36,66,3,nt
T 60,31,32
ZC 116,40,100
T 62,31,36
CV 105,82
E 84
ZC 120,44,96
E 85
ZC 124,44,100
W 4
ZC 128,48,96
s_waitcnt vmcnt(13)
s_barrier
R a,0,12,48
CV 108,84
ZC 132,48,100
E 86
s_xor_b32 m0, s65, 0xc000
s_xor_b32 s66, s63, 0x1000
ZC 136,52,96
G 32,32,66,0,nt
ZC 140,52,100
R a,4,13,48
E 87
W 2
ZC 144,56,96
R a,8,14,48
CV 109,86
ZC 148,56,100
E 88
ZC 152,60,96
G 33,32,66,1,nt
ZC 156,60,100
R a,12,15,48
E 89
ZD 112,52,96
R a,16,12,52
CV 106,88
ZD 116,52,100
E 90
W 3
ZB 64,0,64
G 34,32,66,2,nt
ZB 68,0,68
R a,20,13,52
E 91
MB 64,4,72
R a,24,14,52
CV 107,90
MB 68,4,76
E 92
W 3
MB 64,8,80
G 35,32,66,3,nt
MB 68,8,84
R a,28,15,52
E 93
MB 64,12,88
s_waitcnt vmcnt(13)
s_barrier
T 32,16,0
T 34,16,4
MB 68,12,92
CV 110,92
E 94
s_xor_b32 m0, s65, 0x10000
s_xor_b32 s66, s63, 0x14000
W 4
ZB 72,16,64
G 56,36,66,0,nt
T 36,17,0
ZB 76,16,68
T 38,17,4
E 95
MB 72,20,72
T 40,18,0
MB 76,20,76
T 42,18,4
CV 111,94
W 6
MB 72,24,80
G 57,36,66,1,nt
T 44,19,0
MB 76,24,84
T 46,19,4
E 64
MB 72,28,88
T 48,20,0
T 50,20,4
MB 76,28,92
E 65
W 6
MC 96,32,104
G 56,36,66,2,nt
T 52,21,0
MC 100,32,108
T 54,21,4
CV 96,64
E 66
MC 104,36,104
T 56,22,0
T 58,22,4
MC 108,36,108
E 67
W 6
MC 112,40,104
G 57,36,66,3,nt
T 60,23,0
MC 116,40,108
T 62,23,4
CV 97,66
E 68
MC 120,44,104
E 69
MC 124,44,108
W 4
MC 128,48,104
s_waitcnt vmcnt(13)
s_barrier
R a,0,8,16
CV 100,68
MC 132,48,108
E 70
s_xor_b32 m0, s65, 0x14000
s_xor_b32 s66, s63, 0x11000
MC 136,52,104
G 32,32,66,0,nt
MC 140,52,108
R a,4,9,16
E 71
W 2
MC 144,56,104
R a,8,10,16
CV 101,70
MC 148,56,108
E 72
MC 152,60,104
G 33,32,66,1,nt
MC 156,60,108
R a,12,11,16
E 73
MD 112,52,104
R a,16,8,20
CV 98,72
MD 116,52,108
E 74
W 3
ZB 80,0,64
G 34,32,66,2,nt
ZB 84,0,68
R a,20,9,20
E 75
MB 80,4,72
R a,24,10,20
CV 99,74
MB 84,4,76
E 76
W 3
MB 80,8,80
G 35,32,66,3,nt
MB 84,8,84
R a,28,11,20
E 77
MB 80,12,88
s_waitcnt vmcnt(12)
s_barrier
T 32,16,32
T 34,16,36
MB 84,12,92
CV 102,76
E 78
s_xor_b32 m0, s65, 0x18000
s_xor_b32 s66, s63, 0x1000
W 4
ZB 88,16,64
G 56,36,66,0,nt
T 36,17,32
ZB 92,16,68
T 38,17,36
E 79
MB 88,20,72
T 40,18,32
MB 92,20,76
T 42,18,36
CV 103,78
W 6
MB 88,24,80
G 57,36,66,1,nt
T 44,19,32
MB 92,24,84
T 46,19,36
E 80
MB 88,28,88
T 48,20,32
T 50,20,36
MB 92,28,92
E 81
W 6
MC 96,32,96
G 56,36,66,2,nt
T 52,21,32
MC 100,32,100
T 54,21,36
CV 104,80
E 82
MC 104,36,96
T 56,22,32
T 58,22,36
MC 108,36,100
E 83
W 6
MC 112,40,96
G 57,36,66,3,nt
T 60,23,32
MC 116,40,100
T 62,23,36
CV 105,82
E 84
MC 120,44,96
E 85
MC 124,44,100
W 4
MC 128,48,96
s_waitcnt vmcnt(12)
s_barrier
R a,0,8,48
CV 108,84
MC 132,48,100
E 86
s_xor_b32 m0, s65, 0x1c000
s_xor_b32 s66, s63, 0x5000
MC 136,52,96
G 32,32,66,0,nt
MC 140,52,100
R a,4,9,48
E 87
W 2
MC 144,56,96
R a,8,10,48
CV 109,86
MC 148,56,100
E 88
MC 152,60,96
G 33,32,66,1,nt
MC 156,60,100
R a,12,11,48
E 89
MD 112,52,96
R a,16,8,52
CV 106,88
MD 116,52,100
E 90
W 3
ZB 64,0,64
G 34,32,66,2,nt
ZB 68,0,68
R a,20,9,52
E 91
MB 64,4,72
R a,24,10,52
CV 107,90
MB 68,4,76
E 92
W 3
MB 64,8,80
G 35,32,66,3,nt
MB 68,8,84
R a,28,11,52
E 93
MB 64,12,88
s_waitcnt vmcnt(12)
s_barrier
T 32,24,0
T 34,24,4
MB 68,12,92
CV 110,92
E 94
s_xor_b32 m0, s65, 0x0
s_xor_b32 s66, s63, 0x11000
W 4
ZB 72,16,64
G 56,36,66,0,nt
T 36,25,0
ZB 76,16,68
T 38,25,4
E 95
MB 72,20,72
T 40,26,0
MB 76,20,76
T 42,26,4
CV 111,94
W 6
MB 72,24,80
G 57,36,66,1,nt
T 44,27,0
MB 76,24,84
T 46,27,4
E 64
MB 72,28,88
T 48,28,0
T 50,28,4
MB 76,28,92
E 65
W 6
MC 96,32,104
G 56,36,66,2,nt
T 52,29,0
MC 100,32,108
T 54,29,4
CV 96,64
E 66
MC 104,36,104
T 56,30,0
T 58,30,4
MC 108,36,108
E 67
W 6
MC 112,40,104
G 57,36,66,3,nt
T 60,31,0
MC 116,40,108
T 62,31,4
CV 97,66
E 68
MC 120,44,104
E 69
MC 124,44,108
W 4
MC 128,48,104
s_waitcnt vmcnt(12)
s_barrier
R a,0,12,16
CV 100,68
MC 132,48,108
E 70
s_xor_b32 m0, s65, 0x4000
s_xor_b32 s66, s63, 0x15000
MC 136,52,104
G 32,32,66,0,nt
MC 140,52,108
R a,4,13,16
E 71
W 2
MC 144,56,104
R a,8,14,16
CV 101,70
MC 148,56,108
E 72
MC 152,60,104
G 33,32,66,1,nt
MC 156,60,108
R a,12,15,16
E 73
MD 112,52,104
R a,16,12,20
CV 98,72
MD 116,52,108
E 74
W 3
ZB 80,0,64
G 34,32,66,2,nt
ZB 84,0,68
R a,20,13,20
E 75
MB 80,4,72
R a,24,14,20
CV 99,74
MB 84,4,76
E 76
W 3
MB 80,8,80
G 35,32,66,3,nt
MB 84,8,84
R a,28,15,20
E 77
MB 80,12,88
s_waitcnt vmcnt(12)
s_barrier
T 32,24,32
T 34,24,36
MB 84,12,92
CV 102,76
E 78
s_xor_b32 m0, s65, 0x8000
s_xor_b32 s66, s63, 0x5000
W 4
ZB 88,16,64
G 56,36,66,0,nt
T 36,25,32
ZB 92,16,68
T 38,25,36
E 79
MB 88,20,72
T 40,26,32
MB 92,20,76
T 42,26,36
CV 103,78
W 6
MB 88,24,80
G 57,36,66,1,nt
T 44,27,32
MB 92,24,84
T 46,27,36
E 80
MB 88,28,88
T 48,28,32
T 50,28,36
MB 92,28,92
E 81
W 6
MC 96,32,96
G 56,36,66,2,nt
T 52,29,32
MC 100,32,100
T 54,29,36
CV 104,80
E 82
MC 104,36,96
T 56,30,32
T 58,30,36
MC 108,36,100
E 83
W 6
MC 112,40,96
G 57,36,66,3,nt
T 60,31,32
MC 116,40,100
T 62,31,36
CV 105,82
E 84
MC 120,44,96
E 85
MC 124,44,100
W 4
MC 128,48,96
s_waitcnt vmcnt(12)
s_barrier
R a,0,12,48
CV 108,84
MC 132,48,100
E 86
s_xor_b32 m0, s65, 0xc000
s_xor_b32 s66, s63, 0x15000
MC 136,52,96
G 56,36,66,0,nt
MC 140,52,100
R a,4,13,48
E 87
W 2
MC 144,56,96
R a,8,14,48
CV 109,86
MC 148,56,100
E 88
MC 152,60,96
G 57,36,66,1,nt
MC 156,60,100
R a,12,15,48
E 89
MD 112,52,96
R a,16,12,52
CV 106,88
MD 116,52,100
E 90
W 3
ZB 64,0,64
G 56,36,66,2,nt
ZB 68,0,68
R a,20,13,52
E 91
MB 64,4,72
R a,24,14,52
CV 107,90
MB 68,4,76
E 92
W 3
MB 64,8,80
G 57,36,66,3,nt
MB 68,8,84
R a,28,15,52
E 93
MB 64,12,88
s_waitcnt vmcnt(12)
s_barrier
T 32,16,0
T 34,16,4
MB 68,12,92
CV 110,92
E 94
s_xor_b32 m0, s65, 0x10000
s_xor_b32 s66, s61, 0x200
W 4
ZB 72,16,64
G 40,40,66,0
T 36,17,0
ZB 76,16,68
T 38,17,4
E 95
MB 72,20,72
T 40,18,0
MB 76,20,76
T 42,18,4
CV 111,94
W 6
MB 72,24,80
G 41,40,66,1
T 44,19,0
MB 76,24,84
T 46,19,4
E 64
MB 72,28,88
T 48,20,0
T 50,20,4
MB 76,28,92
E 65
W 6
MC 96,32,104
G 42,40,66,2
T 52,21,0
MC 100,32,108
T 54,21,4
CV 96,64
E 66
MC 104,36,104
T 56,22,0
T 58,22,4
MC 108,36,108
E 67
W 6
MC 112,40,104
G 43,40,66,3
T 60,23,0
MC 116,40,108
T 62,23,4
CV 97,66
E 68
MC 120,44,104
E 69
MC 124,44,108
W 4
MC 128,48,104
s_waitcnt vmcnt(12)
s_barrier
R a,0,8,16
CV 100,68
MC 132,48,108
E 70
s_xor_b32 m0, s65, 0x14000
s_xor_b32 s66, s61, 0x40200
MC 136,52,104
G 40,40,66,0
MC 140,52,108
R a,4,9,16
E 71
W 2
MC 144,56,104
R a,8,10,16
CV 101,70
MC 148,56,108
E 72
MC 152,60,104
G 41,40,66,1
MC 156,60,108
R a,12,11,16
E 73
MD 112,52,104
R a,16,8,20
CV 98,72
MD 116,52,108
E 74
W 3
ZB 80,0,64
G 42,40,66,2
ZB 84,0,68
R a,20,9,20
E 75
MB 80,4,72
R a,24,10,20
CV 99,74
MB 84,4,76
E 76
W 3
MB 80,8,80
G 43,40,66,3
MB 84,8,84
R a,28,11,20
E 77
MB 80,12,88
s_waitcnt vmcnt(12)
s_barrier
T 32,16,32
T 34,16,36
MB 84,12,92
CV 102,76
E 78
s_xor_b32 m0, s65, 0x18000
s_xor_b32 s66, s61, 0x80200
W 4
ZB 88,16,64
G 40,40,66,0
T 36,17,32
ZB 92,16,68
T 38,17,36
E 79
MB 88,20,72
T 40,18,32
MB 92,20,76
T 42,18,36
CV 103,78
W 6
MB 88,24,80
G 41,40,66,1
T 44,19,32
MB 92,24,84
T 46,19,36
E 80
MB 88,28,88
T 48,20,32
T 50,20,36
MB 92,28,92
E 81
W 6
MC 96,32,96
G 42,40,66,2
T 52,21,32
MC 100,32,100
T 54,21,36
CV 104,80
E 82
MC 104,36,96
T 56,22,32
T 58,22,36
MC 108,36,100
E 83
W 6
MC 112,40,96
G 43,40,66,3
T 60,23,32
MC 116,40,100
T 62,23,36
CV 105,82
E 84
MC 120,44,96
E 85
MC 124,44,100
W 4
MC 128,48,96
CV 108,84
MC 132,48,100
E 86
MC 136,52,96
E 87
MC 140,52,100
W 0
MC 144,56,96
CV 109,86
MC 148,56,100
E 88
MC 152,60,96
E 89
MC 156,60,100
MD 112,52,96
CV 106,88
MD 116,52,100
E 90
E 91
s_nop 0
CV 107,90
E 92
E 93
s_waitcnt vmcnt(12)
s_barrier
T 32,16,48
T 34,16,52
CV 110,92
E 94
s_xor_b32 m0, s65, 0x1c000
s_xor_b32 s66, s61, 0xc0200
T 36,17,48
T 38,17,52
G 40,40,66,0
E 95
T 40,18,48
T 42,18,52
CV 111,94
T 44,19,48
T 46,19,52
G 41,40,66,1
T 48,20,48
T 50,20,52
W 6
MC 96,32,104
G 42,40,66,2
MC 100,32,108
T 52,21,48
T 54,21,52
MC 104,36,104
T 56,22,48
MC 108,36,108
T 58,22,52
W 6
MC 112,40,104
G 43,40,66,3
MC 116,40,108
T 60,23,48
T 62,23,52
MC 120,44,104
MC 124,44,108
W 4
MC 128,48,104
s_waitcnt vmcnt(12)
s_barrier
s_xor_b32 m0, s65, 0x0
s_xor_b32 s66, s61, 0x100200
MC 132,48,108
G 40,40,66,0
T 0,24,0
T 2,24,4
MC 136,52,104
G 41,40,66,1
MC 140,52,108
T 4,25,0
T 6,25,4
W 4
MC 144,56,104
G 42,40,66,2
MC 148,56,108
T 8,26,0
T 10,26,4
MC 152,60,104
G 43,40,66,3
MC 156,60,108
T 12,27,0
T 14,27,4
MD 112,52,104
s_xor_b32 m0, s65, 0x4000
s_xor_b32 s66, s61, 0x140200
MD 116,52,108
G 40,40,66,0
T 16,28,0
T 18,28,4
s_nop 1
v_mov_b32 v6, v112
s_nop 1
v_mov_b32 v7, v116
W 6
ZA 64,0,128
G 41,40,66,1
ZA 68,0,132
T 20,29,0
T 22,29,4
ZA 72,4,128
G 42,40,66,2
ZA 76,4,132
T 24,30,0
T 26,30,4
W 6
ZA 80,8,128
G 43,40,66,3
ZA 84,8,132
T 28,31,0
T 30,31,4
ZA 88,12,128
s_waitcnt vmcnt(16)
s_barrier
T 32,24,16
ZA 92,12,132
T 34,24,20
s_xor_b32 m0, s65, 0x8000
s_xor_b32 s66, s61, 0x180200
W 6
ZA 96,16,128
G 40,40,66,0
ZA 100,16,132
T 36,25,16
T 38,25,20
ZA 104,20,128
T 40,26,16
ZA 108,20,132
T 42,26,20
W 6
ZA 112,24,128
G 41,40,66,1
ZA 116,24,132
T 44,27,16
T 46,27,20
ZA 120,28,128
T 48,28,16
ZA 124,28,132
T 50,28,20
W 6
MA 64,32,136
G 42,40,66,2
MA 68,32,140
T 52,29,16
T 54,29,20
MA 72,36,136
T 56,30,16
MA 76,36,140
T 58,30,20
W 6
MA 80,40,136
G 43,40,66,3
MA 84,40,140
T 60,31,16
T 62,31,20
MA 88,44,136
s_waitcnt vmcnt(16)
s_barrier
T 0,24,32
MA 92,44,140
T 2,24,36
s_xor_b32 m0, s65, 0xc000
s_xor_b32 s66, s61, 0x1c0200
W 6
MA 96,48,136
G 40,40,66,0
MA 100,48,140
T 4,25,32
T 6,25,36
MA 104,52,136
T 8,26,32
MA 108,52,140
T 10,26,36
W 6
MA 112,56,136
G 41,40,66,1
MA 116,56,140
T 12,27,32
T 14,27,36
MA 120,60,136
T 16,28,32
MA 124,60,140
T 18,28,36
W 6
MA 64,0,144
G 42,40,66,2
MA 68,0,148
T 20,29,32
T 22,29,36
MA 72,4,144
T 24,30,32
MA 76,4,148
T 26,30,36
W 6
MA 80,8,144
G 43,40,66,3
MA 84,8,148
T 28,31,32
T 30,31,36
MA 88,12,144
s_waitcnt vmcnt(16)
s_barrier
T 32,24,48
MA 92,12,148
T 34,24,52
s_xor_b32 m0, s65, 0x10000
s_xor_b32 s66, s61, 0x200200
W 6
MA 96,16,144
G 40,40,66,0
MA 100,16,148
T 36,25,48
T 38,25,52
s_getpc_b64 s[88:89]
L_ct3_281:
s_and_b32 s89, s89, 0xffff
s_mov_b32 s90, L_code_end-L_ct3_281
s_mov_b32 s91, 0x20000
v_and_b32 v62, 0x70, v59
v_lshlrev_b32 v62, 3, v62
s_add_u32 s7, s1, 4096
buffer_load_dword v3, v62, s[88:91], s7 offen
MA 104,20,144
T 40,26,48
MA 108,20,148
T 42,26,52
W 6
MA 112,24,144
G 41,40,66,1
MA 116,24,148
T 44,27,48
T 46,27,52
MA 120,28,144
T 48,28,48
MA 124,28,148
T 50,28,52
W 6
MA 64,32,152
G 42,40,66,2
MA 68,32,156
T 52,29,48
T 54,29,52
MA 72,36,152
T 56,30,48
MA 76,36,156
T 58,30,52
W 6
MA 80,40,152
G 43,40,66,3
MA 84,40,156
T 60,31,48
T 62,31,52
MA 88,44,152
s_waitcnt vmcnt(17)
s_barrier
T 0,16,0
MA 92,44,156
T 2,16,4
s_xor_b32 m0, s65, 0x14000
s_xor_b32 s66, s61, 0x240200
W 6
MA 96,48,152
G 40,40,66,0
MA 100,48,156
T 4,17,0
T 6,17,4
MA 104,52,152
T 8,18,0
MA 108,52,156
T 10,18,4
W 6
MA 112,56,152
G 41,40,66,1
MA 116,56,156
T 12,19,0
T 14,19,4
MA 120,60,152
T 16,20,0
MA 124,60,156
T 18,20,4
W 6
MA 64,0,160
G 42,40,66,2
MA 68,0,164
T 20,21,0
T 22,21,4
MA 72,4,160
T 24,22,0
MA 76,4,164
T 26,22,4
W 6
MA 80,8,160
G 43,40,66,3
MA 84,8,164
T 28,23,0
T 30,23,4
MA 88,12,160
s_waitcnt vmcnt(17)
s_barrier
T 32,16,16
MA 92,12,164
T 34,16,20
s_xor_b32 m0, s65, 0x18000
s_xor_b32 s66, s61, 0x280200
W 6
MA 96,16,160
G 40,40,66,0
MA 100,16,164
T 36,17,16
T 38,17,20
MA 104,20,160
T 40,18,16
MA 108,20,164
T 42,18,20
W 6
MA 112,24,160
G 41,40,66,1
MA 116,24,164
T 44,19,16
T 46,19,20
MA 120,28,160
T 48,20,16
MA 124,28,164
T 50,20,20
W 6
MA 64,32,168
G 42,40,66,2
MA 68,32,172
T 52,21,16
T 54,21,20
MA 72,36,168
T 56,22,16
MA 76,36,172
T 58,22,20
W 6
MA 80,40,168
G 43,40,66,3
MA 84,40,172
T 60,23,16
T 62,23,20
MA 88,44,168
s_waitcnt vmcnt(17)
s_barrier
T 0,16,32
MA 92,44,172
T 2,16,36
s_xor_b32 m0, s65, 0x1c000
s_xor_b32 s66, s61, 0x2c0200
W 6
MA 96,48,168
G 40,40,66,0
MA 100,48,172
T 4,17,32
T 6,17,36
MA 104,52,168
T 8,18,32
MA 108,52,172
T 10,18,36
W 6
MA 112,56,168
G 41,40,66,1
MA 116,56,172
T 12,19,32
T 14,19,36
MA 120,60,168
T 16,20,32
MA 124,60,172
T 18,20,36
W 6
MA 64,0,176
G 42,40,66,2
MA 68,0,180
T 20,21,32
T 22,21,36
MA 72,4,176
T 24,22,32
MA 76,4,180
T 26,22,36
W 6
MA 80,8,176
G 43,40,66,3
MA 84,8,180
T 28,23,32
T 30,23,36
MA 88,12,176
s_waitcnt vmcnt(17)
s_barrier
T 32,16,48
MA 92,12,180
T 34,16,52
s_xor_b32 m0, s65, 0x0
s_xor_b32 s66, s61, 0x300200
W 6
MA 96,16,176
G 40,40,66,0
MA 100,16,180
T 36,17,48
T 38,17,52
MA 104,20,176
T 40,18,48
MA 108,20,180
T 42,18,52
W 6
MA 112,24,176
G 41,40,66,1
MA 116,24,180
T 44,19,48
T 46,19,52
MA 120,28,176
T 48,20,48
MA 124,28,180
T 50,20,52
W 6
MA 64,32,184
G 42,40,66,2
MA 68,32,188
T 52,21,48
T 54,21,52
MA 72,36,184
T 56,22,48
MA 76,36,188
T 58,22,52
W 6
MA 80,40,184
G 43,40,66,3
MA 84,40,188
T 60,23,48
T 62,23,52
MA 88,44,184
s_waitcnt vmcnt(16)
s_barrier
T 0,24,0
MA 92,44,188
T 2,24,4
s_xor_b32 m0, s65, 0x4000
s_xor_b32 s66, s61, 0x340200
W 6
MA 96,48,184
G 40,40,66,0
MA 100,48,188
T 4,25,0
T 6,25,4
MA 104,52,184
T 8,26,0
MA 108,52,188
T 10,26,4
W 6
MA 112,56,184
G 41,40,66,1
MA 116,56,188
T 12,27,0
T 14,27,4
MA 120,60,184
T 16,28,0
MA 124,60,188
T 18,28,4
W 6
MA 64,0,192
G 42,40,66,2
MA 68,0,196
T 20,29,0
T 22,29,4
MA 72,4,192
T 24,30,0
MA 76,4,196
T 26,30,4
W 6
MA 80,8,192
G 43,40,66,3
MA 84,8,196
T 28,31,0
T 30,31,4
MA 88,12,192
s_waitcnt vmcnt(16)
s_barrier
T 32,24,16
MA 92,12,196
T 34,24,20
s_xor_b32 m0, s65, 0x8000
s_xor_b32 s66, s61, 0x380200
W 6
MA 96,16,192
G 40,40,66,0
MA 100,16,196
T 36,25,16
T 38,25,20
MA 104,20,192
T 40,26,16
MA 108,20,196
T 42,26,20
W 6
MA 112,24,192
G 41,40,66,1
MA 116,24,196
T 44,27,16
T 46,27,20
MA 120,28,192
T 48,28,16
MA 124,28,196
T 50,28,20
W 6
MA 64,32,200
G 42,40,66,2
MA 68,32,204
T 52,29,16
T 54,29,20
MA 72,36,200
T 56,30,16
MA 76,36,204
T 58,30,20
W 6
MA 80,40,200
G 43,40,66,3
MA 84,40,204
T 60,31,16
T 62,31,20
MA 88,44,200
s_waitcnt vmcnt(16)
s_barrier
T 0,24,32
MA 92,44,204
T 2,24,36
s_xor_b32 m0, s65, 0xc000
s_xor_b32 s66, s61, 0x3c0200
W 6
MA 96,48,200
G 40,40,66,0
MA 100,48,204
T 4,25,32
T 6,25,36
MA 104,52,200
T 8,26,32
MA 108,52,204
T 10,26,36
W 6
MA 112,56,200
G 41,40,66,1
MA 116,56,204
T 12,27,32
T 14,27,36
MA 120,60,200
T 16,28,32
MA 124,60,204
T 18,28,36
W 6
MA 64,0,208
G 42,40,66,2
MA 68,0,212
T 20,29,32
T 22,29,36
MA 72,4,208
T 24,30,32
MA 76,4,212
T 26,30,36
W 6
MA 80,8,208
G 43,40,66,3
MA 84,8,212
T 28,31,32
T 30,31,36
MA 88,12,208
s_waitcnt vmcnt(16)
s_barrier
T 32,24,48
MA 92,12,212
T 34,24,52
s_xor_b32 m0, s65, 0x10000
s_xor_b32 s66, s63, 0x2000
W 6
MA 96,16,208
G 32,32,66,0,nt
MA 100,16,212
T 36,25,48
T 38,25,52
MA 104,20,208
T 40,26,48
MA 108,20,212
T 42,26,52
W 6
MA 112,24,208
G 33,32,66,1,nt
MA 116,24,212
T 44,27,48
T 46,27,52
MA 120,28,208
T 48,28,48
MA 124,28,212
T 50,28,52
W 6
MA 64,32,216
G 34,32,66,2,nt
MA 68,32,220
T 52,29,48
T 54,29,52
MA 72,36,216
T 56,30,48
MA 76,36,220
T 58,30,52
W 6
MA 80,40,216
G 35,32,66,3,nt
MA 84,40,220
T 60,31,48
T 62,31,52
MA 88,44,216
s_waitcnt vmcnt(16)
s_barrier
T 0,16,0
MA 92,44,220
T 2,16,4
s_xor_b32 m0, s65, 0x14000
s_xor_b32 s66, s63, 0x12000
W 6
MA 96,48,216
G 32,32,66,0,nt
MA 100,48,220
T 4,17,0
T 6,17,4
MA 104,52,216
T 8,18,0
MA 108,52,220
T 10,18,4
W 6
MA 112,56,216
G 33,32,66,1,nt
MA 116,56,220
T 12,19,0
T 14,19,4
MA 120,60,216
T 16,20,0
MA 124,60,220
T 18,20,4
W 6
MA 64,0,224
G 34,32,66,2,nt
MA 68,0,228
T 20,21,0
T 22,21,4
MA 72,4,224
T 24,22,0
MA 76,4,228
T 26,22,4
W 6
MA 80,8,224
G 35,32,66,3,nt
MA 84,8,228
T 28,23,0
T 30,23,4
MA 88,12,224
s_waitcnt vmcnt(16)
s_barrier
T 32,16,16
MA 92,12,228
T 34,16,20
s_xor_b32 m0, s65, 0x18000
s_xor_b32 s66, s63, 0x2000
W 6
MA 96,16,224
G 56,36,66,0,nt
MA 100,16,228
T 36,17,16
T 38,17,20
MA 104,20,224
T 40,18,16
MA 108,20,228
T 42,18,20
W 6
MA 112,24,224
G 57,36,66,1,nt
MA 116,24,228
T 44,19,16
T 46,19,20
MA 120,28,224
T 48,20,16
MA 124,28,228
T 50,20,20
W 6
MA 64,32,232
G 56,36,66,2,nt
MA 68,32,236
T 52,21,16
T 54,21,20
MA 72,36,232
T 56,22,16
MA 76,36,236
T 58,22,20
W 6
MA 80,40,232
G 57,36,66,3,nt
MA 84,40,236
T 60,23,16
T 62,23,20
MA 88,44,232
s_waitcnt vmcnt(16)
s_barrier
T 0,16,32
MA 92,44,236
T 2,16,36
s_xor_b32 m0, s65, 0x1c000
s_xor_b32 s66, s63, 0x6000
W 6
MA 96,48,232
G 32,32,66,0,nt
MA 100,48,236
T 4,17,32
T 6,17,36
MA 104,52,232
T 8,18,32
MA 108,52,236
T 10,18,36
W 6
MA 112,56,232
G 33,32,66,1,nt
MA 116,56,236
T 12,19,32
T 14,19,36
MA 120,60,232
T 16,20,32
MA 124,60,236
T 18,20,36
W 6
MA 64,0,240
G 34,32,66,2,nt
MA 68,0,244
T 20,21,32
T 22,21,36
MA 72,4,240
T 24,22,32
MA 76,4,244
T 26,22,36
W 6
MA 80,8,240
G 35,32,66,3,nt
MA 84,8,244
T 28,23,32
T 30,23,36
MA 88,12,240
s_waitcnt vmcnt(16)
s_barrier
MA 92,12,244
T 32,16,48
T 34,16,52
W 6
MA 96,16,240
T 36,17,48
MA 100,16,244
T 38,17,52
MA 104,20,240
T 40,18,48
MA 108,20,244
T 42,18,52
W 6
MA 112,24,240
T 44,19,48
MA 116,24,244
T 46,19,52
MA 120,28,240
T 48,20,48
MA 124,28,244
T 50,20,52
W 6
MA 64,32,248
T 52,21,48
MA 68,32,252
T 54,21,52
MA 72,36,248
T 56,22,48
MA 76,36,252
T 58,22,52
W 6
MA 80,40,248
T 60,23,48
MA 84,40,252
T 62,23,52
MA 88,44,248
s_waitcnt vmcnt(12)
s_barrier
MA 92,44,252
R a,0,12,0
s_xor_b32 m0, s65, 0x0
s_xor_b32 s66, s63, 0x12000
W 5
MA 96,48,248
G 56,36,66,0,nt
MA 100,48,252
R a,4,13,0
MA 104,52,248
R a,8,14,0
MA 108,52,252
W 3
MA 112,56,248
G 57,36,66,1,nt
MA 116,56,252
R a,12,15,0
MA 120,60,248
R a,16,12,4
MA 124,60,252
v_pk_mul_f32 v[64:65], v[64:65], s[74:75]
v_pk_mul_f32 v[66:67], v[66:67], s[74:75]
v_pk_mul_f32 v[68:69], v[68:69], s[74:75]
v_pk_mul_f32 v[70:71], v[70:71], s[74:75]
v_pk_mul_f32 v[72:73], v[72:73], s[74:75]
v_pk_mul_f32 v[74:75], v[74:75], s[74:75]
v_pk_mul_f32 v[76:77], v[76:77], s[74:75]
v_pk_mul_f32 v[78:79], v[78:79], s[74:75]
CV 64,64
CV 66,66
CV 68,68
CV 70,70
CV 72,72
CV 74,74
CV 76,76
CV 78,78
v_permlane32_swap_b32 v64, v72
v_permlane32_swap_b32 v66, v74
v_permlane32_swap_b32 v68, v76
v_permlane32_swap_b32 v70, v78
v_permlane16_swap_b32 v64, v72
v_permlane16_swap_b32 v66, v74
v_permlane16_swap_b32 v68, v76
v_permlane16_swap_b32 v70, v78
AW 160,64
AW 161,66
AW 162,72
AW 163,74
AW 164,68
AW 165,70
AW 166,76
AW 167,78
v_pk_mul_f32 v[80:81], v[80:81], s[74:75]
v_pk_mul_f32 v[82:83], v[82:83], s[74:75]
v_pk_mul_f32 v[84:85], v[84:85], s[74:75]
v_pk_mul_f32 v[86:87], v[86:87], s[74:75]
v_pk_mul_f32 v[88:89], v[88:89], s[74:75]
v_pk_mul_f32 v[90:91], v[90:91], s[74:75]
v_pk_mul_f32 v[92:93], v[92:93], s[74:75]
v_pk_mul_f32 v[94:95], v[94:95], s[74:75]
CV 80,80
CV 82,82
CV 84,84
CV 86,86
CV 88,88
CV 90,90
CV 92,92
CV 94,94
v_permlane32_swap_b32 v80, v88
v_permlane32_swap_b32 v82, v90
v_permlane32_swap_b32 v84, v92
v_permlane32_swap_b32 v86, v94
v_permlane16_swap_b32 v80, v88
v_permlane16_swap_b32 v82, v90
v_permlane16_swap_b32 v84, v92
v_permlane16_swap_b32 v86, v94
AW 168,80
AW 169,82
AW 170,88
AW 171,90
AW 172,84
AW 173,86
AW 174,92
AW 175,94
v_pk_mul_f32 v[96:97], v[96:97], s[74:75]
v_pk_mul_f32 v[98:99], v[98:99], s[74:75]
v_pk_mul_f32 v[100:101], v[100:101], s[74:75]
v_pk_mul_f32 v[102:103], v[102:103], s[74:75]
v_pk_mul_f32 v[104:105], v[104:105], s[74:75]
v_pk_mul_f32 v[106:107], v[106:107], s[74:75]
v_pk_mul_f32 v[108:109], v[108:109], s[74:75]
v_pk_mul_f32 v[110:111], v[110:111], s[74:75]
CV 96,96
CV 98,98
CV 100,100
CV 102,102
CV 104,104
CV 106,106
CV 108,108
CV 110,110
v_permlane32_swap_b32 v96, v104
v_permlane32_swap_b32 v98, v106
v_permlane32_swap_b32 v100, v108
v_permlane32_swap_b32 v102, v110
v_permlane16_swap_b32 v96, v104
v_permlane16_swap_b32 v98, v106
v_permlane16_swap_b32 v100, v108
v_permlane16_swap_b32 v102, v110
AW 176,96
AW 177,98
AW 178,104
AW 179,106
AW 180,100
AW 181,102
AW 182,108
AW 183,110
v_pk_mul_f32 v[112:113], v[112:113], s[74:75]
v_pk_mul_f32 v[114:115], v[114:115], s[74:75]
v_pk_mul_f32 v[116:117], v[116:117], s[74:75]
v_pk_mul_f32 v[118:119], v[118:119], s[74:75]
v_pk_mul_f32 v[120:121], v[120:121], s[74:75]
v_pk_mul_f32 v[122:123], v[122:123], s[74:75]
v_pk_mul_f32 v[124:125], v[124:125], s[74:75]
v_pk_mul_f32 v[126:127], v[126:127], s[74:75]
CV 112,112
CV 114,114
CV 116,116
CV 118,118
CV 120,120
CV 122,122
CV 124,124
CV 126,126
v_permlane32_swap_b32 v112, v120
v_permlane32_swap_b32 v114, v122
v_permlane32_swap_b32 v116, v124
v_permlane32_swap_b32 v118, v126
v_permlane16_swap_b32 v112, v120
v_permlane16_swap_b32 v114, v122
v_permlane16_swap_b32 v116, v124
v_permlane16_swap_b32 v118, v126
AW 184,112
AW 185,114
AW 186,120
AW 187,122
AW 188,116
AW 189,118
AW 190,124
AW 191,126
W 3
ZB 64,0,64
G 56,36,66,2,nt
ZB 68,0,68
R a,20,13,4
MB 64,4,72
R a,24,14,4
MB 68,4,76
W 3
MB 64,8,80
G 57,36,66,3,nt
MB 68,8,84
R a,28,15,4
MB 64,12,88
MB 68,12,92
W 2
ZB 72,16,64
ZB 76,16,68
MB 72,20,72
MB 76,20,76
W 0
MB 72,24,80
E 64
MB 76,24,84
MB 72,28,88
E 65
MB 76,28,92
CV 96,64
E 66
E 67
s_nop 0
CV 97,66
E 68
s_waitcnt vmcnt(12)
s_barrier
R a,0,12,16
E 69
s_xor_b32 m0, s65, 0x4000
s_xor_b32 s66, s63, 0x16000
R a,4,13,16
G 32,32,66,0,nt
CV 100,68
E 70
R a,8,14,16
E 71
R a,12,15,16
G 33,32,66,1,nt
CV 101,70
E 72
R a,16,12,20
E 73
W 3
ZB 80,0,64
G 34,32,66,2,nt
R a,20,13,20
ZB 84,0,68
CV 98,72
E 74
MB 80,4,72
R a,24,14,20
MB 84,4,76
E 75
W 3
MB 80,8,80
G 35,32,66,3,nt
R a,28,15,20
MB 84,8,84
CV 99,74
E 76
MB 80,12,88
s_waitcnt vmcnt(12)
s_barrier
T 32,24,32
T 34,24,36
MB 84,12,92
E 77
s_xor_b32 m0, s65, 0x8000
s_xor_b32 s66, s63, 0x6000
W 4
ZB 88,16,64
G 56,36,66,0,nt
T 36,25,32
ZB 92,16,68
T 38,25,36
CV 102,76
E 78
s_getpc_b64 s[88:89]
L_ct3_409:
s_and_b32 s89, s89, 0xffff
s_mov_b32 s90, L_code_end-L_ct3_409
s_mov_b32 s91, 0x20000
v_and_b32 v62, 0x70, v59
v_lshlrev_b32 v62, 3, v62
s_add_u32 s7, s1, 4096
buffer_load_dword v3, v62, s[88:91], s7 offen
MB 88,20,72
T 40,26,32
T 42,26,36
MB 92,20,76
E 79
W 6
MB 88,24,80
G 57,36,66,1,nt
T 44,27,32
MB 92,24,84
T 46,27,36
CV 103,78
E 80
MB 88,28,88
T 48,28,32
T 50,28,36
MB 92,28,92
E 81
W 6
MC 96,32,96
G 56,36,66,2,nt
T 52,29,32
MC 100,32,100
T 54,29,36
CV 104,80
E 82
MC 104,36,96
T 56,30,32
T 58,30,36
MC 108,36,100
E 83
W 6
MC 112,40,96
G 57,36,66,3,nt
T 60,31,32
MC 116,40,100
T 62,31,36
CV 105,82
E 84
MC 120,44,96
E 85
MC 124,44,100
W 4
MC 128,48,96
s_waitcnt vmcnt(13)
s_barrier
R a,0,12,48
CV 108,84
MC 132,48,100
E 86
s_xor_b32 m0, s65, 0xc000
s_xor_b32 s66, s63, 0x3000
MC 136,52,96
G 32,32,66,0,nt
MC 140,52,100
R a,4,13,48
E 87
W 2
MC 144,56,96
R a,8,14,48
CV 109,86
MC 148,56,100
E 88
MC 152,60,96
G 33,32,66,1,nt
MC 156,60,100
R a,12,15,48
E 89
ZD 112,52,96
R a,16,12,52
CV 106,88
ZD 116,52,100
E 90
W 3
ZB 64,0,64
G 34,32,66,2,nt
ZB 68,0,68
R a,20,13,52
E 91
MB 64,4,72
R a,24,14,52
CV 107,90
MB 68,4,76
E 92
W 3
MB 64,8,80
G 35,32,66,3,nt
MB 68,8,84
R a,28,15,52
E 93
MB 64,12,88
s_waitcnt vmcnt(13)
s_barrier
T 32,16,0
T 34,16,4
MB 68,12,92
CV 110,92
E 94
s_xor_b32 m0, s65, 0x10000
s_xor_b32 s66, s63, 0x16000
W 4
ZB 72,16,64
G 56,36,66,0,nt
T 36,17,0
ZB 76,16,68
T 38,17,4
E 95
MB 72,20,72
T 40,18,0
MB 76,20,76
T 42,18,4
CV 111,94
W 6
MB 72,24,80
G 57,36,66,1,nt
T 44,19,0
MB 76,24,84
T 46,19,4
E 64
MB 72,28,88
T 48,20,0
T 50,20,4
MB 76,28,92
E 65
W 6
MC 96,32,104
G 56,36,66,2,nt
T 52,21,0
MC 100,32,108
T 54,21,4
CV 96,64
E 66
MC 104,36,104
T 56,22,0
T 58,22,4
MC 108,36,108
E 67
W 6
MC 112,40,104
G 57,36,66,3,nt
T 60,23,0
MC 116,40,108
T 62,23,4
CV 97,66
E 68
MC 120,44,104
E 69
MC 124,44,108
W 4
MC 128,48,104
s_waitcnt vmcnt(13)
s_barrier
R a,0,8,16
CV 100,68
MC 132,48,108
E 70
s_xor_b32 m0, s65, 0x14000
s_xor_b32 s66, s63, 0x13000
MC 136,52,104
G 32,32,66,0,nt
MC 140,52,108
R a,4,9,16
E 71
W 2
MC 144,56,104
R a,8,10,16
CV 101,70
MC 148,56,108
E 72
MC 152,60,104
G 33,32,66,1,nt
MC 156,60,108
R a,12,11,16
E 73
MD 112,52,104
R a,16,8,20
CV 98,72
MD 116,52,108
E 74
W 3
ZB 80,0,64
G 34,32,66,2,nt
ZB 84,0,68
R a,20,9,20
E 75
MB 80,4,72
R a,24,10,20
CV 99,74
MB 84,4,76
E 76
W 3
MB 80,8,80
G 35,32,66,3,nt
MB 84,8,84
R a,28,11,20
E 77
MB 80,12,88
s_waitcnt vmcnt(12)
s_barrier
T 32,16,32
T 34,16,36
MB 84,12,92
CV 102,76
E 78
s_xor_b32 m0, s65, 0x18000
s_xor_b32 s66, s63, 0x3000
W 4
ZB 88,16,64
G 56,36,66,0,nt
T 36,17,32
ZB 92,16,68
T 38,17,36
E 79
MB 88,20,72
T 40,18,32
MB 92,20,76
T 42,18,36
CV 103,78
W 6
MB 88,24,80
G 57,36,66,1,nt
T 44,19,32
MB 92,24,84
T 46,19,36
E 80
MB 88,28,88
T 48,20,32
T 50,20,36
MB 92,28,92
E 81
W 6
MC 96,32,96
G 56,36,66,2,nt
T 52,21,32
MC 100,32,100
T 54,21,36
CV 104,80
E 82
MC 104,36,96
T 56,22,32
T 58,22,36
MC 108,36,100
E 83
W 6
MC 112,40,96
G 57,36,66,3,nt
T 60,23,32
MC 116,40,100
T 62,23,36
CV 105,82
E 84
MC 120,44,96
E 85
MC 124,44,100
W 4
MC 128,48,96
s_waitcnt vmcnt(12)
s_barrier
R a,0,8,48
CV 108,84
MC 132,48,100
E 86
s_xor_b32 m0, s65, 0x1c000
s_xor_b32 s66, s63, 0x7000
MC 136,52,96
G 32,32,66,0,nt
MC 140,52,100
R a,4,9,48
E 87
W 2
MC 144,56,96
R a,8,10,48
CV 109,86
MC 148,56,100
E 88
MC 152,60,96
G 33,32,66,1,nt
MC 156,60,100
R a,12,11,48
E 89
MD 112,52,96
R a,16,8,52
CV 106,88
MD 116,52,100
E 90
W 3
ZB 64,0,64
G 34,32,66,2,nt
ZB 68,0,68
R a,20,9,52
E 91
MB 64,4,72
R a,24,10,52
CV 107,90
MB 68,4,76
E 92
W 3
MB 64,8,80
G 35,32,66,3,nt
MB 68,8,84
R a,28,11,52
E 93
MB 64,12,88
s_waitcnt vmcnt(12)
s_barrier
T 32,24,0
T 34,24,4
MB 68,12,92
CV 110,92
E 94
s_xor_b32 m0, s65, 0x0
s_xor_b32 s66, s63, 0x13000
W 4
ZB 72,16,64
G 56,36,66,0,nt
T 36,25,0
ZB 76,16,68
T 38,25,4
E 95
MB 72,20,72
T 40,26,0
MB 76,20,76
T 42,26,4
CV 111,94
W 6
MB 72,24,80
G 57,36,66,1,nt
T 44,27,0
MB 76,24,84
T 46,27,4
E 64
MB 72,28,88
T 48,28,0
T 50,28,4
MB 76,28,92
E 65
W 6
MC 96,32,104
G 56,36,66,2,nt
T 52,29,0
MC 100,32,108
T 54,29,4
CV 96,64
E 66
MC 104,36,104
T 56,30,0
T 58,30,4
MC 108,36,108
E 67
W 6
MC 112,40,104
G 57,36,66,3,nt
T 60,31,0
MC 116,40,108
T 62,31,4
CV 97,66
E 68
MC 120,44,104
E 69
MC 124,44,108
W 4
MC 128,48,104
s_waitcnt vmcnt(12)
s_barrier
R a,0,12,16
CV 100,68
MC 132,48,108
E 70
s_xor_b32 m0, s65, 0x4000
s_xor_b32 s66, s63, 0x17000
MC 136,52,104
G 32,32,66,0,nt
MC 140,52,108
R a,4,13,16
E 71
W 2
MC 144,56,104
R a,8,14,16
CV 101,70
MC 148,56,108
E 72
MC 152,60,104
G 33,32,66,1,nt
MC 156,60,108
R a,12,15,16
E 73
MD 112,52,104
R a,16,12,20
CV 98,72
MD 116,52,108
E 74
W 3
ZB 80,0,64
G 34,32,66,2,nt
ZB 84,0,68
R a,20,13,20
E 75
MB 80,4,72
R a,24,14,20
CV 99,74
MB 84,4,76
E 76
W 3
MB 80,8,80
G 35,32,66,3,nt
MB 84,8,84
R a,28,15,20
E 77
MB 80,12,88
s_waitcnt vmcnt(12)
s_barrier
T 32,24,32
T 34,24,36
MB 84,12,92
CV 102,76
E 78
s_xor_b32 m0, s65, 0x8000
s_xor_b32 s66, s63, 0x7000
W 4
ZB 88,16,64
G 56,36,66,0,nt
T 36,25,32
ZB 92,16,68
T 38,25,36
E 79
MB 88,20,72
T 40,26,32
MB 92,20,76
T 42,26,36
CV 103,78
W 6
MB 88,24,80
G 57,36,66,1,nt
T 44,27,32
MB 92,24,84
T 46,27,36
E 80
MB 88,28,88
T 48,28,32
T 50,28,36
MB 92,28,92
E 81
W 6
MC 96,32,96
G 56,36,66,2,nt
T 52,29,32
MC 100,32,100
T 54,29,36
CV 104,80
E 82
MC 104,36,96
T 56,30,32
T 58,30,36
MC 108,36,100
E 83
W 6
MC 112,40,96
G 57,36,66,3,nt
T 60,31,32
MC 116,40,100
T 62,31,36
CV 105,82
E 84
MC 120,44,96
E 85
MC 124,44,100
W 4
MC 128,48,96
s_waitcnt vmcnt(12)
s_barrier
R a,0,12,48
CV 108,84
MC 132,48,100
E 86
s_xor_b32 m0, s65, 0xc000
s_xor_b32 s66, s63, 0x17000
MC 136,52,96
G 56,36,66,0,nt
MC 140,52,100
R a,4,13,48
E 87
W 2
MC 144,56,96
R a,8,14,48
CV 109,86
MC 148,56,100
E 88
MC 152,60,96
G 57,36,66,1,nt
MC 156,60,100
R a,12,15,48
E 89
MD 112,52,96
R a,16,12,52
CV 106,88
MD 116,52,100
E 90
W 3
ZB 64,0,64
G 56,36,66,2,nt
ZB 68,0,68
R a,20,13,52
E 91
MB 64,4,72
R a,24,14,52
CV 107,90
MB 68,4,76
E 92
W 3
MB 64,8,80
G 57,36,66,3,nt
MB 68,8,84
R a,28,15,52
E 93
MB 64,12,88
s_waitcnt vmcnt(12)
s_barrier
T 32,16,0
T 34,16,4
MB 68,12,92
CV 110,92
E 94
s_xor_b32 m0, s65, 0x10000
s_xor_b32 s66, s60, 0x0
W 4
ZB 72,16,64
G 36,8,66,0
T 36,17,0
ZB 76,16,68
T 38,17,4
E 95
MB 72,20,72
T 40,18,0
MB 76,20,76
T 42,18,4
CV 111,94
W 6
MB 72,24,80
G 37,8,66,1
T 44,19,0
MB 76,24,84
T 46,19,4
E 64
MB 72,28,88
T 48,20,0
T 50,20,4
MB 76,28,92
E 65
W 6
MC 96,32,104
G 38,8,66,2
T 52,21,0
MC 100,32,108
T 54,21,4
CV 96,64
E 66
MC 104,36,104
T 56,22,0
T 58,22,4
MC 108,36,108
E 67
W 6
MC 112,40,104
G 39,8,66,3
T 60,23,0
MC 116,40,108
T 62,23,4
CV 97,66
E 68
MC 120,44,104
E 69
MC 124,44,108
W 4
MC 128,48,104
s_waitcnt vmcnt(12)
s_barrier
R a,0,8,16
CV 100,68
MC 132,48,108
E 70
s_xor_b32 m0, s65, 0x14000
s_xor_b32 s66, s61, 0x0
MC 136,52,104
G 40,20,66,0
MC 140,52,108
R a,4,9,16
E 71
W 2
MC 144,56,104
R a,8,10,16
CV 101,70
MC 148,56,108
E 72
MC 152,60,104
G 41,20,66,1
MC 156,60,108
R a,12,11,16
E 73
MD 112,52,104
R a,16,8,20
CV 98,72
MD 116,52,108
E 74
W 3
ZB 80,0,64
G 42,20,66,2
ZB 84,0,68
R a,20,9,20
E 75
MB 80,4,72
R a,24,10,20
CV 99,74
MB 84,4,76
E 76
W 3
MB 80,8,80
G 43,20,66,3
R a,28,11,20
MB 84,8,84
v_xor_b32 v8, s70, v8
E 77
MB 80,12,88
s_waitcnt vmcnt(12)
s_barrier
T 32,16,32
T 34,16,36
CV 102,76
MB 84,12,92
v_xor_b32 v9, s70, v9
E 78
s_xor_b32 m0, s65, 0x18000
s_xor_b32 s66, s61, 0x40000
W 4
ZB 88,16,64
G 40,20,66,0
T 36,17,32
ZB 92,16,68
T 38,17,36
v_xor_b32 v10, s70, v10
E 79
MB 88,20,72
T 40,18,32
T 42,18,36
MB 92,20,76
CV 103,78
v_xor_b32 v11, s70, v11
W 6
MB 88,24,80
G 41,20,66,1
T 44,19,32
MB 92,24,84
T 46,19,36
v_xor_b32 v12, s70, v12
E 80
MB 88,28,88
T 48,20,32
T 50,20,36
MB 92,28,92
v_xor_b32 v13, s70, v13
E 81
W 6
MC 96,32,96
G 42,20,66,2
T 52,21,32
T 54,21,36
MC 100,32,100
CV 104,80
v_xor_b32 v14, s70, v14
E 82
MC 104,36,96
T 56,22,32
T 58,22,36
MC 108,36,100
v_xor_b32 v15, s70, v15
E 83
W 6
MC 112,40,96
G 43,20,66,3
T 60,23,32
MC 116,40,100
T 62,23,36
CV 105,82
E 84
MC 120,44,96
E 85
MC 124,44,100
W 4
MC 128,48,96
CV 108,84
MC 132,48,100
E 86
MC 136,52,96
E 87
MC 140,52,100
W 0
MC 144,56,96
CV 109,86
MC 148,56,100
E 88
MC 152,60,96
E 89
MC 156,60,100
MD 112,52,96
CV 106,88
MD 116,52,100
E 90
E 91
s_nop 0
CV 107,90
E 92
E 93
s_waitcnt vmcnt(12)
s_barrier
T 32,16,48
T 34,16,52
CV 110,92
E 94
s_xor_b32 m0, s65, 0x1c000
s_xor_b32 s66, s60, 0x100
T 36,17,48
T 38,17,52
G 36,8,66,0
E 95
T 40,18,48
T 42,18,52
CV 111,94
T 44,19,48
T 46,19,52
G 37,8,66,1
T 48,20,48
T 50,20,52
W 6
MC 96,32,104
G 38,8,66,2
MC 100,32,108
T 52,21,48
T 54,21,52
MC 104,36,104
T 56,22,48
MC 108,36,108
T 58,22,52
W 6
MC 112,40,104
G 39,8,66,3
MC 116,40,108
T 60,23,48
T 62,23,52
MC 120,44,104
MC 124,44,108
W 4
MC 128,48,104
MC 132,48,108
MC 136,52,104
MC 140,52,108
W 0
MC 144,56,104
MC 148,56,108
MC 152,60,104
MC 156,60,108
MD 112,52,104
MD 116,52,108
s_nop 6
v_add_f32 v60, v112, v6
v_add_f32 v61, v116, v7
v_cmp_nle_f32 vcc, s76, v60
v_cmp_nge_f32 s[82:83], s77, v60
v_cmp_nle_f32 s[84:85], s76, v61
v_cmp_nge_f32 s[90:91], s77, v61
s_nop 1
s_or_b64 vcc, vcc, s[82:83]
s_or_b64 vcc, vcc, s[84:85]
s_or_b64 vcc, vcc, s[90:91]
s_cbranch_scc1 L_slow_c3B0
L_back_c3B0:
v_rcp_f32 v0, v60
v_rcp_f32 v1, v61
AR 112,96
AR 113,97
AR 114,98
AR 115,99
AR 116,100
AR 117,101
AR 118,102
AR 119,103
AR 120,104
AR 121,105
AR 122,106
AR 123,107
AR 124,108
AR 125,109
AR 126,110
AR 127,111
v_pk_mul_f32 v[112:113], v[112:113], v[0:1] op_sel_hi:[1,0]
v_pk_mul_f32 v[114:115], v[114:115], v[0:1] op_sel_hi:[1,0]
v_pk_mul_f32 v[116:117], v[116:117], v[0:1] op_sel:[0,1]
v_pk_mul_f32 v[118:119], v[118:119], v[0:1] op_sel:[0,1]
v_pk_mul_f32 v[120:121], v[120:121], v[0:1] op_sel_hi:[1,0]
v_pk_mul_f32 v[122:123], v[122:123], v[0:1] op_sel_hi:[1,0]
v_pk_mul_f32 v[124:125], v[124:125], v[0:1] op_sel:[0,1]
v_pk_mul_f32 v[126:127], v[126:127], v[0:1] op_sel:[0,1]
CV 112,112
CV 114,114
CV 116,116
CV 118,118
CV 120,120
CV 122,122
CV 124,124
CV 126,126
AW 64,112
AW 65,114
AW 68,116
AW 69,118
AW 66,120
AW 67,122
AW 70,124
AW 71,126
AR 112,112
AR 113,113
AR 114,114
AR 115,115
AR 116,116
AR 117,117
AR 118,118
AR 119,119
AR 120,120
AR 121,121
AR 122,122
AR 123,123
AR 124,124
AR 125,125
AR 126,126
AR 127,127
v_pk_mul_f32 v[112:113], v[112:113], v[0:1] op_sel_hi:[1,0]
v_pk_mul_f32 v[114:115], v[114:115], v[0:1] op_sel_hi:[1,0]
v_pk_mul_f32 v[116:117], v[116:117], v[0:1] op_sel:[0,1]
v_pk_mul_f32 v[118:119], v[118:119], v[0:1] op_sel:[0,1]
v_pk_mul_f32 v[120:121], v[120:121], v[0:1] op_sel_hi:[1,0]
v_pk_mul_f32 v[122:123], v[122:123], v[0:1] op_sel_hi:[1,0]
v_pk_mul_f32 v[124:125], v[124:125], v[0:1] op_sel:[0,1]
v_pk_mul_f32 v[126:127], v[126:127], v[0:1] op_sel:[0,1]
CV 112,112
CV 114,114
CV 116,116
CV 118,118
CV 120,120
CV 122,122
CV 124,124
CV 126,126
AW 72,112
AW 73,114
AW 76,116
AW 77,118
AW 74,120
AW 75,122
AW 78,124
AW 79,126
AR 112,128
AR 113,129
AR 114,130
AR 115,131
AR 116,132
AR 117,133
AR 118,134
AR 119,135
AR 120,136
AR 121,137
AR 122,138
AR 123,139
AR 124,140
AR 125,141
AR 126,142
AR 127,143
v_pk_mul_f32 v[112:113], v[112:113], v[0:1] op_sel_hi:[1,0]
v_pk_mul_f32 v[114:115], v[114:115], v[0:1] op_sel_hi:[1,0]
v_pk_mul_f32 v[116:117], v[116:117], v[0:1] op_sel:[0,1]
v_pk_mul_f32 v[118:119], v[118:119], v[0:1] op_sel:[0,1]
v_pk_mul_f32 v[120:121], v[120:121], v[0:1] op_sel_hi:[1,0]
v_pk_mul_f32 v[122:123], v[122:123], v[0:1] op_sel_hi:[1,0]
v_pk_mul_f32 v[124:125], v[124:125], v[0:1] op_sel:[0,1]
v_pk_mul_f32 v[126:127], v[126:127], v[0:1] op_sel:[0,1]
CV 112,112
CV 114,114
CV 116,116
CV 118,118
CV 120,120
CV 122,122
CV 124,124
CV 126,126
AW 80,112
AW 81,114
AW 84,116
AW 85,118
AW 82,120
AW 83,122
AW 86,124
AW 87,126
AR 112,144
AR 113,145
AR 114,146
AR 115,147
AR 116,148
AR 117,149
AR 118,150
AR 119,151
AR 120,152
AR 121,153
AR 122,154
AR 123,155
AR 124,156
AR 125,157
AR 126,158
AR 127,159
v_pk_mul_f32 v[112:113], v[112:113], v[0:1] op_sel_hi:[1,0]
v_pk_mul_f32 v[114:115], v[114:115], v[0:1] op_sel_hi:[1,0]
v_pk_mul_f32 v[116:117], v[116:117], v[0:1] op_sel:[0,1]
v_pk_mul_f32 v[118:119], v[118:119], v[0:1] op_sel:[0,1]
v_pk_mul_f32 v[120:121], v[120:121], v[0:1] op_sel_hi:[1,0]
v_pk_mul_f32 v[122:123], v[122:123], v[0:1] op_sel_hi:[1,0]
v_pk_mul_f32 v[124:125], v[124:125], v[0:1] op_sel:[0,1]
v_pk_mul_f32 v[126:127], v[126:127], v[0:1] op_sel:[0,1]
CV 112,112
CV 114,114
CV 116,116
CV 118,118
CV 120,120
CV 122,122
CV 124,124
CV 126,126
AW 88,112
AW 89,114
AW 92,116
AW 93,118
AW 90,120
AW 91,122
AW 94,124
AW 95,126
s_waitcnt vmcnt(8)
s_barrier
R v,128,12,0
R v,132,12,4
R v,136,13,0
R v,140,13,4
R v,144,14,0
R v,148,14,4
R v,152,15,0
R v,156,15,4
T 0,24,16
T 2,24,20
T 4,25,16
T 6,25,20
T 8,26,16
T 10,26,20
T 12,27,16
W 14
T 14,27,20
W 14
T 16,28,16
W 14
T 18,28,20
s_xor_b32 m0, s65, 0x0
s_xor_b32 s66, s61, 0x80000
G 40,20,66,0
G 41,20,66,1
G 42,20,66,2
W 6
ZA 64,0,128
G 43,20,66,3
s_xor_b32 m0, s65, 0x4000
s_xor_b32 s66, s61, 0xc0000
ZA 68,0,132
G 40,20,66,0
G 41,20,66,1
T 20,29,16
T 22,29,20
ZA 72,4,128
G 42,20,66,2
G 43,20,66,3
s_xor_b32 m0, s65, 0x8000
ZA 76,4,132
s_xor_b32 s66, s61, 0x100000
G 40,20,66,0
T 24,30,16
T 26,30,20
W 6
ZA 80,8,128
G 41,20,66,1
G 42,20,66,2
ZA 84,8,132
G 43,20,66,3
T 28,31,16
T 30,31,20
ZA 88,12,128
s_waitcnt vmcnt(16)
s_barrier
T 32,24,32
ZA 92,12,132
T 34,24,36
s_xor_b32 m0, s65, 0xc000
s_xor_b32 s66, s61, 0x140000
W 6
ZA 96,16,128
G 40,20,66,0
ZA 100,16,132
T 36,25,32
T 38,25,36
ZA 104,20,128
G 41,20,66,1
ZA 108,20,132
T 40,26,32
T 42,26,36
W 6
ZA 112,24,128
G 42,20,66,2
ZA 116,24,132
T 44,27,32
T 46,27,36
ZA 120,28,128
G 43,20,66,3
ZA 124,28,132
T 48,28,32
T 50,28,36
W 6
MA 64,32,136
s_waitcnt vmcnt(16)
s_barrier
s_xor_b32 m0, s65, 0x10000
s_xor_b32 s66, s60, 0x200
G 36,8,66,0
MA 68,32,140
G 37,8,66,1
T 52,29,32
T 54,29,36
R v,160,12,48
MA 72,36,136
G 38,8,66,2
MA 76,36,140
T 56,30,32
T 58,30,36
R v,164,12,52
W 8
MA 80,40,136
G 39,8,66,3
MA 84,40,140
T 60,31,32
T 62,31,36
R v,168,13,48
MA 88,44,136
s_waitcnt vmcnt(16)
s_barrier
MA 92,44,140
R v,172,13,52
T 0,16,0
T 2,16,4
W 10
MA 96,48,136
R v,176,14,48
MA 100,48,140
T 4,17,0
T 6,17,4
MA 104,52,136
R v,180,14,52
MA 108,52,140
T 8,18,0
W 14
T 10,18,4
W 10
MA 112,56,136
R v,184,15,48
MA 116,56,140
T 12,19,0
T 14,19,4
MA 120,60,136
R v,188,15,52
MA 124,60,140
T 16,20,0
W 14
T 18,20,4
W 9
MA 64,0,144
T 20,21,0
MA 68,0,148
T 22,21,4
MA 72,4,144
T 24,22,0
MA 76,4,148
T 26,22,4
W 7
MA 80,8,144
T 28,23,0
MA 84,8,148
T 30,23,4
MA 88,12,144
s_waitcnt vmcnt(12) lgkmcnt(8)
s_barrier
s_xor_b32 m0, s65, 0x14000
s_xor_b32 s66, s61, 0x180000
MA 92,12,148
G 40,20,66,0
T 32,16,16
T 34,16,20
W 6
MA 96,16,144
G 41,20,66,1
MA 100,16,148
T 36,17,16
T 38,17,20
s_getpc_b64 s[88:89]
L_ct3_562:
s_and_b32 s89, s89, 0xffff
s_mov_b32 s90, L_code_end-L_ct3_562
s_mov_b32 s91, 0x20000
v_and_b32 v62, 0x70, v59
v_lshlrev_b32 v62, 3, v62
s_add_u32 s7, s1, 4096
buffer_load_dword v3, v62, s[88:91], s7 offen
MA 104,20,144
G 42,20,66,2
MA 108,20,148
T 40,18,16
T 42,18,20
W 6
MA 112,24,144
G 43,20,66,3
MA 116,24,148
T 44,19,16
T 46,19,20
MA 120,28,144
s_xor_b32 m0, s65, 0x18000
s_xor_b32 s66, s61, 0x1c0000
MA 124,28,148
G 40,20,66,0
T 48,20,16
T 50,20,20
W 6
MA 64,32,152
G 41,20,66,1
MA 68,32,156
T 52,21,16
T 54,21,20
MA 72,36,152
G 42,20,66,2
MA 76,36,156
T 56,22,16
T 58,22,20
W 6
MA 80,40,152
G 43,20,66,3
MA 84,40,156
T 60,23,16
T 62,23,20
MA 88,44,152
s_waitcnt vmcnt(17)
s_barrier
T 0,16,32
MA 92,44,156
T 2,16,36
s_xor_b32 m0, s65, 0x1c000
s_xor_b32 s66, s61, 0x200000
W 6
MA 96,48,152
G 40,20,66,0
MA 100,48,156
T 4,17,32
T 6,17,36
MA 104,52,152
T 8,18,32
MA 108,52,156
T 10,18,36
W 6
MA 112,56,152
G 41,20,66,1
MA 116,56,156
T 12,19,32
T 14,19,36
MA 120,60,152
T 16,20,32
MA 124,60,156
T 18,20,36
W 6
MA 64,0,160
G 42,20,66,2
MA 68,0,164
T 20,21,32
T 22,21,36
MA 72,4,160
T 24,22,32
MA 76,4,164
T 26,22,36
W 6
MA 80,8,160
G 43,20,66,3
MA 84,8,164
T 28,23,32
T 30,23,36
MA 88,12,160
s_waitcnt vmcnt(17)
s_barrier
T 32,16,48
MA 92,12,164
T 34,16,52
s_xor_b32 m0, s65, 0x0
s_xor_b32 s66, s61, 0x240000
W 6
MA 96,16,160
G 40,20,66,0
MA 100,16,164
T 36,17,48
T 38,17,52
MA 104,20,160
G 41,20,66,1
MA 108,20,164
T 40,18,48
T 42,18,52
W 6
MA 112,24,160
G 42,20,66,2
MA 116,24,164
T 44,19,48
T 46,19,52
MA 120,28,160
G 43,20,66,3
MA 124,28,164
T 48,20,48
T 50,20,52
W 6
MA 64,32,168
s_waitcnt vmcnt(17)
s_barrier
s_xor_b32 m0, s65, 0x4000
s_xor_b32 s66, s60, 0x300
G 36,8,66,0
MA 68,32,172
G 37,8,66,1
T 52,21,48
T 54,21,52
R v,192,12,0
MA 72,36,168
G 38,8,66,2
MA 76,36,172
T 56,22,48
T 58,22,52
R v,196,12,4
W 8
MA 80,40,168
G 39,8,66,3
MA 84,40,172
T 60,23,48
T 62,23,52
R v,200,13,0
MA 88,44,168
s_waitcnt vmcnt(16)
s_barrier
MA 92,44,172
R v,204,13,4
T 0,24,16
T 2,24,20
W 10
MA 96,48,168
R v,208,14,0
MA 100,48,172
T 4,25,16
T 6,25,20
MA 104,52,168
R v,212,14,4
MA 108,52,172
T 8,26,16
W 14
T 10,26,20
W 10
MA 112,56,168
R v,216,15,0
MA 116,56,172
T 12,27,16
T 14,27,20
MA 120,60,168
R v,220,15,4
MA 124,60,172
T 16,28,16
W 14
T 18,28,20
W 9
MA 64,0,176
T 20,29,16
MA 68,0,180
T 22,29,20
MA 72,4,176
T 24,30,16
MA 76,4,180
T 26,30,20
W 7
MA 80,8,176
T 28,31,16
MA 84,8,180
T 30,31,20
MA 88,12,176
s_waitcnt vmcnt(12) lgkmcnt(8)
s_barrier
s_xor_b32 m0, s65, 0x8000
s_xor_b32 s66, s61, 0x280000
MA 92,12,180
G 40,20,66,0
T 32,24,32
T 34,24,36
W 6
MA 96,16,176
G 41,20,66,1
MA 100,16,180
T 36,25,32
T 38,25,36
MA 104,20,176
G 42,20,66,2
MA 108,20,180
T 40,26,32
T 42,26,36
W 6
MA 112,24,176
G 43,20,66,3
MA 116,24,180
T 44,27,32
T 46,27,36
MA 120,28,176
s_xor_b32 m0, s65, 0xc000
s_xor_b32 s66, s61, 0x2c0000
MA 124,28,180
G 40,20,66,0
T 48,28,32
T 50,28,36
W 6
MA 64,32,184
G 41,20,66,1
MA 68,32,188
T 52,29,32
T 54,29,36
MA 72,36,184
G 42,20,66,2
MA 76,36,188
T 56,30,32
T 58,30,36
W 6
MA 80,40,184
G 43,20,66,3
MA 84,40,188
T 60,31,32
T 62,31,36
MA 88,44,184
s_waitcnt vmcnt(16)
s_barrier
T 0,24,48
MA 92,44,188
T 2,24,52
s_xor_b32 m0, s65, 0x10000
s_xor_b32 s66, s61, 0x300000
W 6
MA 96,48,184
G 40,20,66,0
MA 100,48,188
T 4,25,48
T 6,25,52
MA 104,52,184
T 8,26,48
MA 108,52,188
T 10,26,52
W 6
MA 112,56,184
G 41,20,66,1
MA 116,56,188
T 12,27,48
T 14,27,52
MA 120,60,184
T 16,28,48
MA 124,60,188
T 18,28,52
W 6
MA 64,0,192
G 42,20,66,2
MA 68,0,196
T 20,29,48
T 22,29,52
MA 72,4,192
T 24,30,48
MA 76,4,196
T 26,30,52
W 6
MA 80,8,192
G 43,20,66,3
MA 84,8,196
T 28,31,48
T 30,31,52
MA 88,12,192
s_waitcnt vmcnt(16)
s_barrier
T 32,16,0
MA 92,12,196
T 34,16,4
s_xor_b32 m0, s65, 0x14000
s_xor_b32 s66, s61, 0x340000
W 6
MA 96,16,192
G 40,20,66,0
MA 100,16,196
T 36,17,0
T 38,17,4
MA 104,20,192
G 41,20,66,1
MA 108,20,196
T 40,18,0
T 42,18,4
W 6
MA 112,24,192
G 42,20,66,2
MA 116,24,196
T 44,19,0
T 46,19,4
MA 120,28,192
G 43,20,66,3
MA 124,28,196
T 48,20,0
T 50,20,4
W 6
MA 64,32,200
s_waitcnt vmcnt(16)
s_barrier
s_xor_b32 m0, s65, 0x18000
s_xor_b32 s66, s61, 0x380000
G 40,20,66,0
MA 68,32,204
G 41,20,66,1
T 52,21,0
T 54,21,4
R v,224,8,16
MA 72,36,200
G 42,20,66,2
MA 76,36,204
T 56,22,0
T 58,22,4
R v,228,8,20
W 8
MA 80,40,200
G 43,20,66,3
MA 84,40,204
T 60,23,0
T 62,23,4
R v,232,9,16
MA 88,44,200
s_waitcnt vmcnt(16)
s_barrier
MA 92,44,204
R v,236,9,20
T 0,16,32
T 2,16,36
W 10
MA 96,48,200
R v,240,10,16
MA 100,48,204
T 4,17,32
T 6,17,36
MA 104,52,200
R v,244,10,20
MA 108,52,204
T 8,18,32
W 14
T 10,18,36
W 10
MA 112,56,200
R v,248,11,16
MA 116,56,204
T 12,19,32
T 14,19,36
MA 120,60,200
R v,252,11,20
T 16,20,32
MA 124,60,204
W 14
T 18,20,36
v_xor_b32 v8, s69, v8
W 9
MA 64,0,208
T 20,21,32
MA 68,0,212
T 22,21,36
v_xor_b32 v9, s69, v9
MA 72,4,208
T 24,22,32
MA 76,4,212
T 26,22,36
v_xor_b32 v10, s69, v10
W 7
MA 80,8,208
T 28,23,32
MA 84,8,212
T 30,23,36
v_xor_b32 v11, s69, v11
MA 88,12,208
s_waitcnt vmcnt(12) lgkmcnt(8)
s_barrier
s_xor_b32 m0, s65, 0x1c000
s_xor_b32 s66, s61, 0x3c0000
MA 92,12,212
G 40,20,66,0
T 32,16,48
T 34,16,52
v_xor_b32 v12, s69, v12
W 6
MA 96,16,208
G 41,20,66,1
MA 100,16,212
T 36,17,48
T 38,17,52
v_xor_b32 v13, s69, v13
MA 104,20,208
G 42,20,66,2
MA 108,20,212
T 40,18,48
T 42,18,52
v_xor_b32 v14, s69, v14
W 6
MA 112,24,208
G 43,20,66,3
MA 116,24,212
T 44,19,48
T 46,19,52
v_xor_b32 v15, s69, v15
MA 120,28,208
s_xor_b32 m0, s65, 0x0
s_xor_b32 s66, s61, 0x200
MA 124,28,212
G 40,20,66,0
T 48,20,48
T 50,20,52
W 6
MA 64,32,216
G 41,20,66,1
MA 68,32,220
T 52,21,48
T 54,21,52
MA 72,36,216
G 42,20,66,2
MA 76,36,220
T 56,22,48
T 58,22,52
W 6
MA 80,40,216
G 43,20,66,3
MA 84,40,220
T 60,23,48
T 62,23,52
MA 88,44,216
s_waitcnt vmcnt(16)
s_barrier
T 0,24,0
MA 92,44,220
T 2,24,4
s_xor_b32 m0, s65, 0x4000
s_xor_b32 s66, s61, 0x40200
W 6
MA 96,48,216
G 40,20,66,0
MA 100,48,220
T 4,25,0
T 6,25,4
MA 104,52,216
T 8,26,0
MA 108,52,220
T 10,26,4
W 6
MA 112,56,216
G 41,20,66,1
MA 116,56,220
T 12,27,0
T 14,27,4
MA 120,60,216
T 16,28,0
MA 124,60,220
T 18,28,4
W 6
MA 64,0,224
G 42,20,66,2
MA 68,0,228
T 20,29,0
T 22,29,4
MA 72,4,224
T 24,30,0
MA 76,4,228
T 26,30,4
W 6
MA 80,8,224
G 43,20,66,3
MA 84,8,228
T 28,31,0
T 30,31,4
MA 88,12,224
s_waitcnt vmcnt(16)
s_barrier
T 32,24,16
MA 92,12,228
T 34,24,20
s_xor_b32 m0, s65, 0x8000
s_xor_b32 s66, s61, 0x80200
W 6
MA 96,16,224
G 40,20,66,0
MA 100,16,228
T 36,25,16
T 38,25,20
MA 104,20,224
T 40,26,16
MA 108,20,228
T 42,26,20
W 6
MA 112,24,224
G 41,20,66,1
MA 116,24,228
T 44,27,16
T 46,27,20
MA 120,28,224
T 48,28,16
MA 124,28,228
T 50,28,20
W 6
MA 64,32,232
G 42,20,66,2
MA 68,32,236
T 52,29,16
T 54,29,20
MA 72,36,232
T 56,30,16
MA 76,36,236
T 58,30,20
W 6
MA 80,40,232
G 43,20,66,3
MA 84,40,236
T 60,31,16
T 62,31,20
MA 88,44,232
s_waitcnt vmcnt(16)
s_barrier
T 0,24,32
MA 92,44,236
T 2,24,36
s_xor_b32 m0, s65, 0xc000
s_xor_b32 s66, s61, 0xc0200
W 6
MA 96,48,232
G 40,20,66,0
MA 100,48,236
T 4,25,32
T 6,25,36
MA 104,52,232
T 8,26,32
MA 108,52,236
T 10,26,36
W 6
MA 112,56,232
G 41,20,66,1
MA 116,56,236
T 12,27,32
T 14,27,36
MA 120,60,232
T 16,28,32
MA 124,60,236
T 18,28,36
W 6
MA 64,0,240
G 42,20,66,2
MA 68,0,244
T 20,29,32
T 22,29,36
MA 72,4,240
T 24,30,32
MA 76,4,244
T 26,30,36
W 6
MA 80,8,240
G 43,20,66,3
MA 84,8,244
T 28,31,32
T 30,31,36
MA 88,12,240
s_waitcnt vmcnt(16)
s_barrier
T 32,24,48
MA 92,12,244
T 34,24,52
s_xor_b32 m0, s65, 0x10000
s_xor_b32 s66, s61, 0x100200
W 6
MA 96,16,240
G 40,20,66,0
MA 100,16,244
T 36,25,48
T 38,25,52
MA 104,20,240
T 40,26,48
MA 108,20,244
T 42,26,52
W 6
MA 112,24,240
G 41,20,66,1
MA 116,24,244
T 44,27,48
T 46,27,52
MA 120,28,240
T 48,28,48
MA 124,28,244
T 50,28,52
W 6
MA 64,32,248
G 42,20,66,2
MA 68,32,252
T 52,29,48
T 54,29,52
MA 72,36,248
T 56,30,48
MA 76,36,252
T 58,30,52
W 6
MA 80,40,248
G 43,20,66,3
MA 84,40,252
T 60,31,48
T 62,31,52
MA 88,44,248
s_waitcnt vmcnt(16)
s_barrier
T 0,16,0
MA 92,44,252
T 2,16,4
s_xor_b32 m0, s65, 0x14000
s_xor_b32 s66, s61, 0x140200
W 6
MA 96,48,248
G 40,20,66,0
G 41,20,66,1
MA 100,48,252
G 42,20,66,2
G 43,20,66,3
T 4,17,0
T 6,17,4
MA 104,52,248
T 8,18,0
MA 108,52,252
T 10,18,4
W 6
MA 112,56,248
T 12,19,0
MA 116,56,252
T 14,19,4
MA 120,60,248
T 16,20,0
MA 124,60,252
T 18,20,4
v_pk_mul_f32 v[64:65], v[64:65], s[74:75]
v_pk_mul_f32 v[66:67], v[66:67], s[74:75]
v_pk_mul_f32 v[68:69], v[68:69], s[74:75]
v_pk_mul_f32 v[70:71], v[70:71], s[74:75]
v_pk_mul_f32 v[72:73], v[72:73], s[74:75]
v_pk_mul_f32 v[74:75], v[74:75], s[74:75]
v_pk_mul_f32 v[76:77], v[76:77], s[74:75]
v_pk_mul_f32 v[78:79], v[78:79], s[74:75]
CV 64,64
CV 66,66
CV 68,68
CV 70,70
CV 72,72
CV 74,74
CV 76,76
CV 78,78
v_permlane32_swap_b32 v64, v72
v_permlane32_swap_b32 v66, v74
v_permlane32_swap_b32 v68, v76
v_permlane32_swap_b32 v70, v78
v_permlane16_swap_b32 v64, v72
v_permlane16_swap_b32 v66, v74
v_permlane16_swap_b32 v68, v76
v_permlane16_swap_b32 v70, v78
AW 192,64
AW 193,66
AW 194,72
AW 195,74
AW 196,68
AW 197,70
AW 198,76
AW 199,78
v_pk_mul_f32 v[80:81], v[80:81], s[74:75]
v_pk_mul_f32 v[82:83], v[82:83], s[74:75]
v_pk_mul_f32 v[84:85], v[84:85], s[74:75]
v_pk_mul_f32 v[86:87], v[86:87], s[74:75]
v_pk_mul_f32 v[88:89], v[88:89], s[74:75]
v_pk_mul_f32 v[90:91], v[90:91], s[74:75]
v_pk_mul_f32 v[92:93], v[92:93], s[74:75]
v_pk_mul_f32 v[94:95], v[94:95], s[74:75]
CV 80,80
CV 82,82
CV 84,84
CV 86,86
CV 88,88
CV 90,90
CV 92,92
CV 94,94
v_permlane32_swap_b32 v80, v88
v_permlane32_swap_b32 v82, v90
v_permlane32_swap_b32 v84, v92
v_permlane32_swap_b32 v86, v94
v_permlane16_swap_b32 v80, v88
v_permlane16_swap_b32 v82, v90
v_permlane16_swap_b32 v84, v92
v_permlane16_swap_b32 v86, v94
AW 200,80
AW 201,82
AW 202,88
AW 203,90
AW 204,84
AW 205,86
AW 206,92
AW 207,94
v_pk_mul_f32 v[96:97], v[96:97], s[74:75]
v_pk_mul_f32 v[98:99], v[98:99], s[74:75]
v_pk_mul_f32 v[100:101], v[100:101], s[74:75]
v_pk_mul_f32 v[102:103], v[102:103], s[74:75]
v_pk_mul_f32 v[104:105], v[104:105], s[74:75]
v_pk_mul_f32 v[106:107], v[106:107], s[74:75]
v_pk_mul_f32 v[108:109], v[108:109], s[74:75]
v_pk_mul_f32 v[110:111], v[110:111], s[74:75]
CV 96,96
CV 98,98
CV 100,100
CV 102,102
CV 104,104
CV 106,106
CV 108,108
CV 110,110
v_permlane32_swap_b32 v96, v104
v_permlane32_swap_b32 v98, v106
v_permlane32_swap_b32 v100, v108
v_permlane32_swap_b32 v102, v110
v_permlane16_swap_b32 v96, v104
v_permlane16_swap_b32 v98, v106
v_permlane16_swap_b32 v100, v108
v_permlane16_swap_b32 v102, v110
AW 208,96
AW 209,98
AW 210,104
AW 211,106
AW 212,100
AW 213,102
AW 214,108
AW 215,110
v_pk_mul_f32 v[112:113], v[112:113], s[74:75]
v_pk_mul_f32 v[114:115], v[114:115], s[74:75]
v_pk_mul_f32 v[116:117], v[116:117], s[74:75]
v_pk_mul_f32 v[118:119], v[118:119], s[74:75]
v_pk_mul_f32 v[120:121], v[120:121], s[74:75]
v_pk_mul_f32 v[122:123], v[122:123], s[74:75]
v_pk_mul_f32 v[124:125], v[124:125], s[74:75]
v_pk_mul_f32 v[126:127], v[126:127], s[74:75]
CV 112,112
CV 114,114
CV 116,116
CV 118,118
CV 120,120
CV 122,122
CV 124,124
CV 126,126
v_permlane32_swap_b32 v112, v120
v_permlane32_swap_b32 v114, v122
v_permlane32_swap_b32 v116, v124
v_permlane32_swap_b32 v118, v126
v_permlane16_swap_b32 v112, v120
v_permlane16_swap_b32 v114, v122
v_permlane16_swap_b32 v116, v124
v_permlane16_swap_b32 v118, v126
AW 216,112
AW 217,114
AW 218,120
AW 219,122
AW 220,116
AW 221,118
AW 222,124
AW 223,126
W 6
ZA 64,0,128
T 20,21,0
ZA 68,0,132
T 22,21,4
ZA 72,4,128
T 24,22,0
ZA 76,4,132
T 26,22,4
W 6
ZA 80,8,128
T 28,23,0
ZA 84,8,132
T 30,23,4
ZA 88,12,128
s_waitcnt vmcnt(16)
s_barrier
T 32,16,16
ZA 92,12,132
T 34,16,20
s_xor_b32 m0, s65, 0x18000
s_xor_b32 s66, s61, 0x180200
W 6
ZA 96,16,128
G 40,20,66,0
G 41,20,66,1
ZA 100,16,132
G 42,20,66,2
G 43,20,66,3
T 36,17,16
T 38,17,20
ZA 104,20,128
T 40,18,16
ZA 108,20,132
T 42,18,20
W 6
ZA 112,24,128
T 44,19,16
ZA 116,24,132
T 46,19,20
ZA 120,28,128
T 48,20,16
ZA 124,28,132
T 50,20,20
W 6
MA 64,32,136
T 52,21,16
MA 68,32,140
T 54,21,20
MA 72,36,136
T 56,22,16
MA 76,36,140
T 58,22,20
W 6
MA 80,40,136
T 60,23,16
MA 84,40,140
T 62,23,20
MA 88,44,136
s_waitcnt vmcnt(16)
s_barrier
T 0,16,32
MA 92,44,140
T 2,16,36
s_xor_b32 m0, s65, 0x1c000
s_xor_b32 s66, s61, 0x1c0200
W 6
MA 96,48,136
G 40,20,66,0
G 41,20,66,1
MA 100,48,140
G 42,20,66,2
G 43,20,66,3
T 4,17,32
T 6,17,36
MA 104,52,136
T 8,18,32
MA 108,52,140
T 10,18,36
W 6
MA 112,56,136
T 12,19,32
MA 116,56,140
T 14,19,36
MA 120,60,136
T 16,20,32
MA 124,60,140
T 18,20,36
W 6
MA 64,0,144
T 20,21,32
MA 68,0,148
T 22,21,36
MA 72,4,144
T 24,22,32
MA 76,4,148
T 26,22,36
W 6
MA 80,8,144
T 28,23,32
MA 84,8,148
T 30,23,36
MA 88,12,144
s_waitcnt vmcnt(16)
s_barrier
T 32,16,48
MA 92,12,148
T 34,16,52
s_xor_b32 m0, s65, 0x0
s_xor_b32 s66, s61, 0x200200
W 6
MA 96,16,144
G 40,20,66,0
G 41,20,66,1
MA 100,16,148
G 42,20,66,2
G 43,20,66,3
T 36,17,48
T 38,17,52
s_getpc_b64 s[88:89]
L_ct3_690:
s_and_b32 s89, s89, 0xffff
s_mov_b32 s90, L_code_end-L_ct3_690
s_mov_b32 s91, 0x20000
v_and_b32 v62, 0x70, v59
v_lshlrev_b32 v62, 3, v62
s_add_u32 s7, s1, 4096
buffer_load_dword v3, v62, s[88:91], s7 offen
MA 104,20,144
T 40,18,48
MA 108,20,148
T 42,18,52
W 6
MA 112,24,144
T 44,19,48
MA 116,24,148
T 46,19,52
MA 120,28,144
T 48,20,48
MA 124,28,148
T 50,20,52
W 6
MA 64,32,152
T 52,21,48
MA 68,32,156
T 54,21,52
MA 72,36,152
T 56,22,48
MA 76,36,156
T 58,22,52
W 6
MA 80,40,152
T 60,23,48
MA 84,40,156
T 62,23,52
MA 88,44,152
s_waitcnt vmcnt(17)
s_barrier
T 0,24,0
MA 92,44,156
T 2,24,4
s_xor_b32 m0, s65, 0x4000
s_xor_b32 s66, s61, 0x240200
W 6
MA 96,48,152
G 40,20,66,0
G 41,20,66,1
MA 100,48,156
G 42,20,66,2
G 43,20,66,3
T 4,25,0
T 6,25,4
MA 104,52,152
T 8,26,0
MA 108,52,156
T 10,26,4
W 6
MA 112,56,152
T 12,27,0
MA 116,56,156
T 14,27,4
MA 120,60,152
T 16,28,0
MA 124,60,156
T 18,28,4
W 6
MA 64,0,160
T 20,29,0
MA 68,0,164
T 22,29,4
MA 72,4,160
T 24,30,0
MA 76,4,164
T 26,30,4
W 6
MA 80,8,160
T 28,31,0
MA 84,8,164
T 30,31,4
MA 88,12,160
s_waitcnt vmcnt(17)
s_barrier
T 32,24,16
MA 92,12,164
T 34,24,20
s_xor_b32 m0, s65, 0x8000
s_xor_b32 s66, s61, 0x280200
W 6
MA 96,16,160
G 40,20,66,0
G 41,20,66,1
MA 100,16,164
G 42,20,66,2
G 43,20,66,3
T 36,25,16
T 38,25,20
MA 104,20,160
T 40,26,16
MA 108,20,164
T 42,26,20
W 6
MA 112,24,160
T 44,27,16
MA 116,24,164
T 46,27,20
MA 120,28,160
T 48,28,16
MA 124,28,164
T 50,28,20
W 6
MA 64,32,168
T 52,29,16
MA 68,32,172
T 54,29,20
MA 72,36,168
T 56,30,16
MA 76,36,172
T 58,30,20
W 6
MA 80,40,168
T 60,31,16
MA 84,40,172
T 62,31,20
MA 88,44,168
s_waitcnt vmcnt(17)
s_barrier
T 0,24,32
MA 92,44,172
T 2,24,36
s_xor_b32 m0, s65, 0xc000
s_xor_b32 s66, s61, 0x2c0200
W 6
MA 96,48,168
G 40,20,66,0
G 41,20,66,1
MA 100,48,172
G 42,20,66,2
G 43,20,66,3
T 4,25,32
T 6,25,36
MA 104,52,168
T 8,26,32
MA 108,52,172
T 10,26,36
W 6
MA 112,56,168
T 12,27,32
MA 116,56,172
T 14,27,36
MA 120,60,168
T 16,28,32
MA 124,60,172
T 18,28,36
W 6
MA 64,0,176
T 20,29,32
MA 68,0,180
T 22,29,36
MA 72,4,176
T 24,30,32
MA 76,4,180
T 26,30,36
W 6
MA 80,8,176
T 28,31,32
MA 84,8,180
T 30,31,36
MA 88,12,176
s_waitcnt vmcnt(17)
s_barrier
T 32,24,48
MA 92,12,180
T 34,24,52
s_xor_b32 m0, s65, 0x10000
s_xor_b32 s66, s61, 0x300200
W 6
MA 96,16,176
G 40,20,66,0
G 41,20,66,1
MA 100,16,180
G 42,20,66,2
G 43,20,66,3
T 36,25,48
T 38,25,52
MA 104,20,176
T 40,26,48
MA 108,20,180
T 42,26,52
W 6
MA 112,24,176
T 44,27,48
MA 116,24,180
T 46,27,52
MA 120,28,176
T 48,28,48
MA 124,28,180
T 50,28,52
W 6
MA 64,32,184
T 52,29,48
MA 68,32,188
T 54,29,52
MA 72,36,184
T 56,30,48
MA 76,36,188
T 58,30,52
W 6
MA 80,40,184
T 60,31,48
MA 84,40,188
T 62,31,52
MA 88,44,184
s_waitcnt vmcnt(17)
s_barrier
T 0,16,0
MA 92,44,188
T 2,16,4
s_xor_b32 m0, s65, 0x14000
s_xor_b32 s66, s61, 0x340200
W 6
MA 96,48,184
G 40,20,66,0
G 41,20,66,1
MA 100,48,188
G 42,20,66,2
G 43,20,66,3
T 4,17,0
T 6,17,4
MA 104,52,184
T 8,18,0
MA 108,52,188
T 10,18,4
W 6
MA 112,56,184
T 12,19,0
MA 116,56,188
T 14,19,4
MA 120,60,184
T 16,20,0
MA 124,60,188
T 18,20,4
W 6
MA 64,0,192
T 20,21,0
MA 68,0,196
T 22,21,4
MA 72,4,192
T 24,22,0
MA 76,4,196
T 26,22,4
W 6
MA 80,8,192
T 28,23,0
MA 84,8,196
T 30,23,4
MA 88,12,192
s_waitcnt vmcnt(16)
s_barrier
T 32,16,16
MA 92,12,196
T 34,16,20
s_xor_b32 m0, s65, 0x18000
s_xor_b32 s66, s61, 0x380200
W 6
MA 96,16,192
G 40,20,66,0
G 41,20,66,1
MA 100,16,196
G 42,20,66,2
G 43,20,66,3
T 36,17,16
T 38,17,20
MA 104,20,192
T 40,18,16
MA 108,20,196
T 42,18,20
W 6
MA 112,24,192
T 44,19,16
MA 116,24,196
T 46,19,20
MA 120,28,192
T 48,20,16
MA 124,28,196
T 50,20,20
W 6
MA 64,32,200
T 52,21,16
MA 68,32,204
T 54,21,20
MA 72,36,200
T 56,22,16
MA 76,36,204
T 58,22,20
W 6
MA 80,40,200
T 60,23,16
MA 84,40,204
T 62,23,20
MA 88,44,200
s_waitcnt vmcnt(16)
s_barrier
T 0,16,32
MA 92,44,204
T 2,16,36
s_xor_b32 m0, s65, 0x1c000
s_xor_b32 s66, s61, 0x3c0200
W 6
MA 96,48,200
G 40,20,66,0
G 41,20,66,1
MA 100,48,204
G 42,20,66,2
G 43,20,66,3
T 4,17,32
T 6,17,36
MA 104,52,200
T 8,18,32
MA 108,52,204
T 10,18,36
W 6
MA 112,56,200
T 12,19,32
MA 116,56,204
T 14,19,36
MA 120,60,200
T 16,20,32
MA 124,60,204
T 18,20,36
W 6
MA 64,0,208
T 20,21,32
MA 68,0,212
T 22,21,36
MA 72,4,208
T 24,22,32
MA 76,4,212
T 26,22,36
W 6
MA 80,8,208
T 28,23,32
MA 84,8,212
T 30,23,36
MA 88,12,208
s_waitcnt vmcnt(16)
s_barrier
T 32,16,48
MA 92,12,212
T 34,16,52
s_xor_b32 m0, s65, 0x0
s_xor_b32 s66, s64, 0x0
W 6
MA 96,16,208
G 48,48,66,0,nt
G 49,48,66,1,nt
MA 100,16,212
G 50,48,66,2,nt
G 51,48,66,3,nt
T 36,17,48
T 38,17,52
MA 104,20,208
T 40,18,48
MA 108,20,212
T 42,18,52
W 6
MA 112,24,208
T 44,19,48
MA 116,24,212
T 46,19,52
MA 120,28,208
T 48,20,48
MA 124,28,212
T 50,20,52
W 6
MA 64,32,216
T 52,21,48
MA 68,32,220
T 54,21,52
MA 72,36,216
T 56,22,48
MA 76,36,220
T 58,22,52
W 6
MA 80,40,216
T 60,23,48
MA 84,40,220
T 62,23,52
MA 88,44,216
s_waitcnt vmcnt(16)
s_barrier
T 0,24,0
MA 92,44,220
T 2,24,4
s_xor_b32 m0, s65, 0x4000
s_xor_b32 s66, s64, 0x10000
W 6
MA 96,48,216
G 48,48,66,0,nt
G 49,48,66,1,nt
MA 100,48,220
G 50,48,66,2,nt
G 51,48,66,3,nt
T 4,25,0
T 6,25,4
MA 104,52,216
T 8,26,0
MA 108,52,220
T 10,26,4
W 6
MA 112,56,216
T 12,27,0
MA 116,56,220
T 14,27,4
MA 120,60,216
T 16,28,0
MA 124,60,220
T 18,28,4
W 6
MA 64,0,224
T 20,29,0
MA 68,0,228
T 22,29,4
MA 72,4,224
T 24,30,0
MA 76,4,228
T 26,30,4
W 6
MA 80,8,224
T 28,31,0
MA 84,8,228
T 30,31,4
MA 88,12,224
s_waitcnt vmcnt(16)
s_barrier
T 32,24,16
MA 92,12,228
T 34,24,20
s_xor_b32 m0, s65, 0x8000
s_xor_b32 s66, s64, 0x2000
W 6
MA 96,16,224
G 48,48,66,0,nt
G 49,48,66,1,nt
MA 100,16,228
G 50,48,66,2,nt
G 51,48,66,3,nt
T 36,25,16
T 38,25,20
MA 104,20,224
T 40,26,16
MA 108,20,228
T 42,26,20
W 6
MA 112,24,224
T 44,27,16
MA 116,24,228
T 46,27,20
MA 120,28,224
T 48,28,16
MA 124,28,228
T 50,28,20
W 6
MA 64,32,232
T 52,29,16
MA 68,32,236
T 54,29,20
MA 72,36,232
T 56,30,16
MA 76,36,236
T 58,30,20
W 6
MA 80,40,232
T 60,31,16
MA 84,40,236
T 62,31,20
MA 88,44,232
s_waitcnt vmcnt(16)
s_barrier
MA 92,44,236
T 0,24,32
T 2,24,36
W 6
MA 96,48,232
T 4,25,32
MA 100,48,236
T 6,25,36
MA 104,52,232
T 8,26,32
MA 108,52,236
T 10,26,36
W 6
MA 112,56,232
T 12,27,32
MA 116,56,236
T 14,27,36
MA 120,60,232
T 16,28,32
MA 124,60,236
T 18,28,36
W 6
MA 64,0,240
T 20,29,32
MA 68,0,244
T 22,29,36
MA 72,4,240
T 24,30,32
MA 76,4,244
T 26,30,36
W 6
MA 80,8,240
T 28,31,32
MA 84,8,244
T 30,31,36
MA 88,12,240
s_waitcnt vmcnt(12)
s_barrier
MA 92,12,244
T 32,24,48
T 34,24,52
W 6
MA 96,16,240
T 36,25,48
MA 100,16,244
T 38,25,52
MA 104,20,240
T 40,26,48
MA 108,20,244
T 42,26,52
W 6
MA 112,24,240
T 44,27,48
MA 116,24,244
T 46,27,52
MA 120,28,240
T 48,28,48
MA 124,28,244
T 50,28,52
W 6
MA 64,32,248
T 52,29,48
MA 68,32,252
T 54,29,52
MA 72,36,248
T 56,30,48
MA 76,36,252
T 58,30,52
W 6
MA 80,40,248
T 60,31,48
T 62,31,52
MA 84,40,252
v_xor_b32 v16, s71, v16
v_xor_b32 v17, s71, v17
v_xor_b32 v18, s71, v18
MA 88,44,248
s_waitcnt vmcnt(8)
s_barrier
R a,0,8,0
v_xor_b32 v19, s71, v19
MA 92,44,252
v_xor_b32 v20, s71, v20
v_xor_b32 v21, s71, v21
s_xor_b32 m0, s65, 0xc000
s_xor_b32 s66, s64, 0x12000
W 5
MA 96,48,248
G 48,48,66,0,nt
MA 100,48,252
R a,4,9,0
v_xor_b32 v22, s71, v22
v_xor_b32 v23, s71, v23
MA 104,52,248
R a,8,10,0
v_xor_b32 v24, s71, v24
MA 108,52,252
v_xor_b32 v25, s71, v25
v_xor_b32 v26, s71, v26
W 3
MA 112,56,248
G 49,48,66,1,nt
R a,12,11,0
MA 116,56,252
v_xor_b32 v27, s71, v27
v_xor_b32 v28, s71, v28
v_xor_b32 v29, s71, v29
MA 120,60,248
R a,16,8,4
MA 124,60,252
v_xor_b32 v30, s71, v30
v_xor_b32 v31, s71, v31
v_pk_mul_f32 v[64:65], v[64:65], s[74:75]
v_pk_mul_f32 v[66:67], v[66:67], s[74:75]
v_pk_mul_f32 v[68:69], v[68:69], s[74:75]
v_pk_mul_f32 v[70:71], v[70:71], s[74:75]
v_pk_mul_f32 v[72:73], v[72:73], s[74:75]
v_pk_mul_f32 v[74:75], v[74:75], s[74:75]
v_pk_mul_f32 v[76:77], v[76:77], s[74:75]
v_pk_mul_f32 v[78:79], v[78:79], s[74:75]
CV 64,64
CV 66,66
CV 68,68
CV 70,70
CV 72,72
CV 74,74
CV 76,76
CV 78,78
v_permlane32_swap_b32 v64, v72
v_permlane32_swap_b32 v66, v74
v_permlane32_swap_b32 v68, v76
v_permlane32_swap_b32 v70, v78
v_permlane16_swap_b32 v64, v72
v_permlane16_swap_b32 v66, v74
v_permlane16_swap_b32 v68, v76
v_permlane16_swap_b32 v70, v78
AW 224,64
AW 225,66
AW 226,72
AW 227,74
AW 228,68
AW 229,70
AW 230,76
AW 231,78
v_pk_mul_f32 v[80:81], v[80:81], s[74:75]
v_pk_mul_f32 v[82:83], v[82:83], s[74:75]
v_pk_mul_f32 v[84:85], v[84:85], s[74:75]
v_pk_mul_f32 v[86:87], v[86:87], s[74:75]
v_pk_mul_f32 v[88:89], v[88:89], s[74:75]
v_pk_mul_f32 v[90:91], v[90:91], s[74:75]
v_pk_mul_f32 v[92:93], v[92:93], s[74:75]
v_pk_mul_f32 v[94:95], v[94:95], s[74:75]
CV 80,80
CV 82,82
CV 84,84
CV 86,86
CV 88,88
CV 90,90
CV 92,92
CV 94,94
v_permlane32_swap_b32 v80, v88
v_permlane32_swap_b32 v82, v90
v_permlane32_swap_b32 v84, v92
v_permlane32_swap_b32 v86, v94
v_permlane16_swap_b32 v80, v88
v_permlane16_swap_b32 v82, v90
v_permlane16_swap_b32 v84, v92
v_permlane16_swap_b32 v86, v94
AW 232,80
AW 233,82
AW 234,88
AW 235,90
AW 236,84
AW 237,86
AW 238,92
AW 239,94
v_pk_mul_f32 v[96:97], v[96:97], s[74:75]
v_pk_mul_f32 v[98:99], v[98:99], s[74:75]
v_pk_mul_f32 v[100:101], v[100:101], s[74:75]
v_pk_mul_f32 v[102:103], v[102:103], s[74:75]
v_pk_mul_f32 v[104:105], v[104:105], s[74:75]
v_pk_mul_f32 v[106:107], v[106:107], s[74:75]
v_pk_mul_f32 v[108:109], v[108:109], s[74:75]
v_pk_mul_f32 v[110:111], v[110:111], s[74:75]
CV 96,96
CV 98,98
CV 100,100
CV 102,102
CV 104,104
CV 106,106
CV 108,108
CV 110,110
v_permlane32_swap_b32 v96, v104
v_permlane32_swap_b32 v98, v106
v_permlane32_swap_b32 v100, v108
v_permlane32_swap_b32 v102, v110
v_permlane16_swap_b32 v96, v104
v_permlane16_swap_b32 v98, v106
v_permlane16_swap_b32 v100, v108
v_permlane16_swap_b32 v102, v110
AW 240,96
AW 241,98
AW 242,104
AW 243,106
AW 244,100
AW 245,102
AW 246,108
AW 247,110
v_pk_mul_f32 v[112:113], v[112:113], s[74:75]
v_pk_mul_f32 v[114:115], v[114:115], s[74:75]
v_pk_mul_f32 v[116:117], v[116:117], s[74:75]
v_pk_mul_f32 v[118:119], v[118:119], s[74:75]
v_pk_mul_f32 v[120:121], v[120:121], s[74:75]
v_pk_mul_f32 v[122:123], v[122:123], s[74:75]
v_pk_mul_f32 v[124:125], v[124:125], s[74:75]
v_pk_mul_f32 v[126:127], v[126:127], s[74:75]
CV 112,112
CV 114,114
CV 116,116
CV 118,118
CV 120,120
CV 122,122
CV 124,124
CV 126,126
v_permlane32_swap_b32 v112, v120
v_permlane32_swap_b32 v114, v122
v_permlane32_swap_b32 v116, v124
v_permlane32_swap_b32 v118, v126
v_permlane16_swap_b32 v112, v120
v_permlane16_swap_b32 v114, v122
v_permlane16_swap_b32 v116, v124
v_permlane16_swap_b32 v118, v126
AW 248,112
AW 249,114
AW 250,120
AW 251,122
AW 252,116
AW 253,118
AW 254,124
AW 255,126
W 3
ZB 64,0,192
G 50,48,66,2,nt
ZB 68,0,196
R a,20,9,4
MB 64,4,200
R a,24,10,4
MB 68,4,204
W 3
MB 64,8,208
G 51,48,66,3,nt
MB 68,8,212
R a,28,11,4
MB 64,12,216
MB 68,12,220
W 2
ZB 72,16,192
ZB 76,16,196
MB 72,20,200
MB 76,20,204
W 0
MB 72,24,208
E 64
MB 76,24,212
MB 72,28,216
E 65
MB 76,28,220
CV 96,64
E 66
T 32,16,0
E 67
T 34,16,4
T 36,17,0
CV 97,66
E 68
T 38,17,4
E 69
T 40,18,0
CV 100,68
E 70
T 42,18,4
T 44,19,0
E 71
T 46,19,4
CV 101,70
E 72
T 48,20,0
E 73
T 50,20,4
T 52,21,0
CV 98,72
E 74
ZB 80,0,224
T 54,21,4
ZB 84,0,228
E 75
MB 80,4,232
T 56,22,0
CV 99,74
MB 84,4,236
E 76
MB 80,8,240
T 58,22,4
T 60,23,0
MB 84,8,244
E 77
MB 80,12,248
W 14
T 62,23,4
CV 102,76
MB 84,12,252
E 78
s_getpc_b64 s[88:89]
L_ct3_818:
s_and_b32 s89, s89, 0xffff
s_mov_b32 s90, L_code_end-L_ct3_818
s_mov_b32 s91, 0x20000
v_and_b32 v62, 0x70, v59
v_lshlrev_b32 v62, 3, v62
s_add_u32 s7, s1, 4096
buffer_load_dword v3, v62, s[88:91], s7 offen
ZB 88,16,224
E 79
ZB 92,16,228
MB 88,20,232
CV 103,78
MB 92,20,236
MB 88,24,240
E 80
MB 92,24,244
MB 88,28,248
E 81
MB 92,28,252
W 12
ZA 128,32,96
s_waitcnt vmcnt(9) lgkmcnt(0)
s_barrier
R a,0,8,16
ZA 132,32,100
CV 104,80
E 82
ZA 136,36,96
R a,4,9,16
ZA 140,36,100
E 83
ZA 144,40,96
R a,8,10,16
CV 105,82
ZA 148,40,100
E 84
ZA 152,44,96
R a,12,11,16
ZA 156,44,100
E 85
ZA 160,48,96
R a,16,8,20
CV 108,84
ZA 164,48,100
E 86
ZA 168,52,96
R a,20,9,20
ZA 172,52,100
E 87
ZA 176,56,96
R a,24,10,20
CV 109,86
ZA 180,56,100
E 88
ZA 184,60,96
R a,28,11,20
ZA 188,60,100
E 89
ZD 112,52,96
CV 106,88
E 90
ZD 116,52,100
s_xor_b32 m0, s65, 0x10000
s_xor_b32 s66, s64, 0x1000
W 6
ZB 64,0,192
G 48,48,66,0,nt
ZB 68,0,196
E 91
MB 64,4,200
CV 107,90
MB 68,4,204
E 92
W 4
MB 64,8,208
G 49,48,66,1,nt
MB 68,8,212
E 93
MB 64,12,216
CV 110,92
MB 68,12,220
E 94
W 2
ZB 72,16,192
G 50,48,66,2,nt
ZB 76,16,196
E 95
MB 72,20,200
CV 111,94
MB 76,20,204
W 0
MB 72,24,208
G 51,48,66,3,nt
MB 76,24,212
E 64
MB 72,28,216
E 65
MB 76,28,220
ZA 192,32,104
CV 96,64
ZA 196,32,108
E 66
ZA 200,36,104
T 32,16,16
ZA 204,36,108
E 67
ZA 208,40,104
T 34,16,20
T 36,17,16
ZA 212,40,108
CV 97,66
E 68
ZA 216,44,104
T 38,17,20
ZA 220,44,108
E 69
ZA 224,48,104
T 40,18,16
CV 100,68
ZA 228,48,108
E 70
ZA 232,52,104
T 42,18,20
T 44,19,16
ZA 236,52,108
E 71
ZA 240,56,104
T 46,19,20
CV 101,70
ZA 244,56,108
E 72
ZA 248,60,104
T 48,20,16
ZA 252,60,108
E 73
ZD 120,52,104
T 50,20,20
T 52,21,16
ZD 124,52,108
CV 98,72
E 74
ZB 80,0,224
T 54,21,20
ZB 84,0,228
E 75
MB 80,4,232
T 56,22,16
CV 99,74
MB 84,4,236
E 76
MB 80,8,240
T 58,22,20
T 60,23,16
MB 84,8,244
E 77
MB 80,12,248
W 14
T 62,23,20
CV 102,76
MB 84,12,252
E 78
ZB 88,16,224
E 79
ZB 92,16,228
MB 88,20,232
CV 103,78
MB 92,20,236
MB 88,24,240
E 80
MB 92,24,244
MB 88,28,248
E 81
MB 92,28,252
W 12
MA 128,32,96
s_waitcnt vmcnt(9) lgkmcnt(0)
s_barrier
R a,0,8,32
MA 132,32,100
CV 104,80
E 82
MA 136,36,96
R a,4,9,32
MA 140,36,100
E 83
MA 144,40,96
R a,8,10,32
CV 105,82
MA 148,40,100
E 84
MA 152,44,96
R a,12,11,32
MA 156,44,100
E 85
MA 160,48,96
R a,16,8,36
CV 108,84
MA 164,48,100
E 86
MA 168,52,96
R a,20,9,36
MA 172,52,100
E 87
MA 176,56,96
R a,24,10,36
CV 109,86
MA 180,56,100
E 88
MA 184,60,96
R a,28,11,36
MA 188,60,100
E 89
MD 112,52,96
CV 106,88
E 90
MD 116,52,100
s_xor_b32 m0, s65, 0x14000
s_xor_b32 s66, s64, 0x11000
W 6
ZB 64,0,192
G 48,48,66,0,nt
ZB 68,0,196
E 91
MB 64,4,200
CV 107,90
MB 68,4,204
E 92
W 4
MB 64,8,208
G 49,48,66,1,nt
MB 68,8,212
E 93
MB 64,12,216
CV 110,92
MB 68,12,220
E 94
W 2
ZB 72,16,192
G 50,48,66,2,nt
ZB 76,16,196
E 95
MB 72,20,200
CV 111,94
MB 76,20,204
W 0
MB 72,24,208
G 51,48,66,3,nt
MB 76,24,212
E 64
MB 72,28,216
E 65
MB 76,28,220
MA 192,32,104
CV 96,64
MA 196,32,108
E 66
MA 200,36,104
T 32,16,32
MA 204,36,108
E 67
MA 208,40,104
T 34,16,36
T 36,17,32
MA 212,40,108
CV 97,66
E 68
MA 216,44,104
T 38,17,36
MA 220,44,108
E 69
MA 224,48,104
T 40,18,32
CV 100,68
MA 228,48,108
E 70
MA 232,52,104
T 42,18,36
T 44,19,32
MA 236,52,108
E 71
MA 240,56,104
T 46,19,36
CV 101,70
MA 244,56,108
E 72
MA 248,60,104
T 48,20,32
MA 252,60,108
E 73
MD 120,52,104
T 50,20,36
T 52,21,32
MD 124,52,108
CV 98,72
E 74
ZB 80,0,224
T 54,21,36
ZB 84,0,228
E 75
MB 80,4,232
T 56,22,32
CV 99,74
MB 84,4,236
E 76
MB 80,8,240
T 58,22,36
T 60,23,32
MB 84,8,244
E 77
MB 80,12,248
W 14
T 62,23,36
CV 102,76
MB 84,12,252
E 78
ZB 88,16,224
E 79
ZB 92,16,228
MB 88,20,232
CV 103,78
MB 92,20,236
MB 88,24,240
E 80
MB 92,24,244
MB 88,28,248
E 81
MB 92,28,252
W 12
MA 128,32,96
s_waitcnt vmcnt(9) lgkmcnt(0)
s_barrier
R a,0,8,48
MA 132,32,100
CV 104,80
E 82
MA 136,36,96
R a,4,9,48
MA 140,36,100
E 83
MA 144,40,96
R a,8,10,48
CV 105,82
MA 148,40,100
E 84
MA 152,44,96
R a,12,11,48
MA 156,44,100
E 85
MA 160,48,96
R a,16,8,52
CV 108,84
MA 164,48,100
E 86
MA 168,52,96
R a,20,9,52
MA 172,52,100
E 87
MA 176,56,96
R a,24,10,52
CV 109,86
MA 180,56,100
E 88
MA 184,60,96
R a,28,11,52
MA 188,60,100
E 89
MD 112,52,96
CV 106,88
E 90
MD 116,52,100
s_xor_b32 m0, s65, 0x18000
s_xor_b32 s66, s64, 0x3000
W 6
ZB 64,0,192
G 48,48,66,0,nt
ZB 68,0,196
E 91
MB 64,4,200
CV 107,90
MB 68,4,204
E 92
W 4
MB 64,8,208
G 49,48,66,1,nt
MB 68,8,212
E 93
MB 64,12,216
CV 110,92
MB 68,12,220
E 94
W 2
ZB 72,16,192
G 50,48,66,2,nt
ZB 76,16,196
E 95
MB 72,20,200
CV 111,94
MB 76,20,204
W 0
MB 72,24,208
G 51,48,66,3,nt
MB 76,24,212
E 64
MB 72,28,216
E 65
MB 76,28,220
MA 192,32,104
CV 96,64
MA 196,32,108
E 66
MA 200,36,104
T 32,16,48
MA 204,36,108
E 67
MA 208,40,104
T 34,16,52
T 36,17,48
MA 212,40,108
CV 97,66
E 68
MA 216,44,104
T 38,17,52
MA 220,44,108
E 69
MA 224,48,104
T 40,18,48
CV 100,68
MA 228,48,108
E 70
MA 232,52,104
T 42,18,52
T 44,19,48
MA 236,52,108
E 71
MA 240,56,104
T 46,19,52
CV 101,70
MA 244,56,108
E 72
MA 248,60,104
T 48,20,48
MA 252,60,108
E 73
MD 120,52,104
T 50,20,52
T 52,21,48
MD 124,52,108
CV 98,72
E 74
ZB 80,0,224
T 54,21,52
ZB 84,0,228
E 75
MB 80,4,232
T 56,22,48
CV 99,74
MB 84,4,236
E 76
MB 80,8,240
T 58,22,52
T 60,23,48
MB 84,8,244
E 77
MB 80,12,248
W 14
T 62,23,52
CV 102,76
MB 84,12,252
E 78
ZB 88,16,224
E 79
ZB 92,16,228
MB 88,20,232
CV 103,78
MB 92,20,236
MB 88,24,240
E 80
MB 92,24,244
MB 88,28,248
E 81
MB 92,28,252
W 12
MA 128,32,96
s_waitcnt vmcnt(8) lgkmcnt(0)
s_barrier
R a,0,12,0
MA 132,32,100
CV 104,80
E 82
MA 136,36,96
R a,4,13,0
MA 140,36,100
E 83
MA 144,40,96
R a,8,14,0
CV 105,82
MA 148,40,100
E 84
MA 152,44,96
R a,12,15,0
MA 156,44,100
E 85
MA 160,48,96
R a,16,12,4
CV 108,84
MA 164,48,100
E 86
MA 168,52,96
R a,20,13,4
MA 172,52,100
E 87
MA 176,56,96
R a,24,14,4
CV 109,86
MA 180,56,100
E 88
MA 184,60,96
R a,28,15,4
MA 188,60,100
E 89
MD 112,52,96
CV 106,88
E 90
MD 116,52,100
s_xor_b32 m0, s65, 0x1c000
s_xor_b32 s66, s64, 0x13000
W 6
ZB 64,0,192
G 48,48,66,0,nt
ZB 68,0,196
E 91
MB 64,4,200
CV 107,90
MB 68,4,204
E 92
W 4
MB 64,8,208
G 49,48,66,1,nt
MB 68,8,212
E 93
MB 64,12,216
CV 110,92
MB 68,12,220
E 94
W 2
ZB 72,16,192
G 50,48,66,2,nt
ZB 76,16,196
E 95
MB 72,20,200
CV 111,94
MB 76,20,204
W 0
MB 72,24,208
G 51,48,66,3,nt
MB 76,24,212
E 64
MB 72,28,216
E 65
MB 76,28,220
MA 192,32,104
CV 96,64
MA 196,32,108
E 66
MA 200,36,104
T 32,24,0
MA 204,36,108
E 67
MA 208,40,104
T 34,24,4
T 36,25,0
MA 212,40,108
CV 97,66
E 68
MA 216,44,104
T 38,25,4
MA 220,44,108
E 69
MA 224,48,104
T 40,26,0
CV 100,68
MA 228,48,108
E 70
MA 232,52,104
T 42,26,4
T 44,27,0
MA 236,52,108
E 71
MA 240,56,104
T 46,27,4
CV 101,70
MA 244,56,108
E 72
MA 248,60,104
T 48,28,0
MA 252,60,108
E 73
MD 120,52,104
T 50,28,4
T 52,29,0
MD 124,52,108
CV 98,72
E 74
ZB 80,0,224
T 54,29,4
ZB 84,0,228
E 75
MB 80,4,232
T 56,30,0
CV 99,74
MB 84,4,236
E 76
MB 80,8,240
T 58,30,4
T 60,31,0
MB 84,8,244
E 77
MB 80,12,248
W 14
T 62,31,4
CV 102,76
MB 84,12,252
E 78
ZB 88,16,224
E 79
ZB 92,16,228
MB 88,20,232
CV 103,78
MB 92,20,236
MB 88,24,240
E 80
MB 92,24,244
MB 88,28,248
E 81
MB 92,28,252
W 12
MA 128,32,96
s_waitcnt vmcnt(8) lgkmcnt(0)
s_barrier
R a,0,12,16
MA 132,32,100
CV 104,80
E 82
MA 136,36,96
R a,4,13,16
MA 140,36,100
E 83
MA 144,40,96
R a,8,14,16
CV 105,82
MA 148,40,100
E 84
MA 152,44,96
R a,12,15,16
MA 156,44,100
E 85
MA 160,48,96
R a,16,12,20
CV 108,84
MA 164,48,100
E 86
MA 168,52,96
R a,20,13,20
MA 172,52,100
E 87
MA 176,56,96
R a,24,14,20
CV 109,86
MA 180,56,100
E 88
MA 184,60,96
R a,28,15,20
MA 188,60,100
E 89
MD 112,52,96
CV 106,88
E 90
MD 116,52,100
s_xor_b32 m0, s65, 0x0
s_xor_b32 s66, s64, 0x4000
W 6
ZB 64,0,192
G 48,48,66,0,nt
ZB 68,0,196
E 91
MB 64,4,200
CV 107,90
MB 68,4,204
E 92
W 4
MB 64,8,208
G 49,48,66,1,nt
MB 68,8,212
E 93
MB 64,12,216
CV 110,92
MB 68,12,220
E 94
W 2
ZB 72,16,192
G 50,48,66,2,nt
ZB 76,16,196
E 95
MB 72,20,200
CV 111,94
MB 76,20,204
W 0
MB 72,24,208
G 51,48,66,3,nt
MB 76,24,212
E 64
MB 72,28,216
E 65
MB 76,28,220
MA 192,32,104
CV 96,64
MA 196,32,108
E 66
MA 200,36,104
T 32,24,16
MA 204,36,108
E 67
MA 208,40,104
T 34,24,20
T 36,25,16
MA 212,40,108
CV 97,66
E 68
MA 216,44,104
T 38,25,20
MA 220,44,108
E 69
MA 224,48,104
T 40,26,16
CV 100,68
MA 228,48,108
E 70
MA 232,52,104
T 42,26,20
T 44,27,16
MA 236,52,108
E 71
MA 240,56,104
T 46,27,20
CV 101,70
MA 244,56,108
E 72
MA 248,60,104
T 48,28,16
MA 252,60,108
E 73
MD 120,52,104
T 50,28,20
T 52,29,16
MD 124,52,108
CV 98,72
E 74
ZB 80,0,224
T 54,29,20
ZB 84,0,228
E 75
MB 80,4,232
T 56,30,16
CV 99,74
MB 84,4,236
E 76
MB 80,8,240
T 58,30,20
T 60,31,16
MB 84,8,244
E 77
MB 80,12,248
W 14
T 62,31,20
CV 102,76
MB 84,12,252
E 78
ZB 88,16,224
E 79
ZB 92,16,228
MB 88,20,232
CV 103,78
MB 92,20,236
MB 88,24,240
E 80
MB 92,24,244
MB 88,28,248
E 81
MB 92,28,252
W 12
MA 128,32,96
s_waitcnt vmcnt(8) lgkmcnt(0)
s_barrier
R a,0,12,32
MA 132,32,100
CV 104,80
E 82
MA 136,36,96
R a,4,13,32
MA 140,36,100
E 83
MA 144,40,96
R a,8,14,32
CV 105,82
MA 148,40,100
E 84
MA 152,44,96
R a,12,15,32
MA 156,44,100
E 85
MA 160,48,96
R a,16,12,36
CV 108,84
MA 164,48,100
E 86
MA 168,52,96
R a,20,13,36
MA 172,52,100
E 87
MA 176,56,96
R a,24,14,36
CV 109,86
MA 180,56,100
E 88
MA 184,60,96
R a,28,15,36
MA 188,60,100
E 89
MD 112,52,96
CV 106,88
E 90
MD 116,52,100
s_xor_b32 m0, s65, 0x4000
s_xor_b32 s66, s64, 0x14000
W 6
ZB 64,0,192
G 48,48,66,0,nt
ZB 68,0,196
E 91
MB 64,4,200
CV 107,90
MB 68,4,204
E 92
W 4
MB 64,8,208
G 49,48,66,1,nt
MB 68,8,212
E 93
MB 64,12,216
CV 110,92
MB 68,12,220
E 94
W 2
ZB 72,16,192
G 50,48,66,2,nt
ZB 76,16,196
E 95
MB 72,20,200
CV 111,94
MB 76,20,204
W 0
MB 72,24,208
G 51,48,66,3,nt
MB 76,24,212
E 64
MB 72,28,216
E 65
MB 76,28,220
MA 192,32,104
CV 96,64
MA 196,32,108
E 66
MA 200,36,104
T 32,24,32
MA 204,36,108
E 67
MA 208,40,104
T 34,24,36
T 36,25,32
MA 212,40,108
CV 97,66
E 68
MA 216,44,104
T 38,25,36
MA 220,44,108
E 69
MA 224,48,104
T 40,26,32
CV 100,68
MA 228,48,108
E 70
MA 232,52,104
T 42,26,36
T 44,27,32
MA 236,52,108
E 71
MA 240,56,104
T 46,27,36
CV 101,70
MA 244,56,108
E 72
MA 248,60,104
T 48,28,32
MA 252,60,108
E 73
MD 120,52,104
T 50,28,36
T 52,29,32
MD 124,52,108
CV 98,72
E 74
ZB 80,0,224
T 54,29,36
ZB 84,0,228
E 75
MB 80,4,232
T 56,30,32
CV 99,74
MB 84,4,236
E 76
MB 80,8,240
T 58,30,36
T 60,31,32
MB 84,8,244
E 77
MB 80,12,248
W 14
T 62,31,36
CV 102,76
MB 84,12,252
E 78
ZB 88,16,224
E 79
ZB 92,16,228
MB 88,20,232
CV 103,78
MB 92,20,236
MB 88,24,240
E 80
MB 92,24,244
MB 88,28,248
E 81
MB 92,28,252
W 12
MA 128,32,96
s_waitcnt vmcnt(8) lgkmcnt(0)
s_barrier
R a,0,12,48
MA 132,32,100
CV 104,80
E 82
MA 136,36,96
R a,4,13,48
MA 140,36,100
E 83
MA 144,40,96
R a,8,14,48
CV 105,82
MA 148,40,100
E 84
MA 152,44,96
R a,12,15,48
MA 156,44,100
E 85
MA 160,48,96
R a,16,12,52
CV 108,84
MA 164,48,100
E 86
MA 168,52,96
R a,20,13,52
MA 172,52,100
E 87
MA 176,56,96
R a,24,14,52
CV 109,86
MA 180,56,100
E 88
MA 184,60,96
R a,28,15,52
MA 188,60,100
E 89
MD 112,52,96
CV 106,88
E 90
MD 116,52,100
s_xor_b32 m0, s65, 0x8000
s_xor_b32 s66, s64, 0x6000
W 6
ZB 64,0,192
G 48,48,66,0,nt
ZB 68,0,196
E 91
MB 64,4,200
CV 107,90
MB 68,4,204
E 92
W 4
MB 64,8,208
G 49,48,66,1,nt
MB 68,8,212
E 93
MB 64,12,216
CV 110,92
MB 68,12,220
E 94
W 2
ZB 72,16,192
G 50,48,66,2,nt
ZB 76,16,196
E 95
MB 72,20,200
CV 111,94
MB 76,20,204
W 0
MB 72,24,208
G 51,48,66,3,nt
MB 76,24,212
E 64
MB 72,28,216
E 65
MB 76,28,220
MA 192,32,104
CV 96,64
MA 196,32,108
E 66
MA 200,36,104
T 32,24,48
MA 204,36,108
E 67
MA 208,40,104
T 34,24,52
T 36,25,48
MA 212,40,108
CV 97,66
E 68
MA 216,44,104
T 38,25,52
MA 220,44,108
E 69
MA 224,48,104
T 40,26,48
CV 100,68
MA 228,48,108
E 70
MA 232,52,104
T 42,26,52
T 44,27,48
MA 236,52,108
E 71
MA 240,56,104
T 46,27,52
CV 101,70
MA 244,56,108
E 72
MA 248,60,104
T 48,28,48
MA 252,60,108
E 73
MD 120,52,104
T 50,28,52
T 52,29,48
MD 124,52,108
CV 98,72
E 74
ZB 80,0,224
T 54,29,52
ZB 84,0,228
E 75
MB 80,4,232
T 56,30,48
CV 99,74
MB 84,4,236
E 76
MB 80,8,240
T 58,30,52
T 60,31,48
MB 84,8,244
E 77
MB 80,12,248
W 14
T 62,31,52
CV 102,76
MB 84,12,252
E 78
ZB 88,16,224
E 79
ZB 92,16,228
MB 88,20,232
CV 103,78
MB 92,20,236
MB 88,24,240
E 80
MB 92,24,244
MB 88,28,248
E 81
MB 92,28,252
W 12
MA 128,32,96
s_waitcnt vmcnt(8) lgkmcnt(0)
s_barrier
R a,0,8,0
MA 132,32,100
CV 104,80
E 82
MA 136,36,96
R a,4,9,0
MA 140,36,100
E 83
MA 144,40,96
R a,8,10,0
CV 105,82
MA 148,40,100
E 84
MA 152,44,96
R a,12,11,0
MA 156,44,100
E 85
MA 160,48,96
R a,16,8,4
CV 108,84
MA 164,48,100
E 86
MA 168,52,96
R a,20,9,4
MA 172,52,100
E 87
MA 176,56,96
R a,24,10,4
CV 109,86
MA 180,56,100
E 88
MA 184,60,96
R a,28,11,4
MA 188,60,100
E 89
MD 112,52,96
CV 106,88
E 90
MD 116,52,100
s_xor_b32 m0, s65, 0xc000
s_xor_b32 s66, s64, 0x16000
W 6
ZB 64,0,192
G 48,48,66,0,nt
ZB 68,0,196
E 91
MB 64,4,200
CV 107,90
MB 68,4,204
E 92
W 4
MB 64,8,208
G 49,48,66,1,nt
MB 68,8,212
E 93
MB 64,12,216
CV 110,92
MB 68,12,220
E 94
W 2
ZB 72,16,192
G 50,48,66,2,nt
ZB 76,16,196
E 95
MB 72,20,200
CV 111,94
MB 76,20,204
W 0
MB 72,24,208
G 51,48,66,3,nt
MB 76,24,212
E 64
MB 72,28,216
E 65
MB 76,28,220
MA 192,32,104
CV 96,64
MA 196,32,108
E 66
MA 200,36,104
T 32,16,0
MA 204,36,108
E 67
MA 208,40,104
T 34,16,4
T 36,17,0
MA 212,40,108
CV 97,66
E 68
MA 216,44,104
T 38,17,4
MA 220,44,108
E 69
MA 224,48,104
T 40,18,0
CV 100,68
MA 228,48,108
E 70
MA 232,52,104
T 42,18,4
T 44,19,0
MA 236,52,108
E 71
MA 240,56,104
T 46,19,4
CV 101,70
MA 244,56,108
E 72
MA 248,60,104
T 48,20,0
MA 252,60,108
E 73
MD 120,52,104
T 50,20,4
T 52,21,0
MD 124,52,108
CV 98,72
E 74
ZB 80,0,224
T 54,21,4
ZB 84,0,228
E 75
MB 80,4,232
T 56,22,0
CV 99,74
MB 84,4,236
E 76
MB 80,8,240
T 58,22,4
T 60,23,0
MB 84,8,244
E 77
MB 80,12,248
W 14
T 62,23,4
CV 102,76
MB 84,12,252
E 78
ZB 88,16,224
E 79
ZB 92,16,228
MB 88,20,232
CV 103,78
MB 92,20,236
MB 88,24,240
E 80
MB 92,24,244
MB 88,28,248
E 81
MB 92,28,252
W 12
MA 128,32,96
s_waitcnt vmcnt(8) lgkmcnt(0)
s_barrier
R a,0,8,16
MA 132,32,100
CV 104,80
E 82
MA 136,36,96
R a,4,9,16
MA 140,36,100
E 83
MA 144,40,96
R a,8,10,16
CV 105,82
MA 148,40,100
E 84
MA 152,44,96
R a,12,11,16
MA 156,44,100
E 85
MA 160,48,96
R a,16,8,20
CV 108,84
MA 164,48,100
E 86
MA 168,52,96
R a,20,9,20
MA 172,52,100
E 87
MA 176,56,96
R a,24,10,20
CV 109,86
MA 180,56,100
E 88
MA 184,60,96
R a,28,11,20
MA 188,60,100
E 89
MD 112,52,96
CV 106,88
E 90
MD 116,52,100
s_xor_b32 m0, s65, 0x10000
s_xor_b32 s66, s64, 0x5000
W 6
ZB 64,0,192
G 48,48,66,0,nt
ZB 68,0,196
E 91
MB 64,4,200
CV 107,90
MB 68,4,204
E 92
W 4
MB 64,8,208
G 49,48,66,1,nt
MB 68,8,212
E 93
MB 64,12,216
CV 110,92
MB 68,12,220
E 94
W 2
ZB 72,16,192
G 50,48,66,2,nt
ZB 76,16,196
E 95
MB 72,20,200
CV 111,94
MB 76,20,204
W 0
MB 72,24,208
G 51,48,66,3,nt
MB 76,24,212
E 64
MB 72,28,216
E 65
MB 76,28,220
MA 192,32,104
CV 96,64
MA 196,32,108
E 66
MA 200,36,104
T 32,16,16
MA 204,36,108
E 67
MA 208,40,104
T 34,16,20
T 36,17,16
MA 212,40,108
CV 97,66
E 68
MA 216,44,104
T 38,17,20
MA 220,44,108
E 69
MA 224,48,104
T 40,18,16
CV 100,68
MA 228,48,108
E 70
MA 232,52,104
T 42,18,20
T 44,19,16
MA 236,52,108
E 71
MA 240,56,104
T 46,19,20
CV 101,70
MA 244,56,108
E 72
MA 248,60,104
T 48,20,16
MA 252,60,108
E 73
MD 120,52,104
T 50,20,20
T 52,21,16
MD 124,52,108
CV 98,72
E 74
ZB 80,0,224
T 54,21,20
ZB 84,0,228
E 75
MB 80,4,232
T 56,22,16
CV 99,74
MB 84,4,236
E 76
MB 80,8,240
T 58,22,20
T 60,23,16
MB 84,8,244
E 77
MB 80,12,248
W 14
T 62,23,20
CV 102,76
MB 84,12,252
E 78
ZB 88,16,224
E 79
ZB 92,16,228
MB 88,20,232
CV 103,78
MB 92,20,236
MB 88,24,240
E 80
MB 92,24,244
MB 88,28,248
E 81
MB 92,28,252
W 12
MA 128,32,96
s_waitcnt vmcnt(8) lgkmcnt(0)
s_barrier
R a,0,8,32
MA 132,32,100
CV 104,80
E 82
MA 136,36,96
R a,4,9,32
MA 140,36,100
E 83
MA 144,40,96
R a,8,10,32
CV 105,82
MA 148,40,100
E 84
MA 152,44,96
R a,12,11,32
MA 156,44,100
E 85
MA 160,48,96
R a,16,8,36
CV 108,84
MA 164,48,100
E 86
MA 168,52,96
R a,20,9,36
MA 172,52,100
E 87
MA 176,56,96
R a,24,10,36
CV 109,86
MA 180,56,100
E 88
MA 184,60,96
R a,28,11,36
MA 188,60,100
E 89
MD 112,52,96
CV 106,88
E 90
MD 116,52,100
s_xor_b32 m0, s65, 0x14000
s_xor_b32 s66, s64, 0x15000
W 6
ZB 64,0,192
G 48,48,66,0,nt
ZB 68,0,196
E 91
MB 64,4,200
CV 107,90
MB 68,4,204
E 92
W 4
MB 64,8,208
G 49,48,66,1,nt
MB 68,8,212
E 93
MB 64,12,216
CV 110,92
MB 68,12,220
E 94
W 2
ZB 72,16,192
G 50,48,66,2,nt
ZB 76,16,196
E 95
MB 72,20,200
CV 111,94
MB 76,20,204
W 0
MB 72,24,208
G 51,48,66,3,nt
MB 76,24,212
E 64
MB 72,28,216
E 65
MB 76,28,220
MA 192,32,104
CV 96,64
MA 196,32,108
E 66
MA 200,36,104
T 32,16,32
MA 204,36,108
E 67
MA 208,40,104
T 34,16,36
T 36,17,32
MA 212,40,108
CV 97,66
E 68
MA 216,44,104
T 38,17,36
MA 220,44,108
E 69
MA 224,48,104
T 40,18,32
CV 100,68
MA 228,48,108
E 70
MA 232,52,104
T 42,18,36
T 44,19,32
MA 236,52,108
E 71
MA 240,56,104
T 46,19,36
CV 101,70
MA 244,56,108
E 72
MA 248,60,104
T 48,20,32
MA 252,60,108
E 73
MD 120,52,104
T 50,20,36
T 52,21,32
MD 124,52,108
CV 98,72
E 74
ZB 80,0,224
T 54,21,36
ZB 84,0,228
E 75
MB 80,4,232
T 56,22,32
CV 99,74
MB 84,4,236
E 76
MB 80,8,240
T 58,22,36
T 60,23,32
MB 84,8,244
E 77
MB 80,12,248
W 14
T 62,23,36
CV 102,76
MB 84,12,252
E 78
ZB 88,16,224
E 79
ZB 92,16,228
MB 88,20,232
CV 103,78
MB 92,20,236
MB 88,24,240
E 80
MB 92,24,244
MB 88,28,248
E 81
MB 92,28,252
W 12
MA 128,32,96
s_waitcnt vmcnt(8) lgkmcnt(0)
s_barrier
R a,0,8,48
MA 132,32,100
CV 104,80
E 82
MA 136,36,96
R a,4,9,48
MA 140,36,100
E 83
MA 144,40,96
R a,8,10,48
CV 105,82
MA 148,40,100
E 84
MA 152,44,96
R a,12,11,48
MA 156,44,100
E 85
MA 160,48,96
R a,16,8,52
CV 108,84
MA 164,48,100
E 86
MA 168,52,96
R a,20,9,52
MA 172,52,100
E 87
MA 176,56,96
R a,24,10,52
CV 109,86
MA 180,56,100
E 88
MA 184,60,96
R a,28,11,52
MA 188,60,100
E 89
MD 112,52,96
CV 106,88
E 90
MD 116,52,100
s_xor_b32 m0, s65, 0x18000
s_xor_b32 s66, s64, 0x7000
W 6
ZB 64,0,192
G 48,48,66,0,nt
ZB 68,0,196
E 91
MB 64,4,200
CV 107,90
MB 68,4,204
E 92
W 4
MB 64,8,208
G 49,48,66,1,nt
MB 68,8,212
E 93
MB 64,12,216
CV 110,92
MB 68,12,220
E 94
W 2
ZB 72,16,192
G 50,48,66,2,nt
ZB 76,16,196
E 95
MB 72,20,200
CV 111,94
MB 76,20,204
W 0
MB 72,24,208
G 51,48,66,3,nt
MB 76,24,212
E 64
MB 72,28,216
E 65
MB 76,28,220
MA 192,32,104
CV 96,64
MA 196,32,108
E 66
MA 200,36,104
T 32,16,48
MA 204,36,108
E 67
MA 208,40,104
T 34,16,52
T 36,17,48
MA 212,40,108
CV 97,66
E 68
MA 216,44,104
T 38,17,52
MA 220,44,108
E 69
MA 224,48,104
T 40,18,48
CV 100,68
MA 228,48,108
E 70
MA 232,52,104
T 42,18,52
T 44,19,48
MA 236,52,108
E 71
MA 240,56,104
T 46,19,52
CV 101,70
MA 244,56,108
E 72
MA 248,60,104
T 48,20,48
MA 252,60,108
E 73
MD 120,52,104
T 50,20,52
T 52,21,48
MD 124,52,108
CV 98,72
E 74
ZB 80,0,224
T 54,21,52
ZB 84,0,228
E 75
MB 80,4,232
T 56,22,48
CV 99,74
MB 84,4,236
E 76
MB 80,8,240
T 58,22,52
T 60,23,48
MB 84,8,244
E 77
MB 80,12,248
W 14
T 62,23,52
CV 102,76
MB 84,12,252
E 78
ZB 88,16,224
E 79
ZB 92,16,228
MB 88,20,232
CV 103,78
MB 92,20,236
MB 88,24,240
E 80
MB 92,24,244
MB 88,28,248
E 81
MB 92,28,252
W 12
MA 128,32,96
s_waitcnt vmcnt(8) lgkmcnt(0)
s_barrier
R a,0,12,0
MA 132,32,100
CV 104,80
E 82
MA 136,36,96
R a,4,13,0
MA 140,36,100
E 83
MA 144,40,96
R a,8,14,0
CV 105,82
MA 148,40,100
E 84
MA 152,44,96
R a,12,15,0
MA 156,44,100
E 85
MA 160,48,96
R a,16,12,4
CV 108,84
MA 164,48,100
E 86
MA 168,52,96
R a,20,13,4
MA 172,52,100
E 87
MA 176,56,96
R a,24,14,4
CV 109,86
MA 180,56,100
E 88
MA 184,60,96
R a,28,15,4
MA 188,60,100
E 89
MD 112,52,96
CV 106,88
E 90
MD 116,52,100
s_xor_b32 m0, s65, 0x1c000
s_xor_b32 s66, s64, 0x17000
W 6
ZB 64,0,192
G 48,48,66,0,nt
ZB 68,0,196
E 91
MB 64,4,200
CV 107,90
MB 68,4,204
E 92
W 4
MB 64,8,208
G 49,48,66,1,nt
MB 68,8,212
E 93
MB 64,12,216
CV 110,92
MB 68,12,220
E 94
W 2
ZB 72,16,192
G 50,48,66,2,nt
ZB 76,16,196
E 95
MB 72,20,200
CV 111,94
MB 76,20,204
W 0
MB 72,24,208
G 51,48,66,3,nt
MB 76,24,212
E 64
MB 72,28,216
E 65
MB 76,28,220
s_xor_b32 m0, s65, 0x0
s_xor_b32 s66, s62, 0x0
MA 192,32,104
G 44,24,66,0
MA 196,32,108
CV 96,64
E 66
MA 200,36,104
T 32,24,0
MA 204,36,108
E 67
MA 208,40,104
G 45,24,66,1
T 34,24,4
MA 212,40,108
T 36,25,0
CV 97,66
E 68
MA 216,44,104
T 38,25,4
MA 220,44,108
E 69
MA 224,48,104
G 46,24,66,2
T 40,26,0
MA 228,48,108
CV 100,68
E 70
MA 232,52,104
T 42,26,4
T 44,27,0
MA 236,52,108
E 71
MA 240,56,104
G 47,24,66,3
T 46,27,4
MA 244,56,108
CV 101,70
E 72
MA 248,60,104
T 48,28,0
MA 252,60,108
E 73
MD 120,52,104
T 50,28,4
T 52,29,0
MD 124,52,108
CV 98,72
E 74
ZB 80,0,224
T 54,29,4
ZB 84,0,228
E 75
MB 80,4,232
T 56,30,0
CV 99,74
MB 84,4,236
E 76
MB 80,8,240
T 58,30,4
T 60,31,0
MB 84,8,244
E 77
MB 80,12,248
W 14
T 62,31,4
CV 102,76
MB 84,12,252
E 78
ZB 88,16,224
E 79
ZB 92,16,228
MB 88,20,232
CV 103,78
MB 92,20,236
MB 88,24,240
E 80
MB 92,24,244
MB 88,28,248
E 81
MB 92,28,252
W 12
MA 128,32,96
s_waitcnt vmcnt(12) lgkmcnt(0)
s_barrier
R a,0,12,16
MA 132,32,100
CV 104,80
E 82
MA 136,36,96
R a,4,13,16
MA 140,36,100
E 83
MA 144,40,96
R a,8,14,16
CV 105,82
MA 148,40,100
E 84
MA 152,44,96
R a,12,15,16
MA 156,44,100
E 85
MA 160,48,96
R a,16,12,20
CV 108,84
MA 164,48,100
E 86
MA 168,52,96
R a,20,13,20
MA 172,52,100
E 87
MA 176,56,96
R a,24,14,20
CV 109,86
MA 180,56,100
E 88
MA 184,60,96
R a,28,15,20
MA 188,60,100
E 89
MD 112,52,96
CV 106,88
E 90
MD 116,52,100
s_xor_b32 m0, s65, 0x4000
s_xor_b32 s66, s62, 0x8000
W 6
ZB 64,0,192
G 44,24,66,0
ZB 68,0,196
E 91
MB 64,4,200
CV 107,90
MB 68,4,204
E 92
W 4
MB 64,8,208
G 45,24,66,1
MB 68,8,212
E 93
MB 64,12,216
CV 110,92
MB 68,12,220
E 94
W 2
ZB 72,16,192
G 46,24,66,2
ZB 76,16,196
E 95
MB 72,20,200
CV 111,94
MB 76,20,204
W 0
MB 72,24,208
G 47,24,66,3
MB 76,24,212
E 64
MB 72,28,216
E 65
MB 76,28,220
s_xor_b32 m0, s65, 0x8000
s_xor_b32 s66, s62, 0x10000
MA 192,32,104
G 44,24,66,0
MA 196,32,108
CV 96,64
E 66
MA 200,36,104
T 32,24,16
MA 204,36,108
E 67
MA 208,40,104
G 45,24,66,1
T 34,24,20
MA 212,40,108
T 36,25,16
CV 97,66
E 68
MA 216,44,104
T 38,25,20
MA 220,44,108
E 69
MA 224,48,104
G 46,24,66,2
T 40,26,16
MA 228,48,108
CV 100,68
E 70
MA 232,52,104
T 42,26,20
T 44,27,16
MA 236,52,108
E 71
MA 240,56,104
G 47,24,66,3
T 46,27,20
MA 244,56,108
CV 101,70
E 72
MA 248,60,104
T 48,28,16
MA 252,60,108
E 73
MD 120,52,104
T 50,28,20
T 52,29,16
MD 124,52,108
CV 98,72
E 74
ZB 80,0,224
T 54,29,20
ZB 84,0,228
E 75
MB 80,4,232
T 56,30,16
CV 99,74
MB 84,4,236
E 76
MB 80,8,240
T 58,30,20
T 60,31,16
MB 84,8,244
E 77
MB 80,12,248
W 14
T 62,31,20
CV 102,76
MB 84,12,252
E 78
ZB 88,16,224
E 79
ZB 92,16,228
MB 88,20,232
CV 103,78
MB 92,20,236
MB 88,24,240
E 80
MB 92,24,244
MB 88,28,248
E 81
MB 92,28,252
W 12
MA 128,32,96
s_waitcnt vmcnt(16) lgkmcnt(0)
s_barrier
R a,0,12,32
MA 132,32,100
CV 104,80
E 82
MA 136,36,96
R a,4,13,32
MA 140,36,100
E 83
MA 144,40,96
R a,8,14,32
CV 105,82
MA 148,40,100
E 84
MA 152,44,96
R a,12,15,32
MA 156,44,100
E 85
MA 160,48,96
R a,16,12,36
CV 108,84
MA 164,48,100
E 86
MA 168,52,96
R a,20,13,36
MA 172,52,100
E 87
MA 176,56,96
R a,24,14,36
CV 109,86
MA 180,56,100
E 88
MA 184,60,96
R a,28,15,36
MA 188,60,100
E 89
MD 112,52,96
CV 106,88
E 90
MD 116,52,100
s_xor_b32 m0, s65, 0xc000
s_xor_b32 s66, s62, 0x18000
W 6
ZB 64,0,192
G 44,24,66,0
ZB 68,0,196
E 91
MB 64,4,200
CV 107,90
MB 68,4,204
E 92
W 4
MB 64,8,208
G 45,24,66,1
MB 68,8,212
E 93
MB 64,12,216
CV 110,92
MB 68,12,220
E 94
W 2
ZB 72,16,192
G 46,24,66,2
ZB 76,16,196
E 95
MB 72,20,200
CV 111,94
MB 76,20,204
W 0
MB 72,24,208
G 47,24,66,3
MB 76,24,212
E 64
MB 72,28,216
E 65
MB 76,28,220
s_xor_b32 m0, s65, 0x10000
s_xor_b32 s66, s62, 0x20000
MA 192,32,104
G 44,24,66,0
MA 196,32,108
CV 96,64
E 66
MA 200,36,104
T 32,24,32
MA 204,36,108
E 67
MA 208,40,104
G 45,24,66,1
T 34,24,36
MA 212,40,108
T 36,25,32
CV 97,66
E 68
MA 216,44,104
T 38,25,36
MA 220,44,108
E 69
MA 224,48,104
G 46,24,66,2
T 40,26,32
MA 228,48,108
CV 100,68
E 70
MA 232,52,104
T 42,26,36
T 44,27,32
MA 236,52,108
E 71
MA 240,56,104
G 47,24,66,3
T 46,27,36
MA 244,56,108
CV 101,70
E 72
MA 248,60,104
T 48,28,32
MA 252,60,108
E 73
MD 120,52,104
T 50,28,36
T 52,29,32
MD 124,52,108
CV 98,72
E 74
ZB 80,0,224
T 54,29,36
ZB 84,0,228
E 75
MB 80,4,232
T 56,30,32
CV 99,74
MB 84,4,236
E 76
MB 80,8,240
T 58,30,36
T 60,31,32
MB 84,8,244
E 77
MB 80,12,248
W 14
T 62,31,36
CV 102,76
MB 84,12,252
E 78
ZB 88,16,224
E 79
ZB 92,16,228
MB 88,20,232
CV 103,78
MB 92,20,236
MB 88,24,240
E 80
MB 92,24,244
MB 88,28,248
E 81
MB 92,28,252
W 12
MA 128,32,96
s_waitcnt vmcnt(20) lgkmcnt(0)
s_barrier
R a,0,12,48
MA 132,32,100
CV 104,80
E 82
MA 136,36,96
R a,4,13,48
MA 140,36,100
E 83
MA 144,40,96
R a,8,14,48
CV 105,82
MA 148,40,100
E 84
MA 152,44,96
R a,12,15,48
MA 156,44,100
E 85
MA 160,48,96
R a,16,12,52
CV 108,84
MA 164,48,100
E 86
MA 168,52,96
R a,20,13,52
MA 172,52,100
E 87
MA 176,56,96
R a,24,14,52
CV 109,86
MA 180,56,100
E 88
MA 184,60,96
R a,28,15,52
v_xor_b32 v8, s68, v8
MA 188,60,100
E 89
MD 112,52,96
CV 106,88
v_xor_b32 v9, s68, v9
MD 116,52,100
E 90
s_xor_b32 m0, s65, 0x14000
s_xor_b32 s66, s62, 0x28000
W 6
ZB 64,0,192
G 44,24,66,0
ZB 68,0,196
v_xor_b32 v10, s68, v10
E 91
MB 64,4,200
CV 107,90
v_xor_b32 v11, s68, v11
MB 68,4,204
E 92
W 4
MB 64,8,208
G 45,24,66,1
MB 68,8,212
v_xor_b32 v12, s68, v12
E 93
MB 64,12,216
CV 110,92
v_xor_b32 v13, s68, v13
MB 68,12,220
E 94
W 2
ZB 72,16,192
G 46,24,66,2
ZB 76,16,196
v_xor_b32 v14, s68, v14
E 95
MB 72,20,200
CV 111,94
MB 76,20,204
v_xor_b32 v15, s68, v15
W 0
MB 72,24,208
G 47,24,66,3
MB 76,24,212
E 64
MB 72,28,216
E 65
MB 76,28,220
MA 192,32,104
CV 96,64
MA 196,32,108
E 66
MA 200,36,104
T 32,24,48
MA 204,36,108
E 67
MA 208,40,104
T 34,24,52
T 36,25,48
MA 212,40,108
CV 97,66
E 68
MA 216,44,104
T 38,25,52
MA 220,44,108
E 69
MA 224,48,104
T 40,26,48
CV 100,68
MA 228,48,108
E 70
MA 232,52,104
T 42,26,52
T 44,27,48
MA 236,52,108
E 71
MA 240,56,104
T 46,27,52
CV 101,70
MA 244,56,108
E 72
MA 248,60,104
T 48,28,48
MA 252,60,108
E 73
MD 120,52,104
T 50,28,52
T 52,29,48
MD 124,52,108
CV 98,72
E 74
ZB 80,0,224
T 54,29,52
ZB 84,0,228
E 75
MB 80,4,232
T 56,30,48
CV 99,74
MB 84,4,236
E 76
MB 80,8,240
T 58,30,52
T 60,31,48
MB 84,8,244
E 77
MB 80,12,248
W 14
T 62,31,52
CV 102,76
v_xor_b32 v16, s71, v16
MB 84,12,252
v_xor_b32 v17, s71, v17
E 78
ZB 88,16,224
v_xor_b32 v18, s71, v18
v_xor_b32 v19, s71, v19
ZB 92,16,228
E 79
MB 88,20,232
CV 103,78
MB 92,20,236
v_xor_b32 v20, s71, v20
v_xor_b32 v21, s71, v21
MB 88,24,240
v_xor_b32 v22, s71, v22
v_xor_b32 v23, s71, v23
MB 92,24,244
E 80
MB 88,28,248
v_xor_b32 v24, s71, v24
v_xor_b32 v25, s71, v25
MB 92,28,252
E 81
W 12
MA 128,32,96
CV 104,80
v_xor_b32 v26, s71, v26
MA 132,32,100
v_xor_b32 v27, s71, v27
E 82
MA 136,36,96
v_xor_b32 v28, s71, v28
v_xor_b32 v29, s71, v29
MA 140,36,100
E 83
W 8
MA 144,40,96
CV 105,82
v_xor_b32 v30, s71, v30
MA 148,40,100
v_xor_b32 v31, s71, v31
E 84
MA 152,44,96
E 85
MA 156,44,100
W 4
MA 160,48,96
CV 108,84
MA 164,48,100
E 86
MA 168,52,96
E 87
MA 172,52,100
W 0
MA 176,56,96
CV 109,86
MA 180,56,100
E 88
MA 184,60,96
E 89
MA 188,60,100
MD 112,52,96
CV 106,88
MD 116,52,100
E 90
E 91
s_nop 0
CV 107,90
E 92
E 93
s_nop 0
CV 110,92
E 94
E 95
s_nop 0
CV 111,94
MA 192,32,104
s_nop 0
MA 196,32,108
MA 200,36,104
MA 204,36,108
MA 208,40,104
MA 212,40,108
MA 216,44,104
MA 220,44,108
MA 224,48,104
s_waitcnt vmcnt(20)
s_barrier
T 0,16,0
MA 228,48,108
T 2,16,4
s_xor_b32 m0, s65, 0x18000
s_xor_b32 s66, s62, 0x30000
MA 232,52,104
G 44,24,66,0
MA 236,52,108
T 4,17,0
T 6,17,4
MA 240,56,104
T 8,18,0
MA 244,56,108
T 10,18,4
MA 248,60,104
G 45,24,66,1
MA 252,60,108
T 12,19,0
T 14,19,4
MD 120,52,104
T 16,20,0
MD 124,52,108
T 18,20,4
v_mov_b32 v60, v112
v_mov_b32 v61, v116
v_cmp_nle_f32 vcc, s76, v60
v_cmp_nge_f32 s[82:83], s77, v60
v_cmp_nle_f32 s[84:85], s76, v61
v_cmp_nge_f32 s[90:91], s77, v61
s_nop 1
s_or_b64 vcc, vcc, s[82:83]
s_or_b64 vcc, vcc, s[84:85]
s_or_b64 vcc, vcc, s[90:91]
s_cbranch_scc1 L_slow_c3A0
L_back_c3A0:
v_rcp_f32 v0, v60
v_rcp_f32 v1, v61
s_nop 0
v_pk_mul_f32 v[128:129], v[128:129], v[0:1] op_sel_hi:[1,0]
v_pk_mul_f32 v[130:131], v[130:131], v[0:1] op_sel_hi:[1,0]
v_pk_mul_f32 v[132:133], v[132:133], v[0:1] op_sel:[0,1]
v_pk_mul_f32 v[134:135], v[134:135], v[0:1] op_sel:[0,1]
v_pk_mul_f32 v[136:137], v[136:137], v[0:1] op_sel_hi:[1,0]
v_pk_mul_f32 v[138:139], v[138:139], v[0:1] op_sel_hi:[1,0]
v_pk_mul_f32 v[140:141], v[140:141], v[0:1] op_sel:[0,1]
v_pk_mul_f32 v[142:143], v[142:143], v[0:1] op_sel:[0,1]
CV 128,128
CV 130,130
CV 132,132
CV 134,134
CV 136,136
CV 138,138
CV 140,140
CV 142,142
AW 192,128
AW 193,130
AW 196,132
AW 197,134
AW 194,136
AW 195,138
AW 198,140
AW 199,142
v_pk_mul_f32 v[144:145], v[144:145], v[0:1] op_sel_hi:[1,0]
v_pk_mul_f32 v[146:147], v[146:147], v[0:1] op_sel_hi:[1,0]
v_pk_mul_f32 v[148:149], v[148:149], v[0:1] op_sel:[0,1]
v_pk_mul_f32 v[150:151], v[150:151], v[0:1] op_sel:[0,1]
v_pk_mul_f32 v[152:153], v[152:153], v[0:1] op_sel_hi:[1,0]
v_pk_mul_f32 v[154:155], v[154:155], v[0:1] op_sel_hi:[1,0]
v_pk_mul_f32 v[156:157], v[156:157], v[0:1] op_sel:[0,1]
v_pk_mul_f32 v[158:159], v[158:159], v[0:1] op_sel:[0,1]
CV 144,144
CV 146,146
CV 148,148
CV 150,150
CV 152,152
CV 154,154
CV 156,156
CV 158,158
AW 200,144
AW 201,146
AW 204,148
AW 205,150
AW 202,152
AW 203,154
AW 206,156
AW 207,158
v_pk_mul_f32 v[160:161], v[160:161], v[0:1] op_sel_hi:[1,0]
v_pk_mul_f32 v[162:163], v[162:163], v[0:1] op_sel_hi:[1,0]
v_pk_mul_f32 v[164:165], v[164:165], v[0:1] op_sel:[0,1]
v_pk_mul_f32 v[166:167], v[166:167], v[0:1] op_sel:[0,1]
v_pk_mul_f32 v[168:169], v[168:169], v[0:1] op_sel_hi:[1,0]
v_pk_mul_f32 v[170:171], v[170:171], v[0:1] op_sel_hi:[1,0]
v_pk_mul_f32 v[172:173], v[172:173], v[0:1] op_sel:[0,1]
v_pk_mul_f32 v[174:175], v[174:175], v[0:1] op_sel:[0,1]
CV 160,160
CV 162,162
CV 164,164
CV 166,166
CV 168,168
CV 170,170
CV 172,172
CV 174,174
AW 208,160
AW 209,162
AW 212,164
AW 213,166
AW 210,168
AW 211,170
AW 214,172
AW 215,174
v_pk_mul_f32 v[176:177], v[176:177], v[0:1] op_sel_hi:[1,0]
v_pk_mul_f32 v[178:179], v[178:179], v[0:1] op_sel_hi:[1,0]
v_pk_mul_f32 v[180:181], v[180:181], v[0:1] op_sel:[0,1]
v_pk_mul_f32 v[182:183], v[182:183], v[0:1] op_sel:[0,1]
v_pk_mul_f32 v[184:185], v[184:185], v[0:1] op_sel_hi:[1,0]
v_pk_mul_f32 v[186:187], v[186:187], v[0:1] op_sel_hi:[1,0]
v_pk_mul_f32 v[188:189], v[188:189], v[0:1] op_sel:[0,1]
v_pk_mul_f32 v[190:191], v[190:191], v[0:1] op_sel:[0,1]
CV 176,176
CV 178,178
CV 180,180
CV 182,182
CV 184,184
CV 186,186
CV 188,188
CV 190,190
AW 216,176
AW 217,178
AW 220,180
AW 221,182
AW 218,184
AW 219,186
AW 222,188
AW 223,190
v_mov_b32 v60, v120
v_mov_b32 v61, v124
v_cmp_nle_f32 vcc, s76, v60
v_cmp_nge_f32 s[82:83], s77, v60
v_cmp_nle_f32 s[84:85], s76, v61
v_cmp_nge_f32 s[90:91], s77, v61
s_nop 1
s_or_b64 vcc, vcc, s[82:83]
s_or_b64 vcc, vcc, s[84:85]
s_or_b64 vcc, vcc, s[90:91]
s_cbranch_scc1 L_slow_c3A1
L_back_c3A1:
v_rcp_f32 v0, v60
v_rcp_f32 v1, v61
s_nop 0
v_pk_mul_f32 v[192:193], v[192:193], v[0:1] op_sel_hi:[1,0]
v_pk_mul_f32 v[194:195], v[194:195], v[0:1] op_sel_hi:[1,0]
v_pk_mul_f32 v[196:197], v[196:197], v[0:1] op_sel:[0,1]
v_pk_mul_f32 v[198:199], v[198:199], v[0:1] op_sel:[0,1]
v_pk_mul_f32 v[200:201], v[200:201], v[0:1] op_sel_hi:[1,0]
v_pk_mul_f32 v[202:203], v[202:203], v[0:1] op_sel_hi:[1,0]
v_pk_mul_f32 v[204:205], v[204:205], v[0:1] op_sel:[0,1]
v_pk_mul_f32 v[206:207], v[206:207], v[0:1] op_sel:[0,1]
CV 192,192
CV 194,194
CV 196,196
CV 198,198
CV 200,200
CV 202,202
CV 204,204
CV 206,206
AW 224,192
AW 225,194
AW 228,196
AW 229,198
AW 226,200
AW 227,202
AW 230,204
AW 231,206
v_pk_mul_f32 v[208:209], v[208:209], v[0:1] op_sel_hi:[1,0]
v_pk_mul_f32 v[210:211], v[210:211], v[0:1] op_sel_hi:[1,0]
v_pk_mul_f32 v[212:213], v[212:213], v[0:1] op_sel:[0,1]
v_pk_mul_f32 v[214:215], v[214:215], v[0:1] op_sel:[0,1]
v_pk_mul_f32 v[216:217], v[216:217], v[0:1] op_sel_hi:[1,0]
v_pk_mul_f32 v[218:219], v[218:219], v[0:1] op_sel_hi:[1,0]
v_pk_mul_f32 v[220:221], v[220:221], v[0:1] op_sel:[0,1]
v_pk_mul_f32 v[222:223], v[222:223], v[0:1] op_sel:[0,1]
CV 208,208
CV 210,210
CV 212,212
CV 214,214
CV 216,216
CV 218,218
CV 220,220
CV 222,222
AW 232,208
AW 233,210
AW 236,212
AW 237,214
AW 234,216
AW 235,218
AW 238,220
AW 239,222
v_pk_mul_f32 v[224:225], v[224:225], v[0:1] op_sel_hi:[1,0]
v_pk_mul_f32 v[226:227], v[226:227], v[0:1] op_sel_hi:[1,0]
v_pk_mul_f32 v[228:229], v[228:229], v[0:1] op_sel:[0,1]
v_pk_mul_f32 v[230:231], v[230:231], v[0:1] op_sel:[0,1]
v_pk_mul_f32 v[232:233], v[232:233], v[0:1] op_sel_hi:[1,0]
v_pk_mul_f32 v[234:235], v[234:235], v[0:1] op_sel_hi:[1,0]
v_pk_mul_f32 v[236:237], v[236:237], v[0:1] op_sel:[0,1]
v_pk_mul_f32 v[238:239], v[238:239], v[0:1] op_sel:[0,1]
CV 224,224
CV 226,226
CV 228,228
CV 230,230
CV 232,232
CV 234,234
CV 236,236
CV 238,238
AW 240,224
AW 241,226
AW 244,228
AW 245,230
AW 242,232
AW 243,234
AW 246,236
AW 247,238
v_pk_mul_f32 v[240:241], v[240:241], v[0:1] op_sel_hi:[1,0]
v_pk_mul_f32 v[242:243], v[242:243], v[0:1] op_sel_hi:[1,0]
v_pk_mul_f32 v[244:245], v[244:245], v[0:1] op_sel:[0,1]
v_pk_mul_f32 v[246:247], v[246:247], v[0:1] op_sel:[0,1]
v_pk_mul_f32 v[248:249], v[248:249], v[0:1] op_sel_hi:[1,0]
v_pk_mul_f32 v[250:251], v[250:251], v[0:1] op_sel_hi:[1,0]
v_pk_mul_f32 v[252:253], v[252:253], v[0:1] op_sel:[0,1]
v_pk_mul_f32 v[254:255], v[254:255], v[0:1] op_sel:[0,1]
CV 240,240
CV 242,242
CV 244,244
CV 246,246
CV 248,248
CV 250,250
CV 252,252
CV 254,254
AW 248,240
AW 249,242
AW 252,244
AW 253,246
AW 250,248
AW 251,250
AW 254,252
AW 255,254
W 6
ZB 128,0,192
G 46,24,66,2
ZB 132,0,196
T 20,21,0
T 22,21,4
ds_write_b128 v58, a[192:195] offset:0
ZB 136,4,192
T 24,22,0
ZB 140,4,196
T 26,22,4
ds_write_b128 v58, a[196:199] offset:1024
W 8
ZB 144,8,192
G 47,24,66,3
ZB 148,8,196
T 28,23,0
T 30,23,4
ds_write_b128 v58, a[200:203] offset:2048
ZB 152,12,192
s_waitcnt vmcnt(20) lgkmcnt(0)
s_barrier
ZB 156,12,196
T 32,16,16
T 34,16,20
ds_write_b128 v58, a[204:207] offset:3072
ZB 160,16,192
T 36,17,16
ZB 164,16,196
T 38,17,20
ds_write_b128 v58, a[208:211] offset:4096
ZB 168,20,192
T 40,18,16
ZB 172,20,196
T 42,18,20
ds_write_b128 v58, a[212:215] offset:5120
ZB 176,24,192
T 44,19,16
ZB 180,24,196
T 46,19,20
ds_write_b128 v58, a[216:219] offset:6144
ZB 184,28,192
T 48,20,16
ZB 188,28,196
T 50,20,20
ds_write_b128 v58, a[220:223] offset:7168
W 10
MB 128,32,200
T 52,21,16
MB 132,32,204
T 54,21,20
MB 136,36,200
T 56,22,16
MB 140,36,204
T 58,22,20
W 8
MB 144,40,200
T 60,23,16
MB 148,40,204
T 62,23,20
MB 152,44,200
s_waitcnt vmcnt(16) lgkmcnt(6)
s_barrier
T 0,16,32
MB 156,44,204
T 2,16,36
R a,96,2,0
s_xor_b32 m0, s65, 0x1c000
s_xor_b32 s66, s62, 0x38000
MB 160,48,200
G 44,24,66,0
MB 164,48,204
T 4,17,32
T 6,17,36
R a,100,2,1
W 10
MB 168,52,200
T 8,18,32
MB 172,52,204
T 10,18,36
R a,104,2,2
W 9
MB 176,56,200
G 45,24,66,1
MB 180,56,204
T 12,19,32
T 14,19,36
R a,108,2,3
MB 184,60,200
T 16,20,32
MB 188,60,204
T 18,20,36
R a,112,2,4
W 10
MB 128,0,208
G 46,24,66,2
MB 132,0,212
T 20,21,32
T 22,21,36
R a,116,2,5
MB 136,4,208
T 24,22,32
MB 140,4,212
T 26,22,36
W 14
R a,120,2,6
W 10
MB 144,8,208
G 47,24,66,3
MB 148,8,212
T 28,23,32
T 30,23,36
R a,124,2,7
MB 152,12,208
s_waitcnt vmcnt(16)
s_barrier
T 32,16,48
MB 156,12,212
T 34,16,52
s_xor_b32 m0, s65, 0x0
s_xor_b32 s66, s62, 0x100
W 9
MB 160,16,208
G 44,24,66,0
MB 164,16,212
T 36,17,48
T 38,17,52
s_getpc_b64 s[88:89]
L_ct3_1379:
s_and_b32 s89, s89, 0xffff
s_mov_b32 s90, L_code_end-L_ct3_1379
s_mov_b32 s91, 0x20000
v_and_b32 v62, 0x70, v59
v_lshlrev_b32 v62, 3, v62
s_add_u32 s7, s1, 4096
buffer_load_dword v3, v62, s[88:91], s7 offen
MB 168,20,208
T 40,18,48
MB 172,20,212
T 42,18,52
W 7
MB 176,24,208
G 45,24,66,1
MB 180,24,212
T 44,19,48
T 46,19,52
MB 184,28,208
T 48,20,48
MB 188,28,212
T 50,20,52
W 6
MB 128,32,216
G 46,24,66,2
MB 132,32,220
T 52,21,48
T 54,21,52
MB 136,36,216
T 56,22,48
MB 140,36,220
T 58,22,52
W 6
MB 144,40,216
G 47,24,66,3
MB 148,40,220
T 60,23,48
T 62,23,52
MB 152,44,216
s_waitcnt vmcnt(17)
s_barrier
T 0,24,0
MB 156,44,220
T 2,24,4
s_xor_b32 m0, s65, 0x4000
s_xor_b32 s66, s62, 0x8100
W 6
MB 160,48,216
G 44,24,66,0
MB 164,48,220
T 4,25,0
T 6,25,4
MB 168,52,216
T 8,26,0
MB 172,52,220
T 10,26,4
W 6
MB 176,56,216
G 45,24,66,1
MB 180,56,220
T 12,27,0
T 14,27,4
MB 184,60,216
T 16,28,0
MB 188,60,220
T 18,28,4
W 6
MB 128,0,96
G 46,24,66,2
MB 132,0,100
T 20,29,0
T 22,29,4
MB 136,4,96
T 24,30,0
MB 140,4,100
T 26,30,4
W 6
MB 144,8,96
G 47,24,66,3
MB 148,8,100
T 28,31,0
T 30,31,4
MB 152,12,96
s_waitcnt vmcnt(17)
s_barrier
T 32,24,16
MB 156,12,100
T 34,24,20
s_xor_b32 m0, s65, 0x8000
s_xor_b32 s66, s62, 0x10100
W 6
MB 160,16,96
G 44,24,66,0
MB 164,16,100
T 36,25,16
T 38,25,20
MB 168,20,96
T 40,26,16
MB 172,20,100
T 42,26,20
W 6
MB 176,24,96
G 45,24,66,1
MB 180,24,100
T 44,27,16
T 46,27,20
MB 184,28,96
T 48,28,16
MB 188,28,100
T 50,28,20
W 6
MB 128,32,104
G 46,24,66,2
MB 132,32,108
T 52,29,16
T 54,29,20
MB 136,36,104
T 56,30,16
MB 140,36,108
T 58,30,20
W 6
MB 144,40,104
G 47,24,66,3
MB 148,40,108
T 60,31,16
T 62,31,20
MB 152,44,104
s_waitcnt vmcnt(17)
s_barrier
T 0,24,32
MB 156,44,108
T 2,24,36
s_xor_b32 m0, s65, 0xc000
s_xor_b32 s66, s62, 0x18100
W 6
MB 160,48,104
G 44,24,66,0
MB 164,48,108
T 4,25,32
T 6,25,36
MB 168,52,104
T 8,26,32
MB 172,52,108
T 10,26,36
W 6
MB 176,56,104
G 45,24,66,1
MB 180,56,108
T 12,27,32
T 14,27,36
MB 184,60,104
T 16,28,32
MB 188,60,108
T 18,28,36
W 6
MB 128,0,112
G 46,24,66,2
MB 132,0,116
T 20,29,32
T 22,29,36
MB 136,4,112
T 24,30,32
MB 140,4,116
T 26,30,36
W 6
MB 144,8,112
G 47,24,66,3
MB 148,8,116
T 28,31,32
T 30,31,36
MB 152,12,112
s_waitcnt vmcnt(17)
s_barrier
T 32,24,48
MB 156,12,116
T 34,24,52
s_xor_b32 m0, s65, 0x10000
s_xor_b32 s66, s62, 0x20100
W 6
MB 160,16,112
G 44,24,66,0
MB 164,16,116
T 36,25,48
T 38,25,52
MB 168,20,112
T 40,26,48
MB 172,20,116
T 42,26,52
W 6
MB 176,24,112
G 45,24,66,1
MB 180,24,116
T 44,27,48
T 46,27,52
MB 184,28,112
T 48,28,48
MB 188,28,116
T 50,28,52
W 6
MB 128,32,120
G 46,24,66,2
MB 132,32,124
T 52,29,48
T 54,29,52
MB 136,36,120
T 56,30,48
MB 140,36,124
T 58,30,52
W 6
MB 144,40,120
G 47,24,66,3
MB 148,40,124
T 60,31,48
T 62,31,52
MB 152,44,120
s_waitcnt vmcnt(16)
s_barrier
T 0,16,0
MB 156,44,124
T 2,16,4
s_xor_b32 m0, s65, 0x14000
s_xor_b32 s66, s62, 0x28100
W 6
MB 160,48,120
G 44,24,66,0
MB 164,48,124
T 4,17,0
T 6,17,4
MB 168,52,120
T 8,18,0
MB 172,52,124
T 10,18,4
W 6
MB 176,56,120
G 45,24,66,1
MB 180,56,124
T 12,19,0
T 14,19,4
MB 184,60,120
T 16,20,0
MB 188,60,124
T 18,20,4
W 6
ZB 192,0,192
G 46,24,66,2
ZB 196,0,196
T 20,21,0
T 22,21,4
ZB 200,4,192
T 24,22,0
ZB 204,4,196
T 26,22,4
W 6
ZB 208,8,192
G 47,24,66,3
ZB 212,8,196
T 28,23,0
T 30,23,4
ZB 216,12,192
s_waitcnt vmcnt(16)
s_barrier
T 32,16,16
ZB 220,12,196
T 34,16,20
s_xor_b32 m0, s65, 0x18000
s_xor_b32 s66, s62, 0x30100
W 6
ZB 224,16,192
G 44,24,66,0
ZB 228,16,196
T 36,17,16
T 38,17,20
ZB 232,20,192
T 40,18,16
ZB 236,20,196
T 42,18,20
W 6
ZB 240,24,192
G 45,24,66,1
ZB 244,24,196
T 44,19,16
T 46,19,20
ZB 248,28,192
T 48,20,16
ZB 252,28,196
T 50,20,20
W 6
MB 192,32,200
G 46,24,66,2
MB 196,32,204
T 52,21,16
T 54,21,20
MB 200,36,200
T 56,22,16
MB 204,36,204
T 58,22,20
W 6
MB 208,40,200
G 47,24,66,3
MB 212,40,204
T 60,23,16
T 62,23,20
MB 216,44,200
s_waitcnt vmcnt(16)
s_barrier
T 0,16,32
MB 220,44,204
T 2,16,36
s_xor_b32 m0, s65, 0x1c000
s_xor_b32 s66, s62, 0x38100
W 6
MB 224,48,200
G 44,24,66,0
MB 228,48,204
T 4,17,32
T 6,17,36
MB 232,52,200
T 8,18,32
MB 236,52,204
T 10,18,36
W 6
MB 240,56,200
G 45,24,66,1
MB 244,56,204
T 12,19,32
T 14,19,36
MB 248,60,200
T 16,20,32
MB 252,60,204
T 18,20,36
W 6
MB 192,0,208
G 46,24,66,2
MB 196,0,212
T 20,21,32
T 22,21,36
MB 200,4,208
T 24,22,32
MB 204,4,212
T 26,22,36
W 6
MB 208,8,208
G 47,24,66,3
MB 212,8,212
T 28,23,32
T 30,23,36
MB 216,12,208
s_waitcnt vmcnt(16)
s_barrier
T 32,16,48
MB 220,12,212
T 34,16,52
s_xor_b32 m0, s65, 0x0
s_xor_b32 s66, s63, 0x40000
W 6
MB 224,16,208
G 32,32,66,0,nt
MB 228,16,212
T 36,17,48
T 38,17,52
MB 232,20,208
T 40,18,48
MB 236,20,212
T 42,18,52
W 6
MB 240,24,208
G 33,32,66,1,nt
MB 244,24,212
T 44,19,48
T 46,19,52
MB 248,28,208
T 48,20,48
MB 252,28,212
T 50,20,52
W 6
MB 192,32,216
G 34,32,66,2,nt
MB 196,32,220
T 52,21,48
T 54,21,52
MB 200,36,216
T 56,22,48
MB 204,36,220
T 58,22,52
W 6
MB 208,40,216
G 35,32,66,3,nt
MB 212,40,220
T 60,23,48
T 62,23,52
MB 216,44,216
s_waitcnt vmcnt(16)
s_barrier
T 0,24,0
MB 220,44,220
T 2,24,4
s_xor_b32 m0, s65, 0x4000
s_xor_b32 s66, s63, 0x50000
W 6
MB 224,48,216
G 32,32,66,0,nt
MB 228,48,220
T 4,25,0
T 6,25,4
MB 232,52,216
T 8,26,0
MB 236,52,220
T 10,26,4
W 6
MB 240,56,216
G 33,32,66,1,nt
MB 244,56,220
T 12,27,0
T 14,27,4
MB 248,60,216
T 16,28,0
MB 252,60,220
T 18,28,4
W 6
MB 192,0,96
G 34,32,66,2,nt
MB 196,0,100
T 20,29,0
T 22,29,4
MB 200,4,96
T 24,30,0
MB 204,4,100
T 26,30,4
W 6
MB 208,8,96
G 35,32,66,3,nt
MB 212,8,100
T 28,31,0
T 30,31,4
MB 216,12,96
s_waitcnt vmcnt(16)
s_barrier
T 32,24,16
MB 220,12,100
T 34,24,20
s_xor_b32 m0, s65, 0x8000
s_xor_b32 s66, s63, 0x40000
W 6
MB 224,16,96
G 56,36,66,0,nt
MB 228,16,100
T 36,25,16
T 38,25,20
MB 232,20,96
T 40,26,16
MB 236,20,100
T 42,26,20
W 6
MB 240,24,96
G 57,36,66,1,nt
MB 244,24,100
T 44,27,16
T 46,27,20
MB 248,28,96
T 48,28,16
MB 252,28,100
T 50,28,20
W 6
MB 192,32,104
G 56,36,66,2,nt
MB 196,32,108
T 52,29,16
T 54,29,20
MB 200,36,104
T 56,30,16
MB 204,36,108
T 58,30,20
W 6
MB 208,40,104
G 57,36,66,3,nt
MB 212,40,108
T 60,31,16
T 62,31,20
MB 216,44,104
s_waitcnt vmcnt(16)
s_barrier
T 0,24,32
MB 220,44,108
T 2,24,36
s_xor_b32 m0, s65, 0xc000
s_xor_b32 s66, s63, 0x44000
W 6
MB 224,48,104
G 32,32,66,0,nt
MB 228,48,108
T 4,25,32
T 6,25,36
MB 232,52,104
T 8,26,32
MB 236,52,108
T 10,26,36
W 6
MB 240,56,104
G 33,32,66,1,nt
MB 244,56,108
T 12,27,32
T 14,27,36
MB 248,60,104
T 16,28,32
MB 252,60,108
T 18,28,36
W 6
MB 192,0,112
G 34,32,66,2,nt
MB 196,0,116
T 20,29,32
T 22,29,36
MB 200,4,112
T 24,30,32
MB 204,4,116
T 26,30,36
W 6
MB 208,8,112
G 35,32,66,3,nt
MB 212,8,116
T 28,31,32
T 30,31,36
MB 216,12,112
s_waitcnt vmcnt(16)
s_barrier
MB 220,12,116
T 32,24,48
T 34,24,52
W 6
MB 224,16,112
T 36,25,48
MB 228,16,116
T 38,25,52
MB 232,20,112
T 40,26,48
MB 236,20,116
T 42,26,52
W 6
MB 240,24,112
T 44,27,48
MB 244,24,116
T 46,27,52
MB 248,28,112
T 48,28,48
MB 252,28,116
T 50,28,52
W 6
MB 192,32,120
T 52,29,48
MB 196,32,124
T 54,29,52
MB 200,36,120
T 56,30,48
MB 204,36,124
T 58,30,52
W 6
MB 208,40,120
T 60,31,48
MB 212,40,124
T 62,31,52
MB 216,44,120
s_waitcnt vmcnt(12)
s_barrier
MB 220,44,124
R a,0,8,0
s_xor_b32 m0, s65, 0x10000
s_xor_b32 s66, s63, 0x50000
W 5
MB 224,48,120
G 56,36,66,0,nt
MB 228,48,124
R a,4,9,0
MB 232,52,120
R a,8,10,0
MB 236,52,124
W 3
MB 240,56,120
G 57,36,66,1,nt
MB 244,56,124
R a,12,11,0
MB 248,60,120
R a,16,8,4
MB 252,60,124
W 3
ZB 64,0,160
G 56,36,66,2,nt
ZB 68,0,164
R a,20,9,4
MB 64,4,168
R a,24,10,4
MB 68,4,172
W 3
MB 64,8,176
G 57,36,66,3,nt
MB 68,8,180
R a,28,11,4
MB 64,12,184
MB 68,12,188
W 2
ZB 72,16,160
ZB 76,16,164
MB 72,20,168
MB 76,20,172
W 0
MB 72,24,176
E 64
MB 76,24,180
MB 72,28,184
E 65
MB 76,28,188
CV 96,64
E 66
E 67
s_nop 0
CV 97,66
E 68
s_waitcnt vmcnt(12)
s_barrier
R a,0,8,16
E 69
s_xor_b32 m0, s65, 0x14000
s_xor_b32 s66, s63, 0x54000
R a,4,9,16
G 32,32,66,0,nt
CV 100,68
E 70
R a,8,10,16
E 71
R a,12,11,16
G 33,32,66,1,nt
CV 101,70
E 72
R a,16,8,20
E 73
W 3
ZB 80,0,160
G 34,32,66,2,nt
R a,20,9,20
ZB 84,0,164
CV 98,72
E 74
MB 80,4,168
R a,24,10,20
MB 84,4,172
E 75
W 3
MB 80,8,176
G 35,32,66,3,nt
R a,28,11,20
MB 84,8,180
CV 99,74
E 76
MB 80,12,184
s_waitcnt vmcnt(12)
s_barrier
T 32,16,32
T 34,16,36
MB 84,12,188
E 77
s_xor_b32 m0, s65, 0x18000
s_xor_b32 s66, s63, 0x44000
W 4
ZB 88,16,160
G 56,36,66,0,nt
T 36,17,32
ZB 92,16,164
T 38,17,36
CV 102,76
E 78
s_getpc_b64 s[88:89]
L_ct3_1507:
s_and_b32 s89, s89, 0xffff
s_mov_b32 s90, L_code_end-L_ct3_1507
s_mov_b32 s91, 0x20000
v_and_b32 v62, 0x70, v59
v_lshlrev_b32 v62, 3, v62
s_add_u32 s7, s1, 4096
buffer_load_dword v3, v62, s[88:91], s7 offen
MB 88,20,168
T 40,18,32
T 42,18,36
MB 92,20,172
E 79
W 6
MB 88,24,176
G 57,36,66,1,nt
T 44,19,32
MB 92,24,180
T 46,19,36
CV 103,78
E 80
MB 88,28,184
T 48,20,32
T 50,20,36
MB 92,28,188
E 81
W 6
ZC 128,32,96
G 56,36,66,2,nt
T 52,21,32
ZC 132,32,100
T 54,21,36
CV 104,80
E 82
ZC 136,36,96
T 56,22,32
T 58,22,36
ZC 140,36,100
E 83
W 6
ZC 144,40,96
G 57,36,66,3,nt
T 60,23,32
ZC 148,40,100
T 62,23,36
CV 105,82
E 84
ZC 152,44,96
E 85
ZC 156,44,100
W 4
ZC 96,48,96
s_waitcnt vmcnt(13)
s_barrier
R a,0,8,48
CV 108,84
ZC 100,48,100
E 86
s_xor_b32 m0, s65, 0x1c000
s_xor_b32 s66, s63, 0x41000
ZC 104,52,96
G 32,32,66,0,nt
ZC 108,52,100
R a,4,9,48
E 87
W 2
ZC 112,56,96
R a,8,10,48
CV 109,86
ZC 116,56,100
E 88
ZC 120,60,96
G 33,32,66,1,nt
ZC 124,60,100
R a,12,11,48
E 89
ZD 112,52,96
R a,16,8,52
CV 106,88
ZD 116,52,100
E 90
W 3
ZB 64,0,160
G 34,32,66,2,nt
ZB 68,0,164
R a,20,9,52
E 91
MB 64,4,168
R a,24,10,52
CV 107,90
MB 68,4,172
E 92
W 3
MB 64,8,176
G 35,32,66,3,nt
MB 68,8,180
R a,28,11,52
E 93
MB 64,12,184
s_waitcnt vmcnt(13)
s_barrier
T 32,24,0
T 34,24,4
MB 68,12,188
CV 110,92
E 94
s_xor_b32 m0, s65, 0x0
s_xor_b32 s66, s63, 0x54000
W 4
ZB 72,16,160
G 56,36,66,0,nt
T 36,25,0
ZB 76,16,164
T 38,25,4
E 95
MB 72,20,168
T 40,26,0
MB 76,20,172
T 42,26,4
CV 111,94
W 6
MB 72,24,176
G 57,36,66,1,nt
T 44,27,0
MB 76,24,180
T 46,27,4
E 64
MB 72,28,184
T 48,28,0
T 50,28,4
MB 76,28,188
E 65
W 6
MC 128,32,104
G 56,36,66,2,nt
T 52,29,0
MC 132,32,108
T 54,29,4
CV 96,64
E 66
MC 136,36,104
T 56,30,0
T 58,30,4
MC 140,36,108
E 67
W 6
MC 144,40,104
G 57,36,66,3,nt
T 60,31,0
MC 148,40,108
T 62,31,4
CV 97,66
E 68
MC 152,44,104
E 69
MC 156,44,108
W 4
MC 96,48,104
s_waitcnt vmcnt(13)
s_barrier
R a,0,12,16
CV 100,68
MC 100,48,108
E 70
s_xor_b32 m0, s65, 0x4000
s_xor_b32 s66, s63, 0x51000
MC 104,52,104
G 32,32,66,0,nt
MC 108,52,108
R a,4,13,16
E 71
W 2
MC 112,56,104
R a,8,14,16
CV 101,70
MC 116,56,108
E 72
MC 120,60,104
G 33,32,66,1,nt
MC 124,60,108
R a,12,15,16
E 73
MD 112,52,104
R a,16,12,20
CV 98,72
MD 116,52,108
E 74
W 3
ZB 80,0,160
G 34,32,66,2,nt
ZB 84,0,164
R a,20,13,20
E 75
MB 80,4,168
R a,24,14,20
CV 99,74
MB 84,4,172
E 76
W 3
MB 80,8,176
G 35,32,66,3,nt
MB 84,8,180
R a,28,15,20
E 77
MB 80,12,184
s_waitcnt vmcnt(12)
s_barrier
T 32,24,32
T 34,24,36
MB 84,12,188
CV 102,76
E 78
s_xor_b32 m0, s65, 0x8000
s_xor_b32 s66, s63, 0x41000
W 4
ZB 88,16,160
G 56,36,66,0,nt
T 36,25,32
ZB 92,16,164
T 38,25,36
E 79
MB 88,20,168
T 40,26,32
MB 92,20,172
T 42,26,36
CV 103,78
W 6
MB 88,24,176
G 57,36,66,1,nt
T 44,27,32
MB 92,24,180
T 46,27,36
E 80
MB 88,28,184
T 48,28,32
T 50,28,36
MB 92,28,188
E 81
W 6
MC 128,32,96
G 56,36,66,2,nt
T 52,29,32
MC 132,32,100
T 54,29,36
CV 104,80
E 82
MC 136,36,96
T 56,30,32
T 58,30,36
MC 140,36,100
E 83
W 6
MC 144,40,96
G 57,36,66,3,nt
T 60,31,32
MC 148,40,100
T 62,31,36
CV 105,82
E 84
MC 152,44,96
E 85
MC 156,44,100
W 4
MC 96,48,96
s_waitcnt vmcnt(12)
s_barrier
R a,0,12,48
CV 108,84
MC 100,48,100
E 86
s_xor_b32 m0, s65, 0xc000
s_xor_b32 s66, s63, 0x45000
MC 104,52,96
G 32,32,66,0,nt
MC 108,52,100
R a,4,13,48
E 87
W 2
MC 112,56,96
R a,8,14,48
CV 109,86
MC 116,56,100
E 88
MC 120,60,96
G 33,32,66,1,nt
MC 124,60,100
R a,12,15,48
E 89
MD 112,52,96
R a,16,12,52
CV 106,88
MD 116,52,100
E 90
W 3
ZB 64,0,160
G 34,32,66,2,nt
ZB 68,0,164
R a,20,13,52
E 91
MB 64,4,168
R a,24,14,52
CV 107,90
MB 68,4,172
E 92
W 3
MB 64,8,176
G 35,32,66,3,nt
MB 68,8,180
R a,28,15,52
E 93
MB 64,12,184
s_waitcnt vmcnt(12)
s_barrier
T 32,16,0
T 34,16,4
MB 68,12,188
CV 110,92
E 94
s_xor_b32 m0, s65, 0x10000
s_xor_b32 s66, s63, 0x51000
W 4
ZB 72,16,160
G 56,36,66,0,nt
T 36,17,0
ZB 76,16,164
T 38,17,4
E 95
MB 72,20,168
T 40,18,0
MB 76,20,172
T 42,18,4
CV 111,94
W 6
MB 72,24,176
G 57,36,66,1,nt
T 44,19,0
MB 76,24,180
T 46,19,4
E 64
MB 72,28,184
T 48,20,0
T 50,20,4
MB 76,28,188
E 65
W 6
MC 128,32,104
G 56,36,66,2,nt
T 52,21,0
MC 132,32,108
T 54,21,4
CV 96,64
E 66
MC 136,36,104
T 56,22,0
T 58,22,4
MC 140,36,108
E 67
W 6
MC 144,40,104
G 57,36,66,3,nt
T 60,23,0
MC 148,40,108
T 62,23,4
CV 97,66
E 68
MC 152,44,104
E 69
MC 156,44,108
W 4
MC 96,48,104
s_waitcnt vmcnt(12)
s_barrier
R a,0,8,16
CV 100,68
MC 100,48,108
E 70
s_xor_b32 m0, s65, 0x14000
s_xor_b32 s66, s63, 0x45000
MC 104,52,104
G 56,36,66,0,nt
MC 108,52,108
R a,4,9,16
E 71
W 2
MC 112,56,104
R a,8,10,16
CV 101,70
MC 116,56,108
E 72
MC 120,60,104
G 57,36,66,1,nt
MC 124,60,108
R a,12,11,16
E 73
MD 112,52,104
R a,16,8,20
CV 98,72
MD 116,52,108
E 74
W 3
ZB 80,0,160
G 56,36,66,2,nt
ZB 84,0,164
R a,20,9,20
E 75
MB 80,4,168
R a,24,10,20
CV 99,74
MB 84,4,172
E 76
W 3
MB 80,8,176
G 57,36,66,3,nt
MB 84,8,180
R a,28,11,20
E 77
MB 80,12,184
s_waitcnt vmcnt(12)
s_barrier
T 32,16,32
T 34,16,36
MB 84,12,188
CV 102,76
E 78
s_xor_b32 m0, s65, 0x18000
s_xor_b32 s66, s62, 0x40000
W 4
ZB 88,16,160
G 44,24,66,0
T 36,17,32
ZB 92,16,164
T 38,17,36
E 79
MB 88,20,168
T 40,18,32
MB 92,20,172
T 42,18,36
CV 103,78
W 6
MB 88,24,176
G 45,24,66,1
T 44,19,32
MB 92,24,180
T 46,19,36
E 80
MB 88,28,184
T 48,20,32
T 50,20,36
MB 92,28,188
E 81
W 6
MC 128,32,96
G 46,24,66,2
T 52,21,32
MC 132,32,100
T 54,21,36
CV 104,80
E 82
MC 136,36,96
T 56,22,32
T 58,22,36
MC 140,36,100
E 83
W 6
MC 144,40,96
G 47,24,66,3
T 60,23,32
MC 148,40,100
T 62,23,36
CV 105,82
E 84
MC 152,44,96
E 85
MC 156,44,100
W 4
MC 96,48,96
s_waitcnt vmcnt(12)
s_barrier
R a,0,8,48
CV 108,84
MC 100,48,100
E 86
s_xor_b32 m0, s65, 0x1c000
s_xor_b32 s66, s62, 0x48000
MC 104,52,96
G 44,24,66,0
MC 108,52,100
R a,4,9,48
E 87
W 2
MC 112,56,96
R a,8,10,48
CV 109,86
MC 116,56,100
E 88
MC 120,60,96
G 45,24,66,1
MC 124,60,100
R a,12,11,48
E 89
MD 112,52,96
R a,16,8,52
CV 106,88
MD 116,52,100
E 90
W 3
ZB 64,0,160
G 46,24,66,2
ZB 68,0,164
R a,20,9,52
E 91
MB 64,4,168
R a,24,10,52
CV 107,90
MB 68,4,172
E 92
W 3
MB 64,8,176
G 47,24,66,3
MB 68,8,180
R a,28,11,52
E 93
MB 64,12,184
s_waitcnt vmcnt(12)
s_barrier
T 32,24,0
T 34,24,4
MB 68,12,188
CV 110,92
E 94
s_xor_b32 m0, s65, 0x0
s_xor_b32 s66, s62, 0x50000
W 4
ZB 72,16,160
G 44,24,66,0
T 36,25,0
ZB 76,16,164
T 38,25,4
E 95
MB 72,20,168
T 40,26,0
MB 76,20,172
T 42,26,4
CV 111,94
W 6
MB 72,24,176
G 45,24,66,1
T 44,27,0
MB 76,24,180
T 46,27,4
E 64
MB 72,28,184
T 48,28,0
T 50,28,4
MB 76,28,188
E 65
W 6
MC 128,32,104
G 46,24,66,2
T 52,29,0
MC 132,32,108
T 54,29,4
CV 96,64
E 66
MC 136,36,104
T 56,30,0
T 58,30,4
MC 140,36,108
E 67
W 6
MC 144,40,104
G 47,24,66,3
T 60,31,0
MC 148,40,108
T 62,31,4
CV 97,66
E 68
MC 152,44,104
E 69
MC 156,44,108
W 4
MC 96,48,104
CV 100,68
MC 100,48,108
E 70
MC 104,52,104
E 71
MC 108,52,108
W 0
MC 112,56,104
CV 101,70
MC 116,56,108
E 72
MC 120,60,104
E 73
MC 124,60,108
MD 112,52,104
CV 98,72
MD 116,52,108
E 74
E 75
s_nop 0
CV 99,74
E 76
E 77
s_waitcnt vmcnt(12)
s_barrier
T 32,24,16
T 34,24,20
CV 102,76
E 78
s_xor_b32 m0, s65, 0x4000
s_xor_b32 s66, s62, 0x58000
T 36,25,16
T 38,25,20
G 44,24,66,0
E 79
T 40,26,16
T 42,26,20
CV 103,78
T 44,27,16
T 46,27,20
G 45,24,66,1
T 48,28,16
T 50,28,20
W 6
MC 128,32,96
G 46,24,66,2
MC 132,32,100
T 52,29,16
T 54,29,20
MC 136,36,96
T 56,30,16
MC 140,36,100
T 58,30,20
W 6
MC 144,40,96
G 47,24,66,3
MC 148,40,100
T 60,31,16
T 62,31,20
MC 152,44,96
MC 156,44,100
W 4
MC 96,48,96
s_waitcnt vmcnt(12)
s_barrier
s_xor_b32 m0, s65, 0x8000
s_xor_b32 s66, s62, 0x60000
MC 100,48,100
G 44,24,66,0
T 0,24,32
T 2,24,36
MC 104,52,96
G 45,24,66,1
MC 108,52,100
T 4,25,32
T 6,25,36
W 4
MC 112,56,96
G 46,24,66,2
MC 116,56,100
T 8,26,32
T 10,26,36
MC 120,60,96
G 47,24,66,3
MC 124,60,100
T 12,27,32
T 14,27,36
MD 112,52,96
s_xor_b32 m0, s65, 0xc000
s_xor_b32 s66, s62, 0x68000
MD 116,52,100
G 44,24,66,0
T 16,28,32
T 18,28,36
s_nop 1
v_mov_b32 v6, v112
s_nop 1
v_mov_b32 v7, v116
W 6
MB 128,0,224
G 45,24,66,1
MB 132,0,228
T 20,29,32
T 22,29,36
ds_write_b128 v58, a[224:227] offset:0
MB 136,4,224
G 46,24,66,2
MB 140,4,228
T 24,30,32
T 26,30,36
ds_write_b128 v58, a[228:231] offset:1024
W 8
MB 144,8,224
G 47,24,66,3
MB 148,8,228
T 28,31,32
T 30,31,36
ds_write_b128 v58, a[232:235] offset:2048
MB 152,12,224
s_waitcnt vmcnt(16) lgkmcnt(0)
s_barrier
T 32,24,48
MB 156,12,228
T 34,24,52
ds_write_b128 v58, a[236:239] offset:3072
s_xor_b32 m0, s65, 0x10000
s_xor_b32 s66, s62, 0x70000
MB 160,16,224
G 44,24,66,0
MB 164,16,228
T 36,25,48
T 38,25,52
ds_write_b128 v58, a[240:243] offset:4096
MB 168,20,224
T 40,26,48
MB 172,20,228
T 42,26,52
ds_write_b128 v58, a[244:247] offset:5120
MB 176,24,224
G 45,24,66,1
MB 180,24,228
T 44,27,48
T 46,27,52
ds_write_b128 v58, a[248:251] offset:6144
MB 184,28,224
T 48,28,48
MB 188,28,228
T 50,28,52
ds_write_b128 v58, a[252:255] offset:7168
W 10
MB 128,32,232
G 46,24,66,2
MB 132,32,236
T 52,29,48
T 54,29,52
MB 136,36,232
T 56,30,48
MB 140,36,236
T 58,30,52
W 8
MB 144,40,232
G 47,24,66,3
MB 148,40,236
T 60,31,48
T 62,31,52
MB 152,44,232
s_waitcnt vmcnt(16) lgkmcnt(6)
s_barrier
T 0,16,0
MB 156,44,236
T 2,16,4
R a,192,2,0
s_xor_b32 m0, s65, 0x14000
s_xor_b32 s66, s62, 0x78000
MB 160,48,232
G 44,24,66,0
MB 164,48,236
T 4,17,0
T 6,17,4
R a,196,2,1
W 10
MB 168,52,232
T 8,18,0
MB 172,52,236
T 10,18,4
R a,200,2,2
W 9
MB 176,56,232
G 45,24,66,1
MB 180,56,236
T 12,19,0
T 14,19,4
R a,204,2,3
MB 184,60,232
T 16,20,0
MB 188,60,236
T 18,20,4
R a,208,2,4
W 10
MB 128,0,240
G 46,24,66,2
MB 132,0,244
T 20,21,0
T 22,21,4
R a,212,2,5
MB 136,4,240
T 24,22,0
MB 140,4,244
T 26,22,4
W 14
R a,216,2,6
W 10
MB 144,8,240
G 47,24,66,3
MB 148,8,244
T 28,23,0
T 30,23,4
R a,220,2,7
MB 152,12,240
s_waitcnt vmcnt(16)
s_barrier
T 32,16,16
MB 156,12,244
T 34,16,20
s_xor_b32 m0, s65, 0x18000
s_xor_b32 s66, s62, 0x40100
W 9
MB 160,16,240
G 44,24,66,0
MB 164,16,244
T 36,17,16
T 38,17,20
s_getpc_b64 s[88:89]
L_ct3_1642:
s_and_b32 s89, s89, 0xffff
s_mov_b32 s90, L_code_end-L_ct3_1642
s_mov_b32 s91, 0x20000
v_and_b32 v62, 0x70, v59
v_lshlrev_b32 v62, 3, v62
s_add_u32 s7, s1, 4096
buffer_load_dword v3, v62, s[88:91], s7 offen
MB 168,20,240
T 40,18,16
MB 172,20,244
T 42,18,20
W 7
MB 176,24,240
G 45,24,66,1
MB 180,24,244
T 44,19,16
T 46,19,20
MB 184,28,240
T 48,20,16
MB 188,28,244
T 50,20,20
W 6
MB 128,32,248
G 46,24,66,2
MB 132,32,252
T 52,21,16
T 54,21,20
MB 136,36,248
T 56,22,16
MB 140,36,252
T 58,22,20
W 6
MB 144,40,248
G 47,24,66,3
MB 148,40,252
T 60,23,16
T 62,23,20
MB 152,44,248
s_waitcnt vmcnt(17)
s_barrier
T 0,16,32
MB 156,44,252
T 2,16,36
s_xor_b32 m0, s65, 0x1c000
s_xor_b32 s66, s62, 0x48100
W 6
MB 160,48,248
G 44,24,66,0
MB 164,48,252
T 4,17,32
T 6,17,36
MB 168,52,248
T 8,18,32
MB 172,52,252
T 10,18,36
W 6
MB 176,56,248
G 45,24,66,1
MB 180,56,252
T 12,19,32
T 14,19,36
MB 184,60,248
T 16,20,32
MB 188,60,252
T 18,20,36
W 6
MB 128,0,192
G 46,24,66,2
MB 132,0,196
T 20,21,32
T 22,21,36
MB 136,4,192
T 24,22,32
MB 140,4,196
T 26,22,36
W 6
MB 144,8,192
G 47,24,66,3
MB 148,8,196
T 28,23,32
T 30,23,36
MB 152,12,192
s_waitcnt vmcnt(17)
s_barrier
T 32,16,48
MB 156,12,196
T 34,16,52
s_xor_b32 m0, s65, 0x0
s_xor_b32 s66, s62, 0x50100
W 6
MB 160,16,192
G 44,24,66,0
MB 164,16,196
T 36,17,48
T 38,17,52
MB 168,20,192
T 40,18,48
MB 172,20,196
T 42,18,52
W 6
MB 176,24,192
G 45,24,66,1
MB 180,24,196
T 44,19,48
T 46,19,52
MB 184,28,192
T 48,20,48
MB 188,28,196
T 50,20,52
W 6
MB 128,32,200
G 46,24,66,2
MB 132,32,204
T 52,21,48
T 54,21,52
MB 136,36,200
T 56,22,48
MB 140,36,204
T 58,22,52
W 6
MB 144,40,200
G 47,24,66,3
MB 148,40,204
T 60,23,48
T 62,23,52
MB 152,44,200
s_waitcnt vmcnt(17)
s_barrier
T 0,24,0
MB 156,44,204
T 2,24,4
s_xor_b32 m0, s65, 0x4000
s_xor_b32 s66, s62, 0x58100
W 6
MB 160,48,200
G 44,24,66,0
MB 164,48,204
T 4,25,0
T 6,25,4
MB 168,52,200
T 8,26,0
MB 172,52,204
T 10,26,4
W 6
MB 176,56,200
G 45,24,66,1
MB 180,56,204
T 12,27,0
T 14,27,4
MB 184,60,200
T 16,28,0
MB 188,60,204
T 18,28,4
W 6
MB 128,0,208
G 46,24,66,2
MB 132,0,212
T 20,29,0
T 22,29,4
MB 136,4,208
T 24,30,0
MB 140,4,212
T 26,30,4
W 6
MB 144,8,208
G 47,24,66,3
MB 148,8,212
T 28,31,0
T 30,31,4
MB 152,12,208
s_waitcnt vmcnt(17)
s_barrier
T 32,24,16
MB 156,12,212
T 34,24,20
s_xor_b32 m0, s65, 0x8000
s_xor_b32 s66, s62, 0x60100
W 6
MB 160,16,208
G 44,24,66,0
MB 164,16,212
T 36,25,16
T 38,25,20
MB 168,20,208
T 40,26,16
MB 172,20,212
T 42,26,20
W 6
MB 176,24,208
G 45,24,66,1
MB 180,24,212
T 44,27,16
T 46,27,20
MB 184,28,208
T 48,28,16
MB 188,28,212
T 50,28,20
W 6
MB 128,32,216
G 46,24,66,2
MB 132,32,220
T 52,29,16
T 54,29,20
MB 136,36,216
T 56,30,16
MB 140,36,220
T 58,30,20
W 6
MB 144,40,216
G 47,24,66,3
MB 148,40,220
T 60,31,16
T 62,31,20
MB 152,44,216
s_waitcnt vmcnt(16)
s_barrier
T 0,24,32
MB 156,44,220
T 2,24,36
s_xor_b32 m0, s65, 0xc000
s_xor_b32 s66, s62, 0x68100
W 6
MB 160,48,216
G 44,24,66,0
MB 164,48,220
T 4,25,32
T 6,25,36
MB 168,52,216
T 8,26,32
MB 172,52,220
T 10,26,36
W 6
MB 176,56,216
G 45,24,66,1
MB 180,56,220
T 12,27,32
T 14,27,36
MB 184,60,216
T 16,28,32
MB 188,60,220
T 18,28,36
W 6
MB 192,0,224
G 46,24,66,2
MB 196,0,228
T 20,29,32
T 22,29,36
MB 200,4,224
T 24,30,32
MB 204,4,228
T 26,30,36
W 6
MB 208,8,224
G 47,24,66,3
MB 212,8,228
T 28,31,32
T 30,31,36
MB 216,12,224
s_waitcnt vmcnt(16)
s_barrier
T 32,24,48
T 34,24,52
MB 220,12,228
CV 68,132
CV 69,134
s_xor_b32 m0, s65, 0x10000
s_xor_b32 s66, s62, 0x70100
W 6
MB 224,16,224
G 44,24,66,0
MB 228,16,228
T 36,25,48
T 38,25,52
CV 70,140
MB 232,20,224
T 40,26,48
T 42,26,52
MB 236,20,228
CV 71,142
s_xor_b32 s79, s67, 0x11000
W 6
MB 240,24,224
G 45,24,66,1
T 44,27,48
MB 244,24,228
T 46,27,52
buffer_store_dwordx4 v[68:71], v59, s[52:55], s79 offen sc1
MB 248,28,224
T 48,28,48
T 50,28,52
MB 252,28,228
CV 72,144
CV 73,146
W 6
MB 192,32,232
G 46,24,66,2
MB 196,32,236
T 52,29,48
T 54,29,52
CV 74,152
MB 200,36,232
T 56,30,48
T 58,30,52
MB 204,36,236
CV 75,154
s_xor_b32 s79, s67, 0x22000
W 6
MB 208,40,232
G 47,24,66,3
T 60,31,48
MB 212,40,236
T 62,31,52
buffer_store_dwordx4 v[72:75], v59, s[52:55], s79 offen sc1
MB 216,44,232
s_waitcnt vmcnt(18)
s_barrier
T 0,16,0
T 2,16,4
MB 220,44,236
CV 76,148
CV 77,150
s_xor_b32 m0, s65, 0x14000
s_xor_b32 s66, s62, 0x78100
W 6
MB 224,48,232
G 44,24,66,0
MB 228,48,236
T 4,17,0
T 6,17,4
CV 78,156
MB 232,52,232
T 8,18,0
T 10,18,4
MB 236,52,236
CV 79,158
s_xor_b32 s79, s67, 0x33000
W 6
MB 240,56,232
G 45,24,66,1
T 12,19,0
MB 244,56,236
T 14,19,4
buffer_store_dwordx4 v[76:79], v59, s[52:55], s79 offen sc1
MB 248,60,232
T 16,20,0
T 18,20,4
MB 252,60,236
CV 80,160
CV 81,162
W 6
MB 192,0,240
G 46,24,66,2
MB 196,0,244
T 20,21,0
T 22,21,4
CV 82,168
MB 200,4,240
T 24,22,0
T 26,22,4
MB 204,4,244
CV 83,170
s_xor_b32 s79, s67, 0x44000
W 6
MB 208,8,240
G 47,24,66,3
T 28,23,0
MB 212,8,244
T 30,23,4
buffer_store_dwordx4 v[80:83], v59, s[52:55], s79 offen sc1
MB 216,12,240
s_waitcnt vmcnt(20)
s_barrier
T 32,16,16
T 34,16,20
MB 220,12,244
CV 84,164
CV 85,166
s_xor_b32 m0, s65, 0x18000
s_xor_b32 s66, s62, 0x0
W 6
MB 224,16,240
G 44,44,66,0
MB 228,16,244
T 36,17,16
T 38,17,20
CV 86,172
MB 232,20,240
T 40,18,16
T 42,18,20
MB 236,20,244
CV 87,174
s_xor_b32 s79, s67, 0x55000
W 6
MB 240,24,240
G 45,44,66,1
T 44,19,16
MB 244,24,244
T 46,19,20
buffer_store_dwordx4 v[84:87], v59, s[52:55], s79 offen sc1
MB 248,28,240
T 48,20,16
T 50,20,20
MB 252,28,244
CV 88,176
CV 89,178
W 6
MB 192,32,248
G 46,44,66,2
MB 196,32,252
T 52,21,16
T 54,21,20
CV 90,184
MB 200,36,248
T 56,22,16
T 58,22,20
MB 204,36,252
CV 91,186
s_xor_b32 s79, s67, 0x66000
W 6
MB 208,40,248
G 47,44,66,3
T 60,23,16
MB 212,40,252
T 62,23,20
buffer_store_dwordx4 v[88:91], v59, s[52:55], s79 offen sc1
MB 216,44,248
s_waitcnt vmcnt(22)
s_barrier
T 0,16,32
T 2,16,36
MB 220,44,252
CV 92,180
CV 93,182
s_xor_b32 m0, s65, 0x1c000
s_xor_b32 s66, s62, 0x8000
W 6
MB 224,48,248
G 44,44,66,0
MB 228,48,252
T 4,17,32
T 6,17,36
CV 94,188
MB 232,52,248
T 8,18,32
T 10,18,36
MB 236,52,252
CV 95,190
s_xor_b32 s79, s67, 0x77000
W 6
MB 240,56,248
G 45,44,66,1
T 12,19,32
MB 244,56,252
T 14,19,36
buffer_store_dwordx4 v[92:95], v59, s[52:55], s79 offen sc1
MB 248,60,248
T 16,20,32
MB 252,60,252
T 18,20,36
CV 36,128
W 6
MB 192,0,192
G 46,44,66,2
MB 196,0,196
T 20,21,32
T 22,21,36
CV 37,130
MB 200,4,192
T 24,22,32
MB 204,4,196
T 26,22,36
CV 38,136
W 6
MB 208,8,192
G 47,44,66,3
MB 212,8,196
T 28,23,32
T 30,23,36
CV 39,138
MB 216,12,192
s_waitcnt vmcnt(23)
s_barrier
T 32,16,48
MB 220,12,196
T 34,16,52
s_xor_b32 m0, s65, 0x0
s_xor_b32 s66, s62, 0x10000
W 6
MB 224,16,192
G 44,44,66,0
MB 228,16,196
T 36,17,48
T 38,17,52
MB 232,20,192
T 40,18,48
MB 236,20,196
T 42,18,52
W 6
MB 240,24,192
G 45,44,66,1
MB 244,24,196
T 44,19,48
T 46,19,52
MB 248,28,192
T 48,20,48
MB 252,28,196
T 50,20,52
W 6
MB 192,32,200
G 46,44,66,2
MB 196,32,204
T 52,21,48
T 54,21,52
MB 200,36,200
T 56,22,48
MB 204,36,204
T 58,22,52
W 6
MB 208,40,200
G 47,44,66,3
MB 212,40,204
T 60,23,48
T 62,23,52
MB 216,44,200
s_waitcnt vmcnt(22)
s_barrier
T 0,24,0
MB 220,44,204
T 2,24,4
s_xor_b32 m0, s65, 0x4000
s_xor_b32 s66, s62, 0x18000
W 6
MB 224,48,200
G 44,44,66,0
MB 228,48,204
T 4,25,0
T 6,25,4
MB 232,52,200
T 8,26,0
MB 236,52,204
T 10,26,4
W 6
MB 240,56,200
G 45,44,66,1
MB 244,56,204
T 12,27,0
T 14,27,4
MB 248,60,200
T 16,28,0
MB 252,60,204
T 18,28,4
W 6
MB 192,0,208
G 46,44,66,2
MB 196,0,212
T 20,29,0
T 22,29,4
MB 200,4,208
T 24,30,0
MB 204,4,212
T 26,30,4
W 6
MB 208,8,208
G 47,44,66,3
MB 212,8,212
T 28,31,0
T 30,31,4
MB 216,12,208
s_waitcnt vmcnt(20)
s_barrier
T 32,24,16
MB 220,12,212
T 34,24,20
s_xor_b32 m0, s65, 0x8000
s_xor_b32 s66, s62, 0x20000
W 6
MB 224,16,208
G 44,44,66,0
MB 228,16,212
T 36,25,16
T 38,25,20
MB 232,20,208
T 40,26,16
MB 236,20,212
T 42,26,20
W 6
MB 240,24,208
G 45,44,66,1
MB 244,24,212
T 44,27,16
T 46,27,20
MB 248,28,208
T 48,28,16
MB 252,28,212
T 50,28,20
W 6
MB 192,32,216
G 46,44,66,2
MB 196,32,220
T 52,29,16
T 54,29,20
MB 200,36,216
T 56,30,16
MB 204,36,220
T 58,30,20
W 6
MB 208,40,216
G 47,44,66,3
MB 212,40,220
T 60,31,16
T 62,31,20
MB 216,44,216
s_waitcnt vmcnt(18)
s_barrier
T 0,24,32
MB 220,44,220
T 2,24,36
s_xor_b32 m0, s65, 0xc000
s_xor_b32 s66, s62, 0x28000
W 6
MB 224,48,216
G 44,44,66,0
MB 228,48,220
T 4,25,32
T 6,25,36
MB 232,52,216
T 8,26,32
MB 236,52,220
T 10,26,36
W 6
MB 240,56,216
G 45,44,66,1
MB 244,56,220
T 12,27,32
T 14,27,36
MB 248,60,216
T 16,28,32
MB 252,60,220
T 18,28,36
CV 100,196
CV 101,198
CV 102,204
CV 103,206
s_xor_b32 s79, s67, 0x19000
buffer_store_dwordx4 v[100:103], v59, s[52:55], s79 offen sc1
CV 104,208
CV 105,210
CV 106,216
CV 107,218
s_xor_b32 s79, s67, 0x2a000
buffer_store_dwordx4 v[104:107], v59, s[52:55], s79 offen sc1
CV 108,212
CV 109,214
CV 110,220
CV 111,222
s_xor_b32 s79, s67, 0x3b000
buffer_store_dwordx4 v[108:111], v59, s[52:55], s79 offen sc1
CV 112,224
CV 113,226
CV 114,232
CV 115,234
s_xor_b32 s79, s67, 0x4c000
buffer_store_dwordx4 v[112:115], v59, s[52:55], s79 offen sc1
CV 116,228
CV 117,230
CV 118,236
CV 119,238
s_xor_b32 s79, s67, 0x5d000
buffer_store_dwordx4 v[116:119], v59, s[52:55], s79 offen sc1
CV 120,240
CV 121,242
CV 122,248
CV 123,250
s_xor_b32 s79, s67, 0x6e000
buffer_store_dwordx4 v[120:123], v59, s[52:55], s79 offen sc1
CV 124,244
CV 125,246
CV 126,252
CV 127,254
s_xor_b32 s79, s67, 0x7f000
buffer_store_dwordx4 v[124:127], v59, s[52:55], s79 offen sc1
CV 40,192
CV 41,194
CV 42,200
CV 43,202
W 6
ZB 128,0,64
G 46,44,66,2
ZB 132,0,68
T 20,29,32
T 22,29,36
ds_write_b128 v58, a[64:67] offset:0
ZB 136,4,64
T 24,30,32
ZB 140,4,68
T 26,30,36
ds_write_b128 v58, a[68:71] offset:1024
W 8
ZB 144,8,64
G 47,44,66,3
ZB 148,8,68
T 28,31,32
T 30,31,36
ds_write_b128 v58, a[72:75] offset:2048
ZB 152,12,64
s_waitcnt vmcnt(23) lgkmcnt(0)
s_barrier
T 32,24,48
ZB 156,12,68
T 34,24,52
ds_write_b128 v58, a[76:79] offset:3072
s_xor_b32 m0, s65, 0x10000
s_xor_b32 s66, s62, 0x30000
ZB 160,16,64
G 44,44,66,0
ZB 164,16,68
T 36,25,48
T 38,25,52
ds_write_b128 v58, a[80:83] offset:4096
ZB 168,20,64
T 40,26,48
ZB 172,20,68
T 42,26,52
ds_write_b128 v58, a[84:87] offset:5120
ZB 176,24,64
G 45,44,66,1
ZB 180,24,68
T 44,27,48
T 46,27,52
ds_write_b128 v58, a[88:91] offset:6144
ZB 184,28,64
T 48,28,48
ZB 188,28,68
T 50,28,52
ds_write_b128 v58, a[92:95] offset:7168
W 10
MB 128,32,72
G 46,44,66,2
MB 132,32,76
T 52,29,48
T 54,29,52
MB 136,36,72
T 56,30,48
MB 140,36,76
T 58,30,52
W 8
MB 144,40,72
G 47,44,66,3
MB 148,40,76
T 60,31,48
T 62,31,52
MB 152,44,72
s_waitcnt vmcnt(23) lgkmcnt(6)
s_barrier
T 0,16,0
MB 156,44,76
T 2,16,4
R a,192,2,0
s_xor_b32 m0, s65, 0x14000
s_xor_b32 s66, s62, 0x38000
MB 160,48,72
G 44,44,66,0
MB 164,48,76
T 4,17,0
T 6,17,4
R a,196,2,1
W 10
MB 168,52,72
T 8,18,0
MB 172,52,76
T 10,18,4
R a,200,2,2
W 9
MB 176,56,72
G 45,44,66,1
MB 180,56,76
T 12,19,0
T 14,19,4
R a,204,2,3
MB 184,60,72
T 16,20,0
MB 188,60,76
T 18,20,4
R a,208,2,4
W 10
MB 128,0,80
G 46,44,66,2
MB 132,0,84
T 20,21,0
T 22,21,4
R a,212,2,5
v_mov_b32 v61, 1
v_mov_b32 v62, 0
s_mov_b64 exec, 1
buffer_store_dword v61, v62, s[52:55], s5 offen offset:0 sc1
s_mov_b64 exec, -1
MB 136,4,80
T 24,22,0
MB 140,4,84
T 26,22,4
W 14
R a,216,2,6
W 10
MB 144,8,80
G 47,44,66,3
MB 148,8,84
T 28,23,0
T 30,23,4
R a,220,2,7
MB 152,12,80
s_waitcnt vmcnt(24)
s_barrier
T 32,16,16
MB 156,12,84
T 34,16,20
s_xor_b32 m0, s65, 0x18000
s_xor_b32 s66, s62, 0x100
W 9
MB 160,16,80
G 44,44,66,0
MB 164,16,84
T 36,17,16
T 38,17,20
s_getpc_b64 s[88:89]
L_ct3_1770:
s_and_b32 s89, s89, 0xffff
s_mov_b32 s90, L_code_end-L_ct3_1770
s_mov_b32 s91, 0x20000
v_and_b32 v62, 0x70, v59
v_lshlrev_b32 v62, 3, v62
s_add_u32 s7, s1, 4096
buffer_load_dword v3, v62, s[88:91], s7 offen
MB 168,20,80
T 40,18,16
MB 172,20,84
T 42,18,20
W 7
MB 176,24,80
G 45,44,66,1
MB 180,24,84
T 44,19,16
T 46,19,20
MB 184,28,80
T 48,20,16
MB 188,28,84
T 50,20,20
W 6
MB 128,32,88
G 46,44,66,2
MB 132,32,92
T 52,21,16
T 54,21,20
MB 136,36,88
T 56,22,16
MB 140,36,92
T 58,22,20
W 6
MB 144,40,88
G 47,44,66,3
MB 148,40,92
T 60,23,16
T 62,23,20
MB 152,44,88
s_waitcnt vmcnt(25)
s_barrier
T 0,16,32
MB 156,44,92
T 2,16,36
s_xor_b32 m0, s65, 0x1c000
s_xor_b32 s66, s62, 0x8100
W 6
MB 160,48,88
G 44,44,66,0
MB 164,48,92
T 4,17,32
T 6,17,36
MB 168,52,88
T 8,18,32
MB 172,52,92
T 10,18,36
W 6
MB 176,56,88
G 45,44,66,1
MB 180,56,92
T 12,19,32
T 14,19,36
MB 184,60,88
T 16,20,32
MB 188,60,92
T 18,20,36
W 6
MB 128,0,192
G 46,44,66,2
MB 132,0,196
T 20,21,32
T 22,21,36
MB 136,4,192
T 24,22,32
MB 140,4,196
T 26,22,36
W 6
MB 144,8,192
G 47,44,66,3
MB 148,8,196
T 28,23,32
T 30,23,36
MB 152,12,192
s_waitcnt vmcnt(18)
s_barrier
T 32,16,48
MB 156,12,196
T 34,16,52
s_xor_b32 m0, s65, 0x0
s_xor_b32 s66, s62, 0x10100
W 6
MB 160,16,192
G 44,44,66,0
MB 164,16,196
T 36,17,48
T 38,17,52
MB 168,20,192
T 40,18,48
MB 172,20,196
T 42,18,52
W 6
MB 176,24,192
G 45,44,66,1
MB 180,24,196
T 44,19,48
T 46,19,52
MB 184,28,192
T 48,20,48
MB 188,28,196
T 50,20,52
W 6
MB 128,32,200
G 46,44,66,2
MB 132,32,204
T 52,21,48
T 54,21,52
MB 136,36,200
T 56,22,48
MB 140,36,204
T 58,22,52
W 6
MB 144,40,200
G 47,44,66,3
MB 148,40,204
T 60,23,48
T 62,23,52
MB 152,44,200
s_waitcnt vmcnt(18)
s_barrier
T 0,24,0
MB 156,44,204
T 2,24,4
s_xor_b32 m0, s65, 0x4000
s_xor_b32 s66, s62, 0x18100
W 6
MB 160,48,200
G 44,44,66,0
MB 164,48,204
T 4,25,0
T 6,25,4
MB 168,52,200
T 8,26,0
MB 172,52,204
T 10,26,4
W 6
MB 176,56,200
G 45,44,66,1
MB 180,56,204
T 12,27,0
T 14,27,4
MB 184,60,200
T 16,28,0
MB 188,60,204
T 18,28,4
W 6
MB 128,0,208
G 46,44,66,2
MB 132,0,212
T 20,29,0
T 22,29,4
v_mov_b32 v61, 1
v_mov_b32 v62, 0
s_mov_b64 exec, 1
buffer_store_dword v61, v62, s[52:55], s5 offen offset:128 sc1
s_mov_b64 exec, -1
MB 136,4,208
T 24,30,0
MB 140,4,212
T 26,30,4
W 6
MB 144,8,208
G 47,44,66,3
MB 148,8,212
T 28,31,0
T 30,31,4
MB 152,12,208
s_waitcnt vmcnt(18)
s_barrier
T 32,24,16
MB 156,12,212
T 34,24,20
s_xor_b32 m0, s65, 0x8000
s_xor_b32 s66, s62, 0x20100
W 6
MB 160,16,208
G 44,44,66,0
MB 164,16,212
T 36,25,16
T 38,25,20
MB 168,20,208
T 40,26,16
MB 172,20,212
T 42,26,20
W 6
MB 176,24,208
G 45,44,66,1
MB 180,24,212
T 44,27,16
T 46,27,20
MB 184,28,208
T 48,28,16
MB 188,28,212
T 50,28,20
W 6
MB 128,32,216
G 46,44,66,2
MB 132,32,220
T 52,29,16
T 54,29,20
MB 136,36,216
T 56,30,16
MB 140,36,220
T 58,30,20
W 6
MB 144,40,216
G 47,44,66,3
MB 148,40,220
T 60,31,16
T 62,31,20
MB 152,44,216
s_waitcnt vmcnt(17)
s_barrier
T 0,24,32
MB 156,44,220
T 2,24,36
s_xor_b32 m0, s65, 0xc000
s_xor_b32 s66, s62, 0x28100
W 6
MB 160,48,216
G 44,44,66,0
MB 164,48,220
T 4,25,32
T 6,25,36
MB 168,52,216
T 8,26,32
MB 172,52,220
T 10,26,36
W 6
MB 176,56,216
G 45,44,66,1
MB 180,56,220
T 12,27,32
T 14,27,36
MB 184,60,216
T 16,28,32
MB 188,60,220
T 18,28,36
W 6
ZB 192,0,64
G 46,44,66,2
ZB 196,0,68
T 20,29,32
T 22,29,36
ZB 200,4,64
T 24,30,32
ZB 204,4,68
T 26,30,36
W 6
ZB 208,8,64
G 47,44,66,3
ZB 212,8,68
T 28,31,32
T 30,31,36
ZB 216,12,64
s_waitcnt vmcnt(17)
s_barrier
T 32,24,48
ZB 220,12,68
T 34,24,52
s_xor_b32 m0, s65, 0x10000
s_xor_b32 s66, s62, 0x30100
W 6
ZB 224,16,64
G 44,44,66,0
ZB 228,16,68
T 36,25,48
T 38,25,52
ZB 232,20,64
T 40,26,48
ZB 236,20,68
T 42,26,52
W 6
ZB 240,24,64
G 45,44,66,1
ZB 244,24,68
T 44,27,48
T 46,27,52
ZB 248,28,64
T 48,28,48
ZB 252,28,68
T 50,28,52
W 6
MB 192,32,72
G 46,44,66,2
MB 196,32,76
T 52,29,48
T 54,29,52
MB 200,36,72
T 56,30,48
MB 204,36,76
T 58,30,52
W 6
MB 208,40,72
G 47,44,66,3
MB 212,40,76
T 60,31,48
T 62,31,52
MB 216,44,72
s_waitcnt vmcnt(17)
s_barrier
T 0,16,0
MB 220,44,76
T 2,16,4
s_xor_b32 m0, s65, 0x14000
s_xor_b32 s66, s62, 0x38100
W 6
MB 224,48,72
G 44,44,66,0
MB 228,48,76
T 4,17,0
T 6,17,4
MB 232,52,72
T 8,18,0
MB 236,52,76
T 10,18,4
W 6
MB 240,56,72
G 45,44,66,1
MB 244,56,76
T 12,19,0
T 14,19,4
MB 248,60,72
T 16,20,0
MB 252,60,76
T 18,20,4
W 6
MB 192,0,80
G 46,44,66,2
MB 196,0,84
T 20,21,0
T 22,21,4
MB 200,4,80
T 24,22,0
MB 204,4,84
T 26,22,4
W 6
MB 208,8,80
G 47,44,66,3
MB 212,8,84
T 28,23,0
T 30,23,4
MB 216,12,80
s_waitcnt vmcnt(16)
s_barrier
T 32,16,16
MB 220,12,84
T 34,16,20
s_xor_b32 m0, s65, 0x18000
s_xor_b32 s66, s63, 0x55000
W 6
MB 224,16,80
G 32,32,66,0,nt
MB 228,16,84
T 36,17,16
T 38,17,20
MB 232,20,80
T 40,18,16
MB 236,20,84
T 42,18,20
W 6
MB 240,24,80
G 33,32,66,1,nt
MB 244,24,84
T 44,19,16
T 46,19,20
MB 248,28,80
T 48,20,16
MB 252,28,84
T 50,20,20
W 6
MB 192,32,88
G 34,32,66,2,nt
MB 196,32,92
T 52,21,16
T 54,21,20
MB 200,36,88
T 56,22,16
MB 204,36,92
T 58,22,20
W 6
MB 208,40,88
G 35,32,66,3,nt
MB 212,40,92
T 60,23,16
T 62,23,20
MB 216,44,88
s_waitcnt vmcnt(16)
s_barrier
T 0,16,32
MB 220,44,92
T 2,16,36
s_xor_b32 m0, s65, 0x1c000
s_xor_b32 s66, s63, 0x42000
W 6
MB 224,48,88
G 32,32,66,0,nt
MB 228,48,92
T 4,17,32
T 6,17,36
MB 232,52,88
T 8,18,32
MB 236,52,92
T 10,18,36
W 6
MB 240,56,88
G 33,32,66,1,nt
MB 244,56,92
T 12,19,32
T 14,19,36
MB 248,60,88
T 16,20,32
MB 252,60,92
T 18,20,36
W 6
MB 192,0,192
G 34,32,66,2,nt
MB 196,0,196
T 20,21,32
T 22,21,36
MB 200,4,192
T 24,22,32
MB 204,4,196
T 26,22,36
W 6
MB 208,8,192
G 35,32,66,3,nt
MB 212,8,196
T 28,23,32
T 30,23,36
MB 216,12,192
s_waitcnt vmcnt(16)
s_barrier
T 32,16,48
MB 220,12,196
T 34,16,52
s_xor_b32 m0, s65, 0x0
s_xor_b32 s66, s63, 0x55000
W 6
MB 224,16,192
G 56,36,66,0,nt
MB 228,16,196
T 36,17,48
T 38,17,52
MB 232,20,192
T 40,18,48
MB 236,20,196
T 42,18,52
W 6
MB 240,24,192
G 57,36,66,1,nt
MB 244,24,196
T 44,19,48
T 46,19,52
MB 248,28,192
T 48,20,48
MB 252,28,196
T 50,20,52
W 6
MB 192,32,200
G 56,36,66,2,nt
MB 196,32,204
T 52,21,48
T 54,21,52
MB 200,36,200
T 56,22,48
MB 204,36,204
T 58,22,52
W 6
MB 208,40,200
G 57,36,66,3,nt
MB 212,40,204
T 60,23,48
T 62,23,52
MB 216,44,200
s_waitcnt vmcnt(16)
s_barrier
T 0,24,0
MB 220,44,204
T 2,24,4
s_xor_b32 m0, s65, 0x4000
s_xor_b32 s66, s63, 0x52000
W 6
MB 224,48,200
G 32,32,66,0,nt
MB 228,48,204
T 4,25,0
T 6,25,4
MB 232,52,200
T 8,26,0
MB 236,52,204
T 10,26,4
W 6
MB 240,56,200
G 33,32,66,1,nt
MB 244,56,204
T 12,27,0
T 14,27,4
MB 248,60,200
T 16,28,0
MB 252,60,204
T 18,28,4
W 6
MB 192,0,208
G 34,32,66,2,nt
MB 196,0,212
T 20,29,0
T 22,29,4
MB 200,4,208
T 24,30,0
MB 204,4,212
T 26,30,4
W 6
MB 208,8,208
G 35,32,66,3,nt
MB 212,8,212
T 28,31,0
T 30,31,4
MB 216,12,208
s_waitcnt vmcnt(16)
s_barrier
MB 220,12,212
T 32,24,16
T 34,24,20
W 6
MB 224,16,208
T 36,25,16
MB 228,16,212
T 38,25,20
MB 232,20,208
T 40,26,16
MB 236,20,212
T 42,26,20
W 6
MB 240,24,208
T 44,27,16
MB 244,24,212
T 46,27,20
MB 248,28,208
T 48,28,16
MB 252,28,212
T 50,28,20
W 6
MB 192,32,216
T 52,29,16
MB 196,32,220
T 54,29,20
MB 200,36,216
T 56,30,16
MB 204,36,220
T 58,30,20
W 6
MB 208,40,216
T 60,31,16
MB 212,40,220
T 62,31,20
MB 216,44,216
s_waitcnt vmcnt(12)
s_barrier
MB 220,44,220
R a,0,12,32
s_xor_b32 m0, s65, 0x8000
s_xor_b32 s66, s63, 0x42000
W 5
MB 224,48,216
G 56,36,66,0,nt
MB 228,48,220
R a,4,13,32
MB 232,52,216
R a,8,14,32
MB 236,52,220
W 3
MB 240,56,216
G 57,36,66,1,nt
MB 244,56,220
R a,12,15,32
MB 248,60,216
R a,16,12,36
MB 252,60,220
W 3
ZB 80,0,160
G 56,36,66,2,nt
ZB 84,0,164
R a,20,13,36
MB 80,4,168
R a,24,14,36
MB 84,4,172
W 3
MB 80,8,176
G 57,36,66,3,nt
MB 84,8,180
R a,28,15,36
MB 80,12,184
MB 84,12,188
W 2
ZB 88,16,160
ZB 92,16,164
MB 88,20,168
MB 92,20,172
W 0
MB 88,24,176
E 80
MB 92,24,180
MB 88,28,184
E 81
MB 92,28,188
CV 104,80
E 82
E 83
s_nop 0
CV 105,82
E 84
s_waitcnt vmcnt(12)
s_barrier
R a,0,12,48
E 85
s_xor_b32 m0, s65, 0xc000
s_xor_b32 s66, s63, 0x46000
R a,4,13,48
G 32,32,66,0,nt
CV 108,84
E 86
R a,8,14,48
E 87
R a,12,15,48
G 33,32,66,1,nt
CV 109,86
E 88
R a,16,12,52
E 89
W 3
ZB 64,0,160
G 34,32,66,2,nt
R a,20,13,52
ZB 68,0,164
CV 106,88
E 90
MB 64,4,168
R a,24,14,52
MB 68,4,172
E 91
W 3
MB 64,8,176
G 35,32,66,3,nt
R a,28,15,52
MB 68,8,180
CV 107,90
E 92
MB 64,12,184
s_waitcnt vmcnt(12)
s_barrier
T 32,16,0
T 34,16,4
MB 68,12,188
E 93
s_xor_b32 m0, s65, 0x10000
s_xor_b32 s66, s63, 0x52000
W 4
ZB 72,16,160
G 56,36,66,0,nt
T 36,17,0
ZB 76,16,164
T 38,17,4
CV 110,92
E 94
s_getpc_b64 s[88:89]
L_ct3_1898:
s_and_b32 s89, s89, 0xffff
s_mov_b32 s90, L_code_end-L_ct3_1898
s_mov_b32 s91, 0x20000
v_and_b32 v62, 0x70, v59
v_lshlrev_b32 v62, 3, v62
s_add_u32 s7, s1, 4096
buffer_load_dword v3, v62, s[88:91], s7 offen
MB 72,20,168
T 40,18,0
T 42,18,4
MB 76,20,172
E 95
W 6
MB 72,24,176
G 57,36,66,1,nt
T 44,19,0
MB 76,24,180
T 46,19,4
CV 111,94
E 64
MB 72,28,184
T 48,20,0
T 50,20,4
MB 76,28,188
E 65
W 6
MC 128,32,104
G 56,36,66,2,nt
T 52,21,0
MC 132,32,108
T 54,21,4
CV 96,64
E 66
MC 136,36,104
T 56,22,0
T 58,22,4
MC 140,36,108
E 67
W 6
MC 144,40,104
G 57,36,66,3,nt
T 60,23,0
MC 148,40,108
T 62,23,4
CV 97,66
E 68
MC 152,44,104
E 69
MC 156,44,108
W 4
MC 96,48,104
s_waitcnt vmcnt(13)
s_barrier
R a,0,8,16
CV 100,68
MC 100,48,108
E 70
s_xor_b32 m0, s65, 0x14000
s_xor_b32 s66, s63, 0x56000
MC 104,52,104
G 32,32,66,0,nt
MC 108,52,108
R a,4,9,16
E 71
W 2
MC 112,56,104
R a,8,10,16
CV 101,70
MC 116,56,108
E 72
MC 120,60,104
G 33,32,66,1,nt
MC 124,60,108
R a,12,11,16
E 73
ZD 112,52,104
R a,16,8,20
CV 98,72
ZD 116,52,108
E 74
W 3
ZB 80,0,160
G 34,32,66,2,nt
ZB 84,0,164
R a,20,9,20
E 75
MB 80,4,168
R a,24,10,20
CV 99,74
MB 84,4,172
E 76
W 3
MB 80,8,176
G 35,32,66,3,nt
MB 84,8,180
R a,28,11,20
E 77
MB 80,12,184
s_waitcnt vmcnt(13)
s_barrier
T 32,16,32
T 34,16,36
MB 84,12,188
CV 102,76
E 78
s_xor_b32 m0, s65, 0x18000
s_xor_b32 s66, s63, 0x46000
W 4
ZB 88,16,160
G 56,36,66,0,nt
T 36,17,32
ZB 92,16,164
T 38,17,36
E 79
MB 88,20,168
T 40,18,32
MB 92,20,172
T 42,18,36
CV 103,78
W 6
MB 88,24,176
G 57,36,66,1,nt
T 44,19,32
MB 92,24,180
T 46,19,36
E 80
MB 88,28,184
T 48,20,32
T 50,20,36
MB 92,28,188
E 81
W 6
MC 128,32,96
G 56,36,66,2,nt
T 52,21,32
MC 132,32,100
T 54,21,36
CV 104,80
E 82
MC 136,36,96
T 56,22,32
T 58,22,36
MC 140,36,100
E 83
W 6
MC 144,40,96
G 57,36,66,3,nt
T 60,23,32
MC 148,40,100
T 62,23,36
CV 105,82
E 84
MC 152,44,96
E 85
MC 156,44,100
W 4
MC 96,48,96
s_waitcnt vmcnt(13)
s_barrier
R a,0,8,48
CV 108,84
MC 100,48,100
E 86
s_xor_b32 m0, s65, 0x1c000
s_xor_b32 s66, s63, 0x43000
MC 104,52,96
G 32,32,66,0,nt
MC 108,52,100
R a,4,9,48
E 87
W 2
MC 112,56,96
R a,8,10,48
CV 109,86
MC 116,56,100
E 88
MC 120,60,96
G 33,32,66,1,nt
MC 124,60,100
R a,12,11,48
E 89
MD 112,52,96
R a,16,8,52
CV 106,88
MD 116,52,100
E 90
W 3
ZB 64,0,160
G 34,32,66,2,nt
ZB 68,0,164
R a,20,9,52
E 91
MB 64,4,168
R a,24,10,52
CV 107,90
MB 68,4,172
E 92
W 3
MB 64,8,176
G 35,32,66,3,nt
MB 68,8,180
R a,28,11,52
E 93
MB 64,12,184
s_waitcnt vmcnt(12)
s_barrier
T 32,24,0
T 34,24,4
MB 68,12,188
CV 110,92
E 94
s_xor_b32 m0, s65, 0x0
s_xor_b32 s66, s63, 0x56000
W 4
ZB 72,16,160
G 56,36,66,0,nt
T 36,25,0
ZB 76,16,164
T 38,25,4
E 95
MB 72,20,168
T 40,26,0
MB 76,20,172
T 42,26,4
CV 111,94
W 6
MB 72,24,176
G 57,36,66,1,nt
T 44,27,0
MB 76,24,180
T 46,27,4
E 64
MB 72,28,184
T 48,28,0
T 50,28,4
MB 76,28,188
E 65
W 6
MC 128,32,104
G 56,36,66,2,nt
T 52,29,0
MC 132,32,108
T 54,29,4
CV 96,64
E 66
MC 136,36,104
T 56,30,0
T 58,30,4
MC 140,36,108
E 67
W 6
MC 144,40,104
G 57,36,66,3,nt
T 60,31,0
MC 148,40,108
T 62,31,4
CV 97,66
E 68
MC 152,44,104
E 69
MC 156,44,108
W 4
MC 96,48,104
s_waitcnt vmcnt(12)
s_barrier
R a,0,12,16
CV 100,68
MC 100,48,108
E 70
s_xor_b32 m0, s65, 0x4000
s_xor_b32 s66, s63, 0x53000
MC 104,52,104
G 32,32,66,0,nt
MC 108,52,108
R a,4,13,16
E 71
W 2
MC 112,56,104
R a,8,14,16
CV 101,70
MC 116,56,108
E 72
MC 120,60,104
G 33,32,66,1,nt
MC 124,60,108
R a,12,15,16
E 73
MD 112,52,104
R a,16,12,20
CV 98,72
MD 116,52,108
E 74
W 3
ZB 80,0,160
G 34,32,66,2,nt
ZB 84,0,164
R a,20,13,20
E 75
MB 80,4,168
R a,24,14,20
CV 99,74
MB 84,4,172
E 76
W 3
MB 80,8,176
G 35,32,66,3,nt
MB 84,8,180
R a,28,15,20
E 77
MB 80,12,184
s_waitcnt vmcnt(12)
s_barrier
T 32,24,32
T 34,24,36
MB 84,12,188
CV 102,76
E 78
s_xor_b32 m0, s65, 0x8000
s_xor_b32 s66, s63, 0x43000
W 4
ZB 88,16,160
G 56,36,66,0,nt
T 36,25,32
ZB 92,16,164
T 38,25,36
E 79
MB 88,20,168
T 40,26,32
MB 92,20,172
T 42,26,36
CV 103,78
W 6
MB 88,24,176
G 57,36,66,1,nt
T 44,27,32
MB 92,24,180
T 46,27,36
E 80
MB 88,28,184
T 48,28,32
T 50,28,36
MB 92,28,188
E 81
W 6
MC 128,32,96
G 56,36,66,2,nt
T 52,29,32
MC 132,32,100
T 54,29,36
CV 104,80
E 82
MC 136,36,96
T 56,30,32
T 58,30,36
MC 140,36,100
E 83
W 6
MC 144,40,96
G 57,36,66,3,nt
T 60,31,32
MC 148,40,100
T 62,31,36
CV 105,82
E 84
MC 152,44,96
E 85
MC 156,44,100
W 4
MC 96,48,96
s_waitcnt vmcnt(12)
s_barrier
R a,0,12,48
CV 108,84
MC 100,48,100
E 86
s_xor_b32 m0, s65, 0xc000
s_xor_b32 s66, s63, 0x47000
MC 104,52,96
G 32,32,66,0,nt
MC 108,52,100
R a,4,13,48
E 87
W 2
MC 112,56,96
R a,8,14,48
CV 109,86
MC 116,56,100
E 88
MC 120,60,96
G 33,32,66,1,nt
MC 124,60,100
R a,12,15,48
E 89
MD 112,52,96
R a,16,12,52
CV 106,88
MD 116,52,100
E 90
W 3
ZB 64,0,160
G 34,32,66,2,nt
ZB 68,0,164
R a,20,13,52
E 91
MB 64,4,168
R a,24,14,52
CV 107,90
MB 68,4,172
E 92
W 3
MB 64,8,176
G 35,32,66,3,nt
MB 68,8,180
R a,28,15,52
E 93
MB 64,12,184
s_waitcnt vmcnt(12)
s_barrier
T 32,16,0
T 34,16,4
MB 68,12,188
CV 110,92
E 94
s_xor_b32 m0, s65, 0x10000
s_xor_b32 s66, s63, 0x53000
W 4
ZB 72,16,160
G 56,36,66,0,nt
T 36,17,0
ZB 76,16,164
T 38,17,4
E 95
MB 72,20,168
T 40,18,0
MB 76,20,172
T 42,18,4
CV 111,94
W 6
MB 72,24,176
G 57,36,66,1,nt
T 44,19,0
MB 76,24,180
T 46,19,4
E 64
MB 72,28,184
T 48,20,0
T 50,20,4
MB 76,28,188
E 65
W 6
MC 128,32,104
G 56,36,66,2,nt
T 52,21,0
MC 132,32,108
T 54,21,4
CV 96,64
E 66
MC 136,36,104
T 56,22,0
T 58,22,4
MC 140,36,108
E 67
W 6
MC 144,40,104
G 57,36,66,3,nt
T 60,23,0
MC 148,40,108
T 62,23,4
CV 97,66
E 68
MC 152,44,104
E 69
MC 156,44,108
W 4
MC 96,48,104
s_waitcnt vmcnt(12)
s_barrier
R a,0,8,16
CV 100,68
MC 100,48,108
E 70
s_xor_b32 m0, s65, 0x14000
s_xor_b32 s66, s63, 0x57000
MC 104,52,104
G 32,32,66,0,nt
MC 108,52,108
R a,4,9,16
E 71
W 2
MC 112,56,104
R a,8,10,16
CV 101,70
MC 116,56,108
E 72
MC 120,60,104
G 33,32,66,1,nt
MC 124,60,108
R a,12,11,16
E 73
MD 112,52,104
R a,16,8,20
CV 98,72
MD 116,52,108
E 74
W 3
ZB 80,0,160
G 34,32,66,2,nt
ZB 84,0,164
R a,20,9,20
E 75
MB 80,4,168
R a,24,10,20
CV 99,74
MB 84,4,172
E 76
W 3
MB 80,8,176
G 35,32,66,3,nt
MB 84,8,180
R a,28,11,20
E 77
MB 80,12,184
s_waitcnt vmcnt(12)
s_barrier
T 32,16,32
T 34,16,36
MB 84,12,188
CV 102,76
E 78
s_xor_b32 m0, s65, 0x18000
s_xor_b32 s66, s63, 0x47000
W 4
ZB 88,16,160
G 56,36,66,0,nt
T 36,17,32
ZB 92,16,164
T 38,17,36
E 79
MB 88,20,168
T 40,18,32
MB 92,20,172
T 42,18,36
CV 103,78
W 6
MB 88,24,176
G 57,36,66,1,nt
T 44,19,32
MB 92,24,180
T 46,19,36
E 80
MB 88,28,184
T 48,20,32
T 50,20,36
MB 92,28,188
E 81
W 6
MC 128,32,96
G 56,36,66,2,nt
T 52,21,32
MC 132,32,100
T 54,21,36
CV 104,80
E 82
MC 136,36,96
T 56,22,32
T 58,22,36
MC 140,36,100
E 83
W 6
MC 144,40,96
G 57,36,66,3,nt
T 60,23,32
MC 148,40,100
T 62,23,36
CV 105,82
E 84
MC 152,44,96
E 85
MC 156,44,100
W 4
MC 96,48,96
s_waitcnt vmcnt(12)
s_barrier
R a,0,8,48
CV 108,84
MC 100,48,100
E 86
s_xor_b32 m0, s65, 0x1c000
s_xor_b32 s66, s63, 0x57000
MC 104,52,96
G 56,36,66,0,nt
MC 108,52,100
R a,4,9,48
E 87
W 2
MC 112,56,96
R a,8,10,48
CV 109,86
MC 116,56,100
E 88
MC 120,60,96
G 57,36,66,1,nt
MC 124,60,100
R a,12,11,48
E 89
MD 112,52,96
R a,16,8,52
CV 106,88
MD 116,52,100
E 90
W 3
ZB 64,0,160
G 56,36,66,2,nt
ZB 68,0,164
R a,20,9,52
E 91
MB 64,4,168
R a,24,10,52
CV 107,90
MB 68,4,172
E 92
W 3
MB 64,8,176
G 57,36,66,3,nt
MB 68,8,180
R a,28,11,52
E 93
MB 64,12,184
s_waitcnt vmcnt(12)
s_barrier
T 32,24,0
T 34,24,4
MB 68,12,188
CV 110,92
E 94
s_xor_b32 m0, s65, 0x0
s_xor_b32 s66, s62, 0x40000
W 4
ZB 72,16,160
G 44,44,66,0
T 36,25,0
ZB 76,16,164
T 38,25,4
E 95
MB 72,20,168
T 40,26,0
MB 76,20,172
T 42,26,4
CV 111,94
W 6
MB 72,24,176
G 45,44,66,1
T 44,27,0
MB 76,24,180
T 46,27,4
E 64
MB 72,28,184
T 48,28,0
T 50,28,4
MB 76,28,188
E 65
W 6
MC 128,32,104
G 46,44,66,2
T 52,29,0
MC 132,32,108
T 54,29,4
CV 96,64
E 66
MC 136,36,104
T 56,30,0
T 58,30,4
MC 140,36,108
E 67
W 6
MC 144,40,104
G 47,44,66,3
T 60,31,0
MC 148,40,108
T 62,31,4
CV 97,66
E 68
MC 152,44,104
E 69
MC 156,44,108
v_mov_b32 v62, 0
buffer_load_dword v4, v62, s[96:99], s87 offen sc1
W 4
MC 96,48,104
s_waitcnt vmcnt(13)
s_barrier
R a,0,12,16
CV 100,68
MC 100,48,108
E 70
s_xor_b32 m0, s65, 0x4000
s_xor_b32 s66, s62, 0x48000
MC 104,52,104
G 44,44,66,0
MC 108,52,108
R a,4,13,16
E 71
W 2
MC 112,56,104
R a,8,14,16
CV 101,70
MC 116,56,108
E 72
MC 120,60,104
G 45,44,66,1
MC 124,60,108
R a,12,15,16
E 73
MD 112,52,104
R a,16,12,20
CV 98,72
MD 116,52,108
E 74
W 3
ZB 80,0,160
G 46,44,66,2
ZB 84,0,164
R a,20,13,20
E 75
MB 80,4,168
R a,24,14,20
CV 99,74
MB 84,4,172
E 76
W 3
MB 80,8,176
G 47,44,66,3
MB 84,8,180
R a,28,15,20
E 77
MB 80,12,184
s_waitcnt vmcnt(13)
s_barrier
T 32,24,32
T 34,24,36
MB 84,12,188
CV 102,76
E 78
s_xor_b32 m0, s65, 0x8000
s_xor_b32 s66, s62, 0x50000
W 4
ZB 88,16,160
G 44,44,66,0
T 36,25,32
ZB 92,16,164
T 38,25,36
E 79
MB 88,20,168
T 40,26,32
MB 92,20,172
T 42,26,36
CV 103,78
W 6
MB 88,24,176
G 45,44,66,1
T 44,27,32
MB 92,24,180
T 46,27,36
E 80
MB 88,28,184
T 48,28,32
T 50,28,36
MB 92,28,188
E 81
W 6
MC 128,32,96
G 46,44,66,2
T 52,29,32
MC 132,32,100
T 54,29,36
CV 104,80
E 82
MC 136,36,96
T 56,30,32
T 58,30,36
MC 140,36,100
E 83
W 6
MC 144,40,96
G 47,44,66,3
T 60,31,32
MC 148,40,100
T 62,31,36
CV 105,82
E 84
MC 152,44,96
E 85
MC 156,44,100
W 4
MC 96,48,96
CV 108,84
MC 100,48,100
E 86
MC 104,52,96
E 87
MC 108,52,100
W 0
MC 112,56,96
CV 109,86
MC 116,56,100
E 88
MC 120,60,96
E 89
MC 124,60,100
MD 112,52,96
CV 106,88
MD 116,52,100
E 90
E 91
s_nop 0
CV 107,90
E 92
E 93
s_waitcnt vmcnt(13)
s_barrier
T 32,24,48
T 34,24,52
CV 110,92
E 94
s_xor_b32 m0, s65, 0xc000
s_xor_b32 s66, s62, 0x58000
T 36,25,48
T 38,25,52
G 44,44,66,0
E 95
T 40,26,48
T 42,26,52
CV 111,94
T 44,27,48
T 46,27,52
G 45,44,66,1
T 48,28,48
T 50,28,52
W 6
MC 128,32,104
G 46,44,66,2
MC 132,32,108
T 52,29,48
T 54,29,52
MC 136,36,104
T 56,30,48
MC 140,36,108
T 58,30,52
W 6
MC 144,40,104
G 47,44,66,3
MC 148,40,108
T 60,31,48
T 62,31,52
MC 152,44,104
MC 156,44,108
W 4
MC 96,48,104
s_waitcnt vmcnt(13)
s_barrier
s_xor_b32 m0, s65, 0x10000
s_xor_b32 s66, s62, 0x60000
MC 100,48,108
G 44,44,66,0
T 0,16,0
T 2,16,4
MC 104,52,104
G 45,44,66,1
MC 108,52,108
T 4,17,0
T 6,17,4
W 4
MC 112,56,104
G 46,44,66,2
MC 116,56,108
T 8,18,0
T 10,18,4
MC 120,60,104
G 47,44,66,3
MC 124,60,108
T 12,19,0
T 14,19,4
MD 112,52,104
s_xor_b32 m0, s65, 0x14000
s_xor_b32 s66, s62, 0x68000
MD 116,52,108
G 44,44,66,0
T 16,20,0
T 18,20,4
s_nop 1
v_add_f32 v60, v112, v6
s_nop 1
v_add_f32 v61, v116, v7
v_cmp_nle_f32 vcc, s76, v60
v_cmp_nge_f32 s[82:83], s77, v60
v_cmp_nle_f32 s[84:85], s76, v61
v_cmp_nge_f32 s[90:91], s77, v61
s_nop 1
s_or_b64 vcc, vcc, s[82:83]
s_or_b64 vcc, vcc, s[84:85]
s_or_b64 vcc, vcc, s[90:91]
s_cbranch_scc1 L_slow_c3B1
L_back_c3B1:
v_rcp_f32 v0, v60
v_rcp_f32 v1, v61
AR 112,128
AR 113,129
AR 114,130
AR 115,131
AR 116,132
AR 117,133
AR 118,134
AR 119,135
AR 120,136
AR 121,137
AR 122,138
AR 123,139
AR 124,140
AR 125,141
AR 126,142
AR 127,143
v_pk_mul_f32 v[112:113], v[112:113], v[0:1] op_sel_hi:[1,0]
v_pk_mul_f32 v[114:115], v[114:115], v[0:1] op_sel_hi:[1,0]
v_pk_mul_f32 v[116:117], v[116:117], v[0:1] op_sel:[0,1]
v_pk_mul_f32 v[118:119], v[118:119], v[0:1] op_sel:[0,1]
v_pk_mul_f32 v[120:121], v[120:121], v[0:1] op_sel_hi:[1,0]
v_pk_mul_f32 v[122:123], v[122:123], v[0:1] op_sel_hi:[1,0]
v_pk_mul_f32 v[124:125], v[124:125], v[0:1] op_sel:[0,1]
v_pk_mul_f32 v[126:127], v[126:127], v[0:1] op_sel:[0,1]
CV 112,112
CV 114,114
CV 116,116
CV 118,118
CV 120,120
CV 122,122
CV 124,124
CV 126,126
AW 160,112
AW 161,114
AW 164,116
AW 165,118
AW 162,120
AW 163,122
AW 166,124
AW 167,126
AR 112,144
AR 113,145
AR 114,146
AR 115,147
AR 116,148
AR 117,149
AR 118,150
AR 119,151
AR 120,152
AR 121,153
AR 122,154
AR 123,155
AR 124,156
AR 125,157
AR 126,158
AR 127,159
v_pk_mul_f32 v[112:113], v[112:113], v[0:1] op_sel_hi:[1,0]
v_pk_mul_f32 v[114:115], v[114:115], v[0:1] op_sel_hi:[1,0]
v_pk_mul_f32 v[116:117], v[116:117], v[0:1] op_sel:[0,1]
v_pk_mul_f32 v[118:119], v[118:119], v[0:1] op_sel:[0,1]
v_pk_mul_f32 v[120:121], v[120:121], v[0:1] op_sel_hi:[1,0]
v_pk_mul_f32 v[122:123], v[122:123], v[0:1] op_sel_hi:[1,0]
v_pk_mul_f32 v[124:125], v[124:125], v[0:1] op_sel:[0,1]
v_pk_mul_f32 v[126:127], v[126:127], v[0:1] op_sel:[0,1]
CV 112,112
CV 114,114
CV 116,116
CV 118,118
CV 120,120
CV 122,122
CV 124,124
CV 126,126
AW 168,112
AW 169,114
AW 172,116
AW 173,118
AW 170,120
AW 171,122
AW 174,124
AW 175,126
AR 112,96
AR 113,97
AR 114,98
AR 115,99
AR 116,100
AR 117,101
AR 118,102
AR 119,103
AR 120,104
AR 121,105
AR 122,106
AR 123,107
AR 124,108
AR 125,109
AR 126,110
AR 127,111
v_pk_mul_f32 v[112:113], v[112:113], v[0:1] op_sel_hi:[1,0]
v_pk_mul_f32 v[114:115], v[114:115], v[0:1] op_sel_hi:[1,0]
v_pk_mul_f32 v[116:117], v[116:117], v[0:1] op_sel:[0,1]
v_pk_mul_f32 v[118:119], v[118:119], v[0:1] op_sel:[0,1]
v_pk_mul_f32 v[120:121], v[120:121], v[0:1] op_sel_hi:[1,0]
v_pk_mul_f32 v[122:123], v[122:123], v[0:1] op_sel_hi:[1,0]
v_pk_mul_f32 v[124:125], v[124:125], v[0:1] op_sel:[0,1]
v_pk_mul_f32 v[126:127], v[126:127], v[0:1] op_sel:[0,1]
CV 112,112
CV 114,114
CV 116,116
CV 118,118
CV 120,120
CV 122,122
CV 124,124
CV 126,126
AW 176,112
AW 177,114
AW 180,116
AW 181,118
AW 178,120
AW 179,122
AW 182,124
AW 183,126
AR 112,112
AR 113,113
AR 114,114
AR 115,115
AR 116,116
AR 117,117
AR 118,118
AR 119,119
AR 120,120
AR 121,121
AR 122,122
AR 123,123
AR 124,124
AR 125,125
AR 126,126
AR 127,127
v_pk_mul_f32 v[112:113], v[112:113], v[0:1] op_sel_hi:[1,0]
v_pk_mul_f32 v[114:115], v[114:115], v[0:1] op_sel_hi:[1,0]
v_pk_mul_f32 v[116:117], v[116:117], v[0:1] op_sel:[0,1]
v_pk_mul_f32 v[118:119], v[118:119], v[0:1] op_sel:[0,1]
v_pk_mul_f32 v[120:121], v[120:121], v[0:1] op_sel_hi:[1,0]
v_pk_mul_f32 v[122:123], v[122:123], v[0:1] op_sel_hi:[1,0]
v_pk_mul_f32 v[124:125], v[124:125], v[0:1] op_sel:[0,1]
v_pk_mul_f32 v[126:127], v[126:127], v[0:1] op_sel:[0,1]
CV 112,112
CV 114,114
CV 116,116
CV 118,118
CV 120,120
CV 122,122
CV 124,124
CV 126,126
AW 184,112
AW 185,114
AW 188,116
AW 189,118
AW 186,120
AW 187,122
AW 190,124
AW 191,126
W 6
MB 128,0,160
G 45,44,66,1
MB 132,0,164
T 20,21,0
T 22,21,4
ds_write_b128 v58, a[160:163] offset:0
s_and_b32 s7, s2, 7
v_bfe_u32 v7, v59, 4, 3
v_max_u32 v7, 1, v7
v_xor_b32 v7, s7, v7
v_lshlrev_b32 v7, 2, v7
MB 136,4,160
G 46,44,66,2
MB 140,4,164
T 24,22,0
T 26,22,4
ds_write_b128 v58, a[164:167] offset:1024
W 8
MB 144,8,160
G 47,44,66,3
MB 148,8,164
T 28,23,0
T 30,23,4
ds_write_b128 v58, a[168:171] offset:2048
v_and_b32 v6, 0xf0, v59
v_lshlrev_b32 v6, 7, v6
v_lshrrev_b32 v62, 8, v59
v_lshl_add_u32 v6, v62, 4, v6
MB 152,12,160
s_waitcnt vmcnt(16) lgkmcnt(0)
s_barrier
T 32,16,16
MB 156,12,164
T 34,16,20
ds_write_b128 v58, a[172:175] offset:3072
s_xor_b32 m0, s65, 0x18000
s_xor_b32 s66, s62, 0x70000
MB 160,16,160
G 44,44,66,0
MB 164,16,164
T 36,17,16
T 38,17,20
ds_write_b128 v58, a[176:179] offset:4096
MB 168,20,160
T 40,18,16
MB 172,20,164
T 42,18,20
ds_write_b128 v58, a[180:183] offset:5120
MB 176,24,160
G 45,44,66,1
MB 180,24,164
T 44,19,16
T 46,19,20
ds_write_b128 v58, a[184:187] offset:6144
MB 184,28,160
T 48,20,16
MB 188,28,164
T 50,20,20
ds_write_b128 v58, a[188:191] offset:7168
W 10
MB 128,32,168
G 46,44,66,2
MB 132,32,172
T 52,21,16
T 54,21,20
L_ci_c3:
v_cmp_gt_u32 vcc, 8, v4
s_nop 3
s_or_b64 vcc, vcc, vcc
s_cbranch_scc1 L_wi_c3
L_gi_c3:
MB 136,36,168
T 56,22,16
MB 140,36,172
T 58,22,20
W 8
MB 144,40,168
G 47,44,66,3
MB 148,40,172
T 60,23,16
T 62,23,20
MB 152,44,168
s_waitcnt vmcnt(16) lgkmcnt(6)
s_barrier
T 0,16,32
MB 156,44,172
T 2,16,36
R a,224,2,0
s_xor_b32 m0, s65, 0x1c000
s_xor_b32 s66, s62, 0x78000
MB 160,48,168
G 44,44,66,0
MB 164,48,172
T 4,17,32
T 6,17,36
R a,228,2,1
W 10
MB 168,52,168
T 8,18,32
MB 172,52,172
T 10,18,36
R a,232,2,2
W 9
MB 176,56,168
G 45,44,66,1
MB 180,56,172
T 12,19,32
T 14,19,36
R a,236,2,3
MB 184,60,168
T 16,20,32
MB 188,60,172
T 18,20,36
R a,240,2,4
W 10
MB 128,0,176
G 46,44,66,2
MB 132,0,180
T 20,21,32
T 22,21,36
R a,244,2,5
MB 136,4,176
T 24,22,32
MB 140,4,180
T 26,22,36
W 14
R a,248,2,6
W 10
MB 144,8,176
G 47,44,66,3
MB 148,8,180
T 28,23,32
T 30,23,36
R a,252,2,7
MB 152,12,176
s_waitcnt vmcnt(16)
s_barrier
T 32,16,48
MB 156,12,180
T 34,16,52
s_xor_b32 m0, s65, 0x0
s_xor_b32 s66, s62, 0x40100
W 9
MB 160,16,176
G 44,44,66,0
MB 164,16,180
T 36,17,48
T 38,17,52
MB 168,20,176
T 40,18,48
MB 172,20,180
T 42,18,52
W 7
MB 176,24,176
G 45,44,66,1
MB 180,24,180
T 44,19,48
T 46,19,52
MB 184,28,176
T 48,20,48
MB 188,28,180
T 50,20,52
W 6
MB 128,32,184
G 46,44,66,2
MB 132,32,188
T 52,21,48
T 54,21,52
buffer_load_dword v3, v7, s[52:55], s72 offen offset:0 sc1
buffer_load_dword v4, v7, s[52:55], s72 offen offset:128 sc1
MB 136,36,184
T 56,22,48
MB 140,36,188
T 58,22,52
W 6
MB 144,40,184
G 47,44,66,3
MB 148,40,188
T 60,23,48
T 62,23,52
MB 152,44,184
s_waitcnt vmcnt(18)
s_barrier
T 0,24,0
MB 156,44,188
T 2,24,4
s_xor_b32 m0, s65, 0x4000
s_xor_b32 s66, s62, 0x48100
W 6
MB 160,48,184
G 44,44,66,0
MB 164,48,188
T 4,25,0
T 6,25,4
MB 168,52,184
T 8,26,0
MB 172,52,188
T 10,26,4
W 6
MB 176,56,184
G 45,44,66,1
MB 180,56,188
T 12,27,0
T 14,27,4
MB 184,60,184
T 16,28,0
MB 188,60,188
T 18,28,4
W 6
MB 128,0,224
G 46,44,66,2
MB 132,0,228
T 20,29,0
T 22,29,4
MB 136,4,224
T 24,30,0
MB 140,4,228
T 26,30,4
W 6
MB 144,8,224
G 47,44,66,3
MB 148,8,228
T 28,31,0
T 30,31,4
MB 152,12,224
s_waitcnt vmcnt(18)
s_barrier
T 32,24,16
MB 156,12,228
T 34,24,20
s_xor_b32 m0, s65, 0x8000
s_xor_b32 s66, s62, 0x50100
W 6
MB 160,16,224
G 44,44,66,0
MB 164,16,228
T 36,25,16
T 38,25,20
MB 168,20,224
T 40,26,16
MB 172,20,228
T 42,26,20
W 6
MB 176,24,224
G 45,44,66,1
MB 180,24,228
T 44,27,16
T 46,27,20
MB 184,28,224
T 48,28,16
MB 188,28,228
T 50,28,20
W 6
MB 128,32,232
G 46,44,66,2
MB 132,32,236
T 52,29,16
T 54,29,20
MB 136,36,232
T 56,30,16
MB 140,36,236
T 58,30,20
W 6
MB 144,40,232
G 47,44,66,3
MB 148,40,236
T 60,31,16
T 62,31,20
MB 152,44,232
s_waitcnt vmcnt(18)
s_barrier
T 0,24,32
MB 156,44,236
T 2,24,36
s_xor_b32 m0, s65, 0xc000
s_xor_b32 s66, s62, 0x58100
W 6
MB 160,48,232
G 44,44,66,0
MB 164,48,236
T 4,25,32
T 6,25,36
MB 168,52,232
T 8,26,32
MB 172,52,236
T 10,26,36
W 6
MB 176,56,232
G 45,44,66,1
MB 180,56,236
T 12,27,32
T 14,27,36
MB 184,60,232
T 16,28,32
MB 188,60,236
T 18,28,36
W 6
MB 128,0,240
G 46,44,66,2
MB 132,0,244
T 20,29,32
T 22,29,36
MB 136,4,240
T 24,30,32
MB 140,4,244
T 26,30,36
W 6
MB 144,8,240
G 47,44,66,3
MB 148,8,244
T 28,31,32
T 30,31,36
MB 152,12,240
s_waitcnt vmcnt(18)
s_barrier
T 32,24,48
MB 156,12,244
T 34,24,52
s_xor_b32 m0, s65, 0x10000
s_xor_b32 s66, s62, 0x60100
W 6
MB 160,16,240
G 44,44,66,0
MB 164,16,244
T 36,25,48
T 38,25,52
MB 168,20,240
T 40,26,48
MB 172,20,244
T 42,26,52
W 6
MB 176,24,240
G 45,44,66,1
MB 180,24,244
T 44,27,48
T 46,27,52
MB 184,28,240
T 48,28,48
MB 188,28,244
T 50,28,52
W 6
MB 128,32,248
G 46,44,66,2
MB 132,32,252
T 52,29,48
T 54,29,52
MB 136,36,248
T 56,30,48
MB 140,36,252
T 58,30,52
W 6
MB 144,40,248
G 47,44,66,3
MB 148,40,252
T 60,31,48
T 62,31,52
MB 152,44,248
s_waitcnt vmcnt(16)
s_barrier
T 0,16,0
MB 156,44,252
T 2,16,4
s_xor_b32 m0, s65, 0x14000
s_xor_b32 s66, s62, 0x68100
W 6
MB 160,48,248
G 44,44,66,0
MB 164,48,252
T 4,17,0
T 6,17,4
MB 168,52,248
T 8,18,0
MB 172,52,252
T 10,18,4
W 6
MB 176,56,248
G 45,44,66,1
MB 180,56,252
T 12,19,0
T 14,19,4
MB 184,60,248
T 16,20,0
MB 188,60,252
T 18,20,4
W 6
MB 192,0,160
G 46,44,66,2
MB 196,0,164
T 20,21,0
T 22,21,4
MB 200,4,160
T 24,22,0
MB 204,4,164
T 26,22,4
W 6
MB 208,8,160
G 47,44,66,3
MB 212,8,164
T 28,23,0
T 30,23,4
MB 216,12,160
s_waitcnt vmcnt(16)
s_barrier
T 32,16,16
T 34,16,20
MB 220,12,164
CV 68,132
CV 69,134
CV 70,140
s_xor_b32 m0, s65, 0x18000
s_xor_b32 s66, s62, 0x70100
W 6
MB 224,16,160
G 44,44,66,0
T 36,17,16
T 38,17,20
MB 228,16,164
CV 71,142
s_xor_b32 s79, s67, 0x1011000
buffer_store_dwordx4 v[68:71], v59, s[52:55], s79 offen sc1
MB 232,20,160
T 40,18,16
T 42,18,20
MB 236,20,164
CV 72,144
CV 73,146
CV 74,152
W 6
MB 240,24,160
G 45,44,66,1
T 44,19,16
T 46,19,20
MB 244,24,164
CV 75,154
s_xor_b32 s79, s67, 0x1022000
buffer_store_dwordx4 v[72:75], v59, s[52:55], s79 offen sc1
MB 248,28,160
T 48,20,16
T 50,20,20
MB 252,28,164
CV 76,148
CV 77,150
CV 78,156
W 6
MB 192,32,168
G 46,44,66,2
T 52,21,16
T 54,21,20
MB 196,32,172
CV 79,158
s_xor_b32 s79, s67, 0x1033000
buffer_store_dwordx4 v[76:79], v59, s[52:55], s79 offen sc1
L_ce_c3:
v_cmp_ne_u32 vcc, 1, v3
v_cmp_ne_u32 s[82:83], 1, v4
s_nop 3
s_or_b64 vcc, vcc, s[82:83]
s_cbranch_scc1 L_we_c3
L_ge_c3:
MB 200,36,168
T 56,22,16
T 58,22,20
MB 204,36,172
CV 80,160
CV 81,162
CV 82,168
W 6
MB 208,40,168
G 47,44,66,3
T 60,23,16
T 62,23,20
MB 212,40,172
CV 83,170
s_xor_b32 s79, s67, 0x1044000
buffer_store_dwordx4 v[80:83], v59, s[52:55], s79 offen sc1
MB 216,44,168
s_waitcnt vmcnt(20)
s_barrier
T 0,16,32
T 2,16,36
MB 220,44,172
CV 84,164
CV 85,166
CV 86,172
s_xor_b32 m0, s65, 0x1c000
s_xor_b32 s66, s62, 0x78100
W 6
MB 224,48,168
G 44,44,66,0
T 4,17,32
T 6,17,36
MB 228,48,172
CV 87,174
s_xor_b32 s79, s67, 0x1055000
buffer_store_dwordx4 v[84:87], v59, s[52:55], s79 offen sc1
MB 232,52,168
T 8,18,32
T 10,18,36
MB 236,52,172
CV 88,176
CV 89,178
CV 90,184
W 6
MB 240,56,168
G 45,44,66,1
T 12,19,32
T 14,19,36
MB 244,56,172
CV 91,186
s_xor_b32 s79, s67, 0x1066000
buffer_store_dwordx4 v[88:91], v59, s[52:55], s79 offen sc1
MB 248,60,168
T 16,20,32
T 18,20,36
MB 252,60,172
CV 92,180
CV 93,182
CV 94,188
W 6
MB 192,0,176
G 46,44,66,2
T 20,21,32
T 22,21,36
MB 196,0,180
CV 95,190
s_xor_b32 s79, s67, 0x1077000
buffer_store_dwordx4 v[92:95], v59, s[52:55], s79 offen sc1
MB 200,4,176
T 24,22,32
T 26,22,36
MB 204,4,180
CV 64,128
CV 65,130
W 6
MB 208,8,176
G 47,44,66,3
T 28,23,32
MB 212,8,180
T 30,23,36
CV 66,136
CV 67,138
MB 216,12,176
s_waitcnt vmcnt(23)
s_barrier
MB 220,12,180
T 32,16,48
T 34,16,52
W 6
MB 224,16,176
s_xor_b32 s80, s67, 0x1000
buffer_load_dwordx4 v[132:135], v59, s[52:55], s80 offen sc1
MB 228,16,180
T 36,17,48
T 38,17,52
MB 232,20,176
T 40,18,48
MB 236,20,180
T 42,18,52
W 6
MB 240,24,176
T 44,19,48
MB 244,24,180
T 46,19,52
MB 248,28,176
T 48,20,48
MB 252,28,180
T 50,20,52
W 6
MB 192,32,184
T 52,21,48
MB 196,32,188
T 54,21,52
MB 200,36,184
T 56,22,48
MB 204,36,188
T 58,22,52
W 6
MB 208,40,184
s_xor_b32 s80, s67, 0x2000
buffer_load_dwordx4 v[136:139], v59, s[52:55], s80 offen sc1
MB 212,40,188
T 60,23,48
T 62,23,52
MB 216,44,184
s_waitcnt vmcnt(21)
s_barrier
MB 220,44,188
T 0,24,0
T 2,24,4
W 6
MB 224,48,184
T 4,25,0
MB 228,48,188
T 6,25,4
MB 232,52,184
T 8,26,0
MB 236,52,188
T 10,26,4
W 6
MB 240,56,184
T 12,27,0
MB 244,56,188
T 14,27,4
MB 248,60,184
T 16,28,0
MB 252,60,188
T 18,28,4
W 6
MB 192,0,224
s_xor_b32 s80, s67, 0x3000
buffer_load_dwordx4 v[140:143], v59, s[52:55], s80 offen sc1
MB 196,0,228
T 20,29,0
T 22,29,4
MB 200,4,224
T 24,30,0
MB 204,4,228
T 26,30,4
W 6
MB 208,8,224
T 28,31,0
MB 212,8,228
T 30,31,4
MB 216,12,224
s_waitcnt vmcnt(18)
s_barrier
MB 220,12,228
T 32,24,16
T 34,24,20
W 6
MB 224,16,224
T 36,25,16
MB 228,16,228
T 38,25,20
MB 232,20,224
T 40,26,16
MB 236,20,228
T 42,26,20
W 6
MB 240,24,224
s_xor_b32 s80, s67, 0x4000
buffer_load_dwordx4 v[144:147], v59, s[52:55], s80 offen sc1
MB 244,24,228
T 44,27,16
T 46,27,20
MB 248,28,224
T 48,28,16
MB 252,28,228
T 50,28,20
W 6
MB 192,32,232
T 52,29,16
MB 196,32,236
T 54,29,20
MB 200,36,232
T 56,30,16
MB 204,36,236
T 58,30,20
W 6
MB 208,40,232
T 60,31,16
MB 212,40,236
T 62,31,20
MB 216,44,232
s_waitcnt vmcnt(12)
s_barrier
MB 220,44,236
T 0,24,32
T 2,24,36
W 6
MB 224,48,232
T 4,25,32
MB 228,48,236
T 6,25,36
MB 232,52,232
s_xor_b32 s80, s67, 0x5000
buffer_load_dwordx4 v[148:151], v59, s[52:55], s80 offen sc1
MB 236,52,236
T 8,26,32
T 10,26,36
W 6
MB 240,56,232
T 12,27,32
MB 244,56,236
T 14,27,36
MB 248,60,232
T 16,28,32
MB 252,60,236
T 18,28,36
W 6
MB 192,0,240
T 20,29,32
MB 196,0,244
T 22,29,36
MB 200,4,240
T 24,30,32
MB 204,4,244
T 26,30,36
W 6
MB 208,8,240
T 28,31,32
MB 212,8,244
T 30,31,36
MB 216,12,240
s_waitcnt vmcnt(5)
s_barrier
s_xor_b32 s80, s67, 0x6000
MB 220,12,244
buffer_load_dwordx4 v[152:155], v59, s[52:55], s80 offen sc1
T 32,24,48
T 34,24,52
W 6
MB 224,16,240
T 36,25,48
MB 228,16,244
T 38,25,52
MB 232,20,240
T 40,26,48
MB 236,20,244
T 42,26,52
W 6
MB 240,24,240
T 44,27,48
MB 244,24,244
T 46,27,52
MB 248,28,240
T 48,28,48
MB 252,28,244
T 50,28,52
W 6
MB 192,32,248
T 52,29,48
MB 196,32,252
T 54,29,52
MB 200,36,248
s_xor_b32 s80, s67, 0x7000
buffer_load_dwordx4 v[156:159], v59, s[52:55], s80 offen sc1
MB 204,36,252
T 56,30,48
T 58,30,52
W 6
MB 208,40,248
T 60,31,48
MB 212,40,252
T 62,31,52
MB 216,44,248
MB 220,44,252
W 4
MB 224,48,248
MB 228,48,252
MB 232,52,248
MB 236,52,252
W 0
MB 240,56,248
MB 244,56,252
v_mov_b32 v61, 1
v_mov_b32 v62, 0
s_mov_b64 exec, 1
buffer_store_dword v61, v62, s[52:55], s5 offen offset:256 sc1
s_mov_b64 exec, -1
MB 248,60,248
MB 252,60,252
CV 100,196
CV 101,198
CV 102,204
CV 103,206
s_xor_b32 s79, s67, 0x1019000
buffer_store_dwordx4 v[100:103], v59, s[52:55], s79 offen sc1
CV 104,208
CV 105,210
CV 106,216
CV 107,218
s_xor_b32 s79, s67, 0x102a000
buffer_store_dwordx4 v[104:107], v59, s[52:55], s79 offen sc1
CV 108,212
CV 109,214
CV 110,220
CV 111,222
s_xor_b32 s79, s67, 0x103b000
buffer_store_dwordx4 v[108:111], v59, s[52:55], s79 offen sc1
CV 112,224
CV 113,226
CV 114,232
CV 115,234
s_xor_b32 s79, s67, 0x104c000
buffer_store_dwordx4 v[112:115], v59, s[52:55], s79 offen sc1
CV 116,228
CV 117,230
CV 118,236
CV 119,238
s_xor_b32 s79, s67, 0x105d000
buffer_store_dwordx4 v[116:119], v59, s[52:55], s79 offen sc1
CV 120,240
CV 121,242
CV 122,248
CV 123,250
s_xor_b32 s79, s67, 0x106e000
buffer_store_dwordx4 v[120:123], v59, s[52:55], s79 offen sc1
CV 124,244
CV 125,246
CV 126,252
CV 127,254
s_xor_b32 s79, s67, 0x107f000
buffer_store_dwordx4 v[124:127], v59, s[52:55], s79 offen sc1
CV 96,192
CV 97,194
CV 98,200
CV 99,202
buffer_load_dword v0, v7, s[52:55], s72 offen offset:256 sc1
UP 68,36
UH 69,36
UP 70,37
UH 71,37
UP 72,38
UH 73,38
UP 74,39
UH 75,39
s_waitcnt vmcnt(15)
UP 76,132
UH 77,132
UP 78,133
UH 79,133
UP 80,134
UH 81,134
UP 82,135
UH 83,135
PA 68,76
PA 70,78
PA 72,80
PA 74,82
s_waitcnt vmcnt(14)
UP 76,136
UH 77,136
UP 78,137
UH 79,137
UP 80,138
UH 81,138
UP 82,139
UH 83,139
PA 68,76
PA 70,78
PA 72,80
PA 74,82
s_waitcnt vmcnt(13)
UP 76,140
UH 77,140
UP 78,141
UH 79,141
UP 80,142
UH 81,142
UP 82,143
UH 83,143
PA 68,76
PA 70,78
PA 72,80
PA 74,82
s_waitcnt vmcnt(12)
UP 76,144
UH 77,144
UP 78,145
UH 79,145
UP 80,146
UH 81,146
UP 82,147
UH 83,147
PA 68,76
PA 70,78
PA 72,80
PA 74,82
s_waitcnt vmcnt(11)
UP 76,148
UH 77,148
UP 78,149
UH 79,149
UP 80,150
UH 81,150
UP 82,151
UH 83,151
PA 68,76
PA 70,78
PA 72,80
PA 74,82
s_waitcnt vmcnt(10)
UP 76,152
UH 77,152
UP 78,153
UH 79,153
UP 80,154
UH 81,154
UP 82,155
UH 83,155
PA 68,76
PA 70,78
PA 72,80
PA 74,82
s_waitcnt vmcnt(9)
UP 76,156
UH 77,156
UP 78,157
UH 79,157
UP 80,158
UH 81,158
UP 82,159
UH 83,159
PA 68,76
PA 70,78
PA 72,80
PA 74,82
CV 128,68
CV 129,70
CV 130,72
CV 131,74
s_nop 0
v_permlane32_swap_b32 v128, v130
v_permlane32_swap_b32 v129, v131
s_nop 0
v_permlane16_swap_b32 v128, v130
v_permlane16_swap_b32 v129, v131
s_xor_b32 s80, s4, 0x0
buffer_store_dwordx4 v[128:131], v6, s[56:59], s80 offen
s_waitcnt vmcnt(2)
v_mov_b32 v61, 1
v_mov_b32 v62, 0
s_mov_b64 exec, 1
buffer_store_dword v61, v62, s[52:55], s5 offen offset:384 sc1
s_mov_b64 exec, -1
s_xor_b32 s80, s67, 0x9000
buffer_load_dwordx4 v[164:167], v59, s[52:55], s80 offen sc1
s_xor_b32 s80, s67, 0xa000
buffer_load_dwordx4 v[168:171], v59, s[52:55], s80 offen sc1
s_xor_b32 s80, s67, 0xb000
buffer_load_dwordx4 v[172:175], v59, s[52:55], s80 offen sc1
s_xor_b32 s80, s67, 0xc000
buffer_load_dwordx4 v[176:179], v59, s[52:55], s80 offen sc1
s_xor_b32 s80, s67, 0xd000
buffer_load_dwordx4 v[180:183], v59, s[52:55], s80 offen sc1
s_xor_b32 s80, s67, 0xe000
buffer_load_dwordx4 v[184:187], v59, s[52:55], s80 offen sc1
s_xor_b32 s80, s67, 0xf000
buffer_load_dwordx4 v[188:191], v59, s[52:55], s80 offen sc1
L_cm_c3:
s_waitcnt vmcnt(9)
v_cmp_ne_u32 vcc, 1, v0
s_nop 3
s_or_b64 vcc, vcc, vcc
s_cbranch_scc1 L_wm_c3
L_gm_c3:
s_xor_b32 s80, s67, 0x1001000
buffer_load_dwordx4 v[196:199], v59, s[52:55], s80 offen sc1
s_xor_b32 s80, s67, 0x1002000
buffer_load_dwordx4 v[200:203], v59, s[52:55], s80 offen sc1
s_xor_b32 s80, s67, 0x1003000
buffer_load_dwordx4 v[204:207], v59, s[52:55], s80 offen sc1
s_xor_b32 s80, s67, 0x1004000
buffer_load_dwordx4 v[208:211], v59, s[52:55], s80 offen sc1
s_xor_b32 s80, s67, 0x1005000
buffer_load_dwordx4 v[212:215], v59, s[52:55], s80 offen sc1
s_xor_b32 s80, s67, 0x1006000
buffer_load_dwordx4 v[216:219], v59, s[52:55], s80 offen sc1
s_xor_b32 s80, s67, 0x1007000
buffer_load_dwordx4 v[220:223], v59, s[52:55], s80 offen sc1
buffer_load_dword v4, v7, s[52:55], s72 offen offset:384 sc1
UP 68,40
UH 69,40
UP 70,41
UH 71,41
UP 72,42
UH 73,42
UP 74,43
UH 75,43
s_waitcnt vmcnt(14)
UP 76,164
UH 77,164
UP 78,165
UH 79,165
UP 80,166
UH 81,166
UP 82,167
UH 83,167
PA 68,76
PA 70,78
PA 72,80
PA 74,82
s_waitcnt vmcnt(13)
UP 76,168
UH 77,168
UP 78,169
UH 79,169
UP 80,170
UH 81,170
UP 82,171
UH 83,171
PA 68,76
PA 70,78
PA 72,80
PA 74,82
s_waitcnt vmcnt(12)
UP 76,172
UH 77,172
UP 78,173
UH 79,173
UP 80,174
UH 81,174
UP 82,175
UH 83,175
PA 68,76
PA 70,78
PA 72,80
PA 74,82
s_waitcnt vmcnt(11)
UP 76,176
UH 77,176
UP 78,177
UH 79,177
UP 80,178
UH 81,178
UP 82,179
UH 83,179
PA 68,76
PA 70,78
PA 72,80
PA 74,82
s_waitcnt vmcnt(10)
UP 76,180
UH 77,180
UP 78,181
UH 79,181
UP 80,182
UH 81,182
UP 82,183
UH 83,183
PA 68,76
PA 70,78
PA 72,80
PA 74,82
s_waitcnt vmcnt(9)
UP 76,184
UH 77,184
UP 78,185
UH 79,185
UP 80,186
UH 81,186
UP 82,187
UH 83,187
PA 68,76
PA 70,78
PA 72,80
PA 74,82
s_waitcnt vmcnt(8)
UP 76,188
UH 77,188
UP 78,189
UH 79,189
UP 80,190
UH 81,190
UP 82,191
UH 83,191
PA 68,76
PA 70,78
PA 72,80
PA 74,82
CV 160,68
CV 161,70
CV 162,72
CV 163,74
s_nop 0
v_permlane32_swap_b32 v160, v162
v_permlane32_swap_b32 v161, v163
s_nop 0
v_permlane16_swap_b32 v160, v162
v_permlane16_swap_b32 v161, v163
s_xor_b32 s80, s4, 0x100
buffer_store_dwordx4 v[160:163], v6, s[56:59], s80 offen
L_cl_c3:
s_waitcnt vmcnt(1)
v_cmp_ne_u32 vcc, 1, v4
s_nop 3
s_or_b64 vcc, vcc, vcc
s_cbranch_scc1 L_wl_c3
L_gl_c3:
s_xor_b32 s80, s67, 0x1009000
buffer_load_dwordx4 v[228:231], v59, s[52:55], s80 offen sc1
s_xor_b32 s80, s67, 0x100a000
buffer_load_dwordx4 v[232:235], v59, s[52:55], s80 offen sc1
s_xor_b32 s80, s67, 0x100b000
buffer_load_dwordx4 v[236:239], v59, s[52:55], s80 offen sc1
s_xor_b32 s80, s67, 0x100c000
buffer_load_dwordx4 v[240:243], v59, s[52:55], s80 offen sc1
s_xor_b32 s80, s67, 0x100d000
buffer_load_dwordx4 v[244:247], v59, s[52:55], s80 offen sc1
s_xor_b32 s80, s67, 0x100e000
buffer_load_dwordx4 v[248:251], v59, s[52:55], s80 offen sc1
s_xor_b32 s80, s67, 0x100f000
buffer_load_dwordx4 v[252:255], v59, s[52:55], s80 offen sc1
UP 68,64
UH 69,64
UP 70,65
UH 71,65
UP 72,66
UH 73,66
UP 74,67
UH 75,67
UP 76,196
UH 77,196
UP 78,197
UH 79,197
UP 80,198
UH 81,198
UP 82,199
UH 83,199
PA 68,76
PA 70,78
PA 72,80
PA 74,82
UP 76,200
UH 77,200
UP 78,201
UH 79,201
UP 80,202
UH 81,202
UP 82,203
UH 83,203
PA 68,76
PA 70,78
PA 72,80
PA 74,82
UP 76,204
UH 77,204
UP 78,205
UH 79,205
UP 80,206
UH 81,206
UP 82,207
UH 83,207
PA 68,76
PA 70,78
PA 72,80
PA 74,82
UP 76,208
UH 77,208
UP 78,209
UH 79,209
UP 80,210
UH 81,210
UP 82,211
UH 83,211
PA 68,76
PA 70,78
PA 72,80
PA 74,82
UP 76,212
UH 77,212
UP 78,213
UH 79,213
UP 80,214
UH 81,214
UP 82,215
UH 83,215
PA 68,76
PA 70,78
PA 72,80
PA 74,82
UP 76,216
UH 77,216
UP 78,217
UH 79,217
UP 80,218
UH 81,218
UP 82,219
UH 83,219
PA 68,76
PA 70,78
PA 72,80
PA 74,82
UP 76,220
UH 77,220
UP 78,221
UH 79,221
UP 80,222
UH 81,222
UP 82,223
UH 83,223
PA 68,76
PA 70,78
PA 72,80
PA 74,82
CV 192,68
CV 193,70
CV 194,72
CV 195,74
s_nop 0
v_permlane32_swap_b32 v192, v194
v_permlane32_swap_b32 v193, v195
s_nop 0
v_permlane16_swap_b32 v192, v194
v_permlane16_swap_b32 v193, v195
s_xor_b32 s80, s4, 0x400
buffer_store_dwordx4 v[192:195], v6, s[56:59], s80 offen
UP 68,96
UH 69,96
UP 70,97
UH 71,97
UP 72,98
UH 73,98
UP 74,99
UH 75,99
s_waitcnt vmcnt(7)
UP 76,228
UH 77,228
UP 78,229
UH 79,229
UP 80,230
UH 81,230
UP 82,231
UH 83,231
PA 68,76
PA 70,78
PA 72,80
PA 74,82
s_waitcnt vmcnt(6)
UP 76,232
UH 77,232
UP 78,233
UH 79,233
UP 80,234
UH 81,234
UP 82,235
UH 83,235
PA 68,76
PA 70,78
PA 72,80
PA 74,82
s_waitcnt vmcnt(5)
UP 76,236
UH 77,236
UP 78,237
UH 79,237
UP 80,238
UH 81,238
UP 82,239
UH 83,239
PA 68,76
PA 70,78
PA 72,80
PA 74,82
s_waitcnt vmcnt(4)
UP 76,240
UH 77,240
UP 78,241
UH 79,241
UP 80,242
UH 81,242
UP 82,243
UH 83,243
PA 68,76
PA 70,78
PA 72,80
PA 74,82
s_waitcnt vmcnt(3)
UP 76,244
UH 77,244
UP 78,245
UH 79,245
UP 80,246
UH 81,246
UP 82,247
UH 83,247
PA 68,76
PA 70,78
PA 72,80
PA 74,82
s_waitcnt vmcnt(2)
UP 76,248
UH 77,248
UP 78,249
UH 79,249
UP 80,250
UH 81,250
UP 82,251
UH 83,251
PA 68,76
PA 70,78
PA 72,80
PA 74,82
s_waitcnt vmcnt(1)
UP 76,252
UH 77,252
UP 78,253
UH 79,253
UP 80,254
UH 81,254
UP 82,255
UH 83,255
PA 68,76
PA 70,78
PA 72,80
PA 74,82
CV 224,68
CV 225,70
CV 226,72
CV 227,74
s_nop 0
v_permlane32_swap_b32 v224, v226
v_permlane32_swap_b32 v225, v227
s_nop 0
v_permlane16_swap_b32 v224, v226
v_permlane16_swap_b32 v225, v227
s_xor_b32 s80, s4, 0x500
buffer_store_dwordx4 v[224:227], v6, s[56:59], s80 offen
s_endpgm
L_slow_c3B0:
s_waitcnt vmcnt(0) lgkmcnt(0)
s_nop 15
s_mov_b32 s93, m0
s_andn2_b32 s80, s63, 0x1ff00
s_xor_b32 s80, s80, 0x0
v_mov_b32 v62, 0xff800000
v_mov_b32 v63, 0xff800000
s_mov_b32 s94, s80
s_mov_b32 s81, 0
L_slow1_c3B0:
s_add_u32 m0, s78, 0
s_add_u32 s92, s94, 0
G 32,32,92,0
G 33,32,92,1
G 34,32,92,2
G 35,32,92,3
s_add_u32 m0, s78, 4096
s_add_u32 s92, s94, 512
G 32,32,92,0
G 33,32,92,1
G 34,32,92,2
G 35,32,92,3
s_waitcnt vmcnt(0)
v_and_b32 v0, 0x1fff, v8
v_add_u32 v0, s78, v0
R a,32,0,0
R a,48,0,4
v_and_b32 v0, 0x1fff, v9
v_add_u32 v0, s78, v0
R a,36,0,0
R a,52,0,4
v_and_b32 v0, 0x1fff, v10
v_add_u32 v0, s78, v0
R a,40,0,0
R a,56,0,4
v_and_b32 v0, 0x1fff, v11
v_add_u32 v0, s78, v0
R a,44,0,0
R a,60,0,4
W 7
ZB 64,32,64
ZB 68,32,68
W 5
MB 64,36,72
MB 68,36,76
W 3
MB 64,40,80
MB 68,40,84
W 1
MB 64,44,88
MB 68,44,92
ZB 72,48,64
ZB 76,48,68
MB 72,52,72
MB 76,52,76
MB 72,56,80
MB 76,56,84
W 0
MB 72,60,88
MB 76,60,92
v_max_f32 v62, v62, v64
v_max_f32 v62, v62, v65
v_max_f32 v62, v62, v66
v_max_f32 v62, v62, v67
v_max_f32 v63, v63, v68
v_max_f32 v63, v63, v69
v_max_f32 v63, v63, v70
v_max_f32 v63, v63, v71
v_max_f32 v62, v62, v72
v_max_f32 v62, v62, v73
v_max_f32 v62, v62, v74
v_max_f32 v62, v62, v75
v_max_f32 v63, v63, v76
v_max_f32 v63, v63, v77
v_max_f32 v63, v63, v78
v_max_f32 v63, v63, v79
s_or_b32 s81, s81, 0x7ffe8fff
s_add_u32 s81, s81, 1
s_and_b32 s81, s81, 0x17000
s_add_u32 s94, s80, s81
s_cmp_lg_u32 s81, 0
s_cbranch_scc1 L_slow1_c3B0
v_mov_b32 v1, v62
s_nop 1
v_permlane32_swap_b32 v1, v62
v_max_f32 v62, v62, v1
v_mov_b32 v1, v62
s_nop 1
v_permlane16_swap_b32 v1, v62
v_max_f32 v62, v62, v1
v_mov_b32 v1, v63
s_nop 1
v_permlane32_swap_b32 v1, v63
v_max_f32 v63, v63, v1
v_mov_b32 v1, v63
s_nop 1
v_permlane16_swap_b32 v1, v63
v_max_f32 v63, v63, v1
v_mov_b32 v60, 0
v_mov_b32 v61, 0
v_accvgpr_write_b32 a96, 0
v_accvgpr_write_b32 a97, 0
v_accvgpr_write_b32 a98, 0
v_accvgpr_write_b32 a99, 0
v_accvgpr_write_b32 a100, 0
v_accvgpr_write_b32 a101, 0
v_accvgpr_write_b32 a102, 0
v_accvgpr_write_b32 a103, 0
v_accvgpr_write_b32 a104, 0
v_accvgpr_write_b32 a105, 0
v_accvgpr_write_b32 a106, 0
v_accvgpr_write_b32 a107, 0
v_accvgpr_write_b32 a108, 0
v_accvgpr_write_b32 a109, 0
v_accvgpr_write_b32 a110, 0
v_accvgpr_write_b32 a111, 0
v_accvgpr_write_b32 a112, 0
v_accvgpr_write_b32 a113, 0
v_accvgpr_write_b32 a114, 0
v_accvgpr_write_b32 a115, 0
v_accvgpr_write_b32 a116, 0
v_accvgpr_write_b32 a117, 0
v_accvgpr_write_b32 a118, 0
v_accvgpr_write_b32 a119, 0
v_accvgpr_write_b32 a120, 0
v_accvgpr_write_b32 a121, 0
v_accvgpr_write_b32 a122, 0
v_accvgpr_write_b32 a123, 0
v_accvgpr_write_b32 a124, 0
v_accvgpr_write_b32 a125, 0
v_accvgpr_write_b32 a126, 0
v_accvgpr_write_b32 a127, 0
v_accvgpr_write_b32 a128, 0
v_accvgpr_write_b32 a129, 0
v_accvgpr_write_b32 a130, 0
v_accvgpr_write_b32 a131, 0
v_accvgpr_write_b32 a132, 0
v_accvgpr_write_b32 a133, 0
v_accvgpr_write_b32 a134, 0
v_accvgpr_write_b32 a135, 0
v_accvgpr_write_b32 a136, 0
v_accvgpr_write_b32 a137, 0
v_accvgpr_write_b32 a138, 0
v_accvgpr_write_b32 a139, 0
v_accvgpr_write_b32 a140, 0
v_accvgpr_write_b32 a141, 0
v_accvgpr_write_b32 a142, 0
v_accvgpr_write_b32 a143, 0
v_accvgpr_write_b32 a144, 0
v_accvgpr_write_b32 a145, 0
v_accvgpr_write_b32 a146, 0
v_accvgpr_write_b32 a147, 0
v_accvgpr_write_b32 a148, 0
v_accvgpr_write_b32 a149, 0
v_accvgpr_write_b32 a150, 0
v_accvgpr_write_b32 a151, 0
v_accvgpr_write_b32 a152, 0
v_accvgpr_write_b32 a153, 0
v_accvgpr_write_b32 a154, 0
v_accvgpr_write_b32 a155, 0
v_accvgpr_write_b32 a156, 0
v_accvgpr_write_b32 a157, 0
v_accvgpr_write_b32 a158, 0
v_accvgpr_write_b32 a159, 0
s_mov_b32 s94, s80
s_mov_b32 s81, 0
s_nop 4
L_slow2_c3B0:
s_add_u32 m0, s78, 0
s_add_u32 s92, s94, 0
G 32,32,92,0
G 33,32,92,1
G 34,32,92,2
G 35,32,92,3
s_add_u32 m0, s78, 4096
s_add_u32 s92, s94, 512
G 32,32,92,0
G 33,32,92,1
G 34,32,92,2
G 35,32,92,3
s_waitcnt vmcnt(0)
v_and_b32 v0, 0x1fff, v8
v_add_u32 v0, s78, v0
R a,32,0,0
R a,48,0,4
v_and_b32 v0, 0x1fff, v9
v_add_u32 v0, s78, v0
R a,36,0,0
R a,52,0,4
v_and_b32 v0, 0x1fff, v10
v_add_u32 v0, s78, v0
R a,40,0,0
R a,56,0,4
v_and_b32 v0, 0x1fff, v11
v_add_u32 v0, s78, v0
R a,44,0,0
R a,60,0,4
W 7
ZB 64,32,64
ZB 68,32,68
W 5
MB 64,36,72
MB 68,36,76
W 3
MB 64,40,80
MB 68,40,84
W 1
MB 64,44,88
MB 68,44,92
ZB 72,48,64
ZB 76,48,68
MB 72,52,72
MB 76,52,76
MB 72,56,80
MB 76,56,84
W 0
MB 72,60,88
MB 76,60,92
v_sub_f32 v64, v64, v62
v_sub_f32 v65, v65, v62
v_sub_f32 v66, v66, v62
v_sub_f32 v67, v67, v62
v_sub_f32 v68, v68, v63
v_sub_f32 v69, v69, v63
v_sub_f32 v70, v70, v63
v_sub_f32 v71, v71, v63
v_sub_f32 v72, v72, v62
v_sub_f32 v73, v73, v62
v_sub_f32 v74, v74, v62
v_sub_f32 v75, v75, v62
v_sub_f32 v76, v76, v63
v_sub_f32 v77, v77, v63
v_sub_f32 v78, v78, v63
v_sub_f32 v79, v79, v63
E 64
E 65
E 66
E 67
E 68
E 69
E 70
E 71
E 72
E 73
E 74
E 75
E 76
E 77
E 78
E 79
v_add_f32 v60, v60, v64
v_add_f32 v60, v60, v65
v_add_f32 v60, v60, v66
v_add_f32 v60, v60, v67
v_add_f32 v61, v61, v68
v_add_f32 v61, v61, v69
v_add_f32 v61, v61, v70
v_add_f32 v61, v61, v71
v_add_f32 v60, v60, v72
v_add_f32 v60, v60, v73
v_add_f32 v60, v60, v74
v_add_f32 v60, v60, v75
v_add_f32 v61, v61, v76
v_add_f32 v61, v61, v77
v_add_f32 v61, v61, v78
v_add_f32 v61, v61, v79
CV 96,64
CV 97,66
CV 100,68
CV 101,70
CV 98,72
CV 99,74
CV 102,76
CV 103,78
s_add_u32 m0, s78, 0
s_add_u32 s92, s94, 0
G 56,36,92,0
G 57,36,92,1
G 56,36,92,2
G 57,36,92,3
s_add_u32 m0, s78, 4096
s_add_u32 s92, s94, 512
G 56,36,92,0
G 57,36,92,1
G 56,36,92,2
G 57,36,92,3
s_waitcnt vmcnt(0)
v_and_b32 v0, 0x1fff, v16
v_add_u32 v0, s78, v0
T 32,0,0
T 34,0,4
v_and_b32 v0, 0x1fff, v17
v_add_u32 v0, s78, v0
T 36,0,0
T 38,0,4
v_and_b32 v0, 0x1fff, v18
v_add_u32 v0, s78, v0
T 40,0,0
T 42,0,4
v_and_b32 v0, 0x1fff, v19
v_add_u32 v0, s78, v0
T 44,0,0
T 46,0,4
v_and_b32 v0, 0x1fff, v20
v_add_u32 v0, s78, v0
T 48,0,0
T 50,0,4
v_and_b32 v0, 0x1fff, v21
v_add_u32 v0, s78, v0
T 52,0,0
T 54,0,4
v_and_b32 v0, 0x1fff, v22
v_add_u32 v0, s78, v0
T 56,0,0
T 58,0,4
v_and_b32 v0, 0x1fff, v23
v_add_u32 v0, s78, v0
T 60,0,0
W 14
T 62,0,4
W 14
MC 96,32,96
MC 100,32,100
W 12
MC 104,36,96
MC 108,36,100
W 10
MC 112,40,96
MC 116,40,100
W 8
MC 120,44,96
MC 124,44,100
W 6
MC 128,48,96
MC 132,48,100
W 4
MC 136,52,96
MC 140,52,100
W 2
MC 144,56,96
MC 148,56,100
W 0
MC 152,60,96
MC 156,60,100
s_nop 15
s_or_b32 s81, s81, 0x7ffe8fff
s_add_u32 s81, s81, 1
s_and_b32 s81, s81, 0x17000
s_add_u32 s94, s80, s81
s_cmp_lg_u32 s81, 0
s_cbranch_scc1 L_slow2_c3B0
v_mov_b32 v1, v60
s_nop 1
v_permlane32_swap_b32 v1, v60
v_add_f32 v60, v60, v1
v_mov_b32 v1, v60
s_nop 1
v_permlane16_swap_b32 v1, v60
v_add_f32 v60, v60, v1
v_mov_b32 v1, v61
s_nop 1
v_permlane32_swap_b32 v1, v61
v_add_f32 v61, v61, v1
v_mov_b32 v1, v61
s_nop 1
v_permlane16_swap_b32 v1, v61
v_add_f32 v61, v61, v1
s_mov_b32 m0, s93
s_nop 4
s_branch L_back_c3B0
L_slow_c3A0:
s_waitcnt vmcnt(0) lgkmcnt(0)
s_nop 15
s_mov_b32 s93, m0
s_andn2_b32 s80, s64, 0x1ff00
s_xor_b32 s80, s80, 0x0
v_mov_b32 v62, 0xff800000
v_mov_b32 v63, 0xff800000
s_mov_b32 s94, s80
s_mov_b32 s81, 0
L_slow1_c3A0:
s_add_u32 m0, s78, 0
s_add_u32 s92, s94, 0
G 32,12,92,0
G 33,12,92,1
G 34,12,92,2
G 35,12,92,3
s_add_u32 m0, s78, 4096
s_add_u32 s92, s94, 512
G 32,12,92,0
G 33,12,92,1
G 34,12,92,2
G 35,12,92,3
s_waitcnt vmcnt(0)
v_and_b32 v0, 0x1fff, v8
v_add_u32 v0, s78, v0
R a,32,0,0
R a,48,0,4
v_and_b32 v0, 0x1fff, v9
v_add_u32 v0, s78, v0
R a,36,0,0
R a,52,0,4
v_and_b32 v0, 0x1fff, v10
v_add_u32 v0, s78, v0
R a,40,0,0
R a,56,0,4
v_and_b32 v0, 0x1fff, v11
v_add_u32 v0, s78, v0
R a,44,0,0
R a,60,0,4
W 7
ZB 64,32,192
ZB 68,32,196
W 5
MB 64,36,200
MB 68,36,204
W 3
MB 64,40,208
MB 68,40,212
W 1
MB 64,44,216
MB 68,44,220
ZB 72,48,192
ZB 76,48,196
MB 72,52,200
MB 76,52,204
MB 72,56,208
MB 76,56,212
W 0
MB 72,60,216
MB 76,60,220
v_max_f32 v62, v62, v64
v_max_f32 v62, v62, v65
v_max_f32 v62, v62, v66
v_max_f32 v62, v62, v67
v_max_f32 v63, v63, v68
v_max_f32 v63, v63, v69
v_max_f32 v63, v63, v70
v_max_f32 v63, v63, v71
v_max_f32 v62, v62, v72
v_max_f32 v62, v62, v73
v_max_f32 v62, v62, v74
v_max_f32 v62, v62, v75
v_max_f32 v63, v63, v76
v_max_f32 v63, v63, v77
v_max_f32 v63, v63, v78
v_max_f32 v63, v63, v79
s_or_b32 s81, s81, 0x7ffe8fff
s_add_u32 s81, s81, 1
s_and_b32 s81, s81, 0x17000
s_add_u32 s94, s80, s81
s_cmp_lg_u32 s81, 0
s_cbranch_scc1 L_slow1_c3A0
v_mov_b32 v1, v62
s_nop 1
v_permlane32_swap_b32 v1, v62
v_max_f32 v62, v62, v1
v_mov_b32 v1, v62
s_nop 1
v_permlane16_swap_b32 v1, v62
v_max_f32 v62, v62, v1
v_mov_b32 v1, v63
s_nop 1
v_permlane32_swap_b32 v1, v63
v_max_f32 v63, v63, v1
v_mov_b32 v1, v63
s_nop 1
v_permlane16_swap_b32 v1, v63
v_max_f32 v63, v63, v1
v_mov_b32 v60, 0
v_mov_b32 v61, 0
v_mov_b32 v128, 0
v_mov_b32 v129, 0
v_mov_b32 v130, 0
v_mov_b32 v131, 0
v_mov_b32 v132, 0
v_mov_b32 v133, 0
v_mov_b32 v134, 0
v_mov_b32 v135, 0
v_mov_b32 v136, 0
v_mov_b32 v137, 0
v_mov_b32 v138, 0
v_mov_b32 v139, 0
v_mov_b32 v140, 0
v_mov_b32 v141, 0
v_mov_b32 v142, 0
v_mov_b32 v143, 0
v_mov_b32 v144, 0
v_mov_b32 v145, 0
v_mov_b32 v146, 0
v_mov_b32 v147, 0
v_mov_b32 v148, 0
v_mov_b32 v149, 0
v_mov_b32 v150, 0
v_mov_b32 v151, 0
v_mov_b32 v152, 0
v_mov_b32 v153, 0
v_mov_b32 v154, 0
v_mov_b32 v155, 0
v_mov_b32 v156, 0
v_mov_b32 v157, 0
v_mov_b32 v158, 0
v_mov_b32 v159, 0
v_mov_b32 v160, 0
v_mov_b32 v161, 0
v_mov_b32 v162, 0
v_mov_b32 v163, 0
v_mov_b32 v164, 0
v_mov_b32 v165, 0
v_mov_b32 v166, 0
v_mov_b32 v167, 0
v_mov_b32 v168, 0
v_mov_b32 v169, 0
v_mov_b32 v170, 0
v_mov_b32 v171, 0
v_mov_b32 v172, 0
v_mov_b32 v173, 0
v_mov_b32 v174, 0
v_mov_b32 v175, 0
v_mov_b32 v176, 0
v_mov_b32 v177, 0
v_mov_b32 v178, 0
v_mov_b32 v179, 0
v_mov_b32 v180, 0
v_mov_b32 v181, 0
v_mov_b32 v182, 0
v_mov_b32 v183, 0
v_mov_b32 v184, 0
v_mov_b32 v185, 0
v_mov_b32 v186, 0
v_mov_b32 v187, 0
v_mov_b32 v188, 0
v_mov_b32 v189, 0
v_mov_b32 v190, 0
v_mov_b32 v191, 0
s_mov_b32 s94, s80
s_mov_b32 s81, 0
s_nop 4
L_slow2_c3A0:
s_add_u32 m0, s78, 0
s_add_u32 s92, s94, 0
G 32,12,92,0
G 33,12,92,1
G 34,12,92,2
G 35,12,92,3
s_add_u32 m0, s78, 4096
s_add_u32 s92, s94, 512
G 32,12,92,0
G 33,12,92,1
G 34,12,92,2
G 35,12,92,3
s_waitcnt vmcnt(0)
v_and_b32 v0, 0x1fff, v8
v_add_u32 v0, s78, v0
R a,32,0,0
R a,48,0,4
v_and_b32 v0, 0x1fff, v9
v_add_u32 v0, s78, v0
R a,36,0,0
R a,52,0,4
v_and_b32 v0, 0x1fff, v10
v_add_u32 v0, s78, v0
R a,40,0,0
R a,56,0,4
v_and_b32 v0, 0x1fff, v11
v_add_u32 v0, s78, v0
R a,44,0,0
R a,60,0,4
W 7
ZB 64,32,192
ZB 68,32,196
W 5
MB 64,36,200
MB 68,36,204
W 3
MB 64,40,208
MB 68,40,212
W 1
MB 64,44,216
MB 68,44,220
ZB 72,48,192
ZB 76,48,196
MB 72,52,200
MB 76,52,204
MB 72,56,208
MB 76,56,212
W 0
MB 72,60,216
MB 76,60,220
v_sub_f32 v64, v64, v62
v_sub_f32 v65, v65, v62
v_sub_f32 v66, v66, v62
v_sub_f32 v67, v67, v62
v_sub_f32 v68, v68, v63
v_sub_f32 v69, v69, v63
v_sub_f32 v70, v70, v63
v_sub_f32 v71, v71, v63
v_sub_f32 v72, v72, v62
v_sub_f32 v73, v73, v62
v_sub_f32 v74, v74, v62
v_sub_f32 v75, v75, v62
v_sub_f32 v76, v76, v63
v_sub_f32 v77, v77, v63
v_sub_f32 v78, v78, v63
v_sub_f32 v79, v79, v63
E 64
E 65
E 66
E 67
E 68
E 69
E 70
E 71
E 72
E 73
E 74
E 75
E 76
E 77
E 78
E 79
v_add_f32 v60, v60, v64
v_add_f32 v60, v60, v65
v_add_f32 v60, v60, v66
v_add_f32 v60, v60, v67
v_add_f32 v61, v61, v68
v_add_f32 v61, v61, v69
v_add_f32 v61, v61, v70
v_add_f32 v61, v61, v71
v_add_f32 v60, v60, v72
v_add_f32 v60, v60, v73
v_add_f32 v60, v60, v74
v_add_f32 v60, v60, v75
v_add_f32 v61, v61, v76
v_add_f32 v61, v61, v77
v_add_f32 v61, v61, v78
v_add_f32 v61, v61, v79
CV 96,64
CV 97,66
CV 100,68
CV 101,70
CV 98,72
CV 99,74
CV 102,76
CV 103,78
s_add_u32 m0, s78, 0
s_add_u32 s92, s94, 0
G 56,16,92,0
G 57,16,92,1
G 56,16,92,2
G 57,16,92,3
s_add_u32 m0, s78, 4096
s_add_u32 s92, s94, 512
G 56,16,92,0
G 57,16,92,1
G 56,16,92,2
G 57,16,92,3
s_waitcnt vmcnt(0)
v_and_b32 v0, 0x1fff, v16
v_add_u32 v0, s78, v0
T 32,0,0
T 34,0,4
v_and_b32 v0, 0x1fff, v17
v_add_u32 v0, s78, v0
T 36,0,0
T 38,0,4
v_and_b32 v0, 0x1fff, v18
v_add_u32 v0, s78, v0
T 40,0,0
T 42,0,4
v_and_b32 v0, 0x1fff, v19
v_add_u32 v0, s78, v0
T 44,0,0
T 46,0,4
v_and_b32 v0, 0x1fff, v20
v_add_u32 v0, s78, v0
T 48,0,0
T 50,0,4
v_and_b32 v0, 0x1fff, v21
v_add_u32 v0, s78, v0
T 52,0,0
T 54,0,4
v_and_b32 v0, 0x1fff, v22
v_add_u32 v0, s78, v0
T 56,0,0
T 58,0,4
v_and_b32 v0, 0x1fff, v23
v_add_u32 v0, s78, v0
T 60,0,0
W 14
T 62,0,4
W 14
MA 128,32,96
MA 132,32,100
W 12
MA 136,36,96
MA 140,36,100
W 10
MA 144,40,96
MA 148,40,100
W 8
MA 152,44,96
MA 156,44,100
W 6
MA 160,48,96
MA 164,48,100
W 4
MA 168,52,96
MA 172,52,100
W 2
MA 176,56,96
MA 180,56,100
W 0
MA 184,60,96
MA 188,60,100
s_nop 15
s_or_b32 s81, s81, 0x7ffe8fff
s_add_u32 s81, s81, 1
s_and_b32 s81, s81, 0x17000
s_add_u32 s94, s80, s81
s_cmp_lg_u32 s81, 0
s_cbranch_scc1 L_slow2_c3A0
v_mov_b32 v1, v60
s_nop 1
v_permlane32_swap_b32 v1, v60
v_add_f32 v60, v60, v1
v_mov_b32 v1, v60
s_nop 1
v_permlane16_swap_b32 v1, v60
v_add_f32 v60, v60, v1
v_mov_b32 v1, v61
s_nop 1
v_permlane32_swap_b32 v1, v61
v_add_f32 v61, v61, v1
v_mov_b32 v1, v61
s_nop 1
v_permlane16_swap_b32 v1, v61
v_add_f32 v61, v61, v1
s_mov_b32 m0, s93
s_nop 4
s_branch L_back_c3A0
L_slow_c3A1:
s_waitcnt vmcnt(0) lgkmcnt(0)
s_nop 15
s_mov_b32 s93, m0
s_andn2_b32 s80, s64, 0x1ff00
s_xor_b32 s80, s80, 0x0
v_mov_b32 v62, 0xff800000
v_mov_b32 v63, 0xff800000
s_mov_b32 s94, s80
s_mov_b32 s81, 0
L_slow1_c3A1:
s_add_u32 m0, s78, 0
s_add_u32 s92, s94, 0
G 32,12,92,0
G 33,12,92,1
G 34,12,92,2
G 35,12,92,3
s_add_u32 m0, s78, 4096
s_add_u32 s92, s94, 512
G 32,12,92,0
G 33,12,92,1
G 34,12,92,2
G 35,12,92,3
s_waitcnt vmcnt(0)
v_and_b32 v0, 0x1fff, v8
v_add_u32 v0, s78, v0
R a,32,0,0
R a,48,0,4
v_and_b32 v0, 0x1fff, v9
v_add_u32 v0, s78, v0
R a,36,0,0
R a,52,0,4
v_and_b32 v0, 0x1fff, v10
v_add_u32 v0, s78, v0
R a,40,0,0
R a,56,0,4
v_and_b32 v0, 0x1fff, v11
v_add_u32 v0, s78, v0
R a,44,0,0
R a,60,0,4
W 7
ZB 64,32,224
ZB 68,32,228
W 5
MB 64,36,232
MB 68,36,236
W 3
MB 64,40,240
MB 68,40,244
W 1
MB 64,44,248
MB 68,44,252
ZB 72,48,224
ZB 76,48,228
MB 72,52,232
MB 76,52,236
MB 72,56,240
MB 76,56,244
W 0
MB 72,60,248
MB 76,60,252
v_max_f32 v62, v62, v64
v_max_f32 v62, v62, v65
v_max_f32 v62, v62, v66
v_max_f32 v62, v62, v67
v_max_f32 v63, v63, v68
v_max_f32 v63, v63, v69
v_max_f32 v63, v63, v70
v_max_f32 v63, v63, v71
v_max_f32 v62, v62, v72
v_max_f32 v62, v62, v73
v_max_f32 v62, v62, v74
v_max_f32 v62, v62, v75
v_max_f32 v63, v63, v76
v_max_f32 v63, v63, v77
v_max_f32 v63, v63, v78
v_max_f32 v63, v63, v79
s_or_b32 s81, s81, 0x7ffe8fff
s_add_u32 s81, s81, 1
s_and_b32 s81, s81, 0x17000
s_add_u32 s94, s80, s81
s_cmp_lg_u32 s81, 0
s_cbranch_scc1 L_slow1_c3A1
v_mov_b32 v1, v62
s_nop 1
v_permlane32_swap_b32 v1, v62
v_max_f32 v62, v62, v1
v_mov_b32 v1, v62
s_nop 1
v_permlane16_swap_b32 v1, v62
v_max_f32 v62, v62, v1
v_mov_b32 v1, v63
s_nop 1
v_permlane32_swap_b32 v1, v63
v_max_f32 v63, v63, v1
v_mov_b32 v1, v63
s_nop 1
v_permlane16_swap_b32 v1, v63
v_max_f32 v63, v63, v1
v_mov_b32 v60, 0
v_mov_b32 v61, 0
v_mov_b32 v192, 0
v_mov_b32 v193, 0
v_mov_b32 v194, 0
v_mov_b32 v195, 0
v_mov_b32 v196, 0
v_mov_b32 v197, 0
v_mov_b32 v198, 0
v_mov_b32 v199, 0
v_mov_b32 v200, 0
v_mov_b32 v201, 0
v_mov_b32 v202, 0
v_mov_b32 v203, 0
v_mov_b32 v204, 0
v_mov_b32 v205, 0
v_mov_b32 v206, 0
v_mov_b32 v207, 0
v_mov_b32 v208, 0
v_mov_b32 v209, 0
v_mov_b32 v210, 0
v_mov_b32 v211, 0
v_mov_b32 v212, 0
v_mov_b32 v213, 0
v_mov_b32 v214, 0
v_mov_b32 v215, 0
v_mov_b32 v216, 0
v_mov_b32 v217, 0
v_mov_b32 v218, 0
v_mov_b32 v219, 0
v_mov_b32 v220, 0
v_mov_b32 v221, 0
v_mov_b32 v222, 0
v_mov_b32 v223, 0
v_mov_b32 v224, 0
v_mov_b32 v225, 0
v_mov_b32 v226, 0
v_mov_b32 v227, 0
v_mov_b32 v228, 0
v_mov_b32 v229, 0
v_mov_b32 v230, 0
v_mov_b32 v231, 0
v_mov_b32 v232, 0
v_mov_b32 v233, 0
v_mov_b32 v234, 0
v_mov_b32 v235, 0
v_mov_b32 v236, 0
v_mov_b32 v237, 0
v_mov_b32 v238, 0
v_mov_b32 v239, 0
v_mov_b32 v240, 0
v_mov_b32 v241, 0
v_mov_b32 v242, 0
v_mov_b32 v243, 0
v_mov_b32 v244, 0
v_mov_b32 v245, 0
v_mov_b32 v246, 0
v_mov_b32 v247, 0
v_mov_b32 v248, 0
v_mov_b32 v249, 0
v_mov_b32 v250, 0
v_mov_b32 v251, 0
v_mov_b32 v252, 0
v_mov_b32 v253, 0
v_mov_b32 v254, 0
v_mov_b32 v255, 0
s_mov_b32 s94, s80
s_mov_b32 s81, 0
s_nop 4
L_slow2_c3A1:
s_add_u32 m0, s78, 0
s_add_u32 s92, s94, 0
G 32,12,92,0
G 33,12,92,1
G 34,12,92,2
G 35,12,92,3
s_add_u32 m0, s78, 4096
s_add_u32 s92, s94, 512
G 32,12,92,0
G 33,12,92,1
G 34,12,92,2
G 35,12,92,3
s_waitcnt vmcnt(0)
v_and_b32 v0, 0x1fff, v8
v_add_u32 v0, s78, v0
R a,32,0,0
R a,48,0,4
v_and_b32 v0, 0x1fff, v9
v_add_u32 v0, s78, v0
R a,36,0,0
R a,52,0,4
v_and_b32 v0, 0x1fff, v10
v_add_u32 v0, s78, v0
R a,40,0,0
R a,56,0,4
v_and_b32 v0, 0x1fff, v11
v_add_u32 v0, s78, v0
R a,44,0,0
R a,60,0,4
W 7
ZB 64,32,224
ZB 68,32,228
W 5
MB 64,36,232
MB 68,36,236
W 3
MB 64,40,240
MB 68,40,244
W 1
MB 64,44,248
MB 68,44,252
ZB 72,48,224
ZB 76,48,228
MB 72,52,232
MB 76,52,236
MB 72,56,240
MB 76,56,244
W 0
MB 72,60,248
MB 76,60,252
v_sub_f32 v64, v64, v62
v_sub_f32 v65, v65, v62
v_sub_f32 v66, v66, v62
v_sub_f32 v67, v67, v62
v_sub_f32 v68, v68, v63
v_sub_f32 v69, v69, v63
v_sub_f32 v70, v70, v63
v_sub_f32 v71, v71, v63
v_sub_f32 v72, v72, v62
v_sub_f32 v73, v73, v62
v_sub_f32 v74, v74, v62
v_sub_f32 v75, v75, v62
v_sub_f32 v76, v76, v63
v_sub_f32 v77, v77, v63
v_sub_f32 v78, v78, v63
v_sub_f32 v79, v79, v63
E 64
E 65
E 66
E 67
E 68
E 69
E 70
E 71
E 72
E 73
E 74
E 75
E 76
E 77
E 78
E 79
v_add_f32 v60, v60, v64
v_add_f32 v60, v60, v65
v_add_f32 v60, v60, v66
v_add_f32 v60, v60, v67
v_add_f32 v61, v61, v68
v_add_f32 v61, v61, v69
v_add_f32 v61, v61, v70
v_add_f32 v61, v61, v71
v_add_f32 v60, v60, v72
v_add_f32 v60, v60, v73
v_add_f32 v60, v60, v74
v_add_f32 v60, v60, v75
v_add_f32 v61, v61, v76
v_add_f32 v61, v61, v77
v_add_f32 v61, v61, v78
v_add_f32 v61, v61, v79
CV 96,64
CV 97,66
CV 100,68
CV 101,70
CV 98,72
CV 99,74
CV 102,76
CV 103,78
s_add_u32 m0, s78, 0
s_add_u32 s92, s94, 0
G 56,16,92,0
G 57,16,92,1
G 56,16,92,2
G 57,16,92,3
s_add_u32 m0, s78, 4096
s_add_u32 s92, s94, 512
G 56,16,92,0
G 57,16,92,1
G 56,16,92,2
G 57,16,92,3
s_waitcnt vmcnt(0)
v_and_b32 v0, 0x1fff, v16
v_add_u32 v0, s78, v0
T 32,0,0
T 34,0,4
v_and_b32 v0, 0x1fff, v17
v_add_u32 v0, s78, v0
T 36,0,0
T 38,0,4
v_and_b32 v0, 0x1fff, v18
v_add_u32 v0, s78, v0
T 40,0,0
T 42,0,4
v_and_b32 v0, 0x1fff, v19
v_add_u32 v0, s78, v0
T 44,0,0
T 46,0,4
v_and_b32 v0, 0x1fff, v20
v_add_u32 v0, s78, v0
T 48,0,0
T 50,0,4
v_and_b32 v0, 0x1fff, v21
v_add_u32 v0, s78, v0
T 52,0,0
T 54,0,4
v_and_b32 v0, 0x1fff, v22
v_add_u32 v0, s78, v0
T 56,0,0
T 58,0,4
v_and_b32 v0, 0x1fff, v23
v_add_u32 v0, s78, v0
T 60,0,0
W 14
T 62,0,4
W 14
MA 192,32,96
MA 196,32,100
W 12
MA 200,36,96
MA 204,36,100
W 10
MA 208,40,96
MA 212,40,100
W 8
MA 216,44,96
MA 220,44,100
W 6
MA 224,48,96
MA 228,48,100
W 4
MA 232,52,96
MA 236,52,100
W 2
MA 240,56,96
MA 244,56,100
W 0
MA 248,60,96
MA 252,60,100
s_nop 15
s_or_b32 s81, s81, 0x7ffe8fff
s_add_u32 s81, s81, 1
s_and_b32 s81, s81, 0x17000
s_add_u32 s94, s80, s81
s_cmp_lg_u32 s81, 0
s_cbranch_scc1 L_slow2_c3A1
v_mov_b32 v1, v60
s_nop 1
v_permlane32_swap_b32 v1, v60
v_add_f32 v60, v60, v1
v_mov_b32 v1, v60
s_nop 1
v_permlane16_swap_b32 v1, v60
v_add_f32 v60, v60, v1
v_mov_b32 v1, v61
s_nop 1
v_permlane32_swap_b32 v1, v61
v_add_f32 v61, v61, v1
v_mov_b32 v1, v61
s_nop 1
v_permlane16_swap_b32 v1, v61
v_add_f32 v61, v61, v1
s_mov_b32 m0, s93
s_nop 4
s_branch L_back_c3A1
L_slow_c3B1:
s_waitcnt vmcnt(0) lgkmcnt(0)
s_nop 15
s_mov_b32 s93, m0
s_andn2_b32 s80, s63, 0x1ff00
s_xor_b32 s80, s80, 0x40000
v_mov_b32 v62, 0xff800000
v_mov_b32 v63, 0xff800000
s_mov_b32 s94, s80
s_mov_b32 s81, 0
L_slow1_c3B1:
s_add_u32 m0, s78, 0
s_add_u32 s92, s94, 0
G 32,32,92,0
G 33,32,92,1
G 34,32,92,2
G 35,32,92,3
s_add_u32 m0, s78, 4096
s_add_u32 s92, s94, 512
G 32,32,92,0
G 33,32,92,1
G 34,32,92,2
G 35,32,92,3
s_waitcnt vmcnt(0)
v_and_b32 v0, 0x1fff, v8
v_add_u32 v0, s78, v0
R a,32,0,0
R a,48,0,4
v_and_b32 v0, 0x1fff, v9
v_add_u32 v0, s78, v0
R a,36,0,0
R a,52,0,4
v_and_b32 v0, 0x1fff, v10
v_add_u32 v0, s78, v0
R a,40,0,0
R a,56,0,4
v_and_b32 v0, 0x1fff, v11
v_add_u32 v0, s78, v0
R a,44,0,0
R a,60,0,4
W 7
ZB 64,32,160
ZB 68,32,164
W 5
MB 64,36,168
MB 68,36,172
W 3
MB 64,40,176
MB 68,40,180
W 1
MB 64,44,184
MB 68,44,188
ZB 72,48,160
ZB 76,48,164
MB 72,52,168
MB 76,52,172
MB 72,56,176
MB 76,56,180
W 0
MB 72,60,184
MB 76,60,188
v_max_f32 v62, v62, v64
v_max_f32 v62, v62, v65
v_max_f32 v62, v62, v66
v_max_f32 v62, v62, v67
v_max_f32 v63, v63, v68
v_max_f32 v63, v63, v69
v_max_f32 v63, v63, v70
v_max_f32 v63, v63, v71
v_max_f32 v62, v62, v72
v_max_f32 v62, v62, v73
v_max_f32 v62, v62, v74
v_max_f32 v62, v62, v75
v_max_f32 v63, v63, v76
v_max_f32 v63, v63, v77
v_max_f32 v63, v63, v78
v_max_f32 v63, v63, v79
s_or_b32 s81, s81, 0x7ffe8fff
s_add_u32 s81, s81, 1
s_and_b32 s81, s81, 0x17000
s_add_u32 s94, s80, s81
s_cmp_lg_u32 s81, 0
s_cbranch_scc1 L_slow1_c3B1
v_mov_b32 v1, v62
s_nop 1
v_permlane32_swap_b32 v1, v62
v_max_f32 v62, v62, v1
v_mov_b32 v1, v62
s_nop 1
v_permlane16_swap_b32 v1, v62
v_max_f32 v62, v62, v1
v_mov_b32 v1, v63
s_nop 1
v_permlane32_swap_b32 v1, v63
v_max_f32 v63, v63, v1
v_mov_b32 v1, v63
s_nop 1
v_permlane16_swap_b32 v1, v63
v_max_f32 v63, v63, v1
v_mov_b32 v60, 0
v_mov_b32 v61, 0
v_accvgpr_write_b32 a128, 0
v_accvgpr_write_b32 a129, 0
v_accvgpr_write_b32 a130, 0
v_accvgpr_write_b32 a131, 0
v_accvgpr_write_b32 a132, 0
v_accvgpr_write_b32 a133, 0
v_accvgpr_write_b32 a134, 0
v_accvgpr_write_b32 a135, 0
v_accvgpr_write_b32 a136, 0
v_accvgpr_write_b32 a137, 0
v_accvgpr_write_b32 a138, 0
v_accvgpr_write_b32 a139, 0
v_accvgpr_write_b32 a140, 0
v_accvgpr_write_b32 a141, 0
v_accvgpr_write_b32 a142, 0
v_accvgpr_write_b32 a143, 0
v_accvgpr_write_b32 a144, 0
v_accvgpr_write_b32 a145, 0
v_accvgpr_write_b32 a146, 0
v_accvgpr_write_b32 a147, 0
v_accvgpr_write_b32 a148, 0
v_accvgpr_write_b32 a149, 0
v_accvgpr_write_b32 a150, 0
v_accvgpr_write_b32 a151, 0
v_accvgpr_write_b32 a152, 0
v_accvgpr_write_b32 a153, 0
v_accvgpr_write_b32 a154, 0
v_accvgpr_write_b32 a155, 0
v_accvgpr_write_b32 a156, 0
v_accvgpr_write_b32 a157, 0
v_accvgpr_write_b32 a158, 0
v_accvgpr_write_b32 a159, 0
v_accvgpr_write_b32 a96, 0
v_accvgpr_write_b32 a97, 0
v_accvgpr_write_b32 a98, 0
v_accvgpr_write_b32 a99, 0
v_accvgpr_write_b32 a100, 0
v_accvgpr_write_b32 a101, 0
v_accvgpr_write_b32 a102, 0
v_accvgpr_write_b32 a103, 0
v_accvgpr_write_b32 a104, 0
v_accvgpr_write_b32 a105, 0
v_accvgpr_write_b32 a106, 0
v_accvgpr_write_b32 a107, 0
v_accvgpr_write_b32 a108, 0
v_accvgpr_write_b32 a109, 0
v_accvgpr_write_b32 a110, 0
v_accvgpr_write_b32 a111, 0
v_accvgpr_write_b32 a112, 0
v_accvgpr_write_b32 a113, 0
v_accvgpr_write_b32 a114, 0
v_accvgpr_write_b32 a115, 0
v_accvgpr_write_b32 a116, 0
v_accvgpr_write_b32 a117, 0
v_accvgpr_write_b32 a118, 0
v_accvgpr_write_b32 a119, 0
v_accvgpr_write_b32 a120, 0
v_accvgpr_write_b32 a121, 0
v_accvgpr_write_b32 a122, 0
v_accvgpr_write_b32 a123, 0
v_accvgpr_write_b32 a124, 0
v_accvgpr_write_b32 a125, 0
v_accvgpr_write_b32 a126, 0
v_accvgpr_write_b32 a127, 0
s_mov_b32 s94, s80
s_mov_b32 s81, 0
s_nop 4
L_slow2_c3B1:
s_add_u32 m0, s78, 0
s_add_u32 s92, s94, 0
G 32,32,92,0
G 33,32,92,1
G 34,32,92,2
G 35,32,92,3
s_add_u32 m0, s78, 4096
s_add_u32 s92, s94, 512
G 32,32,92,0
G 33,32,92,1
G 34,32,92,2
G 35,32,92,3
s_waitcnt vmcnt(0)
v_and_b32 v0, 0x1fff, v8
v_add_u32 v0, s78, v0
R a,32,0,0
R a,48,0,4
v_and_b32 v0, 0x1fff, v9
v_add_u32 v0, s78, v0
R a,36,0,0
R a,52,0,4
v_and_b32 v0, 0x1fff, v10
v_add_u32 v0, s78, v0
R a,40,0,0
R a,56,0,4
v_and_b32 v0, 0x1fff, v11
v_add_u32 v0, s78, v0
R a,44,0,0
R a,60,0,4
W 7
ZB 64,32,160
ZB 68,32,164
W 5
MB 64,36,168
MB 68,36,172
W 3
MB 64,40,176
MB 68,40,180
W 1
MB 64,44,184
MB 68,44,188
ZB 72,48,160
ZB 76,48,164
MB 72,52,168
MB 76,52,172
MB 72,56,176
MB 76,56,180
W 0
MB 72,60,184
MB 76,60,188
v_sub_f32 v64, v64, v62
v_sub_f32 v65, v65, v62
v_sub_f32 v66, v66, v62
v_sub_f32 v67, v67, v62
v_sub_f32 v68, v68, v63
v_sub_f32 v69, v69, v63
v_sub_f32 v70, v70, v63
v_sub_f32 v71, v71, v63
v_sub_f32 v72, v72, v62
v_sub_f32 v73, v73, v62
v_sub_f32 v74, v74, v62
v_sub_f32 v75, v75, v62
v_sub_f32 v76, v76, v63
v_sub_f32 v77, v77, v63
v_sub_f32 v78, v78, v63
v_sub_f32 v79, v79, v63
E 64
E 65
E 66
E 67
E 68
E 69
E 70
E 71
E 72
E 73
E 74
E 75
E 76
E 77
E 78
E 79
v_add_f32 v60, v60, v64
v_add_f32 v60, v60, v65
v_add_f32 v60, v60, v66
v_add_f32 v60, v60, v67
v_add_f32 v61, v61, v68
v_add_f32 v61, v61, v69
v_add_f32 v61, v61, v70
v_add_f32 v61, v61, v71
v_add_f32 v60, v60, v72
v_add_f32 v60, v60, v73
v_add_f32 v60, v60, v74
v_add_f32 v60, v60, v75
v_add_f32 v61, v61, v76
v_add_f32 v61, v61, v77
v_add_f32 v61, v61, v78
v_add_f32 v61, v61, v79
CV 96,64
CV 97,66
CV 100,68
CV 101,70
CV 98,72
CV 99,74
CV 102,76
CV 103,78
s_add_u32 m0, s78, 0
s_add_u32 s92, s94, 0
G 56,36,92,0
G 57,36,92,1
G 56,36,92,2
G 57,36,92,3
s_add_u32 m0, s78, 4096
s_add_u32 s92, s94, 512
G 56,36,92,0
G 57,36,92,1
G 56,36,92,2
G 57,36,92,3
s_waitcnt vmcnt(0)
v_and_b32 v0, 0x1fff, v16
v_add_u32 v0, s78, v0
T 32,0,0
T 34,0,4
v_and_b32 v0, 0x1fff, v17
v_add_u32 v0, s78, v0
T 36,0,0
T 38,0,4
v_and_b32 v0, 0x1fff, v18
v_add_u32 v0, s78, v0
T 40,0,0
T 42,0,4
v_and_b32 v0, 0x1fff, v19
v_add_u32 v0, s78, v0
T 44,0,0
T 46,0,4
v_and_b32 v0, 0x1fff, v20
v_add_u32 v0, s78, v0
T 48,0,0
T 50,0,4
v_and_b32 v0, 0x1fff, v21
v_add_u32 v0, s78, v0
T 52,0,0
T 54,0,4
v_and_b32 v0, 0x1fff, v22
v_add_u32 v0, s78, v0
T 56,0,0
T 58,0,4
v_and_b32 v0, 0x1fff, v23
v_add_u32 v0, s78, v0
T 60,0,0
W 14
T 62,0,4
W 14
MC 128,32,96
MC 132,32,100
W 12
MC 136,36,96
MC 140,36,100
W 10
MC 144,40,96
MC 148,40,100
W 8
MC 152,44,96
MC 156,44,100
W 6
MC 96,48,96
MC 100,48,100
W 4
MC 104,52,96
MC 108,52,100
W 2
MC 112,56,96
MC 116,56,100
W 0
MC 120,60,96
MC 124,60,100
s_nop 15
s_or_b32 s81, s81, 0x7ffe8fff
s_add_u32 s81, s81, 1
s_and_b32 s81, s81, 0x17000
s_add_u32 s94, s80, s81
s_cmp_lg_u32 s81, 0
s_cbranch_scc1 L_slow2_c3B1
v_mov_b32 v1, v60
s_nop 1
v_permlane32_swap_b32 v1, v60
v_add_f32 v60, v60, v1
v_mov_b32 v1, v60
s_nop 1
v_permlane16_swap_b32 v1, v60
v_add_f32 v60, v60, v1
v_mov_b32 v1, v61
s_nop 1
v_permlane32_swap_b32 v1, v61
v_add_f32 v61, v61, v1
v_mov_b32 v1, v61
s_nop 1
v_permlane16_swap_b32 v1, v61
v_add_f32 v61, v61, v1
s_mov_b32 m0, s93
s_nop 4
s_branch L_back_c3B1
L_wi_c3:
s_sleep 6
v_mov_b32 v62, 0
buffer_load_dword v4, v62, s[96:99], s87 offen sc1
s_waitcnt vmcnt(0)
s_add_u32 s6, s6, 1
s_cmp_ge_u32 s6, 0x100000
s_cbranch_scc1 L_gi_c3
s_branch L_ci_c3
L_we_c3:
s_sleep 6
buffer_load_dword v3, v7, s[52:55], s72 offen offset:0 sc1
buffer_load_dword v4, v7, s[52:55], s72 offen offset:128 sc1
s_waitcnt vmcnt(0)
s_add_u32 s6, s6, 1
s_cmp_ge_u32 s6, 0x100000
s_cbranch_scc1 L_ge_c3
s_branch L_ce_c3
L_wm_c3:
s_sleep 6
buffer_load_dword v0, v7, s[52:55], s72 offen offset:256 sc1
s_waitcnt vmcnt(0)
s_add_u32 s6, s6, 1
s_cmp_ge_u32 s6, 0x100000
s_cbranch_scc1 L_gm_c3
s_branch L_cm_c3
L_wl_c3:
s_sleep 6
buffer_load_dword v4, v7, s[52:55], s72 offen offset:384 sc1
s_waitcnt vmcnt(0)
s_add_u32 s6, s6, 1
s_cmp_ge_u32 s6, 0x100000
s_cbranch_scc1 L_gl_c3
s_branch L_cl_c3
L_code_end:
.section .rodata,"a"
.p2align 6
.amdhsa_kernel concat_heads__gqa_block_cached__mha_block_cached__near_ridge_kernel
  .amdhsa_next_free_vgpr 512
  .amdhsa_next_free_sgpr 102
  .amdhsa_accum_offset 256
  .amdhsa_group_segment_fixed_size 0
  .amdhsa_kernarg_size 104
  .amdhsa_user_sgpr_count 2
  .amdhsa_user_sgpr_kernarg_segment_ptr 1
  .amdhsa_system_sgpr_workgroup_id_x 1
.end_amdhsa_kernel
```
